```python
import torch

def _softmax(x, axis=-1):
    return torch.softmax(x, dim=axis)
def _gelu(x):
    return torch.nn.functional.gelu(x, approximate="tanh")
def _silu(x):
    return torch.nn.functional.silu(x)
def _sigmoid(x):
    return torch.sigmoid(x)
def _layernorm(x, axis=-1, eps=1e-5):
    m = x.mean(dim=axis, keepdim=True)
    v = x.var(dim=axis, keepdim=True, unbiased=False)
    return (x - m) / torch.sqrt(v + eps)
def _scatter_add(tgt, idx, src, axis=0):
    return tgt.clone().index_add_(axis, idx, src)
def _segment_sum(src, seg, n):
    out = torch.zeros((n,) + src.shape[1:], dtype=src.dtype)
    return out.index_add_(0, seg, src)
def _pad(x, pw):
    flat = tuple(v for pair in reversed(pw) for v in pair)
    return torch.nn.functional.pad(x, flat)

kernel_name = 'concat_heads__ssm_conv_h3__compressed_kv_cla__prompt'

def setup_inputs():

    _w = (lambda a: (lambda t: t.to(torch.bfloat16) if t.is_floating_point() else t)(torch.as_tensor(a)))
    def _A_setup():
        B, S, D = 1, 2048, 512
        ks = 4
        return {
            "q": _w((lambda *s: torch.randn(*s, dtype=torch.bfloat16) * 0.05)(B, S, D)),
            "k": _w((lambda *s: torch.randn(*s, dtype=torch.bfloat16) * 0.1)(B, S, D)),
            "v": _w((lambda *s: torch.randn(*s, dtype=torch.bfloat16) * 0.1)(B, S, D)),
            "shift_k": _w((lambda *s: torch.randn(*s, dtype=torch.bfloat16) * 0.1)(D, ks) * 0.5),
            "ssm_k": _w((lambda *s: torch.randn(*s, dtype=torch.bfloat16) * 0.1)(D, S) * (1.0 / S ** 0.5)),
            "ssm_D": _w((lambda *s: torch.randn(*s, dtype=torch.bfloat16) * 0.1)(D)),
        }
    _A_in = _A_setup()

    def _B_setup():
        B, H, Sq, Sk, D, M = 1, 32, 2048, 2048, 128, 512
        Dc = 4 * D
        return {
            "x": _w((lambda *s: torch.randn(*s, dtype=torch.bfloat16) * 3.2)(B, Sq, M)),
            "c_kv": _w((lambda *s: torch.randn(*s, dtype=torch.bfloat16) * 0.05)(B, Sk, Dc)),
            "w_q": _w((lambda *s: torch.randn(*s, dtype=torch.bfloat16) * 3.2)(M, H, D) * (M ** -0.5)),
            "w_uk": _w((lambda *s: torch.randn(*s, dtype=torch.bfloat16) * 3.2)(Dc, H, D) * (Dc ** -0.5)),
            "w_uv": _w((lambda *s: torch.randn(*s, dtype=torch.bfloat16) * 0.05)(Dc, H, D) * (Dc ** -0.5)),
            "w_o": _w((lambda *s: torch.randn(*s, dtype=torch.bfloat16) * 0.05)(H, D, M) * ((H * D) ** -0.5)),
        }
    _B_in = _B_setup()

    return {
        "A_q": _A_in["q"],
        "A_k": _A_in["k"],
        "A_v": _A_in["v"],
        "A_shift_k": _A_in["shift_k"],
        "A_ssm_k": _A_in["ssm_k"],
        "A_ssm_D": _A_in["ssm_D"],
        "B_x": _B_in["x"],
        "B_c_kv": _B_in["c_kv"],
        "B_w_q": _B_in["w_q"],
        "B_w_uk": _B_in["w_uk"],
        "B_w_uv": _B_in["w_uv"],
        "B_w_o": _B_in["w_o"],
    }

def reference(A_q, A_k, A_v, A_shift_k, A_ssm_k, A_ssm_D, B_x, B_c_kv, B_w_q, B_w_uk, B_w_uv, B_w_o):
    def _A_ref(q, k, v, shift_k, ssm_k, ssm_D):
        B, S, D = q.shape
        ks = shift_k.shape[-1]
        k_pad = _pad(k, ((0, 0), (ks - 1, 0), (0, 0)))
        k_shift = torch.zeros_like(k)
        for t in range(ks):
            k_shift = k_shift + k_pad[:, t:t + S, :] * shift_k[:, ks - 1 - t][None, None, :]
        kv = k_shift * v
        L = 2 * S
        kv_pad = _pad(kv, ((0, 0), (0, S), (0, 0)))
        kf_pad = _pad(ssm_k, ((0, 0), (0, S)))
        kv_f = (lambda x, axes=(-2,-1): torch.fft.rfft2(x.float(), dim=axes))(kv_pad[:, None, :, :], axes=(1, 2))
        kf_f = (lambda x, axes=(-2,-1): torch.fft.rfft2(x.float(), dim=axes))(kf_pad[:, None, :], axes=(1, 2))
        kf_f = (lambda x, *d: x.permute(*d))(kf_f, 1, 2, 0)
        y_f = kv_f * kf_f[None, :, :, :]
        y = (lambda x, s, axes=(-2,-1): torch.fft.irfft2(x, s=s, dim=axes).to(torch.bfloat16))(y_f, (1, L), axes=(1, 2))[:, 0, :S, :]
        y = y + kv * ssm_D[None, None, :]
        return q * y

    def _B_ref(x, c_kv, w_q, w_uk, w_uv, w_o):
        B, Sq, M = x.shape[0], x.shape[1], x.shape[2]
        Sk = c_kv.shape[1]
        H, D = w_q.shape[1], w_q.shape[2]
        q = torch.einsum("bqm,mhd->bhqd", x, w_q)
        k = torch.einsum("bkc,chd->bhkd", c_kv, w_uk)
        v = torch.einsum("bkc,chd->bhkd", c_kv, w_uv)
        scores = torch.einsum("bhqd,bhkd->bhqk", q, k) * (D ** -0.5)
        off = Sk - Sq
        qi = torch.arange(Sq)[:, None]
        kj = torch.arange(Sk)[None, :]
        cmask = kj <= (qi + off)
        scores = torch.where(cmask[None, None], scores, -1e9)
        p = _softmax(scores, axis=-1)
        ctx = torch.einsum("bhqk,bhkd->bhqd", p, v)
        return torch.einsum("bhqd,hdm->bqm", ctx, w_o)

    a = _A_ref(A_q, A_k, A_v, A_shift_k, A_ssm_k, A_ssm_D)
    b = _B_ref(B_x, B_c_kv, B_w_q, B_w_uk, B_w_uv, B_w_o)
    return torch.concatenate([a, b], axis=-1)
```

```asm
; @launch grid=(256,1,1) block=(256,1,1) lds=163840
.amdgcn_target "amdgcn-amd-amdhsa--gfx950"
.text
.globl concat_heads__ssm_conv_h3__compressed_kv_cla__prompt_kernel
.p2align 8
.type concat_heads__ssm_conv_h3__compressed_kv_cla__prompt_kernel,@function
concat_heads__ssm_conv_h3__compressed_kv_cla__prompt_kernel:
s_cmp_ge_u32 s2,256
s_cbranch_scc1 F_END
s_load_dwordx8 s[72:79],s[0:1],48
s_load_dwordx2 s[4:5],s[0:1],80
s_load_dwordx2 s[16:17],s[0:1],112
s_load_dwordx2 s[90:91],s[0:1],88
s_load_dwordx4 s[92:95],s[0:1],96
s_load_dwordx8 s[56:63],s[0:1],0
s_load_dwordx4 s[24:27],s[0:1],32
v_lshrrev_b32 v20,6,v0
v_and_b32 v7,63,v0
v_readfirstlane_b32 s20,v20
s_and_b32 s21,s2,7
s_lshl_b32 s21,s21,2
s_bfe_u32 s28,s2,0x20003
s_add_u32 s21,s21,s28
s_lshr_b32 s22,s2,5
s_lshl_b32 s68,s20,13
s_mov_b32 s32,0
s_mov_b32 s33,8192
s_mov_b32 s34,16384
s_mov_b32 s35,24576
s_mov_b32 s36,524288
s_mov_b32 s37,532480
s_mov_b32 s38,540672
s_mov_b32 s39,548864
v_lshrrev_b32 v20,3,v7
v_and_b32 v21,6,v20
v_xor_b32 v21,v21,v7
v_and_b32 v21,7,v21
v_lshlrev_b32 v21,4,v21
v_lshl_add_u32 v4,v20,10,v21
s_lshl_b32 s28,s22,16
s_and_b32 s29,s20,1
s_lshl_b32 s30,s29,20
s_add_u32 s28,s28,s30
s_lshr_b32 s30,s20,1
s_lshl_b32 s30,s30,15
s_add_u32 s71,s28,s30
s_add_u32 s88,s22,s21
s_and_b32 s88,s88,0
s_lshl_b32 s30,s88,9
s_add_u32 s28,s71,s30
v_add_u32 v4,s28,v4
s_sub_u32 s71,s71,s30
s_waitcnt lgkmcnt(0)
s_mov_b32 s8,s74
s_and_b32 s9,s75,0xffff
s_mov_b32 s10,2097152
s_mov_b32 s11,0x20000
s_add_u32 m0,s68,0
s_nop 0
buffer_load_dwordx4 v4,s[8:11],s32 offen lds
s_add_u32 m0,s68,1024
s_nop 0
buffer_load_dwordx4 v4,s[8:11],s33 offen lds
s_add_u32 m0,s68,2048
s_nop 0
buffer_load_dwordx4 v4,s[8:11],s34 offen lds
s_add_u32 m0,s68,3072
s_nop 0
buffer_load_dwordx4 v4,s[8:11],s35 offen lds
s_add_u32 m0,s68,4096
s_nop 0
buffer_load_dwordx4 v4,s[8:11],s36 offen lds
s_add_u32 m0,s68,5120
s_nop 0
buffer_load_dwordx4 v4,s[8:11],s37 offen lds
s_add_u32 m0,s68,6144
s_nop 0
buffer_load_dwordx4 v4,s[8:11],s38 offen lds
s_add_u32 m0,s68,7168
s_nop 0
buffer_load_dwordx4 v4,s[8:11],s39 offen lds
s_mov_b32 s40,0
s_mov_b32 s41,131072
s_mov_b32 s42,32768
s_mov_b32 s43,163840
s_mov_b32 s44,262144
s_mov_b32 s45,393216
s_mov_b32 s46,294912
s_mov_b32 s47,425984
v_lshrrev_b32 v21,2,v20
v_lshlrev_b32 v21,3,v21
v_and_b32 v22,3,v20
v_add_u32 v21,v21,v22
v_lshlrev_b32 v5,13,v21
v_bfe_u32 v21,v7,1,2
v_lshrrev_b32 v22,4,v7
v_xor_b32 v21,v21,v22
v_lshl_add_u32 v5,v21,5,v5
v_and_b32 v21,1,v7
v_lshl_add_u32 v5,v21,4,v5
s_lshl_b32 s28,s21,8
s_lshl_b32 s29,s29,7
s_add_u32 s28,s28,s29
s_lshl_b32 s29,s88,21
s_add_u32 s28,s28,s29
v_add_u32 v5,s28,v5
s_cmp_lt_u32 s20,2
s_cselect_b32 s12,s78,s4
s_cselect_b32 s13,s79,s5
s_and_b32 s13,s13,0xffff
s_mov_b32 s14,4194304
s_mov_b32 s15,0x20000
s_add_u32 m0,s68,65536
s_nop 0
buffer_load_dwordx4 v5,s[12:15],s40 offen nt lds
s_add_u32 m0,s68,66560
s_nop 0
buffer_load_dwordx4 v5,s[12:15],s41 offen nt lds
s_add_u32 m0,s68,67584
s_nop 0
buffer_load_dwordx4 v5,s[12:15],s42 offen nt lds
s_and_b32 s17,s17,0xffff
s_mov_b32 s18,134217728
s_mov_b32 s19,0x20000
v_mov_b32 v21,0
s_lshl_b32 s99,s20,3
s_and_b32 s28,s2,7
s_add_u32 s99,s99,s28
s_lshl_b32 s99,s99,5
s_lshr_b32 s28,s2,3
s_add_u32 s99,s99,s28
s_lshl_b32 s99,s99,7
s_add_u32 s99,s99,62914560
v_mov_b32 v24,0
v_mov_b32 v25,0
v_mov_b32 v26,0
v_mov_b32 v27,0
s_lshl_b32 s23,s20,12
v_lshlrev_b32 v1,4,v7
s_sub_u32 s28,15,s22
s_lshl_b32 s28,s28,3
s_lshr_b32 s29,s20,1
s_add_u32 s28,s28,s29
s_and_b32 s29,s20,1
s_lshl_b32 s29,s29,1
s_add_u32 s80,s28,s29
s_add_u32 s81,s28,6
s_sub_u32 s81,s81,s29
s_add_u32 s84,s28,2
s_sub_u32 s84,s84,s29
s_add_u32 s85,s28,4
s_add_u32 s85,s85,s29
s_lshl_b32 s28,s22,3
s_add_u32 s82,s28,s20
s_add_u32 s83,s82,4
s_and_b32 s28,s2,7
s_lshl_b32 s28,s28,5
s_lshr_b32 s29,s2,3
s_add_u32 s28,s28,s29
s_lshl_b32 s28,s28,2
s_load_dword s89,s[26:27],s28
s_lshl_b32 s28,s88,10
s_sub_u32 s86,128,s28
s_lshl_b32 s28,s88,22
s_sub_u32 s87,524288,s28
s_lshl_b32 s28,s88,21
s_sub_u32 s88,3670016,s28
v_and_b32 v20,15,v7
v_lshrrev_b32 v21,4,v7
v_and_b32 v22,6,v20
v_xor_b32 v21,v21,v22
v_lshlrev_b32 v21,4,v21
v_lshl_add_u32 v6,v20,7,v21
s_lshr_b32 s28,s20,1
s_lshl_b32 s28,s28,14
v_add_u32 v2,s28,v6
v_xor_b32 v3,64,v2
v_lshrrev_b32 v20,2,v7
v_lshlrev_b32 v20,7,v20
v_and_b32 v21,3,v7
v_lshl_add_u32 v20,v21,3,v20
v_bfe_u32 v21,v7,3,2
v_lshl_add_u32 v20,v21,5,v20
s_and_b32 s28,s20,1
s_lshl_b32 s28,s28,14
s_add_u32 s28,s28,65536
v_add_u32 v20,s28,v20
v_xor_b32 v8,0,v20
v_add_u32 v12,65536,v8
v_xor_b32 v9,32,v20
v_add_u32 v13,65536,v9
v_xor_b32 v10,64,v20
v_add_u32 v14,65536,v10
v_xor_b32 v11,96,v20
v_add_u32 v15,65536,v11
s_lshl_b32 s28,s21,19
s_lshl_b32 s29,s22,14
s_add_u32 s28,s28,s29
s_lshr_b32 s29,s20,1
s_lshl_b32 s30,s29,13
s_lshl_b32 s29,s29,12
s_add_u32 s29,s29,16777216
s_bitcmp1_b32 s20,0
s_cselect_b32 s29,s29,s30
s_movk_i32 s30,4096
s_cselect_b32 s30,8192,s30
s_add_u32 s48,s28,s29
s_add_u32 s49,s48,s30
s_add_u32 s50,s48,131072
s_add_u32 s51,s49,131072
s_add_u32 s52,s50,131072
s_add_u32 s53,s51,131072
s_add_u32 s54,s52,131072
s_add_u32 s55,s53,131072
s_lshr_b32 s64,s22,2
s_lshl_b32 s64,s64,5
s_and_b32 s28,s22,1
s_lshl_b32 s28,s28,4
s_add_u32 s64,s64,s28
s_and_b32 s28,s22,2
s_lshl_b32 s28,s28,1
s_add_u32 s64,s64,s28
s_lshl_b32 s64,s64,13
s_and_b32 s65,s21,2
s_lshl_b32 s65,s65,18
s_and_b32 s28,s21,1
s_lshl_b32 s28,s28,14
s_add_u32 s65,s65,s28
s_add_u32 s66,s65,8192
v_lshrrev_b32 v28,2,v7
v_lshlrev_b32 v28,7,v28
s_lshl_b32 s67,s2,13
s_lshl_b32 s28,s20,11
s_add_u32 s67,s67,s28
s_and_b32 s28,s20,1
s_lshl_b32 s28,s28,13
s_lshr_b32 s29,s20,1
s_lshl_b32 s29,s29,12
s_add_u32 s69,s28,s29
s_mov_b32 s70,0x3e0293ee
s_cmp_lt_u32 s20,2
s_cselect_b32 s100,s76,s72
s_cselect_b32 s101,s77,s73
s_movk_i32 s28,256
s_cselect_b32 s79,1048576,s28
s_cselect_b64 vcc,-1,0
s_lshl_b32 s28,s22,17
s_lshl_b32 s29,s21,8
s_add_u32 s28,s28,s29
s_and_b32 s30,s20,1
s_lshl_b32 s29,s30,7
s_add_u32 s28,s28,s29
v_and_b32 v20,15,v7
v_lshlrev_b32 v20,13,v20
v_add_u32 v20,s28,v20
s_lshl_b32 s28,s2,13
s_lshl_b32 s29,s30,12
s_add_u32 s28,s28,s29
v_and_b32 v21,3,v7
v_lshlrev_b32 v21,10,v21
v_bfe_u32 v22,v7,2,1
v_lshl_add_u32 v21,v22,7,v21
v_add_u32 v21,s28,v21
v_cndmask_b32 v0,v21,v20,vcc
s_mov_b32 s74,s56
s_mov_b32 s75,s57
s_mov_b32 s4,s58
s_and_b32 s5,s59,0xffff
s_mov_b32 s6,2097152
s_mov_b32 s7,0x20000
s_add_u32 m0,s68,68608
s_nop 0
buffer_load_dwordx4 v5,s[12:15],s43 offen nt lds
s_add_u32 m0,s68,69632
s_nop 0
buffer_load_dwordx4 v5,s[12:15],s44 offen nt lds
s_add_u32 m0,s68,70656
s_nop 0
buffer_load_dwordx4 v5,s[12:15],s45 offen nt lds
s_add_u32 m0,s68,71680
s_nop 0
buffer_load_dwordx4 v5,s[12:15],s46 offen nt lds
s_add_u32 m0,s68,72704
s_nop 0
buffer_load_dwordx4 v5,s[12:15],s47 offen nt lds
s_getpc_b64 s[28:29]
F_PC:
s_lshr_b32 s30,s2,3
s_lshl_b32 s30,s30,2
s_add_u32 s30,s30,s20
s_lshl_b32 s30,s30,10
v_and_b32 v20,7,v7
v_lshlrev_b32 v20,7,v20
v_add_u32 v20,s30,v20
v_min_u32 v20,F_END-F_PC,v20
global_load_dword a249,v20,s[28:29]
v_accvgpr_write_b32 a251,v20
v_add_u32 v4,128,v4
s_add_u32 m0,s68,32768
s_nop 0
buffer_load_dwordx4 v4,s[8:11],s32 offen lds
s_add_u32 m0,s68,33792
s_nop 0
buffer_load_dwordx4 v4,s[8:11],s33 offen lds
s_add_u32 m0,s68,34816
s_nop 0
buffer_load_dwordx4 v4,s[8:11],s34 offen lds
s_add_u32 m0,s68,35840
s_nop 0
buffer_load_dwordx4 v4,s[8:11],s35 offen lds
s_add_u32 m0,s68,36864
s_nop 0
buffer_load_dwordx4 v4,s[8:11],s36 offen lds
s_add_u32 m0,s68,37888
s_nop 0
buffer_load_dwordx4 v4,s[8:11],s37 offen lds
s_add_u32 m0,s68,38912
s_nop 0
buffer_load_dwordx4 v4,s[8:11],s38 offen lds
s_add_u32 m0,s68,39936
s_nop 0
buffer_load_dwordx4 v4,s[8:11],s39 offen lds
s_mov_b64 exec,0xff
buffer_store_dwordx4 v[24:27],v1,s[16:19],s99 offen sc1
s_mov_b64 exec,-1
buffer_load_dword a248,v28,s[8:11],s67 offen
s_waitcnt vmcnt(11) lgkmcnt(0)
s_barrier
ds_read_b64_tr_b16 a[160:161],v8 offset:0
ds_read_b64_tr_b16 a[162:163],v8 offset:2048
ds_read_b64_tr_b16 a[164:165],v8 offset:4096
ds_read_b64_tr_b16 a[166:167],v8 offset:6144
ds_read_b128 a[32:35],v2 offset:0
ds_read_b128 a[36:39],v3 offset:0
ds_read_b128 a[40:43],v2 offset:2048
ds_read_b128 a[44:47],v3 offset:2048
ds_read_b128 a[48:51],v2 offset:4096
ds_read_b128 a[52:55],v3 offset:4096
ds_read_b128 a[56:59],v2 offset:6144
ds_read_b128 a[60:63],v3 offset:6144
s_bitcmp1_b32 s20,0
s_cbranch_scc1 F_A1
s_waitcnt lgkmcnt(7)
v_mfma_f32_16x16x32_bf16 a[0:3],a[160:163],a[32:35],0
ds_read_b128 a[64:67],v2 offset:8192
s_waitcnt lgkmcnt(7)
v_mfma_f32_16x16x32_bf16 a[0:3],a[164:167],a[36:39],a[0:3]
ds_read_b128 a[68:71],v3 offset:8192
s_waitcnt lgkmcnt(7)
v_mfma_f32_16x16x32_bf16 a[8:11],a[160:163],a[40:43],0
ds_read_b128 a[72:75],v2 offset:10240
s_waitcnt lgkmcnt(7)
v_mfma_f32_16x16x32_bf16 a[8:11],a[164:167],a[44:47],a[8:11]
ds_read_b128 a[76:79],v3 offset:10240
s_waitcnt lgkmcnt(7)
v_mfma_f32_16x16x32_bf16 v[64:67],a[160:163],a[48:51],0
ds_read_b128 a[80:83],v2 offset:12288
s_waitcnt lgkmcnt(7)
v_mfma_f32_16x16x32_bf16 v[64:67],a[164:167],a[52:55],v[64:67]
ds_read_b128 a[84:87],v3 offset:12288
s_waitcnt lgkmcnt(7)
v_mfma_f32_16x16x32_bf16 v[72:75],a[160:163],a[56:59],0
ds_read_b128 a[88:91],v2 offset:14336
s_waitcnt lgkmcnt(7)
v_mfma_f32_16x16x32_bf16 v[72:75],a[164:167],a[60:63],v[72:75]
ds_read_b128 a[92:95],v3 offset:14336
s_waitcnt lgkmcnt(7)
v_mfma_f32_16x16x32_bf16 v[128:131],a[160:163],a[64:67],0
ds_read_b64_tr_b16 a[168:169],v9 offset:0
s_waitcnt lgkmcnt(7)
v_mfma_f32_16x16x32_bf16 v[128:131],a[164:167],a[68:71],v[128:131]
ds_read_b64_tr_b16 a[170:171],v9 offset:2048
s_waitcnt lgkmcnt(7)
v_mfma_f32_16x16x32_bf16 v[136:139],a[160:163],a[72:75],0
ds_read_b64_tr_b16 a[172:173],v9 offset:4096
s_waitcnt lgkmcnt(7)
v_mfma_f32_16x16x32_bf16 v[136:139],a[164:167],a[76:79],v[136:139]
s_add_u32 m0,s68,98304
v_add_u32 v5,524288,v5
s_waitcnt lgkmcnt(6)
v_mfma_f32_16x16x32_bf16 v[192:195],a[160:163],a[80:83],0
ds_read_b64_tr_b16 a[174:175],v9 offset:6144
s_waitcnt lgkmcnt(6)
v_mfma_f32_16x16x32_bf16 v[192:195],a[164:167],a[84:87],v[192:195]
buffer_load_dwordx4 v5,s[12:15],s40 offen nt lds
s_waitcnt lgkmcnt(5)
v_mfma_f32_16x16x32_bf16 v[200:203],a[160:163],a[88:91],0
s_add_u32 m0,s68,99328
s_waitcnt lgkmcnt(4)
v_mfma_f32_16x16x32_bf16 v[200:203],a[164:167],a[92:95],v[200:203]
buffer_load_dwordx4 v5,s[12:15],s41 offen nt lds
s_waitcnt lgkmcnt(2)
v_mfma_f32_16x16x32_bf16 a[4:7],a[168:171],a[32:35],0
ds_read_b64_tr_b16 a[176:177],v10 offset:0
s_add_u32 m0,s68,100352
s_waitcnt lgkmcnt(1)
v_mfma_f32_16x16x32_bf16 a[4:7],a[172:175],a[36:39],a[4:7]
ds_read_b64_tr_b16 a[178:179],v10 offset:2048
v_mfma_f32_16x16x32_bf16 a[12:15],a[168:171],a[40:43],0
ds_read_b64_tr_b16 a[180:181],v10 offset:4096
v_mfma_f32_16x16x32_bf16 a[12:15],a[172:175],a[44:47],a[12:15]
ds_read_b64_tr_b16 a[182:183],v10 offset:6144
v_mfma_f32_16x16x32_bf16 v[68:71],a[168:171],a[48:51],0
v_mfma_f32_16x16x32_bf16 v[68:71],a[172:175],a[52:55],v[68:71]
buffer_load_dwordx4 v5,s[12:15],s42 offen nt lds
v_mfma_f32_16x16x32_bf16 v[76:79],a[168:171],a[56:59],0
s_add_u32 m0,s68,101376
v_mfma_f32_16x16x32_bf16 v[76:79],a[172:175],a[60:63],v[76:79]
v_mfma_f32_16x16x32_bf16 v[132:135],a[168:171],a[64:67],0
v_mfma_f32_16x16x32_bf16 v[132:135],a[172:175],a[68:71],v[132:135]
buffer_load_dwordx4 v5,s[12:15],s43 offen nt lds
v_mfma_f32_16x16x32_bf16 v[140:143],a[168:171],a[72:75],0
s_add_u32 m0,s68,102400
v_mfma_f32_16x16x32_bf16 v[140:143],a[172:175],a[76:79],v[140:143]
v_mfma_f32_16x16x32_bf16 v[196:199],a[168:171],a[80:83],0
v_mfma_f32_16x16x32_bf16 v[196:199],a[172:175],a[84:87],v[196:199]
buffer_load_dwordx4 v5,s[12:15],s44 offen nt lds
v_mfma_f32_16x16x32_bf16 v[204:207],a[168:171],a[88:91],0
s_add_u32 m0,s68,103424
v_mfma_f32_16x16x32_bf16 v[204:207],a[172:175],a[92:95],v[204:207]
s_waitcnt lgkmcnt(0)
v_mfma_f32_16x16x32_bf16 a[16:19],a[176:179],a[32:35],0
ds_read_b64_tr_b16 a[184:185],v11 offset:0
v_mfma_f32_16x16x32_bf16 a[16:19],a[180:183],a[36:39],a[16:19]
ds_read_b64_tr_b16 a[186:187],v11 offset:2048
v_mfma_f32_16x16x32_bf16 a[24:27],a[176:179],a[40:43],0
ds_read_b64_tr_b16 a[188:189],v11 offset:4096
v_mfma_f32_16x16x32_bf16 a[24:27],a[180:183],a[44:47],a[24:27]
ds_read_b64_tr_b16 a[190:191],v11 offset:6144
v_mfma_f32_16x16x32_bf16 v[80:83],a[176:179],a[48:51],0
v_mfma_f32_16x16x32_bf16 v[80:83],a[180:183],a[52:55],v[80:83]
buffer_load_dwordx4 v5,s[12:15],s45 offen nt lds
v_mfma_f32_16x16x32_bf16 v[88:91],a[176:179],a[56:59],0
s_add_u32 m0,s68,104448
v_mfma_f32_16x16x32_bf16 v[88:91],a[180:183],a[60:63],v[88:91]
v_mfma_f32_16x16x32_bf16 v[144:147],a[176:179],a[64:67],0
v_mfma_f32_16x16x32_bf16 v[144:147],a[180:183],a[68:71],v[144:147]
buffer_load_dwordx4 v5,s[12:15],s46 offen nt lds
v_mfma_f32_16x16x32_bf16 v[152:155],a[176:179],a[72:75],0
s_add_u32 m0,s68,105472
v_mfma_f32_16x16x32_bf16 v[152:155],a[180:183],a[76:79],v[152:155]
v_mfma_f32_16x16x32_bf16 v[208:211],a[176:179],a[80:83],0
v_mfma_f32_16x16x32_bf16 v[208:211],a[180:183],a[84:87],v[208:211]
buffer_load_dwordx4 v5,s[12:15],s47 offen nt lds
v_mfma_f32_16x16x32_bf16 v[216:219],a[176:179],a[88:91],0
s_add_u32 m0,s68,0
v_mfma_f32_16x16x32_bf16 v[216:219],a[180:183],a[92:95],v[216:219]
s_waitcnt lgkmcnt(0)
v_mfma_f32_16x16x32_bf16 a[20:23],a[184:187],a[32:35],0
ds_read_b64_tr_b16 a[160:161],v8 offset:8192
v_mfma_f32_16x16x32_bf16 a[20:23],a[188:191],a[36:39],a[20:23]
ds_read_b64_tr_b16 a[162:163],v8 offset:10240
v_mfma_f32_16x16x32_bf16 a[28:31],a[184:187],a[40:43],0
ds_read_b64_tr_b16 a[164:165],v8 offset:12288
v_mfma_f32_16x16x32_bf16 a[28:31],a[188:191],a[44:47],a[28:31]
ds_read_b64_tr_b16 a[166:167],v8 offset:14336
v_mfma_f32_16x16x32_bf16 v[84:87],a[184:187],a[48:51],0
v_mfma_f32_16x16x32_bf16 v[84:87],a[188:191],a[52:55],v[84:87]
v_mfma_f32_16x16x32_bf16 v[92:95],a[184:187],a[56:59],0
v_mfma_f32_16x16x32_bf16 v[92:95],a[188:191],a[60:63],v[92:95]
v_mfma_f32_16x16x32_bf16 v[148:151],a[184:187],a[64:67],0
v_mfma_f32_16x16x32_bf16 v[148:151],a[188:191],a[68:71],v[148:151]
v_mfma_f32_16x16x32_bf16 v[156:159],a[184:187],a[72:75],0
v_mfma_f32_16x16x32_bf16 v[156:159],a[188:191],a[76:79],v[156:159]
v_mfma_f32_16x16x32_bf16 v[212:215],a[184:187],a[80:83],0
v_mfma_f32_16x16x32_bf16 v[212:215],a[188:191],a[84:87],v[212:215]
v_mfma_f32_16x16x32_bf16 v[220:223],a[184:187],a[88:91],0
s_waitcnt vmcnt(10) lgkmcnt(0)
v_mfma_f32_16x16x32_bf16 v[220:223],a[188:191],a[92:95],v[220:223]
s_barrier
v_mfma_f32_16x16x32_bf16 v[32:35],a[160:163],a[32:35],0
ds_read_b64_tr_b16 a[168:169],v9 offset:8192
v_mfma_f32_16x16x32_bf16 v[32:35],a[164:167],a[36:39],v[32:35]
ds_read_b64_tr_b16 a[170:171],v9 offset:10240
v_mfma_f32_16x16x32_bf16 v[40:43],a[160:163],a[40:43],0
ds_read_b64_tr_b16 a[172:173],v9 offset:12288
v_mfma_f32_16x16x32_bf16 v[40:43],a[164:167],a[44:47],v[40:43]
ds_read_b64_tr_b16 a[174:175],v9 offset:14336
v_add_u32 v4,128,v4
v_mfma_f32_16x16x32_bf16 v[96:99],a[160:163],a[48:51],0
ds_read_b128 a[96:99],v2 offset:32768
v_mfma_f32_16x16x32_bf16 v[96:99],a[164:167],a[52:55],v[96:99]
buffer_load_dwordx4 v4,s[8:11],s32 offen lds
v_mfma_f32_16x16x32_bf16 v[104:107],a[160:163],a[56:59],0
s_add_u32 s67,s64,1048576
buffer_load_dword a220,v5,s[12:15],s67 offen nt
v_mfma_f32_16x16x32_bf16 v[104:107],a[164:167],a[60:63],v[104:107]
ds_read_b128 a[100:103],v3 offset:32768
s_add_u32 m0,s68,1024
v_mfma_f32_16x16x32_bf16 v[160:163],a[160:163],a[64:67],0
ds_read_b128 a[104:107],v2 offset:34816
v_mfma_f32_16x16x32_bf16 v[160:163],a[164:167],a[68:71],v[160:163]
v_mfma_f32_16x16x32_bf16 v[168:171],a[160:163],a[72:75],0
ds_read_b128 a[108:111],v3 offset:34816
v_mfma_f32_16x16x32_bf16 v[168:171],a[164:167],a[76:79],v[168:171]
buffer_load_dwordx4 v4,s[8:11],s33 offen lds
v_mfma_f32_16x16x32_bf16 v[224:227],a[160:163],a[80:83],0
ds_read_b128 a[112:115],v2 offset:36864
s_add_u32 m0,s68,2048
v_mfma_f32_16x16x32_bf16 v[224:227],a[164:167],a[84:87],v[224:227]
s_waitcnt lgkmcnt(7)
v_mfma_f32_16x16x32_bf16 v[232:235],a[160:163],a[88:91],0
ds_read_b128 a[116:119],v3 offset:36864
v_mfma_f32_16x16x32_bf16 v[232:235],a[164:167],a[92:95],v[232:235]
buffer_load_dwordx4 v4,s[8:11],s34 offen lds
v_mfma_f32_16x16x32_bf16 v[36:39],a[168:171],a[32:35],0
ds_read_b64_tr_b16 a[176:177],v10 offset:8192
s_add_u32 m0,s68,3072
s_waitcnt lgkmcnt(7)
v_mfma_f32_16x16x32_bf16 v[36:39],a[172:175],a[36:39],v[36:39]
ds_read_b64_tr_b16 a[178:179],v10 offset:10240
v_mfma_f32_16x16x32_bf16 v[44:47],a[168:171],a[40:43],0
ds_read_b64_tr_b16 a[180:181],v10 offset:12288
v_mfma_f32_16x16x32_bf16 v[44:47],a[172:175],a[44:47],v[44:47]
ds_read_b64_tr_b16 a[182:183],v10 offset:14336
v_mfma_f32_16x16x32_bf16 v[100:103],a[168:171],a[48:51],0
ds_read_b128 a[120:123],v2 offset:38912
v_mfma_f32_16x16x32_bf16 v[100:103],a[172:175],a[52:55],v[100:103]
buffer_load_dwordx4 v4,s[8:11],s35 offen lds
v_mfma_f32_16x16x32_bf16 v[108:111],a[168:171],a[56:59],0
ds_read_b128 a[124:127],v3 offset:38912
s_add_u32 m0,s68,4096
v_mfma_f32_16x16x32_bf16 v[108:111],a[172:175],a[60:63],v[108:111]
v_mfma_f32_16x16x32_bf16 v[164:167],a[168:171],a[64:67],0
ds_read_b128 a[128:131],v2 offset:40960
v_mfma_f32_16x16x32_bf16 v[164:167],a[172:175],a[68:71],v[164:167]
v_mfma_f32_16x16x32_bf16 v[172:175],a[168:171],a[72:75],0
ds_read_b128 a[132:135],v3 offset:40960
v_mfma_f32_16x16x32_bf16 v[172:175],a[172:175],a[76:79],v[172:175]
buffer_load_dwordx4 v4,s[8:11],s36 offen lds
v_mfma_f32_16x16x32_bf16 v[228:231],a[168:171],a[80:83],0
ds_read_b128 a[136:139],v2 offset:43008
s_add_u32 m0,s68,5120
v_mfma_f32_16x16x32_bf16 v[228:231],a[172:175],a[84:87],v[228:231]
s_waitcnt lgkmcnt(7)
v_mfma_f32_16x16x32_bf16 v[236:239],a[168:171],a[88:91],0
ds_read_b128 a[140:143],v3 offset:43008
v_mfma_f32_16x16x32_bf16 v[236:239],a[172:175],a[92:95],v[236:239]
buffer_load_dwordx4 v4,s[8:11],s37 offen lds
v_mfma_f32_16x16x32_bf16 v[48:51],a[176:179],a[32:35],0
ds_read_b64_tr_b16 a[184:185],v11 offset:8192
s_add_u32 m0,s68,6144
s_waitcnt lgkmcnt(7)
v_mfma_f32_16x16x32_bf16 v[48:51],a[180:183],a[36:39],v[48:51]
ds_read_b64_tr_b16 a[186:187],v11 offset:10240
v_mfma_f32_16x16x32_bf16 v[56:59],a[176:179],a[40:43],0
ds_read_b64_tr_b16 a[188:189],v11 offset:12288
v_mfma_f32_16x16x32_bf16 v[56:59],a[180:183],a[44:47],v[56:59]
ds_read_b64_tr_b16 a[190:191],v11 offset:14336
v_mfma_f32_16x16x32_bf16 v[112:115],a[176:179],a[48:51],0
ds_read_b128 a[144:147],v2 offset:45056
v_mfma_f32_16x16x32_bf16 v[112:115],a[180:183],a[52:55],v[112:115]
buffer_load_dwordx4 v4,s[8:11],s38 offen lds
v_mfma_f32_16x16x32_bf16 v[120:123],a[176:179],a[56:59],0
ds_read_b128 a[148:151],v3 offset:45056
s_add_u32 m0,s68,7168
v_mfma_f32_16x16x32_bf16 v[120:123],a[180:183],a[60:63],v[120:123]
v_mfma_f32_16x16x32_bf16 v[176:179],a[176:179],a[64:67],0
ds_read_b128 a[152:155],v2 offset:47104
v_mfma_f32_16x16x32_bf16 v[176:179],a[180:183],a[68:71],v[176:179]
v_mfma_f32_16x16x32_bf16 v[184:187],a[176:179],a[72:75],0
ds_read_b128 a[156:159],v3 offset:47104
v_mfma_f32_16x16x32_bf16 v[184:187],a[180:183],a[76:79],v[184:187]
buffer_load_dwordx4 v4,s[8:11],s39 offen lds
v_mfma_f32_16x16x32_bf16 v[240:243],a[176:179],a[80:83],0
v_mfma_f32_16x16x32_bf16 v[240:243],a[180:183],a[84:87],v[240:243]
v_mfma_f32_16x16x32_bf16 v[248:251],a[176:179],a[88:91],0
v_mfma_f32_16x16x32_bf16 v[248:251],a[180:183],a[92:95],v[248:251]
s_waitcnt lgkmcnt(6)
v_mfma_f32_16x16x32_bf16 v[52:55],a[184:187],a[32:35],0
s_waitcnt vmcnt(9) lgkmcnt(0)
v_mfma_f32_16x16x32_bf16 v[52:55],a[188:191],a[36:39],v[52:55]
s_barrier
v_mfma_f32_16x16x32_bf16 v[60:63],a[184:187],a[40:43],0
ds_read_b64_tr_b16 a[160:161],v8 offset:32768
v_mfma_f32_16x16x32_bf16 v[60:63],a[188:191],a[44:47],v[60:63]
ds_read_b64_tr_b16 a[162:163],v8 offset:34816
v_mfma_f32_16x16x32_bf16 v[116:119],a[184:187],a[48:51],0
ds_read_b64_tr_b16 a[164:165],v8 offset:36864
v_mfma_f32_16x16x32_bf16 v[116:119],a[188:191],a[52:55],v[116:119]
s_add_u32 m0,s68,131072
v_add_u32 v5,524288,v5
v_mfma_f32_16x16x32_bf16 v[124:127],a[184:187],a[56:59],0
ds_read_b64_tr_b16 a[166:167],v8 offset:38912
v_mfma_f32_16x16x32_bf16 v[124:127],a[188:191],a[60:63],v[124:127]
buffer_load_dwordx4 v5,s[12:15],s40 offen nt lds
v_mfma_f32_16x16x32_bf16 v[180:183],a[184:187],a[64:67],0
s_add_u32 m0,s68,132096
v_mfma_f32_16x16x32_bf16 v[180:183],a[188:191],a[68:71],v[180:183]
v_mfma_f32_16x16x32_bf16 v[188:191],a[184:187],a[72:75],0
v_mfma_f32_16x16x32_bf16 v[188:191],a[188:191],a[76:79],v[188:191]
buffer_load_dwordx4 v5,s[12:15],s41 offen nt lds
v_mfma_f32_16x16x32_bf16 v[244:247],a[184:187],a[80:83],0
s_add_u32 m0,s68,133120
v_mfma_f32_16x16x32_bf16 v[244:247],a[188:191],a[84:87],v[244:247]
v_mfma_f32_16x16x32_bf16 v[252:255],a[184:187],a[88:91],0
s_waitcnt lgkmcnt(0)
v_mfma_f32_16x16x32_bf16 v[252:255],a[188:191],a[92:95],v[252:255]
buffer_load_dwordx4 v5,s[12:15],s42 offen nt lds
v_mfma_f32_16x16x32_bf16 a[0:3],a[160:163],a[96:99],a[0:3]
ds_read_b64_tr_b16 a[168:169],v9 offset:32768
s_add_u32 m0,s68,134144
v_mfma_f32_16x16x32_bf16 a[0:3],a[164:167],a[100:103],a[0:3]
ds_read_b64_tr_b16 a[170:171],v9 offset:34816
v_mfma_f32_16x16x32_bf16 a[8:11],a[160:163],a[104:107],a[8:11]
ds_read_b64_tr_b16 a[172:173],v9 offset:36864
v_mfma_f32_16x16x32_bf16 a[8:11],a[164:167],a[108:111],a[8:11]
ds_read_b64_tr_b16 a[174:175],v9 offset:38912
v_mfma_f32_16x16x32_bf16 v[64:67],a[160:163],a[112:115],v[64:67]
v_mfma_f32_16x16x32_bf16 v[64:67],a[164:167],a[116:119],v[64:67]
buffer_load_dwordx4 v5,s[12:15],s43 offen nt lds
v_mfma_f32_16x16x32_bf16 v[72:75],a[160:163],a[120:123],v[72:75]
s_add_u32 m0,s68,135168
v_mfma_f32_16x16x32_bf16 v[72:75],a[164:167],a[124:127],v[72:75]
v_mfma_f32_16x16x32_bf16 v[128:131],a[160:163],a[128:131],v[128:131]
v_mfma_f32_16x16x32_bf16 v[128:131],a[164:167],a[132:135],v[128:131]
buffer_load_dwordx4 v5,s[12:15],s44 offen nt lds
v_mfma_f32_16x16x32_bf16 v[136:139],a[160:163],a[136:139],v[136:139]
s_add_u32 m0,s68,136192
v_mfma_f32_16x16x32_bf16 v[136:139],a[164:167],a[140:143],v[136:139]
v_mfma_f32_16x16x32_bf16 v[192:195],a[160:163],a[144:147],v[192:195]
v_mfma_f32_16x16x32_bf16 v[192:195],a[164:167],a[148:151],v[192:195]
buffer_load_dwordx4 v5,s[12:15],s45 offen nt lds
v_mfma_f32_16x16x32_bf16 v[200:203],a[160:163],a[152:155],v[200:203]
s_add_u32 m0,s68,137216
s_and_b32 s31,s2,7
s_lshr_b32 s28,s2,3
v_mfma_f32_16x16x32_bf16 v[200:203],a[164:167],a[156:159],v[200:203]
s_waitcnt lgkmcnt(0)
v_and_b32 v17,31,v7
v_lshrrev_b32 v18,5,v7
v_mfma_f32_16x16x32_bf16 a[4:7],a[168:171],a[96:99],a[4:7]
ds_read_b64_tr_b16 a[176:177],v10 offset:32768
v_lshlrev_b32 v18,3,v18
v_mfma_f32_16x16x32_bf16 a[4:7],a[172:175],a[100:103],a[4:7]
ds_read_b64_tr_b16 a[178:179],v10 offset:34816
s_lshl_b32 s29,s28,6
v_mfma_f32_16x16x32_bf16 a[12:15],a[168:171],a[104:107],a[12:15]
ds_read_b64_tr_b16 a[180:181],v10 offset:36864
s_lshl_b32 s30,s20,4
v_mfma_f32_16x16x32_bf16 a[12:15],a[172:175],a[108:111],a[12:15]
ds_read_b64_tr_b16 a[182:183],v10 offset:38912
s_add_u32 s29,s29,s30
v_mfma_f32_16x16x32_bf16 v[68:71],a[168:171],a[112:115],v[68:71]
v_add_u32 v18,s29,v18
s_lshl_b32 s29,s31,5
v_mfma_f32_16x16x32_bf16 v[68:71],a[172:175],a[116:119],v[68:71]
buffer_load_dwordx4 v5,s[12:15],s46 offen nt lds
v_mfma_f32_16x16x32_bf16 v[76:79],a[168:171],a[120:123],v[76:79]
s_add_u32 m0,s68,138240
v_add_u32 v17,s29,v17
v_lshlrev_b32 v16,10,v18
v_mfma_f32_16x16x32_bf16 v[76:79],a[172:175],a[124:127],v[76:79]
v_lshl_add_u32 v16,v17,2,v16
v_subrev_u32 v19,4096,v16
v_mfma_f32_16x16x32_bf16 v[132:135],a[168:171],a[128:131],v[132:135]
v_lshlrev_b32 v20,4,v17
s_movk_i32 s3,4096
v_mfma_f32_16x16x32_bf16 v[132:135],a[172:175],a[132:135],v[132:135]
buffer_load_dwordx4 v5,s[12:15],s47 offen nt lds
v_mfma_f32_16x16x32_bf16 v[140:143],a[168:171],a[136:139],v[140:143]
s_add_u32 m0,s68,32768
v_mfma_f32_16x16x32_bf16 v[140:143],a[172:175],a[140:143],v[140:143]
v_add_u32 v4,128,v4
v_mfma_f32_16x16x32_bf16 v[196:199],a[168:171],a[144:147],v[196:199]
v_mfma_f32_16x16x32_bf16 v[196:199],a[172:175],a[148:151],v[196:199]
buffer_load_dwordx4 v4,s[8:11],s32 offen lds
v_mfma_f32_16x16x32_bf16 v[204:207],a[168:171],a[152:155],v[204:207]
s_add_u32 m0,s68,33792
v_mfma_f32_16x16x32_bf16 v[204:207],a[172:175],a[156:159],v[204:207]
s_waitcnt lgkmcnt(0)
v_mfma_f32_16x16x32_bf16 a[16:19],a[176:179],a[96:99],a[16:19]
ds_read_b64_tr_b16 a[184:185],v11 offset:32768
v_mfma_f32_16x16x32_bf16 a[16:19],a[180:183],a[100:103],a[16:19]
ds_read_b64_tr_b16 a[186:187],v11 offset:34816
v_mfma_f32_16x16x32_bf16 a[24:27],a[176:179],a[104:107],a[24:27]
ds_read_b64_tr_b16 a[188:189],v11 offset:36864
v_mfma_f32_16x16x32_bf16 a[24:27],a[180:183],a[108:111],a[24:27]
ds_read_b64_tr_b16 a[190:191],v11 offset:38912
v_mfma_f32_16x16x32_bf16 v[80:83],a[176:179],a[112:115],v[80:83]
v_mfma_f32_16x16x32_bf16 v[80:83],a[180:183],a[116:119],v[80:83]
buffer_load_dwordx4 v4,s[8:11],s33 offen lds
v_mfma_f32_16x16x32_bf16 v[88:91],a[176:179],a[120:123],v[88:91]
s_add_u32 m0,s68,34816
v_mfma_f32_16x16x32_bf16 v[88:91],a[180:183],a[124:127],v[88:91]
v_mfma_f32_16x16x32_bf16 v[144:147],a[176:179],a[128:131],v[144:147]
v_mfma_f32_16x16x32_bf16 v[144:147],a[180:183],a[132:135],v[144:147]
buffer_load_dwordx4 v4,s[8:11],s34 offen lds
v_mfma_f32_16x16x32_bf16 v[152:155],a[176:179],a[136:139],v[152:155]
s_add_u32 m0,s68,35840
v_mfma_f32_16x16x32_bf16 v[152:155],a[180:183],a[140:143],v[152:155]
v_mfma_f32_16x16x32_bf16 v[208:211],a[176:179],a[144:147],v[208:211]
v_mfma_f32_16x16x32_bf16 v[208:211],a[180:183],a[148:151],v[208:211]
buffer_load_dwordx4 v4,s[8:11],s35 offen lds
v_mfma_f32_16x16x32_bf16 v[216:219],a[176:179],a[152:155],v[216:219]
s_add_u32 m0,s68,36864
v_mfma_f32_16x16x32_bf16 v[216:219],a[180:183],a[156:159],v[216:219]
s_waitcnt lgkmcnt(0)
v_mfma_f32_16x16x32_bf16 a[20:23],a[184:187],a[96:99],a[20:23]
ds_read_b64_tr_b16 a[160:161],v8 offset:40960
v_mfma_f32_16x16x32_bf16 a[20:23],a[188:191],a[100:103],a[20:23]
ds_read_b64_tr_b16 a[162:163],v8 offset:43008
v_mfma_f32_16x16x32_bf16 a[28:31],a[184:187],a[104:107],a[28:31]
ds_read_b64_tr_b16 a[164:165],v8 offset:45056
v_mfma_f32_16x16x32_bf16 a[28:31],a[188:191],a[108:111],a[28:31]
ds_read_b64_tr_b16 a[166:167],v8 offset:47104
v_mfma_f32_16x16x32_bf16 v[84:87],a[184:187],a[112:115],v[84:87]
v_mfma_f32_16x16x32_bf16 v[84:87],a[188:191],a[116:119],v[84:87]
buffer_load_dwordx4 v4,s[8:11],s36 offen lds
v_mfma_f32_16x16x32_bf16 v[92:95],a[184:187],a[120:123],v[92:95]
s_add_u32 m0,s68,37888
v_mfma_f32_16x16x32_bf16 v[92:95],a[188:191],a[124:127],v[92:95]
v_mfma_f32_16x16x32_bf16 v[148:151],a[184:187],a[128:131],v[148:151]
v_mfma_f32_16x16x32_bf16 v[148:151],a[188:191],a[132:135],v[148:151]
buffer_load_dwordx4 v4,s[8:11],s37 offen lds
v_mfma_f32_16x16x32_bf16 v[156:159],a[184:187],a[136:139],v[156:159]
s_add_u32 m0,s68,38912
v_mfma_f32_16x16x32_bf16 v[156:159],a[188:191],a[140:143],v[156:159]
v_mfma_f32_16x16x32_bf16 v[212:215],a[184:187],a[144:147],v[212:215]
v_mfma_f32_16x16x32_bf16 v[212:215],a[188:191],a[148:151],v[212:215]
buffer_load_dwordx4 v4,s[8:11],s38 offen lds
v_mfma_f32_16x16x32_bf16 v[220:223],a[184:187],a[152:155],v[220:223]
s_waitcnt vmcnt(15)
s_add_u32 m0,s68,39936
v_mfma_f32_16x16x32_bf16 v[220:223],a[188:191],a[156:159],v[220:223]
s_barrier
s_waitcnt lgkmcnt(2)
v_mfma_f32_16x16x32_bf16 v[32:35],a[160:163],a[96:99],v[32:35]
ds_read_b64_tr_b16 a[168:169],v9 offset:40960
s_waitcnt lgkmcnt(1)
v_mfma_f32_16x16x32_bf16 v[32:35],a[164:167],a[100:103],v[32:35]
ds_read_b64_tr_b16 a[170:171],v9 offset:43008
v_mfma_f32_16x16x32_bf16 v[40:43],a[160:163],a[104:107],v[40:43]
ds_read_b64_tr_b16 a[172:173],v9 offset:45056
v_mfma_f32_16x16x32_bf16 v[40:43],a[164:167],a[108:111],v[40:43]
ds_read_b64_tr_b16 a[174:175],v9 offset:47104
v_mfma_f32_16x16x32_bf16 v[96:99],a[160:163],a[112:115],v[96:99]
ds_read_b128 a[32:35],v2 offset:0
v_mfma_f32_16x16x32_bf16 v[96:99],a[164:167],a[116:119],v[96:99]
buffer_load_dwordx4 v4,s[8:11],s39 offen lds
v_mfma_f32_16x16x32_bf16 v[104:107],a[160:163],a[120:123],v[104:107]
s_add_u32 s67,s64,1048576
buffer_load_dword a221,v5,s[12:15],s67 offen nt
v_mfma_f32_16x16x32_bf16 v[104:107],a[164:167],a[124:127],v[104:107]
ds_read_b128 a[36:39],v3 offset:0
v_mfma_f32_16x16x32_bf16 v[160:163],a[160:163],a[128:131],v[160:163]
global_load_dword a252,v0,s[100:101]
v_mfma_f32_16x16x32_bf16 v[160:163],a[164:167],a[132:135],v[160:163]
ds_read_b128 a[40:43],v2 offset:2048
v_mfma_f32_16x16x32_bf16 v[168:171],a[160:163],a[136:139],v[168:171]
ds_read_b128 a[44:47],v3 offset:2048
v_mfma_f32_16x16x32_bf16 v[168:171],a[164:167],a[140:143],v[168:171]
v_mfma_f32_16x16x32_bf16 v[224:227],a[160:163],a[144:147],v[224:227]
ds_read_b128 a[48:51],v2 offset:4096
v_mfma_f32_16x16x32_bf16 v[224:227],a[164:167],a[148:151],v[224:227]
v_add_u32 v0,s79,v0
v_mfma_f32_16x16x32_bf16 v[232:235],a[160:163],a[152:155],v[232:235]
ds_read_b128 a[52:55],v3 offset:4096
v_mfma_f32_16x16x32_bf16 v[232:235],a[164:167],a[156:159],v[232:235]
s_waitcnt lgkmcnt(6)
v_mfma_f32_16x16x32_bf16 v[36:39],a[168:171],a[96:99],v[36:39]
ds_read_b64_tr_b16 a[176:177],v10 offset:40960
v_mfma_f32_16x16x32_bf16 v[36:39],a[172:175],a[100:103],v[36:39]
ds_read_b64_tr_b16 a[178:179],v10 offset:43008
v_mfma_f32_16x16x32_bf16 v[44:47],a[168:171],a[104:107],v[44:47]
ds_read_b64_tr_b16 a[180:181],v10 offset:45056
v_mfma_f32_16x16x32_bf16 v[44:47],a[172:175],a[108:111],v[44:47]
ds_read_b64_tr_b16 a[182:183],v10 offset:47104
v_mfma_f32_16x16x32_bf16 v[100:103],a[168:171],a[112:115],v[100:103]
ds_read_b128 a[56:59],v2 offset:6144
v_mfma_f32_16x16x32_bf16 v[100:103],a[172:175],a[116:119],v[100:103]
v_mfma_f32_16x16x32_bf16 v[108:111],a[168:171],a[120:123],v[108:111]
ds_read_b128 a[60:63],v3 offset:6144
v_mfma_f32_16x16x32_bf16 v[108:111],a[172:175],a[124:127],v[108:111]
v_mfma_f32_16x16x32_bf16 v[164:167],a[168:171],a[128:131],v[164:167]
ds_read_b128 a[64:67],v2 offset:8192
v_mfma_f32_16x16x32_bf16 v[164:167],a[172:175],a[132:135],v[164:167]
v_mfma_f32_16x16x32_bf16 v[172:175],a[168:171],a[136:139],v[172:175]
ds_read_b128 a[68:71],v3 offset:8192
v_mfma_f32_16x16x32_bf16 v[172:175],a[172:175],a[140:143],v[172:175]
v_mfma_f32_16x16x32_bf16 v[228:231],a[168:171],a[144:147],v[228:231]
ds_read_b128 a[72:75],v2 offset:10240
v_mfma_f32_16x16x32_bf16 v[228:231],a[172:175],a[148:151],v[228:231]
v_mfma_f32_16x16x32_bf16 v[236:239],a[168:171],a[152:155],v[236:239]
ds_read_b128 a[76:79],v3 offset:10240
v_mfma_f32_16x16x32_bf16 v[236:239],a[172:175],a[156:159],v[236:239]
s_waitcnt lgkmcnt(6)
v_mfma_f32_16x16x32_bf16 v[48:51],a[176:179],a[96:99],v[48:51]
ds_read_b64_tr_b16 a[184:185],v11 offset:40960
v_mfma_f32_16x16x32_bf16 v[48:51],a[180:183],a[100:103],v[48:51]
ds_read_b64_tr_b16 a[186:187],v11 offset:43008
v_mfma_f32_16x16x32_bf16 v[56:59],a[176:179],a[104:107],v[56:59]
ds_read_b64_tr_b16 a[188:189],v11 offset:45056
v_mfma_f32_16x16x32_bf16 v[56:59],a[180:183],a[108:111],v[56:59]
ds_read_b64_tr_b16 a[190:191],v11 offset:47104
v_mfma_f32_16x16x32_bf16 v[112:115],a[176:179],a[112:115],v[112:115]
ds_read_b128 a[80:83],v2 offset:12288
v_mfma_f32_16x16x32_bf16 v[112:115],a[180:183],a[116:119],v[112:115]
v_mfma_f32_16x16x32_bf16 v[120:123],a[176:179],a[120:123],v[120:123]
ds_read_b128 a[84:87],v3 offset:12288
v_mfma_f32_16x16x32_bf16 v[120:123],a[180:183],a[124:127],v[120:123]
v_mfma_f32_16x16x32_bf16 v[176:179],a[176:179],a[128:131],v[176:179]
ds_read_b128 a[88:91],v2 offset:14336
v_mfma_f32_16x16x32_bf16 v[176:179],a[180:183],a[132:135],v[176:179]
v_mfma_f32_16x16x32_bf16 v[184:187],a[176:179],a[136:139],v[184:187]
ds_read_b128 a[92:95],v3 offset:14336
v_mfma_f32_16x16x32_bf16 v[184:187],a[180:183],a[140:143],v[184:187]
v_mfma_f32_16x16x32_bf16 v[240:243],a[176:179],a[144:147],v[240:243]
v_mfma_f32_16x16x32_bf16 v[240:243],a[180:183],a[148:151],v[240:243]
v_mfma_f32_16x16x32_bf16 v[248:251],a[176:179],a[152:155],v[248:251]
v_mfma_f32_16x16x32_bf16 v[248:251],a[180:183],a[156:159],v[248:251]
s_waitcnt lgkmcnt(6)
v_mfma_f32_16x16x32_bf16 v[52:55],a[184:187],a[96:99],v[52:55]
s_waitcnt vmcnt(10) lgkmcnt(0)
v_mfma_f32_16x16x32_bf16 v[52:55],a[188:191],a[100:103],v[52:55]
s_barrier
s_lshr_b32 s28,s22,1
s_lshl_b32 s29,s20,2
s_add_u32 s28,s28,s29
s_cmp_lg_u32 s28,0
s_cbranch_scc1 F_ARR1
s_mov_b64 exec,1
s_and_b32 s28,s2,7
s_lshl_b32 s28,s28,5
v_mov_b32 v28,s28
v_mov_b32 v29,1
global_atomic_add v28,v29,s[94:95] sc1
s_mov_b64 exec,-1
F_ARR1:
v_mfma_f32_16x16x32_bf16 v[60:63],a[184:187],a[104:107],v[60:63]
ds_read_b64_tr_b16 a[160:161],v12 offset:0
v_mfma_f32_16x16x32_bf16 v[60:63],a[188:191],a[108:111],v[60:63]
ds_read_b64_tr_b16 a[162:163],v12 offset:2048
v_mfma_f32_16x16x32_bf16 v[116:119],a[184:187],a[112:115],v[116:119]
ds_read_b64_tr_b16 a[164:165],v12 offset:4096
v_mfma_f32_16x16x32_bf16 v[116:119],a[188:191],a[116:119],v[116:119]
s_add_u32 m0,s68,65536
v_add_u32 v5,524288,v5
v_mfma_f32_16x16x32_bf16 v[124:127],a[184:187],a[120:123],v[124:127]
ds_read_b64_tr_b16 a[166:167],v12 offset:6144
v_mfma_f32_16x16x32_bf16 v[124:127],a[188:191],a[124:127],v[124:127]
buffer_load_dwordx4 v5,s[12:15],s40 offen nt lds
v_mfma_f32_16x16x32_bf16 v[180:183],a[184:187],a[128:131],v[180:183]
s_add_u32 m0,s68,66560
v_mfma_f32_16x16x32_bf16 v[180:183],a[188:191],a[132:135],v[180:183]
v_mfma_f32_16x16x32_bf16 v[188:191],a[184:187],a[136:139],v[188:191]
v_mfma_f32_16x16x32_bf16 v[188:191],a[188:191],a[140:143],v[188:191]
buffer_load_dwordx4 v5,s[12:15],s41 offen nt lds
v_mfma_f32_16x16x32_bf16 v[244:247],a[184:187],a[144:147],v[244:247]
s_add_u32 m0,s68,67584
v_mfma_f32_16x16x32_bf16 v[244:247],a[188:191],a[148:151],v[244:247]
v_mfma_f32_16x16x32_bf16 v[252:255],a[184:187],a[152:155],v[252:255]
s_waitcnt lgkmcnt(0)
v_mfma_f32_16x16x32_bf16 v[252:255],a[188:191],a[156:159],v[252:255]
buffer_load_dwordx4 v5,s[12:15],s42 offen nt lds
v_mfma_f32_16x16x32_bf16 a[0:3],a[160:163],a[32:35],a[0:3]
ds_read_b64_tr_b16 a[168:169],v13 offset:0
s_add_u32 m0,s68,68608
v_mfma_f32_16x16x32_bf16 a[0:3],a[164:167],a[36:39],a[0:3]
ds_read_b64_tr_b16 a[170:171],v13 offset:2048
v_mfma_f32_16x16x32_bf16 a[8:11],a[160:163],a[40:43],a[8:11]
ds_read_b64_tr_b16 a[172:173],v13 offset:4096
v_mfma_f32_16x16x32_bf16 a[8:11],a[164:167],a[44:47],a[8:11]
ds_read_b64_tr_b16 a[174:175],v13 offset:6144
v_mfma_f32_16x16x32_bf16 v[64:67],a[160:163],a[48:51],v[64:67]
v_mfma_f32_16x16x32_bf16 v[64:67],a[164:167],a[52:55],v[64:67]
buffer_load_dwordx4 v5,s[12:15],s43 offen nt lds
v_mfma_f32_16x16x32_bf16 v[72:75],a[160:163],a[56:59],v[72:75]
s_add_u32 m0,s68,69632
v_mfma_f32_16x16x32_bf16 v[72:75],a[164:167],a[60:63],v[72:75]
v_mfma_f32_16x16x32_bf16 v[128:131],a[160:163],a[64:67],v[128:131]
v_mfma_f32_16x16x32_bf16 v[128:131],a[164:167],a[68:71],v[128:131]
buffer_load_dwordx4 v5,s[12:15],s44 offen nt lds
v_mfma_f32_16x16x32_bf16 v[136:139],a[160:163],a[72:75],v[136:139]
s_add_u32 m0,s68,70656
v_mfma_f32_16x16x32_bf16 v[136:139],a[164:167],a[76:79],v[136:139]
v_mfma_f32_16x16x32_bf16 v[192:195],a[160:163],a[80:83],v[192:195]
v_mfma_f32_16x16x32_bf16 v[192:195],a[164:167],a[84:87],v[192:195]
buffer_load_dwordx4 v5,s[12:15],s45 offen nt lds
v_mfma_f32_16x16x32_bf16 v[200:203],a[160:163],a[88:91],v[200:203]
s_add_u32 m0,s68,71680
v_mfma_f32_16x16x32_bf16 v[200:203],a[164:167],a[92:95],v[200:203]
s_waitcnt lgkmcnt(0)
v_mfma_f32_16x16x32_bf16 a[4:7],a[168:171],a[32:35],a[4:7]
ds_read_b64_tr_b16 a[176:177],v14 offset:0
v_mfma_f32_16x16x32_bf16 a[4:7],a[172:175],a[36:39],a[4:7]
ds_read_b64_tr_b16 a[178:179],v14 offset:2048
v_mfma_f32_16x16x32_bf16 a[12:15],a[168:171],a[40:43],a[12:15]
ds_read_b64_tr_b16 a[180:181],v14 offset:4096
v_mfma_f32_16x16x32_bf16 a[12:15],a[172:175],a[44:47],a[12:15]
ds_read_b64_tr_b16 a[182:183],v14 offset:6144
v_mfma_f32_16x16x32_bf16 v[68:71],a[168:171],a[48:51],v[68:71]
v_mfma_f32_16x16x32_bf16 v[68:71],a[172:175],a[52:55],v[68:71]
buffer_load_dwordx4 v5,s[12:15],s46 offen nt lds
v_mfma_f32_16x16x32_bf16 v[76:79],a[168:171],a[56:59],v[76:79]
s_add_u32 m0,s68,72704
v_mfma_f32_16x16x32_bf16 v[76:79],a[172:175],a[60:63],v[76:79]
v_mfma_f32_16x16x32_bf16 v[132:135],a[168:171],a[64:67],v[132:135]
v_mfma_f32_16x16x32_bf16 v[132:135],a[172:175],a[68:71],v[132:135]
buffer_load_dwordx4 v5,s[12:15],s47 offen nt lds
v_mfma_f32_16x16x32_bf16 v[140:143],a[168:171],a[72:75],v[140:143]
s_add_u32 m0,s68,0
v_mfma_f32_16x16x32_bf16 v[140:143],a[172:175],a[76:79],v[140:143]
v_add_u32 v4,s86,v4
v_mfma_f32_16x16x32_bf16 v[196:199],a[168:171],a[80:83],v[196:199]
v_mfma_f32_16x16x32_bf16 v[196:199],a[172:175],a[84:87],v[196:199]
buffer_load_dwordx4 v4,s[8:11],s32 offen lds
v_mfma_f32_16x16x32_bf16 v[204:207],a[168:171],a[88:91],v[204:207]
s_add_u32 m0,s68,1024
v_mfma_f32_16x16x32_bf16 v[204:207],a[172:175],a[92:95],v[204:207]
s_waitcnt lgkmcnt(0)
v_mfma_f32_16x16x32_bf16 a[16:19],a[176:179],a[32:35],a[16:19]
ds_read_b64_tr_b16 a[184:185],v15 offset:0
v_mfma_f32_16x16x32_bf16 a[16:19],a[180:183],a[36:39],a[16:19]
ds_read_b64_tr_b16 a[186:187],v15 offset:2048
v_mfma_f32_16x16x32_bf16 a[24:27],a[176:179],a[40:43],a[24:27]
ds_read_b64_tr_b16 a[188:189],v15 offset:4096
v_mfma_f32_16x16x32_bf16 a[24:27],a[180:183],a[44:47],a[24:27]
ds_read_b64_tr_b16 a[190:191],v15 offset:6144
v_mfma_f32_16x16x32_bf16 v[80:83],a[176:179],a[48:51],v[80:83]
v_mfma_f32_16x16x32_bf16 v[80:83],a[180:183],a[52:55],v[80:83]
buffer_load_dwordx4 v4,s[8:11],s33 offen lds
v_mfma_f32_16x16x32_bf16 v[88:91],a[176:179],a[56:59],v[88:91]
s_add_u32 m0,s68,2048
v_mfma_f32_16x16x32_bf16 v[88:91],a[180:183],a[60:63],v[88:91]
v_mfma_f32_16x16x32_bf16 v[144:147],a[176:179],a[64:67],v[144:147]
v_mfma_f32_16x16x32_bf16 v[144:147],a[180:183],a[68:71],v[144:147]
buffer_load_dwordx4 v4,s[8:11],s34 offen lds
v_mfma_f32_16x16x32_bf16 v[152:155],a[176:179],a[72:75],v[152:155]
s_add_u32 m0,s68,3072
v_mfma_f32_16x16x32_bf16 v[152:155],a[180:183],a[76:79],v[152:155]
v_mfma_f32_16x16x32_bf16 v[208:211],a[176:179],a[80:83],v[208:211]
v_mfma_f32_16x16x32_bf16 v[208:211],a[180:183],a[84:87],v[208:211]
buffer_load_dwordx4 v4,s[8:11],s35 offen lds
v_mfma_f32_16x16x32_bf16 v[216:219],a[176:179],a[88:91],v[216:219]
s_add_u32 m0,s68,4096
v_mfma_f32_16x16x32_bf16 v[216:219],a[180:183],a[92:95],v[216:219]
s_waitcnt lgkmcnt(0)
v_mfma_f32_16x16x32_bf16 a[20:23],a[184:187],a[32:35],a[20:23]
ds_read_b64_tr_b16 a[160:161],v12 offset:8192
v_mfma_f32_16x16x32_bf16 a[20:23],a[188:191],a[36:39],a[20:23]
ds_read_b64_tr_b16 a[162:163],v12 offset:10240
v_mfma_f32_16x16x32_bf16 a[28:31],a[184:187],a[40:43],a[28:31]
ds_read_b64_tr_b16 a[164:165],v12 offset:12288
v_mfma_f32_16x16x32_bf16 a[28:31],a[188:191],a[44:47],a[28:31]
ds_read_b64_tr_b16 a[166:167],v12 offset:14336
v_mfma_f32_16x16x32_bf16 v[84:87],a[184:187],a[48:51],v[84:87]
v_mfma_f32_16x16x32_bf16 v[84:87],a[188:191],a[52:55],v[84:87]
buffer_load_dwordx4 v4,s[8:11],s36 offen lds
v_mfma_f32_16x16x32_bf16 v[92:95],a[184:187],a[56:59],v[92:95]
s_add_u32 m0,s68,5120
v_mfma_f32_16x16x32_bf16 v[92:95],a[188:191],a[60:63],v[92:95]
v_mfma_f32_16x16x32_bf16 v[148:151],a[184:187],a[64:67],v[148:151]
v_mfma_f32_16x16x32_bf16 v[148:151],a[188:191],a[68:71],v[148:151]
buffer_load_dwordx4 v4,s[8:11],s37 offen lds
v_mfma_f32_16x16x32_bf16 v[156:159],a[184:187],a[72:75],v[156:159]
s_add_u32 m0,s68,6144
v_mfma_f32_16x16x32_bf16 v[156:159],a[188:191],a[76:79],v[156:159]
v_mfma_f32_16x16x32_bf16 v[212:215],a[184:187],a[80:83],v[212:215]
v_mfma_f32_16x16x32_bf16 v[212:215],a[188:191],a[84:87],v[212:215]
buffer_load_dwordx4 v4,s[8:11],s38 offen lds
v_mfma_f32_16x16x32_bf16 v[220:223],a[184:187],a[88:91],v[220:223]
s_waitcnt vmcnt(17)
s_add_u32 m0,s68,7168
v_mfma_f32_16x16x32_bf16 v[220:223],a[188:191],a[92:95],v[220:223]
s_barrier
s_waitcnt lgkmcnt(2)
v_mfma_f32_16x16x32_bf16 v[32:35],a[160:163],a[32:35],v[32:35]
ds_read_b64_tr_b16 a[168:169],v13 offset:8192
s_waitcnt lgkmcnt(1)
v_mfma_f32_16x16x32_bf16 v[32:35],a[164:167],a[36:39],v[32:35]
ds_read_b64_tr_b16 a[170:171],v13 offset:10240
v_mfma_f32_16x16x32_bf16 v[40:43],a[160:163],a[40:43],v[40:43]
ds_read_b64_tr_b16 a[172:173],v13 offset:12288
v_mfma_f32_16x16x32_bf16 v[40:43],a[164:167],a[44:47],v[40:43]
ds_read_b64_tr_b16 a[174:175],v13 offset:14336
v_mfma_f32_16x16x32_bf16 v[96:99],a[160:163],a[48:51],v[96:99]
ds_read_b128 a[96:99],v2 offset:32768
v_mfma_f32_16x16x32_bf16 v[96:99],a[164:167],a[52:55],v[96:99]
buffer_load_dwordx4 v4,s[8:11],s39 offen lds
v_mfma_f32_16x16x32_bf16 v[104:107],a[160:163],a[56:59],v[104:107]
s_add_u32 s67,s64,1048576
buffer_load_dword a220,v5,s[12:15],s67 offen nt
v_mfma_f32_16x16x32_bf16 v[104:107],a[164:167],a[60:63],v[104:107]
ds_read_b128 a[100:103],v3 offset:32768
v_mfma_f32_16x16x32_bf16 v[160:163],a[160:163],a[64:67],v[160:163]
global_load_dword a253,v0,s[100:101]
v_mfma_f32_16x16x32_bf16 v[160:163],a[164:167],a[68:71],v[160:163]
ds_read_b128 a[104:107],v2 offset:34816
v_mfma_f32_16x16x32_bf16 v[168:171],a[160:163],a[72:75],v[168:171]
ds_read_b128 a[108:111],v3 offset:34816
v_mfma_f32_16x16x32_bf16 v[168:171],a[164:167],a[76:79],v[168:171]
buffer_load_dword a192,v19,s[4:7],0 offen offset:0 nt
v_mfma_f32_16x16x32_bf16 v[224:227],a[160:163],a[80:83],v[224:227]
ds_read_b128 a[112:115],v2 offset:36864
v_mfma_f32_16x16x32_bf16 v[224:227],a[164:167],a[84:87],v[224:227]
s_waitcnt lgkmcnt(7)
v_add_u32 v0,s79,v0
v_mfma_f32_16x16x32_bf16 v[232:235],a[160:163],a[88:91],v[232:235]
ds_read_b128 a[116:119],v3 offset:36864
v_mfma_f32_16x16x32_bf16 v[232:235],a[164:167],a[92:95],v[232:235]
buffer_load_dword a193,v19,s[4:7],0 offen offset:1024 nt
v_mfma_f32_16x16x32_bf16 v[36:39],a[168:171],a[32:35],v[36:39]
ds_read_b64_tr_b16 a[176:177],v14 offset:8192
s_waitcnt lgkmcnt(7)
v_mfma_f32_16x16x32_bf16 v[36:39],a[172:175],a[36:39],v[36:39]
ds_read_b64_tr_b16 a[178:179],v14 offset:10240
v_mfma_f32_16x16x32_bf16 v[44:47],a[168:171],a[40:43],v[44:47]
ds_read_b64_tr_b16 a[180:181],v14 offset:12288
v_mfma_f32_16x16x32_bf16 v[44:47],a[172:175],a[44:47],v[44:47]
ds_read_b64_tr_b16 a[182:183],v14 offset:14336
v_mfma_f32_16x16x32_bf16 v[100:103],a[168:171],a[48:51],v[100:103]
ds_read_b128 a[120:123],v2 offset:38912
v_mfma_f32_16x16x32_bf16 v[100:103],a[172:175],a[52:55],v[100:103]
buffer_load_dword a194,v19,s[4:7],0 offen offset:2048 nt
v_mfma_f32_16x16x32_bf16 v[108:111],a[168:171],a[56:59],v[108:111]
ds_read_b128 a[124:127],v3 offset:38912
v_mfma_f32_16x16x32_bf16 v[108:111],a[172:175],a[60:63],v[108:111]
buffer_load_dword a195,v19,s[4:7],0 offen offset:3072 nt
v_mfma_f32_16x16x32_bf16 v[164:167],a[168:171],a[64:67],v[164:167]
ds_read_b128 a[128:131],v2 offset:40960
v_mfma_f32_16x16x32_bf16 v[164:167],a[172:175],a[68:71],v[164:167]
buffer_load_dword a196,v16,s[4:7],0 offen offset:0 nt
v_mfma_f32_16x16x32_bf16 v[172:175],a[168:171],a[72:75],v[172:175]
ds_read_b128 a[132:135],v3 offset:40960
v_mfma_f32_16x16x32_bf16 v[172:175],a[172:175],a[76:79],v[172:175]
buffer_load_dword a197,v16,s[4:7],0 offen offset:1024 nt
v_mfma_f32_16x16x32_bf16 v[228:231],a[168:171],a[80:83],v[228:231]
ds_read_b128 a[136:139],v2 offset:43008
v_mfma_f32_16x16x32_bf16 v[228:231],a[172:175],a[84:87],v[228:231]
buffer_load_dword a198,v16,s[4:7],0 offen offset:2048 nt
v_mfma_f32_16x16x32_bf16 v[236:239],a[168:171],a[88:91],v[236:239]
ds_read_b128 a[140:143],v3 offset:43008
v_mfma_f32_16x16x32_bf16 v[236:239],a[172:175],a[92:95],v[236:239]
buffer_load_dword a199,v16,s[4:7],0 offen offset:3072 nt
s_waitcnt lgkmcnt(8)
v_mfma_f32_16x16x32_bf16 v[48:51],a[176:179],a[32:35],v[48:51]
ds_read_b64_tr_b16 a[184:185],v15 offset:8192
s_waitcnt lgkmcnt(7)
v_mfma_f32_16x16x32_bf16 v[48:51],a[180:183],a[36:39],v[48:51]
ds_read_b64_tr_b16 a[186:187],v15 offset:10240
v_mfma_f32_16x16x32_bf16 v[56:59],a[176:179],a[40:43],v[56:59]
ds_read_b64_tr_b16 a[188:189],v15 offset:12288
v_mfma_f32_16x16x32_bf16 v[56:59],a[180:183],a[44:47],v[56:59]
ds_read_b64_tr_b16 a[190:191],v15 offset:14336
v_mfma_f32_16x16x32_bf16 v[112:115],a[176:179],a[48:51],v[112:115]
ds_read_b128 a[144:147],v2 offset:45056
v_mfma_f32_16x16x32_bf16 v[112:115],a[180:183],a[52:55],v[112:115]
buffer_load_dword a200,v16,s[4:7],s3 offen offset:0 nt
v_mfma_f32_16x16x32_bf16 v[120:123],a[176:179],a[56:59],v[120:123]
ds_read_b128 a[148:151],v3 offset:45056
v_mfma_f32_16x16x32_bf16 v[120:123],a[180:183],a[60:63],v[120:123]
buffer_load_dword a201,v16,s[4:7],s3 offen offset:1024 nt
v_mfma_f32_16x16x32_bf16 v[176:179],a[176:179],a[64:67],v[176:179]
ds_read_b128 a[152:155],v2 offset:47104
v_mfma_f32_16x16x32_bf16 v[176:179],a[180:183],a[68:71],v[176:179]
buffer_load_dword a202,v16,s[4:7],s3 offen offset:2048 nt
v_mfma_f32_16x16x32_bf16 v[184:187],a[176:179],a[72:75],v[184:187]
ds_read_b128 a[156:159],v3 offset:47104
v_mfma_f32_16x16x32_bf16 v[184:187],a[180:183],a[76:79],v[184:187]
buffer_load_dword a203,v16,s[4:7],s3 offen offset:3072 nt
v_mfma_f32_16x16x32_bf16 v[240:243],a[176:179],a[80:83],v[240:243]
s_mov_b32 s4,s60
s_and_b32 s5,s61,0xffff
v_mfma_f32_16x16x32_bf16 v[240:243],a[180:183],a[84:87],v[240:243]
v_mfma_f32_16x16x32_bf16 v[248:251],a[176:179],a[88:91],v[248:251]
v_mfma_f32_16x16x32_bf16 v[248:251],a[180:183],a[92:95],v[248:251]
s_waitcnt lgkmcnt(6)
v_mfma_f32_16x16x32_bf16 v[52:55],a[184:187],a[32:35],v[52:55]
s_waitcnt vmcnt(22) lgkmcnt(0)
v_mfma_f32_16x16x32_bf16 v[52:55],a[188:191],a[36:39],v[52:55]
s_barrier
s_lshr_b32 s28,s22,1
s_lshl_b32 s29,s20,2
s_add_u32 s28,s28,s29
s_cmp_lg_u32 s28,1
s_cbranch_scc1 F_ARR2
s_mov_b64 exec,1
s_and_b32 s28,s2,7
s_lshl_b32 s28,s28,5
v_mov_b32 v28,s28
v_mov_b32 v29,1
global_atomic_add v28,v29,s[94:95] sc1
s_mov_b64 exec,-1
F_ARR2:
v_mfma_f32_16x16x32_bf16 v[60:63],a[184:187],a[40:43],v[60:63]
ds_read_b64_tr_b16 a[160:161],v8 offset:0
v_mfma_f32_16x16x32_bf16 v[60:63],a[188:191],a[44:47],v[60:63]
ds_read_b64_tr_b16 a[162:163],v8 offset:2048
v_mfma_f32_16x16x32_bf16 v[116:119],a[184:187],a[48:51],v[116:119]
ds_read_b64_tr_b16 a[164:165],v8 offset:4096
v_mfma_f32_16x16x32_bf16 v[116:119],a[188:191],a[52:55],v[116:119]
s_add_u32 m0,s68,98304
v_add_u32 v5,s87,v5
v_mfma_f32_16x16x32_bf16 v[124:127],a[184:187],a[56:59],v[124:127]
ds_read_b64_tr_b16 a[166:167],v8 offset:6144
v_mfma_f32_16x16x32_bf16 v[124:127],a[188:191],a[60:63],v[124:127]
buffer_load_dwordx4 v5,s[12:15],s40 offen nt lds
v_mfma_f32_16x16x32_bf16 v[180:183],a[184:187],a[64:67],v[180:183]
s_add_u32 m0,s68,99328
v_mfma_f32_16x16x32_bf16 v[180:183],a[188:191],a[68:71],v[180:183]
v_mfma_f32_16x16x32_bf16 v[188:191],a[184:187],a[72:75],v[188:191]
v_mfma_f32_16x16x32_bf16 v[188:191],a[188:191],a[76:79],v[188:191]
buffer_load_dwordx4 v5,s[12:15],s41 offen nt lds
v_mfma_f32_16x16x32_bf16 v[244:247],a[184:187],a[80:83],v[244:247]
s_add_u32 m0,s68,100352
v_mfma_f32_16x16x32_bf16 v[244:247],a[188:191],a[84:87],v[244:247]
v_mfma_f32_16x16x32_bf16 v[252:255],a[184:187],a[88:91],v[252:255]
s_waitcnt lgkmcnt(0)
v_mfma_f32_16x16x32_bf16 v[252:255],a[188:191],a[92:95],v[252:255]
buffer_load_dwordx4 v5,s[12:15],s42 offen nt lds
v_mfma_f32_16x16x32_bf16 a[0:3],a[160:163],a[96:99],a[0:3]
ds_read_b64_tr_b16 a[168:169],v9 offset:0
s_add_u32 m0,s68,101376
v_mfma_f32_16x16x32_bf16 a[0:3],a[164:167],a[100:103],a[0:3]
ds_read_b64_tr_b16 a[170:171],v9 offset:2048
v_mfma_f32_16x16x32_bf16 a[8:11],a[160:163],a[104:107],a[8:11]
ds_read_b64_tr_b16 a[172:173],v9 offset:4096
v_mfma_f32_16x16x32_bf16 a[8:11],a[164:167],a[108:111],a[8:11]
ds_read_b64_tr_b16 a[174:175],v9 offset:6144
v_mfma_f32_16x16x32_bf16 v[64:67],a[160:163],a[112:115],v[64:67]
v_mfma_f32_16x16x32_bf16 v[64:67],a[164:167],a[116:119],v[64:67]
buffer_load_dwordx4 v5,s[12:15],s43 offen nt lds
v_mfma_f32_16x16x32_bf16 v[72:75],a[160:163],a[120:123],v[72:75]
s_add_u32 m0,s68,102400
v_mfma_f32_16x16x32_bf16 v[72:75],a[164:167],a[124:127],v[72:75]
v_mfma_f32_16x16x32_bf16 v[128:131],a[160:163],a[128:131],v[128:131]
v_mfma_f32_16x16x32_bf16 v[128:131],a[164:167],a[132:135],v[128:131]
buffer_load_dwordx4 v5,s[12:15],s44 offen nt lds
v_mfma_f32_16x16x32_bf16 v[136:139],a[160:163],a[136:139],v[136:139]
s_add_u32 m0,s68,103424
v_mfma_f32_16x16x32_bf16 v[136:139],a[164:167],a[140:143],v[136:139]
v_mfma_f32_16x16x32_bf16 v[192:195],a[160:163],a[144:147],v[192:195]
v_mfma_f32_16x16x32_bf16 v[192:195],a[164:167],a[148:151],v[192:195]
buffer_load_dwordx4 v5,s[12:15],s45 offen nt lds
v_mfma_f32_16x16x32_bf16 v[200:203],a[160:163],a[152:155],v[200:203]
s_add_u32 m0,s68,104448
v_mfma_f32_16x16x32_bf16 v[200:203],a[164:167],a[156:159],v[200:203]
s_waitcnt lgkmcnt(0)
v_mfma_f32_16x16x32_bf16 a[4:7],a[168:171],a[96:99],a[4:7]
ds_read_b64_tr_b16 a[176:177],v10 offset:0
v_mfma_f32_16x16x32_bf16 a[4:7],a[172:175],a[100:103],a[4:7]
ds_read_b64_tr_b16 a[178:179],v10 offset:2048
v_mfma_f32_16x16x32_bf16 a[12:15],a[168:171],a[104:107],a[12:15]
ds_read_b64_tr_b16 a[180:181],v10 offset:4096
v_mfma_f32_16x16x32_bf16 a[12:15],a[172:175],a[108:111],a[12:15]
ds_read_b64_tr_b16 a[182:183],v10 offset:6144
v_mfma_f32_16x16x32_bf16 v[68:71],a[168:171],a[112:115],v[68:71]
v_mfma_f32_16x16x32_bf16 v[68:71],a[172:175],a[116:119],v[68:71]
buffer_load_dwordx4 v5,s[12:15],s46 offen nt lds
v_mfma_f32_16x16x32_bf16 v[76:79],a[168:171],a[120:123],v[76:79]
s_add_u32 m0,s68,105472
v_mfma_f32_16x16x32_bf16 v[76:79],a[172:175],a[124:127],v[76:79]
v_mfma_f32_16x16x32_bf16 v[132:135],a[168:171],a[128:131],v[132:135]
v_mfma_f32_16x16x32_bf16 v[132:135],a[172:175],a[132:135],v[132:135]
buffer_load_dwordx4 v5,s[12:15],s47 offen nt lds
v_mfma_f32_16x16x32_bf16 v[140:143],a[168:171],a[136:139],v[140:143]
s_add_u32 m0,s68,32768
v_mfma_f32_16x16x32_bf16 v[140:143],a[172:175],a[140:143],v[140:143]
v_add_u32 v4,128,v4
v_mfma_f32_16x16x32_bf16 v[196:199],a[168:171],a[144:147],v[196:199]
v_mfma_f32_16x16x32_bf16 v[196:199],a[172:175],a[148:151],v[196:199]
buffer_load_dwordx4 v4,s[8:11],s32 offen lds
v_mfma_f32_16x16x32_bf16 v[204:207],a[168:171],a[152:155],v[204:207]
s_add_u32 m0,s68,33792
v_mfma_f32_16x16x32_bf16 v[204:207],a[172:175],a[156:159],v[204:207]
s_waitcnt lgkmcnt(0)
v_mfma_f32_16x16x32_bf16 a[16:19],a[176:179],a[96:99],a[16:19]
ds_read_b64_tr_b16 a[184:185],v11 offset:0
v_mfma_f32_16x16x32_bf16 a[16:19],a[180:183],a[100:103],a[16:19]
ds_read_b64_tr_b16 a[186:187],v11 offset:2048
v_mfma_f32_16x16x32_bf16 a[24:27],a[176:179],a[104:107],a[24:27]
ds_read_b64_tr_b16 a[188:189],v11 offset:4096
v_mfma_f32_16x16x32_bf16 a[24:27],a[180:183],a[108:111],a[24:27]
ds_read_b64_tr_b16 a[190:191],v11 offset:6144
v_mfma_f32_16x16x32_bf16 v[80:83],a[176:179],a[112:115],v[80:83]
v_mfma_f32_16x16x32_bf16 v[80:83],a[180:183],a[116:119],v[80:83]
buffer_load_dwordx4 v4,s[8:11],s33 offen lds
v_mfma_f32_16x16x32_bf16 v[88:91],a[176:179],a[120:123],v[88:91]
s_add_u32 m0,s68,34816
v_mfma_f32_16x16x32_bf16 v[88:91],a[180:183],a[124:127],v[88:91]
v_mfma_f32_16x16x32_bf16 v[144:147],a[176:179],a[128:131],v[144:147]
v_mfma_f32_16x16x32_bf16 v[144:147],a[180:183],a[132:135],v[144:147]
buffer_load_dwordx4 v4,s[8:11],s34 offen lds
v_mfma_f32_16x16x32_bf16 v[152:155],a[176:179],a[136:139],v[152:155]
s_add_u32 m0,s68,35840
v_mfma_f32_16x16x32_bf16 v[152:155],a[180:183],a[140:143],v[152:155]
v_mfma_f32_16x16x32_bf16 v[208:211],a[176:179],a[144:147],v[208:211]
v_mfma_f32_16x16x32_bf16 v[208:211],a[180:183],a[148:151],v[208:211]
buffer_load_dwordx4 v4,s[8:11],s35 offen lds
v_mfma_f32_16x16x32_bf16 v[216:219],a[176:179],a[152:155],v[216:219]
s_add_u32 m0,s68,36864
v_mfma_f32_16x16x32_bf16 v[216:219],a[180:183],a[156:159],v[216:219]
s_waitcnt lgkmcnt(0)
v_mfma_f32_16x16x32_bf16 a[20:23],a[184:187],a[96:99],a[20:23]
ds_read_b64_tr_b16 a[160:161],v8 offset:8192
v_mfma_f32_16x16x32_bf16 a[20:23],a[188:191],a[100:103],a[20:23]
ds_read_b64_tr_b16 a[162:163],v8 offset:10240
v_mfma_f32_16x16x32_bf16 a[28:31],a[184:187],a[104:107],a[28:31]
ds_read_b64_tr_b16 a[164:165],v8 offset:12288
v_mfma_f32_16x16x32_bf16 a[28:31],a[188:191],a[108:111],a[28:31]
ds_read_b64_tr_b16 a[166:167],v8 offset:14336
v_mfma_f32_16x16x32_bf16 v[84:87],a[184:187],a[112:115],v[84:87]
v_mfma_f32_16x16x32_bf16 v[84:87],a[188:191],a[116:119],v[84:87]
buffer_load_dwordx4 v4,s[8:11],s36 offen lds
v_mfma_f32_16x16x32_bf16 v[92:95],a[184:187],a[120:123],v[92:95]
s_add_u32 m0,s68,37888
v_mfma_f32_16x16x32_bf16 v[92:95],a[188:191],a[124:127],v[92:95]
v_mfma_f32_16x16x32_bf16 v[148:151],a[184:187],a[128:131],v[148:151]
v_mfma_f32_16x16x32_bf16 v[148:151],a[188:191],a[132:135],v[148:151]
buffer_load_dwordx4 v4,s[8:11],s37 offen lds
v_mfma_f32_16x16x32_bf16 v[156:159],a[184:187],a[136:139],v[156:159]
s_add_u32 m0,s68,38912
v_mfma_f32_16x16x32_bf16 v[156:159],a[188:191],a[140:143],v[156:159]
v_mfma_f32_16x16x32_bf16 v[212:215],a[184:187],a[144:147],v[212:215]
v_mfma_f32_16x16x32_bf16 v[212:215],a[188:191],a[148:151],v[212:215]
buffer_load_dwordx4 v4,s[8:11],s38 offen lds
v_mfma_f32_16x16x32_bf16 v[220:223],a[184:187],a[152:155],v[220:223]
s_waitcnt vmcnt(29)
s_add_u32 m0,s68,39936
v_mfma_f32_16x16x32_bf16 v[220:223],a[188:191],a[156:159],v[220:223]
s_barrier
s_waitcnt lgkmcnt(2)
v_mfma_f32_16x16x32_bf16 v[32:35],a[160:163],a[96:99],v[32:35]
ds_read_b64_tr_b16 a[168:169],v9 offset:8192
s_waitcnt lgkmcnt(1)
v_mfma_f32_16x16x32_bf16 v[32:35],a[164:167],a[100:103],v[32:35]
ds_read_b64_tr_b16 a[170:171],v9 offset:10240
v_mfma_f32_16x16x32_bf16 v[40:43],a[160:163],a[104:107],v[40:43]
ds_read_b64_tr_b16 a[172:173],v9 offset:12288
v_mfma_f32_16x16x32_bf16 v[40:43],a[164:167],a[108:111],v[40:43]
ds_read_b64_tr_b16 a[174:175],v9 offset:14336
v_mfma_f32_16x16x32_bf16 v[96:99],a[160:163],a[112:115],v[96:99]
ds_read_b128 a[32:35],v2 offset:0
v_mfma_f32_16x16x32_bf16 v[96:99],a[164:167],a[116:119],v[96:99]
buffer_load_dwordx4 v4,s[8:11],s39 offen lds
v_mfma_f32_16x16x32_bf16 v[104:107],a[160:163],a[120:123],v[104:107]
s_add_u32 s67,s64,1048576
buffer_load_dword a221,v5,s[12:15],s67 offen nt
v_mfma_f32_16x16x32_bf16 v[104:107],a[164:167],a[124:127],v[104:107]
ds_read_b128 a[36:39],v3 offset:0
v_mfma_f32_16x16x32_bf16 v[160:163],a[160:163],a[128:131],v[160:163]
global_load_dword a254,v0,s[100:101]
v_mfma_f32_16x16x32_bf16 v[160:163],a[164:167],a[132:135],v[160:163]
ds_read_b128 a[40:43],v2 offset:2048
v_mfma_f32_16x16x32_bf16 v[168:171],a[160:163],a[136:139],v[168:171]
ds_read_b128 a[44:47],v3 offset:2048
v_mfma_f32_16x16x32_bf16 v[168:171],a[164:167],a[140:143],v[168:171]
buffer_load_dword a204,v19,s[4:7],0 offen offset:3072 nt
v_mfma_f32_16x16x32_bf16 v[224:227],a[160:163],a[144:147],v[224:227]
ds_read_b128 a[48:51],v2 offset:4096
v_mfma_f32_16x16x32_bf16 v[224:227],a[164:167],a[148:151],v[224:227]
s_waitcnt lgkmcnt(7)
v_add_u32 v0,s79,v0
v_mfma_f32_16x16x32_bf16 v[232:235],a[160:163],a[152:155],v[232:235]
ds_read_b128 a[52:55],v3 offset:4096
v_mfma_f32_16x16x32_bf16 v[232:235],a[164:167],a[156:159],v[232:235]
buffer_load_dword a205,v16,s[4:7],0 offen offset:0 nt
v_mfma_f32_16x16x32_bf16 v[36:39],a[168:171],a[96:99],v[36:39]
ds_read_b64_tr_b16 a[176:177],v10 offset:8192
s_waitcnt lgkmcnt(7)
v_mfma_f32_16x16x32_bf16 v[36:39],a[172:175],a[100:103],v[36:39]
ds_read_b64_tr_b16 a[178:179],v10 offset:10240
v_mfma_f32_16x16x32_bf16 v[44:47],a[168:171],a[104:107],v[44:47]
ds_read_b64_tr_b16 a[180:181],v10 offset:12288
v_mfma_f32_16x16x32_bf16 v[44:47],a[172:175],a[108:111],v[44:47]
ds_read_b64_tr_b16 a[182:183],v10 offset:14336
v_mfma_f32_16x16x32_bf16 v[100:103],a[168:171],a[112:115],v[100:103]
ds_read_b128 a[56:59],v2 offset:6144
v_mfma_f32_16x16x32_bf16 v[100:103],a[172:175],a[116:119],v[100:103]
buffer_load_dword a206,v16,s[4:7],0 offen offset:1024 nt
v_mfma_f32_16x16x32_bf16 v[108:111],a[168:171],a[120:123],v[108:111]
ds_read_b128 a[60:63],v3 offset:6144
v_mfma_f32_16x16x32_bf16 v[108:111],a[172:175],a[124:127],v[108:111]
buffer_load_dword a207,v16,s[4:7],0 offen offset:2048 nt
v_mfma_f32_16x16x32_bf16 v[164:167],a[168:171],a[128:131],v[164:167]
ds_read_b128 a[64:67],v2 offset:8192
v_mfma_f32_16x16x32_bf16 v[164:167],a[172:175],a[132:135],v[164:167]
buffer_load_dword a208,v16,s[4:7],0 offen offset:3072 nt
v_mfma_f32_16x16x32_bf16 v[172:175],a[168:171],a[136:139],v[172:175]
ds_read_b128 a[68:71],v3 offset:8192
v_mfma_f32_16x16x32_bf16 v[172:175],a[172:175],a[140:143],v[172:175]
buffer_load_dword a209,v16,s[4:7],s3 offen offset:0 nt
v_mfma_f32_16x16x32_bf16 v[228:231],a[168:171],a[144:147],v[228:231]
ds_read_b128 a[72:75],v2 offset:10240
v_mfma_f32_16x16x32_bf16 v[228:231],a[172:175],a[148:151],v[228:231]
buffer_load_dword a210,v16,s[4:7],s3 offen offset:1024 nt
v_mfma_f32_16x16x32_bf16 v[236:239],a[168:171],a[152:155],v[236:239]
ds_read_b128 a[76:79],v3 offset:10240
v_mfma_f32_16x16x32_bf16 v[236:239],a[172:175],a[156:159],v[236:239]
buffer_load_dword a211,v16,s[4:7],s3 offen offset:2048 nt
s_waitcnt lgkmcnt(8)
v_mfma_f32_16x16x32_bf16 v[48:51],a[176:179],a[96:99],v[48:51]
ds_read_b64_tr_b16 a[184:185],v11 offset:8192
s_waitcnt lgkmcnt(7)
v_mfma_f32_16x16x32_bf16 v[48:51],a[180:183],a[100:103],v[48:51]
ds_read_b64_tr_b16 a[186:187],v11 offset:10240
v_mfma_f32_16x16x32_bf16 v[56:59],a[176:179],a[104:107],v[56:59]
ds_read_b64_tr_b16 a[188:189],v11 offset:12288
v_mfma_f32_16x16x32_bf16 v[56:59],a[180:183],a[108:111],v[56:59]
ds_read_b64_tr_b16 a[190:191],v11 offset:14336
v_mfma_f32_16x16x32_bf16 v[112:115],a[176:179],a[112:115],v[112:115]
ds_read_b128 a[80:83],v2 offset:12288
v_mfma_f32_16x16x32_bf16 v[112:115],a[180:183],a[116:119],v[112:115]
buffer_load_dword a212,v16,s[4:7],s3 offen offset:3072 nt
v_mfma_f32_16x16x32_bf16 v[120:123],a[176:179],a[120:123],v[120:123]
ds_read_b128 a[84:87],v3 offset:12288
s_mov_b32 s4,s62
v_mfma_f32_16x16x32_bf16 v[120:123],a[180:183],a[124:127],v[120:123]
s_and_b32 s5,s63,0xffff
s_movk_i32 s6,4096
v_mfma_f32_16x16x32_bf16 v[176:179],a[176:179],a[128:131],v[176:179]
ds_read_b128 a[88:91],v2 offset:14336
v_mfma_f32_16x16x32_bf16 v[176:179],a[180:183],a[132:135],v[176:179]
buffer_load_dwordx4 a[216:219],v20,s[4:7],0 offen
v_mfma_f32_16x16x32_bf16 v[184:187],a[176:179],a[136:139],v[184:187]
ds_read_b128 a[92:95],v3 offset:14336
s_mov_b32 s4,s24
v_mfma_f32_16x16x32_bf16 v[184:187],a[180:183],a[140:143],v[184:187]
s_and_b32 s5,s25,0xffff
s_mov_b32 s6,2097152
s_and_b32 s3,s2,7
v_mfma_f32_16x16x32_bf16 v[240:243],a[176:179],a[144:147],v[240:243]
s_lshl_b32 s3,s3,5
s_lshr_b32 s24,s2,3
s_add_u32 s3,s3,s24
v_mfma_f32_16x16x32_bf16 v[240:243],a[180:183],a[148:151],v[240:243]
s_lshl_b32 s3,s3,13
s_lshl_b32 s24,s20,11
s_add_u32 s3,s3,s24
v_mfma_f32_16x16x32_bf16 v[248:251],a[176:179],a[152:155],v[248:251]
buffer_load_dwordx4 a[240:243],v1,s[4:7],s3 offen offset:0 nt
v_mfma_f32_16x16x32_bf16 v[248:251],a[180:183],a[156:159],v[248:251]
buffer_load_dwordx4 a[244:247],v1,s[4:7],s3 offen offset:1024 nt
s_waitcnt lgkmcnt(6)
v_mfma_f32_16x16x32_bf16 v[52:55],a[184:187],a[96:99],v[52:55]
s_waitcnt vmcnt(22) lgkmcnt(0)
v_mfma_f32_16x16x32_bf16 v[52:55],a[188:191],a[100:103],v[52:55]
s_barrier
s_lshr_b32 s28,s22,1
s_lshl_b32 s29,s20,2
s_add_u32 s28,s28,s29
s_cmp_lg_u32 s28,2
s_cbranch_scc1 F_ARR3
s_mov_b64 exec,1
s_and_b32 s28,s2,7
s_lshl_b32 s28,s28,5
v_mov_b32 v28,s28
v_mov_b32 v29,1
global_atomic_add v28,v29,s[94:95] sc1
s_mov_b64 exec,-1
F_ARR3:
v_mfma_f32_16x16x32_bf16 v[60:63],a[184:187],a[104:107],v[60:63]
ds_read_b64_tr_b16 a[160:161],v8 offset:32768
v_mfma_f32_16x16x32_bf16 v[60:63],a[188:191],a[108:111],v[60:63]
ds_read_b64_tr_b16 a[162:163],v8 offset:34816
v_mfma_f32_16x16x32_bf16 v[116:119],a[184:187],a[112:115],v[116:119]
ds_read_b64_tr_b16 a[164:165],v8 offset:36864
v_mfma_f32_16x16x32_bf16 v[116:119],a[188:191],a[116:119],v[116:119]
s_add_u32 m0,s68,131072
v_add_u32 v5,524288,v5
v_mfma_f32_16x16x32_bf16 v[124:127],a[184:187],a[120:123],v[124:127]
ds_read_b64_tr_b16 a[166:167],v8 offset:38912
v_mfma_f32_16x16x32_bf16 v[124:127],a[188:191],a[124:127],v[124:127]
buffer_load_dwordx4 v5,s[12:15],s40 offen nt lds
v_mfma_f32_16x16x32_bf16 v[180:183],a[184:187],a[128:131],v[180:183]
s_add_u32 m0,s68,132096
v_mfma_f32_16x16x32_bf16 v[180:183],a[188:191],a[132:135],v[180:183]
v_mfma_f32_16x16x32_bf16 v[188:191],a[184:187],a[136:139],v[188:191]
v_mfma_f32_16x16x32_bf16 v[188:191],a[188:191],a[140:143],v[188:191]
buffer_load_dwordx4 v5,s[12:15],s41 offen nt lds
v_mfma_f32_16x16x32_bf16 v[244:247],a[184:187],a[144:147],v[244:247]
s_add_u32 m0,s68,133120
v_mfma_f32_16x16x32_bf16 v[244:247],a[188:191],a[148:151],v[244:247]
v_mfma_f32_16x16x32_bf16 v[252:255],a[184:187],a[152:155],v[252:255]
s_waitcnt lgkmcnt(0)
v_mfma_f32_16x16x32_bf16 v[252:255],a[188:191],a[156:159],v[252:255]
buffer_load_dwordx4 v5,s[12:15],s42 offen nt lds
v_mfma_f32_16x16x32_bf16 a[0:3],a[160:163],a[32:35],a[0:3]
ds_read_b64_tr_b16 a[168:169],v9 offset:32768
s_add_u32 m0,s68,134144
v_mfma_f32_16x16x32_bf16 a[0:3],a[164:167],a[36:39],a[0:3]
ds_read_b64_tr_b16 a[170:171],v9 offset:34816
v_mfma_f32_16x16x32_bf16 a[8:11],a[160:163],a[40:43],a[8:11]
ds_read_b64_tr_b16 a[172:173],v9 offset:36864
v_mfma_f32_16x16x32_bf16 a[8:11],a[164:167],a[44:47],a[8:11]
ds_read_b64_tr_b16 a[174:175],v9 offset:38912
v_mfma_f32_16x16x32_bf16 v[64:67],a[160:163],a[48:51],v[64:67]
v_mfma_f32_16x16x32_bf16 v[64:67],a[164:167],a[52:55],v[64:67]
buffer_load_dwordx4 v5,s[12:15],s43 offen nt lds
v_mfma_f32_16x16x32_bf16 v[72:75],a[160:163],a[56:59],v[72:75]
s_add_u32 m0,s68,135168
v_mfma_f32_16x16x32_bf16 v[72:75],a[164:167],a[60:63],v[72:75]
v_mfma_f32_16x16x32_bf16 v[128:131],a[160:163],a[64:67],v[128:131]
v_mfma_f32_16x16x32_bf16 v[128:131],a[164:167],a[68:71],v[128:131]
buffer_load_dwordx4 v5,s[12:15],s44 offen nt lds
v_mfma_f32_16x16x32_bf16 v[136:139],a[160:163],a[72:75],v[136:139]
s_add_u32 m0,s68,136192
v_mfma_f32_16x16x32_bf16 v[136:139],a[164:167],a[76:79],v[136:139]
v_mfma_f32_16x16x32_bf16 v[192:195],a[160:163],a[80:83],v[192:195]
v_mfma_f32_16x16x32_bf16 v[192:195],a[164:167],a[84:87],v[192:195]
buffer_load_dwordx4 v5,s[12:15],s45 offen nt lds
v_mfma_f32_16x16x32_bf16 v[200:203],a[160:163],a[88:91],v[200:203]
s_add_u32 m0,s68,137216
v_mfma_f32_16x16x32_bf16 v[200:203],a[164:167],a[92:95],v[200:203]
s_waitcnt lgkmcnt(0)
v_mfma_f32_16x16x32_bf16 a[4:7],a[168:171],a[32:35],a[4:7]
ds_read_b64_tr_b16 a[176:177],v10 offset:32768
v_mfma_f32_16x16x32_bf16 a[4:7],a[172:175],a[36:39],a[4:7]
ds_read_b64_tr_b16 a[178:179],v10 offset:34816
v_mfma_f32_16x16x32_bf16 a[12:15],a[168:171],a[40:43],a[12:15]
ds_read_b64_tr_b16 a[180:181],v10 offset:36864
v_mfma_f32_16x16x32_bf16 a[12:15],a[172:175],a[44:47],a[12:15]
ds_read_b64_tr_b16 a[182:183],v10 offset:38912
v_mfma_f32_16x16x32_bf16 v[68:71],a[168:171],a[48:51],v[68:71]
v_mfma_f32_16x16x32_bf16 v[68:71],a[172:175],a[52:55],v[68:71]
buffer_load_dwordx4 v5,s[12:15],s46 offen nt lds
v_mfma_f32_16x16x32_bf16 v[76:79],a[168:171],a[56:59],v[76:79]
s_add_u32 m0,s68,138240
v_mfma_f32_16x16x32_bf16 v[76:79],a[172:175],a[60:63],v[76:79]
v_mfma_f32_16x16x32_bf16 v[132:135],a[168:171],a[64:67],v[132:135]
v_mfma_f32_16x16x32_bf16 v[132:135],a[172:175],a[68:71],v[132:135]
buffer_load_dwordx4 v5,s[12:15],s47 offen nt lds
v_mfma_f32_16x16x32_bf16 v[140:143],a[168:171],a[72:75],v[140:143]
s_add_u32 m0,s68,0
v_mfma_f32_16x16x32_bf16 v[140:143],a[172:175],a[76:79],v[140:143]
v_add_u32 v4,128,v4
v_mfma_f32_16x16x32_bf16 v[196:199],a[168:171],a[80:83],v[196:199]
v_mfma_f32_16x16x32_bf16 v[196:199],a[172:175],a[84:87],v[196:199]
buffer_load_dwordx4 v4,s[8:11],s32 offen lds
v_mfma_f32_16x16x32_bf16 v[204:207],a[168:171],a[88:91],v[204:207]
s_add_u32 m0,s68,1024
v_mfma_f32_16x16x32_bf16 v[204:207],a[172:175],a[92:95],v[204:207]
s_waitcnt lgkmcnt(0)
v_mfma_f32_16x16x32_bf16 a[16:19],a[176:179],a[32:35],a[16:19]
ds_read_b64_tr_b16 a[184:185],v11 offset:32768
v_mfma_f32_16x16x32_bf16 a[16:19],a[180:183],a[36:39],a[16:19]
ds_read_b64_tr_b16 a[186:187],v11 offset:34816
v_mfma_f32_16x16x32_bf16 a[24:27],a[176:179],a[40:43],a[24:27]
ds_read_b64_tr_b16 a[188:189],v11 offset:36864
v_mfma_f32_16x16x32_bf16 a[24:27],a[180:183],a[44:47],a[24:27]
ds_read_b64_tr_b16 a[190:191],v11 offset:38912
v_mfma_f32_16x16x32_bf16 v[80:83],a[176:179],a[48:51],v[80:83]
v_mfma_f32_16x16x32_bf16 v[80:83],a[180:183],a[52:55],v[80:83]
buffer_load_dwordx4 v4,s[8:11],s33 offen lds
v_mfma_f32_16x16x32_bf16 v[88:91],a[176:179],a[56:59],v[88:91]
s_add_u32 m0,s68,2048
v_mfma_f32_16x16x32_bf16 v[88:91],a[180:183],a[60:63],v[88:91]
v_mfma_f32_16x16x32_bf16 v[144:147],a[176:179],a[64:67],v[144:147]
v_mfma_f32_16x16x32_bf16 v[144:147],a[180:183],a[68:71],v[144:147]
buffer_load_dwordx4 v4,s[8:11],s34 offen lds
v_mfma_f32_16x16x32_bf16 v[152:155],a[176:179],a[72:75],v[152:155]
s_add_u32 m0,s68,3072
v_mfma_f32_16x16x32_bf16 v[152:155],a[180:183],a[76:79],v[152:155]
v_mfma_f32_16x16x32_bf16 v[208:211],a[176:179],a[80:83],v[208:211]
v_mfma_f32_16x16x32_bf16 v[208:211],a[180:183],a[84:87],v[208:211]
buffer_load_dwordx4 v4,s[8:11],s35 offen lds
v_mfma_f32_16x16x32_bf16 v[216:219],a[176:179],a[88:91],v[216:219]
s_add_u32 m0,s68,4096
v_mfma_f32_16x16x32_bf16 v[216:219],a[180:183],a[92:95],v[216:219]
s_waitcnt lgkmcnt(0)
v_mfma_f32_16x16x32_bf16 a[20:23],a[184:187],a[32:35],a[20:23]
ds_read_b64_tr_b16 a[160:161],v8 offset:40960
v_mfma_f32_16x16x32_bf16 a[20:23],a[188:191],a[36:39],a[20:23]
ds_read_b64_tr_b16 a[162:163],v8 offset:43008
v_mfma_f32_16x16x32_bf16 a[28:31],a[184:187],a[40:43],a[28:31]
ds_read_b64_tr_b16 a[164:165],v8 offset:45056
v_mfma_f32_16x16x32_bf16 a[28:31],a[188:191],a[44:47],a[28:31]
ds_read_b64_tr_b16 a[166:167],v8 offset:47104
v_mfma_f32_16x16x32_bf16 v[84:87],a[184:187],a[48:51],v[84:87]
v_mfma_f32_16x16x32_bf16 v[84:87],a[188:191],a[52:55],v[84:87]
buffer_load_dwordx4 v4,s[8:11],s36 offen lds
v_mfma_f32_16x16x32_bf16 v[92:95],a[184:187],a[56:59],v[92:95]
s_add_u32 m0,s68,5120
v_mfma_f32_16x16x32_bf16 v[92:95],a[188:191],a[60:63],v[92:95]
v_mfma_f32_16x16x32_bf16 v[148:151],a[184:187],a[64:67],v[148:151]
v_mfma_f32_16x16x32_bf16 v[148:151],a[188:191],a[68:71],v[148:151]
buffer_load_dwordx4 v4,s[8:11],s37 offen lds
v_mfma_f32_16x16x32_bf16 v[156:159],a[184:187],a[72:75],v[156:159]
s_add_u32 m0,s68,6144
v_mfma_f32_16x16x32_bf16 v[156:159],a[188:191],a[76:79],v[156:159]
v_mfma_f32_16x16x32_bf16 v[212:215],a[184:187],a[80:83],v[212:215]
v_mfma_f32_16x16x32_bf16 v[212:215],a[188:191],a[84:87],v[212:215]
buffer_load_dwordx4 v4,s[8:11],s38 offen lds
v_mfma_f32_16x16x32_bf16 v[220:223],a[184:187],a[88:91],v[220:223]
s_waitcnt vmcnt(29)
s_add_u32 m0,s68,7168
v_mfma_f32_16x16x32_bf16 v[220:223],a[188:191],a[92:95],v[220:223]
s_barrier
s_waitcnt lgkmcnt(2)
v_mfma_f32_16x16x32_bf16 v[32:35],a[160:163],a[32:35],v[32:35]
ds_read_b64_tr_b16 a[168:169],v9 offset:40960
s_waitcnt lgkmcnt(1)
v_mfma_f32_16x16x32_bf16 v[32:35],a[164:167],a[36:39],v[32:35]
ds_read_b64_tr_b16 a[170:171],v9 offset:43008
v_mfma_f32_16x16x32_bf16 v[40:43],a[160:163],a[40:43],v[40:43]
ds_read_b64_tr_b16 a[172:173],v9 offset:45056
v_mfma_f32_16x16x32_bf16 v[40:43],a[164:167],a[44:47],v[40:43]
ds_read_b64_tr_b16 a[174:175],v9 offset:47104
v_mfma_f32_16x16x32_bf16 v[96:99],a[160:163],a[48:51],v[96:99]
ds_read_b128 a[96:99],v2 offset:32768
v_mfma_f32_16x16x32_bf16 v[96:99],a[164:167],a[52:55],v[96:99]
buffer_load_dwordx4 v4,s[8:11],s39 offen lds
v_mfma_f32_16x16x32_bf16 v[104:107],a[160:163],a[56:59],v[104:107]
s_add_u32 s67,s64,1048576
buffer_load_dword a220,v5,s[12:15],s67 offen nt
v_mfma_f32_16x16x32_bf16 v[104:107],a[164:167],a[60:63],v[104:107]
ds_read_b128 a[100:103],v3 offset:32768
v_mfma_f32_16x16x32_bf16 v[160:163],a[160:163],a[64:67],v[160:163]
global_load_dword a255,v0,s[100:101]
v_mfma_f32_16x16x32_bf16 v[160:163],a[164:167],a[68:71],v[160:163]
ds_read_b128 a[104:107],v2 offset:34816
v_mfma_f32_16x16x32_bf16 v[168:171],a[160:163],a[72:75],v[168:171]
ds_read_b128 a[108:111],v3 offset:34816
v_mfma_f32_16x16x32_bf16 v[168:171],a[164:167],a[76:79],v[168:171]
v_mfma_f32_16x16x32_bf16 v[224:227],a[160:163],a[80:83],v[224:227]
ds_read_b128 a[112:115],v2 offset:36864
v_mfma_f32_16x16x32_bf16 v[224:227],a[164:167],a[84:87],v[224:227]
v_add_u32 v0,s79,v0
v_mfma_f32_16x16x32_bf16 v[232:235],a[160:163],a[88:91],v[232:235]
ds_read_b128 a[116:119],v3 offset:36864
v_mfma_f32_16x16x32_bf16 v[232:235],a[164:167],a[92:95],v[232:235]
s_waitcnt lgkmcnt(6)
v_mfma_f32_16x16x32_bf16 v[36:39],a[168:171],a[32:35],v[36:39]
ds_read_b64_tr_b16 a[176:177],v10 offset:40960
v_mfma_f32_16x16x32_bf16 v[36:39],a[172:175],a[36:39],v[36:39]
ds_read_b64_tr_b16 a[178:179],v10 offset:43008
v_mfma_f32_16x16x32_bf16 v[44:47],a[168:171],a[40:43],v[44:47]
ds_read_b64_tr_b16 a[180:181],v10 offset:45056
v_mfma_f32_16x16x32_bf16 v[44:47],a[172:175],a[44:47],v[44:47]
ds_read_b64_tr_b16 a[182:183],v10 offset:47104
v_mfma_f32_16x16x32_bf16 v[100:103],a[168:171],a[48:51],v[100:103]
ds_read_b128 a[120:123],v2 offset:38912
v_mfma_f32_16x16x32_bf16 v[100:103],a[172:175],a[52:55],v[100:103]
v_mfma_f32_16x16x32_bf16 v[108:111],a[168:171],a[56:59],v[108:111]
ds_read_b128 a[124:127],v3 offset:38912
v_mfma_f32_16x16x32_bf16 v[108:111],a[172:175],a[60:63],v[108:111]
v_mfma_f32_16x16x32_bf16 v[164:167],a[168:171],a[64:67],v[164:167]
ds_read_b128 a[128:131],v2 offset:40960
v_mfma_f32_16x16x32_bf16 v[164:167],a[172:175],a[68:71],v[164:167]
v_mfma_f32_16x16x32_bf16 v[172:175],a[168:171],a[72:75],v[172:175]
ds_read_b128 a[132:135],v3 offset:40960
v_mfma_f32_16x16x32_bf16 v[172:175],a[172:175],a[76:79],v[172:175]
v_mfma_f32_16x16x32_bf16 v[228:231],a[168:171],a[80:83],v[228:231]
ds_read_b128 a[136:139],v2 offset:43008
v_mfma_f32_16x16x32_bf16 v[228:231],a[172:175],a[84:87],v[228:231]
v_mfma_f32_16x16x32_bf16 v[236:239],a[168:171],a[88:91],v[236:239]
ds_read_b128 a[140:143],v3 offset:43008
v_mfma_f32_16x16x32_bf16 v[236:239],a[172:175],a[92:95],v[236:239]
s_waitcnt lgkmcnt(6)
v_mfma_f32_16x16x32_bf16 v[48:51],a[176:179],a[32:35],v[48:51]
ds_read_b64_tr_b16 a[184:185],v11 offset:40960
v_mfma_f32_16x16x32_bf16 v[48:51],a[180:183],a[36:39],v[48:51]
ds_read_b64_tr_b16 a[186:187],v11 offset:43008
v_mfma_f32_16x16x32_bf16 v[56:59],a[176:179],a[40:43],v[56:59]
ds_read_b64_tr_b16 a[188:189],v11 offset:45056
v_mfma_f32_16x16x32_bf16 v[56:59],a[180:183],a[44:47],v[56:59]
ds_read_b64_tr_b16 a[190:191],v11 offset:47104
v_mfma_f32_16x16x32_bf16 v[112:115],a[176:179],a[48:51],v[112:115]
ds_read_b128 a[144:147],v2 offset:45056
v_mfma_f32_16x16x32_bf16 v[112:115],a[180:183],a[52:55],v[112:115]
v_mfma_f32_16x16x32_bf16 v[120:123],a[176:179],a[56:59],v[120:123]
ds_read_b128 a[148:151],v3 offset:45056
v_mfma_f32_16x16x32_bf16 v[120:123],a[180:183],a[60:63],v[120:123]
v_mfma_f32_16x16x32_bf16 v[176:179],a[176:179],a[64:67],v[176:179]
ds_read_b128 a[152:155],v2 offset:47104
v_mfma_f32_16x16x32_bf16 v[176:179],a[180:183],a[68:71],v[176:179]
v_mfma_f32_16x16x32_bf16 v[184:187],a[176:179],a[72:75],v[184:187]
ds_read_b128 a[156:159],v3 offset:47104
v_mfma_f32_16x16x32_bf16 v[184:187],a[180:183],a[76:79],v[184:187]
v_mfma_f32_16x16x32_bf16 v[240:243],a[176:179],a[80:83],v[240:243]
v_mfma_f32_16x16x32_bf16 v[240:243],a[180:183],a[84:87],v[240:243]
v_mfma_f32_16x16x32_bf16 v[248:251],a[176:179],a[88:91],v[248:251]
v_mfma_f32_16x16x32_bf16 v[248:251],a[180:183],a[92:95],v[248:251]
s_waitcnt lgkmcnt(6)
v_mfma_f32_16x16x32_bf16 v[52:55],a[184:187],a[32:35],v[52:55]
s_waitcnt vmcnt(10) lgkmcnt(0)
v_mfma_f32_16x16x32_bf16 v[52:55],a[188:191],a[36:39],v[52:55]
s_barrier
s_lshr_b32 s28,s22,1
s_lshl_b32 s29,s20,2
s_add_u32 s28,s28,s29
s_cmp_lg_u32 s28,3
s_cbranch_scc1 F_ARR4
s_mov_b64 exec,1
s_and_b32 s28,s2,7
s_lshl_b32 s28,s28,5
v_mov_b32 v28,s28
v_mov_b32 v29,1
global_atomic_add v28,v29,s[94:95] sc1
s_mov_b64 exec,-1
F_ARR4:
v_mfma_f32_16x16x32_bf16 v[60:63],a[184:187],a[40:43],v[60:63]
ds_read_b64_tr_b16 a[160:161],v12 offset:0
v_mfma_f32_16x16x32_bf16 v[60:63],a[188:191],a[44:47],v[60:63]
ds_read_b64_tr_b16 a[162:163],v12 offset:2048
v_mfma_f32_16x16x32_bf16 v[116:119],a[184:187],a[48:51],v[116:119]
ds_read_b64_tr_b16 a[164:165],v12 offset:4096
v_mfma_f32_16x16x32_bf16 v[116:119],a[188:191],a[52:55],v[116:119]
s_add_u32 m0,s68,65536
v_add_u32 v5,524288,v5
v_mfma_f32_16x16x32_bf16 v[124:127],a[184:187],a[56:59],v[124:127]
ds_read_b64_tr_b16 a[166:167],v12 offset:6144
v_mfma_f32_16x16x32_bf16 v[124:127],a[188:191],a[60:63],v[124:127]
buffer_load_dwordx4 v5,s[12:15],s40 offen nt lds
v_mfma_f32_16x16x32_bf16 v[180:183],a[184:187],a[64:67],v[180:183]
s_add_u32 m0,s68,66560
v_mfma_f32_16x16x32_bf16 v[180:183],a[188:191],a[68:71],v[180:183]
v_mfma_f32_16x16x32_bf16 v[188:191],a[184:187],a[72:75],v[188:191]
v_mfma_f32_16x16x32_bf16 v[188:191],a[188:191],a[76:79],v[188:191]
buffer_load_dwordx4 v5,s[12:15],s41 offen nt lds
v_mfma_f32_16x16x32_bf16 v[244:247],a[184:187],a[80:83],v[244:247]
s_add_u32 m0,s68,67584
v_mfma_f32_16x16x32_bf16 v[244:247],a[188:191],a[84:87],v[244:247]
v_mfma_f32_16x16x32_bf16 v[252:255],a[184:187],a[88:91],v[252:255]
s_waitcnt lgkmcnt(0)
v_mfma_f32_16x16x32_bf16 v[252:255],a[188:191],a[92:95],v[252:255]
buffer_load_dwordx4 v5,s[12:15],s42 offen nt lds
v_mfma_f32_16x16x32_bf16 a[0:3],a[160:163],a[96:99],a[0:3]
ds_read_b64_tr_b16 a[168:169],v13 offset:0
s_add_u32 m0,s68,68608
v_mfma_f32_16x16x32_bf16 a[0:3],a[164:167],a[100:103],a[0:3]
ds_read_b64_tr_b16 a[170:171],v13 offset:2048
v_accvgpr_read_b32 v19,a216
v_mfma_f32_16x16x32_bf16 a[8:11],a[160:163],a[104:107],a[8:11]
ds_read_b64_tr_b16 a[172:173],v13 offset:4096
v_lshlrev_b32 v19,16,v19
v_mfma_f32_16x16x32_bf16 a[8:11],a[164:167],a[108:111],a[8:11]
ds_read_b64_tr_b16 a[174:175],v13 offset:6144
v_accvgpr_read_b32 v20,a216
v_mfma_f32_16x16x32_bf16 v[64:67],a[160:163],a[112:115],v[64:67]
v_and_b32 v20,0xffff0000,v20
v_accvgpr_read_b32 v21,a217
v_mfma_f32_16x16x32_bf16 v[64:67],a[164:167],a[116:119],v[64:67]
buffer_load_dwordx4 v5,s[12:15],s43 offen nt lds
v_mfma_f32_16x16x32_bf16 v[72:75],a[160:163],a[120:123],v[72:75]
s_add_u32 m0,s68,69632
v_lshlrev_b32 v21,16,v21
v_accvgpr_read_b32 v22,a217
v_mfma_f32_16x16x32_bf16 v[72:75],a[164:167],a[124:127],v[72:75]
v_and_b32 v22,0xffff0000,v22
v_accvgpr_read_b32 v24,a192
v_mfma_f32_16x16x32_bf16 v[128:131],a[160:163],a[128:131],v[128:131]
v_lshlrev_b32 v24,16,v24
v_accvgpr_read_b32 v25,a193
v_mfma_f32_16x16x32_bf16 v[128:131],a[164:167],a[132:135],v[128:131]
buffer_load_dwordx4 v5,s[12:15],s44 offen nt lds
v_mfma_f32_16x16x32_bf16 v[136:139],a[160:163],a[136:139],v[136:139]
s_add_u32 m0,s68,70656
v_lshlrev_b32 v25,16,v25
v_accvgpr_read_b32 v26,a194
v_mfma_f32_16x16x32_bf16 v[136:139],a[164:167],a[140:143],v[136:139]
v_lshlrev_b32 v26,16,v26
v_accvgpr_read_b32 v27,a195
v_mfma_f32_16x16x32_bf16 v[192:195],a[160:163],a[144:147],v[192:195]
v_lshlrev_b32 v27,16,v27
v_mul_f32 v30,v24,v22
v_mfma_f32_16x16x32_bf16 v[192:195],a[164:167],a[148:151],v[192:195]
buffer_load_dwordx4 v5,s[12:15],s45 offen nt lds
v_mfma_f32_16x16x32_bf16 v[200:203],a[160:163],a[152:155],v[200:203]
s_add_u32 m0,s68,71680
v_fmac_f32 v30,v25,v21
v_fmac_f32 v30,v26,v20
v_mfma_f32_16x16x32_bf16 v[200:203],a[164:167],a[156:159],v[200:203]
s_waitcnt lgkmcnt(0)
v_fmac_f32 v30,v27,v19
v_accvgpr_read_b32 v17,a204
v_mfma_f32_16x16x32_bf16 a[4:7],a[168:171],a[96:99],a[4:7]
ds_read_b64_tr_b16 a[176:177],v14 offset:0
v_lshlrev_b32 v17,16,v17
v_mfma_f32_16x16x32_bf16 a[4:7],a[172:175],a[100:103],a[4:7]
ds_read_b64_tr_b16 a[178:179],v14 offset:2048
v_mul_f32 v30,v30,v17
v_mfma_f32_16x16x32_bf16 a[12:15],a[168:171],a[104:107],a[12:15]
ds_read_b64_tr_b16 a[180:181],v14 offset:4096
v_accvgpr_read_b32 v24,a196
v_mfma_f32_16x16x32_bf16 a[12:15],a[172:175],a[108:111],a[12:15]
ds_read_b64_tr_b16 a[182:183],v14 offset:6144
v_lshlrev_b32 v24,16,v24
v_mfma_f32_16x16x32_bf16 v[68:71],a[168:171],a[112:115],v[68:71]
v_mul_f32 v31,v25,v22
v_fmac_f32 v31,v26,v21
v_mfma_f32_16x16x32_bf16 v[68:71],a[172:175],a[116:119],v[68:71]
buffer_load_dwordx4 v5,s[12:15],s46 offen nt lds
v_mfma_f32_16x16x32_bf16 v[76:79],a[168:171],a[120:123],v[76:79]
s_add_u32 m0,s68,72704
v_fmac_f32 v31,v27,v20
v_fmac_f32 v31,v24,v19
v_mfma_f32_16x16x32_bf16 v[76:79],a[172:175],a[124:127],v[76:79]
v_accvgpr_read_b32 v17,a205
v_lshlrev_b32 v17,16,v17
v_mfma_f32_16x16x32_bf16 v[132:135],a[168:171],a[128:131],v[132:135]
v_mul_f32 v31,v31,v17
v_cvt_pk_bf16_f32 v17,v31,v30
v_mfma_f32_16x16x32_bf16 v[132:135],a[172:175],a[132:135],v[132:135]
buffer_load_dwordx4 v5,s[12:15],s47 offen nt lds
v_mfma_f32_16x16x32_bf16 v[140:143],a[168:171],a[136:139],v[140:143]
s_add_u32 m0,s68,32768
v_accvgpr_write_b32 a231,v17
v_accvgpr_read_b32 v25,a197
v_mfma_f32_16x16x32_bf16 v[140:143],a[172:175],a[140:143],v[140:143]
v_add_u32 v4,128,v4
v_lshlrev_b32 v25,16,v25
v_mfma_f32_16x16x32_bf16 v[196:199],a[168:171],a[144:147],v[196:199]
v_mul_f32 v30,v26,v22
v_fmac_f32 v30,v27,v21
v_mfma_f32_16x16x32_bf16 v[196:199],a[172:175],a[148:151],v[196:199]
buffer_load_dwordx4 v4,s[8:11],s32 offen lds
v_mfma_f32_16x16x32_bf16 v[204:207],a[168:171],a[152:155],v[204:207]
s_add_u32 m0,s68,33792
v_fmac_f32 v30,v24,v20
v_fmac_f32 v30,v25,v19
v_mfma_f32_16x16x32_bf16 v[204:207],a[172:175],a[156:159],v[204:207]
s_waitcnt lgkmcnt(0)
v_accvgpr_read_b32 v17,a206
v_lshlrev_b32 v17,16,v17
v_mfma_f32_16x16x32_bf16 a[16:19],a[176:179],a[96:99],a[16:19]
ds_read_b64_tr_b16 a[184:185],v15 offset:0
v_mul_f32 v30,v30,v17
v_mfma_f32_16x16x32_bf16 a[16:19],a[180:183],a[100:103],a[16:19]
ds_read_b64_tr_b16 a[186:187],v15 offset:2048
v_cvt_pk_bf16_f32 v17,v30,v31
v_mfma_f32_16x16x32_bf16 a[24:27],a[176:179],a[104:107],a[24:27]
ds_read_b64_tr_b16 a[188:189],v15 offset:4096
v_accvgpr_write_b32 a227,v17
v_mfma_f32_16x16x32_bf16 a[24:27],a[180:183],a[108:111],a[24:27]
ds_read_b64_tr_b16 a[190:191],v15 offset:6144
v_accvgpr_read_b32 v26,a198
v_mfma_f32_16x16x32_bf16 v[80:83],a[176:179],a[112:115],v[80:83]
v_lshlrev_b32 v26,16,v26
v_mul_f32 v31,v27,v22
v_mfma_f32_16x16x32_bf16 v[80:83],a[180:183],a[116:119],v[80:83]
buffer_load_dwordx4 v4,s[8:11],s33 offen lds
v_mfma_f32_16x16x32_bf16 v[88:91],a[176:179],a[120:123],v[88:91]
s_add_u32 m0,s68,34816
v_fmac_f32 v31,v24,v21
v_fmac_f32 v31,v25,v20
v_mfma_f32_16x16x32_bf16 v[88:91],a[180:183],a[124:127],v[88:91]
v_fmac_f32 v31,v26,v19
v_accvgpr_read_b32 v17,a207
v_mfma_f32_16x16x32_bf16 v[144:147],a[176:179],a[128:131],v[144:147]
v_lshlrev_b32 v17,16,v17
v_mul_f32 v31,v31,v17
v_mfma_f32_16x16x32_bf16 v[144:147],a[180:183],a[132:135],v[144:147]
buffer_load_dwordx4 v4,s[8:11],s34 offen lds
v_mfma_f32_16x16x32_bf16 v[152:155],a[176:179],a[136:139],v[152:155]
s_add_u32 m0,s68,35840
v_cvt_pk_bf16_f32 v17,v31,v30
v_accvgpr_write_b32 a230,v17
v_mfma_f32_16x16x32_bf16 v[152:155],a[180:183],a[140:143],v[152:155]
v_accvgpr_read_b32 v27,a199
v_lshlrev_b32 v27,16,v27
v_mfma_f32_16x16x32_bf16 v[208:211],a[176:179],a[144:147],v[208:211]
v_mul_f32 v30,v24,v22
v_fmac_f32 v30,v25,v21
v_mfma_f32_16x16x32_bf16 v[208:211],a[180:183],a[148:151],v[208:211]
buffer_load_dwordx4 v4,s[8:11],s35 offen lds
v_mfma_f32_16x16x32_bf16 v[216:219],a[176:179],a[152:155],v[216:219]
s_add_u32 m0,s68,36864
v_fmac_f32 v30,v26,v20
v_fmac_f32 v30,v27,v19
v_mfma_f32_16x16x32_bf16 v[216:219],a[180:183],a[156:159],v[216:219]
s_waitcnt lgkmcnt(0)
v_accvgpr_read_b32 v17,a208
v_lshlrev_b32 v17,16,v17
v_mfma_f32_16x16x32_bf16 a[20:23],a[184:187],a[96:99],a[20:23]
ds_read_b64_tr_b16 a[160:161],v12 offset:8192
v_mul_f32 v30,v30,v17
v_mfma_f32_16x16x32_bf16 a[20:23],a[188:191],a[100:103],a[20:23]
ds_read_b64_tr_b16 a[162:163],v12 offset:10240
v_cvt_pk_bf16_f32 v17,v30,v31
v_mfma_f32_16x16x32_bf16 a[28:31],a[184:187],a[104:107],a[28:31]
ds_read_b64_tr_b16 a[164:165],v12 offset:12288
v_accvgpr_write_b32 a226,v17
v_mfma_f32_16x16x32_bf16 a[28:31],a[188:191],a[108:111],a[28:31]
ds_read_b64_tr_b16 a[166:167],v12 offset:14336
v_accvgpr_read_b32 v24,a200
v_mfma_f32_16x16x32_bf16 v[84:87],a[184:187],a[112:115],v[84:87]
v_lshlrev_b32 v24,16,v24
v_mul_f32 v31,v25,v22
v_mfma_f32_16x16x32_bf16 v[84:87],a[188:191],a[116:119],v[84:87]
buffer_load_dwordx4 v4,s[8:11],s36 offen lds
v_mfma_f32_16x16x32_bf16 v[92:95],a[184:187],a[120:123],v[92:95]
s_add_u32 m0,s68,37888
v_fmac_f32 v31,v26,v21
v_fmac_f32 v31,v27,v20
v_mfma_f32_16x16x32_bf16 v[92:95],a[188:191],a[124:127],v[92:95]
v_fmac_f32 v31,v24,v19
v_accvgpr_read_b32 v17,a209
v_mfma_f32_16x16x32_bf16 v[148:151],a[184:187],a[128:131],v[148:151]
v_lshlrev_b32 v17,16,v17
v_mul_f32 v31,v31,v17
v_mfma_f32_16x16x32_bf16 v[148:151],a[188:191],a[132:135],v[148:151]
buffer_load_dwordx4 v4,s[8:11],s37 offen lds
v_mfma_f32_16x16x32_bf16 v[156:159],a[184:187],a[136:139],v[156:159]
s_add_u32 m0,s68,38912
v_cvt_pk_bf16_f32 v17,v31,v30
v_accvgpr_write_b32 a229,v17
v_mfma_f32_16x16x32_bf16 v[156:159],a[188:191],a[140:143],v[156:159]
v_accvgpr_read_b32 v25,a201
v_lshlrev_b32 v25,16,v25
v_mfma_f32_16x16x32_bf16 v[212:215],a[184:187],a[144:147],v[212:215]
v_mul_f32 v30,v26,v22
v_fmac_f32 v30,v27,v21
v_mfma_f32_16x16x32_bf16 v[212:215],a[188:191],a[148:151],v[212:215]
buffer_load_dwordx4 v4,s[8:11],s38 offen lds
v_mfma_f32_16x16x32_bf16 v[220:223],a[184:187],a[152:155],v[220:223]
s_waitcnt vmcnt(17)
s_add_u32 m0,s68,39936
v_fmac_f32 v30,v24,v20
v_mfma_f32_16x16x32_bf16 v[220:223],a[188:191],a[156:159],v[220:223]
s_barrier
v_fmac_f32 v30,v25,v19
v_accvgpr_read_b32 v17,a210
s_waitcnt lgkmcnt(2)
v_mfma_f32_16x16x32_bf16 v[32:35],a[160:163],a[96:99],v[32:35]
ds_read_b64_tr_b16 a[168:169],v13 offset:8192
v_lshlrev_b32 v17,16,v17
s_waitcnt lgkmcnt(1)
v_mfma_f32_16x16x32_bf16 v[32:35],a[164:167],a[100:103],v[32:35]
ds_read_b64_tr_b16 a[170:171],v13 offset:10240
v_mul_f32 v30,v30,v17
v_mfma_f32_16x16x32_bf16 v[40:43],a[160:163],a[104:107],v[40:43]
ds_read_b64_tr_b16 a[172:173],v13 offset:12288
v_cvt_pk_bf16_f32 v17,v30,v31
v_mfma_f32_16x16x32_bf16 v[40:43],a[164:167],a[108:111],v[40:43]
ds_read_b64_tr_b16 a[174:175],v13 offset:14336
v_accvgpr_write_b32 a225,v17
v_mfma_f32_16x16x32_bf16 v[96:99],a[160:163],a[112:115],v[96:99]
s_lshl_b32 s56,s80,14
ds_read_b128 a[32:35],v2 offset:0
v_mfma_f32_16x16x32_bf16 v[96:99],a[164:167],a[116:119],v[96:99]
buffer_load_dwordx4 v4,s[8:11],s39 offen lds
v_mfma_f32_16x16x32_bf16 v[104:107],a[160:163],a[120:123],v[104:107]
s_lshl_b32 s57,s80,14
ds_read_b128 a[36:39],v3 offset:0
v_mfma_f32_16x16x32_bf16 v[104:107],a[164:167],a[124:127],v[104:107]
s_add_u32 s57,s57,8192
s_add_u32 m0,s68,98304
v_accvgpr_read_b32 v26,a202
v_mfma_f32_16x16x32_bf16 v[160:163],a[160:163],a[128:131],v[160:163]
s_lshl_b32 s58,s81,14
ds_read_b128 a[40:43],v2 offset:2048
v_mfma_f32_16x16x32_bf16 v[160:163],a[164:167],a[132:135],v[160:163]
s_lshl_b32 s59,s81,14
v_add_u32 v5,524288,v5
v_lshlrev_b32 v26,16,v26
v_mfma_f32_16x16x32_bf16 v[168:171],a[160:163],a[136:139],v[168:171]
s_add_u32 s59,s59,8192
ds_read_b128 a[44:47],v3 offset:2048
v_mfma_f32_16x16x32_bf16 v[168:171],a[164:167],a[140:143],v[168:171]
buffer_load_dwordx4 v5,s[12:15],s40 offen nt lds
v_mfma_f32_16x16x32_bf16 v[224:227],a[160:163],a[144:147],v[224:227]
s_lshl_b32 s60,s82,14
ds_read_b128 a[48:51],v2 offset:4096
v_mfma_f32_16x16x32_bf16 v[224:227],a[164:167],a[148:151],v[224:227]
s_lshl_b32 s61,s82,14
s_add_u32 m0,s68,99328
v_mul_f32 v31,v27,v22
v_mfma_f32_16x16x32_bf16 v[232:235],a[160:163],a[152:155],v[232:235]
s_add_u32 s61,s61,8192
ds_read_b128 a[52:55],v3 offset:4096
v_mfma_f32_16x16x32_bf16 v[232:235],a[164:167],a[156:159],v[232:235]
buffer_load_dwordx4 v5,s[12:15],s41 offen nt lds
s_waitcnt lgkmcnt(8)
v_mfma_f32_16x16x32_bf16 v[36:39],a[168:171],a[96:99],v[36:39]
s_lshl_b32 s62,s83,14
ds_read_b64_tr_b16 a[176:177],v14 offset:8192
s_waitcnt lgkmcnt(7)
v_mfma_f32_16x16x32_bf16 v[36:39],a[172:175],a[100:103],v[36:39]
s_lshl_b32 s63,s83,14
ds_read_b64_tr_b16 a[178:179],v14 offset:10240
v_mfma_f32_16x16x32_bf16 v[44:47],a[168:171],a[104:107],v[44:47]
s_add_u32 s63,s63,8192
ds_read_b64_tr_b16 a[180:181],v14 offset:12288
v_mfma_f32_16x16x32_bf16 v[44:47],a[172:175],a[108:111],v[44:47]
s_add_u32 s71,s71,896
ds_read_b64_tr_b16 a[182:183],v14 offset:14336
v_mfma_f32_16x16x32_bf16 v[100:103],a[168:171],a[112:115],v[100:103]
s_lshr_b32 s64,s20,1
ds_read_b128 a[56:59],v2 offset:6144
v_mfma_f32_16x16x32_bf16 v[100:103],a[172:175],a[116:119],v[100:103]
s_add_u32 m0,s68,100352
v_fmac_f32 v31,v24,v21
v_fmac_f32 v31,v25,v20
v_mfma_f32_16x16x32_bf16 v[108:111],a[168:171],a[120:123],v[108:111]
buffer_load_dwordx4 v5,s[12:15],s42 offen nt lds
v_mfma_f32_16x16x32_bf16 v[108:111],a[172:175],a[124:127],v[108:111]
s_lshl_b32 s64,s64,18
ds_read_b128 a[60:63],v3 offset:6144
v_mfma_f32_16x16x32_bf16 v[164:167],a[168:171],a[128:131],v[164:167]
s_add_u32 s65,s64,131072
ds_read_b128 a[64:67],v2 offset:8192
v_mfma_f32_16x16x32_bf16 v[164:167],a[172:175],a[132:135],v[164:167]
s_add_u32 s66,s64,32768
s_add_u32 m0,s68,101376
v_fmac_f32 v31,v26,v19
v_mfma_f32_16x16x32_bf16 v[172:175],a[168:171],a[136:139],v[172:175]
s_add_u32 s67,s64,163840
ds_read_b128 a[68:71],v3 offset:8192
v_mfma_f32_16x16x32_bf16 v[172:175],a[172:175],a[140:143],v[172:175]
buffer_load_dwordx4 v5,s[12:15],s43 offen nt lds
v_mfma_f32_16x16x32_bf16 v[228:231],a[168:171],a[144:147],v[228:231]
ds_read_b128 a[72:75],v2 offset:10240
s_add_u32 m0,s68,102400
v_mfma_f32_16x16x32_bf16 v[228:231],a[172:175],a[148:151],v[228:231]
s_waitcnt lgkmcnt(7)
v_accvgpr_read_b32 v17,a211
v_lshlrev_b32 v17,16,v17
v_mfma_f32_16x16x32_bf16 v[236:239],a[168:171],a[152:155],v[236:239]
ds_read_b128 a[76:79],v3 offset:10240
v_mul_f32 v31,v31,v17
v_mfma_f32_16x16x32_bf16 v[236:239],a[172:175],a[156:159],v[236:239]
buffer_load_dwordx4 v5,s[12:15],s44 offen nt lds
v_mfma_f32_16x16x32_bf16 v[48:51],a[176:179],a[96:99],v[48:51]
ds_read_b64_tr_b16 a[184:185],v15 offset:8192
s_add_u32 m0,s68,103424
s_waitcnt lgkmcnt(7)
v_mfma_f32_16x16x32_bf16 v[48:51],a[180:183],a[100:103],v[48:51]
ds_read_b64_tr_b16 a[186:187],v15 offset:10240
v_cvt_pk_bf16_f32 v17,v31,v30
v_mfma_f32_16x16x32_bf16 v[56:59],a[176:179],a[104:107],v[56:59]
ds_read_b64_tr_b16 a[188:189],v15 offset:12288
v_accvgpr_write_b32 a228,v17
v_mfma_f32_16x16x32_bf16 v[56:59],a[180:183],a[108:111],v[56:59]
ds_read_b64_tr_b16 a[190:191],v15 offset:14336
v_accvgpr_read_b32 v27,a203
v_mfma_f32_16x16x32_bf16 v[112:115],a[176:179],a[112:115],v[112:115]
ds_read_b128 a[80:83],v2 offset:12288
v_subrev_u32 v4,s71,v4
v_mfma_f32_16x16x32_bf16 v[112:115],a[180:183],a[116:119],v[112:115]
buffer_load_dwordx4 v5,s[12:15],s45 offen nt lds
v_mfma_f32_16x16x32_bf16 v[120:123],a[176:179],a[120:123],v[120:123]
ds_read_b128 a[84:87],v3 offset:12288
s_add_u32 m0,s68,104448
v_mfma_f32_16x16x32_bf16 v[120:123],a[180:183],a[124:127],v[120:123]
v_lshlrev_b32 v27,16,v27
v_mul_f32 v30,v24,v22
v_mfma_f32_16x16x32_bf16 v[176:179],a[176:179],a[128:131],v[176:179]
ds_read_b128 a[88:91],v2 offset:14336
v_fmac_f32 v30,v25,v21
v_mfma_f32_16x16x32_bf16 v[176:179],a[180:183],a[132:135],v[176:179]
buffer_load_dwordx4 v5,s[12:15],s46 offen nt lds
v_mfma_f32_16x16x32_bf16 v[184:187],a[176:179],a[136:139],v[184:187]
ds_read_b128 a[92:95],v3 offset:14336
s_add_u32 m0,s68,105472
v_mfma_f32_16x16x32_bf16 v[184:187],a[180:183],a[140:143],v[184:187]
v_fmac_f32 v30,v26,v20
v_fmac_f32 v30,v27,v19
v_mfma_f32_16x16x32_bf16 v[240:243],a[176:179],a[144:147],v[240:243]
v_accvgpr_read_b32 v17,a212
v_lshlrev_b32 v17,16,v17
v_mfma_f32_16x16x32_bf16 v[240:243],a[180:183],a[148:151],v[240:243]
buffer_load_dwordx4 v5,s[12:15],s47 offen nt lds
v_mfma_f32_16x16x32_bf16 v[248:251],a[176:179],a[152:155],v[248:251]
v_mul_f32 v30,v30,v17
v_cvt_pk_bf16_f32 v17,v30,v31
v_mfma_f32_16x16x32_bf16 v[248:251],a[180:183],a[156:159],v[248:251]
s_waitcnt lgkmcnt(6)
v_accvgpr_write_b32 a224,v17
v_accvgpr_read_b32 v19,a218
v_mfma_f32_16x16x32_bf16 v[52:55],a[184:187],a[96:99],v[52:55]
s_waitcnt vmcnt(8) lgkmcnt(0)
v_lshlrev_b32 v19,16,v19
v_accvgpr_read_b32 v20,a218
v_mfma_f32_16x16x32_bf16 v[52:55],a[188:191],a[100:103],v[52:55]
s_barrier
v_and_b32 v20,0xffff0000,v20
v_accvgpr_read_b32 v21,a219
v_mfma_f32_16x16x32_bf16 v[60:63],a[184:187],a[104:107],v[60:63]
s_mov_b32 s8,s72
v_subrev_u32 v5,s88,v5
v_lshlrev_b32 v21,16,v21
v_mfma_f32_16x16x32_bf16 v[60:63],a[188:191],a[108:111],v[60:63]
s_and_b32 s9,s73,0xffff
ds_read_b64_tr_b16 a[160:161],v8 offset:0
v_mfma_f32_16x16x32_bf16 v[116:119],a[184:187],a[112:115],v[116:119]
s_mov_b32 s12,s76
s_and_b32 s13,s77,0xffff
v_accvgpr_read_b32 v22,a219
v_mfma_f32_16x16x32_bf16 v[116:119],a[188:191],a[116:119],v[116:119]
s_add_u32 m0,s68,0
ds_read_b64_tr_b16 a[162:163],v8 offset:2048
v_mfma_f32_16x16x32_bf16 v[124:127],a[184:187],a[120:123],v[124:127]
ds_read_b64_tr_b16 a[164:165],v8 offset:4096
v_and_b32 v22,0xffff0000,v22
v_mfma_f32_16x16x32_bf16 v[124:127],a[188:191],a[124:127],v[124:127]
ds_read_b64_tr_b16 a[166:167],v8 offset:6144
v_accvgpr_read_b32 v24,a192
v_mfma_f32_16x16x32_bf16 v[180:183],a[184:187],a[128:131],v[180:183]
buffer_load_dwordx4 v4,s[8:11],s56 offen lds
v_mfma_f32_16x16x32_bf16 v[180:183],a[188:191],a[132:135],v[180:183]
s_add_u32 m0,s68,1024
v_and_b32 v24,0xffff0000,v24
v_accvgpr_read_b32 v25,a193
v_mfma_f32_16x16x32_bf16 v[188:191],a[184:187],a[136:139],v[188:191]
v_and_b32 v25,0xffff0000,v25
v_accvgpr_read_b32 v26,a194
v_mfma_f32_16x16x32_bf16 v[188:191],a[188:191],a[140:143],v[188:191]
v_and_b32 v26,0xffff0000,v26
v_accvgpr_read_b32 v27,a195
v_mfma_f32_16x16x32_bf16 v[244:247],a[184:187],a[144:147],v[244:247]
v_and_b32 v27,0xffff0000,v27
v_mul_f32 v30,v24,v22
v_mfma_f32_16x16x32_bf16 v[244:247],a[188:191],a[148:151],v[244:247]
buffer_load_dwordx4 v4,s[8:11],s57 offen lds
v_mfma_f32_16x16x32_bf16 v[252:255],a[184:187],a[152:155],v[252:255]
s_add_u32 m0,s68,2048
v_fmac_f32 v30,v25,v21
v_fmac_f32 v30,v26,v20
v_mfma_f32_16x16x32_bf16 v[252:255],a[188:191],a[156:159],v[252:255]
s_waitcnt lgkmcnt(0)
v_fmac_f32 v30,v27,v19
v_accvgpr_read_b32 v17,a204
v_mfma_f32_16x16x32_bf16 a[0:3],a[160:163],a[32:35],a[0:3]
ds_read_b64_tr_b16 a[168:169],v9 offset:0
v_and_b32 v17,0xffff0000,v17
v_mfma_f32_16x16x32_bf16 a[0:3],a[164:167],a[36:39],a[0:3]
ds_read_b64_tr_b16 a[170:171],v9 offset:2048
v_mul_f32 v30,v30,v17
v_mfma_f32_16x16x32_bf16 a[8:11],a[160:163],a[40:43],a[8:11]
ds_read_b64_tr_b16 a[172:173],v9 offset:4096
v_accvgpr_read_b32 v24,a196
v_mfma_f32_16x16x32_bf16 a[8:11],a[164:167],a[44:47],a[8:11]
ds_read_b64_tr_b16 a[174:175],v9 offset:6144
v_and_b32 v24,0xffff0000,v24
v_mfma_f32_16x16x32_bf16 v[64:67],a[160:163],a[48:51],v[64:67]
v_mul_f32 v31,v25,v22
v_fmac_f32 v31,v26,v21
v_mfma_f32_16x16x32_bf16 v[64:67],a[164:167],a[52:55],v[64:67]
buffer_load_dwordx4 v4,s[8:11],s58 offen lds
v_mfma_f32_16x16x32_bf16 v[72:75],a[160:163],a[56:59],v[72:75]
s_add_u32 m0,s68,3072
v_fmac_f32 v31,v27,v20
v_fmac_f32 v31,v24,v19
v_mfma_f32_16x16x32_bf16 v[72:75],a[164:167],a[60:63],v[72:75]
ds_read_b128 a[96:99],v2 offset:32768
v_accvgpr_read_b32 v17,a205
v_mfma_f32_16x16x32_bf16 v[128:131],a[160:163],a[64:67],v[128:131]
v_and_b32 v17,0xffff0000,v17
v_mul_f32 v31,v31,v17
v_mfma_f32_16x16x32_bf16 v[128:131],a[164:167],a[68:71],v[128:131]
ds_read_b128 a[100:103],v3 offset:32768
v_cvt_pk_bf16_f32 v17,v31,v30
v_mfma_f32_16x16x32_bf16 v[136:139],a[160:163],a[72:75],v[136:139]
v_accvgpr_write_b32 a239,v17
v_accvgpr_read_b32 v25,a197
v_mfma_f32_16x16x32_bf16 v[136:139],a[164:167],a[76:79],v[136:139]
ds_read_b128 a[104:107],v2 offset:34816
v_and_b32 v25,0xffff0000,v25
v_mfma_f32_16x16x32_bf16 v[192:195],a[160:163],a[80:83],v[192:195]
v_mul_f32 v30,v26,v22
v_fmac_f32 v30,v27,v21
v_mfma_f32_16x16x32_bf16 v[192:195],a[164:167],a[84:87],v[192:195]
buffer_load_dwordx4 v4,s[8:11],s59 offen lds
v_mfma_f32_16x16x32_bf16 v[200:203],a[160:163],a[88:91],v[200:203]
s_add_u32 m0,s68,4096
v_fmac_f32 v30,v24,v20
v_fmac_f32 v30,v25,v19
v_mfma_f32_16x16x32_bf16 v[200:203],a[164:167],a[92:95],v[200:203]
s_waitcnt lgkmcnt(3)
v_accvgpr_read_b32 v17,a206
v_and_b32 v17,0xffff0000,v17
v_mfma_f32_16x16x32_bf16 a[4:7],a[168:171],a[32:35],a[4:7]
ds_read_b64_tr_b16 a[176:177],v10 offset:0
v_mul_f32 v30,v30,v17
v_mfma_f32_16x16x32_bf16 a[4:7],a[172:175],a[36:39],a[4:7]
ds_read_b64_tr_b16 a[178:179],v10 offset:2048
v_cvt_pk_bf16_f32 v17,v30,v31
v_mfma_f32_16x16x32_bf16 a[12:15],a[168:171],a[40:43],a[12:15]
ds_read_b64_tr_b16 a[180:181],v10 offset:4096
v_accvgpr_write_b32 a235,v17
v_mfma_f32_16x16x32_bf16 a[12:15],a[172:175],a[44:47],a[12:15]
ds_read_b64_tr_b16 a[182:183],v10 offset:6144
v_accvgpr_read_b32 v26,a198
v_mfma_f32_16x16x32_bf16 v[68:71],a[168:171],a[48:51],v[68:71]
v_add_u32 v12,s68,v6
v_xor_b32 v13,64,v12
v_mfma_f32_16x16x32_bf16 v[68:71],a[172:175],a[52:55],v[68:71]
buffer_load_dwordx4 v4,s[8:11],s60 offen lds
v_mfma_f32_16x16x32_bf16 v[76:79],a[168:171],a[56:59],v[76:79]
s_add_u32 m0,s68,5120
v_add_u32 v14,65536,v12
v_add_u32 v15,65536,v13
v_mfma_f32_16x16x32_bf16 v[76:79],a[172:175],a[60:63],v[76:79]
ds_read_b128 a[108:111],v3 offset:34816
v_and_b32 v26,0xffff0000,v26
v_mfma_f32_16x16x32_bf16 v[132:135],a[168:171],a[64:67],v[132:135]
v_mul_f32 v31,v27,v22
v_fmac_f32 v31,v24,v21
v_mfma_f32_16x16x32_bf16 v[132:135],a[172:175],a[68:71],v[132:135]
ds_read_b128 a[112:115],v2 offset:36864
v_fmac_f32 v31,v25,v20
v_mfma_f32_16x16x32_bf16 v[140:143],a[168:171],a[72:75],v[140:143]
v_fmac_f32 v31,v26,v19
v_accvgpr_read_b32 v17,a207
v_mfma_f32_16x16x32_bf16 v[140:143],a[172:175],a[76:79],v[140:143]
ds_read_b128 a[116:119],v3 offset:36864
v_and_b32 v17,0xffff0000,v17
v_mfma_f32_16x16x32_bf16 v[196:199],a[168:171],a[80:83],v[196:199]
v_mul_f32 v31,v31,v17
v_cvt_pk_bf16_f32 v17,v31,v30
v_mfma_f32_16x16x32_bf16 v[196:199],a[172:175],a[84:87],v[196:199]
buffer_load_dwordx4 v4,s[8:11],s61 offen lds
v_mfma_f32_16x16x32_bf16 v[204:207],a[168:171],a[88:91],v[204:207]
s_add_u32 m0,s68,6144
v_accvgpr_write_b32 a238,v17
v_accvgpr_read_b32 v27,a199
v_mfma_f32_16x16x32_bf16 v[204:207],a[172:175],a[92:95],v[204:207]
s_waitcnt lgkmcnt(3)
v_and_b32 v27,0xffff0000,v27
v_mul_f32 v30,v24,v22
v_mfma_f32_16x16x32_bf16 a[16:19],a[176:179],a[32:35],a[16:19]
ds_read_b64_tr_b16 a[184:185],v11 offset:0
v_fmac_f32 v30,v25,v21
v_mfma_f32_16x16x32_bf16 a[16:19],a[180:183],a[36:39],a[16:19]
ds_read_b64_tr_b16 a[186:187],v11 offset:2048
v_fmac_f32 v30,v26,v20
v_mfma_f32_16x16x32_bf16 a[24:27],a[176:179],a[40:43],a[24:27]
ds_read_b64_tr_b16 a[188:189],v11 offset:4096
v_fmac_f32 v30,v27,v19
v_mfma_f32_16x16x32_bf16 a[24:27],a[180:183],a[44:47],a[24:27]
ds_read_b64_tr_b16 a[190:191],v11 offset:6144
v_accvgpr_read_b32 v17,a208
v_mfma_f32_16x16x32_bf16 v[80:83],a[176:179],a[48:51],v[80:83]
v_and_b32 v17,0xffff0000,v17
v_mul_f32 v30,v30,v17
v_mfma_f32_16x16x32_bf16 v[80:83],a[180:183],a[52:55],v[80:83]
buffer_load_dwordx4 v4,s[8:11],s62 offen lds
v_mfma_f32_16x16x32_bf16 v[88:91],a[176:179],a[56:59],v[88:91]
s_add_u32 m0,s68,7168
v_cvt_pk_bf16_f32 v17,v30,v31
v_accvgpr_write_b32 a234,v17
v_mfma_f32_16x16x32_bf16 v[88:91],a[180:183],a[60:63],v[88:91]
ds_read_b128 a[120:123],v2 offset:38912
v_accvgpr_read_b32 v24,a200
v_mfma_f32_16x16x32_bf16 v[144:147],a[176:179],a[64:67],v[144:147]
v_and_b32 v24,0xffff0000,v24
v_mul_f32 v31,v25,v22
v_mfma_f32_16x16x32_bf16 v[144:147],a[180:183],a[68:71],v[144:147]
ds_read_b128 a[124:127],v3 offset:38912
v_fmac_f32 v31,v26,v21
v_mfma_f32_16x16x32_bf16 v[152:155],a[176:179],a[72:75],v[152:155]
v_fmac_f32 v31,v27,v20
v_fmac_f32 v31,v24,v19
v_mfma_f32_16x16x32_bf16 v[152:155],a[180:183],a[76:79],v[152:155]
ds_read_b128 a[128:131],v2 offset:40960
v_accvgpr_read_b32 v17,a209
v_mfma_f32_16x16x32_bf16 v[208:211],a[176:179],a[80:83],v[208:211]
v_and_b32 v17,0xffff0000,v17
v_mul_f32 v31,v31,v17
v_mfma_f32_16x16x32_bf16 v[208:211],a[180:183],a[84:87],v[208:211]
buffer_load_dwordx4 v4,s[8:11],s63 offen lds
v_mfma_f32_16x16x32_bf16 v[216:219],a[176:179],a[88:91],v[216:219]
s_getpc_b64 s[28:29]
F_W1:
s_sub_u32 s28,s28,F_W1-F_PC
s_subb_u32 s29,s29,0
v_accvgpr_read_b32 v28,a251
global_load_dword a249,v28,s[28:29]
v_mfma_f32_16x16x32_bf16 v[216:219],a[180:183],a[92:95],v[216:219]
s_add_u32 m0,s69,131072
v_cvt_pk_bf16_f32 v17,v31,v30
v_accvgpr_write_b32 a237,v17
s_waitcnt lgkmcnt(5)
v_mfma_f32_16x16x32_bf16 a[20:23],a[184:187],a[32:35],a[20:23]
ds_read_b64_tr_b16 a[160:161],v8 offset:8192
v_accvgpr_read_b32 v25,a201
s_waitcnt lgkmcnt(4)
v_mfma_f32_16x16x32_bf16 a[20:23],a[188:191],a[36:39],a[20:23]
ds_read_b64_tr_b16 a[162:163],v8 offset:10240
v_and_b32 v25,0xffff0000,v25
v_mfma_f32_16x16x32_bf16 a[28:31],a[184:187],a[40:43],a[28:31]
ds_read_b64_tr_b16 a[164:165],v8 offset:12288
v_mul_f32 v30,v26,v22
v_mfma_f32_16x16x32_bf16 a[28:31],a[188:191],a[44:47],a[28:31]
ds_read_b64_tr_b16 a[166:167],v8 offset:14336
v_fmac_f32 v30,v27,v21
v_mfma_f32_16x16x32_bf16 v[84:87],a[184:187],a[48:51],v[84:87]
v_fmac_f32 v30,v24,v20
v_fmac_f32 v30,v25,v19
v_mfma_f32_16x16x32_bf16 v[84:87],a[188:191],a[52:55],v[84:87]
buffer_load_dwordx4 v5,s[12:15],s64 offen lds
v_mfma_f32_16x16x32_bf16 v[92:95],a[184:187],a[56:59],v[92:95]
s_add_u32 m0,s69,132096
v_accvgpr_read_b32 v17,a210
v_and_b32 v17,0xffff0000,v17
v_mfma_f32_16x16x32_bf16 v[92:95],a[188:191],a[60:63],v[92:95]
ds_read_b128 a[132:135],v3 offset:40960
v_mul_f32 v30,v30,v17
v_mfma_f32_16x16x32_bf16 v[148:151],a[184:187],a[64:67],v[148:151]
v_cvt_pk_bf16_f32 v17,v30,v31
v_accvgpr_write_b32 a233,v17
v_mfma_f32_16x16x32_bf16 v[148:151],a[188:191],a[68:71],v[148:151]
ds_read_b128 a[136:139],v2 offset:43008
v_accvgpr_read_b32 v26,a202
v_mfma_f32_16x16x32_bf16 v[156:159],a[184:187],a[72:75],v[156:159]
v_and_b32 v26,0xffff0000,v26
v_mul_f32 v31,v27,v22
v_mfma_f32_16x16x32_bf16 v[156:159],a[188:191],a[76:79],v[156:159]
ds_read_b128 a[140:143],v3 offset:43008
v_fmac_f32 v31,v24,v21
v_mfma_f32_16x16x32_bf16 v[212:215],a[184:187],a[80:83],v[212:215]
v_fmac_f32 v31,v25,v20
v_fmac_f32 v31,v26,v19
v_mfma_f32_16x16x32_bf16 v[212:215],a[188:191],a[84:87],v[212:215]
buffer_load_dwordx4 v5,s[12:15],s65 offen lds
v_mfma_f32_16x16x32_bf16 v[220:223],a[184:187],a[88:91],v[220:223]
s_add_u32 m0,s69,133120
v_accvgpr_read_b32 v17,a211
v_and_b32 v17,0xffff0000,v17
v_mfma_f32_16x16x32_bf16 v[220:223],a[188:191],a[92:95],v[220:223]
s_waitcnt lgkmcnt(3)
v_mul_f32 v31,v31,v17
v_cvt_pk_bf16_f32 v17,v31,v30
v_mfma_f32_16x16x32_bf16 v[32:35],a[160:163],a[32:35],v[32:35]
ds_read_b64_tr_b16 a[168:169],v9 offset:8192
v_accvgpr_write_b32 a236,v17
v_mfma_f32_16x16x32_bf16 v[32:35],a[164:167],a[36:39],v[32:35]
ds_read_b64_tr_b16 a[170:171],v9 offset:10240
v_accvgpr_read_b32 v27,a203
v_mfma_f32_16x16x32_bf16 v[40:43],a[160:163],a[40:43],v[40:43]
ds_read_b64_tr_b16 a[172:173],v9 offset:12288
v_and_b32 v27,0xffff0000,v27
v_mfma_f32_16x16x32_bf16 v[40:43],a[164:167],a[44:47],v[40:43]
ds_read_b64_tr_b16 a[174:175],v9 offset:14336
v_mul_f32 v30,v24,v22
v_mfma_f32_16x16x32_bf16 v[96:99],a[160:163],a[48:51],v[96:99]
v_fmac_f32 v30,v25,v21
v_fmac_f32 v30,v26,v20
v_mfma_f32_16x16x32_bf16 v[96:99],a[164:167],a[52:55],v[96:99]
buffer_load_dwordx4 v5,s[12:15],s66 offen lds
v_mfma_f32_16x16x32_bf16 v[104:107],a[160:163],a[56:59],v[104:107]
s_add_u32 m0,s69,134144
v_fmac_f32 v30,v27,v19
v_accvgpr_read_b32 v17,a212
v_mfma_f32_16x16x32_bf16 v[104:107],a[164:167],a[60:63],v[104:107]
ds_read_b128 a[144:147],v2 offset:45056
v_and_b32 v17,0xffff0000,v17
v_mfma_f32_16x16x32_bf16 v[160:163],a[160:163],a[64:67],v[160:163]
v_mul_f32 v30,v30,v17
v_cvt_pk_bf16_f32 v17,v30,v31
v_mfma_f32_16x16x32_bf16 v[160:163],a[164:167],a[68:71],v[160:163]
ds_read_b128 a[148:151],v3 offset:45056
v_accvgpr_write_b32 a232,v17
v_mfma_f32_16x16x32_bf16 v[168:171],a[160:163],a[72:75],v[168:171]
v_and_b32 v24,31,v7
v_lshrrev_b32 v25,5,v7
v_mfma_f32_16x16x32_bf16 v[168:171],a[164:167],a[76:79],v[168:171]
ds_read_b128 a[152:155],v2 offset:47104
s_lshl_b32 s24,s20,1
v_mfma_f32_16x16x32_bf16 v[224:227],a[160:163],a[80:83],v[224:227]
s_sub_u32 s24,7,s24
v_sub_u32 v25,s24,v25
v_xor_b32 v25,v25,v24
v_mfma_f32_16x16x32_bf16 v[224:227],a[164:167],a[84:87],v[224:227]
buffer_load_dwordx4 v5,s[12:15],s67 offen lds
v_mfma_f32_16x16x32_bf16 v[232:235],a[160:163],a[88:91],v[232:235]
s_add_u32 m0,s69,147456
v_and_b32 v25,7,v25
v_lshlrev_b32 v24,9,v24
v_mfma_f32_16x16x32_bf16 v[232:235],a[164:167],a[92:95],v[232:235]
s_waitcnt lgkmcnt(3)
v_lshl_add_u32 v24,v25,4,v24
v_add_u32 v20,114688,v24
v_mfma_f32_16x16x32_bf16 v[36:39],a[168:171],a[32:35],v[36:39]
ds_read_b64_tr_b16 a[176:177],v10 offset:8192
v_lshrrev_b32 v25,3,v7
v_mfma_f32_16x16x32_bf16 v[36:39],a[172:175],a[36:39],v[36:39]
ds_read_b64_tr_b16 a[178:179],v10 offset:10240
s_lshl_b32 s24,s20,3
v_mfma_f32_16x16x32_bf16 v[44:47],a[168:171],a[40:43],v[44:47]
ds_read_b64_tr_b16 a[180:181],v10 offset:12288
v_add_u32 v26,s24,v25
v_mfma_f32_16x16x32_bf16 v[44:47],a[172:175],a[44:47],v[44:47]
ds_read_b64_tr_b16 a[182:183],v10 offset:14336
v_add_u32 v5,524288,v5
v_mfma_f32_16x16x32_bf16 v[100:103],a[168:171],a[48:51],v[100:103]
v_xor_b32 v25,v25,v7
v_and_b32 v25,7,v25
v_mfma_f32_16x16x32_bf16 v[100:103],a[172:175],a[52:55],v[100:103]
buffer_load_dwordx4 v5,s[12:15],s64 offen lds
v_mfma_f32_16x16x32_bf16 v[108:111],a[168:171],a[56:59],v[108:111]
s_add_u32 m0,s69,148480
v_lshlrev_b32 v21,9,v26
v_lshl_add_u32 v21,v25,4,v21
v_mfma_f32_16x16x32_bf16 v[108:111],a[172:175],a[60:63],v[108:111]
ds_read_b128 a[156:159],v3 offset:47104
v_add_u32 v21,114688,v21
v_mfma_f32_16x16x32_bf16 v[164:167],a[168:171],a[64:67],v[164:167]
s_and_b32 s24,s2,7
s_lshl_b32 s24,s24,5
v_add_u32 v26,s24,v26
v_mfma_f32_16x16x32_bf16 v[164:167],a[172:175],a[68:71],v[164:167]
v_lshlrev_b32 v22,14,v26
v_and_b32 v25,7,v7
v_mfma_f32_16x16x32_bf16 v[172:175],a[168:171],a[72:75],v[172:175]
v_lshl_add_u32 v22,v25,4,v22
s_lshr_b32 s24,s2,3
v_mfma_f32_16x16x32_bf16 v[172:175],a[172:175],a[76:79],v[172:175]
s_sub_u32 s24,31,s24
s_lshl_b32 s24,s24,7
s_add_u32 s24,s24,50331648
v_mfma_f32_16x16x32_bf16 v[228:231],a[168:171],a[80:83],v[228:231]
v_add_u32 v22,s24,v22
v_mfma_f32_16x16x32_bf16 v[228:231],a[172:175],a[84:87],v[228:231]
buffer_load_dwordx4 v5,s[12:15],s65 offen lds
v_mfma_f32_16x16x32_bf16 v[236:239],a[168:171],a[88:91],v[236:239]
s_add_u32 m0,s69,149504
v_mfma_f32_16x16x32_bf16 v[236:239],a[172:175],a[92:95],v[236:239]
s_waitcnt lgkmcnt(1)
v_mfma_f32_16x16x32_bf16 v[48:51],a[176:179],a[32:35],v[48:51]
ds_read_b64_tr_b16 a[184:185],v11 offset:8192
v_mfma_f32_16x16x32_bf16 v[48:51],a[180:183],a[36:39],v[48:51]
ds_read_b64_tr_b16 a[186:187],v11 offset:10240
v_mfma_f32_16x16x32_bf16 v[56:59],a[176:179],a[40:43],v[56:59]
ds_read_b64_tr_b16 a[188:189],v11 offset:12288
v_mfma_f32_16x16x32_bf16 v[56:59],a[180:183],a[44:47],v[56:59]
ds_read_b64_tr_b16 a[190:191],v11 offset:14336
v_mfma_f32_16x16x32_bf16 v[112:115],a[176:179],a[48:51],v[112:115]
v_mfma_f32_16x16x32_bf16 v[112:115],a[180:183],a[52:55],v[112:115]
buffer_load_dwordx4 v5,s[12:15],s66 offen lds
v_mfma_f32_16x16x32_bf16 v[120:123],a[176:179],a[56:59],v[120:123]
s_add_u32 m0,s69,150528
v_mfma_f32_16x16x32_bf16 v[120:123],a[180:183],a[60:63],v[120:123]
v_mfma_f32_16x16x32_bf16 v[176:179],a[176:179],a[64:67],v[176:179]
v_mfma_f32_16x16x32_bf16 v[176:179],a[180:183],a[68:71],v[176:179]
v_mfma_f32_16x16x32_bf16 v[184:187],a[176:179],a[72:75],v[184:187]
v_mfma_f32_16x16x32_bf16 v[184:187],a[180:183],a[76:79],v[184:187]
v_mfma_f32_16x16x32_bf16 v[240:243],a[176:179],a[80:83],v[240:243]
v_mfma_f32_16x16x32_bf16 v[240:243],a[180:183],a[84:87],v[240:243]
buffer_load_dwordx4 v5,s[12:15],s67 offen lds
v_mfma_f32_16x16x32_bf16 v[248:251],a[176:179],a[88:91],v[248:251]
v_mfma_f32_16x16x32_bf16 v[248:251],a[180:183],a[92:95],v[248:251]
s_waitcnt lgkmcnt(2)
v_mfma_f32_16x16x32_bf16 v[52:55],a[184:187],a[32:35],v[52:55]
s_waitcnt vmcnt(17) lgkmcnt(0)
v_mfma_f32_16x16x32_bf16 v[52:55],a[188:191],a[36:39],v[52:55]
s_barrier
v_mfma_f32_16x16x32_bf16 v[60:63],a[184:187],a[40:43],v[60:63]
ds_read_b64_tr_b16 a[160:161],v8 offset:32768
v_mfma_f32_16x16x32_bf16 v[60:63],a[188:191],a[44:47],v[60:63]
ds_read_b64_tr_b16 a[162:163],v8 offset:34816
v_mfma_f32_16x16x32_bf16 v[116:119],a[184:187],a[48:51],v[116:119]
ds_read_b64_tr_b16 a[164:165],v8 offset:36864
v_mfma_f32_16x16x32_bf16 v[116:119],a[188:191],a[52:55],v[116:119]
s_add_u32 m0,s68,32768
v_add_u32 v4,128,v4
v_mfma_f32_16x16x32_bf16 v[124:127],a[184:187],a[56:59],v[124:127]
ds_read_b64_tr_b16 a[166:167],v8 offset:38912
v_mfma_f32_16x16x32_bf16 v[124:127],a[188:191],a[60:63],v[124:127]
buffer_load_dwordx4 v4,s[8:11],s56 offen lds
v_mfma_f32_16x16x32_bf16 v[180:183],a[184:187],a[64:67],v[180:183]
s_add_u32 m0,s68,33792
v_mfma_f32_16x16x32_bf16 v[180:183],a[188:191],a[68:71],v[180:183]
v_mfma_f32_16x16x32_bf16 v[188:191],a[184:187],a[72:75],v[188:191]
v_mfma_f32_16x16x32_bf16 v[188:191],a[188:191],a[76:79],v[188:191]
v_mfma_f32_16x16x32_bf16 v[244:247],a[184:187],a[80:83],v[244:247]
v_mfma_f32_16x16x32_bf16 v[244:247],a[188:191],a[84:87],v[244:247]
buffer_load_dwordx4 v4,s[8:11],s57 offen lds
v_mfma_f32_16x16x32_bf16 v[252:255],a[184:187],a[88:91],v[252:255]
s_add_u32 m0,s68,34816
v_mfma_f32_16x16x32_bf16 v[252:255],a[188:191],a[92:95],v[252:255]
s_waitcnt lgkmcnt(0)
v_mfma_f32_16x16x32_bf16 a[0:3],a[160:163],a[96:99],a[0:3]
ds_read_b64_tr_b16 a[168:169],v9 offset:32768
v_mfma_f32_16x16x32_bf16 a[0:3],a[164:167],a[100:103],a[0:3]
ds_read_b64_tr_b16 a[170:171],v9 offset:34816
v_mfma_f32_16x16x32_bf16 a[8:11],a[160:163],a[104:107],a[8:11]
ds_read_b64_tr_b16 a[172:173],v9 offset:36864
v_mfma_f32_16x16x32_bf16 a[8:11],a[164:167],a[108:111],a[8:11]
ds_read_b64_tr_b16 a[174:175],v9 offset:38912
v_mfma_f32_16x16x32_bf16 v[64:67],a[160:163],a[112:115],v[64:67]
v_mfma_f32_16x16x32_bf16 v[64:67],a[164:167],a[116:119],v[64:67]
buffer_load_dwordx4 v4,s[8:11],s58 offen lds
v_mfma_f32_16x16x32_bf16 v[72:75],a[160:163],a[120:123],v[72:75]
s_add_u32 m0,s68,35840
v_mfma_f32_16x16x32_bf16 v[72:75],a[164:167],a[124:127],v[72:75]
v_mfma_f32_16x16x32_bf16 v[128:131],a[160:163],a[128:131],v[128:131]
v_mfma_f32_16x16x32_bf16 v[128:131],a[164:167],a[132:135],v[128:131]
v_mfma_f32_16x16x32_bf16 v[136:139],a[160:163],a[136:139],v[136:139]
v_mfma_f32_16x16x32_bf16 v[136:139],a[164:167],a[140:143],v[136:139]
v_mfma_f32_16x16x32_bf16 v[192:195],a[160:163],a[144:147],v[192:195]
v_mfma_f32_16x16x32_bf16 v[192:195],a[164:167],a[148:151],v[192:195]
buffer_load_dwordx4 v4,s[8:11],s59 offen lds
v_mfma_f32_16x16x32_bf16 v[200:203],a[160:163],a[152:155],v[200:203]
s_add_u32 m0,s68,36864
v_mfma_f32_16x16x32_bf16 v[200:203],a[164:167],a[156:159],v[200:203]
s_waitcnt lgkmcnt(0)
v_mfma_f32_16x16x32_bf16 a[4:7],a[168:171],a[96:99],a[4:7]
ds_read_b64_tr_b16 a[176:177],v10 offset:32768
v_mfma_f32_16x16x32_bf16 a[4:7],a[172:175],a[100:103],a[4:7]
ds_read_b64_tr_b16 a[178:179],v10 offset:34816
v_mfma_f32_16x16x32_bf16 a[12:15],a[168:171],a[104:107],a[12:15]
ds_read_b64_tr_b16 a[180:181],v10 offset:36864
v_mfma_f32_16x16x32_bf16 a[12:15],a[172:175],a[108:111],a[12:15]
ds_read_b64_tr_b16 a[182:183],v10 offset:38912
v_mfma_f32_16x16x32_bf16 v[68:71],a[168:171],a[112:115],v[68:71]
v_mfma_f32_16x16x32_bf16 v[68:71],a[172:175],a[116:119],v[68:71]
buffer_load_dwordx4 v4,s[8:11],s60 offen lds
v_mfma_f32_16x16x32_bf16 v[76:79],a[168:171],a[120:123],v[76:79]
s_add_u32 m0,s68,37888
v_accvgpr_read_b32 v24,a0
v_accvgpr_read_b32 v25,a1
v_mfma_f32_16x16x32_bf16 v[76:79],a[172:175],a[124:127],v[76:79]
v_accvgpr_read_b32 v26,a2
v_accvgpr_read_b32 v27,a3
v_mfma_f32_16x16x32_bf16 v[132:135],a[168:171],a[128:131],v[132:135]
v_accvgpr_read_b32 v28,a4
v_accvgpr_read_b32 v29,a5
v_mfma_f32_16x16x32_bf16 v[132:135],a[172:175],a[132:135],v[132:135]
v_accvgpr_read_b32 v30,a6
v_accvgpr_read_b32 v31,a7
v_mfma_f32_16x16x32_bf16 v[140:143],a[168:171],a[136:139],v[140:143]
v_cvt_pk_bf16_f32 v24,v24,v25
v_cvt_pk_bf16_f32 v25,v26,v27
v_mfma_f32_16x16x32_bf16 v[140:143],a[172:175],a[140:143],v[140:143]
v_cvt_pk_bf16_f32 v26,v28,v29
v_cvt_pk_bf16_f32 v27,v30,v31
v_mfma_f32_16x16x32_bf16 v[196:199],a[168:171],a[144:147],v[196:199]
buffer_store_dwordx4 v[24:27],v1,s[16:19],s48 offen offset:0 sc1
v_mfma_f32_16x16x32_bf16 v[196:199],a[172:175],a[148:151],v[196:199]
buffer_load_dwordx4 v4,s[8:11],s61 offen lds
v_mfma_f32_16x16x32_bf16 v[204:207],a[168:171],a[152:155],v[204:207]
s_add_u32 m0,s68,38912
v_accvgpr_read_b32 v24,a8
v_accvgpr_read_b32 v25,a9
v_mfma_f32_16x16x32_bf16 v[204:207],a[172:175],a[156:159],v[204:207]
s_waitcnt lgkmcnt(0)
v_accvgpr_read_b32 v26,a10
v_accvgpr_read_b32 v27,a11
v_mfma_f32_16x16x32_bf16 a[16:19],a[176:179],a[96:99],a[16:19]
ds_read_b64_tr_b16 a[184:185],v11 offset:32768
v_accvgpr_read_b32 v28,a12
v_mfma_f32_16x16x32_bf16 a[16:19],a[180:183],a[100:103],a[16:19]
ds_read_b64_tr_b16 a[186:187],v11 offset:34816
v_accvgpr_read_b32 v29,a13
v_mfma_f32_16x16x32_bf16 a[24:27],a[176:179],a[104:107],a[24:27]
ds_read_b64_tr_b16 a[188:189],v11 offset:36864
v_accvgpr_read_b32 v30,a14
v_mfma_f32_16x16x32_bf16 a[24:27],a[180:183],a[108:111],a[24:27]
ds_read_b64_tr_b16 a[190:191],v11 offset:38912
v_accvgpr_read_b32 v31,a15
v_mfma_f32_16x16x32_bf16 v[80:83],a[176:179],a[112:115],v[80:83]
v_cvt_pk_bf16_f32 v24,v24,v25
v_cvt_pk_bf16_f32 v25,v26,v27
v_mfma_f32_16x16x32_bf16 v[80:83],a[180:183],a[116:119],v[80:83]
buffer_load_dwordx4 v4,s[8:11],s62 offen lds
v_mfma_f32_16x16x32_bf16 v[88:91],a[176:179],a[120:123],v[88:91]
s_add_u32 m0,s68,39936
v_cvt_pk_bf16_f32 v26,v28,v29
v_cvt_pk_bf16_f32 v27,v30,v31
v_mfma_f32_16x16x32_bf16 v[88:91],a[180:183],a[124:127],v[88:91]
buffer_store_dwordx4 v[24:27],v1,s[16:19],s49 offen offset:0 sc1
v_mfma_f32_16x16x32_bf16 v[144:147],a[176:179],a[128:131],v[144:147]
v_cvt_pk_bf16_f32 v64,v64,v65
v_cvt_pk_bf16_f32 v65,v66,v67
v_mfma_f32_16x16x32_bf16 v[144:147],a[180:183],a[132:135],v[144:147]
v_cvt_pk_bf16_f32 v66,v68,v69
v_cvt_pk_bf16_f32 v67,v70,v71
v_mfma_f32_16x16x32_bf16 v[152:155],a[176:179],a[136:139],v[152:155]
v_cvt_pk_bf16_f32 v72,v72,v73
v_cvt_pk_bf16_f32 v73,v74,v75
v_mfma_f32_16x16x32_bf16 v[152:155],a[180:183],a[140:143],v[152:155]
v_cvt_pk_bf16_f32 v74,v76,v77
v_cvt_pk_bf16_f32 v75,v78,v79
v_mfma_f32_16x16x32_bf16 v[208:211],a[176:179],a[144:147],v[208:211]
v_cvt_pk_bf16_f32 v128,v128,v129
v_cvt_pk_bf16_f32 v129,v130,v131
v_mfma_f32_16x16x32_bf16 v[208:211],a[180:183],a[148:151],v[208:211]
buffer_load_dwordx4 v4,s[8:11],s63 offen lds
v_mfma_f32_16x16x32_bf16 v[216:219],a[176:179],a[152:155],v[216:219]
s_add_u32 m0,s68,65536
v_cvt_pk_bf16_f32 v130,v132,v133
v_cvt_pk_bf16_f32 v131,v134,v135
v_mfma_f32_16x16x32_bf16 v[216:219],a[180:183],a[156:159],v[216:219]
s_waitcnt lgkmcnt(0)
v_cvt_pk_bf16_f32 v136,v136,v137
v_cvt_pk_bf16_f32 v137,v138,v139
v_mfma_f32_16x16x32_bf16 a[20:23],a[184:187],a[96:99],a[20:23]
ds_read_b64_tr_b16 a[160:161],v8 offset:40960
v_cvt_pk_bf16_f32 v138,v140,v141
v_mfma_f32_16x16x32_bf16 a[20:23],a[188:191],a[100:103],a[20:23]
ds_read_b64_tr_b16 a[162:163],v8 offset:43008
v_cvt_pk_bf16_f32 v139,v142,v143
v_mfma_f32_16x16x32_bf16 a[28:31],a[184:187],a[104:107],a[28:31]
ds_read_b64_tr_b16 a[164:165],v8 offset:45056
v_cvt_pk_bf16_f32 v192,v192,v193
v_mfma_f32_16x16x32_bf16 a[28:31],a[188:191],a[108:111],a[28:31]
ds_read_b64_tr_b16 a[166:167],v8 offset:47104
v_cvt_pk_bf16_f32 v193,v194,v195
v_mfma_f32_16x16x32_bf16 v[84:87],a[184:187],a[112:115],v[84:87]
v_cvt_pk_bf16_f32 v194,v196,v197
v_cvt_pk_bf16_f32 v195,v198,v199
v_cvt_pk_bf16_f32 v200,v200,v201
v_cvt_pk_bf16_f32 v201,v202,v203
v_cvt_pk_bf16_f32 v202,v204,v205
v_cvt_pk_bf16_f32 v203,v206,v207
v_add_u32 v4,128,v4
v_mfma_f32_16x16x32_bf16 v[84:87],a[188:191],a[116:119],v[84:87]
buffer_load_dwordx4 v4,s[8:11],s56 offen lds
v_mfma_f32_16x16x32_bf16 v[92:95],a[184:187],a[120:123],v[92:95]
s_waitcnt vmcnt(20)
s_add_u32 m0,s68,66560
v_accvgpr_read_b32 v24,a16
v_mfma_f32_16x16x32_bf16 v[92:95],a[188:191],a[124:127],v[92:95]
ds_read_b128 a[32:35],v12 offset:0
v_accvgpr_read_b32 v25,a17
v_mfma_f32_16x16x32_bf16 v[148:151],a[184:187],a[128:131],v[148:151]
v_accvgpr_read_b32 v26,a18
v_accvgpr_read_b32 v27,a19
v_mfma_f32_16x16x32_bf16 v[148:151],a[188:191],a[132:135],v[148:151]
ds_read_b128 a[36:39],v13 offset:0
v_accvgpr_read_b32 v28,a20
v_mfma_f32_16x16x32_bf16 v[156:159],a[184:187],a[136:139],v[156:159]
v_accvgpr_read_b32 v29,a21
v_accvgpr_read_b32 v30,a22
v_mfma_f32_16x16x32_bf16 v[156:159],a[188:191],a[140:143],v[156:159]
ds_read_b128 a[40:43],v12 offset:2048
v_accvgpr_read_b32 v31,a23
v_mfma_f32_16x16x32_bf16 v[212:215],a[184:187],a[144:147],v[212:215]
v_cvt_pk_bf16_f32 v24,v24,v25
v_cvt_pk_bf16_f32 v25,v26,v27
v_mfma_f32_16x16x32_bf16 v[212:215],a[188:191],a[148:151],v[212:215]
buffer_load_dwordx4 v4,s[8:11],s57 offen lds
v_mfma_f32_16x16x32_bf16 v[220:223],a[184:187],a[152:155],v[220:223]
s_add_u32 m0,s68,67584
v_cvt_pk_bf16_f32 v26,v28,v29
v_cvt_pk_bf16_f32 v27,v30,v31
v_mfma_f32_16x16x32_bf16 v[220:223],a[188:191],a[156:159],v[220:223]
buffer_store_dwordx4 v[24:27],v1,s[16:19],s48 offen offset:1024 sc1
s_waitcnt lgkmcnt(5)
v_mfma_f32_16x16x32_bf16 v[32:35],a[160:163],a[96:99],v[32:35]
ds_read_b64_tr_b16 a[168:169],v9 offset:40960
v_accvgpr_read_b32 v24,a24
s_waitcnt lgkmcnt(4)
v_mfma_f32_16x16x32_bf16 v[32:35],a[164:167],a[100:103],v[32:35]
ds_read_b64_tr_b16 a[170:171],v9 offset:43008
v_accvgpr_read_b32 v25,a25
v_mfma_f32_16x16x32_bf16 v[40:43],a[160:163],a[104:107],v[40:43]
ds_read_b64_tr_b16 a[172:173],v9 offset:45056
v_accvgpr_read_b32 v26,a26
v_mfma_f32_16x16x32_bf16 v[40:43],a[164:167],a[108:111],v[40:43]
ds_read_b64_tr_b16 a[174:175],v9 offset:47104
v_accvgpr_read_b32 v27,a27
v_mfma_f32_16x16x32_bf16 v[96:99],a[160:163],a[112:115],v[96:99]
v_accvgpr_read_b32 v28,a28
v_accvgpr_read_b32 v29,a29
v_mfma_f32_16x16x32_bf16 v[96:99],a[164:167],a[116:119],v[96:99]
buffer_load_dwordx4 v4,s[8:11],s58 offen lds
v_mfma_f32_16x16x32_bf16 v[104:107],a[160:163],a[120:123],v[104:107]
s_add_u32 m0,s68,68608
v_accvgpr_read_b32 v30,a30
v_accvgpr_read_b32 v31,a31
v_mfma_f32_16x16x32_bf16 v[104:107],a[164:167],a[124:127],v[104:107]
ds_read_b128 a[44:47],v13 offset:2048
v_cvt_pk_bf16_f32 v24,v24,v25
v_mfma_f32_16x16x32_bf16 v[160:163],a[160:163],a[128:131],v[160:163]
v_cvt_pk_bf16_f32 v25,v26,v27
v_cvt_pk_bf16_f32 v26,v28,v29
v_mfma_f32_16x16x32_bf16 v[160:163],a[164:167],a[132:135],v[160:163]
ds_read_b128 a[48:51],v12 offset:4096
v_cvt_pk_bf16_f32 v27,v30,v31
v_mfma_f32_16x16x32_bf16 v[168:171],a[160:163],a[136:139],v[168:171]
buffer_store_dwordx4 v[24:27],v1,s[16:19],s49 offen offset:1024 sc1
v_mfma_f32_16x16x32_bf16 v[168:171],a[164:167],a[140:143],v[168:171]
ds_read_b128 a[52:55],v13 offset:4096
v_cvt_pk_bf16_f32 v80,v80,v81
v_mfma_f32_16x16x32_bf16 v[224:227],a[160:163],a[144:147],v[224:227]
v_cvt_pk_bf16_f32 v81,v82,v83
v_cvt_pk_bf16_f32 v82,v84,v85
v_mfma_f32_16x16x32_bf16 v[224:227],a[164:167],a[148:151],v[224:227]
buffer_load_dwordx4 v4,s[8:11],s59 offen lds
v_mfma_f32_16x16x32_bf16 v[232:235],a[160:163],a[152:155],v[232:235]
s_add_u32 m0,s68,69632
v_cvt_pk_bf16_f32 v83,v86,v87
v_cvt_pk_bf16_f32 v88,v88,v89
v_mfma_f32_16x16x32_bf16 v[232:235],a[164:167],a[156:159],v[232:235]
s_waitcnt lgkmcnt(3)
v_cvt_pk_bf16_f32 v89,v90,v91
v_cvt_pk_bf16_f32 v90,v92,v93
v_mfma_f32_16x16x32_bf16 v[36:39],a[168:171],a[96:99],v[36:39]
ds_read_b64_tr_b16 a[176:177],v10 offset:40960
v_cvt_pk_bf16_f32 v91,v94,v95
v_mfma_f32_16x16x32_bf16 v[36:39],a[172:175],a[100:103],v[36:39]
ds_read_b64_tr_b16 a[178:179],v10 offset:43008
v_cvt_pk_bf16_f32 v144,v144,v145
v_mfma_f32_16x16x32_bf16 v[44:47],a[168:171],a[104:107],v[44:47]
ds_read_b64_tr_b16 a[180:181],v10 offset:45056
v_cvt_pk_bf16_f32 v145,v146,v147
v_mfma_f32_16x16x32_bf16 v[44:47],a[172:175],a[108:111],v[44:47]
ds_read_b64_tr_b16 a[182:183],v10 offset:47104
v_cvt_pk_bf16_f32 v146,v148,v149
v_mfma_f32_16x16x32_bf16 v[100:103],a[168:171],a[112:115],v[100:103]
v_cvt_pk_bf16_f32 v147,v150,v151
v_cvt_pk_bf16_f32 v152,v152,v153
v_mfma_f32_16x16x32_bf16 v[100:103],a[172:175],a[116:119],v[100:103]
buffer_load_dwordx4 v4,s[8:11],s60 offen lds
v_mfma_f32_16x16x32_bf16 v[108:111],a[168:171],a[120:123],v[108:111]
s_add_u32 m0,s68,70656
v_cvt_pk_bf16_f32 v153,v154,v155
v_cvt_pk_bf16_f32 v154,v156,v157
v_mfma_f32_16x16x32_bf16 v[108:111],a[172:175],a[124:127],v[108:111]
ds_read_b128 a[56:59],v12 offset:6144
v_cvt_pk_bf16_f32 v155,v158,v159
v_mfma_f32_16x16x32_bf16 v[164:167],a[168:171],a[128:131],v[164:167]
v_cvt_pk_bf16_f32 v208,v208,v209
v_cvt_pk_bf16_f32 v209,v210,v211
v_mfma_f32_16x16x32_bf16 v[164:167],a[172:175],a[132:135],v[164:167]
ds_read_b128 a[60:63],v13 offset:6144
v_cvt_pk_bf16_f32 v210,v212,v213
v_mfma_f32_16x16x32_bf16 v[172:175],a[168:171],a[136:139],v[172:175]
v_cvt_pk_bf16_f32 v211,v214,v215
v_cvt_pk_bf16_f32 v216,v216,v217
v_mfma_f32_16x16x32_bf16 v[172:175],a[172:175],a[140:143],v[172:175]
v_cvt_pk_bf16_f32 v217,v218,v219
v_cvt_pk_bf16_f32 v218,v220,v221
v_mfma_f32_16x16x32_bf16 v[228:231],a[168:171],a[144:147],v[228:231]
v_cvt_pk_bf16_f32 v219,v222,v223
v_cvt_pk_bf16_f32 v32,v32,v33
v_mfma_f32_16x16x32_bf16 v[228:231],a[172:175],a[148:151],v[228:231]
buffer_load_dwordx4 v4,s[8:11],s61 offen lds
v_mfma_f32_16x16x32_bf16 v[236:239],a[168:171],a[152:155],v[236:239]
s_add_u32 m0,s68,71680
v_cvt_pk_bf16_f32 v33,v34,v35
v_cvt_pk_bf16_f32 v34,v36,v37
v_mfma_f32_16x16x32_bf16 v[236:239],a[172:175],a[156:159],v[236:239]
s_waitcnt lgkmcnt(2)
v_cvt_pk_bf16_f32 v35,v38,v39
v_mfma_f32_16x16x32_bf16 v[48:51],a[176:179],a[96:99],v[48:51]
buffer_store_dwordx4 v[32:35],v1,s[16:19],s48 offen offset:2048 sc1
v_mfma_f32_16x16x32_bf16 v[48:51],a[180:183],a[100:103],v[48:51]
ds_read_b64_tr_b16 a[184:185],v11 offset:40960
v_cvt_pk_bf16_f32 v40,v40,v41
v_mfma_f32_16x16x32_bf16 v[56:59],a[176:179],a[104:107],v[56:59]
ds_read_b64_tr_b16 a[186:187],v11 offset:43008
v_cvt_pk_bf16_f32 v41,v42,v43
v_mfma_f32_16x16x32_bf16 v[56:59],a[180:183],a[108:111],v[56:59]
ds_read_b64_tr_b16 a[188:189],v11 offset:45056
v_cvt_pk_bf16_f32 v42,v44,v45
v_mfma_f32_16x16x32_bf16 v[112:115],a[176:179],a[112:115],v[112:115]
ds_read_b64_tr_b16 a[190:191],v11 offset:47104
v_cvt_pk_bf16_f32 v43,v46,v47
v_mfma_f32_16x16x32_bf16 v[112:115],a[180:183],a[116:119],v[112:115]
buffer_store_dwordx4 v[40:43],v1,s[16:19],s49 offen offset:2048 sc1
v_mfma_f32_16x16x32_bf16 v[120:123],a[176:179],a[120:123],v[120:123]
buffer_load_dwordx4 v4,s[8:11],s62 offen lds
v_mfma_f32_16x16x32_bf16 v[120:123],a[180:183],a[124:127],v[120:123]
s_add_u32 m0,s68,72704
v_cvt_pk_bf16_f32 v96,v96,v97
v_cvt_pk_bf16_f32 v97,v98,v99
v_mfma_f32_16x16x32_bf16 v[176:179],a[176:179],a[128:131],v[176:179]
v_cvt_pk_bf16_f32 v98,v100,v101
v_cvt_pk_bf16_f32 v99,v102,v103
v_mfma_f32_16x16x32_bf16 v[176:179],a[180:183],a[132:135],v[176:179]
v_cvt_pk_bf16_f32 v104,v104,v105
v_cvt_pk_bf16_f32 v105,v106,v107
v_mfma_f32_16x16x32_bf16 v[184:187],a[176:179],a[136:139],v[184:187]
v_cvt_pk_bf16_f32 v106,v108,v109
v_cvt_pk_bf16_f32 v107,v110,v111
v_mfma_f32_16x16x32_bf16 v[184:187],a[180:183],a[140:143],v[184:187]
v_cvt_pk_bf16_f32 v160,v160,v161
v_cvt_pk_bf16_f32 v161,v162,v163
v_mfma_f32_16x16x32_bf16 v[240:243],a[176:179],a[144:147],v[240:243]
v_cvt_pk_bf16_f32 v162,v164,v165
v_cvt_pk_bf16_f32 v163,v166,v167
v_mfma_f32_16x16x32_bf16 v[240:243],a[180:183],a[148:151],v[240:243]
buffer_load_dwordx4 v4,s[8:11],s63 offen lds
v_mfma_f32_16x16x32_bf16 v[248:251],a[176:179],a[152:155],v[248:251]
v_add_u32 v8,32768,v8
v_add_u32 v9,32768,v9
v_add_u32 v10,32768,v10
v_add_u32 v11,32768,v11
v_mfma_f32_16x16x32_bf16 v[248:251],a[180:183],a[156:159],v[248:251]
s_waitcnt lgkmcnt(2)
v_cvt_pk_bf16_f32 v168,v168,v169
v_cvt_pk_bf16_f32 v169,v170,v171
v_mfma_f32_16x16x32_bf16 v[52:55],a[184:187],a[96:99],v[52:55]
s_waitcnt vmcnt(12) lgkmcnt(0)
v_cvt_pk_bf16_f32 v170,v172,v173
v_cvt_pk_bf16_f32 v171,v174,v175
v_mfma_f32_16x16x32_bf16 v[52:55],a[188:191],a[100:103],v[52:55]
s_barrier
v_cvt_pk_bf16_f32 v224,v224,v225
v_cvt_pk_bf16_f32 v225,v226,v227
v_mfma_f32_16x16x32_bf16 v[60:63],a[184:187],a[104:107],v[60:63]
ds_read_b64_tr_b16 a[192:193],v8 offset:32768
v_cvt_pk_bf16_f32 v226,v228,v229
v_mfma_f32_16x16x32_bf16 v[60:63],a[188:191],a[108:111],v[60:63]
ds_read_b64_tr_b16 a[194:195],v8 offset:34816
v_cvt_pk_bf16_f32 v227,v230,v231
v_mfma_f32_16x16x32_bf16 v[116:119],a[184:187],a[112:115],v[116:119]
ds_read_b64_tr_b16 a[196:197],v8 offset:36864
v_cvt_pk_bf16_f32 v232,v232,v233
v_mfma_f32_16x16x32_bf16 v[116:119],a[188:191],a[116:119],v[116:119]
ds_read_b64_tr_b16 a[198:199],v8 offset:38912
v_cvt_pk_bf16_f32 v233,v234,v235
v_mfma_f32_16x16x32_bf16 v[124:127],a[184:187],a[120:123],v[124:127]
ds_read_b64_tr_b16 a[200:201],v9 offset:32768
v_cvt_pk_bf16_f32 v234,v236,v237
v_mfma_f32_16x16x32_bf16 v[124:127],a[188:191],a[124:127],v[124:127]
ds_read_b64_tr_b16 a[202:203],v9 offset:34816
v_cvt_pk_bf16_f32 v235,v238,v239
v_mfma_f32_16x16x32_bf16 v[180:183],a[184:187],a[128:131],v[180:183]
ds_read_b64_tr_b16 a[204:205],v9 offset:36864
v_cvt_pk_bf16_f32 v48,v48,v49
v_mfma_f32_16x16x32_bf16 v[180:183],a[188:191],a[132:135],v[180:183]
ds_read_b64_tr_b16 a[206:207],v9 offset:38912
v_cvt_pk_bf16_f32 v49,v50,v51
v_mfma_f32_16x16x32_bf16 v[188:191],a[184:187],a[136:139],v[188:191]
ds_write_b128 v20,a[224:227] offset:0
v_mfma_f32_16x16x32_bf16 v[188:191],a[188:191],a[140:143],v[188:191]
ds_write_b128 v20,a[228:231] offset:128
v_mfma_f32_16x16x32_bf16 v[244:247],a[184:187],a[144:147],v[244:247]
ds_write_b128 v20,a[232:235] offset:256
v_mfma_f32_16x16x32_bf16 v[244:247],a[188:191],a[148:151],v[244:247]
ds_write_b128 v20,a[236:239] offset:384
v_mfma_f32_16x16x32_bf16 v[252:255],a[184:187],a[152:155],v[252:255]
v_cvt_pk_bf16_f32 v50,v52,v53
v_cvt_pk_bf16_f32 v51,v54,v55
v_mfma_f32_16x16x32_bf16 v[252:255],a[188:191],a[156:159],v[252:255]
v_cvt_pk_bf16_f32 v56,v56,v57
v_cvt_pk_bf16_f32 v57,v58,v59
v_cvt_pk_bf16_f32 v58,v60,v61
v_cvt_pk_bf16_f32 v59,v62,v63
s_branch F_B
F_A1:
s_waitcnt lgkmcnt(7)
v_mfma_f32_16x16x32_bf16 a[0:3],a[32:35],a[160:163],0
ds_read_b128 a[64:67],v2 offset:8192
s_waitcnt lgkmcnt(7)
v_mfma_f32_16x16x32_bf16 a[0:3],a[36:39],a[164:167],a[0:3]
ds_read_b128 a[68:71],v3 offset:8192
s_waitcnt lgkmcnt(7)
v_mfma_f32_16x16x32_bf16 a[4:7],a[40:43],a[160:163],0
ds_read_b128 a[72:75],v2 offset:10240
s_waitcnt lgkmcnt(7)
v_mfma_f32_16x16x32_bf16 a[4:7],a[44:47],a[164:167],a[4:7]
ds_read_b128 a[76:79],v3 offset:10240
s_waitcnt lgkmcnt(7)
v_mfma_f32_16x16x32_bf16 v[64:67],a[48:51],a[160:163],0
ds_read_b128 a[80:83],v2 offset:12288
s_waitcnt lgkmcnt(7)
v_mfma_f32_16x16x32_bf16 v[64:67],a[52:55],a[164:167],v[64:67]
ds_read_b128 a[84:87],v3 offset:12288
s_waitcnt lgkmcnt(7)
v_mfma_f32_16x16x32_bf16 v[68:71],a[56:59],a[160:163],0
ds_read_b128 a[88:91],v2 offset:14336
s_waitcnt lgkmcnt(7)
v_mfma_f32_16x16x32_bf16 v[68:71],a[60:63],a[164:167],v[68:71]
ds_read_b128 a[92:95],v3 offset:14336
s_waitcnt lgkmcnt(7)
v_mfma_f32_16x16x32_bf16 v[128:131],a[64:67],a[160:163],0
ds_read_b64_tr_b16 a[168:169],v9 offset:0
s_waitcnt lgkmcnt(7)
v_mfma_f32_16x16x32_bf16 v[128:131],a[68:71],a[164:167],v[128:131]
ds_read_b64_tr_b16 a[170:171],v9 offset:2048
s_waitcnt lgkmcnt(7)
v_mfma_f32_16x16x32_bf16 v[132:135],a[72:75],a[160:163],0
ds_read_b64_tr_b16 a[172:173],v9 offset:4096
s_waitcnt lgkmcnt(7)
v_mfma_f32_16x16x32_bf16 v[132:135],a[76:79],a[164:167],v[132:135]
s_add_u32 m0,s68,98304
v_add_u32 v5,524288,v5
s_waitcnt lgkmcnt(6)
v_mfma_f32_16x16x32_bf16 v[192:195],a[80:83],a[160:163],0
ds_read_b64_tr_b16 a[174:175],v9 offset:6144
s_waitcnt lgkmcnt(6)
v_mfma_f32_16x16x32_bf16 v[192:195],a[84:87],a[164:167],v[192:195]
buffer_load_dwordx4 v5,s[12:15],s40 offen nt lds
s_waitcnt lgkmcnt(5)
v_mfma_f32_16x16x32_bf16 v[196:199],a[88:91],a[160:163],0
s_add_u32 m0,s68,99328
s_waitcnt lgkmcnt(4)
v_mfma_f32_16x16x32_bf16 v[196:199],a[92:95],a[164:167],v[196:199]
buffer_load_dwordx4 v5,s[12:15],s41 offen nt lds
s_waitcnt lgkmcnt(2)
v_mfma_f32_16x16x32_bf16 a[8:11],a[32:35],a[168:171],0
ds_read_b64_tr_b16 a[176:177],v10 offset:0
s_add_u32 m0,s68,100352
s_waitcnt lgkmcnt(1)
v_mfma_f32_16x16x32_bf16 a[8:11],a[36:39],a[172:175],a[8:11]
ds_read_b64_tr_b16 a[178:179],v10 offset:2048
v_mfma_f32_16x16x32_bf16 a[12:15],a[40:43],a[168:171],0
ds_read_b64_tr_b16 a[180:181],v10 offset:4096
v_mfma_f32_16x16x32_bf16 a[12:15],a[44:47],a[172:175],a[12:15]
ds_read_b64_tr_b16 a[182:183],v10 offset:6144
v_mfma_f32_16x16x32_bf16 v[72:75],a[48:51],a[168:171],0
v_mfma_f32_16x16x32_bf16 v[72:75],a[52:55],a[172:175],v[72:75]
buffer_load_dwordx4 v5,s[12:15],s42 offen nt lds
v_mfma_f32_16x16x32_bf16 v[76:79],a[56:59],a[168:171],0
s_add_u32 m0,s68,101376
v_mfma_f32_16x16x32_bf16 v[76:79],a[60:63],a[172:175],v[76:79]
v_mfma_f32_16x16x32_bf16 v[136:139],a[64:67],a[168:171],0
v_mfma_f32_16x16x32_bf16 v[136:139],a[68:71],a[172:175],v[136:139]
buffer_load_dwordx4 v5,s[12:15],s43 offen nt lds
v_mfma_f32_16x16x32_bf16 v[140:143],a[72:75],a[168:171],0
s_add_u32 m0,s68,102400
v_mfma_f32_16x16x32_bf16 v[140:143],a[76:79],a[172:175],v[140:143]
v_mfma_f32_16x16x32_bf16 v[200:203],a[80:83],a[168:171],0
v_mfma_f32_16x16x32_bf16 v[200:203],a[84:87],a[172:175],v[200:203]
buffer_load_dwordx4 v5,s[12:15],s44 offen nt lds
v_mfma_f32_16x16x32_bf16 v[204:207],a[88:91],a[168:171],0
s_add_u32 m0,s68,103424
v_mfma_f32_16x16x32_bf16 v[204:207],a[92:95],a[172:175],v[204:207]
s_waitcnt lgkmcnt(0)
v_mfma_f32_16x16x32_bf16 a[16:19],a[32:35],a[176:179],0
ds_read_b64_tr_b16 a[184:185],v11 offset:0
v_mfma_f32_16x16x32_bf16 a[16:19],a[36:39],a[180:183],a[16:19]
ds_read_b64_tr_b16 a[186:187],v11 offset:2048
v_mfma_f32_16x16x32_bf16 a[20:23],a[40:43],a[176:179],0
ds_read_b64_tr_b16 a[188:189],v11 offset:4096
v_mfma_f32_16x16x32_bf16 a[20:23],a[44:47],a[180:183],a[20:23]
ds_read_b64_tr_b16 a[190:191],v11 offset:6144
v_mfma_f32_16x16x32_bf16 v[80:83],a[48:51],a[176:179],0
v_mfma_f32_16x16x32_bf16 v[80:83],a[52:55],a[180:183],v[80:83]
buffer_load_dwordx4 v5,s[12:15],s45 offen nt lds
v_mfma_f32_16x16x32_bf16 v[84:87],a[56:59],a[176:179],0
s_add_u32 m0,s68,104448
v_mfma_f32_16x16x32_bf16 v[84:87],a[60:63],a[180:183],v[84:87]
v_mfma_f32_16x16x32_bf16 v[144:147],a[64:67],a[176:179],0
v_mfma_f32_16x16x32_bf16 v[144:147],a[68:71],a[180:183],v[144:147]
buffer_load_dwordx4 v5,s[12:15],s46 offen nt lds
v_mfma_f32_16x16x32_bf16 v[148:151],a[72:75],a[176:179],0
s_add_u32 m0,s68,105472
v_mfma_f32_16x16x32_bf16 v[148:151],a[76:79],a[180:183],v[148:151]
v_mfma_f32_16x16x32_bf16 v[208:211],a[80:83],a[176:179],0
v_mfma_f32_16x16x32_bf16 v[208:211],a[84:87],a[180:183],v[208:211]
buffer_load_dwordx4 v5,s[12:15],s47 offen nt lds
v_mfma_f32_16x16x32_bf16 v[212:215],a[88:91],a[176:179],0
s_add_u32 m0,s68,0
v_mfma_f32_16x16x32_bf16 v[212:215],a[92:95],a[180:183],v[212:215]
s_waitcnt lgkmcnt(0)
v_mfma_f32_16x16x32_bf16 a[24:27],a[32:35],a[184:187],0
ds_read_b64_tr_b16 a[160:161],v8 offset:8192
v_mfma_f32_16x16x32_bf16 a[24:27],a[36:39],a[188:191],a[24:27]
ds_read_b64_tr_b16 a[162:163],v8 offset:10240
v_mfma_f32_16x16x32_bf16 a[28:31],a[40:43],a[184:187],0
ds_read_b64_tr_b16 a[164:165],v8 offset:12288
v_mfma_f32_16x16x32_bf16 a[28:31],a[44:47],a[188:191],a[28:31]
ds_read_b64_tr_b16 a[166:167],v8 offset:14336
v_mfma_f32_16x16x32_bf16 v[88:91],a[48:51],a[184:187],0
v_mfma_f32_16x16x32_bf16 v[88:91],a[52:55],a[188:191],v[88:91]
v_mfma_f32_16x16x32_bf16 v[92:95],a[56:59],a[184:187],0
v_mfma_f32_16x16x32_bf16 v[92:95],a[60:63],a[188:191],v[92:95]
v_mfma_f32_16x16x32_bf16 v[152:155],a[64:67],a[184:187],0
v_mfma_f32_16x16x32_bf16 v[152:155],a[68:71],a[188:191],v[152:155]
v_mfma_f32_16x16x32_bf16 v[156:159],a[72:75],a[184:187],0
v_mfma_f32_16x16x32_bf16 v[156:159],a[76:79],a[188:191],v[156:159]
v_mfma_f32_16x16x32_bf16 v[216:219],a[80:83],a[184:187],0
v_mfma_f32_16x16x32_bf16 v[216:219],a[84:87],a[188:191],v[216:219]
v_mfma_f32_16x16x32_bf16 v[220:223],a[88:91],a[184:187],0
s_waitcnt vmcnt(10) lgkmcnt(0)
v_mfma_f32_16x16x32_bf16 v[220:223],a[92:95],a[188:191],v[220:223]
s_barrier
v_mfma_f32_16x16x32_bf16 v[32:35],a[32:35],a[160:163],0
ds_read_b64_tr_b16 a[168:169],v9 offset:8192
v_mfma_f32_16x16x32_bf16 v[32:35],a[36:39],a[164:167],v[32:35]
ds_read_b64_tr_b16 a[170:171],v9 offset:10240
v_mfma_f32_16x16x32_bf16 v[36:39],a[40:43],a[160:163],0
ds_read_b64_tr_b16 a[172:173],v9 offset:12288
v_mfma_f32_16x16x32_bf16 v[36:39],a[44:47],a[164:167],v[36:39]
ds_read_b64_tr_b16 a[174:175],v9 offset:14336
v_add_u32 v4,128,v4
v_mfma_f32_16x16x32_bf16 v[96:99],a[48:51],a[160:163],0
ds_read_b128 a[96:99],v2 offset:32768
v_mfma_f32_16x16x32_bf16 v[96:99],a[52:55],a[164:167],v[96:99]
buffer_load_dwordx4 v4,s[8:11],s32 offen lds
v_mfma_f32_16x16x32_bf16 v[100:103],a[56:59],a[160:163],0
s_add_u32 s67,s64,1048576
buffer_load_dword a220,v5,s[12:15],s67 offen nt
v_mfma_f32_16x16x32_bf16 v[100:103],a[60:63],a[164:167],v[100:103]
ds_read_b128 a[100:103],v3 offset:32768
s_add_u32 m0,s68,1024
v_mfma_f32_16x16x32_bf16 v[160:163],a[64:67],a[160:163],0
ds_read_b128 a[104:107],v2 offset:34816
v_mfma_f32_16x16x32_bf16 v[160:163],a[68:71],a[164:167],v[160:163]
v_mfma_f32_16x16x32_bf16 v[164:167],a[72:75],a[160:163],0
ds_read_b128 a[108:111],v3 offset:34816
v_mfma_f32_16x16x32_bf16 v[164:167],a[76:79],a[164:167],v[164:167]
buffer_load_dwordx4 v4,s[8:11],s33 offen lds
v_mfma_f32_16x16x32_bf16 v[224:227],a[80:83],a[160:163],0
ds_read_b128 a[112:115],v2 offset:36864
s_add_u32 m0,s68,2048
v_mfma_f32_16x16x32_bf16 v[224:227],a[84:87],a[164:167],v[224:227]
s_waitcnt lgkmcnt(7)
v_mfma_f32_16x16x32_bf16 v[228:231],a[88:91],a[160:163],0
ds_read_b128 a[116:119],v3 offset:36864
v_mfma_f32_16x16x32_bf16 v[228:231],a[92:95],a[164:167],v[228:231]
buffer_load_dwordx4 v4,s[8:11],s34 offen lds
v_mfma_f32_16x16x32_bf16 v[40:43],a[32:35],a[168:171],0
ds_read_b64_tr_b16 a[176:177],v10 offset:8192
s_add_u32 m0,s68,3072
s_waitcnt lgkmcnt(7)
v_mfma_f32_16x16x32_bf16 v[40:43],a[36:39],a[172:175],v[40:43]
ds_read_b64_tr_b16 a[178:179],v10 offset:10240
v_mfma_f32_16x16x32_bf16 v[44:47],a[40:43],a[168:171],0
ds_read_b64_tr_b16 a[180:181],v10 offset:12288
v_mfma_f32_16x16x32_bf16 v[44:47],a[44:47],a[172:175],v[44:47]
ds_read_b64_tr_b16 a[182:183],v10 offset:14336
v_mfma_f32_16x16x32_bf16 v[104:107],a[48:51],a[168:171],0
ds_read_b128 a[120:123],v2 offset:38912
v_mfma_f32_16x16x32_bf16 v[104:107],a[52:55],a[172:175],v[104:107]
buffer_load_dwordx4 v4,s[8:11],s35 offen lds
v_mfma_f32_16x16x32_bf16 v[108:111],a[56:59],a[168:171],0
ds_read_b128 a[124:127],v3 offset:38912
s_add_u32 m0,s68,4096
v_mfma_f32_16x16x32_bf16 v[108:111],a[60:63],a[172:175],v[108:111]
v_mfma_f32_16x16x32_bf16 v[168:171],a[64:67],a[168:171],0
ds_read_b128 a[128:131],v2 offset:40960
v_mfma_f32_16x16x32_bf16 v[168:171],a[68:71],a[172:175],v[168:171]
v_mfma_f32_16x16x32_bf16 v[172:175],a[72:75],a[168:171],0
ds_read_b128 a[132:135],v3 offset:40960
v_mfma_f32_16x16x32_bf16 v[172:175],a[76:79],a[172:175],v[172:175]
buffer_load_dwordx4 v4,s[8:11],s36 offen lds
v_mfma_f32_16x16x32_bf16 v[232:235],a[80:83],a[168:171],0
ds_read_b128 a[136:139],v2 offset:43008
s_add_u32 m0,s68,5120
v_mfma_f32_16x16x32_bf16 v[232:235],a[84:87],a[172:175],v[232:235]
s_waitcnt lgkmcnt(7)
v_mfma_f32_16x16x32_bf16 v[236:239],a[88:91],a[168:171],0
ds_read_b128 a[140:143],v3 offset:43008
v_mfma_f32_16x16x32_bf16 v[236:239],a[92:95],a[172:175],v[236:239]
buffer_load_dwordx4 v4,s[8:11],s37 offen lds
v_mfma_f32_16x16x32_bf16 v[48:51],a[32:35],a[176:179],0
ds_read_b64_tr_b16 a[184:185],v11 offset:8192
s_add_u32 m0,s68,6144
s_waitcnt lgkmcnt(7)
v_mfma_f32_16x16x32_bf16 v[48:51],a[36:39],a[180:183],v[48:51]
ds_read_b64_tr_b16 a[186:187],v11 offset:10240
v_mfma_f32_16x16x32_bf16 v[52:55],a[40:43],a[176:179],0
ds_read_b64_tr_b16 a[188:189],v11 offset:12288
v_mfma_f32_16x16x32_bf16 v[52:55],a[44:47],a[180:183],v[52:55]
ds_read_b64_tr_b16 a[190:191],v11 offset:14336
v_mfma_f32_16x16x32_bf16 v[112:115],a[48:51],a[176:179],0
ds_read_b128 a[144:147],v2 offset:45056
v_mfma_f32_16x16x32_bf16 v[112:115],a[52:55],a[180:183],v[112:115]
buffer_load_dwordx4 v4,s[8:11],s38 offen lds
v_mfma_f32_16x16x32_bf16 v[116:119],a[56:59],a[176:179],0
ds_read_b128 a[148:151],v3 offset:45056
s_add_u32 m0,s68,7168
v_mfma_f32_16x16x32_bf16 v[116:119],a[60:63],a[180:183],v[116:119]
v_mfma_f32_16x16x32_bf16 v[176:179],a[64:67],a[176:179],0
ds_read_b128 a[152:155],v2 offset:47104
v_mfma_f32_16x16x32_bf16 v[176:179],a[68:71],a[180:183],v[176:179]
v_mfma_f32_16x16x32_bf16 v[180:183],a[72:75],a[176:179],0
ds_read_b128 a[156:159],v3 offset:47104
v_mfma_f32_16x16x32_bf16 v[180:183],a[76:79],a[180:183],v[180:183]
buffer_load_dwordx4 v4,s[8:11],s39 offen lds
v_mfma_f32_16x16x32_bf16 v[240:243],a[80:83],a[176:179],0
v_mfma_f32_16x16x32_bf16 v[240:243],a[84:87],a[180:183],v[240:243]
v_mfma_f32_16x16x32_bf16 v[244:247],a[88:91],a[176:179],0
v_mfma_f32_16x16x32_bf16 v[244:247],a[92:95],a[180:183],v[244:247]
s_waitcnt lgkmcnt(6)
v_mfma_f32_16x16x32_bf16 v[56:59],a[32:35],a[184:187],0
s_waitcnt vmcnt(9) lgkmcnt(0)
v_mfma_f32_16x16x32_bf16 v[56:59],a[36:39],a[188:191],v[56:59]
s_barrier
v_mfma_f32_16x16x32_bf16 v[60:63],a[40:43],a[184:187],0
ds_read_b64_tr_b16 a[160:161],v8 offset:32768
v_mfma_f32_16x16x32_bf16 v[60:63],a[44:47],a[188:191],v[60:63]
ds_read_b64_tr_b16 a[162:163],v8 offset:34816
v_mfma_f32_16x16x32_bf16 v[120:123],a[48:51],a[184:187],0
ds_read_b64_tr_b16 a[164:165],v8 offset:36864
v_mfma_f32_16x16x32_bf16 v[120:123],a[52:55],a[188:191],v[120:123]
s_add_u32 m0,s68,131072
v_add_u32 v5,524288,v5
v_mfma_f32_16x16x32_bf16 v[124:127],a[56:59],a[184:187],0
ds_read_b64_tr_b16 a[166:167],v8 offset:38912
v_mfma_f32_16x16x32_bf16 v[124:127],a[60:63],a[188:191],v[124:127]
buffer_load_dwordx4 v5,s[12:15],s40 offen nt lds
v_mfma_f32_16x16x32_bf16 v[184:187],a[64:67],a[184:187],0
s_add_u32 m0,s68,132096
v_mfma_f32_16x16x32_bf16 v[184:187],a[68:71],a[188:191],v[184:187]
v_mfma_f32_16x16x32_bf16 v[188:191],a[72:75],a[184:187],0
v_mfma_f32_16x16x32_bf16 v[188:191],a[76:79],a[188:191],v[188:191]
buffer_load_dwordx4 v5,s[12:15],s41 offen nt lds
v_mfma_f32_16x16x32_bf16 v[248:251],a[80:83],a[184:187],0
s_add_u32 m0,s68,133120
v_mfma_f32_16x16x32_bf16 v[248:251],a[84:87],a[188:191],v[248:251]
v_mfma_f32_16x16x32_bf16 v[252:255],a[88:91],a[184:187],0
s_waitcnt lgkmcnt(0)
v_mfma_f32_16x16x32_bf16 v[252:255],a[92:95],a[188:191],v[252:255]
buffer_load_dwordx4 v5,s[12:15],s42 offen nt lds
v_mfma_f32_16x16x32_bf16 a[0:3],a[96:99],a[160:163],a[0:3]
ds_read_b64_tr_b16 a[168:169],v9 offset:32768
s_add_u32 m0,s68,134144
v_mfma_f32_16x16x32_bf16 a[0:3],a[100:103],a[164:167],a[0:3]
ds_read_b64_tr_b16 a[170:171],v9 offset:34816
v_mfma_f32_16x16x32_bf16 a[4:7],a[104:107],a[160:163],a[4:7]
ds_read_b64_tr_b16 a[172:173],v9 offset:36864
v_mfma_f32_16x16x32_bf16 a[4:7],a[108:111],a[164:167],a[4:7]
ds_read_b64_tr_b16 a[174:175],v9 offset:38912
v_mfma_f32_16x16x32_bf16 v[64:67],a[112:115],a[160:163],v[64:67]
v_mfma_f32_16x16x32_bf16 v[64:67],a[116:119],a[164:167],v[64:67]
buffer_load_dwordx4 v5,s[12:15],s43 offen nt lds
v_mfma_f32_16x16x32_bf16 v[68:71],a[120:123],a[160:163],v[68:71]
s_add_u32 m0,s68,135168
v_mfma_f32_16x16x32_bf16 v[68:71],a[124:127],a[164:167],v[68:71]
v_mfma_f32_16x16x32_bf16 v[128:131],a[128:131],a[160:163],v[128:131]
v_mfma_f32_16x16x32_bf16 v[128:131],a[132:135],a[164:167],v[128:131]
buffer_load_dwordx4 v5,s[12:15],s44 offen nt lds
v_mfma_f32_16x16x32_bf16 v[132:135],a[136:139],a[160:163],v[132:135]
s_add_u32 m0,s68,136192
v_mfma_f32_16x16x32_bf16 v[132:135],a[140:143],a[164:167],v[132:135]
v_mfma_f32_16x16x32_bf16 v[192:195],a[144:147],a[160:163],v[192:195]
v_mfma_f32_16x16x32_bf16 v[192:195],a[148:151],a[164:167],v[192:195]
buffer_load_dwordx4 v5,s[12:15],s45 offen nt lds
v_mfma_f32_16x16x32_bf16 v[196:199],a[152:155],a[160:163],v[196:199]
s_add_u32 m0,s68,137216
s_and_b32 s31,s2,7
s_lshr_b32 s28,s2,3
v_mfma_f32_16x16x32_bf16 v[196:199],a[156:159],a[164:167],v[196:199]
s_waitcnt lgkmcnt(0)
v_and_b32 v17,31,v7
v_lshrrev_b32 v18,5,v7
v_mfma_f32_16x16x32_bf16 a[8:11],a[96:99],a[168:171],a[8:11]
ds_read_b64_tr_b16 a[176:177],v10 offset:32768
v_lshlrev_b32 v18,3,v18
v_mfma_f32_16x16x32_bf16 a[8:11],a[100:103],a[172:175],a[8:11]
ds_read_b64_tr_b16 a[178:179],v10 offset:34816
s_lshl_b32 s29,s28,6
v_mfma_f32_16x16x32_bf16 a[12:15],a[104:107],a[168:171],a[12:15]
ds_read_b64_tr_b16 a[180:181],v10 offset:36864
s_lshl_b32 s30,s20,4
v_mfma_f32_16x16x32_bf16 a[12:15],a[108:111],a[172:175],a[12:15]
ds_read_b64_tr_b16 a[182:183],v10 offset:38912
s_add_u32 s29,s29,s30
v_mfma_f32_16x16x32_bf16 v[72:75],a[112:115],a[168:171],v[72:75]
v_add_u32 v18,s29,v18
s_lshl_b32 s29,s31,5
v_mfma_f32_16x16x32_bf16 v[72:75],a[116:119],a[172:175],v[72:75]
buffer_load_dwordx4 v5,s[12:15],s46 offen nt lds
v_mfma_f32_16x16x32_bf16 v[76:79],a[120:123],a[168:171],v[76:79]
s_add_u32 m0,s68,138240
v_add_u32 v17,s29,v17
v_lshlrev_b32 v16,10,v18
v_mfma_f32_16x16x32_bf16 v[76:79],a[124:127],a[172:175],v[76:79]
v_lshl_add_u32 v16,v17,2,v16
v_subrev_u32 v19,4096,v16
v_mfma_f32_16x16x32_bf16 v[136:139],a[128:131],a[168:171],v[136:139]
v_lshlrev_b32 v20,4,v17
s_movk_i32 s3,4096
v_mfma_f32_16x16x32_bf16 v[136:139],a[132:135],a[172:175],v[136:139]
buffer_load_dwordx4 v5,s[12:15],s47 offen nt lds
v_mfma_f32_16x16x32_bf16 v[140:143],a[136:139],a[168:171],v[140:143]
s_add_u32 m0,s68,32768
v_mfma_f32_16x16x32_bf16 v[140:143],a[140:143],a[172:175],v[140:143]
v_add_u32 v4,128,v4
v_mfma_f32_16x16x32_bf16 v[200:203],a[144:147],a[168:171],v[200:203]
v_mfma_f32_16x16x32_bf16 v[200:203],a[148:151],a[172:175],v[200:203]
buffer_load_dwordx4 v4,s[8:11],s32 offen lds
v_mfma_f32_16x16x32_bf16 v[204:207],a[152:155],a[168:171],v[204:207]
s_add_u32 m0,s68,33792
v_mfma_f32_16x16x32_bf16 v[204:207],a[156:159],a[172:175],v[204:207]
s_waitcnt lgkmcnt(0)
v_mfma_f32_16x16x32_bf16 a[16:19],a[96:99],a[176:179],a[16:19]
ds_read_b64_tr_b16 a[184:185],v11 offset:32768
v_mfma_f32_16x16x32_bf16 a[16:19],a[100:103],a[180:183],a[16:19]
ds_read_b64_tr_b16 a[186:187],v11 offset:34816
v_mfma_f32_16x16x32_bf16 a[20:23],a[104:107],a[176:179],a[20:23]
ds_read_b64_tr_b16 a[188:189],v11 offset:36864
v_mfma_f32_16x16x32_bf16 a[20:23],a[108:111],a[180:183],a[20:23]
ds_read_b64_tr_b16 a[190:191],v11 offset:38912
v_mfma_f32_16x16x32_bf16 v[80:83],a[112:115],a[176:179],v[80:83]
v_mfma_f32_16x16x32_bf16 v[80:83],a[116:119],a[180:183],v[80:83]
buffer_load_dwordx4 v4,s[8:11],s33 offen lds
v_mfma_f32_16x16x32_bf16 v[84:87],a[120:123],a[176:179],v[84:87]
s_add_u32 m0,s68,34816
v_mfma_f32_16x16x32_bf16 v[84:87],a[124:127],a[180:183],v[84:87]
v_mfma_f32_16x16x32_bf16 v[144:147],a[128:131],a[176:179],v[144:147]
v_mfma_f32_16x16x32_bf16 v[144:147],a[132:135],a[180:183],v[144:147]
buffer_load_dwordx4 v4,s[8:11],s34 offen lds
v_mfma_f32_16x16x32_bf16 v[148:151],a[136:139],a[176:179],v[148:151]
s_add_u32 m0,s68,35840
v_mfma_f32_16x16x32_bf16 v[148:151],a[140:143],a[180:183],v[148:151]
v_mfma_f32_16x16x32_bf16 v[208:211],a[144:147],a[176:179],v[208:211]
v_mfma_f32_16x16x32_bf16 v[208:211],a[148:151],a[180:183],v[208:211]
buffer_load_dwordx4 v4,s[8:11],s35 offen lds
v_mfma_f32_16x16x32_bf16 v[212:215],a[152:155],a[176:179],v[212:215]
s_add_u32 m0,s68,36864
v_mfma_f32_16x16x32_bf16 v[212:215],a[156:159],a[180:183],v[212:215]
s_waitcnt lgkmcnt(0)
v_mfma_f32_16x16x32_bf16 a[24:27],a[96:99],a[184:187],a[24:27]
ds_read_b64_tr_b16 a[160:161],v8 offset:40960
v_mfma_f32_16x16x32_bf16 a[24:27],a[100:103],a[188:191],a[24:27]
ds_read_b64_tr_b16 a[162:163],v8 offset:43008
v_mfma_f32_16x16x32_bf16 a[28:31],a[104:107],a[184:187],a[28:31]
ds_read_b64_tr_b16 a[164:165],v8 offset:45056
v_mfma_f32_16x16x32_bf16 a[28:31],a[108:111],a[188:191],a[28:31]
ds_read_b64_tr_b16 a[166:167],v8 offset:47104
v_mfma_f32_16x16x32_bf16 v[88:91],a[112:115],a[184:187],v[88:91]
v_mfma_f32_16x16x32_bf16 v[88:91],a[116:119],a[188:191],v[88:91]
buffer_load_dwordx4 v4,s[8:11],s36 offen lds
v_mfma_f32_16x16x32_bf16 v[92:95],a[120:123],a[184:187],v[92:95]
s_add_u32 m0,s68,37888
v_mfma_f32_16x16x32_bf16 v[92:95],a[124:127],a[188:191],v[92:95]
v_mfma_f32_16x16x32_bf16 v[152:155],a[128:131],a[184:187],v[152:155]
v_mfma_f32_16x16x32_bf16 v[152:155],a[132:135],a[188:191],v[152:155]
buffer_load_dwordx4 v4,s[8:11],s37 offen lds
v_mfma_f32_16x16x32_bf16 v[156:159],a[136:139],a[184:187],v[156:159]
s_add_u32 m0,s68,38912
v_mfma_f32_16x16x32_bf16 v[156:159],a[140:143],a[188:191],v[156:159]
v_mfma_f32_16x16x32_bf16 v[216:219],a[144:147],a[184:187],v[216:219]
v_mfma_f32_16x16x32_bf16 v[216:219],a[148:151],a[188:191],v[216:219]
buffer_load_dwordx4 v4,s[8:11],s38 offen lds
v_mfma_f32_16x16x32_bf16 v[220:223],a[152:155],a[184:187],v[220:223]
s_waitcnt vmcnt(15)
s_add_u32 m0,s68,39936
v_mfma_f32_16x16x32_bf16 v[220:223],a[156:159],a[188:191],v[220:223]
s_barrier
s_waitcnt lgkmcnt(2)
v_mfma_f32_16x16x32_bf16 v[32:35],a[96:99],a[160:163],v[32:35]
ds_read_b64_tr_b16 a[168:169],v9 offset:40960
s_waitcnt lgkmcnt(1)
v_mfma_f32_16x16x32_bf16 v[32:35],a[100:103],a[164:167],v[32:35]
ds_read_b64_tr_b16 a[170:171],v9 offset:43008
v_mfma_f32_16x16x32_bf16 v[36:39],a[104:107],a[160:163],v[36:39]
ds_read_b64_tr_b16 a[172:173],v9 offset:45056
v_mfma_f32_16x16x32_bf16 v[36:39],a[108:111],a[164:167],v[36:39]
ds_read_b64_tr_b16 a[174:175],v9 offset:47104
v_mfma_f32_16x16x32_bf16 v[96:99],a[112:115],a[160:163],v[96:99]
ds_read_b128 a[32:35],v2 offset:0
v_mfma_f32_16x16x32_bf16 v[96:99],a[116:119],a[164:167],v[96:99]
buffer_load_dwordx4 v4,s[8:11],s39 offen lds
v_mfma_f32_16x16x32_bf16 v[100:103],a[120:123],a[160:163],v[100:103]
s_add_u32 s67,s64,1048576
buffer_load_dword a221,v5,s[12:15],s67 offen nt
v_mfma_f32_16x16x32_bf16 v[100:103],a[124:127],a[164:167],v[100:103]
ds_read_b128 a[36:39],v3 offset:0
v_mfma_f32_16x16x32_bf16 v[160:163],a[128:131],a[160:163],v[160:163]
global_load_dword a252,v0,s[100:101]
v_mfma_f32_16x16x32_bf16 v[160:163],a[132:135],a[164:167],v[160:163]
ds_read_b128 a[40:43],v2 offset:2048
v_mfma_f32_16x16x32_bf16 v[164:167],a[136:139],a[160:163],v[164:167]
ds_read_b128 a[44:47],v3 offset:2048
v_mfma_f32_16x16x32_bf16 v[164:167],a[140:143],a[164:167],v[164:167]
v_mfma_f32_16x16x32_bf16 v[224:227],a[144:147],a[160:163],v[224:227]
ds_read_b128 a[48:51],v2 offset:4096
v_mfma_f32_16x16x32_bf16 v[224:227],a[148:151],a[164:167],v[224:227]
v_add_u32 v0,s79,v0
v_mfma_f32_16x16x32_bf16 v[228:231],a[152:155],a[160:163],v[228:231]
ds_read_b128 a[52:55],v3 offset:4096
v_mfma_f32_16x16x32_bf16 v[228:231],a[156:159],a[164:167],v[228:231]
s_waitcnt lgkmcnt(6)
v_mfma_f32_16x16x32_bf16 v[40:43],a[96:99],a[168:171],v[40:43]
ds_read_b64_tr_b16 a[176:177],v10 offset:40960
v_mfma_f32_16x16x32_bf16 v[40:43],a[100:103],a[172:175],v[40:43]
ds_read_b64_tr_b16 a[178:179],v10 offset:43008
v_mfma_f32_16x16x32_bf16 v[44:47],a[104:107],a[168:171],v[44:47]
ds_read_b64_tr_b16 a[180:181],v10 offset:45056
v_mfma_f32_16x16x32_bf16 v[44:47],a[108:111],a[172:175],v[44:47]
ds_read_b64_tr_b16 a[182:183],v10 offset:47104
v_mfma_f32_16x16x32_bf16 v[104:107],a[112:115],a[168:171],v[104:107]
ds_read_b128 a[56:59],v2 offset:6144
v_mfma_f32_16x16x32_bf16 v[104:107],a[116:119],a[172:175],v[104:107]
v_mfma_f32_16x16x32_bf16 v[108:111],a[120:123],a[168:171],v[108:111]
ds_read_b128 a[60:63],v3 offset:6144
v_mfma_f32_16x16x32_bf16 v[108:111],a[124:127],a[172:175],v[108:111]
v_mfma_f32_16x16x32_bf16 v[168:171],a[128:131],a[168:171],v[168:171]
ds_read_b128 a[64:67],v2 offset:8192
v_mfma_f32_16x16x32_bf16 v[168:171],a[132:135],a[172:175],v[168:171]
v_mfma_f32_16x16x32_bf16 v[172:175],a[136:139],a[168:171],v[172:175]
ds_read_b128 a[68:71],v3 offset:8192
v_mfma_f32_16x16x32_bf16 v[172:175],a[140:143],a[172:175],v[172:175]
v_mfma_f32_16x16x32_bf16 v[232:235],a[144:147],a[168:171],v[232:235]
ds_read_b128 a[72:75],v2 offset:10240
v_mfma_f32_16x16x32_bf16 v[232:235],a[148:151],a[172:175],v[232:235]
v_mfma_f32_16x16x32_bf16 v[236:239],a[152:155],a[168:171],v[236:239]
ds_read_b128 a[76:79],v3 offset:10240
v_mfma_f32_16x16x32_bf16 v[236:239],a[156:159],a[172:175],v[236:239]
s_waitcnt lgkmcnt(6)
v_mfma_f32_16x16x32_bf16 v[48:51],a[96:99],a[176:179],v[48:51]
ds_read_b64_tr_b16 a[184:185],v11 offset:40960
v_mfma_f32_16x16x32_bf16 v[48:51],a[100:103],a[180:183],v[48:51]
ds_read_b64_tr_b16 a[186:187],v11 offset:43008
v_mfma_f32_16x16x32_bf16 v[52:55],a[104:107],a[176:179],v[52:55]
ds_read_b64_tr_b16 a[188:189],v11 offset:45056
v_mfma_f32_16x16x32_bf16 v[52:55],a[108:111],a[180:183],v[52:55]
ds_read_b64_tr_b16 a[190:191],v11 offset:47104
v_mfma_f32_16x16x32_bf16 v[112:115],a[112:115],a[176:179],v[112:115]
ds_read_b128 a[80:83],v2 offset:12288
v_mfma_f32_16x16x32_bf16 v[112:115],a[116:119],a[180:183],v[112:115]
v_mfma_f32_16x16x32_bf16 v[116:119],a[120:123],a[176:179],v[116:119]
ds_read_b128 a[84:87],v3 offset:12288
v_mfma_f32_16x16x32_bf16 v[116:119],a[124:127],a[180:183],v[116:119]
v_mfma_f32_16x16x32_bf16 v[176:179],a[128:131],a[176:179],v[176:179]
ds_read_b128 a[88:91],v2 offset:14336
v_mfma_f32_16x16x32_bf16 v[176:179],a[132:135],a[180:183],v[176:179]
v_mfma_f32_16x16x32_bf16 v[180:183],a[136:139],a[176:179],v[180:183]
ds_read_b128 a[92:95],v3 offset:14336
v_mfma_f32_16x16x32_bf16 v[180:183],a[140:143],a[180:183],v[180:183]
v_mfma_f32_16x16x32_bf16 v[240:243],a[144:147],a[176:179],v[240:243]
v_mfma_f32_16x16x32_bf16 v[240:243],a[148:151],a[180:183],v[240:243]
v_mfma_f32_16x16x32_bf16 v[244:247],a[152:155],a[176:179],v[244:247]
v_mfma_f32_16x16x32_bf16 v[244:247],a[156:159],a[180:183],v[244:247]
s_waitcnt lgkmcnt(6)
v_mfma_f32_16x16x32_bf16 v[56:59],a[96:99],a[184:187],v[56:59]
s_waitcnt vmcnt(10) lgkmcnt(0)
v_mfma_f32_16x16x32_bf16 v[56:59],a[100:103],a[188:191],v[56:59]
s_barrier
v_mfma_f32_16x16x32_bf16 v[60:63],a[104:107],a[184:187],v[60:63]
ds_read_b64_tr_b16 a[160:161],v12 offset:0
v_mfma_f32_16x16x32_bf16 v[60:63],a[108:111],a[188:191],v[60:63]
ds_read_b64_tr_b16 a[162:163],v12 offset:2048
v_mfma_f32_16x16x32_bf16 v[120:123],a[112:115],a[184:187],v[120:123]
ds_read_b64_tr_b16 a[164:165],v12 offset:4096
v_mfma_f32_16x16x32_bf16 v[120:123],a[116:119],a[188:191],v[120:123]
s_add_u32 m0,s68,65536
v_add_u32 v5,524288,v5
v_mfma_f32_16x16x32_bf16 v[124:127],a[120:123],a[184:187],v[124:127]
ds_read_b64_tr_b16 a[166:167],v12 offset:6144
v_mfma_f32_16x16x32_bf16 v[124:127],a[124:127],a[188:191],v[124:127]
buffer_load_dwordx4 v5,s[12:15],s40 offen nt lds
v_mfma_f32_16x16x32_bf16 v[184:187],a[128:131],a[184:187],v[184:187]
s_add_u32 m0,s68,66560
v_mfma_f32_16x16x32_bf16 v[184:187],a[132:135],a[188:191],v[184:187]
v_mfma_f32_16x16x32_bf16 v[188:191],a[136:139],a[184:187],v[188:191]
v_mfma_f32_16x16x32_bf16 v[188:191],a[140:143],a[188:191],v[188:191]
buffer_load_dwordx4 v5,s[12:15],s41 offen nt lds
v_mfma_f32_16x16x32_bf16 v[248:251],a[144:147],a[184:187],v[248:251]
s_add_u32 m0,s68,67584
v_mfma_f32_16x16x32_bf16 v[248:251],a[148:151],a[188:191],v[248:251]
v_mfma_f32_16x16x32_bf16 v[252:255],a[152:155],a[184:187],v[252:255]
s_waitcnt lgkmcnt(0)
v_mfma_f32_16x16x32_bf16 v[252:255],a[156:159],a[188:191],v[252:255]
buffer_load_dwordx4 v5,s[12:15],s42 offen nt lds
v_mfma_f32_16x16x32_bf16 a[0:3],a[32:35],a[160:163],a[0:3]
ds_read_b64_tr_b16 a[168:169],v13 offset:0
s_add_u32 m0,s68,68608
v_mfma_f32_16x16x32_bf16 a[0:3],a[36:39],a[164:167],a[0:3]
ds_read_b64_tr_b16 a[170:171],v13 offset:2048
v_mfma_f32_16x16x32_bf16 a[4:7],a[40:43],a[160:163],a[4:7]
ds_read_b64_tr_b16 a[172:173],v13 offset:4096
v_mfma_f32_16x16x32_bf16 a[4:7],a[44:47],a[164:167],a[4:7]
ds_read_b64_tr_b16 a[174:175],v13 offset:6144
v_mfma_f32_16x16x32_bf16 v[64:67],a[48:51],a[160:163],v[64:67]
v_mfma_f32_16x16x32_bf16 v[64:67],a[52:55],a[164:167],v[64:67]
buffer_load_dwordx4 v5,s[12:15],s43 offen nt lds
v_mfma_f32_16x16x32_bf16 v[68:71],a[56:59],a[160:163],v[68:71]
s_add_u32 m0,s68,69632
v_mfma_f32_16x16x32_bf16 v[68:71],a[60:63],a[164:167],v[68:71]
v_mfma_f32_16x16x32_bf16 v[128:131],a[64:67],a[160:163],v[128:131]
v_mfma_f32_16x16x32_bf16 v[128:131],a[68:71],a[164:167],v[128:131]
buffer_load_dwordx4 v5,s[12:15],s44 offen nt lds
v_mfma_f32_16x16x32_bf16 v[132:135],a[72:75],a[160:163],v[132:135]
s_add_u32 m0,s68,70656
v_mfma_f32_16x16x32_bf16 v[132:135],a[76:79],a[164:167],v[132:135]
v_mfma_f32_16x16x32_bf16 v[192:195],a[80:83],a[160:163],v[192:195]
v_mfma_f32_16x16x32_bf16 v[192:195],a[84:87],a[164:167],v[192:195]
buffer_load_dwordx4 v5,s[12:15],s45 offen nt lds
v_mfma_f32_16x16x32_bf16 v[196:199],a[88:91],a[160:163],v[196:199]
s_add_u32 m0,s68,71680
v_mfma_f32_16x16x32_bf16 v[196:199],a[92:95],a[164:167],v[196:199]
s_waitcnt lgkmcnt(0)
v_mfma_f32_16x16x32_bf16 a[8:11],a[32:35],a[168:171],a[8:11]
ds_read_b64_tr_b16 a[176:177],v14 offset:0
v_mfma_f32_16x16x32_bf16 a[8:11],a[36:39],a[172:175],a[8:11]
ds_read_b64_tr_b16 a[178:179],v14 offset:2048
v_mfma_f32_16x16x32_bf16 a[12:15],a[40:43],a[168:171],a[12:15]
ds_read_b64_tr_b16 a[180:181],v14 offset:4096
v_mfma_f32_16x16x32_bf16 a[12:15],a[44:47],a[172:175],a[12:15]
ds_read_b64_tr_b16 a[182:183],v14 offset:6144
v_mfma_f32_16x16x32_bf16 v[72:75],a[48:51],a[168:171],v[72:75]
v_mfma_f32_16x16x32_bf16 v[72:75],a[52:55],a[172:175],v[72:75]
buffer_load_dwordx4 v5,s[12:15],s46 offen nt lds
v_mfma_f32_16x16x32_bf16 v[76:79],a[56:59],a[168:171],v[76:79]
s_add_u32 m0,s68,72704
v_mfma_f32_16x16x32_bf16 v[76:79],a[60:63],a[172:175],v[76:79]
v_mfma_f32_16x16x32_bf16 v[136:139],a[64:67],a[168:171],v[136:139]
v_mfma_f32_16x16x32_bf16 v[136:139],a[68:71],a[172:175],v[136:139]
buffer_load_dwordx4 v5,s[12:15],s47 offen nt lds
v_mfma_f32_16x16x32_bf16 v[140:143],a[72:75],a[168:171],v[140:143]
s_add_u32 m0,s68,0
v_mfma_f32_16x16x32_bf16 v[140:143],a[76:79],a[172:175],v[140:143]
v_add_u32 v4,s86,v4
v_mfma_f32_16x16x32_bf16 v[200:203],a[80:83],a[168:171],v[200:203]
v_mfma_f32_16x16x32_bf16 v[200:203],a[84:87],a[172:175],v[200:203]
buffer_load_dwordx4 v4,s[8:11],s32 offen lds
v_mfma_f32_16x16x32_bf16 v[204:207],a[88:91],a[168:171],v[204:207]
s_add_u32 m0,s68,1024
v_mfma_f32_16x16x32_bf16 v[204:207],a[92:95],a[172:175],v[204:207]
s_waitcnt lgkmcnt(0)
v_mfma_f32_16x16x32_bf16 a[16:19],a[32:35],a[176:179],a[16:19]
ds_read_b64_tr_b16 a[184:185],v15 offset:0
v_mfma_f32_16x16x32_bf16 a[16:19],a[36:39],a[180:183],a[16:19]
ds_read_b64_tr_b16 a[186:187],v15 offset:2048
v_mfma_f32_16x16x32_bf16 a[20:23],a[40:43],a[176:179],a[20:23]
ds_read_b64_tr_b16 a[188:189],v15 offset:4096
v_mfma_f32_16x16x32_bf16 a[20:23],a[44:47],a[180:183],a[20:23]
ds_read_b64_tr_b16 a[190:191],v15 offset:6144
v_mfma_f32_16x16x32_bf16 v[80:83],a[48:51],a[176:179],v[80:83]
v_mfma_f32_16x16x32_bf16 v[80:83],a[52:55],a[180:183],v[80:83]
buffer_load_dwordx4 v4,s[8:11],s33 offen lds
v_mfma_f32_16x16x32_bf16 v[84:87],a[56:59],a[176:179],v[84:87]
s_add_u32 m0,s68,2048
v_mfma_f32_16x16x32_bf16 v[84:87],a[60:63],a[180:183],v[84:87]
v_mfma_f32_16x16x32_bf16 v[144:147],a[64:67],a[176:179],v[144:147]
v_mfma_f32_16x16x32_bf16 v[144:147],a[68:71],a[180:183],v[144:147]
buffer_load_dwordx4 v4,s[8:11],s34 offen lds
v_mfma_f32_16x16x32_bf16 v[148:151],a[72:75],a[176:179],v[148:151]
s_add_u32 m0,s68,3072
v_mfma_f32_16x16x32_bf16 v[148:151],a[76:79],a[180:183],v[148:151]
v_mfma_f32_16x16x32_bf16 v[208:211],a[80:83],a[176:179],v[208:211]
v_mfma_f32_16x16x32_bf16 v[208:211],a[84:87],a[180:183],v[208:211]
buffer_load_dwordx4 v4,s[8:11],s35 offen lds
v_mfma_f32_16x16x32_bf16 v[212:215],a[88:91],a[176:179],v[212:215]
s_add_u32 m0,s68,4096
v_mfma_f32_16x16x32_bf16 v[212:215],a[92:95],a[180:183],v[212:215]
s_waitcnt lgkmcnt(0)
v_mfma_f32_16x16x32_bf16 a[24:27],a[32:35],a[184:187],a[24:27]
ds_read_b64_tr_b16 a[160:161],v12 offset:8192
v_mfma_f32_16x16x32_bf16 a[24:27],a[36:39],a[188:191],a[24:27]
ds_read_b64_tr_b16 a[162:163],v12 offset:10240
v_mfma_f32_16x16x32_bf16 a[28:31],a[40:43],a[184:187],a[28:31]
ds_read_b64_tr_b16 a[164:165],v12 offset:12288
v_mfma_f32_16x16x32_bf16 a[28:31],a[44:47],a[188:191],a[28:31]
ds_read_b64_tr_b16 a[166:167],v12 offset:14336
v_mfma_f32_16x16x32_bf16 v[88:91],a[48:51],a[184:187],v[88:91]
v_mfma_f32_16x16x32_bf16 v[88:91],a[52:55],a[188:191],v[88:91]
buffer_load_dwordx4 v4,s[8:11],s36 offen lds
v_mfma_f32_16x16x32_bf16 v[92:95],a[56:59],a[184:187],v[92:95]
s_add_u32 m0,s68,5120
v_mfma_f32_16x16x32_bf16 v[92:95],a[60:63],a[188:191],v[92:95]
v_mfma_f32_16x16x32_bf16 v[152:155],a[64:67],a[184:187],v[152:155]
v_mfma_f32_16x16x32_bf16 v[152:155],a[68:71],a[188:191],v[152:155]
buffer_load_dwordx4 v4,s[8:11],s37 offen lds
v_mfma_f32_16x16x32_bf16 v[156:159],a[72:75],a[184:187],v[156:159]
s_add_u32 m0,s68,6144
v_mfma_f32_16x16x32_bf16 v[156:159],a[76:79],a[188:191],v[156:159]
v_mfma_f32_16x16x32_bf16 v[216:219],a[80:83],a[184:187],v[216:219]
v_mfma_f32_16x16x32_bf16 v[216:219],a[84:87],a[188:191],v[216:219]
buffer_load_dwordx4 v4,s[8:11],s38 offen lds
v_mfma_f32_16x16x32_bf16 v[220:223],a[88:91],a[184:187],v[220:223]
s_waitcnt vmcnt(17)
s_add_u32 m0,s68,7168
v_mfma_f32_16x16x32_bf16 v[220:223],a[92:95],a[188:191],v[220:223]
s_barrier
s_waitcnt lgkmcnt(2)
v_mfma_f32_16x16x32_bf16 v[32:35],a[32:35],a[160:163],v[32:35]
ds_read_b64_tr_b16 a[168:169],v13 offset:8192
s_waitcnt lgkmcnt(1)
v_mfma_f32_16x16x32_bf16 v[32:35],a[36:39],a[164:167],v[32:35]
ds_read_b64_tr_b16 a[170:171],v13 offset:10240
v_mfma_f32_16x16x32_bf16 v[36:39],a[40:43],a[160:163],v[36:39]
ds_read_b64_tr_b16 a[172:173],v13 offset:12288
v_mfma_f32_16x16x32_bf16 v[36:39],a[44:47],a[164:167],v[36:39]
ds_read_b64_tr_b16 a[174:175],v13 offset:14336
v_mfma_f32_16x16x32_bf16 v[96:99],a[48:51],a[160:163],v[96:99]
ds_read_b128 a[96:99],v2 offset:32768
v_mfma_f32_16x16x32_bf16 v[96:99],a[52:55],a[164:167],v[96:99]
buffer_load_dwordx4 v4,s[8:11],s39 offen lds
v_mfma_f32_16x16x32_bf16 v[100:103],a[56:59],a[160:163],v[100:103]
s_add_u32 s67,s64,1048576
buffer_load_dword a220,v5,s[12:15],s67 offen nt
v_mfma_f32_16x16x32_bf16 v[100:103],a[60:63],a[164:167],v[100:103]
ds_read_b128 a[100:103],v3 offset:32768
v_mfma_f32_16x16x32_bf16 v[160:163],a[64:67],a[160:163],v[160:163]
global_load_dword a253,v0,s[100:101]
v_mfma_f32_16x16x32_bf16 v[160:163],a[68:71],a[164:167],v[160:163]
ds_read_b128 a[104:107],v2 offset:34816
v_mfma_f32_16x16x32_bf16 v[164:167],a[72:75],a[160:163],v[164:167]
ds_read_b128 a[108:111],v3 offset:34816
v_mfma_f32_16x16x32_bf16 v[164:167],a[76:79],a[164:167],v[164:167]
buffer_load_dword a192,v19,s[4:7],0 offen offset:0 nt
v_mfma_f32_16x16x32_bf16 v[224:227],a[80:83],a[160:163],v[224:227]
ds_read_b128 a[112:115],v2 offset:36864
v_mfma_f32_16x16x32_bf16 v[224:227],a[84:87],a[164:167],v[224:227]
s_waitcnt lgkmcnt(7)
v_add_u32 v0,s79,v0
v_mfma_f32_16x16x32_bf16 v[228:231],a[88:91],a[160:163],v[228:231]
ds_read_b128 a[116:119],v3 offset:36864
v_mfma_f32_16x16x32_bf16 v[228:231],a[92:95],a[164:167],v[228:231]
buffer_load_dword a193,v19,s[4:7],0 offen offset:1024 nt
v_mfma_f32_16x16x32_bf16 v[40:43],a[32:35],a[168:171],v[40:43]
ds_read_b64_tr_b16 a[176:177],v14 offset:8192
s_waitcnt lgkmcnt(7)
v_mfma_f32_16x16x32_bf16 v[40:43],a[36:39],a[172:175],v[40:43]
ds_read_b64_tr_b16 a[178:179],v14 offset:10240
v_mfma_f32_16x16x32_bf16 v[44:47],a[40:43],a[168:171],v[44:47]
ds_read_b64_tr_b16 a[180:181],v14 offset:12288
v_mfma_f32_16x16x32_bf16 v[44:47],a[44:47],a[172:175],v[44:47]
ds_read_b64_tr_b16 a[182:183],v14 offset:14336
v_mfma_f32_16x16x32_bf16 v[104:107],a[48:51],a[168:171],v[104:107]
ds_read_b128 a[120:123],v2 offset:38912
v_mfma_f32_16x16x32_bf16 v[104:107],a[52:55],a[172:175],v[104:107]
buffer_load_dword a194,v19,s[4:7],0 offen offset:2048 nt
v_mfma_f32_16x16x32_bf16 v[108:111],a[56:59],a[168:171],v[108:111]
ds_read_b128 a[124:127],v3 offset:38912
v_mfma_f32_16x16x32_bf16 v[108:111],a[60:63],a[172:175],v[108:111]
buffer_load_dword a195,v19,s[4:7],0 offen offset:3072 nt
v_mfma_f32_16x16x32_bf16 v[168:171],a[64:67],a[168:171],v[168:171]
ds_read_b128 a[128:131],v2 offset:40960
v_mfma_f32_16x16x32_bf16 v[168:171],a[68:71],a[172:175],v[168:171]
buffer_load_dword a196,v16,s[4:7],0 offen offset:0 nt
v_mfma_f32_16x16x32_bf16 v[172:175],a[72:75],a[168:171],v[172:175]
ds_read_b128 a[132:135],v3 offset:40960
v_mfma_f32_16x16x32_bf16 v[172:175],a[76:79],a[172:175],v[172:175]
buffer_load_dword a197,v16,s[4:7],0 offen offset:1024 nt
v_mfma_f32_16x16x32_bf16 v[232:235],a[80:83],a[168:171],v[232:235]
ds_read_b128 a[136:139],v2 offset:43008
v_mfma_f32_16x16x32_bf16 v[232:235],a[84:87],a[172:175],v[232:235]
buffer_load_dword a198,v16,s[4:7],0 offen offset:2048 nt
v_mfma_f32_16x16x32_bf16 v[236:239],a[88:91],a[168:171],v[236:239]
ds_read_b128 a[140:143],v3 offset:43008
v_mfma_f32_16x16x32_bf16 v[236:239],a[92:95],a[172:175],v[236:239]
buffer_load_dword a199,v16,s[4:7],0 offen offset:3072 nt
s_waitcnt lgkmcnt(8)
v_mfma_f32_16x16x32_bf16 v[48:51],a[32:35],a[176:179],v[48:51]
ds_read_b64_tr_b16 a[184:185],v15 offset:8192
s_waitcnt lgkmcnt(7)
v_mfma_f32_16x16x32_bf16 v[48:51],a[36:39],a[180:183],v[48:51]
ds_read_b64_tr_b16 a[186:187],v15 offset:10240
v_mfma_f32_16x16x32_bf16 v[52:55],a[40:43],a[176:179],v[52:55]
ds_read_b64_tr_b16 a[188:189],v15 offset:12288
v_mfma_f32_16x16x32_bf16 v[52:55],a[44:47],a[180:183],v[52:55]
ds_read_b64_tr_b16 a[190:191],v15 offset:14336
v_mfma_f32_16x16x32_bf16 v[112:115],a[48:51],a[176:179],v[112:115]
ds_read_b128 a[144:147],v2 offset:45056
v_mfma_f32_16x16x32_bf16 v[112:115],a[52:55],a[180:183],v[112:115]
buffer_load_dword a200,v16,s[4:7],s3 offen offset:0 nt
v_mfma_f32_16x16x32_bf16 v[116:119],a[56:59],a[176:179],v[116:119]
ds_read_b128 a[148:151],v3 offset:45056
v_mfma_f32_16x16x32_bf16 v[116:119],a[60:63],a[180:183],v[116:119]
buffer_load_dword a201,v16,s[4:7],s3 offen offset:1024 nt
v_mfma_f32_16x16x32_bf16 v[176:179],a[64:67],a[176:179],v[176:179]
ds_read_b128 a[152:155],v2 offset:47104
v_mfma_f32_16x16x32_bf16 v[176:179],a[68:71],a[180:183],v[176:179]
buffer_load_dword a202,v16,s[4:7],s3 offen offset:2048 nt
v_mfma_f32_16x16x32_bf16 v[180:183],a[72:75],a[176:179],v[180:183]
ds_read_b128 a[156:159],v3 offset:47104
v_mfma_f32_16x16x32_bf16 v[180:183],a[76:79],a[180:183],v[180:183]
buffer_load_dword a203,v16,s[4:7],s3 offen offset:3072 nt
v_mfma_f32_16x16x32_bf16 v[240:243],a[80:83],a[176:179],v[240:243]
s_mov_b32 s4,s60
s_and_b32 s5,s61,0xffff
v_mfma_f32_16x16x32_bf16 v[240:243],a[84:87],a[180:183],v[240:243]
v_mfma_f32_16x16x32_bf16 v[244:247],a[88:91],a[176:179],v[244:247]
v_mfma_f32_16x16x32_bf16 v[244:247],a[92:95],a[180:183],v[244:247]
s_waitcnt lgkmcnt(6)
v_mfma_f32_16x16x32_bf16 v[56:59],a[32:35],a[184:187],v[56:59]
s_waitcnt vmcnt(22) lgkmcnt(0)
v_mfma_f32_16x16x32_bf16 v[56:59],a[36:39],a[188:191],v[56:59]
s_barrier
v_mfma_f32_16x16x32_bf16 v[60:63],a[40:43],a[184:187],v[60:63]
ds_read_b64_tr_b16 a[160:161],v8 offset:0
v_mfma_f32_16x16x32_bf16 v[60:63],a[44:47],a[188:191],v[60:63]
ds_read_b64_tr_b16 a[162:163],v8 offset:2048
v_mfma_f32_16x16x32_bf16 v[120:123],a[48:51],a[184:187],v[120:123]
ds_read_b64_tr_b16 a[164:165],v8 offset:4096
v_mfma_f32_16x16x32_bf16 v[120:123],a[52:55],a[188:191],v[120:123]
s_add_u32 m0,s68,98304
v_add_u32 v5,s87,v5
v_mfma_f32_16x16x32_bf16 v[124:127],a[56:59],a[184:187],v[124:127]
ds_read_b64_tr_b16 a[166:167],v8 offset:6144
v_mfma_f32_16x16x32_bf16 v[124:127],a[60:63],a[188:191],v[124:127]
buffer_load_dwordx4 v5,s[12:15],s40 offen nt lds
v_mfma_f32_16x16x32_bf16 v[184:187],a[64:67],a[184:187],v[184:187]
s_add_u32 m0,s68,99328
v_mfma_f32_16x16x32_bf16 v[184:187],a[68:71],a[188:191],v[184:187]
v_mfma_f32_16x16x32_bf16 v[188:191],a[72:75],a[184:187],v[188:191]
v_mfma_f32_16x16x32_bf16 v[188:191],a[76:79],a[188:191],v[188:191]
buffer_load_dwordx4 v5,s[12:15],s41 offen nt lds
v_mfma_f32_16x16x32_bf16 v[248:251],a[80:83],a[184:187],v[248:251]
s_add_u32 m0,s68,100352
v_mfma_f32_16x16x32_bf16 v[248:251],a[84:87],a[188:191],v[248:251]
v_mfma_f32_16x16x32_bf16 v[252:255],a[88:91],a[184:187],v[252:255]
s_waitcnt lgkmcnt(0)
v_mfma_f32_16x16x32_bf16 v[252:255],a[92:95],a[188:191],v[252:255]
buffer_load_dwordx4 v5,s[12:15],s42 offen nt lds
v_mfma_f32_16x16x32_bf16 a[0:3],a[96:99],a[160:163],a[0:3]
ds_read_b64_tr_b16 a[168:169],v9 offset:0
s_add_u32 m0,s68,101376
v_mfma_f32_16x16x32_bf16 a[0:3],a[100:103],a[164:167],a[0:3]
ds_read_b64_tr_b16 a[170:171],v9 offset:2048
v_mfma_f32_16x16x32_bf16 a[4:7],a[104:107],a[160:163],a[4:7]
ds_read_b64_tr_b16 a[172:173],v9 offset:4096
v_mfma_f32_16x16x32_bf16 a[4:7],a[108:111],a[164:167],a[4:7]
ds_read_b64_tr_b16 a[174:175],v9 offset:6144
v_mfma_f32_16x16x32_bf16 v[64:67],a[112:115],a[160:163],v[64:67]
v_mfma_f32_16x16x32_bf16 v[64:67],a[116:119],a[164:167],v[64:67]
buffer_load_dwordx4 v5,s[12:15],s43 offen nt lds
v_mfma_f32_16x16x32_bf16 v[68:71],a[120:123],a[160:163],v[68:71]
s_add_u32 m0,s68,102400
v_mfma_f32_16x16x32_bf16 v[68:71],a[124:127],a[164:167],v[68:71]
v_mfma_f32_16x16x32_bf16 v[128:131],a[128:131],a[160:163],v[128:131]
v_mfma_f32_16x16x32_bf16 v[128:131],a[132:135],a[164:167],v[128:131]
buffer_load_dwordx4 v5,s[12:15],s44 offen nt lds
v_mfma_f32_16x16x32_bf16 v[132:135],a[136:139],a[160:163],v[132:135]
s_add_u32 m0,s68,103424
v_mfma_f32_16x16x32_bf16 v[132:135],a[140:143],a[164:167],v[132:135]
v_mfma_f32_16x16x32_bf16 v[192:195],a[144:147],a[160:163],v[192:195]
v_mfma_f32_16x16x32_bf16 v[192:195],a[148:151],a[164:167],v[192:195]
buffer_load_dwordx4 v5,s[12:15],s45 offen nt lds
v_mfma_f32_16x16x32_bf16 v[196:199],a[152:155],a[160:163],v[196:199]
s_add_u32 m0,s68,104448
v_mfma_f32_16x16x32_bf16 v[196:199],a[156:159],a[164:167],v[196:199]
s_waitcnt lgkmcnt(0)
v_mfma_f32_16x16x32_bf16 a[8:11],a[96:99],a[168:171],a[8:11]
ds_read_b64_tr_b16 a[176:177],v10 offset:0
v_mfma_f32_16x16x32_bf16 a[8:11],a[100:103],a[172:175],a[8:11]
ds_read_b64_tr_b16 a[178:179],v10 offset:2048
v_mfma_f32_16x16x32_bf16 a[12:15],a[104:107],a[168:171],a[12:15]
ds_read_b64_tr_b16 a[180:181],v10 offset:4096
v_mfma_f32_16x16x32_bf16 a[12:15],a[108:111],a[172:175],a[12:15]
ds_read_b64_tr_b16 a[182:183],v10 offset:6144
v_mfma_f32_16x16x32_bf16 v[72:75],a[112:115],a[168:171],v[72:75]
v_mfma_f32_16x16x32_bf16 v[72:75],a[116:119],a[172:175],v[72:75]
buffer_load_dwordx4 v5,s[12:15],s46 offen nt lds
v_mfma_f32_16x16x32_bf16 v[76:79],a[120:123],a[168:171],v[76:79]
s_add_u32 m0,s68,105472
v_mfma_f32_16x16x32_bf16 v[76:79],a[124:127],a[172:175],v[76:79]
v_mfma_f32_16x16x32_bf16 v[136:139],a[128:131],a[168:171],v[136:139]
v_mfma_f32_16x16x32_bf16 v[136:139],a[132:135],a[172:175],v[136:139]
buffer_load_dwordx4 v5,s[12:15],s47 offen nt lds
v_mfma_f32_16x16x32_bf16 v[140:143],a[136:139],a[168:171],v[140:143]
s_add_u32 m0,s68,32768
v_mfma_f32_16x16x32_bf16 v[140:143],a[140:143],a[172:175],v[140:143]
v_add_u32 v4,128,v4
v_mfma_f32_16x16x32_bf16 v[200:203],a[144:147],a[168:171],v[200:203]
v_mfma_f32_16x16x32_bf16 v[200:203],a[148:151],a[172:175],v[200:203]
buffer_load_dwordx4 v4,s[8:11],s32 offen lds
v_mfma_f32_16x16x32_bf16 v[204:207],a[152:155],a[168:171],v[204:207]
s_add_u32 m0,s68,33792
v_mfma_f32_16x16x32_bf16 v[204:207],a[156:159],a[172:175],v[204:207]
s_waitcnt lgkmcnt(0)
v_mfma_f32_16x16x32_bf16 a[16:19],a[96:99],a[176:179],a[16:19]
ds_read_b64_tr_b16 a[184:185],v11 offset:0
v_mfma_f32_16x16x32_bf16 a[16:19],a[100:103],a[180:183],a[16:19]
ds_read_b64_tr_b16 a[186:187],v11 offset:2048
v_mfma_f32_16x16x32_bf16 a[20:23],a[104:107],a[176:179],a[20:23]
ds_read_b64_tr_b16 a[188:189],v11 offset:4096
v_mfma_f32_16x16x32_bf16 a[20:23],a[108:111],a[180:183],a[20:23]
ds_read_b64_tr_b16 a[190:191],v11 offset:6144
v_mfma_f32_16x16x32_bf16 v[80:83],a[112:115],a[176:179],v[80:83]
v_mfma_f32_16x16x32_bf16 v[80:83],a[116:119],a[180:183],v[80:83]
buffer_load_dwordx4 v4,s[8:11],s33 offen lds
v_mfma_f32_16x16x32_bf16 v[84:87],a[120:123],a[176:179],v[84:87]
s_add_u32 m0,s68,34816
v_mfma_f32_16x16x32_bf16 v[84:87],a[124:127],a[180:183],v[84:87]
v_mfma_f32_16x16x32_bf16 v[144:147],a[128:131],a[176:179],v[144:147]
v_mfma_f32_16x16x32_bf16 v[144:147],a[132:135],a[180:183],v[144:147]
buffer_load_dwordx4 v4,s[8:11],s34 offen lds
v_mfma_f32_16x16x32_bf16 v[148:151],a[136:139],a[176:179],v[148:151]
s_add_u32 m0,s68,35840
v_mfma_f32_16x16x32_bf16 v[148:151],a[140:143],a[180:183],v[148:151]
v_mfma_f32_16x16x32_bf16 v[208:211],a[144:147],a[176:179],v[208:211]
v_mfma_f32_16x16x32_bf16 v[208:211],a[148:151],a[180:183],v[208:211]
buffer_load_dwordx4 v4,s[8:11],s35 offen lds
v_mfma_f32_16x16x32_bf16 v[212:215],a[152:155],a[176:179],v[212:215]
s_add_u32 m0,s68,36864
v_mfma_f32_16x16x32_bf16 v[212:215],a[156:159],a[180:183],v[212:215]
s_waitcnt lgkmcnt(0)
v_mfma_f32_16x16x32_bf16 a[24:27],a[96:99],a[184:187],a[24:27]
ds_read_b64_tr_b16 a[160:161],v8 offset:8192
v_mfma_f32_16x16x32_bf16 a[24:27],a[100:103],a[188:191],a[24:27]
ds_read_b64_tr_b16 a[162:163],v8 offset:10240
v_mfma_f32_16x16x32_bf16 a[28:31],a[104:107],a[184:187],a[28:31]
ds_read_b64_tr_b16 a[164:165],v8 offset:12288
v_mfma_f32_16x16x32_bf16 a[28:31],a[108:111],a[188:191],a[28:31]
ds_read_b64_tr_b16 a[166:167],v8 offset:14336
v_mfma_f32_16x16x32_bf16 v[88:91],a[112:115],a[184:187],v[88:91]
v_mfma_f32_16x16x32_bf16 v[88:91],a[116:119],a[188:191],v[88:91]
buffer_load_dwordx4 v4,s[8:11],s36 offen lds
v_mfma_f32_16x16x32_bf16 v[92:95],a[120:123],a[184:187],v[92:95]
s_add_u32 m0,s68,37888
v_mfma_f32_16x16x32_bf16 v[92:95],a[124:127],a[188:191],v[92:95]
v_mfma_f32_16x16x32_bf16 v[152:155],a[128:131],a[184:187],v[152:155]
v_mfma_f32_16x16x32_bf16 v[152:155],a[132:135],a[188:191],v[152:155]
buffer_load_dwordx4 v4,s[8:11],s37 offen lds
v_mfma_f32_16x16x32_bf16 v[156:159],a[136:139],a[184:187],v[156:159]
s_add_u32 m0,s68,38912
v_mfma_f32_16x16x32_bf16 v[156:159],a[140:143],a[188:191],v[156:159]
v_mfma_f32_16x16x32_bf16 v[216:219],a[144:147],a[184:187],v[216:219]
v_mfma_f32_16x16x32_bf16 v[216:219],a[148:151],a[188:191],v[216:219]
buffer_load_dwordx4 v4,s[8:11],s38 offen lds
v_mfma_f32_16x16x32_bf16 v[220:223],a[152:155],a[184:187],v[220:223]
s_waitcnt vmcnt(29)
s_add_u32 m0,s68,39936
v_mfma_f32_16x16x32_bf16 v[220:223],a[156:159],a[188:191],v[220:223]
s_barrier
s_waitcnt lgkmcnt(2)
v_mfma_f32_16x16x32_bf16 v[32:35],a[96:99],a[160:163],v[32:35]
ds_read_b64_tr_b16 a[168:169],v9 offset:8192
s_waitcnt lgkmcnt(1)
v_mfma_f32_16x16x32_bf16 v[32:35],a[100:103],a[164:167],v[32:35]
ds_read_b64_tr_b16 a[170:171],v9 offset:10240
v_mfma_f32_16x16x32_bf16 v[36:39],a[104:107],a[160:163],v[36:39]
ds_read_b64_tr_b16 a[172:173],v9 offset:12288
v_mfma_f32_16x16x32_bf16 v[36:39],a[108:111],a[164:167],v[36:39]
ds_read_b64_tr_b16 a[174:175],v9 offset:14336
v_mfma_f32_16x16x32_bf16 v[96:99],a[112:115],a[160:163],v[96:99]
ds_read_b128 a[32:35],v2 offset:0
v_mfma_f32_16x16x32_bf16 v[96:99],a[116:119],a[164:167],v[96:99]
buffer_load_dwordx4 v4,s[8:11],s39 offen lds
v_mfma_f32_16x16x32_bf16 v[100:103],a[120:123],a[160:163],v[100:103]
s_add_u32 s67,s64,1048576
buffer_load_dword a221,v5,s[12:15],s67 offen nt
v_mfma_f32_16x16x32_bf16 v[100:103],a[124:127],a[164:167],v[100:103]
ds_read_b128 a[36:39],v3 offset:0
v_mfma_f32_16x16x32_bf16 v[160:163],a[128:131],a[160:163],v[160:163]
global_load_dword a254,v0,s[100:101]
v_mfma_f32_16x16x32_bf16 v[160:163],a[132:135],a[164:167],v[160:163]
ds_read_b128 a[40:43],v2 offset:2048
v_mfma_f32_16x16x32_bf16 v[164:167],a[136:139],a[160:163],v[164:167]
ds_read_b128 a[44:47],v3 offset:2048
v_mfma_f32_16x16x32_bf16 v[164:167],a[140:143],a[164:167],v[164:167]
buffer_load_dword a204,v19,s[4:7],0 offen offset:3072 nt
v_mfma_f32_16x16x32_bf16 v[224:227],a[144:147],a[160:163],v[224:227]
ds_read_b128 a[48:51],v2 offset:4096
v_mfma_f32_16x16x32_bf16 v[224:227],a[148:151],a[164:167],v[224:227]
s_waitcnt lgkmcnt(7)
v_add_u32 v0,s79,v0
v_mfma_f32_16x16x32_bf16 v[228:231],a[152:155],a[160:163],v[228:231]
ds_read_b128 a[52:55],v3 offset:4096
v_mfma_f32_16x16x32_bf16 v[228:231],a[156:159],a[164:167],v[228:231]
buffer_load_dword a205,v16,s[4:7],0 offen offset:0 nt
v_mfma_f32_16x16x32_bf16 v[40:43],a[96:99],a[168:171],v[40:43]
ds_read_b64_tr_b16 a[176:177],v10 offset:8192
s_waitcnt lgkmcnt(7)
v_mfma_f32_16x16x32_bf16 v[40:43],a[100:103],a[172:175],v[40:43]
ds_read_b64_tr_b16 a[178:179],v10 offset:10240
v_mfma_f32_16x16x32_bf16 v[44:47],a[104:107],a[168:171],v[44:47]
ds_read_b64_tr_b16 a[180:181],v10 offset:12288
v_mfma_f32_16x16x32_bf16 v[44:47],a[108:111],a[172:175],v[44:47]
ds_read_b64_tr_b16 a[182:183],v10 offset:14336
v_mfma_f32_16x16x32_bf16 v[104:107],a[112:115],a[168:171],v[104:107]
ds_read_b128 a[56:59],v2 offset:6144
v_mfma_f32_16x16x32_bf16 v[104:107],a[116:119],a[172:175],v[104:107]
buffer_load_dword a206,v16,s[4:7],0 offen offset:1024 nt
v_mfma_f32_16x16x32_bf16 v[108:111],a[120:123],a[168:171],v[108:111]
ds_read_b128 a[60:63],v3 offset:6144
v_mfma_f32_16x16x32_bf16 v[108:111],a[124:127],a[172:175],v[108:111]
buffer_load_dword a207,v16,s[4:7],0 offen offset:2048 nt
v_mfma_f32_16x16x32_bf16 v[168:171],a[128:131],a[168:171],v[168:171]
ds_read_b128 a[64:67],v2 offset:8192
v_mfma_f32_16x16x32_bf16 v[168:171],a[132:135],a[172:175],v[168:171]
buffer_load_dword a208,v16,s[4:7],0 offen offset:3072 nt
v_mfma_f32_16x16x32_bf16 v[172:175],a[136:139],a[168:171],v[172:175]
ds_read_b128 a[68:71],v3 offset:8192
v_mfma_f32_16x16x32_bf16 v[172:175],a[140:143],a[172:175],v[172:175]
buffer_load_dword a209,v16,s[4:7],s3 offen offset:0 nt
v_mfma_f32_16x16x32_bf16 v[232:235],a[144:147],a[168:171],v[232:235]
ds_read_b128 a[72:75],v2 offset:10240
v_mfma_f32_16x16x32_bf16 v[232:235],a[148:151],a[172:175],v[232:235]
buffer_load_dword a210,v16,s[4:7],s3 offen offset:1024 nt
v_mfma_f32_16x16x32_bf16 v[236:239],a[152:155],a[168:171],v[236:239]
ds_read_b128 a[76:79],v3 offset:10240
v_mfma_f32_16x16x32_bf16 v[236:239],a[156:159],a[172:175],v[236:239]
buffer_load_dword a211,v16,s[4:7],s3 offen offset:2048 nt
s_waitcnt lgkmcnt(8)
v_mfma_f32_16x16x32_bf16 v[48:51],a[96:99],a[176:179],v[48:51]
ds_read_b64_tr_b16 a[184:185],v11 offset:8192
s_waitcnt lgkmcnt(7)
v_mfma_f32_16x16x32_bf16 v[48:51],a[100:103],a[180:183],v[48:51]
ds_read_b64_tr_b16 a[186:187],v11 offset:10240
v_mfma_f32_16x16x32_bf16 v[52:55],a[104:107],a[176:179],v[52:55]
ds_read_b64_tr_b16 a[188:189],v11 offset:12288
v_mfma_f32_16x16x32_bf16 v[52:55],a[108:111],a[180:183],v[52:55]
ds_read_b64_tr_b16 a[190:191],v11 offset:14336
v_mfma_f32_16x16x32_bf16 v[112:115],a[112:115],a[176:179],v[112:115]
ds_read_b128 a[80:83],v2 offset:12288
v_mfma_f32_16x16x32_bf16 v[112:115],a[116:119],a[180:183],v[112:115]
buffer_load_dword a212,v16,s[4:7],s3 offen offset:3072 nt
v_mfma_f32_16x16x32_bf16 v[116:119],a[120:123],a[176:179],v[116:119]
ds_read_b128 a[84:87],v3 offset:12288
s_mov_b32 s4,s62
v_mfma_f32_16x16x32_bf16 v[116:119],a[124:127],a[180:183],v[116:119]
s_and_b32 s5,s63,0xffff
s_movk_i32 s6,4096
v_mfma_f32_16x16x32_bf16 v[176:179],a[128:131],a[176:179],v[176:179]
ds_read_b128 a[88:91],v2 offset:14336
v_mfma_f32_16x16x32_bf16 v[176:179],a[132:135],a[180:183],v[176:179]
buffer_load_dwordx4 a[216:219],v20,s[4:7],0 offen
v_mfma_f32_16x16x32_bf16 v[180:183],a[136:139],a[176:179],v[180:183]
ds_read_b128 a[92:95],v3 offset:14336
s_mov_b32 s4,s24
v_mfma_f32_16x16x32_bf16 v[180:183],a[140:143],a[180:183],v[180:183]
s_and_b32 s5,s25,0xffff
s_mov_b32 s6,2097152
s_and_b32 s3,s2,7
v_mfma_f32_16x16x32_bf16 v[240:243],a[144:147],a[176:179],v[240:243]
s_lshl_b32 s3,s3,5
s_lshr_b32 s24,s2,3
s_add_u32 s3,s3,s24
v_mfma_f32_16x16x32_bf16 v[240:243],a[148:151],a[180:183],v[240:243]
s_lshl_b32 s3,s3,13
s_lshl_b32 s24,s20,11
s_add_u32 s3,s3,s24
v_mfma_f32_16x16x32_bf16 v[244:247],a[152:155],a[176:179],v[244:247]
buffer_load_dwordx4 a[240:243],v1,s[4:7],s3 offen offset:0 nt
v_mfma_f32_16x16x32_bf16 v[244:247],a[156:159],a[180:183],v[244:247]
buffer_load_dwordx4 a[244:247],v1,s[4:7],s3 offen offset:1024 nt
s_waitcnt lgkmcnt(6)
v_mfma_f32_16x16x32_bf16 v[56:59],a[96:99],a[184:187],v[56:59]
s_waitcnt vmcnt(22) lgkmcnt(0)
v_mfma_f32_16x16x32_bf16 v[56:59],a[100:103],a[188:191],v[56:59]
s_barrier
v_mfma_f32_16x16x32_bf16 v[60:63],a[104:107],a[184:187],v[60:63]
ds_read_b64_tr_b16 a[160:161],v8 offset:32768
v_mfma_f32_16x16x32_bf16 v[60:63],a[108:111],a[188:191],v[60:63]
ds_read_b64_tr_b16 a[162:163],v8 offset:34816
v_mfma_f32_16x16x32_bf16 v[120:123],a[112:115],a[184:187],v[120:123]
ds_read_b64_tr_b16 a[164:165],v8 offset:36864
v_mfma_f32_16x16x32_bf16 v[120:123],a[116:119],a[188:191],v[120:123]
s_add_u32 m0,s68,131072
v_add_u32 v5,524288,v5
v_mfma_f32_16x16x32_bf16 v[124:127],a[120:123],a[184:187],v[124:127]
ds_read_b64_tr_b16 a[166:167],v8 offset:38912
v_mfma_f32_16x16x32_bf16 v[124:127],a[124:127],a[188:191],v[124:127]
buffer_load_dwordx4 v5,s[12:15],s40 offen nt lds
v_mfma_f32_16x16x32_bf16 v[184:187],a[128:131],a[184:187],v[184:187]
s_add_u32 m0,s68,132096
v_mfma_f32_16x16x32_bf16 v[184:187],a[132:135],a[188:191],v[184:187]
v_mfma_f32_16x16x32_bf16 v[188:191],a[136:139],a[184:187],v[188:191]
v_mfma_f32_16x16x32_bf16 v[188:191],a[140:143],a[188:191],v[188:191]
buffer_load_dwordx4 v5,s[12:15],s41 offen nt lds
v_mfma_f32_16x16x32_bf16 v[248:251],a[144:147],a[184:187],v[248:251]
s_add_u32 m0,s68,133120
v_mfma_f32_16x16x32_bf16 v[248:251],a[148:151],a[188:191],v[248:251]
v_mfma_f32_16x16x32_bf16 v[252:255],a[152:155],a[184:187],v[252:255]
s_waitcnt lgkmcnt(0)
v_mfma_f32_16x16x32_bf16 v[252:255],a[156:159],a[188:191],v[252:255]
buffer_load_dwordx4 v5,s[12:15],s42 offen nt lds
v_mfma_f32_16x16x32_bf16 a[0:3],a[32:35],a[160:163],a[0:3]
ds_read_b64_tr_b16 a[168:169],v9 offset:32768
s_add_u32 m0,s68,134144
v_mfma_f32_16x16x32_bf16 a[0:3],a[36:39],a[164:167],a[0:3]
ds_read_b64_tr_b16 a[170:171],v9 offset:34816
v_mfma_f32_16x16x32_bf16 a[4:7],a[40:43],a[160:163],a[4:7]
ds_read_b64_tr_b16 a[172:173],v9 offset:36864
v_mfma_f32_16x16x32_bf16 a[4:7],a[44:47],a[164:167],a[4:7]
ds_read_b64_tr_b16 a[174:175],v9 offset:38912
v_mfma_f32_16x16x32_bf16 v[64:67],a[48:51],a[160:163],v[64:67]
v_mfma_f32_16x16x32_bf16 v[64:67],a[52:55],a[164:167],v[64:67]
buffer_load_dwordx4 v5,s[12:15],s43 offen nt lds
v_mfma_f32_16x16x32_bf16 v[68:71],a[56:59],a[160:163],v[68:71]
s_add_u32 m0,s68,135168
v_mfma_f32_16x16x32_bf16 v[68:71],a[60:63],a[164:167],v[68:71]
v_mfma_f32_16x16x32_bf16 v[128:131],a[64:67],a[160:163],v[128:131]
v_mfma_f32_16x16x32_bf16 v[128:131],a[68:71],a[164:167],v[128:131]
buffer_load_dwordx4 v5,s[12:15],s44 offen nt lds
v_mfma_f32_16x16x32_bf16 v[132:135],a[72:75],a[160:163],v[132:135]
s_add_u32 m0,s68,136192
v_mfma_f32_16x16x32_bf16 v[132:135],a[76:79],a[164:167],v[132:135]
v_mfma_f32_16x16x32_bf16 v[192:195],a[80:83],a[160:163],v[192:195]
v_mfma_f32_16x16x32_bf16 v[192:195],a[84:87],a[164:167],v[192:195]
buffer_load_dwordx4 v5,s[12:15],s45 offen nt lds
v_mfma_f32_16x16x32_bf16 v[196:199],a[88:91],a[160:163],v[196:199]
s_add_u32 m0,s68,137216
v_mfma_f32_16x16x32_bf16 v[196:199],a[92:95],a[164:167],v[196:199]
s_waitcnt lgkmcnt(0)
v_mfma_f32_16x16x32_bf16 a[8:11],a[32:35],a[168:171],a[8:11]
ds_read_b64_tr_b16 a[176:177],v10 offset:32768
v_mfma_f32_16x16x32_bf16 a[8:11],a[36:39],a[172:175],a[8:11]
ds_read_b64_tr_b16 a[178:179],v10 offset:34816
v_mfma_f32_16x16x32_bf16 a[12:15],a[40:43],a[168:171],a[12:15]
ds_read_b64_tr_b16 a[180:181],v10 offset:36864
v_mfma_f32_16x16x32_bf16 a[12:15],a[44:47],a[172:175],a[12:15]
ds_read_b64_tr_b16 a[182:183],v10 offset:38912
v_mfma_f32_16x16x32_bf16 v[72:75],a[48:51],a[168:171],v[72:75]
v_mfma_f32_16x16x32_bf16 v[72:75],a[52:55],a[172:175],v[72:75]
buffer_load_dwordx4 v5,s[12:15],s46 offen nt lds
v_mfma_f32_16x16x32_bf16 v[76:79],a[56:59],a[168:171],v[76:79]
s_add_u32 m0,s68,138240
v_mfma_f32_16x16x32_bf16 v[76:79],a[60:63],a[172:175],v[76:79]
v_mfma_f32_16x16x32_bf16 v[136:139],a[64:67],a[168:171],v[136:139]
v_mfma_f32_16x16x32_bf16 v[136:139],a[68:71],a[172:175],v[136:139]
buffer_load_dwordx4 v5,s[12:15],s47 offen nt lds
v_mfma_f32_16x16x32_bf16 v[140:143],a[72:75],a[168:171],v[140:143]
s_add_u32 m0,s68,0
v_mfma_f32_16x16x32_bf16 v[140:143],a[76:79],a[172:175],v[140:143]
v_add_u32 v4,128,v4
v_mfma_f32_16x16x32_bf16 v[200:203],a[80:83],a[168:171],v[200:203]
v_mfma_f32_16x16x32_bf16 v[200:203],a[84:87],a[172:175],v[200:203]
buffer_load_dwordx4 v4,s[8:11],s32 offen lds
v_mfma_f32_16x16x32_bf16 v[204:207],a[88:91],a[168:171],v[204:207]
s_add_u32 m0,s68,1024
v_mfma_f32_16x16x32_bf16 v[204:207],a[92:95],a[172:175],v[204:207]
s_waitcnt lgkmcnt(0)
v_mfma_f32_16x16x32_bf16 a[16:19],a[32:35],a[176:179],a[16:19]
ds_read_b64_tr_b16 a[184:185],v11 offset:32768
v_mfma_f32_16x16x32_bf16 a[16:19],a[36:39],a[180:183],a[16:19]
ds_read_b64_tr_b16 a[186:187],v11 offset:34816
v_mfma_f32_16x16x32_bf16 a[20:23],a[40:43],a[176:179],a[20:23]
ds_read_b64_tr_b16 a[188:189],v11 offset:36864
v_mfma_f32_16x16x32_bf16 a[20:23],a[44:47],a[180:183],a[20:23]
ds_read_b64_tr_b16 a[190:191],v11 offset:38912
v_mfma_f32_16x16x32_bf16 v[80:83],a[48:51],a[176:179],v[80:83]
v_mfma_f32_16x16x32_bf16 v[80:83],a[52:55],a[180:183],v[80:83]
buffer_load_dwordx4 v4,s[8:11],s33 offen lds
v_mfma_f32_16x16x32_bf16 v[84:87],a[56:59],a[176:179],v[84:87]
s_add_u32 m0,s68,2048
v_mfma_f32_16x16x32_bf16 v[84:87],a[60:63],a[180:183],v[84:87]
v_mfma_f32_16x16x32_bf16 v[144:147],a[64:67],a[176:179],v[144:147]
v_mfma_f32_16x16x32_bf16 v[144:147],a[68:71],a[180:183],v[144:147]
buffer_load_dwordx4 v4,s[8:11],s34 offen lds
v_mfma_f32_16x16x32_bf16 v[148:151],a[72:75],a[176:179],v[148:151]
s_add_u32 m0,s68,3072
v_mfma_f32_16x16x32_bf16 v[148:151],a[76:79],a[180:183],v[148:151]
v_mfma_f32_16x16x32_bf16 v[208:211],a[80:83],a[176:179],v[208:211]
v_mfma_f32_16x16x32_bf16 v[208:211],a[84:87],a[180:183],v[208:211]
buffer_load_dwordx4 v4,s[8:11],s35 offen lds
v_mfma_f32_16x16x32_bf16 v[212:215],a[88:91],a[176:179],v[212:215]
s_add_u32 m0,s68,4096
v_mfma_f32_16x16x32_bf16 v[212:215],a[92:95],a[180:183],v[212:215]
s_waitcnt lgkmcnt(0)
v_mfma_f32_16x16x32_bf16 a[24:27],a[32:35],a[184:187],a[24:27]
ds_read_b64_tr_b16 a[160:161],v8 offset:40960
v_mfma_f32_16x16x32_bf16 a[24:27],a[36:39],a[188:191],a[24:27]
ds_read_b64_tr_b16 a[162:163],v8 offset:43008
v_mfma_f32_16x16x32_bf16 a[28:31],a[40:43],a[184:187],a[28:31]
ds_read_b64_tr_b16 a[164:165],v8 offset:45056
v_mfma_f32_16x16x32_bf16 a[28:31],a[44:47],a[188:191],a[28:31]
ds_read_b64_tr_b16 a[166:167],v8 offset:47104
v_mfma_f32_16x16x32_bf16 v[88:91],a[48:51],a[184:187],v[88:91]
v_mfma_f32_16x16x32_bf16 v[88:91],a[52:55],a[188:191],v[88:91]
buffer_load_dwordx4 v4,s[8:11],s36 offen lds
v_mfma_f32_16x16x32_bf16 v[92:95],a[56:59],a[184:187],v[92:95]
s_add_u32 m0,s68,5120
v_mfma_f32_16x16x32_bf16 v[92:95],a[60:63],a[188:191],v[92:95]
v_mfma_f32_16x16x32_bf16 v[152:155],a[64:67],a[184:187],v[152:155]
v_mfma_f32_16x16x32_bf16 v[152:155],a[68:71],a[188:191],v[152:155]
buffer_load_dwordx4 v4,s[8:11],s37 offen lds
v_mfma_f32_16x16x32_bf16 v[156:159],a[72:75],a[184:187],v[156:159]
s_add_u32 m0,s68,6144
v_mfma_f32_16x16x32_bf16 v[156:159],a[76:79],a[188:191],v[156:159]
v_mfma_f32_16x16x32_bf16 v[216:219],a[80:83],a[184:187],v[216:219]
v_mfma_f32_16x16x32_bf16 v[216:219],a[84:87],a[188:191],v[216:219]
buffer_load_dwordx4 v4,s[8:11],s38 offen lds
v_mfma_f32_16x16x32_bf16 v[220:223],a[88:91],a[184:187],v[220:223]
s_waitcnt vmcnt(29)
s_add_u32 m0,s68,7168
v_mfma_f32_16x16x32_bf16 v[220:223],a[92:95],a[188:191],v[220:223]
s_barrier
s_waitcnt lgkmcnt(2)
v_mfma_f32_16x16x32_bf16 v[32:35],a[32:35],a[160:163],v[32:35]
ds_read_b64_tr_b16 a[168:169],v9 offset:40960
s_waitcnt lgkmcnt(1)
v_mfma_f32_16x16x32_bf16 v[32:35],a[36:39],a[164:167],v[32:35]
ds_read_b64_tr_b16 a[170:171],v9 offset:43008
v_mfma_f32_16x16x32_bf16 v[36:39],a[40:43],a[160:163],v[36:39]
ds_read_b64_tr_b16 a[172:173],v9 offset:45056
v_mfma_f32_16x16x32_bf16 v[36:39],a[44:47],a[164:167],v[36:39]
ds_read_b64_tr_b16 a[174:175],v9 offset:47104
v_mfma_f32_16x16x32_bf16 v[96:99],a[48:51],a[160:163],v[96:99]
ds_read_b128 a[96:99],v2 offset:32768
v_mfma_f32_16x16x32_bf16 v[96:99],a[52:55],a[164:167],v[96:99]
buffer_load_dwordx4 v4,s[8:11],s39 offen lds
v_mfma_f32_16x16x32_bf16 v[100:103],a[56:59],a[160:163],v[100:103]
s_add_u32 s67,s64,1048576
buffer_load_dword a220,v5,s[12:15],s67 offen nt
v_mfma_f32_16x16x32_bf16 v[100:103],a[60:63],a[164:167],v[100:103]
ds_read_b128 a[100:103],v3 offset:32768
v_mfma_f32_16x16x32_bf16 v[160:163],a[64:67],a[160:163],v[160:163]
global_load_dword a255,v0,s[100:101]
v_mfma_f32_16x16x32_bf16 v[160:163],a[68:71],a[164:167],v[160:163]
ds_read_b128 a[104:107],v2 offset:34816
v_mfma_f32_16x16x32_bf16 v[164:167],a[72:75],a[160:163],v[164:167]
ds_read_b128 a[108:111],v3 offset:34816
v_mfma_f32_16x16x32_bf16 v[164:167],a[76:79],a[164:167],v[164:167]
v_mfma_f32_16x16x32_bf16 v[224:227],a[80:83],a[160:163],v[224:227]
ds_read_b128 a[112:115],v2 offset:36864
v_mfma_f32_16x16x32_bf16 v[224:227],a[84:87],a[164:167],v[224:227]
v_add_u32 v0,s79,v0
v_mfma_f32_16x16x32_bf16 v[228:231],a[88:91],a[160:163],v[228:231]
ds_read_b128 a[116:119],v3 offset:36864
v_mfma_f32_16x16x32_bf16 v[228:231],a[92:95],a[164:167],v[228:231]
s_waitcnt lgkmcnt(6)
v_mfma_f32_16x16x32_bf16 v[40:43],a[32:35],a[168:171],v[40:43]
ds_read_b64_tr_b16 a[176:177],v10 offset:40960
v_mfma_f32_16x16x32_bf16 v[40:43],a[36:39],a[172:175],v[40:43]
ds_read_b64_tr_b16 a[178:179],v10 offset:43008
v_mfma_f32_16x16x32_bf16 v[44:47],a[40:43],a[168:171],v[44:47]
ds_read_b64_tr_b16 a[180:181],v10 offset:45056
v_mfma_f32_16x16x32_bf16 v[44:47],a[44:47],a[172:175],v[44:47]
ds_read_b64_tr_b16 a[182:183],v10 offset:47104
v_mfma_f32_16x16x32_bf16 v[104:107],a[48:51],a[168:171],v[104:107]
ds_read_b128 a[120:123],v2 offset:38912
v_mfma_f32_16x16x32_bf16 v[104:107],a[52:55],a[172:175],v[104:107]
v_mfma_f32_16x16x32_bf16 v[108:111],a[56:59],a[168:171],v[108:111]
ds_read_b128 a[124:127],v3 offset:38912
v_mfma_f32_16x16x32_bf16 v[108:111],a[60:63],a[172:175],v[108:111]
v_mfma_f32_16x16x32_bf16 v[168:171],a[64:67],a[168:171],v[168:171]
ds_read_b128 a[128:131],v2 offset:40960
v_mfma_f32_16x16x32_bf16 v[168:171],a[68:71],a[172:175],v[168:171]
v_mfma_f32_16x16x32_bf16 v[172:175],a[72:75],a[168:171],v[172:175]
ds_read_b128 a[132:135],v3 offset:40960
v_mfma_f32_16x16x32_bf16 v[172:175],a[76:79],a[172:175],v[172:175]
v_mfma_f32_16x16x32_bf16 v[232:235],a[80:83],a[168:171],v[232:235]
ds_read_b128 a[136:139],v2 offset:43008
v_mfma_f32_16x16x32_bf16 v[232:235],a[84:87],a[172:175],v[232:235]
v_mfma_f32_16x16x32_bf16 v[236:239],a[88:91],a[168:171],v[236:239]
ds_read_b128 a[140:143],v3 offset:43008
v_mfma_f32_16x16x32_bf16 v[236:239],a[92:95],a[172:175],v[236:239]
s_waitcnt lgkmcnt(6)
v_mfma_f32_16x16x32_bf16 v[48:51],a[32:35],a[176:179],v[48:51]
ds_read_b64_tr_b16 a[184:185],v11 offset:40960
v_mfma_f32_16x16x32_bf16 v[48:51],a[36:39],a[180:183],v[48:51]
ds_read_b64_tr_b16 a[186:187],v11 offset:43008
v_mfma_f32_16x16x32_bf16 v[52:55],a[40:43],a[176:179],v[52:55]
ds_read_b64_tr_b16 a[188:189],v11 offset:45056
v_mfma_f32_16x16x32_bf16 v[52:55],a[44:47],a[180:183],v[52:55]
ds_read_b64_tr_b16 a[190:191],v11 offset:47104
v_mfma_f32_16x16x32_bf16 v[112:115],a[48:51],a[176:179],v[112:115]
ds_read_b128 a[144:147],v2 offset:45056
v_mfma_f32_16x16x32_bf16 v[112:115],a[52:55],a[180:183],v[112:115]
v_mfma_f32_16x16x32_bf16 v[116:119],a[56:59],a[176:179],v[116:119]
ds_read_b128 a[148:151],v3 offset:45056
v_mfma_f32_16x16x32_bf16 v[116:119],a[60:63],a[180:183],v[116:119]
v_mfma_f32_16x16x32_bf16 v[176:179],a[64:67],a[176:179],v[176:179]
ds_read_b128 a[152:155],v2 offset:47104
v_mfma_f32_16x16x32_bf16 v[176:179],a[68:71],a[180:183],v[176:179]
v_mfma_f32_16x16x32_bf16 v[180:183],a[72:75],a[176:179],v[180:183]
ds_read_b128 a[156:159],v3 offset:47104
v_mfma_f32_16x16x32_bf16 v[180:183],a[76:79],a[180:183],v[180:183]
v_mfma_f32_16x16x32_bf16 v[240:243],a[80:83],a[176:179],v[240:243]
v_mfma_f32_16x16x32_bf16 v[240:243],a[84:87],a[180:183],v[240:243]
v_mfma_f32_16x16x32_bf16 v[244:247],a[88:91],a[176:179],v[244:247]
v_mfma_f32_16x16x32_bf16 v[244:247],a[92:95],a[180:183],v[244:247]
s_waitcnt lgkmcnt(6)
v_mfma_f32_16x16x32_bf16 v[56:59],a[32:35],a[184:187],v[56:59]
s_waitcnt vmcnt(10) lgkmcnt(0)
v_mfma_f32_16x16x32_bf16 v[56:59],a[36:39],a[188:191],v[56:59]
s_barrier
v_mfma_f32_16x16x32_bf16 v[60:63],a[40:43],a[184:187],v[60:63]
ds_read_b64_tr_b16 a[160:161],v12 offset:0
v_mfma_f32_16x16x32_bf16 v[60:63],a[44:47],a[188:191],v[60:63]
ds_read_b64_tr_b16 a[162:163],v12 offset:2048
v_mfma_f32_16x16x32_bf16 v[120:123],a[48:51],a[184:187],v[120:123]
ds_read_b64_tr_b16 a[164:165],v12 offset:4096
v_mfma_f32_16x16x32_bf16 v[120:123],a[52:55],a[188:191],v[120:123]
s_add_u32 m0,s68,65536
v_add_u32 v5,524288,v5
v_mfma_f32_16x16x32_bf16 v[124:127],a[56:59],a[184:187],v[124:127]
ds_read_b64_tr_b16 a[166:167],v12 offset:6144
v_mfma_f32_16x16x32_bf16 v[124:127],a[60:63],a[188:191],v[124:127]
buffer_load_dwordx4 v5,s[12:15],s40 offen nt lds
v_mfma_f32_16x16x32_bf16 v[184:187],a[64:67],a[184:187],v[184:187]
s_add_u32 m0,s68,66560
v_mfma_f32_16x16x32_bf16 v[184:187],a[68:71],a[188:191],v[184:187]
v_mfma_f32_16x16x32_bf16 v[188:191],a[72:75],a[184:187],v[188:191]
v_mfma_f32_16x16x32_bf16 v[188:191],a[76:79],a[188:191],v[188:191]
buffer_load_dwordx4 v5,s[12:15],s41 offen nt lds
v_mfma_f32_16x16x32_bf16 v[248:251],a[80:83],a[184:187],v[248:251]
s_add_u32 m0,s68,67584
v_mfma_f32_16x16x32_bf16 v[248:251],a[84:87],a[188:191],v[248:251]
v_mfma_f32_16x16x32_bf16 v[252:255],a[88:91],a[184:187],v[252:255]
s_waitcnt lgkmcnt(0)
v_mfma_f32_16x16x32_bf16 v[252:255],a[92:95],a[188:191],v[252:255]
buffer_load_dwordx4 v5,s[12:15],s42 offen nt lds
v_mfma_f32_16x16x32_bf16 a[0:3],a[96:99],a[160:163],a[0:3]
ds_read_b64_tr_b16 a[168:169],v13 offset:0
s_add_u32 m0,s68,68608
v_mfma_f32_16x16x32_bf16 a[0:3],a[100:103],a[164:167],a[0:3]
ds_read_b64_tr_b16 a[170:171],v13 offset:2048
v_accvgpr_read_b32 v19,a216
v_mfma_f32_16x16x32_bf16 a[4:7],a[104:107],a[160:163],a[4:7]
ds_read_b64_tr_b16 a[172:173],v13 offset:4096
v_lshlrev_b32 v19,16,v19
v_mfma_f32_16x16x32_bf16 a[4:7],a[108:111],a[164:167],a[4:7]
ds_read_b64_tr_b16 a[174:175],v13 offset:6144
v_accvgpr_read_b32 v20,a216
v_mfma_f32_16x16x32_bf16 v[64:67],a[112:115],a[160:163],v[64:67]
v_and_b32 v20,0xffff0000,v20
v_accvgpr_read_b32 v21,a217
v_mfma_f32_16x16x32_bf16 v[64:67],a[116:119],a[164:167],v[64:67]
buffer_load_dwordx4 v5,s[12:15],s43 offen nt lds
v_mfma_f32_16x16x32_bf16 v[68:71],a[120:123],a[160:163],v[68:71]
s_add_u32 m0,s68,69632
v_lshlrev_b32 v21,16,v21
v_accvgpr_read_b32 v22,a217
v_mfma_f32_16x16x32_bf16 v[68:71],a[124:127],a[164:167],v[68:71]
v_and_b32 v22,0xffff0000,v22
v_accvgpr_read_b32 v24,a192
v_mfma_f32_16x16x32_bf16 v[128:131],a[128:131],a[160:163],v[128:131]
v_lshlrev_b32 v24,16,v24
v_accvgpr_read_b32 v25,a193
v_mfma_f32_16x16x32_bf16 v[128:131],a[132:135],a[164:167],v[128:131]
buffer_load_dwordx4 v5,s[12:15],s44 offen nt lds
v_mfma_f32_16x16x32_bf16 v[132:135],a[136:139],a[160:163],v[132:135]
s_add_u32 m0,s68,70656
v_lshlrev_b32 v25,16,v25
v_accvgpr_read_b32 v26,a194
v_mfma_f32_16x16x32_bf16 v[132:135],a[140:143],a[164:167],v[132:135]
v_lshlrev_b32 v26,16,v26
v_accvgpr_read_b32 v27,a195
v_mfma_f32_16x16x32_bf16 v[192:195],a[144:147],a[160:163],v[192:195]
v_lshlrev_b32 v27,16,v27
v_mul_f32 v30,v24,v22
v_mfma_f32_16x16x32_bf16 v[192:195],a[148:151],a[164:167],v[192:195]
buffer_load_dwordx4 v5,s[12:15],s45 offen nt lds
v_mfma_f32_16x16x32_bf16 v[196:199],a[152:155],a[160:163],v[196:199]
s_add_u32 m0,s68,71680
v_fmac_f32 v30,v25,v21
v_fmac_f32 v30,v26,v20
v_mfma_f32_16x16x32_bf16 v[196:199],a[156:159],a[164:167],v[196:199]
s_waitcnt lgkmcnt(0)
v_fmac_f32 v30,v27,v19
v_accvgpr_read_b32 v17,a204
v_mfma_f32_16x16x32_bf16 a[8:11],a[96:99],a[168:171],a[8:11]
ds_read_b64_tr_b16 a[176:177],v14 offset:0
v_lshlrev_b32 v17,16,v17
v_mfma_f32_16x16x32_bf16 a[8:11],a[100:103],a[172:175],a[8:11]
ds_read_b64_tr_b16 a[178:179],v14 offset:2048
v_mul_f32 v30,v30,v17
v_mfma_f32_16x16x32_bf16 a[12:15],a[104:107],a[168:171],a[12:15]
ds_read_b64_tr_b16 a[180:181],v14 offset:4096
v_accvgpr_read_b32 v24,a196
v_mfma_f32_16x16x32_bf16 a[12:15],a[108:111],a[172:175],a[12:15]
ds_read_b64_tr_b16 a[182:183],v14 offset:6144
v_lshlrev_b32 v24,16,v24
v_mfma_f32_16x16x32_bf16 v[72:75],a[112:115],a[168:171],v[72:75]
v_mul_f32 v31,v25,v22
v_fmac_f32 v31,v26,v21
v_mfma_f32_16x16x32_bf16 v[72:75],a[116:119],a[172:175],v[72:75]
buffer_load_dwordx4 v5,s[12:15],s46 offen nt lds
v_mfma_f32_16x16x32_bf16 v[76:79],a[120:123],a[168:171],v[76:79]
s_add_u32 m0,s68,72704
v_fmac_f32 v31,v27,v20
v_fmac_f32 v31,v24,v19
v_mfma_f32_16x16x32_bf16 v[76:79],a[124:127],a[172:175],v[76:79]
v_accvgpr_read_b32 v17,a205
v_lshlrev_b32 v17,16,v17
v_mfma_f32_16x16x32_bf16 v[136:139],a[128:131],a[168:171],v[136:139]
v_mul_f32 v31,v31,v17
v_cvt_pk_bf16_f32 v17,v31,v30
v_mfma_f32_16x16x32_bf16 v[136:139],a[132:135],a[172:175],v[136:139]
buffer_load_dwordx4 v5,s[12:15],s47 offen nt lds
v_mfma_f32_16x16x32_bf16 v[140:143],a[136:139],a[168:171],v[140:143]
s_add_u32 m0,s68,32768
v_accvgpr_write_b32 a231,v17
v_accvgpr_read_b32 v25,a197
v_mfma_f32_16x16x32_bf16 v[140:143],a[140:143],a[172:175],v[140:143]
v_add_u32 v4,128,v4
v_lshlrev_b32 v25,16,v25
v_mfma_f32_16x16x32_bf16 v[200:203],a[144:147],a[168:171],v[200:203]
v_mul_f32 v30,v26,v22
v_fmac_f32 v30,v27,v21
v_mfma_f32_16x16x32_bf16 v[200:203],a[148:151],a[172:175],v[200:203]
buffer_load_dwordx4 v4,s[8:11],s32 offen lds
v_mfma_f32_16x16x32_bf16 v[204:207],a[152:155],a[168:171],v[204:207]
s_add_u32 m0,s68,33792
v_fmac_f32 v30,v24,v20
v_fmac_f32 v30,v25,v19
v_mfma_f32_16x16x32_bf16 v[204:207],a[156:159],a[172:175],v[204:207]
s_waitcnt lgkmcnt(0)
v_accvgpr_read_b32 v17,a206
v_lshlrev_b32 v17,16,v17
v_mfma_f32_16x16x32_bf16 a[16:19],a[96:99],a[176:179],a[16:19]
ds_read_b64_tr_b16 a[184:185],v15 offset:0
v_mul_f32 v30,v30,v17
v_mfma_f32_16x16x32_bf16 a[16:19],a[100:103],a[180:183],a[16:19]
ds_read_b64_tr_b16 a[186:187],v15 offset:2048
v_cvt_pk_bf16_f32 v17,v30,v31
v_mfma_f32_16x16x32_bf16 a[20:23],a[104:107],a[176:179],a[20:23]
ds_read_b64_tr_b16 a[188:189],v15 offset:4096
v_accvgpr_write_b32 a227,v17
v_mfma_f32_16x16x32_bf16 a[20:23],a[108:111],a[180:183],a[20:23]
ds_read_b64_tr_b16 a[190:191],v15 offset:6144
v_accvgpr_read_b32 v26,a198
v_mfma_f32_16x16x32_bf16 v[80:83],a[112:115],a[176:179],v[80:83]
v_lshlrev_b32 v26,16,v26
v_mul_f32 v31,v27,v22
v_mfma_f32_16x16x32_bf16 v[80:83],a[116:119],a[180:183],v[80:83]
buffer_load_dwordx4 v4,s[8:11],s33 offen lds
v_mfma_f32_16x16x32_bf16 v[84:87],a[120:123],a[176:179],v[84:87]
s_add_u32 m0,s68,34816
v_fmac_f32 v31,v24,v21
v_fmac_f32 v31,v25,v20
v_mfma_f32_16x16x32_bf16 v[84:87],a[124:127],a[180:183],v[84:87]
v_fmac_f32 v31,v26,v19
v_accvgpr_read_b32 v17,a207
v_mfma_f32_16x16x32_bf16 v[144:147],a[128:131],a[176:179],v[144:147]
v_lshlrev_b32 v17,16,v17
v_mul_f32 v31,v31,v17
v_mfma_f32_16x16x32_bf16 v[144:147],a[132:135],a[180:183],v[144:147]
buffer_load_dwordx4 v4,s[8:11],s34 offen lds
v_mfma_f32_16x16x32_bf16 v[148:151],a[136:139],a[176:179],v[148:151]
s_add_u32 m0,s68,35840
v_cvt_pk_bf16_f32 v17,v31,v30
v_accvgpr_write_b32 a230,v17
v_mfma_f32_16x16x32_bf16 v[148:151],a[140:143],a[180:183],v[148:151]
v_accvgpr_read_b32 v27,a199
v_lshlrev_b32 v27,16,v27
v_mfma_f32_16x16x32_bf16 v[208:211],a[144:147],a[176:179],v[208:211]
v_mul_f32 v30,v24,v22
v_fmac_f32 v30,v25,v21
v_mfma_f32_16x16x32_bf16 v[208:211],a[148:151],a[180:183],v[208:211]
buffer_load_dwordx4 v4,s[8:11],s35 offen lds
v_mfma_f32_16x16x32_bf16 v[212:215],a[152:155],a[176:179],v[212:215]
s_add_u32 m0,s68,36864
v_fmac_f32 v30,v26,v20
v_fmac_f32 v30,v27,v19
v_mfma_f32_16x16x32_bf16 v[212:215],a[156:159],a[180:183],v[212:215]
s_waitcnt lgkmcnt(0)
v_accvgpr_read_b32 v17,a208
v_lshlrev_b32 v17,16,v17
v_mfma_f32_16x16x32_bf16 a[24:27],a[96:99],a[184:187],a[24:27]
ds_read_b64_tr_b16 a[160:161],v12 offset:8192
v_mul_f32 v30,v30,v17
v_mfma_f32_16x16x32_bf16 a[24:27],a[100:103],a[188:191],a[24:27]
ds_read_b64_tr_b16 a[162:163],v12 offset:10240
v_cvt_pk_bf16_f32 v17,v30,v31
v_mfma_f32_16x16x32_bf16 a[28:31],a[104:107],a[184:187],a[28:31]
ds_read_b64_tr_b16 a[164:165],v12 offset:12288
v_accvgpr_write_b32 a226,v17
v_mfma_f32_16x16x32_bf16 a[28:31],a[108:111],a[188:191],a[28:31]
ds_read_b64_tr_b16 a[166:167],v12 offset:14336
v_accvgpr_read_b32 v24,a200
v_mfma_f32_16x16x32_bf16 v[88:91],a[112:115],a[184:187],v[88:91]
v_lshlrev_b32 v24,16,v24
v_mul_f32 v31,v25,v22
v_mfma_f32_16x16x32_bf16 v[88:91],a[116:119],a[188:191],v[88:91]
buffer_load_dwordx4 v4,s[8:11],s36 offen lds
v_mfma_f32_16x16x32_bf16 v[92:95],a[120:123],a[184:187],v[92:95]
s_add_u32 m0,s68,37888
v_fmac_f32 v31,v26,v21
v_fmac_f32 v31,v27,v20
v_mfma_f32_16x16x32_bf16 v[92:95],a[124:127],a[188:191],v[92:95]
v_fmac_f32 v31,v24,v19
v_accvgpr_read_b32 v17,a209
v_mfma_f32_16x16x32_bf16 v[152:155],a[128:131],a[184:187],v[152:155]
v_lshlrev_b32 v17,16,v17
v_mul_f32 v31,v31,v17
v_mfma_f32_16x16x32_bf16 v[152:155],a[132:135],a[188:191],v[152:155]
buffer_load_dwordx4 v4,s[8:11],s37 offen lds
v_mfma_f32_16x16x32_bf16 v[156:159],a[136:139],a[184:187],v[156:159]
s_add_u32 m0,s68,38912
v_cvt_pk_bf16_f32 v17,v31,v30
v_accvgpr_write_b32 a229,v17
v_mfma_f32_16x16x32_bf16 v[156:159],a[140:143],a[188:191],v[156:159]
v_accvgpr_read_b32 v25,a201
v_lshlrev_b32 v25,16,v25
v_mfma_f32_16x16x32_bf16 v[216:219],a[144:147],a[184:187],v[216:219]
v_mul_f32 v30,v26,v22
v_fmac_f32 v30,v27,v21
v_mfma_f32_16x16x32_bf16 v[216:219],a[148:151],a[188:191],v[216:219]
buffer_load_dwordx4 v4,s[8:11],s38 offen lds
v_mfma_f32_16x16x32_bf16 v[220:223],a[152:155],a[184:187],v[220:223]
s_waitcnt vmcnt(17)
s_add_u32 m0,s68,39936
v_fmac_f32 v30,v24,v20
v_mfma_f32_16x16x32_bf16 v[220:223],a[156:159],a[188:191],v[220:223]
s_barrier
v_fmac_f32 v30,v25,v19
v_accvgpr_read_b32 v17,a210
s_waitcnt lgkmcnt(2)
v_mfma_f32_16x16x32_bf16 v[32:35],a[96:99],a[160:163],v[32:35]
ds_read_b64_tr_b16 a[168:169],v13 offset:8192
v_lshlrev_b32 v17,16,v17
s_waitcnt lgkmcnt(1)
v_mfma_f32_16x16x32_bf16 v[32:35],a[100:103],a[164:167],v[32:35]
ds_read_b64_tr_b16 a[170:171],v13 offset:10240
v_mul_f32 v30,v30,v17
v_mfma_f32_16x16x32_bf16 v[36:39],a[104:107],a[160:163],v[36:39]
ds_read_b64_tr_b16 a[172:173],v13 offset:12288
v_cvt_pk_bf16_f32 v17,v30,v31
v_mfma_f32_16x16x32_bf16 v[36:39],a[108:111],a[164:167],v[36:39]
ds_read_b64_tr_b16 a[174:175],v13 offset:14336
v_accvgpr_write_b32 a225,v17
v_mfma_f32_16x16x32_bf16 v[96:99],a[112:115],a[160:163],v[96:99]
s_lshl_b32 s56,s80,14
ds_read_b128 a[32:35],v2 offset:0
v_mfma_f32_16x16x32_bf16 v[96:99],a[116:119],a[164:167],v[96:99]
buffer_load_dwordx4 v4,s[8:11],s39 offen lds
v_mfma_f32_16x16x32_bf16 v[100:103],a[120:123],a[160:163],v[100:103]
s_lshl_b32 s57,s80,14
ds_read_b128 a[36:39],v3 offset:0
v_mfma_f32_16x16x32_bf16 v[100:103],a[124:127],a[164:167],v[100:103]
s_add_u32 s57,s57,8192
s_add_u32 m0,s68,98304
v_accvgpr_read_b32 v26,a202
v_mfma_f32_16x16x32_bf16 v[160:163],a[128:131],a[160:163],v[160:163]
s_lshl_b32 s58,s81,14
ds_read_b128 a[40:43],v2 offset:2048
v_mfma_f32_16x16x32_bf16 v[160:163],a[132:135],a[164:167],v[160:163]
s_lshl_b32 s59,s81,14
v_add_u32 v5,524288,v5
v_lshlrev_b32 v26,16,v26
v_mfma_f32_16x16x32_bf16 v[164:167],a[136:139],a[160:163],v[164:167]
s_add_u32 s59,s59,8192
ds_read_b128 a[44:47],v3 offset:2048
v_mfma_f32_16x16x32_bf16 v[164:167],a[140:143],a[164:167],v[164:167]
buffer_load_dwordx4 v5,s[12:15],s40 offen nt lds
v_mfma_f32_16x16x32_bf16 v[224:227],a[144:147],a[160:163],v[224:227]
s_lshl_b32 s60,s82,14
ds_read_b128 a[48:51],v2 offset:4096
v_mfma_f32_16x16x32_bf16 v[224:227],a[148:151],a[164:167],v[224:227]
s_lshl_b32 s61,s82,14
s_add_u32 m0,s68,99328
v_mul_f32 v31,v27,v22
v_mfma_f32_16x16x32_bf16 v[228:231],a[152:155],a[160:163],v[228:231]
s_add_u32 s61,s61,8192
ds_read_b128 a[52:55],v3 offset:4096
v_mfma_f32_16x16x32_bf16 v[228:231],a[156:159],a[164:167],v[228:231]
buffer_load_dwordx4 v5,s[12:15],s41 offen nt lds
s_waitcnt lgkmcnt(8)
v_mfma_f32_16x16x32_bf16 v[40:43],a[96:99],a[168:171],v[40:43]
s_lshl_b32 s62,s83,14
ds_read_b64_tr_b16 a[176:177],v14 offset:8192
s_waitcnt lgkmcnt(7)
v_mfma_f32_16x16x32_bf16 v[40:43],a[100:103],a[172:175],v[40:43]
s_lshl_b32 s63,s83,14
ds_read_b64_tr_b16 a[178:179],v14 offset:10240
v_mfma_f32_16x16x32_bf16 v[44:47],a[104:107],a[168:171],v[44:47]
s_add_u32 s63,s63,8192
ds_read_b64_tr_b16 a[180:181],v14 offset:12288
v_mfma_f32_16x16x32_bf16 v[44:47],a[108:111],a[172:175],v[44:47]
s_add_u32 s71,s71,896
ds_read_b64_tr_b16 a[182:183],v14 offset:14336
v_mfma_f32_16x16x32_bf16 v[104:107],a[112:115],a[168:171],v[104:107]
s_lshr_b32 s64,s20,1
ds_read_b128 a[56:59],v2 offset:6144
v_mfma_f32_16x16x32_bf16 v[104:107],a[116:119],a[172:175],v[104:107]
s_add_u32 m0,s68,100352
v_fmac_f32 v31,v24,v21
v_fmac_f32 v31,v25,v20
v_mfma_f32_16x16x32_bf16 v[108:111],a[120:123],a[168:171],v[108:111]
buffer_load_dwordx4 v5,s[12:15],s42 offen nt lds
v_mfma_f32_16x16x32_bf16 v[108:111],a[124:127],a[172:175],v[108:111]
s_lshl_b32 s64,s64,18
ds_read_b128 a[60:63],v3 offset:6144
v_mfma_f32_16x16x32_bf16 v[168:171],a[128:131],a[168:171],v[168:171]
s_add_u32 s65,s64,131072
ds_read_b128 a[64:67],v2 offset:8192
v_mfma_f32_16x16x32_bf16 v[168:171],a[132:135],a[172:175],v[168:171]
s_add_u32 s66,s64,32768
s_add_u32 m0,s68,101376
v_fmac_f32 v31,v26,v19
v_mfma_f32_16x16x32_bf16 v[172:175],a[136:139],a[168:171],v[172:175]
s_add_u32 s67,s64,163840
ds_read_b128 a[68:71],v3 offset:8192
v_mfma_f32_16x16x32_bf16 v[172:175],a[140:143],a[172:175],v[172:175]
buffer_load_dwordx4 v5,s[12:15],s43 offen nt lds
v_mfma_f32_16x16x32_bf16 v[232:235],a[144:147],a[168:171],v[232:235]
ds_read_b128 a[72:75],v2 offset:10240
s_add_u32 m0,s68,102400
v_mfma_f32_16x16x32_bf16 v[232:235],a[148:151],a[172:175],v[232:235]
s_waitcnt lgkmcnt(7)
v_accvgpr_read_b32 v17,a211
v_lshlrev_b32 v17,16,v17
v_mfma_f32_16x16x32_bf16 v[236:239],a[152:155],a[168:171],v[236:239]
ds_read_b128 a[76:79],v3 offset:10240
v_mul_f32 v31,v31,v17
v_mfma_f32_16x16x32_bf16 v[236:239],a[156:159],a[172:175],v[236:239]
buffer_load_dwordx4 v5,s[12:15],s44 offen nt lds
v_mfma_f32_16x16x32_bf16 v[48:51],a[96:99],a[176:179],v[48:51]
ds_read_b64_tr_b16 a[184:185],v15 offset:8192
s_add_u32 m0,s68,103424
s_waitcnt lgkmcnt(7)
v_mfma_f32_16x16x32_bf16 v[48:51],a[100:103],a[180:183],v[48:51]
ds_read_b64_tr_b16 a[186:187],v15 offset:10240
v_cvt_pk_bf16_f32 v17,v31,v30
v_mfma_f32_16x16x32_bf16 v[52:55],a[104:107],a[176:179],v[52:55]
ds_read_b64_tr_b16 a[188:189],v15 offset:12288
v_accvgpr_write_b32 a228,v17
v_mfma_f32_16x16x32_bf16 v[52:55],a[108:111],a[180:183],v[52:55]
ds_read_b64_tr_b16 a[190:191],v15 offset:14336
v_accvgpr_read_b32 v27,a203
v_mfma_f32_16x16x32_bf16 v[112:115],a[112:115],a[176:179],v[112:115]
ds_read_b128 a[80:83],v2 offset:12288
v_subrev_u32 v4,s71,v4
v_mfma_f32_16x16x32_bf16 v[112:115],a[116:119],a[180:183],v[112:115]
buffer_load_dwordx4 v5,s[12:15],s45 offen nt lds
v_mfma_f32_16x16x32_bf16 v[116:119],a[120:123],a[176:179],v[116:119]
ds_read_b128 a[84:87],v3 offset:12288
s_add_u32 m0,s68,104448
v_mfma_f32_16x16x32_bf16 v[116:119],a[124:127],a[180:183],v[116:119]
v_lshlrev_b32 v27,16,v27
v_mul_f32 v30,v24,v22
v_mfma_f32_16x16x32_bf16 v[176:179],a[128:131],a[176:179],v[176:179]
ds_read_b128 a[88:91],v2 offset:14336
v_fmac_f32 v30,v25,v21
v_mfma_f32_16x16x32_bf16 v[176:179],a[132:135],a[180:183],v[176:179]
buffer_load_dwordx4 v5,s[12:15],s46 offen nt lds
v_mfma_f32_16x16x32_bf16 v[180:183],a[136:139],a[176:179],v[180:183]
ds_read_b128 a[92:95],v3 offset:14336
s_add_u32 m0,s68,105472
v_mfma_f32_16x16x32_bf16 v[180:183],a[140:143],a[180:183],v[180:183]
v_fmac_f32 v30,v26,v20
v_fmac_f32 v30,v27,v19
v_mfma_f32_16x16x32_bf16 v[240:243],a[144:147],a[176:179],v[240:243]
v_accvgpr_read_b32 v17,a212
v_lshlrev_b32 v17,16,v17
v_mfma_f32_16x16x32_bf16 v[240:243],a[148:151],a[180:183],v[240:243]
buffer_load_dwordx4 v5,s[12:15],s47 offen nt lds
v_mfma_f32_16x16x32_bf16 v[244:247],a[152:155],a[176:179],v[244:247]
v_mul_f32 v30,v30,v17
v_cvt_pk_bf16_f32 v17,v30,v31
v_mfma_f32_16x16x32_bf16 v[244:247],a[156:159],a[180:183],v[244:247]
s_waitcnt lgkmcnt(6)
v_accvgpr_write_b32 a224,v17
v_accvgpr_read_b32 v19,a218
v_mfma_f32_16x16x32_bf16 v[56:59],a[96:99],a[184:187],v[56:59]
s_waitcnt vmcnt(8) lgkmcnt(0)
v_lshlrev_b32 v19,16,v19
v_accvgpr_read_b32 v20,a218
v_mfma_f32_16x16x32_bf16 v[56:59],a[100:103],a[188:191],v[56:59]
s_barrier
v_and_b32 v20,0xffff0000,v20
v_accvgpr_read_b32 v21,a219
v_mfma_f32_16x16x32_bf16 v[60:63],a[104:107],a[184:187],v[60:63]
s_mov_b32 s8,s72
v_subrev_u32 v5,s88,v5
v_lshlrev_b32 v21,16,v21
v_mfma_f32_16x16x32_bf16 v[60:63],a[108:111],a[188:191],v[60:63]
s_and_b32 s9,s73,0xffff
ds_read_b64_tr_b16 a[160:161],v8 offset:0
v_mfma_f32_16x16x32_bf16 v[120:123],a[112:115],a[184:187],v[120:123]
s_mov_b32 s12,s76
s_and_b32 s13,s77,0xffff
v_accvgpr_read_b32 v22,a219
v_mfma_f32_16x16x32_bf16 v[120:123],a[116:119],a[188:191],v[120:123]
s_add_u32 m0,s68,0
ds_read_b64_tr_b16 a[162:163],v8 offset:2048
v_mfma_f32_16x16x32_bf16 v[124:127],a[120:123],a[184:187],v[124:127]
ds_read_b64_tr_b16 a[164:165],v8 offset:4096
v_and_b32 v22,0xffff0000,v22
v_mfma_f32_16x16x32_bf16 v[124:127],a[124:127],a[188:191],v[124:127]
ds_read_b64_tr_b16 a[166:167],v8 offset:6144
v_accvgpr_read_b32 v24,a192
v_mfma_f32_16x16x32_bf16 v[184:187],a[128:131],a[184:187],v[184:187]
buffer_load_dwordx4 v4,s[8:11],s56 offen lds
v_mfma_f32_16x16x32_bf16 v[184:187],a[132:135],a[188:191],v[184:187]
s_add_u32 m0,s68,1024
v_and_b32 v24,0xffff0000,v24
v_accvgpr_read_b32 v25,a193
v_mfma_f32_16x16x32_bf16 v[188:191],a[136:139],a[184:187],v[188:191]
v_and_b32 v25,0xffff0000,v25
v_accvgpr_read_b32 v26,a194
v_mfma_f32_16x16x32_bf16 v[188:191],a[140:143],a[188:191],v[188:191]
v_and_b32 v26,0xffff0000,v26
v_accvgpr_read_b32 v27,a195
v_mfma_f32_16x16x32_bf16 v[248:251],a[144:147],a[184:187],v[248:251]
v_and_b32 v27,0xffff0000,v27
v_mul_f32 v30,v24,v22
v_mfma_f32_16x16x32_bf16 v[248:251],a[148:151],a[188:191],v[248:251]
buffer_load_dwordx4 v4,s[8:11],s57 offen lds
v_mfma_f32_16x16x32_bf16 v[252:255],a[152:155],a[184:187],v[252:255]
s_add_u32 m0,s68,2048
v_fmac_f32 v30,v25,v21
v_fmac_f32 v30,v26,v20
v_mfma_f32_16x16x32_bf16 v[252:255],a[156:159],a[188:191],v[252:255]
s_waitcnt lgkmcnt(0)
v_fmac_f32 v30,v27,v19
v_accvgpr_read_b32 v17,a204
v_mfma_f32_16x16x32_bf16 a[0:3],a[32:35],a[160:163],a[0:3]
ds_read_b64_tr_b16 a[168:169],v9 offset:0
v_and_b32 v17,0xffff0000,v17
v_mfma_f32_16x16x32_bf16 a[0:3],a[36:39],a[164:167],a[0:3]
ds_read_b64_tr_b16 a[170:171],v9 offset:2048
v_mul_f32 v30,v30,v17
v_mfma_f32_16x16x32_bf16 a[4:7],a[40:43],a[160:163],a[4:7]
ds_read_b64_tr_b16 a[172:173],v9 offset:4096
v_accvgpr_read_b32 v24,a196
v_mfma_f32_16x16x32_bf16 a[4:7],a[44:47],a[164:167],a[4:7]
ds_read_b64_tr_b16 a[174:175],v9 offset:6144
v_and_b32 v24,0xffff0000,v24
v_mfma_f32_16x16x32_bf16 v[64:67],a[48:51],a[160:163],v[64:67]
v_mul_f32 v31,v25,v22
v_fmac_f32 v31,v26,v21
v_mfma_f32_16x16x32_bf16 v[64:67],a[52:55],a[164:167],v[64:67]
buffer_load_dwordx4 v4,s[8:11],s58 offen lds
v_mfma_f32_16x16x32_bf16 v[68:71],a[56:59],a[160:163],v[68:71]
s_add_u32 m0,s68,3072
v_fmac_f32 v31,v27,v20
v_fmac_f32 v31,v24,v19
v_mfma_f32_16x16x32_bf16 v[68:71],a[60:63],a[164:167],v[68:71]
ds_read_b128 a[96:99],v2 offset:32768
v_accvgpr_read_b32 v17,a205
v_mfma_f32_16x16x32_bf16 v[128:131],a[64:67],a[160:163],v[128:131]
v_and_b32 v17,0xffff0000,v17
v_mul_f32 v31,v31,v17
v_mfma_f32_16x16x32_bf16 v[128:131],a[68:71],a[164:167],v[128:131]
ds_read_b128 a[100:103],v3 offset:32768
v_cvt_pk_bf16_f32 v17,v31,v30
v_mfma_f32_16x16x32_bf16 v[132:135],a[72:75],a[160:163],v[132:135]
v_accvgpr_write_b32 a239,v17
v_accvgpr_read_b32 v25,a197
v_mfma_f32_16x16x32_bf16 v[132:135],a[76:79],a[164:167],v[132:135]
ds_read_b128 a[104:107],v2 offset:34816
v_and_b32 v25,0xffff0000,v25
v_mfma_f32_16x16x32_bf16 v[192:195],a[80:83],a[160:163],v[192:195]
v_mul_f32 v30,v26,v22
v_fmac_f32 v30,v27,v21
v_mfma_f32_16x16x32_bf16 v[192:195],a[84:87],a[164:167],v[192:195]
buffer_load_dwordx4 v4,s[8:11],s59 offen lds
v_mfma_f32_16x16x32_bf16 v[196:199],a[88:91],a[160:163],v[196:199]
s_add_u32 m0,s68,4096
v_fmac_f32 v30,v24,v20
v_fmac_f32 v30,v25,v19
v_mfma_f32_16x16x32_bf16 v[196:199],a[92:95],a[164:167],v[196:199]
s_waitcnt lgkmcnt(3)
v_accvgpr_read_b32 v17,a206
v_and_b32 v17,0xffff0000,v17
v_mfma_f32_16x16x32_bf16 a[8:11],a[32:35],a[168:171],a[8:11]
ds_read_b64_tr_b16 a[176:177],v10 offset:0
v_mul_f32 v30,v30,v17
v_mfma_f32_16x16x32_bf16 a[8:11],a[36:39],a[172:175],a[8:11]
ds_read_b64_tr_b16 a[178:179],v10 offset:2048
v_cvt_pk_bf16_f32 v17,v30,v31
v_mfma_f32_16x16x32_bf16 a[12:15],a[40:43],a[168:171],a[12:15]
ds_read_b64_tr_b16 a[180:181],v10 offset:4096
v_accvgpr_write_b32 a235,v17
v_mfma_f32_16x16x32_bf16 a[12:15],a[44:47],a[172:175],a[12:15]
ds_read_b64_tr_b16 a[182:183],v10 offset:6144
v_accvgpr_read_b32 v26,a198
v_mfma_f32_16x16x32_bf16 v[72:75],a[48:51],a[168:171],v[72:75]
v_add_u32 v12,s68,v6
v_xor_b32 v13,64,v12
v_mfma_f32_16x16x32_bf16 v[72:75],a[52:55],a[172:175],v[72:75]
buffer_load_dwordx4 v4,s[8:11],s60 offen lds
v_mfma_f32_16x16x32_bf16 v[76:79],a[56:59],a[168:171],v[76:79]
s_add_u32 m0,s68,5120
v_add_u32 v14,65536,v12
v_add_u32 v15,65536,v13
v_mfma_f32_16x16x32_bf16 v[76:79],a[60:63],a[172:175],v[76:79]
ds_read_b128 a[108:111],v3 offset:34816
v_and_b32 v26,0xffff0000,v26
v_mfma_f32_16x16x32_bf16 v[136:139],a[64:67],a[168:171],v[136:139]
v_mul_f32 v31,v27,v22
v_fmac_f32 v31,v24,v21
v_mfma_f32_16x16x32_bf16 v[136:139],a[68:71],a[172:175],v[136:139]
ds_read_b128 a[112:115],v2 offset:36864
v_fmac_f32 v31,v25,v20
v_mfma_f32_16x16x32_bf16 v[140:143],a[72:75],a[168:171],v[140:143]
v_fmac_f32 v31,v26,v19
v_accvgpr_read_b32 v17,a207
v_mfma_f32_16x16x32_bf16 v[140:143],a[76:79],a[172:175],v[140:143]
ds_read_b128 a[116:119],v3 offset:36864
v_and_b32 v17,0xffff0000,v17
v_mfma_f32_16x16x32_bf16 v[200:203],a[80:83],a[168:171],v[200:203]
v_mul_f32 v31,v31,v17
v_cvt_pk_bf16_f32 v17,v31,v30
v_mfma_f32_16x16x32_bf16 v[200:203],a[84:87],a[172:175],v[200:203]
buffer_load_dwordx4 v4,s[8:11],s61 offen lds
v_mfma_f32_16x16x32_bf16 v[204:207],a[88:91],a[168:171],v[204:207]
s_add_u32 m0,s68,6144
v_accvgpr_write_b32 a238,v17
v_accvgpr_read_b32 v27,a199
v_mfma_f32_16x16x32_bf16 v[204:207],a[92:95],a[172:175],v[204:207]
s_waitcnt lgkmcnt(3)
v_and_b32 v27,0xffff0000,v27
v_mul_f32 v30,v24,v22
v_mfma_f32_16x16x32_bf16 a[16:19],a[32:35],a[176:179],a[16:19]
ds_read_b64_tr_b16 a[184:185],v11 offset:0
v_fmac_f32 v30,v25,v21
v_mfma_f32_16x16x32_bf16 a[16:19],a[36:39],a[180:183],a[16:19]
ds_read_b64_tr_b16 a[186:187],v11 offset:2048
v_fmac_f32 v30,v26,v20
v_mfma_f32_16x16x32_bf16 a[20:23],a[40:43],a[176:179],a[20:23]
ds_read_b64_tr_b16 a[188:189],v11 offset:4096
v_fmac_f32 v30,v27,v19
v_mfma_f32_16x16x32_bf16 a[20:23],a[44:47],a[180:183],a[20:23]
ds_read_b64_tr_b16 a[190:191],v11 offset:6144
v_accvgpr_read_b32 v17,a208
v_mfma_f32_16x16x32_bf16 v[80:83],a[48:51],a[176:179],v[80:83]
v_and_b32 v17,0xffff0000,v17
v_mul_f32 v30,v30,v17
v_mfma_f32_16x16x32_bf16 v[80:83],a[52:55],a[180:183],v[80:83]
buffer_load_dwordx4 v4,s[8:11],s62 offen lds
v_mfma_f32_16x16x32_bf16 v[84:87],a[56:59],a[176:179],v[84:87]
s_add_u32 m0,s68,7168
v_cvt_pk_bf16_f32 v17,v30,v31
v_accvgpr_write_b32 a234,v17
v_mfma_f32_16x16x32_bf16 v[84:87],a[60:63],a[180:183],v[84:87]
ds_read_b128 a[120:123],v2 offset:38912
v_accvgpr_read_b32 v24,a200
v_mfma_f32_16x16x32_bf16 v[144:147],a[64:67],a[176:179],v[144:147]
v_and_b32 v24,0xffff0000,v24
v_mul_f32 v31,v25,v22
v_mfma_f32_16x16x32_bf16 v[144:147],a[68:71],a[180:183],v[144:147]
ds_read_b128 a[124:127],v3 offset:38912
v_fmac_f32 v31,v26,v21
v_mfma_f32_16x16x32_bf16 v[148:151],a[72:75],a[176:179],v[148:151]
v_fmac_f32 v31,v27,v20
v_fmac_f32 v31,v24,v19
v_mfma_f32_16x16x32_bf16 v[148:151],a[76:79],a[180:183],v[148:151]
ds_read_b128 a[128:131],v2 offset:40960
v_accvgpr_read_b32 v17,a209
v_mfma_f32_16x16x32_bf16 v[208:211],a[80:83],a[176:179],v[208:211]
v_and_b32 v17,0xffff0000,v17
v_mul_f32 v31,v31,v17
v_mfma_f32_16x16x32_bf16 v[208:211],a[84:87],a[180:183],v[208:211]
buffer_load_dwordx4 v4,s[8:11],s63 offen lds
v_mfma_f32_16x16x32_bf16 v[212:215],a[88:91],a[176:179],v[212:215]
s_getpc_b64 s[28:29]
F_W2:
s_sub_u32 s28,s28,F_W2-F_PC
s_subb_u32 s29,s29,0
v_accvgpr_read_b32 v28,a251
global_load_dword a249,v28,s[28:29]
v_mfma_f32_16x16x32_bf16 v[212:215],a[92:95],a[180:183],v[212:215]
s_add_u32 m0,s69,131072
v_cvt_pk_bf16_f32 v17,v31,v30
v_accvgpr_write_b32 a237,v17
s_waitcnt lgkmcnt(5)
v_mfma_f32_16x16x32_bf16 a[24:27],a[32:35],a[184:187],a[24:27]
ds_read_b64_tr_b16 a[160:161],v8 offset:8192
v_accvgpr_read_b32 v25,a201
s_waitcnt lgkmcnt(4)
v_mfma_f32_16x16x32_bf16 a[24:27],a[36:39],a[188:191],a[24:27]
ds_read_b64_tr_b16 a[162:163],v8 offset:10240
v_and_b32 v25,0xffff0000,v25
v_mfma_f32_16x16x32_bf16 a[28:31],a[40:43],a[184:187],a[28:31]
ds_read_b64_tr_b16 a[164:165],v8 offset:12288
v_mul_f32 v30,v26,v22
v_mfma_f32_16x16x32_bf16 a[28:31],a[44:47],a[188:191],a[28:31]
ds_read_b64_tr_b16 a[166:167],v8 offset:14336
v_fmac_f32 v30,v27,v21
v_mfma_f32_16x16x32_bf16 v[88:91],a[48:51],a[184:187],v[88:91]
v_fmac_f32 v30,v24,v20
v_fmac_f32 v30,v25,v19
v_mfma_f32_16x16x32_bf16 v[88:91],a[52:55],a[188:191],v[88:91]
buffer_load_dwordx4 v5,s[12:15],s64 offen lds
v_mfma_f32_16x16x32_bf16 v[92:95],a[56:59],a[184:187],v[92:95]
s_add_u32 m0,s69,132096
v_accvgpr_read_b32 v17,a210
v_and_b32 v17,0xffff0000,v17
v_mfma_f32_16x16x32_bf16 v[92:95],a[60:63],a[188:191],v[92:95]
ds_read_b128 a[132:135],v3 offset:40960
v_mul_f32 v30,v30,v17
v_mfma_f32_16x16x32_bf16 v[152:155],a[64:67],a[184:187],v[152:155]
v_cvt_pk_bf16_f32 v17,v30,v31
v_accvgpr_write_b32 a233,v17
v_mfma_f32_16x16x32_bf16 v[152:155],a[68:71],a[188:191],v[152:155]
ds_read_b128 a[136:139],v2 offset:43008
v_accvgpr_read_b32 v26,a202
v_mfma_f32_16x16x32_bf16 v[156:159],a[72:75],a[184:187],v[156:159]
v_and_b32 v26,0xffff0000,v26
v_mul_f32 v31,v27,v22
v_mfma_f32_16x16x32_bf16 v[156:159],a[76:79],a[188:191],v[156:159]
ds_read_b128 a[140:143],v3 offset:43008
v_fmac_f32 v31,v24,v21
v_mfma_f32_16x16x32_bf16 v[216:219],a[80:83],a[184:187],v[216:219]
v_fmac_f32 v31,v25,v20
v_fmac_f32 v31,v26,v19
v_mfma_f32_16x16x32_bf16 v[216:219],a[84:87],a[188:191],v[216:219]
buffer_load_dwordx4 v5,s[12:15],s65 offen lds
v_mfma_f32_16x16x32_bf16 v[220:223],a[88:91],a[184:187],v[220:223]
s_add_u32 m0,s69,133120
v_accvgpr_read_b32 v17,a211
v_and_b32 v17,0xffff0000,v17
v_mfma_f32_16x16x32_bf16 v[220:223],a[92:95],a[188:191],v[220:223]
s_waitcnt lgkmcnt(3)
v_mul_f32 v31,v31,v17
v_cvt_pk_bf16_f32 v17,v31,v30
v_mfma_f32_16x16x32_bf16 v[32:35],a[32:35],a[160:163],v[32:35]
ds_read_b64_tr_b16 a[168:169],v9 offset:8192
v_accvgpr_write_b32 a236,v17
v_mfma_f32_16x16x32_bf16 v[32:35],a[36:39],a[164:167],v[32:35]
ds_read_b64_tr_b16 a[170:171],v9 offset:10240
v_accvgpr_read_b32 v27,a203
v_mfma_f32_16x16x32_bf16 v[36:39],a[40:43],a[160:163],v[36:39]
ds_read_b64_tr_b16 a[172:173],v9 offset:12288
v_and_b32 v27,0xffff0000,v27
v_mfma_f32_16x16x32_bf16 v[36:39],a[44:47],a[164:167],v[36:39]
ds_read_b64_tr_b16 a[174:175],v9 offset:14336
v_mul_f32 v30,v24,v22
v_mfma_f32_16x16x32_bf16 v[96:99],a[48:51],a[160:163],v[96:99]
v_fmac_f32 v30,v25,v21
v_fmac_f32 v30,v26,v20
v_mfma_f32_16x16x32_bf16 v[96:99],a[52:55],a[164:167],v[96:99]
buffer_load_dwordx4 v5,s[12:15],s66 offen lds
v_mfma_f32_16x16x32_bf16 v[100:103],a[56:59],a[160:163],v[100:103]
s_add_u32 m0,s69,134144
v_fmac_f32 v30,v27,v19
v_accvgpr_read_b32 v17,a212
v_mfma_f32_16x16x32_bf16 v[100:103],a[60:63],a[164:167],v[100:103]
ds_read_b128 a[144:147],v2 offset:45056
v_and_b32 v17,0xffff0000,v17
v_mfma_f32_16x16x32_bf16 v[160:163],a[64:67],a[160:163],v[160:163]
v_mul_f32 v30,v30,v17
v_cvt_pk_bf16_f32 v17,v30,v31
v_mfma_f32_16x16x32_bf16 v[160:163],a[68:71],a[164:167],v[160:163]
ds_read_b128 a[148:151],v3 offset:45056
v_accvgpr_write_b32 a232,v17
v_mfma_f32_16x16x32_bf16 v[164:167],a[72:75],a[160:163],v[164:167]
v_and_b32 v24,31,v7
v_lshrrev_b32 v25,5,v7
v_mfma_f32_16x16x32_bf16 v[164:167],a[76:79],a[164:167],v[164:167]
ds_read_b128 a[152:155],v2 offset:47104
s_lshl_b32 s24,s20,1
v_mfma_f32_16x16x32_bf16 v[224:227],a[80:83],a[160:163],v[224:227]
s_sub_u32 s24,7,s24
v_sub_u32 v25,s24,v25
v_xor_b32 v25,v25,v24
v_mfma_f32_16x16x32_bf16 v[224:227],a[84:87],a[164:167],v[224:227]
buffer_load_dwordx4 v5,s[12:15],s67 offen lds
v_mfma_f32_16x16x32_bf16 v[228:231],a[88:91],a[160:163],v[228:231]
s_add_u32 m0,s69,147456
v_and_b32 v25,7,v25
v_lshlrev_b32 v24,9,v24
v_mfma_f32_16x16x32_bf16 v[228:231],a[92:95],a[164:167],v[228:231]
s_waitcnt lgkmcnt(3)
v_lshl_add_u32 v24,v25,4,v24
v_add_u32 v20,114688,v24
v_mfma_f32_16x16x32_bf16 v[40:43],a[32:35],a[168:171],v[40:43]
ds_read_b64_tr_b16 a[176:177],v10 offset:8192
v_lshrrev_b32 v25,3,v7
v_mfma_f32_16x16x32_bf16 v[40:43],a[36:39],a[172:175],v[40:43]
ds_read_b64_tr_b16 a[178:179],v10 offset:10240
s_lshl_b32 s24,s20,3
v_mfma_f32_16x16x32_bf16 v[44:47],a[40:43],a[168:171],v[44:47]
ds_read_b64_tr_b16 a[180:181],v10 offset:12288
v_add_u32 v26,s24,v25
v_mfma_f32_16x16x32_bf16 v[44:47],a[44:47],a[172:175],v[44:47]
ds_read_b64_tr_b16 a[182:183],v10 offset:14336
v_add_u32 v5,524288,v5
v_mfma_f32_16x16x32_bf16 v[104:107],a[48:51],a[168:171],v[104:107]
v_xor_b32 v25,v25,v7
v_and_b32 v25,7,v25
v_mfma_f32_16x16x32_bf16 v[104:107],a[52:55],a[172:175],v[104:107]
buffer_load_dwordx4 v5,s[12:15],s64 offen lds
v_mfma_f32_16x16x32_bf16 v[108:111],a[56:59],a[168:171],v[108:111]
s_add_u32 m0,s69,148480
v_lshlrev_b32 v21,9,v26
v_lshl_add_u32 v21,v25,4,v21
v_mfma_f32_16x16x32_bf16 v[108:111],a[60:63],a[172:175],v[108:111]
ds_read_b128 a[156:159],v3 offset:47104
v_add_u32 v21,114688,v21
v_mfma_f32_16x16x32_bf16 v[168:171],a[64:67],a[168:171],v[168:171]
s_and_b32 s24,s2,7
s_lshl_b32 s24,s24,5
v_add_u32 v26,s24,v26
v_mfma_f32_16x16x32_bf16 v[168:171],a[68:71],a[172:175],v[168:171]
v_lshlrev_b32 v22,14,v26
v_and_b32 v25,7,v7
v_mfma_f32_16x16x32_bf16 v[172:175],a[72:75],a[168:171],v[172:175]
v_lshl_add_u32 v22,v25,4,v22
s_lshr_b32 s24,s2,3
v_mfma_f32_16x16x32_bf16 v[172:175],a[76:79],a[172:175],v[172:175]
s_sub_u32 s24,31,s24
s_lshl_b32 s24,s24,7
s_add_u32 s24,s24,50331648
v_mfma_f32_16x16x32_bf16 v[232:235],a[80:83],a[168:171],v[232:235]
v_add_u32 v22,s24,v22
v_mfma_f32_16x16x32_bf16 v[232:235],a[84:87],a[172:175],v[232:235]
buffer_load_dwordx4 v5,s[12:15],s65 offen lds
v_mfma_f32_16x16x32_bf16 v[236:239],a[88:91],a[168:171],v[236:239]
s_add_u32 m0,s69,149504
v_mfma_f32_16x16x32_bf16 v[236:239],a[92:95],a[172:175],v[236:239]
s_waitcnt lgkmcnt(1)
v_mfma_f32_16x16x32_bf16 v[48:51],a[32:35],a[176:179],v[48:51]
ds_read_b64_tr_b16 a[184:185],v11 offset:8192
v_mfma_f32_16x16x32_bf16 v[48:51],a[36:39],a[180:183],v[48:51]
ds_read_b64_tr_b16 a[186:187],v11 offset:10240
v_mfma_f32_16x16x32_bf16 v[52:55],a[40:43],a[176:179],v[52:55]
ds_read_b64_tr_b16 a[188:189],v11 offset:12288
v_mfma_f32_16x16x32_bf16 v[52:55],a[44:47],a[180:183],v[52:55]
ds_read_b64_tr_b16 a[190:191],v11 offset:14336
v_mfma_f32_16x16x32_bf16 v[112:115],a[48:51],a[176:179],v[112:115]
v_mfma_f32_16x16x32_bf16 v[112:115],a[52:55],a[180:183],v[112:115]
buffer_load_dwordx4 v5,s[12:15],s66 offen lds
v_mfma_f32_16x16x32_bf16 v[116:119],a[56:59],a[176:179],v[116:119]
s_add_u32 m0,s69,150528
v_mfma_f32_16x16x32_bf16 v[116:119],a[60:63],a[180:183],v[116:119]
v_mfma_f32_16x16x32_bf16 v[176:179],a[64:67],a[176:179],v[176:179]
v_mfma_f32_16x16x32_bf16 v[176:179],a[68:71],a[180:183],v[176:179]
v_mfma_f32_16x16x32_bf16 v[180:183],a[72:75],a[176:179],v[180:183]
v_mfma_f32_16x16x32_bf16 v[180:183],a[76:79],a[180:183],v[180:183]
v_mfma_f32_16x16x32_bf16 v[240:243],a[80:83],a[176:179],v[240:243]
v_mfma_f32_16x16x32_bf16 v[240:243],a[84:87],a[180:183],v[240:243]
buffer_load_dwordx4 v5,s[12:15],s67 offen lds
v_mfma_f32_16x16x32_bf16 v[244:247],a[88:91],a[176:179],v[244:247]
v_mfma_f32_16x16x32_bf16 v[244:247],a[92:95],a[180:183],v[244:247]
s_waitcnt lgkmcnt(2)
v_mfma_f32_16x16x32_bf16 v[56:59],a[32:35],a[184:187],v[56:59]
s_waitcnt vmcnt(17) lgkmcnt(0)
v_mfma_f32_16x16x32_bf16 v[56:59],a[36:39],a[188:191],v[56:59]
s_barrier
v_mfma_f32_16x16x32_bf16 v[60:63],a[40:43],a[184:187],v[60:63]
ds_read_b64_tr_b16 a[160:161],v8 offset:32768
v_mfma_f32_16x16x32_bf16 v[60:63],a[44:47],a[188:191],v[60:63]
ds_read_b64_tr_b16 a[162:163],v8 offset:34816
v_mfma_f32_16x16x32_bf16 v[120:123],a[48:51],a[184:187],v[120:123]
ds_read_b64_tr_b16 a[164:165],v8 offset:36864
v_mfma_f32_16x16x32_bf16 v[120:123],a[52:55],a[188:191],v[120:123]
s_add_u32 m0,s68,32768
v_add_u32 v4,128,v4
v_mfma_f32_16x16x32_bf16 v[124:127],a[56:59],a[184:187],v[124:127]
ds_read_b64_tr_b16 a[166:167],v8 offset:38912
v_mfma_f32_16x16x32_bf16 v[124:127],a[60:63],a[188:191],v[124:127]
buffer_load_dwordx4 v4,s[8:11],s56 offen lds
v_mfma_f32_16x16x32_bf16 v[184:187],a[64:67],a[184:187],v[184:187]
s_add_u32 m0,s68,33792
v_mfma_f32_16x16x32_bf16 v[184:187],a[68:71],a[188:191],v[184:187]
v_mfma_f32_16x16x32_bf16 v[188:191],a[72:75],a[184:187],v[188:191]
v_mfma_f32_16x16x32_bf16 v[188:191],a[76:79],a[188:191],v[188:191]
v_mfma_f32_16x16x32_bf16 v[248:251],a[80:83],a[184:187],v[248:251]
v_mfma_f32_16x16x32_bf16 v[248:251],a[84:87],a[188:191],v[248:251]
buffer_load_dwordx4 v4,s[8:11],s57 offen lds
v_mfma_f32_16x16x32_bf16 v[252:255],a[88:91],a[184:187],v[252:255]
s_add_u32 m0,s68,34816
v_mfma_f32_16x16x32_bf16 v[252:255],a[92:95],a[188:191],v[252:255]
s_waitcnt lgkmcnt(0)
v_mfma_f32_16x16x32_bf16 a[0:3],a[96:99],a[160:163],a[0:3]
ds_read_b64_tr_b16 a[168:169],v9 offset:32768
v_mfma_f32_16x16x32_bf16 a[0:3],a[100:103],a[164:167],a[0:3]
ds_read_b64_tr_b16 a[170:171],v9 offset:34816
v_mfma_f32_16x16x32_bf16 a[4:7],a[104:107],a[160:163],a[4:7]
ds_read_b64_tr_b16 a[172:173],v9 offset:36864
v_mfma_f32_16x16x32_bf16 a[4:7],a[108:111],a[164:167],a[4:7]
ds_read_b64_tr_b16 a[174:175],v9 offset:38912
v_mfma_f32_16x16x32_bf16 v[64:67],a[112:115],a[160:163],v[64:67]
v_mfma_f32_16x16x32_bf16 v[64:67],a[116:119],a[164:167],v[64:67]
buffer_load_dwordx4 v4,s[8:11],s58 offen lds
v_mfma_f32_16x16x32_bf16 v[68:71],a[120:123],a[160:163],v[68:71]
s_add_u32 m0,s68,35840
v_mfma_f32_16x16x32_bf16 v[68:71],a[124:127],a[164:167],v[68:71]
v_mfma_f32_16x16x32_bf16 v[128:131],a[128:131],a[160:163],v[128:131]
v_accvgpr_read_b32 v24,a0
v_accvgpr_read_b32 v25,a1
v_mfma_f32_16x16x32_bf16 v[128:131],a[132:135],a[164:167],v[128:131]
v_accvgpr_read_b32 v26,a2
v_accvgpr_read_b32 v27,a3
v_mfma_f32_16x16x32_bf16 v[132:135],a[136:139],a[160:163],v[132:135]
v_accvgpr_read_b32 v28,a4
v_accvgpr_read_b32 v29,a5
v_mfma_f32_16x16x32_bf16 v[132:135],a[140:143],a[164:167],v[132:135]
v_accvgpr_read_b32 v30,a6
v_accvgpr_read_b32 v31,a7
v_mfma_f32_16x16x32_bf16 v[192:195],a[144:147],a[160:163],v[192:195]
v_cvt_pk_bf16_f32 v24,v24,v25
v_cvt_pk_bf16_f32 v25,v26,v27
v_mfma_f32_16x16x32_bf16 v[192:195],a[148:151],a[164:167],v[192:195]
buffer_load_dwordx4 v4,s[8:11],s59 offen lds
v_mfma_f32_16x16x32_bf16 v[196:199],a[152:155],a[160:163],v[196:199]
s_add_u32 m0,s68,36864
v_cvt_pk_bf16_f32 v26,v28,v29
v_cvt_pk_bf16_f32 v27,v30,v31
v_mfma_f32_16x16x32_bf16 v[196:199],a[156:159],a[164:167],v[196:199]
buffer_store_dwordx4 v[24:27],v1,s[16:19],s48 offen offset:0 sc1
s_waitcnt lgkmcnt(2)
v_mfma_f32_16x16x32_bf16 a[8:11],a[96:99],a[168:171],a[8:11]
ds_read_b64_tr_b16 a[176:177],v10 offset:32768
v_cvt_pk_bf16_f32 v64,v64,v65
s_waitcnt lgkmcnt(1)
v_mfma_f32_16x16x32_bf16 a[8:11],a[100:103],a[172:175],a[8:11]
ds_read_b64_tr_b16 a[178:179],v10 offset:34816
v_cvt_pk_bf16_f32 v65,v66,v67
v_mfma_f32_16x16x32_bf16 a[12:15],a[104:107],a[168:171],a[12:15]
ds_read_b64_tr_b16 a[180:181],v10 offset:36864
v_cvt_pk_bf16_f32 v66,v68,v69
v_mfma_f32_16x16x32_bf16 a[12:15],a[108:111],a[172:175],a[12:15]
ds_read_b64_tr_b16 a[182:183],v10 offset:38912
v_cvt_pk_bf16_f32 v67,v70,v71
v_mfma_f32_16x16x32_bf16 v[72:75],a[112:115],a[168:171],v[72:75]
v_cvt_pk_bf16_f32 v128,v128,v129
v_cvt_pk_bf16_f32 v129,v130,v131
v_mfma_f32_16x16x32_bf16 v[72:75],a[116:119],a[172:175],v[72:75]
buffer_load_dwordx4 v4,s[8:11],s60 offen lds
v_mfma_f32_16x16x32_bf16 v[76:79],a[120:123],a[168:171],v[76:79]
s_add_u32 m0,s68,37888
v_cvt_pk_bf16_f32 v130,v132,v133
v_cvt_pk_bf16_f32 v131,v134,v135
v_mfma_f32_16x16x32_bf16 v[76:79],a[124:127],a[172:175],v[76:79]
v_cvt_pk_bf16_f32 v192,v192,v193
v_cvt_pk_bf16_f32 v193,v194,v195
v_mfma_f32_16x16x32_bf16 v[136:139],a[128:131],a[168:171],v[136:139]
v_cvt_pk_bf16_f32 v194,v196,v197
v_cvt_pk_bf16_f32 v195,v198,v199
v_mfma_f32_16x16x32_bf16 v[136:139],a[132:135],a[172:175],v[136:139]
v_accvgpr_read_b32 v24,a8
v_accvgpr_read_b32 v25,a9
v_mfma_f32_16x16x32_bf16 v[140:143],a[136:139],a[168:171],v[140:143]
v_accvgpr_read_b32 v26,a10
v_accvgpr_read_b32 v27,a11
v_mfma_f32_16x16x32_bf16 v[140:143],a[140:143],a[172:175],v[140:143]
v_accvgpr_read_b32 v28,a12
v_accvgpr_read_b32 v29,a13
v_mfma_f32_16x16x32_bf16 v[200:203],a[144:147],a[168:171],v[200:203]
v_accvgpr_read_b32 v30,a14
v_accvgpr_read_b32 v31,a15
v_mfma_f32_16x16x32_bf16 v[200:203],a[148:151],a[172:175],v[200:203]
buffer_load_dwordx4 v4,s[8:11],s61 offen lds
v_mfma_f32_16x16x32_bf16 v[204:207],a[152:155],a[168:171],v[204:207]
s_add_u32 m0,s68,38912
v_cvt_pk_bf16_f32 v24,v24,v25
v_cvt_pk_bf16_f32 v25,v26,v27
v_mfma_f32_16x16x32_bf16 v[204:207],a[156:159],a[172:175],v[204:207]
s_waitcnt lgkmcnt(0)
v_cvt_pk_bf16_f32 v26,v28,v29
v_cvt_pk_bf16_f32 v27,v30,v31
v_mfma_f32_16x16x32_bf16 a[16:19],a[96:99],a[176:179],a[16:19]
buffer_store_dwordx4 v[24:27],v1,s[16:19],s49 offen offset:0 sc1
v_mfma_f32_16x16x32_bf16 a[16:19],a[100:103],a[180:183],a[16:19]
ds_read_b64_tr_b16 a[184:185],v11 offset:32768
v_cvt_pk_bf16_f32 v72,v72,v73
v_mfma_f32_16x16x32_bf16 a[20:23],a[104:107],a[176:179],a[20:23]
ds_read_b64_tr_b16 a[186:187],v11 offset:34816
v_cvt_pk_bf16_f32 v73,v74,v75
v_mfma_f32_16x16x32_bf16 a[20:23],a[108:111],a[180:183],a[20:23]
ds_read_b64_tr_b16 a[188:189],v11 offset:36864
v_cvt_pk_bf16_f32 v74,v76,v77
v_mfma_f32_16x16x32_bf16 v[80:83],a[112:115],a[176:179],v[80:83]
ds_read_b64_tr_b16 a[190:191],v11 offset:38912
v_cvt_pk_bf16_f32 v75,v78,v79
v_mfma_f32_16x16x32_bf16 v[80:83],a[116:119],a[180:183],v[80:83]
buffer_load_dwordx4 v4,s[8:11],s62 offen lds
v_mfma_f32_16x16x32_bf16 v[84:87],a[120:123],a[176:179],v[84:87]
s_add_u32 m0,s68,39936
v_cvt_pk_bf16_f32 v136,v136,v137
v_cvt_pk_bf16_f32 v137,v138,v139
v_mfma_f32_16x16x32_bf16 v[84:87],a[124:127],a[180:183],v[84:87]
v_cvt_pk_bf16_f32 v138,v140,v141
v_cvt_pk_bf16_f32 v139,v142,v143
v_mfma_f32_16x16x32_bf16 v[144:147],a[128:131],a[176:179],v[144:147]
v_cvt_pk_bf16_f32 v200,v200,v201
v_cvt_pk_bf16_f32 v201,v202,v203
v_mfma_f32_16x16x32_bf16 v[144:147],a[132:135],a[180:183],v[144:147]
v_cvt_pk_bf16_f32 v202,v204,v205
v_cvt_pk_bf16_f32 v203,v206,v207
v_mfma_f32_16x16x32_bf16 v[148:151],a[136:139],a[176:179],v[148:151]
v_accvgpr_read_b32 v24,a16
v_accvgpr_read_b32 v25,a17
v_mfma_f32_16x16x32_bf16 v[148:151],a[140:143],a[180:183],v[148:151]
v_accvgpr_read_b32 v26,a18
v_accvgpr_read_b32 v27,a19
v_mfma_f32_16x16x32_bf16 v[208:211],a[144:147],a[176:179],v[208:211]
v_accvgpr_read_b32 v28,a20
v_accvgpr_read_b32 v29,a21
v_mfma_f32_16x16x32_bf16 v[208:211],a[148:151],a[180:183],v[208:211]
buffer_load_dwordx4 v4,s[8:11],s63 offen lds
v_mfma_f32_16x16x32_bf16 v[212:215],a[152:155],a[176:179],v[212:215]
s_add_u32 m0,s68,65536
v_accvgpr_read_b32 v30,a22
v_accvgpr_read_b32 v31,a23
v_mfma_f32_16x16x32_bf16 v[212:215],a[156:159],a[180:183],v[212:215]
s_waitcnt lgkmcnt(0)
v_cvt_pk_bf16_f32 v24,v24,v25
v_cvt_pk_bf16_f32 v25,v26,v27
v_mfma_f32_16x16x32_bf16 a[24:27],a[96:99],a[184:187],a[24:27]
ds_read_b64_tr_b16 a[160:161],v8 offset:40960
v_cvt_pk_bf16_f32 v26,v28,v29
v_mfma_f32_16x16x32_bf16 a[24:27],a[100:103],a[188:191],a[24:27]
ds_read_b64_tr_b16 a[162:163],v8 offset:43008
v_cvt_pk_bf16_f32 v27,v30,v31
v_mfma_f32_16x16x32_bf16 a[28:31],a[104:107],a[184:187],a[28:31]
buffer_store_dwordx4 v[24:27],v1,s[16:19],s48 offen offset:1024 sc1
v_mfma_f32_16x16x32_bf16 a[28:31],a[108:111],a[188:191],a[28:31]
ds_read_b64_tr_b16 a[164:165],v8 offset:45056
v_add_u32 v4,128,v4
v_mfma_f32_16x16x32_bf16 v[88:91],a[112:115],a[184:187],v[88:91]
ds_read_b64_tr_b16 a[166:167],v8 offset:47104
v_cvt_pk_bf16_f32 v80,v80,v81
v_mfma_f32_16x16x32_bf16 v[88:91],a[116:119],a[188:191],v[88:91]
buffer_load_dwordx4 v4,s[8:11],s56 offen lds
v_mfma_f32_16x16x32_bf16 v[92:95],a[120:123],a[184:187],v[92:95]
s_waitcnt vmcnt(21)
s_add_u32 m0,s68,66560
v_cvt_pk_bf16_f32 v81,v82,v83
v_mfma_f32_16x16x32_bf16 v[92:95],a[124:127],a[188:191],v[92:95]
ds_read_b128 a[32:35],v12 offset:0
v_cvt_pk_bf16_f32 v82,v84,v85
v_mfma_f32_16x16x32_bf16 v[152:155],a[128:131],a[184:187],v[152:155]
v_cvt_pk_bf16_f32 v83,v86,v87
v_cvt_pk_bf16_f32 v144,v144,v145
v_mfma_f32_16x16x32_bf16 v[152:155],a[132:135],a[188:191],v[152:155]
ds_read_b128 a[36:39],v13 offset:0
v_cvt_pk_bf16_f32 v145,v146,v147
v_mfma_f32_16x16x32_bf16 v[156:159],a[136:139],a[184:187],v[156:159]
v_cvt_pk_bf16_f32 v146,v148,v149
v_cvt_pk_bf16_f32 v147,v150,v151
v_mfma_f32_16x16x32_bf16 v[156:159],a[140:143],a[188:191],v[156:159]
ds_read_b128 a[40:43],v12 offset:2048
v_cvt_pk_bf16_f32 v208,v208,v209
v_mfma_f32_16x16x32_bf16 v[216:219],a[144:147],a[184:187],v[216:219]
v_cvt_pk_bf16_f32 v209,v210,v211
v_cvt_pk_bf16_f32 v210,v212,v213
v_mfma_f32_16x16x32_bf16 v[216:219],a[148:151],a[188:191],v[216:219]
buffer_load_dwordx4 v4,s[8:11],s57 offen lds
v_mfma_f32_16x16x32_bf16 v[220:223],a[152:155],a[184:187],v[220:223]
s_add_u32 m0,s68,67584
v_cvt_pk_bf16_f32 v211,v214,v215
v_accvgpr_read_b32 v24,a24
v_mfma_f32_16x16x32_bf16 v[220:223],a[156:159],a[188:191],v[220:223]
s_waitcnt lgkmcnt(3)
v_accvgpr_read_b32 v25,a25
v_accvgpr_read_b32 v26,a26
v_mfma_f32_16x16x32_bf16 v[32:35],a[96:99],a[160:163],v[32:35]
ds_read_b64_tr_b16 a[168:169],v9 offset:40960
v_accvgpr_read_b32 v27,a27
v_mfma_f32_16x16x32_bf16 v[32:35],a[100:103],a[164:167],v[32:35]
ds_read_b64_tr_b16 a[170:171],v9 offset:43008
v_accvgpr_read_b32 v28,a28
v_mfma_f32_16x16x32_bf16 v[36:39],a[104:107],a[160:163],v[36:39]
ds_read_b64_tr_b16 a[172:173],v9 offset:45056
v_accvgpr_read_b32 v29,a29
v_mfma_f32_16x16x32_bf16 v[36:39],a[108:111],a[164:167],v[36:39]
ds_read_b64_tr_b16 a[174:175],v9 offset:47104
v_accvgpr_read_b32 v30,a30
v_mfma_f32_16x16x32_bf16 v[96:99],a[112:115],a[160:163],v[96:99]
v_accvgpr_read_b32 v31,a31
v_cvt_pk_bf16_f32 v24,v24,v25
v_mfma_f32_16x16x32_bf16 v[96:99],a[116:119],a[164:167],v[96:99]
buffer_load_dwordx4 v4,s[8:11],s58 offen lds
v_mfma_f32_16x16x32_bf16 v[100:103],a[120:123],a[160:163],v[100:103]
s_add_u32 m0,s68,68608
v_cvt_pk_bf16_f32 v25,v26,v27
v_cvt_pk_bf16_f32 v26,v28,v29
v_mfma_f32_16x16x32_bf16 v[100:103],a[124:127],a[164:167],v[100:103]
ds_read_b128 a[44:47],v13 offset:2048
v_cvt_pk_bf16_f32 v27,v30,v31
v_mfma_f32_16x16x32_bf16 v[160:163],a[128:131],a[160:163],v[160:163]
buffer_store_dwordx4 v[24:27],v1,s[16:19],s49 offen offset:1024 sc1
v_mfma_f32_16x16x32_bf16 v[160:163],a[132:135],a[164:167],v[160:163]
ds_read_b128 a[48:51],v12 offset:4096
v_cvt_pk_bf16_f32 v88,v88,v89
v_mfma_f32_16x16x32_bf16 v[164:167],a[136:139],a[160:163],v[164:167]
v_cvt_pk_bf16_f32 v89,v90,v91
v_cvt_pk_bf16_f32 v90,v92,v93
v_mfma_f32_16x16x32_bf16 v[164:167],a[140:143],a[164:167],v[164:167]
ds_read_b128 a[52:55],v13 offset:4096
v_cvt_pk_bf16_f32 v91,v94,v95
v_mfma_f32_16x16x32_bf16 v[224:227],a[144:147],a[160:163],v[224:227]
v_cvt_pk_bf16_f32 v152,v152,v153
v_cvt_pk_bf16_f32 v153,v154,v155
v_mfma_f32_16x16x32_bf16 v[224:227],a[148:151],a[164:167],v[224:227]
buffer_load_dwordx4 v4,s[8:11],s59 offen lds
v_mfma_f32_16x16x32_bf16 v[228:231],a[152:155],a[160:163],v[228:231]
s_add_u32 m0,s68,69632
v_cvt_pk_bf16_f32 v154,v156,v157
v_cvt_pk_bf16_f32 v155,v158,v159
v_mfma_f32_16x16x32_bf16 v[228:231],a[156:159],a[164:167],v[228:231]
s_waitcnt lgkmcnt(3)
v_cvt_pk_bf16_f32 v216,v216,v217
v_cvt_pk_bf16_f32 v217,v218,v219
v_mfma_f32_16x16x32_bf16 v[40:43],a[96:99],a[168:171],v[40:43]
ds_read_b64_tr_b16 a[176:177],v10 offset:40960
v_cvt_pk_bf16_f32 v218,v220,v221
v_mfma_f32_16x16x32_bf16 v[40:43],a[100:103],a[172:175],v[40:43]
ds_read_b64_tr_b16 a[178:179],v10 offset:43008
v_cvt_pk_bf16_f32 v219,v222,v223
v_mfma_f32_16x16x32_bf16 v[44:47],a[104:107],a[168:171],v[44:47]
ds_read_b64_tr_b16 a[180:181],v10 offset:45056
v_cvt_pk_bf16_f32 v32,v32,v33
v_mfma_f32_16x16x32_bf16 v[44:47],a[108:111],a[172:175],v[44:47]
ds_read_b64_tr_b16 a[182:183],v10 offset:47104
v_cvt_pk_bf16_f32 v33,v34,v35
v_mfma_f32_16x16x32_bf16 v[104:107],a[112:115],a[168:171],v[104:107]
v_cvt_pk_bf16_f32 v34,v36,v37
v_cvt_pk_bf16_f32 v35,v38,v39
v_mfma_f32_16x16x32_bf16 v[104:107],a[116:119],a[172:175],v[104:107]
buffer_store_dwordx4 v[32:35],v1,s[16:19],s48 offen offset:2048 sc1
v_mfma_f32_16x16x32_bf16 v[108:111],a[120:123],a[168:171],v[108:111]
buffer_load_dwordx4 v4,s[8:11],s60 offen lds
v_mfma_f32_16x16x32_bf16 v[108:111],a[124:127],a[172:175],v[108:111]
ds_read_b128 a[56:59],v12 offset:6144
s_add_u32 m0,s68,70656
v_mfma_f32_16x16x32_bf16 v[168:171],a[128:131],a[168:171],v[168:171]
v_cvt_pk_bf16_f32 v96,v96,v97
v_cvt_pk_bf16_f32 v97,v98,v99
v_mfma_f32_16x16x32_bf16 v[168:171],a[132:135],a[172:175],v[168:171]
ds_read_b128 a[60:63],v13 offset:6144
v_cvt_pk_bf16_f32 v98,v100,v101
v_mfma_f32_16x16x32_bf16 v[172:175],a[136:139],a[168:171],v[172:175]
v_cvt_pk_bf16_f32 v99,v102,v103
v_cvt_pk_bf16_f32 v160,v160,v161
v_mfma_f32_16x16x32_bf16 v[172:175],a[140:143],a[172:175],v[172:175]
v_cvt_pk_bf16_f32 v161,v162,v163
v_cvt_pk_bf16_f32 v162,v164,v165
v_mfma_f32_16x16x32_bf16 v[232:235],a[144:147],a[168:171],v[232:235]
v_cvt_pk_bf16_f32 v163,v166,v167
v_cvt_pk_bf16_f32 v224,v224,v225
v_mfma_f32_16x16x32_bf16 v[232:235],a[148:151],a[172:175],v[232:235]
buffer_load_dwordx4 v4,s[8:11],s61 offen lds
v_mfma_f32_16x16x32_bf16 v[236:239],a[152:155],a[168:171],v[236:239]
s_add_u32 m0,s68,71680
v_cvt_pk_bf16_f32 v225,v226,v227
v_cvt_pk_bf16_f32 v226,v228,v229
v_mfma_f32_16x16x32_bf16 v[236:239],a[156:159],a[172:175],v[236:239]
s_waitcnt lgkmcnt(2)
v_cvt_pk_bf16_f32 v227,v230,v231
v_cvt_pk_bf16_f32 v40,v40,v41
v_mfma_f32_16x16x32_bf16 v[48:51],a[96:99],a[176:179],v[48:51]
ds_read_b64_tr_b16 a[184:185],v11 offset:40960
v_cvt_pk_bf16_f32 v41,v42,v43
v_mfma_f32_16x16x32_bf16 v[48:51],a[100:103],a[180:183],v[48:51]
ds_read_b64_tr_b16 a[186:187],v11 offset:43008
v_cvt_pk_bf16_f32 v42,v44,v45
v_mfma_f32_16x16x32_bf16 v[52:55],a[104:107],a[176:179],v[52:55]
ds_read_b64_tr_b16 a[188:189],v11 offset:45056
v_cvt_pk_bf16_f32 v43,v46,v47
v_mfma_f32_16x16x32_bf16 v[52:55],a[108:111],a[180:183],v[52:55]
buffer_store_dwordx4 v[40:43],v1,s[16:19],s49 offen offset:2048 sc1
v_mfma_f32_16x16x32_bf16 v[112:115],a[112:115],a[176:179],v[112:115]
ds_read_b64_tr_b16 a[190:191],v11 offset:47104
v_cvt_pk_bf16_f32 v104,v104,v105
v_mfma_f32_16x16x32_bf16 v[112:115],a[116:119],a[180:183],v[112:115]
buffer_load_dwordx4 v4,s[8:11],s62 offen lds
v_mfma_f32_16x16x32_bf16 v[116:119],a[120:123],a[176:179],v[116:119]
s_add_u32 m0,s68,72704
v_cvt_pk_bf16_f32 v105,v106,v107
v_cvt_pk_bf16_f32 v106,v108,v109
v_mfma_f32_16x16x32_bf16 v[116:119],a[124:127],a[180:183],v[116:119]
v_cvt_pk_bf16_f32 v107,v110,v111
v_mfma_f32_16x16x32_bf16 v[176:179],a[128:131],a[176:179],v[176:179]
v_add_u32 v8,16384,v8
v_add_u32 v9,16384,v9
v_mfma_f32_16x16x32_bf16 v[176:179],a[132:135],a[180:183],v[176:179]
v_add_u32 v10,16384,v10
v_add_u32 v11,16384,v11
v_mfma_f32_16x16x32_bf16 v[180:183],a[136:139],a[176:179],v[180:183]
v_cvt_pk_bf16_f32 v168,v168,v169
v_cvt_pk_bf16_f32 v169,v170,v171
v_mfma_f32_16x16x32_bf16 v[180:183],a[140:143],a[180:183],v[180:183]
v_cvt_pk_bf16_f32 v170,v172,v173
v_cvt_pk_bf16_f32 v171,v174,v175
v_mfma_f32_16x16x32_bf16 v[240:243],a[144:147],a[176:179],v[240:243]
v_cvt_pk_bf16_f32 v232,v232,v233
v_cvt_pk_bf16_f32 v233,v234,v235
v_mfma_f32_16x16x32_bf16 v[240:243],a[148:151],a[180:183],v[240:243]
buffer_load_dwordx4 v4,s[8:11],s63 offen lds
v_mfma_f32_16x16x32_bf16 v[244:247],a[152:155],a[176:179],v[244:247]
v_cvt_pk_bf16_f32 v234,v236,v237
v_cvt_pk_bf16_f32 v235,v238,v239
v_mfma_f32_16x16x32_bf16 v[244:247],a[156:159],a[180:183],v[244:247]
s_waitcnt lgkmcnt(2)
v_cvt_pk_bf16_f32 v48,v48,v49
v_cvt_pk_bf16_f32 v49,v50,v51
v_mfma_f32_16x16x32_bf16 v[56:59],a[96:99],a[184:187],v[56:59]
s_waitcnt vmcnt(12) lgkmcnt(0)
v_cvt_pk_bf16_f32 v50,v52,v53
v_cvt_pk_bf16_f32 v51,v54,v55
v_mfma_f32_16x16x32_bf16 v[56:59],a[100:103],a[188:191],v[56:59]
s_barrier
v_mfma_f32_16x16x32_bf16 v[60:63],a[104:107],a[184:187],v[60:63]
ds_read_b64_tr_b16 a[192:193],v8 offset:32768
v_mfma_f32_16x16x32_bf16 v[60:63],a[108:111],a[188:191],v[60:63]
ds_read_b64_tr_b16 a[194:195],v8 offset:34816
v_mfma_f32_16x16x32_bf16 v[120:123],a[112:115],a[184:187],v[120:123]
ds_read_b64_tr_b16 a[196:197],v8 offset:36864
v_mfma_f32_16x16x32_bf16 v[120:123],a[116:119],a[188:191],v[120:123]
ds_read_b64_tr_b16 a[198:199],v8 offset:38912
v_mfma_f32_16x16x32_bf16 v[124:127],a[120:123],a[184:187],v[124:127]
ds_read_b64_tr_b16 a[200:201],v9 offset:32768
v_mfma_f32_16x16x32_bf16 v[124:127],a[124:127],a[188:191],v[124:127]
ds_read_b64_tr_b16 a[202:203],v9 offset:34816
v_mfma_f32_16x16x32_bf16 v[184:187],a[128:131],a[184:187],v[184:187]
ds_read_b64_tr_b16 a[204:205],v9 offset:36864
v_cvt_pk_bf16_f32 v56,v56,v57
v_mfma_f32_16x16x32_bf16 v[184:187],a[132:135],a[188:191],v[184:187]
ds_read_b64_tr_b16 a[206:207],v9 offset:38912
v_cvt_pk_bf16_f32 v57,v58,v59
v_mfma_f32_16x16x32_bf16 v[188:191],a[136:139],a[184:187],v[188:191]
ds_write_b128 v20,a[224:227] offset:0
v_mfma_f32_16x16x32_bf16 v[188:191],a[140:143],a[188:191],v[188:191]
ds_write_b128 v20,a[228:231] offset:128
v_mfma_f32_16x16x32_bf16 v[248:251],a[144:147],a[184:187],v[248:251]
ds_write_b128 v20,a[232:235] offset:256
v_mfma_f32_16x16x32_bf16 v[248:251],a[148:151],a[188:191],v[248:251]
ds_write_b128 v20,a[236:239] offset:384
v_mfma_f32_16x16x32_bf16 v[252:255],a[152:155],a[184:187],v[252:255]
v_cvt_pk_bf16_f32 v58,v60,v61
v_cvt_pk_bf16_f32 v59,v62,v63
v_mfma_f32_16x16x32_bf16 v[252:255],a[156:159],a[188:191],v[252:255]
F_B:
s_waitcnt lgkmcnt(10)
v_mfma_f32_16x16x32_bf16 a[160:163],a[192:195],a[32:35],0
ds_read_b64_tr_b16 a[208:209],v10 offset:32768
s_waitcnt lgkmcnt(9)
v_mfma_f32_16x16x32_bf16 a[160:163],a[196:199],a[36:39],a[160:163]
ds_read_b64_tr_b16 a[210:211],v10 offset:34816
v_mfma_f32_16x16x32_bf16 a[164:167],a[192:195],a[40:43],0
ds_read_b64_tr_b16 a[212:213],v10 offset:36864
v_mfma_f32_16x16x32_bf16 a[164:167],a[196:199],a[44:47],a[164:167]
s_add_u32 m0,s69,98304
v_add_u32 v5,524288,v5
v_cvt_pk_bf16_f32 v112,v112,v113
v_mfma_f32_16x16x32_bf16 a[168:171],a[192:195],a[48:51],0
ds_read_b64_tr_b16 a[214:215],v10 offset:38912
v_cvt_pk_bf16_f32 v113,v114,v115
v_mfma_f32_16x16x32_bf16 a[168:171],a[196:199],a[52:55],a[168:171]
ds_read_b128 a[64:67],v12 offset:32768
v_cvt_pk_bf16_f32 v114,v116,v117
v_mfma_f32_16x16x32_bf16 a[172:175],a[192:195],a[56:59],0
buffer_load_dwordx4 v5,s[12:15],s64 offen lds
v_mfma_f32_16x16x32_bf16 a[172:175],a[196:199],a[60:63],a[172:175]
ds_read_b128 a[68:71],v13 offset:32768
s_add_u32 m0,s69,99328
s_waitcnt lgkmcnt(12)
v_mfma_f32_16x16x32_bf16 v[68:71],a[200:203],a[32:35],0
buffer_load_dwordx4 v5,s[12:15],s65 offen lds
s_waitcnt lgkmcnt(10)
v_mfma_f32_16x16x32_bf16 v[68:71],a[204:207],a[36:39],v[68:71]
ds_read_b64_tr_b16 a[216:217],v11 offset:32768
s_add_u32 m0,s69,100352
v_mfma_f32_16x16x32_bf16 v[76:79],a[200:203],a[40:43],0
ds_read_b64_tr_b16 a[218:219],v11 offset:34816
v_cvt_pk_bf16_f32 v115,v118,v119
v_mfma_f32_16x16x32_bf16 v[76:79],a[204:207],a[44:47],v[76:79]
ds_read_b64_tr_b16 a[220:221],v11 offset:36864
v_cvt_pk_bf16_f32 v120,v120,v121
v_mfma_f32_16x16x32_bf16 v[132:135],a[200:203],a[48:51],0
ds_read_b64_tr_b16 a[222:223],v11 offset:38912
v_cvt_pk_bf16_f32 v121,v122,v123
v_mfma_f32_16x16x32_bf16 v[132:135],a[204:207],a[52:55],v[132:135]
ds_read_b128 a[72:75],v12 offset:34816
v_cvt_pk_bf16_f32 v122,v124,v125
v_mfma_f32_16x16x32_bf16 v[140:143],a[200:203],a[56:59],0
buffer_load_dwordx4 v5,s[12:15],s66 offen lds
v_mfma_f32_16x16x32_bf16 v[140:143],a[204:207],a[60:63],v[140:143]
ds_read_b128 a[76:79],v13 offset:34816
s_add_u32 m0,s69,101376
s_waitcnt lgkmcnt(10)
v_mfma_f32_16x16x32_bf16 v[196:199],a[208:211],a[32:35],0
buffer_load_dwordx4 v5,s[12:15],s67 offen lds
s_waitcnt lgkmcnt(8)
v_mfma_f32_16x16x32_bf16 v[196:199],a[212:215],a[36:39],v[196:199]
ds_read_b64_tr_b16 a[192:193],v8 offset:40960
s_add_u32 m0,s68,0
v_mfma_f32_16x16x32_bf16 v[204:207],a[208:211],a[40:43],0
ds_read_b64_tr_b16 a[194:195],v8 offset:43008
v_cvt_pk_bf16_f32 v123,v126,v127
v_mfma_f32_16x16x32_bf16 v[204:207],a[212:215],a[44:47],v[204:207]
ds_read_b64_tr_b16 a[196:197],v8 offset:45056
v_cvt_pk_bf16_f32 v176,v176,v177
v_mfma_f32_16x16x32_bf16 v[84:87],a[208:211],a[48:51],0
s_mov_b32 s4,s52
v_cvt_pk_bf16_f32 v177,v178,v179
v_cvt_pk_bf16_f32 v178,v180,v181
v_cvt_pk_bf16_f32 v179,v182,v183
v_cvt_pk_bf16_f32 v184,v184,v185
v_cvt_pk_bf16_f32 v185,v186,v187
v_cvt_pk_bf16_f32 v186,v188,v189
v_cvt_pk_bf16_f32 v187,v190,v191
v_cvt_pk_bf16_f32 v240,v240,v241
v_cvt_pk_bf16_f32 v241,v242,v243
v_cvt_pk_bf16_f32 v242,v244,v245
v_cvt_pk_bf16_f32 v243,v246,v247
v_cvt_pk_bf16_f32 v248,v248,v249
v_cvt_pk_bf16_f32 v249,v250,v251
v_cvt_pk_bf16_f32 v250,v252,v253
v_cvt_pk_bf16_f32 v251,v254,v255
v_add_u32 v4,128,v4
v_mfma_f32_16x16x32_bf16 v[84:87],a[212:215],a[52:55],v[84:87]
s_mov_b32 s5,s53
ds_read_b64_tr_b16 a[198:199],v8 offset:47104
v_mfma_f32_16x16x32_bf16 v[92:95],a[208:211],a[56:59],0
ds_read_b128 a[80:83],v12 offset:36864
buffer_load_dwordx4 v4,s[8:11],s56 offen lds
v_mfma_f32_16x16x32_bf16 v[92:95],a[212:215],a[60:63],v[92:95]
s_mov_b32 s6,s54
ds_read_b128 a[84:87],v13 offset:36864
s_add_u32 m0,s68,1024
s_waitcnt lgkmcnt(10)
v_mfma_f32_16x16x32_bf16 v[148:151],a[216:219],a[32:35],0
buffer_load_dwordx4 v4,s[8:11],s57 offen lds
s_waitcnt lgkmcnt(8)
v_mfma_f32_16x16x32_bf16 v[148:151],a[220:223],a[36:39],v[148:151]
s_mov_b32 s7,s55
ds_read_b64_tr_b16 a[200:201],v9 offset:40960
v_mfma_f32_16x16x32_bf16 v[156:159],a[216:219],a[40:43],0
ds_read_b64_tr_b16 a[202:203],v9 offset:43008
s_add_u32 m0,s68,2048
v_mfma_f32_16x16x32_bf16 v[156:159],a[220:223],a[44:47],v[156:159]
ds_read_b64_tr_b16 a[204:205],v9 offset:45056
v_mfma_f32_16x16x32_bf16 v[212:215],a[216:219],a[48:51],0
ds_read_b64_tr_b16 a[206:207],v9 offset:47104
v_mfma_f32_16x16x32_bf16 v[212:215],a[220:223],a[52:55],v[212:215]
ds_read_b128 a[88:91],v12 offset:38912
v_mfma_f32_16x16x32_bf16 v[220:223],a[216:219],a[56:59],0
buffer_load_dwordx4 v4,s[8:11],s58 offen lds
v_mfma_f32_16x16x32_bf16 v[220:223],a[220:223],a[60:63],v[220:223]
s_and_b32 s3,s99,0xfffff07f
s_add_u32 m0,s68,3072
v_lshrrev_b32 v28,3,v7
s_waitcnt lgkmcnt(9)
v_mfma_f32_16x16x32_bf16 v[36:39],a[192:195],a[32:35],0
ds_read_b128 a[92:95],v13 offset:38912
buffer_load_dwordx4 v4,s[8:11],s59 offen lds
s_waitcnt lgkmcnt(8)
v_mfma_f32_16x16x32_bf16 v[36:39],a[196:199],a[36:39],v[36:39]
ds_read_b64_tr_b16 a[208:209],v10 offset:40960
s_add_u32 m0,s68,4096
v_mfma_f32_16x16x32_bf16 v[44:47],a[192:195],a[40:43],0
ds_read_b64_tr_b16 a[210:211],v10 offset:43008
v_lshlrev_b32 v28,5,v28
v_mfma_f32_16x16x32_bf16 v[44:47],a[196:199],a[44:47],v[44:47]
ds_read_b64_tr_b16 a[212:213],v10 offset:45056
v_lshrrev_b32 v26,1,v7
v_mfma_f32_16x16x32_bf16 v[100:103],a[192:195],a[48:51],0
ds_read_b64_tr_b16 a[214:215],v10 offset:47104
v_lshlrev_b32 v26,7,v26
v_mfma_f32_16x16x32_bf16 v[100:103],a[196:199],a[52:55],v[100:103]
buffer_load_dwordx4 v4,s[8:11],s60 offen lds
v_mfma_f32_16x16x32_bf16 v[108:111],a[192:195],a[56:59],0
s_add_u32 m0,s68,5120
v_mov_b32 v24,0
v_mov_b32 v25,1
v_mfma_f32_16x16x32_bf16 v[108:111],a[196:199],a[60:63],v[108:111]
buffer_load_dwordx4 v4,s[8:11],s61 offen lds
s_waitcnt lgkmcnt(8)
v_mfma_f32_16x16x32_bf16 v[164:167],a[200:203],a[32:35],0
ds_read_b64_tr_b16 a[216:217],v11 offset:40960
s_add_u32 m0,s68,6144
s_waitcnt lgkmcnt(7)
v_mfma_f32_16x16x32_bf16 v[164:167],a[204:207],a[36:39],v[164:167]
ds_read_b64_tr_b16 a[218:219],v11 offset:43008
v_add_u32 v18,s68,v1
v_mfma_f32_16x16x32_bf16 v[172:175],a[200:203],a[40:43],0
ds_read_b64_tr_b16 a[220:221],v11 offset:45056
v_xor_b32 v19,8192,v18
v_mfma_f32_16x16x32_bf16 v[172:175],a[204:207],a[44:47],v[172:175]
ds_read_b64_tr_b16 a[222:223],v11 offset:47104
v_add_u32 v18,99328,v18
v_mfma_f32_16x16x32_bf16 v[228:231],a[200:203],a[48:51],0
buffer_load_dwordx4 v4,s[8:11],s62 offen lds
v_mfma_f32_16x16x32_bf16 v[228:231],a[204:207],a[52:55],v[228:231]
s_add_u32 m0,s68,7168
v_add_u32 v19,99328,v19
v_mfma_f32_16x16x32_bf16 v[236:239],a[200:203],a[56:59],0
buffer_load_dwordx4 v4,s[8:11],s63 offen lds
v_mfma_f32_16x16x32_bf16 v[236:239],a[204:207],a[60:63],v[236:239]
s_waitcnt lgkmcnt(6)
v_mfma_f32_16x16x32_bf16 v[52:55],a[208:211],a[32:35],0
s_waitcnt vmcnt(12) lgkmcnt(0)
v_mfma_f32_16x16x32_bf16 v[52:55],a[212:215],a[36:39],v[52:55]
s_barrier
v_mfma_f32_16x16x32_bf16 v[60:63],a[208:211],a[40:43],0
ds_read_b64_tr_b16 a[192:193],v8 offset:49152
v_mfma_f32_16x16x32_bf16 v[60:63],a[212:215],a[44:47],v[60:63]
ds_read_b64_tr_b16 a[194:195],v8 offset:51200
v_mfma_f32_16x16x32_bf16 v[116:119],a[208:211],a[48:51],0
ds_read_b64_tr_b16 a[196:197],v8 offset:53248
v_mfma_f32_16x16x32_bf16 v[116:119],a[212:215],a[52:55],v[116:119]
s_add_u32 m0,s69,131072
v_add_u32 v5,524288,v5
v_mfma_f32_16x16x32_bf16 v[124:127],a[208:211],a[56:59],0
ds_read_b64_tr_b16 a[198:199],v8 offset:55296
v_mfma_f32_16x16x32_bf16 v[124:127],a[212:215],a[60:63],v[124:127]
ds_read_b128 a[224:227],v21 offset:0
v_mfma_f32_16x16x32_bf16 v[180:183],a[216:219],a[32:35],0
buffer_load_dwordx4 v5,s[12:15],s64 offen lds
v_mfma_f32_16x16x32_bf16 v[180:183],a[220:223],a[36:39],v[180:183]
ds_read_b64_tr_b16 a[200:201],v9 offset:49152
s_add_u32 m0,s69,132096
v_mfma_f32_16x16x32_bf16 v[188:191],a[216:219],a[40:43],0
ds_read_b64_tr_b16 a[202:203],v9 offset:51200
v_mfma_f32_16x16x32_bf16 v[188:191],a[220:223],a[44:47],v[188:191]
ds_read_b64_tr_b16 a[204:205],v9 offset:53248
v_mfma_f32_16x16x32_bf16 v[244:247],a[216:219],a[48:51],0
ds_read_b64_tr_b16 a[206:207],v9 offset:55296
v_mfma_f32_16x16x32_bf16 v[244:247],a[220:223],a[52:55],v[244:247]
ds_read_b128 a[228:231],v21 offset:128
v_mfma_f32_16x16x32_bf16 v[252:255],a[216:219],a[56:59],0
buffer_store_dwordx4 v[48:51],v1,s[16:19],s48 offen offset:3072 sc1
buffer_load_dwordx4 v5,s[12:15],s65 offen lds
v_mfma_f32_16x16x32_bf16 v[252:255],a[220:223],a[60:63],v[252:255]
ds_read_b128 a[232:235],v21 offset:256
s_add_u32 m0,s69,133120
s_waitcnt lgkmcnt(9)
v_mfma_f32_16x16x32_bf16 a[160:163],a[192:195],a[64:67],a[160:163]
buffer_load_dwordx4 v5,s[12:15],s66 offen lds
s_waitcnt lgkmcnt(7)
v_mfma_f32_16x16x32_bf16 a[160:163],a[196:199],a[68:71],a[160:163]
ds_read_b64_tr_b16 a[208:209],v10 offset:49152
s_add_u32 m0,s69,134144
v_mfma_f32_16x16x32_bf16 a[164:167],a[192:195],a[72:75],a[164:167]
ds_read_b64_tr_b16 a[210:211],v10 offset:51200
v_mfma_f32_16x16x32_bf16 a[164:167],a[196:199],a[76:79],a[164:167]
ds_read_b64_tr_b16 a[212:213],v10 offset:53248
v_mfma_f32_16x16x32_bf16 a[168:171],a[192:195],a[80:83],a[168:171]
ds_read_b64_tr_b16 a[214:215],v10 offset:55296
v_mfma_f32_16x16x32_bf16 a[168:171],a[196:199],a[84:87],a[168:171]
ds_read_b128 a[32:35],v14 offset:0
v_add_u32 v4,128,v4
v_mfma_f32_16x16x32_bf16 a[172:175],a[192:195],a[88:91],a[172:175]
buffer_load_dwordx4 v5,s[12:15],s67 offen lds
v_mfma_f32_16x16x32_bf16 a[172:175],a[196:199],a[92:95],a[172:175]
ds_read_b128 a[36:39],v15 offset:0
s_add_u32 m0,s68,32768
s_waitcnt lgkmcnt(10)
v_mfma_f32_16x16x32_bf16 v[68:71],a[200:203],a[64:67],v[68:71]
buffer_load_dwordx4 v4,s[8:11],s56 offen lds
s_waitcnt lgkmcnt(8)
v_mfma_f32_16x16x32_bf16 v[68:71],a[204:207],a[68:71],v[68:71]
ds_read_b64_tr_b16 a[216:217],v11 offset:49152
s_add_u32 m0,s68,33792
v_mfma_f32_16x16x32_bf16 v[76:79],a[200:203],a[72:75],v[76:79]
ds_read_b64_tr_b16 a[218:219],v11 offset:51200
v_mfma_f32_16x16x32_bf16 v[76:79],a[204:207],a[76:79],v[76:79]
ds_read_b64_tr_b16 a[220:221],v11 offset:53248
v_mfma_f32_16x16x32_bf16 v[132:135],a[200:203],a[80:83],v[132:135]
ds_read_b64_tr_b16 a[222:223],v11 offset:55296
v_mfma_f32_16x16x32_bf16 v[132:135],a[204:207],a[84:87],v[132:135]
ds_read_b128 a[40:43],v14 offset:2048
v_mfma_f32_16x16x32_bf16 v[140:143],a[200:203],a[88:91],v[140:143]
buffer_load_dwordx4 v4,s[8:11],s57 offen lds
v_mfma_f32_16x16x32_bf16 v[140:143],a[204:207],a[92:95],v[140:143]
ds_read_b128 a[44:47],v15 offset:2048
s_add_u32 m0,s68,34816
s_waitcnt lgkmcnt(10)
v_mfma_f32_16x16x32_bf16 v[196:199],a[208:211],a[64:67],v[196:199]
buffer_load_dwordx4 v4,s[8:11],s58 offen lds
s_waitcnt lgkmcnt(8)
v_mfma_f32_16x16x32_bf16 v[196:199],a[212:215],a[68:71],v[196:199]
ds_read_b64_tr_b16 a[192:193],v8 offset:57344
s_add_u32 m0,s68,35840
v_mfma_f32_16x16x32_bf16 v[204:207],a[208:211],a[72:75],v[204:207]
ds_read_b64_tr_b16 a[194:195],v8 offset:59392
v_mfma_f32_16x16x32_bf16 v[204:207],a[212:215],a[76:79],v[204:207]
ds_read_b64_tr_b16 a[196:197],v8 offset:61440
v_mfma_f32_16x16x32_bf16 v[84:87],a[208:211],a[80:83],v[84:87]
ds_read_b64_tr_b16 a[198:199],v8 offset:63488
v_mfma_f32_16x16x32_bf16 v[84:87],a[212:215],a[84:87],v[84:87]
ds_read_b128 a[48:51],v14 offset:4096
v_mfma_f32_16x16x32_bf16 v[92:95],a[208:211],a[88:91],v[92:95]
buffer_load_dwordx4 v4,s[8:11],s59 offen lds
v_mfma_f32_16x16x32_bf16 v[92:95],a[212:215],a[92:95],v[92:95]
ds_read_b128 a[52:55],v15 offset:4096
s_add_u32 m0,s68,36864
s_waitcnt lgkmcnt(10)
v_mfma_f32_16x16x32_bf16 v[148:151],a[216:219],a[64:67],v[148:151]
ds_read_b128 a[236:239],v21 offset:384
s_waitcnt lgkmcnt(9)
v_mfma_f32_16x16x32_bf16 v[148:151],a[220:223],a[68:71],v[148:151]
ds_read_b64_tr_b16 a[200:201],v9 offset:57344
v_mfma_f32_16x16x32_bf16 v[156:159],a[216:219],a[72:75],v[156:159]
ds_read_b64_tr_b16 a[202:203],v9 offset:59392
v_mfma_f32_16x16x32_bf16 v[156:159],a[220:223],a[76:79],v[156:159]
ds_read_b64_tr_b16 a[204:205],v9 offset:61440
v_mfma_f32_16x16x32_bf16 v[212:215],a[216:219],a[80:83],v[212:215]
ds_read_b64_tr_b16 a[206:207],v9 offset:63488
v_mfma_f32_16x16x32_bf16 v[212:215],a[220:223],a[84:87],v[212:215]
ds_read_b128 a[56:59],v14 offset:6144
v_mfma_f32_16x16x32_bf16 v[220:223],a[216:219],a[88:91],v[220:223]
buffer_load_dwordx4 v4,s[8:11],s60 offen lds
v_mfma_f32_16x16x32_bf16 v[220:223],a[220:223],a[92:95],v[220:223]
ds_read_b128 a[60:63],v15 offset:6144
s_add_u32 m0,s68,37888
s_waitcnt lgkmcnt(11)
v_mfma_f32_16x16x32_bf16 v[36:39],a[192:195],a[64:67],v[36:39]
global_load_dword v29,v28,s[94:95] sc1
s_waitcnt lgkmcnt(9)
v_mfma_f32_16x16x32_bf16 v[36:39],a[196:199],a[68:71],v[36:39]
ds_read_b64_tr_b16 a[208:209],v10 offset:57344
v_mfma_f32_16x16x32_bf16 v[44:47],a[192:195],a[72:75],v[44:47]
s_movk_i32 s36,0
ds_read_b64_tr_b16 a[210:211],v10 offset:59392
v_mfma_f32_16x16x32_bf16 v[44:47],a[196:199],a[76:79],v[44:47]
ds_read_b64_tr_b16 a[212:213],v10 offset:61440
v_mfma_f32_16x16x32_bf16 v[100:103],a[192:195],a[80:83],v[100:103]
ds_read_b64_tr_b16 a[214:215],v10 offset:63488
v_mfma_f32_16x16x32_bf16 v[100:103],a[196:199],a[84:87],v[100:103]
buffer_load_dwordx4 v4,s[8:11],s61 offen lds
v_mfma_f32_16x16x32_bf16 v[108:111],a[192:195],a[88:91],v[108:111]
buffer_store_dwordx4 a[224:227],v22,s[16:19],s36 offen sc1
s_add_u32 m0,s68,38912
s_movk_i32 s36,4096
v_mfma_f32_16x16x32_bf16 v[108:111],a[196:199],a[92:95],v[108:111]
buffer_load_dwordx4 v4,s[8:11],s62 offen lds
s_waitcnt lgkmcnt(8)
v_mfma_f32_16x16x32_bf16 v[164:167],a[200:203],a[64:67],v[164:167]
buffer_store_dwordx4 a[228:231],v22,s[16:19],s36 offen sc1
s_waitcnt lgkmcnt(6)
v_mfma_f32_16x16x32_bf16 v[164:167],a[204:207],a[68:71],v[164:167]
ds_read_b64_tr_b16 a[216:217],v11 offset:57344
s_add_u32 m0,s68,39936
v_mfma_f32_16x16x32_bf16 v[172:175],a[200:203],a[72:75],v[172:175]
ds_read_b64_tr_b16 a[218:219],v11 offset:59392
s_movk_i32 s36,8192
v_mfma_f32_16x16x32_bf16 v[172:175],a[204:207],a[76:79],v[172:175]
ds_read_b64_tr_b16 a[220:221],v11 offset:61440
v_mfma_f32_16x16x32_bf16 v[228:231],a[200:203],a[80:83],v[228:231]
ds_read_b64_tr_b16 a[222:223],v11 offset:63488
v_mfma_f32_16x16x32_bf16 v[228:231],a[204:207],a[84:87],v[228:231]
buffer_load_dwordx4 v4,s[8:11],s63 offen lds
v_mfma_f32_16x16x32_bf16 v[236:239],a[200:203],a[88:91],v[236:239]
buffer_store_dwordx4 a[232:235],v22,s[16:19],s36 offen sc1
s_movk_i32 s36,12288
v_mfma_f32_16x16x32_bf16 v[236:239],a[204:207],a[92:95],v[236:239]
buffer_store_dwordx4 a[236:239],v22,s[16:19],s36 offen sc1
s_waitcnt lgkmcnt(6)
v_mfma_f32_16x16x32_bf16 v[52:55],a[208:211],a[64:67],v[52:55]
s_waitcnt vmcnt(18) lgkmcnt(0)
v_mfma_f32_16x16x32_bf16 v[52:55],a[212:215],a[68:71],v[52:55]
s_barrier
v_mfma_f32_16x16x32_bf16 v[60:63],a[208:211],a[72:75],v[60:63]
ds_read_b64_tr_b16 a[192:193],v8 offset:0
v_mfma_f32_16x16x32_bf16 v[60:63],a[212:215],a[76:79],v[60:63]
ds_read_b64_tr_b16 a[194:195],v8 offset:2048
v_mfma_f32_16x16x32_bf16 v[116:119],a[208:211],a[80:83],v[116:119]
ds_read_b64_tr_b16 a[196:197],v8 offset:4096
v_mfma_f32_16x16x32_bf16 v[116:119],a[212:215],a[84:87],v[116:119]
s_add_u32 m0,s69,147456
v_add_u32 v5,524288,v5
v_mfma_f32_16x16x32_bf16 v[124:127],a[208:211],a[88:91],v[124:127]
ds_read_b64_tr_b16 a[198:199],v8 offset:6144
v_mfma_f32_16x16x32_bf16 v[124:127],a[212:215],a[92:95],v[124:127]
buffer_load_dwordx4 v5,s[12:15],s64 offen lds
v_mfma_f32_16x16x32_bf16 v[180:183],a[216:219],a[64:67],v[180:183]
ds_read_b64_tr_b16 a[200:201],v9 offset:0
s_add_u32 m0,s69,148480
v_mfma_f32_16x16x32_bf16 v[180:183],a[220:223],a[68:71],v[180:183]
ds_read_b64_tr_b16 a[202:203],v9 offset:2048
v_mfma_f32_16x16x32_bf16 v[188:191],a[216:219],a[72:75],v[188:191]
ds_read_b64_tr_b16 a[204:205],v9 offset:4096
v_mfma_f32_16x16x32_bf16 v[188:191],a[220:223],a[76:79],v[188:191]
ds_read_b64_tr_b16 a[206:207],v9 offset:6144
v_mfma_f32_16x16x32_bf16 v[244:247],a[216:219],a[80:83],v[244:247]
buffer_store_dwordx4 v[56:59],v1,s[16:19],s49 offen offset:3072 sc1
v_mfma_f32_16x16x32_bf16 v[244:247],a[220:223],a[84:87],v[244:247]
buffer_load_dwordx4 v5,s[12:15],s65 offen lds
v_mfma_f32_16x16x32_bf16 v[252:255],a[216:219],a[88:91],v[252:255]
s_add_u32 m0,s69,149504
v_mfma_f32_16x16x32_bf16 v[252:255],a[220:223],a[92:95],v[252:255]
buffer_load_dwordx4 v5,s[12:15],s66 offen lds
s_waitcnt lgkmcnt(6)
v_mfma_f32_16x16x32_bf16 a[160:163],a[192:195],a[32:35],a[160:163]
ds_read_b64_tr_b16 a[208:209],v10 offset:0
s_add_u32 m0,s69,150528
s_waitcnt lgkmcnt(5)
v_mfma_f32_16x16x32_bf16 a[160:163],a[196:199],a[36:39],a[160:163]
ds_read_b64_tr_b16 a[210:211],v10 offset:2048
v_accvgpr_write_b32 a96,0
v_mfma_f32_16x16x32_bf16 a[164:167],a[192:195],a[40:43],a[164:167]
ds_read_b64_tr_b16 a[212:213],v10 offset:4096
v_accvgpr_write_b32 a97,0
v_mfma_f32_16x16x32_bf16 a[164:167],a[196:199],a[44:47],a[164:167]
ds_read_b64_tr_b16 a[214:215],v10 offset:6144
s_lshl_b32 s28,s21,19
v_mfma_f32_16x16x32_bf16 a[168:171],a[192:195],a[48:51],a[168:171]
ds_read_b128 a[64:67],v12 offset:0
v_accvgpr_write_b32 a98,0
v_mfma_f32_16x16x32_bf16 a[168:171],a[196:199],a[52:55],a[168:171]
buffer_load_dwordx4 v5,s[12:15],s67 offen lds
v_mfma_f32_16x16x32_bf16 a[172:175],a[192:195],a[56:59],a[172:175]
ds_read_b128 a[68:71],v13 offset:0
s_add_u32 m0,s68,65536
v_add_u32 v4,128,v4
v_mfma_f32_16x16x32_bf16 a[172:175],a[196:199],a[60:63],a[172:175]
buffer_load_dwordx4 v4,s[8:11],s56 offen lds
s_waitcnt lgkmcnt(8)
v_mfma_f32_16x16x32_bf16 v[68:71],a[200:203],a[32:35],v[68:71]
ds_read_b64_tr_b16 a[216:217],v11 offset:0
s_add_u32 m0,s68,66560
s_waitcnt lgkmcnt(7)
v_mfma_f32_16x16x32_bf16 v[68:71],a[204:207],a[36:39],v[68:71]
ds_read_b64_tr_b16 a[218:219],v11 offset:2048
v_accvgpr_write_b32 a99,0
v_mfma_f32_16x16x32_bf16 v[76:79],a[200:203],a[40:43],v[76:79]
ds_read_b64_tr_b16 a[220:221],v11 offset:4096
v_accvgpr_write_b32 a100,0
v_mfma_f32_16x16x32_bf16 v[76:79],a[204:207],a[44:47],v[76:79]
ds_read_b64_tr_b16 a[222:223],v11 offset:6144
v_accvgpr_write_b32 a101,0
v_mfma_f32_16x16x32_bf16 v[132:135],a[200:203],a[48:51],v[132:135]
ds_read_b128 a[72:75],v12 offset:2048
v_accvgpr_write_b32 a102,0
v_mfma_f32_16x16x32_bf16 v[132:135],a[204:207],a[52:55],v[132:135]
buffer_load_dwordx4 v4,s[8:11],s57 offen lds
v_mfma_f32_16x16x32_bf16 v[140:143],a[200:203],a[56:59],v[140:143]
ds_read_b128 a[76:79],v13 offset:2048
s_add_u32 m0,s68,67584
v_mfma_f32_16x16x32_bf16 v[140:143],a[204:207],a[60:63],v[140:143]
buffer_load_dwordx4 v4,s[8:11],s58 offen lds
s_waitcnt lgkmcnt(10)
v_mfma_f32_16x16x32_bf16 v[196:199],a[208:211],a[32:35],v[196:199]
ds_read_b64_tr_b16 a[192:193],v8 offset:8192
s_add_u32 m0,s68,68608
s_waitcnt lgkmcnt(9)
v_mfma_f32_16x16x32_bf16 v[196:199],a[212:215],a[36:39],v[196:199]
ds_read_b64_tr_b16 a[194:195],v8 offset:10240
v_accvgpr_write_b32 a103,0
v_mfma_f32_16x16x32_bf16 v[204:207],a[208:211],a[40:43],v[204:207]
ds_read_b64_tr_b16 a[196:197],v8 offset:12288
v_accvgpr_write_b32 a104,0
v_mfma_f32_16x16x32_bf16 v[204:207],a[212:215],a[44:47],v[204:207]
ds_read_b64_tr_b16 a[198:199],v8 offset:14336
v_accvgpr_write_b32 a105,0
v_mfma_f32_16x16x32_bf16 v[84:87],a[208:211],a[48:51],v[84:87]
ds_read_b128 a[80:83],v12 offset:4096
v_accvgpr_write_b32 a106,0
v_mfma_f32_16x16x32_bf16 v[84:87],a[212:215],a[52:55],v[84:87]
buffer_load_dwordx4 v4,s[8:11],s59 offen lds
v_mfma_f32_16x16x32_bf16 v[92:95],a[208:211],a[56:59],v[92:95]
ds_read_b128 a[84:87],v13 offset:4096
s_add_u32 m0,s68,69632
v_mfma_f32_16x16x32_bf16 v[92:95],a[212:215],a[60:63],v[92:95]
s_add_u32 s28,s28,s23
v_accvgpr_write_b32 a107,0
s_sub_u32 s24,s28,16384
s_waitcnt lgkmcnt(10)
v_mfma_f32_16x16x32_bf16 v[148:151],a[216:219],a[32:35],v[148:151]
ds_read_b64_tr_b16 a[200:201],v9 offset:8192
v_accvgpr_write_b32 a108,0
s_waitcnt lgkmcnt(9)
v_mfma_f32_16x16x32_bf16 v[148:151],a[220:223],a[36:39],v[148:151]
ds_read_b64_tr_b16 a[202:203],v9 offset:10240
s_add_u32 s25,s24,16777216
v_mfma_f32_16x16x32_bf16 v[156:159],a[216:219],a[40:43],v[156:159]
ds_read_b64_tr_b16 a[204:205],v9 offset:12288
v_accvgpr_write_b32 a109,0
v_mfma_f32_16x16x32_bf16 v[156:159],a[220:223],a[44:47],v[156:159]
ds_read_b64_tr_b16 a[206:207],v9 offset:14336
s_mov_b32 s27,0
v_mfma_f32_16x16x32_bf16 v[212:215],a[216:219],a[48:51],v[212:215]
ds_read_b128 a[88:91],v12 offset:6144
v_accvgpr_write_b32 a110,0
v_mfma_f32_16x16x32_bf16 v[212:215],a[220:223],a[52:55],v[212:215]
buffer_load_dwordx4 v4,s[8:11],s60 offen lds
v_mfma_f32_16x16x32_bf16 v[220:223],a[216:219],a[56:59],v[220:223]
ds_read_b128 a[92:95],v13 offset:6144
s_add_u32 m0,s68,70656
v_mfma_f32_16x16x32_bf16 v[220:223],a[220:223],a[60:63],v[220:223]
s_and_b32 s38,s2,7
v_accvgpr_write_b32 a111,0
s_lshl_b32 s38,s38,5
s_waitcnt lgkmcnt(10)
v_mfma_f32_16x16x32_bf16 v[36:39],a[192:195],a[32:35],v[36:39]
ds_read_b64_tr_b16 a[208:209],v10 offset:8192
v_accvgpr_write_b32 a112,0
s_waitcnt lgkmcnt(9)
v_mfma_f32_16x16x32_bf16 v[36:39],a[196:199],a[36:39],v[36:39]
ds_read_b64_tr_b16 a[210:211],v10 offset:10240
s_lshr_b32 s39,s2,3
v_mfma_f32_16x16x32_bf16 v[44:47],a[192:195],a[40:43],v[44:47]
ds_read_b64_tr_b16 a[212:213],v10 offset:12288
v_accvgpr_write_b32 a113,0
v_mfma_f32_16x16x32_bf16 v[44:47],a[196:199],a[44:47],v[44:47]
ds_read_b64_tr_b16 a[214:215],v10 offset:14336
s_add_u32 s38,s38,s39
v_mfma_f32_16x16x32_bf16 v[100:103],a[192:195],a[48:51],v[100:103]
buffer_load_dwordx4 v4,s[8:11],s61 offen lds
v_mfma_f32_16x16x32_bf16 v[100:103],a[196:199],a[52:55],v[100:103]
s_add_u32 m0,s68,71680
v_accvgpr_write_b32 a114,0
s_lshl_b32 s32,s38,14
v_mfma_f32_16x16x32_bf16 v[108:111],a[192:195],a[56:59],v[108:111]
buffer_load_dwordx4 v4,s[8:11],s62 offen lds
v_mfma_f32_16x16x32_bf16 v[108:111],a[196:199],a[60:63],v[108:111]
s_add_u32 m0,s68,72704
v_accvgpr_write_b32 a115,0
s_add_u32 s32,s32,50331648
s_waitcnt lgkmcnt(8)
v_mfma_f32_16x16x32_bf16 v[164:167],a[200:203],a[32:35],v[164:167]
ds_read_b64_tr_b16 a[216:217],v11 offset:8192
v_accvgpr_write_b32 a116,0
s_waitcnt lgkmcnt(7)
v_mfma_f32_16x16x32_bf16 v[164:167],a[204:207],a[36:39],v[164:167]
ds_read_b64_tr_b16 a[218:219],v11 offset:10240
s_add_u32 s32,s32,s23
v_mfma_f32_16x16x32_bf16 v[172:175],a[200:203],a[40:43],v[172:175]
ds_read_b64_tr_b16 a[220:221],v11 offset:12288
v_accvgpr_write_b32 a117,0
v_mfma_f32_16x16x32_bf16 v[172:175],a[204:207],a[44:47],v[172:175]
ds_read_b64_tr_b16 a[222:223],v11 offset:14336
s_add_u32 s33,s32,4
v_mfma_f32_16x16x32_bf16 v[228:231],a[200:203],a[48:51],v[228:231]
buffer_load_dwordx4 v4,s[8:11],s63 offen lds
v_mfma_f32_16x16x32_bf16 v[228:231],a[204:207],a[52:55],v[228:231]
s_lshr_b32 s39,s20,1
v_accvgpr_write_b32 a118,0
s_and_b32 s40,s20,1
v_mfma_f32_16x16x32_bf16 v[236:239],a[200:203],a[56:59],v[236:239]
s_mul_i32 s35,s39,16640
v_accvgpr_write_b32 a119,0
s_add_u32 s35,s35,65536
v_mfma_f32_16x16x32_bf16 v[236:239],a[204:207],a[60:63],v[236:239]
s_mul_i32 s34,s40,4160
s_add_u32 s34,s34,s35
s_mul_i32 s41,s39,4608
s_waitcnt lgkmcnt(6)
v_mfma_f32_16x16x32_bf16 v[52:55],a[208:211],a[32:35],v[52:55]
s_waitcnt vmcnt(11) lgkmcnt(0)
v_accvgpr_write_b32 a120,0
s_add_u32 s41,s41,16384
v_mfma_f32_16x16x32_bf16 v[52:55],a[212:215],a[36:39],v[52:55]
s_barrier
buffer_store_dword v25,v24,s[16:19],s99 offen sc1
v_cmp_gt_u32 vcc,32,v29
s_nop 0
s_cbranch_vccnz F_AW_S
F_AW_R:
v_mfma_f32_16x16x32_bf16 v[60:63],a[208:211],a[40:43],v[60:63]
ds_read_b64_tr_b16 a[192:193],v8 offset:32768
v_accvgpr_write_b32 a121,0
v_mfma_f32_16x16x32_bf16 v[60:63],a[212:215],a[44:47],v[60:63]
ds_read_b64_tr_b16 a[194:195],v8 offset:34816
s_lshl_b32 s88,s38,13
v_mfma_f32_16x16x32_bf16 v[116:119],a[208:211],a[48:51],v[116:119]
ds_read_b64_tr_b16 a[196:197],v8 offset:36864
v_accvgpr_write_b32 a122,0
v_mfma_f32_16x16x32_bf16 v[116:119],a[212:215],a[52:55],v[116:119]
s_add_u32 m0,s69,98304
v_add_u32 v5,524288,v5
s_lshl_b32 s42,s20,11
v_mfma_f32_16x16x32_bf16 v[124:127],a[208:211],a[56:59],v[124:127]
ds_read_b64_tr_b16 a[198:199],v8 offset:38912
v_accvgpr_write_b32 a123,0
v_mfma_f32_16x16x32_bf16 v[124:127],a[212:215],a[60:63],v[124:127]
buffer_load_dwordx4 v5,s[12:15],s64 offen lds
v_mfma_f32_16x16x32_bf16 v[180:183],a[216:219],a[32:35],v[180:183]
ds_read_b64_tr_b16 a[200:201],v9 offset:32768
s_add_u32 m0,s69,99328
v_mfma_f32_16x16x32_bf16 v[180:183],a[220:223],a[36:39],v[180:183]
ds_read_b64_tr_b16 a[202:203],v9 offset:34816
v_accvgpr_write_b32 a124,0
v_mfma_f32_16x16x32_bf16 v[188:191],a[216:219],a[40:43],v[188:191]
ds_read_b64_tr_b16 a[204:205],v9 offset:36864
v_accvgpr_write_b32 a125,0
v_mfma_f32_16x16x32_bf16 v[188:191],a[220:223],a[44:47],v[188:191]
ds_read_b64_tr_b16 a[206:207],v9 offset:38912
s_add_u32 s88,s88,s42
v_mfma_f32_16x16x32_bf16 v[244:247],a[216:219],a[48:51],v[244:247]
s_add_u32 s100,s88,58720256
v_accvgpr_write_b32 a126,0
s_mov_b32 s26,s89
v_mfma_f32_16x16x32_bf16 v[244:247],a[220:223],a[52:55],v[244:247]
buffer_load_dwordx4 v5,s[12:15],s65 offen lds
v_mfma_f32_16x16x32_bf16 v[252:255],a[216:219],a[56:59],v[252:255]
s_add_u32 m0,s69,100352
v_accvgpr_write_b32 a127,0
v_and_b32 v20,3,v7
v_mfma_f32_16x16x32_bf16 v[252:255],a[220:223],a[60:63],v[252:255]
buffer_load_dwordx4 v5,s[12:15],s66 offen lds
s_waitcnt lgkmcnt(6)
v_mfma_f32_16x16x32_bf16 a[160:163],a[192:195],a[64:67],a[160:163]
ds_read_b64_tr_b16 a[208:209],v10 offset:32768
s_add_u32 m0,s69,101376
s_waitcnt lgkmcnt(5)
v_mfma_f32_16x16x32_bf16 a[160:163],a[196:199],a[68:71],a[160:163]
ds_read_b64_tr_b16 a[210:211],v10 offset:34816
v_accvgpr_write_b32 a128,0
v_mfma_f32_16x16x32_bf16 a[164:167],a[192:195],a[72:75],a[164:167]
ds_read_b64_tr_b16 a[212:213],v10 offset:36864
v_accvgpr_write_b32 a129,0
v_mfma_f32_16x16x32_bf16 a[164:167],a[196:199],a[76:79],a[164:167]
ds_read_b64_tr_b16 a[214:215],v10 offset:38912
v_mul_u32_u24 v20,4160,v20
v_mfma_f32_16x16x32_bf16 a[168:171],a[192:195],a[80:83],a[168:171]
ds_read_b128 a[32:35],v12 offset:32768
v_accvgpr_write_b32 a130,0
v_mfma_f32_16x16x32_bf16 a[168:171],a[196:199],a[84:87],a[168:171]
buffer_load_dwordx4 v5,s[12:15],s67 offen lds
v_mfma_f32_16x16x32_bf16 a[172:175],a[192:195],a[88:91],a[172:175]
ds_read_b128 a[36:39],v13 offset:32768
s_add_u32 m0,s68,0
v_add_u32 v4,128,v4
v_mfma_f32_16x16x32_bf16 a[172:175],a[196:199],a[92:95],a[172:175]
buffer_load_dwordx4 v4,s[8:11],s56 offen lds
s_waitcnt lgkmcnt(8)
v_mfma_f32_16x16x32_bf16 v[68:71],a[200:203],a[64:67],v[68:71]
ds_read_b64_tr_b16 a[216:217],v11 offset:32768
s_add_u32 m0,s68,1024
s_waitcnt lgkmcnt(7)
v_mfma_f32_16x16x32_bf16 v[68:71],a[204:207],a[68:71],v[68:71]
ds_read_b64_tr_b16 a[218:219],v11 offset:34816
v_accvgpr_write_b32 a131,0
v_mfma_f32_16x16x32_bf16 v[76:79],a[200:203],a[72:75],v[76:79]
ds_read_b64_tr_b16 a[220:221],v11 offset:36864
v_accvgpr_write_b32 a132,0
v_mfma_f32_16x16x32_bf16 v[76:79],a[204:207],a[76:79],v[76:79]
ds_read_b64_tr_b16 a[222:223],v11 offset:38912
v_accvgpr_write_b32 a133,0
v_mfma_f32_16x16x32_bf16 v[132:135],a[200:203],a[80:83],v[132:135]
ds_read_b128 a[40:43],v12 offset:34816
v_accvgpr_write_b32 a134,0
v_mfma_f32_16x16x32_bf16 v[132:135],a[204:207],a[84:87],v[132:135]
buffer_load_dwordx4 v4,s[8:11],s57 offen lds
v_mfma_f32_16x16x32_bf16 v[140:143],a[200:203],a[88:91],v[140:143]
ds_read_b128 a[44:47],v13 offset:34816
s_add_u32 m0,s68,2048
v_mfma_f32_16x16x32_bf16 v[140:143],a[204:207],a[92:95],v[140:143]
buffer_load_dwordx4 v4,s[8:11],s58 offen lds
s_waitcnt lgkmcnt(10)
v_mfma_f32_16x16x32_bf16 v[196:199],a[208:211],a[64:67],v[196:199]
ds_read_b64_tr_b16 a[192:193],v8 offset:40960
s_add_u32 m0,s68,3072
s_waitcnt lgkmcnt(9)
v_mfma_f32_16x16x32_bf16 v[196:199],a[212:215],a[68:71],v[196:199]
ds_read_b64_tr_b16 a[194:195],v8 offset:43008
v_accvgpr_write_b32 a135,0
v_mfma_f32_16x16x32_bf16 v[204:207],a[208:211],a[72:75],v[204:207]
ds_read_b64_tr_b16 a[196:197],v8 offset:45056
v_accvgpr_write_b32 a136,0
v_mfma_f32_16x16x32_bf16 v[204:207],a[212:215],a[76:79],v[204:207]
ds_read_b64_tr_b16 a[198:199],v8 offset:47104
v_accvgpr_write_b32 a137,0
v_mfma_f32_16x16x32_bf16 v[84:87],a[208:211],a[80:83],v[84:87]
ds_read_b128 a[48:51],v12 offset:36864
v_accvgpr_write_b32 a138,0
v_mfma_f32_16x16x32_bf16 v[84:87],a[212:215],a[84:87],v[84:87]
buffer_load_dwordx4 v4,s[8:11],s59 offen lds
v_mfma_f32_16x16x32_bf16 v[92:95],a[208:211],a[88:91],v[92:95]
ds_read_b128 a[52:55],v13 offset:36864
s_add_u32 m0,s68,4096
v_mfma_f32_16x16x32_bf16 v[92:95],a[212:215],a[92:95],v[92:95]
s_waitcnt lgkmcnt(8)
v_accvgpr_write_b32 a139,0
v_bfe_u32 v21,v7,2,1
v_mfma_f32_16x16x32_bf16 v[148:151],a[216:219],a[64:67],v[148:151]
ds_read_b64_tr_b16 a[200:201],v9 offset:40960
v_accvgpr_write_b32 a140,0
v_mfma_f32_16x16x32_bf16 v[148:151],a[220:223],a[68:71],v[148:151]
ds_read_b64_tr_b16 a[202:203],v9 offset:43008
v_lshl_add_u32 v20,v21,4,v20
v_mfma_f32_16x16x32_bf16 v[156:159],a[216:219],a[72:75],v[156:159]
ds_read_b64_tr_b16 a[204:205],v9 offset:45056
v_accvgpr_write_b32 a141,0
v_mfma_f32_16x16x32_bf16 v[156:159],a[220:223],a[76:79],v[156:159]
ds_read_b64_tr_b16 a[206:207],v9 offset:47104
s_add_u32 s42,s35,4096
v_mfma_f32_16x16x32_bf16 v[212:215],a[216:219],a[80:83],v[212:215]
ds_read_b128 a[56:59],v12 offset:38912
v_accvgpr_write_b32 a142,0
v_mfma_f32_16x16x32_bf16 v[212:215],a[220:223],a[84:87],v[212:215]
buffer_load_dwordx4 v4,s[8:11],s60 offen lds
v_mfma_f32_16x16x32_bf16 v[220:223],a[216:219],a[88:91],v[220:223]
ds_read_b128 a[60:63],v13 offset:38912
s_add_u32 m0,s68,5120
v_mfma_f32_16x16x32_bf16 v[220:223],a[220:223],a[92:95],v[220:223]
s_waitcnt lgkmcnt(8)
v_accvgpr_write_b32 a143,0
v_add_u32 v20,s42,v20
v_mfma_f32_16x16x32_bf16 v[36:39],a[192:195],a[64:67],v[36:39]
ds_read_b64_tr_b16 a[208:209],v10 offset:40960
v_accvgpr_write_b32 a144,0
v_mfma_f32_16x16x32_bf16 v[36:39],a[196:199],a[68:71],v[36:39]
ds_read_b64_tr_b16 a[210:211],v10 offset:43008
s_sub_u32 s42,s41,512
v_mfma_f32_16x16x32_bf16 v[44:47],a[192:195],a[72:75],v[44:47]
ds_read_b64_tr_b16 a[212:213],v10 offset:45056
v_accvgpr_write_b32 a145,0
v_mfma_f32_16x16x32_bf16 v[44:47],a[196:199],a[76:79],v[44:47]
ds_read_b64_tr_b16 a[214:215],v10 offset:47104
v_add_u32 v21,s42,v1
v_mfma_f32_16x16x32_bf16 v[100:103],a[192:195],a[80:83],v[100:103]
buffer_load_dwordx4 v4,s[8:11],s61 offen lds
v_mfma_f32_16x16x32_bf16 v[100:103],a[196:199],a[84:87],v[100:103]
s_add_u32 m0,s68,6144
v_accvgpr_write_b32 a146,0
v_cmp_gt_u32 s[44:45],32,v7
v_mfma_f32_16x16x32_bf16 v[108:111],a[192:195],a[88:91],v[108:111]
buffer_load_dwordx4 v4,s[8:11],s62 offen lds
v_mfma_f32_16x16x32_bf16 v[108:111],a[196:199],a[92:95],v[108:111]
s_add_u32 m0,s68,7168
v_accvgpr_write_b32 a147,0
s_lshl_b32 s42,s40,11
s_waitcnt lgkmcnt(8)
v_mfma_f32_16x16x32_bf16 v[164:167],a[200:203],a[64:67],v[164:167]
ds_read_b64_tr_b16 a[216:217],v11 offset:40960
v_accvgpr_write_b32 a148,0
s_waitcnt lgkmcnt(7)
v_mfma_f32_16x16x32_bf16 v[164:167],a[204:207],a[68:71],v[164:167]
ds_read_b64_tr_b16 a[218:219],v11 offset:43008
s_add_u32 s42,s42,s41
v_mfma_f32_16x16x32_bf16 v[172:175],a[200:203],a[72:75],v[172:175]
ds_read_b64_tr_b16 a[220:221],v11 offset:45056
v_accvgpr_write_b32 a149,0
v_mfma_f32_16x16x32_bf16 v[172:175],a[204:207],a[76:79],v[172:175]
ds_read_b64_tr_b16 a[222:223],v11 offset:47104
v_and_b32 v16,3,v7
v_mfma_f32_16x16x32_bf16 v[228:231],a[200:203],a[80:83],v[228:231]
buffer_load_dwordx4 v4,s[8:11],s63 offen lds
v_mfma_f32_16x16x32_bf16 v[228:231],a[204:207],a[84:87],v[228:231]
v_accvgpr_write_b32 a150,0
v_cndmask_b32 v20,v21,v20,s[44:45]
v_mfma_f32_16x16x32_bf16 v[236:239],a[200:203],a[88:91],v[236:239]
v_accvgpr_write_b32 a151,0
v_add_u32 v21,s42,v1
v_mfma_f32_16x16x32_bf16 v[236:239],a[204:207],a[92:95],v[236:239]
s_waitcnt lgkmcnt(6)
v_sub_u32 v16,3,v16
v_mul_u32_u24 v16,4160,v16
v_mfma_f32_16x16x32_bf16 v[52:55],a[208:211],a[64:67],v[52:55]
s_waitcnt vmcnt(13) lgkmcnt(0)
v_accvgpr_write_b32 a152,0
v_lshrrev_b32 v0,5,v7
v_mfma_f32_16x16x32_bf16 v[52:55],a[212:215],a[68:71],v[52:55]
s_barrier
v_lshlrev_b32 v17,2,v0
v_bfe_u32 v22,v7,2,2
v_mfma_f32_16x16x32_bf16 v[60:63],a[208:211],a[72:75],v[60:63]
ds_read_b64_tr_b16 a[192:193],v8 offset:49152
v_accvgpr_write_b32 a153,0
v_mfma_f32_16x16x32_bf16 v[60:63],a[212:215],a[76:79],v[60:63]
ds_read_b64_tr_b16 a[194:195],v8 offset:51200
v_add_u32 v17,v17,v22
v_mfma_f32_16x16x32_bf16 v[116:119],a[208:211],a[80:83],v[116:119]
ds_read_b64_tr_b16 a[196:197],v8 offset:53248
v_accvgpr_write_b32 a154,0
v_mfma_f32_16x16x32_bf16 v[116:119],a[212:215],a[84:87],v[116:119]
s_add_u32 m0,s69,131072
v_add_u32 v5,524288,v5
v_bfe_u32 v22,v7,4,1
v_mfma_f32_16x16x32_bf16 v[124:127],a[208:211],a[88:91],v[124:127]
ds_read_b64_tr_b16 a[198:199],v8 offset:55296
v_accvgpr_write_b32 a155,0
v_mfma_f32_16x16x32_bf16 v[124:127],a[212:215],a[92:95],v[124:127]
buffer_load_dwordx4 v5,s[12:15],s64 offen lds
v_mfma_f32_16x16x32_bf16 v[180:183],a[216:219],a[64:67],v[180:183]
ds_read_b64_tr_b16 a[200:201],v9 offset:49152
s_add_u32 m0,s69,132096
v_mfma_f32_16x16x32_bf16 v[180:183],a[220:223],a[68:71],v[180:183]
ds_read_b64_tr_b16 a[202:203],v9 offset:51200
v_accvgpr_write_b32 a156,0
v_mfma_f32_16x16x32_bf16 v[188:191],a[216:219],a[72:75],v[188:191]
ds_read_b64_tr_b16 a[204:205],v9 offset:53248
v_accvgpr_write_b32 a157,0
v_mfma_f32_16x16x32_bf16 v[188:191],a[220:223],a[76:79],v[188:191]
ds_read_b64_tr_b16 a[206:207],v9 offset:55296
v_lshlrev_b32 v31,1,v22
v_mfma_f32_16x16x32_bf16 v[244:247],a[216:219],a[80:83],v[244:247]
v_accvgpr_write_b32 a158,0
v_sub_u32 v17,v31,v17
v_mfma_f32_16x16x32_bf16 v[244:247],a[220:223],a[84:87],v[244:247]
buffer_load_dwordx4 v5,s[12:15],s65 offen lds
v_mfma_f32_16x16x32_bf16 v[252:255],a[216:219],a[88:91],v[252:255]
s_add_u32 m0,s69,133120
v_accvgpr_write_b32 a159,0
v_add_u32 v17,39,v17
v_mfma_f32_16x16x32_bf16 v[252:255],a[220:223],a[92:95],v[252:255]
buffer_load_dwordx4 v5,s[12:15],s66 offen lds
s_waitcnt lgkmcnt(6)
v_mfma_f32_16x16x32_bf16 a[160:163],a[192:195],a[32:35],a[160:163]
ds_read_b64_tr_b16 a[208:209],v10 offset:49152
s_add_u32 m0,s69,134144
s_waitcnt lgkmcnt(5)
v_mfma_f32_16x16x32_bf16 a[160:163],a[196:199],a[36:39],a[160:163]
ds_read_b64_tr_b16 a[210:211],v10 offset:51200
s_lshl_b32 s42,s40,5
v_mfma_f32_16x16x32_bf16 a[164:167],a[192:195],a[40:43],a[164:167]
ds_read_b64_tr_b16 a[212:213],v10 offset:53248
v_subrev_u32 v17,s42,v17
v_mfma_f32_16x16x32_bf16 a[164:167],a[196:199],a[44:47],a[164:167]
ds_read_b64_tr_b16 a[214:215],v10 offset:55296
v_lshl_add_u32 v16,v17,3,v16
v_mfma_f32_16x16x32_bf16 a[168:171],a[192:195],a[48:51],a[168:171]
ds_read_b128 a[64:67],v14 offset:0
v_add_u32 v16,s35,v16
v_mfma_f32_16x16x32_bf16 a[168:171],a[196:199],a[52:55],a[168:171]
buffer_load_dwordx4 v5,s[12:15],s67 offen lds
v_mfma_f32_16x16x32_bf16 a[172:175],a[192:195],a[56:59],a[172:175]
ds_read_b128 a[68:71],v15 offset:0
s_add_u32 m0,s68,32768
v_add_u32 v4,128,v4
v_mfma_f32_16x16x32_bf16 a[172:175],a[196:199],a[60:63],a[172:175]
buffer_load_dwordx4 v4,s[8:11],s56 offen lds
s_waitcnt lgkmcnt(8)
v_mfma_f32_16x16x32_bf16 v[68:71],a[200:203],a[32:35],v[68:71]
ds_read_b64_tr_b16 a[216:217],v11 offset:49152
s_add_u32 m0,s68,33792
s_waitcnt lgkmcnt(7)
v_mfma_f32_16x16x32_bf16 v[68:71],a[204:207],a[36:39],v[68:71]
ds_read_b64_tr_b16 a[218:219],v11 offset:51200
v_and_b32 v17,15,v7
v_mfma_f32_16x16x32_bf16 v[76:79],a[200:203],a[40:43],v[76:79]
ds_read_b64_tr_b16 a[220:221],v11 offset:53248
v_sub_u32 v17,v17,v0
v_mfma_f32_16x16x32_bf16 v[76:79],a[204:207],a[44:47],v[76:79]
ds_read_b64_tr_b16 a[222:223],v11 offset:55296
v_lshlrev_b32 v17,5,v17
v_mfma_f32_16x16x32_bf16 v[132:135],a[200:203],a[48:51],v[132:135]
ds_read_b128 a[72:75],v14 offset:2048
v_lshl_add_u32 v17,v22,4,v17
v_mfma_f32_16x16x32_bf16 v[132:135],a[204:207],a[52:55],v[132:135]
buffer_load_dwordx4 v4,s[8:11],s57 offen lds
v_mfma_f32_16x16x32_bf16 v[140:143],a[200:203],a[56:59],v[140:143]
ds_read_b128 a[76:79],v15 offset:2048
s_add_u32 m0,s68,34816
v_mfma_f32_16x16x32_bf16 v[140:143],a[204:207],a[60:63],v[140:143]
buffer_load_dwordx4 v4,s[8:11],s58 offen lds
s_waitcnt lgkmcnt(10)
v_mfma_f32_16x16x32_bf16 v[196:199],a[208:211],a[32:35],v[196:199]
ds_read_b64_tr_b16 a[192:193],v8 offset:57344
s_add_u32 m0,s68,35840
s_waitcnt lgkmcnt(9)
v_mfma_f32_16x16x32_bf16 v[196:199],a[212:215],a[36:39],v[196:199]
ds_read_b64_tr_b16 a[194:195],v8 offset:59392
s_lshl_b32 s42,s40,8
v_mfma_f32_16x16x32_bf16 v[204:207],a[208:211],a[40:43],v[204:207]
ds_read_b64_tr_b16 a[196:197],v8 offset:61440
s_sub_u32 s42,s41,s42
v_mfma_f32_16x16x32_bf16 v[204:207],a[212:215],a[44:47],v[204:207]
ds_read_b64_tr_b16 a[198:199],v8 offset:63488
s_add_u32 s42,s42,320
v_mfma_f32_16x16x32_bf16 v[84:87],a[208:211],a[48:51],v[84:87]
ds_read_b128 a[80:83],v14 offset:4096
v_add_u32 v17,s42,v17
v_mfma_f32_16x16x32_bf16 v[84:87],a[212:215],a[52:55],v[84:87]
buffer_load_dwordx4 v4,s[8:11],s59 offen lds
v_mfma_f32_16x16x32_bf16 v[92:95],a[208:211],a[56:59],v[92:95]
ds_read_b128 a[84:87],v15 offset:4096
s_add_u32 m0,s68,36864
v_mfma_f32_16x16x32_bf16 v[92:95],a[212:215],a[60:63],v[92:95]
s_lshl_b32 s42,s20,7
v_add_u32 v0,s42,v7
v_sub_u32 v0,447,v0
s_waitcnt lgkmcnt(10)
v_mfma_f32_16x16x32_bf16 v[148:151],a[216:219],a[32:35],v[148:151]
ds_read_b64_tr_b16 a[200:201],v9 offset:57344
v_lshlrev_b32 v0,3,v0
s_waitcnt lgkmcnt(9)
v_mfma_f32_16x16x32_bf16 v[148:151],a[220:223],a[36:39],v[148:151]
ds_read_b64_tr_b16 a[202:203],v9 offset:59392
v_add_u32 v0,65536,v0
v_mfma_f32_16x16x32_bf16 v[156:159],a[216:219],a[40:43],v[156:159]
ds_read_b64_tr_b16 a[204:205],v9 offset:61440
s_mul_i32 s42,s39,98304
v_mfma_f32_16x16x32_bf16 v[156:159],a[220:223],a[44:47],v[156:159]
ds_read_b64_tr_b16 a[206:207],v9 offset:63488
s_lshl_b32 s43,s40,13
v_mfma_f32_16x16x32_bf16 v[212:215],a[216:219],a[48:51],v[212:215]
ds_read_b128 a[88:91],v14 offset:6144
s_add_u32 s42,s42,s43
v_mfma_f32_16x16x32_bf16 v[212:215],a[220:223],a[52:55],v[212:215]
buffer_load_dwordx4 v4,s[8:11],s60 offen lds
v_mfma_f32_16x16x32_bf16 v[220:223],a[216:219],a[56:59],v[220:223]
ds_read_b128 a[92:95],v15 offset:6144
s_add_u32 m0,s68,37888
v_mfma_f32_16x16x32_bf16 v[220:223],a[220:223],a[60:63],v[220:223]
s_add_u32 s42,s42,49152
v_add_u32 v22,s42,v1
s_waitcnt lgkmcnt(10)
v_mfma_f32_16x16x32_bf16 v[36:39],a[192:195],a[32:35],v[36:39]
ds_read_b64_tr_b16 a[208:209],v10 offset:57344
s_waitcnt lgkmcnt(9)
v_mfma_f32_16x16x32_bf16 v[36:39],a[196:199],a[36:39],v[36:39]
ds_read_b64_tr_b16 a[210:211],v10 offset:59392
v_mfma_f32_16x16x32_bf16 v[44:47],a[192:195],a[40:43],v[44:47]
ds_read_b64_tr_b16 a[212:213],v10 offset:61440
v_mfma_f32_16x16x32_bf16 v[44:47],a[196:199],a[44:47],v[44:47]
ds_read_b64_tr_b16 a[214:215],v10 offset:63488
v_mfma_f32_16x16x32_bf16 v[100:103],a[192:195],a[48:51],v[100:103]
buffer_load_dwordx4 v4,s[8:11],s61 offen lds
v_mfma_f32_16x16x32_bf16 v[100:103],a[196:199],a[52:55],v[100:103]
s_add_u32 m0,s68,38912
v_mfma_f32_16x16x32_bf16 v[108:111],a[192:195],a[56:59],v[108:111]
buffer_load_dwordx4 v4,s[8:11],s62 offen lds
v_mfma_f32_16x16x32_bf16 v[108:111],a[196:199],a[60:63],v[108:111]
s_add_u32 m0,s68,39936
s_waitcnt lgkmcnt(8)
v_mfma_f32_16x16x32_bf16 v[164:167],a[200:203],a[32:35],v[164:167]
ds_read_b64_tr_b16 a[216:217],v11 offset:57344
s_waitcnt lgkmcnt(7)
v_mfma_f32_16x16x32_bf16 v[164:167],a[204:207],a[36:39],v[164:167]
ds_read_b64_tr_b16 a[218:219],v11 offset:59392
v_mfma_f32_16x16x32_bf16 v[172:175],a[200:203],a[40:43],v[172:175]
ds_read_b64_tr_b16 a[220:221],v11 offset:61440
v_mfma_f32_16x16x32_bf16 v[172:175],a[204:207],a[44:47],v[172:175]
ds_read_b64_tr_b16 a[222:223],v11 offset:63488
v_mfma_f32_16x16x32_bf16 v[228:231],a[200:203],a[48:51],v[228:231]
buffer_load_dwordx4 v4,s[8:11],s63 offen lds
v_mfma_f32_16x16x32_bf16 v[228:231],a[204:207],a[52:55],v[228:231]
v_mfma_f32_16x16x32_bf16 v[236:239],a[200:203],a[56:59],v[236:239]
s_getpc_b64 s[28:29]
F_W3:
s_sub_u32 s28,s28,F_W3-F_PC
s_subb_u32 s29,s29,0
v_accvgpr_read_b32 v30,a251
global_load_dword a249,v30,s[28:29]
v_mfma_f32_16x16x32_bf16 v[236:239],a[204:207],a[60:63],v[236:239]
s_waitcnt lgkmcnt(6)
v_mfma_f32_16x16x32_bf16 v[52:55],a[208:211],a[32:35],v[52:55]
s_waitcnt vmcnt(13) lgkmcnt(0)
v_mfma_f32_16x16x32_bf16 v[52:55],a[212:215],a[36:39],v[52:55]
s_barrier
v_mfma_f32_16x16x32_bf16 v[60:63],a[208:211],a[40:43],v[60:63]
ds_read_b64_tr_b16 a[192:193],v8 offset:0
v_mfma_f32_16x16x32_bf16 v[60:63],a[212:215],a[44:47],v[60:63]
ds_read_b64_tr_b16 a[194:195],v8 offset:2048
v_mfma_f32_16x16x32_bf16 v[116:119],a[208:211],a[48:51],v[116:119]
ds_read_b64_tr_b16 a[196:197],v8 offset:4096
v_mfma_f32_16x16x32_bf16 v[116:119],a[212:215],a[52:55],v[116:119]
s_add_u32 m0,s69,147456
v_add_u32 v5,524288,v5
v_mfma_f32_16x16x32_bf16 v[124:127],a[208:211],a[56:59],v[124:127]
ds_read_b64_tr_b16 a[198:199],v8 offset:6144
v_mfma_f32_16x16x32_bf16 v[124:127],a[212:215],a[60:63],v[124:127]
buffer_load_dwordx4 v5,s[12:15],s64 offen lds
v_mfma_f32_16x16x32_bf16 v[180:183],a[216:219],a[32:35],v[180:183]
ds_read_b64_tr_b16 a[200:201],v9 offset:0
s_add_u32 m0,s69,148480
v_mfma_f32_16x16x32_bf16 v[180:183],a[220:223],a[36:39],v[180:183]
ds_read_b64_tr_b16 a[202:203],v9 offset:2048
v_mfma_f32_16x16x32_bf16 v[188:191],a[216:219],a[40:43],v[188:191]
ds_read_b64_tr_b16 a[204:205],v9 offset:4096
v_mfma_f32_16x16x32_bf16 v[188:191],a[220:223],a[44:47],v[188:191]
ds_read_b64_tr_b16 a[206:207],v9 offset:6144
v_mfma_f32_16x16x32_bf16 v[244:247],a[216:219],a[48:51],v[244:247]
v_mfma_f32_16x16x32_bf16 v[244:247],a[220:223],a[52:55],v[244:247]
buffer_load_dwordx4 v5,s[12:15],s65 offen lds
v_mfma_f32_16x16x32_bf16 v[252:255],a[216:219],a[56:59],v[252:255]
buffer_load_dword v27,v26,s[16:19],s3 offen sc1
v_mfma_f32_16x16x32_bf16 v[252:255],a[220:223],a[60:63],v[252:255]
s_add_u32 m0,s69,149504
s_waitcnt lgkmcnt(6)
v_mfma_f32_16x16x32_bf16 a[160:163],a[192:195],a[64:67],a[160:163]
buffer_load_dwordx4 v5,s[12:15],s66 offen lds
s_waitcnt lgkmcnt(4)
v_mfma_f32_16x16x32_bf16 a[160:163],a[196:199],a[68:71],a[160:163]
ds_read_b64_tr_b16 a[208:209],v10 offset:0
s_add_u32 m0,s69,150528
v_mfma_f32_16x16x32_bf16 a[164:167],a[192:195],a[72:75],a[164:167]
ds_read_b64_tr_b16 a[210:211],v10 offset:2048
s_mov_b32 s94,s74
v_mfma_f32_16x16x32_bf16 a[164:167],a[196:199],a[76:79],a[164:167]
ds_read_b64_tr_b16 a[212:213],v10 offset:4096
s_mov_b32 s95,s75
v_mfma_f32_16x16x32_bf16 a[168:171],a[192:195],a[80:83],a[168:171]
ds_read_b64_tr_b16 a[214:215],v10 offset:6144
s_mov_b32 s8,s16
v_mfma_f32_16x16x32_bf16 a[168:171],a[196:199],a[84:87],a[168:171]
ds_read_b128 a[32:35],v12 offset:0
s_mov_b32 s9,s17
v_mfma_f32_16x16x32_bf16 a[172:175],a[192:195],a[88:91],a[172:175]
buffer_load_dwordx4 v5,s[12:15],s67 offen lds
v_mfma_f32_16x16x32_bf16 a[172:175],a[196:199],a[92:95],a[172:175]
ds_read_b128 a[36:39],v13 offset:0
s_add_u32 s10,s32,4096
s_waitcnt lgkmcnt(8)
v_mfma_f32_16x16x32_bf16 v[68:71],a[200:203],a[64:67],v[68:71]
ds_read_b64_tr_b16 a[216:217],v11 offset:0
s_waitcnt lgkmcnt(7)
v_mfma_f32_16x16x32_bf16 v[68:71],a[204:207],a[68:71],v[68:71]
ds_read_b64_tr_b16 a[218:219],v11 offset:2048
v_mfma_f32_16x16x32_bf16 v[76:79],a[200:203],a[72:75],v[76:79]
ds_read_b64_tr_b16 a[220:221],v11 offset:4096
v_mfma_f32_16x16x32_bf16 v[76:79],a[204:207],a[76:79],v[76:79]
ds_read_b64_tr_b16 a[222:223],v11 offset:6144
v_mfma_f32_16x16x32_bf16 v[132:135],a[200:203],a[80:83],v[132:135]
ds_read_b128 a[40:43],v12 offset:2048
v_mfma_f32_16x16x32_bf16 v[132:135],a[204:207],a[84:87],v[132:135]
v_mfma_f32_16x16x32_bf16 v[140:143],a[200:203],a[88:91],v[140:143]
ds_read_b128 a[44:47],v13 offset:2048
v_mfma_f32_16x16x32_bf16 v[140:143],a[204:207],a[92:95],v[140:143]
s_waitcnt lgkmcnt(8)
v_mfma_f32_16x16x32_bf16 v[196:199],a[208:211],a[64:67],v[196:199]
ds_read_b64_tr_b16 a[192:193],v8 offset:8192
v_mfma_f32_16x16x32_bf16 v[196:199],a[212:215],a[68:71],v[196:199]
ds_read_b64_tr_b16 a[194:195],v8 offset:10240
v_mfma_f32_16x16x32_bf16 v[204:207],a[208:211],a[72:75],v[204:207]
ds_read_b64_tr_b16 a[196:197],v8 offset:12288
v_mfma_f32_16x16x32_bf16 v[204:207],a[212:215],a[76:79],v[204:207]
ds_read_b64_tr_b16 a[198:199],v8 offset:14336
v_mfma_f32_16x16x32_bf16 v[84:87],a[208:211],a[80:83],v[84:87]
ds_read_b128 a[48:51],v12 offset:4096
v_mfma_f32_16x16x32_bf16 v[84:87],a[212:215],a[84:87],v[84:87]
s_waitcnt lgkmcnt(9)
v_mfma_f32_16x16x32_bf16 v[92:95],a[208:211],a[88:91],v[92:95]
ds_read_b128 a[52:55],v13 offset:4096
v_mfma_f32_16x16x32_bf16 v[92:95],a[212:215],a[92:95],v[92:95]
buffer_store_dwordx4 v[64:67],v1,s[16:19],s50 offen offset:0 sc1
v_mfma_f32_16x16x32_bf16 v[148:151],a[216:219],a[64:67],v[148:151]
ds_read_b64_tr_b16 a[200:201],v9 offset:8192
s_waitcnt lgkmcnt(9)
v_mfma_f32_16x16x32_bf16 v[148:151],a[220:223],a[68:71],v[148:151]
ds_read_b64_tr_b16 a[202:203],v9 offset:10240
v_mfma_f32_16x16x32_bf16 v[156:159],a[216:219],a[72:75],v[156:159]
ds_read_b64_tr_b16 a[204:205],v9 offset:12288
v_mfma_f32_16x16x32_bf16 v[156:159],a[220:223],a[76:79],v[156:159]
ds_read_b64_tr_b16 a[206:207],v9 offset:14336
v_mfma_f32_16x16x32_bf16 v[212:215],a[216:219],a[80:83],v[212:215]
ds_read_b128 a[56:59],v12 offset:6144
v_mfma_f32_16x16x32_bf16 v[212:215],a[220:223],a[84:87],v[212:215]
v_mfma_f32_16x16x32_bf16 v[220:223],a[216:219],a[88:91],v[220:223]
ds_read_b128 a[60:63],v13 offset:6144
v_mfma_f32_16x16x32_bf16 v[220:223],a[220:223],a[92:95],v[220:223]
s_waitcnt lgkmcnt(8)
v_mfma_f32_16x16x32_bf16 v[36:39],a[192:195],a[64:67],v[36:39]
ds_read_b64_tr_b16 a[208:209],v10 offset:8192
v_mfma_f32_16x16x32_bf16 v[36:39],a[196:199],a[68:71],v[36:39]
ds_read_b64_tr_b16 a[210:211],v10 offset:10240
v_mfma_f32_16x16x32_bf16 v[44:47],a[192:195],a[72:75],v[44:47]
ds_read_b64_tr_b16 a[212:213],v10 offset:12288
v_mfma_f32_16x16x32_bf16 v[44:47],a[196:199],a[76:79],v[44:47]
ds_read_b64_tr_b16 a[214:215],v10 offset:14336
v_mfma_f32_16x16x32_bf16 v[100:103],a[192:195],a[80:83],v[100:103]
v_mfma_f32_16x16x32_bf16 v[100:103],a[196:199],a[84:87],v[100:103]
v_mfma_f32_16x16x32_bf16 v[108:111],a[192:195],a[88:91],v[108:111]
v_mfma_f32_16x16x32_bf16 v[108:111],a[196:199],a[92:95],v[108:111]
s_waitcnt lgkmcnt(6)
v_mfma_f32_16x16x32_bf16 v[164:167],a[200:203],a[64:67],v[164:167]
ds_read_b64_tr_b16 a[216:217],v11 offset:8192
v_mfma_f32_16x16x32_bf16 v[164:167],a[204:207],a[68:71],v[164:167]
ds_read_b64_tr_b16 a[218:219],v11 offset:10240
v_mfma_f32_16x16x32_bf16 v[172:175],a[200:203],a[72:75],v[172:175]
ds_read_b64_tr_b16 a[220:221],v11 offset:12288
v_mfma_f32_16x16x32_bf16 v[172:175],a[204:207],a[76:79],v[172:175]
ds_read_b64_tr_b16 a[222:223],v11 offset:14336
v_mfma_f32_16x16x32_bf16 v[228:231],a[200:203],a[80:83],v[228:231]
v_mfma_f32_16x16x32_bf16 v[228:231],a[204:207],a[84:87],v[228:231]
v_mfma_f32_16x16x32_bf16 v[236:239],a[200:203],a[88:91],v[236:239]
v_mfma_f32_16x16x32_bf16 v[236:239],a[204:207],a[92:95],v[236:239]
s_waitcnt lgkmcnt(6)
v_mfma_f32_16x16x32_bf16 v[52:55],a[208:211],a[64:67],v[52:55]
s_waitcnt vmcnt(3) lgkmcnt(0)
v_mfma_f32_16x16x32_bf16 v[52:55],a[212:215],a[68:71],v[52:55]
s_barrier
v_cmp_gt_u32 vcc,1,v27
s_nop 0
s_cbranch_vccnz F_P1_S
F_P1_R:
v_mfma_f32_16x16x32_bf16 v[60:63],a[208:211],a[72:75],v[60:63]
ds_read_b64_tr_b16 a[192:193],v8 offset:32768
v_mfma_f32_16x16x32_bf16 v[60:63],a[212:215],a[76:79],v[60:63]
ds_read_b64_tr_b16 a[194:195],v8 offset:34816
v_mfma_f32_16x16x32_bf16 v[116:119],a[208:211],a[80:83],v[116:119]
s_add_u32 m0,s34,0
ds_read_b64_tr_b16 a[196:197],v8 offset:36864
v_mfma_f32_16x16x32_bf16 v[116:119],a[212:215],a[84:87],v[116:119]
ds_read_b64_tr_b16 a[198:199],v8 offset:38912
v_mfma_f32_16x16x32_bf16 v[124:127],a[208:211],a[88:91],v[124:127]
buffer_store_dwordx4 v[72:75],v1,s[16:19],s51 offen offset:0 sc1
v_mfma_f32_16x16x32_bf16 v[124:127],a[212:215],a[92:95],v[124:127]
buffer_load_dwordx4 v1,s[8:11],s32 offen offset:0 sc1 lds
v_mfma_f32_16x16x32_bf16 v[180:183],a[216:219],a[64:67],v[180:183]
ds_read_b64_tr_b16 a[200:201],v9 offset:32768
v_mfma_f32_16x16x32_bf16 v[180:183],a[220:223],a[68:71],v[180:183]
ds_read_b64_tr_b16 a[202:203],v9 offset:34816
v_mfma_f32_16x16x32_bf16 v[188:191],a[216:219],a[72:75],v[188:191]
ds_read_b64_tr_b16 a[204:205],v9 offset:36864
v_mfma_f32_16x16x32_bf16 v[188:191],a[220:223],a[76:79],v[188:191]
ds_read_b64_tr_b16 a[206:207],v9 offset:38912
v_mfma_f32_16x16x32_bf16 v[244:247],a[216:219],a[80:83],v[244:247]
v_mfma_f32_16x16x32_bf16 v[244:247],a[220:223],a[84:87],v[244:247]
buffer_load_dwordx4 v1,s[8:11],s32 offen offset:1024 sc1 lds
v_mfma_f32_16x16x32_bf16 v[252:255],a[216:219],a[88:91],v[252:255]
s_waitcnt lgkmcnt(4)
v_mfma_f32_16x16x32_bf16 v[252:255],a[220:223],a[92:95],v[252:255]
buffer_load_dwordx4 v1,s[8:11],s32 offen offset:2048 sc1 lds
v_mfma_f32_16x16x32_bf16 a[160:163],a[192:195],a[32:35],a[160:163]
ds_read_b64_tr_b16 a[208:209],v10 offset:32768
v_mfma_f32_16x16x32_bf16 a[160:163],a[196:199],a[36:39],a[160:163]
ds_read_b64_tr_b16 a[210:211],v10 offset:34816
v_mfma_f32_16x16x32_bf16 a[164:167],a[192:195],a[40:43],a[164:167]
ds_read_b64_tr_b16 a[212:213],v10 offset:36864
v_mfma_f32_16x16x32_bf16 a[164:167],a[196:199],a[44:47],a[164:167]
ds_read_b64_tr_b16 a[214:215],v10 offset:38912
v_mfma_f32_16x16x32_bf16 a[168:171],a[192:195],a[48:51],a[168:171]
ds_read_b128 a[64:67],v12 offset:32768
v_mfma_f32_16x16x32_bf16 a[168:171],a[196:199],a[52:55],a[168:171]
buffer_load_dwordx4 v1,s[8:11],s32 offen offset:3072 sc1 lds
v_mfma_f32_16x16x32_bf16 a[172:175],a[192:195],a[56:59],a[172:175]
ds_read_b128 a[68:71],v13 offset:32768
s_add_u32 m0,s34,8320
v_mfma_f32_16x16x32_bf16 a[172:175],a[196:199],a[60:63],a[172:175]
buffer_load_dwordx4 v1,s[8:11],s33 offen offset:0 sc1 lds
s_waitcnt lgkmcnt(8)
v_mfma_f32_16x16x32_bf16 v[68:71],a[200:203],a[32:35],v[68:71]
ds_read_b64_tr_b16 a[216:217],v11 offset:32768
s_waitcnt lgkmcnt(7)
v_mfma_f32_16x16x32_bf16 v[68:71],a[204:207],a[36:39],v[68:71]
ds_read_b64_tr_b16 a[218:219],v11 offset:34816
v_mfma_f32_16x16x32_bf16 v[76:79],a[200:203],a[40:43],v[76:79]
ds_read_b64_tr_b16 a[220:221],v11 offset:36864
v_mfma_f32_16x16x32_bf16 v[76:79],a[204:207],a[44:47],v[76:79]
ds_read_b64_tr_b16 a[222:223],v11 offset:38912
v_mfma_f32_16x16x32_bf16 v[132:135],a[200:203],a[48:51],v[132:135]
ds_read_b128 a[72:75],v12 offset:34816
v_mfma_f32_16x16x32_bf16 v[132:135],a[204:207],a[52:55],v[132:135]
buffer_load_dwordx4 v1,s[8:11],s33 offen offset:1024 sc1 lds
v_mfma_f32_16x16x32_bf16 v[140:143],a[200:203],a[56:59],v[140:143]
ds_read_b128 a[76:79],v13 offset:34816
v_mfma_f32_16x16x32_bf16 v[140:143],a[204:207],a[60:63],v[140:143]
buffer_load_dwordx4 v1,s[8:11],s33 offen offset:2048 sc1 lds
s_waitcnt lgkmcnt(10)
v_mfma_f32_16x16x32_bf16 v[196:199],a[208:211],a[32:35],v[196:199]
buffer_store_dwordx4 v[80:83],v1,s[16:19],s50 offen offset:1024 sc1
s_waitcnt lgkmcnt(8)
v_mfma_f32_16x16x32_bf16 v[196:199],a[212:215],a[36:39],v[196:199]
ds_read_b64_tr_b16 a[192:193],v8 offset:40960
v_mfma_f32_16x16x32_bf16 v[204:207],a[208:211],a[40:43],v[204:207]
ds_read_b64_tr_b16 a[194:195],v8 offset:43008
v_mfma_f32_16x16x32_bf16 v[204:207],a[212:215],a[44:47],v[204:207]
ds_read_b64_tr_b16 a[196:197],v8 offset:45056
v_mfma_f32_16x16x32_bf16 v[84:87],a[208:211],a[48:51],v[84:87]
ds_read_b64_tr_b16 a[198:199],v8 offset:47104
v_mfma_f32_16x16x32_bf16 v[84:87],a[212:215],a[52:55],v[84:87]
ds_read_b128 a[80:83],v12 offset:36864
v_mfma_f32_16x16x32_bf16 v[92:95],a[208:211],a[56:59],v[92:95]
buffer_load_dwordx4 v1,s[8:11],s33 offen offset:3072 sc1 lds
v_mfma_f32_16x16x32_bf16 v[92:95],a[212:215],a[60:63],v[92:95]
ds_read_b128 a[84:87],v13 offset:36864
s_add_u32 m0,s23,0
s_waitcnt lgkmcnt(10)
v_mfma_f32_16x16x32_bf16 v[148:151],a[216:219],a[32:35],v[148:151]
ds_write_b128 v21,a[240:243] offset:512
s_waitcnt lgkmcnt(9)
v_mfma_f32_16x16x32_bf16 v[148:151],a[220:223],a[36:39],v[148:151]
ds_read_b64_tr_b16 a[200:201],v9 offset:40960
s_add_u32 s24,s24,16384
v_mfma_f32_16x16x32_bf16 v[156:159],a[216:219],a[40:43],v[156:159]
ds_read_b64_tr_b16 a[202:203],v9 offset:43008
v_mfma_f32_16x16x32_bf16 v[156:159],a[220:223],a[44:47],v[156:159]
ds_read_b64_tr_b16 a[204:205],v9 offset:45056
v_mfma_f32_16x16x32_bf16 v[212:215],a[216:219],a[48:51],v[212:215]
ds_read_b64_tr_b16 a[206:207],v9 offset:47104
v_mfma_f32_16x16x32_bf16 v[212:215],a[220:223],a[52:55],v[212:215]
ds_read_b128 a[88:91],v12 offset:38912
v_mfma_f32_16x16x32_bf16 v[220:223],a[216:219],a[56:59],v[220:223]
buffer_load_dwordx4 v1,s[16:19],s24 offen offset:0 sc1 lds
v_mfma_f32_16x16x32_bf16 v[220:223],a[220:223],a[60:63],v[220:223]
ds_read_b128 a[92:95],v13 offset:38912
s_waitcnt lgkmcnt(11)
v_mfma_f32_16x16x32_bf16 v[36:39],a[192:195],a[32:35],v[36:39]
ds_write_b128 v21,a[244:247] offset:1536
s_waitcnt lgkmcnt(10)
v_mfma_f32_16x16x32_bf16 v[36:39],a[196:199],a[36:39],v[36:39]
ds_read_b64_tr_b16 a[208:209],v10 offset:40960
v_mfma_f32_16x16x32_bf16 v[44:47],a[192:195],a[40:43],v[44:47]
ds_read_b64_tr_b16 a[210:211],v10 offset:43008
v_mfma_f32_16x16x32_bf16 v[44:47],a[196:199],a[44:47],v[44:47]
ds_read_b64_tr_b16 a[212:213],v10 offset:45056
v_mfma_f32_16x16x32_bf16 v[100:103],a[192:195],a[48:51],v[100:103]
ds_read_b64_tr_b16 a[214:215],v10 offset:47104
v_mfma_f32_16x16x32_bf16 v[100:103],a[196:199],a[52:55],v[100:103]
buffer_load_dwordx4 v1,s[16:19],s24 offen offset:1024 sc1 lds
v_mfma_f32_16x16x32_bf16 v[108:111],a[192:195],a[56:59],v[108:111]
ds_write_b128 v20,a[96:99]
v_mfma_f32_16x16x32_bf16 v[108:111],a[196:199],a[60:63],v[108:111]
buffer_load_dwordx4 v1,s[16:19],s24 offen offset:2048 sc1 lds
s_waitcnt lgkmcnt(10)
v_mfma_f32_16x16x32_bf16 v[164:167],a[200:203],a[32:35],v[164:167]
buffer_store_dwordx4 v[88:91],v1,s[16:19],s51 offen offset:1024 sc1
s_waitcnt lgkmcnt(8)
v_mfma_f32_16x16x32_bf16 v[164:167],a[204:207],a[36:39],v[164:167]
ds_read_b64_tr_b16 a[216:217],v11 offset:40960
v_mfma_f32_16x16x32_bf16 v[172:175],a[200:203],a[40:43],v[172:175]
ds_read_b64_tr_b16 a[218:219],v11 offset:43008
v_mov_b32 v2,v1
v_mfma_f32_16x16x32_bf16 v[172:175],a[204:207],a[44:47],v[172:175]
ds_read_b64_tr_b16 a[220:221],v11 offset:45056
s_and_b32 s28,s20,1
v_mfma_f32_16x16x32_bf16 v[228:231],a[200:203],a[48:51],v[228:231]
ds_read_b64_tr_b16 a[222:223],v11 offset:47104
s_lshl_b32 s28,s28,14
v_mfma_f32_16x16x32_bf16 v[228:231],a[204:207],a[52:55],v[228:231]
buffer_load_dwordx4 v1,s[16:19],s24 offen offset:3072 sc1 lds
v_mfma_f32_16x16x32_bf16 v[236:239],a[200:203],a[56:59],v[236:239]
v_add_u32 v3,s28,v1
v_add_u32 v4,65536,v2
v_mfma_f32_16x16x32_bf16 v[236:239],a[204:207],a[60:63],v[236:239]
s_waitcnt lgkmcnt(7)
v_add_u32 v5,65536,v3
v_mov_b32 v6,0xff800000
v_mfma_f32_16x16x32_bf16 v[52:55],a[208:211],a[32:35],v[52:55]
s_waitcnt vmcnt(16) lgkmcnt(0)
s_lshl_b32 s42,s20,11
s_add_u32 s42,s42,49152
v_mfma_f32_16x16x32_bf16 v[52:55],a[212:215],a[36:39],v[52:55]
s_barrier
v_and_b32 v20,3,v7
v_lshlrev_b32 v20,4,v20
v_mfma_f32_16x16x32_bf16 v[60:63],a[208:211],a[40:43],v[60:63]
ds_read_b64_tr_b16 a[192:193],v8 offset:49152
v_lshrrev_b32 v21,2,v7
v_mfma_f32_16x16x32_bf16 v[60:63],a[212:215],a[44:47],v[60:63]
ds_read_b64_tr_b16 a[194:195],v8 offset:51200
v_add_lshl_u32 v20,v20,v21,4
v_mfma_f32_16x16x32_bf16 v[116:119],a[208:211],a[48:51],v[116:119]
s_add_u32 m0,s23,32768
ds_read_b64_tr_b16 a[196:197],v8 offset:53248
v_mfma_f32_16x16x32_bf16 v[116:119],a[212:215],a[52:55],v[116:119]
s_add_u32 s24,s24,16384
ds_read_b64_tr_b16 a[198:199],v8 offset:55296
v_mfma_f32_16x16x32_bf16 v[124:127],a[208:211],a[56:59],v[124:127]
v_add_u32 v20,s42,v20
v_add_u32 v21,98304,v20
v_mfma_f32_16x16x32_bf16 v[124:127],a[212:215],a[60:63],v[124:127]
buffer_load_dwordx4 v1,s[16:19],s24 offen offset:0 sc1 lds
v_mfma_f32_16x16x32_bf16 v[180:183],a[216:219],a[32:35],v[180:183]
ds_read_b64_tr_b16 a[200:201],v9 offset:49152
v_mfma_f32_16x16x32_bf16 v[180:183],a[220:223],a[36:39],v[180:183]
ds_read_b64_tr_b16 a[202:203],v9 offset:51200
v_mfma_f32_16x16x32_bf16 v[188:191],a[216:219],a[40:43],v[188:191]
ds_read_b64_tr_b16 a[204:205],v9 offset:53248
v_mfma_f32_16x16x32_bf16 v[188:191],a[220:223],a[44:47],v[188:191]
ds_read_b64_tr_b16 a[206:207],v9 offset:55296
v_mfma_f32_16x16x32_bf16 v[244:247],a[216:219],a[48:51],v[244:247]
buffer_store_dwordx4 v[96:99],v1,s[16:19],s50 offen offset:2048 sc1
v_mfma_f32_16x16x32_bf16 v[244:247],a[220:223],a[52:55],v[244:247]
buffer_load_dwordx4 v1,s[16:19],s24 offen offset:1024 sc1 lds
v_mfma_f32_16x16x32_bf16 v[252:255],a[216:219],a[56:59],v[252:255]
s_waitcnt lgkmcnt(4)
v_mfma_f32_16x16x32_bf16 v[252:255],a[220:223],a[60:63],v[252:255]
buffer_load_dwordx4 v1,s[16:19],s24 offen offset:2048 sc1 lds
v_mfma_f32_16x16x32_bf16 a[160:163],a[192:195],a[64:67],a[160:163]
ds_read_b64_tr_b16 a[208:209],v10 offset:49152
v_mfma_f32_16x16x32_bf16 a[160:163],a[196:199],a[68:71],a[160:163]
ds_read_b64_tr_b16 a[210:211],v10 offset:51200
v_mfma_f32_16x16x32_bf16 a[164:167],a[192:195],a[72:75],a[164:167]
ds_read_b64_tr_b16 a[212:213],v10 offset:53248
v_mfma_f32_16x16x32_bf16 a[164:167],a[196:199],a[76:79],a[164:167]
ds_read_b64_tr_b16 a[214:215],v10 offset:55296
v_mfma_f32_16x16x32_bf16 a[168:171],a[192:195],a[80:83],a[168:171]
v_mfma_f32_16x16x32_bf16 a[168:171],a[196:199],a[84:87],a[168:171]
buffer_load_dwordx4 v1,s[16:19],s24 offen offset:3072 sc1 lds
v_mfma_f32_16x16x32_bf16 a[172:175],a[192:195],a[88:91],a[172:175]
v_mfma_f32_16x16x32_bf16 a[172:175],a[196:199],a[92:95],a[172:175]
s_waitcnt lgkmcnt(4)
v_mfma_f32_16x16x32_bf16 v[68:71],a[200:203],a[64:67],v[68:71]
ds_read_b64_tr_b16 a[216:217],v11 offset:49152
v_mfma_f32_16x16x32_bf16 v[68:71],a[204:207],a[68:71],v[68:71]
ds_read_b64_tr_b16 a[218:219],v11 offset:51200
v_mfma_f32_16x16x32_bf16 v[76:79],a[200:203],a[72:75],v[76:79]
ds_read_b64_tr_b16 a[220:221],v11 offset:53248
v_mfma_f32_16x16x32_bf16 v[76:79],a[204:207],a[76:79],v[76:79]
ds_read_b64_tr_b16 a[222:223],v11 offset:55296
v_mfma_f32_16x16x32_bf16 v[132:135],a[200:203],a[80:83],v[132:135]
v_mfma_f32_16x16x32_bf16 v[132:135],a[204:207],a[84:87],v[132:135]
v_mfma_f32_16x16x32_bf16 v[140:143],a[200:203],a[88:91],v[140:143]
s_waitcnt lgkmcnt(4)
v_accvgpr_read_b32 v32,a160
v_accvgpr_read_b32 v33,a161
v_mfma_f32_16x16x32_bf16 v[140:143],a[204:207],a[92:95],v[140:143]
buffer_store_dwordx4 v[104:107],v1,s[16:19],s51 offen offset:2048 sc1
v_mfma_f32_16x16x32_bf16 v[196:199],a[208:211],a[64:67],v[196:199]
ds_read_b64_tr_b16 a[192:193],v8 offset:57344
v_accvgpr_read_b32 v34,a162
v_mfma_f32_16x16x32_bf16 v[196:199],a[212:215],a[68:71],v[196:199]
ds_read_b64_tr_b16 a[194:195],v8 offset:59392
v_accvgpr_read_b32 v35,a163
v_mfma_f32_16x16x32_bf16 v[204:207],a[208:211],a[72:75],v[204:207]
ds_read_b64_tr_b16 a[196:197],v8 offset:61440
v_mul_f32 v32,s70,v32
v_mfma_f32_16x16x32_bf16 v[204:207],a[212:215],a[76:79],v[204:207]
ds_read_b64_tr_b16 a[198:199],v8 offset:63488
v_mul_f32 v33,s70,v33
v_mfma_f32_16x16x32_bf16 v[84:87],a[208:211],a[80:83],v[84:87]
v_mul_f32 v34,s70,v34
v_mul_f32 v35,s70,v35
v_mfma_f32_16x16x32_bf16 v[84:87],a[212:215],a[84:87],v[84:87]
v_mul_f32 v68,s70,v68
v_mul_f32 v69,s70,v69
v_mfma_f32_16x16x32_bf16 v[92:95],a[208:211],a[88:91],v[92:95]
v_mul_f32 v70,s70,v70
v_mul_f32 v71,s70,v71
v_mfma_f32_16x16x32_bf16 v[92:95],a[212:215],a[92:95],v[92:95]
s_waitcnt lgkmcnt(4)
v_cvt_pk_bf16_f32 v32,v32,v33
v_cvt_pk_bf16_f32 v33,v34,v35
v_mfma_f32_16x16x32_bf16 v[148:151],a[216:219],a[64:67],v[148:151]
ds_read_b64_tr_b16 a[200:201],v9 offset:57344
v_cvt_pk_bf16_f32 v34,v68,v69
v_mfma_f32_16x16x32_bf16 v[148:151],a[220:223],a[68:71],v[148:151]
ds_read_b64_tr_b16 a[202:203],v9 offset:59392
v_cvt_pk_bf16_f32 v35,v70,v71
v_mfma_f32_16x16x32_bf16 v[156:159],a[216:219],a[72:75],v[156:159]
ds_read_b64_tr_b16 a[204:205],v9 offset:61440
v_accvgpr_write_b32 a0,v32
v_mfma_f32_16x16x32_bf16 v[156:159],a[220:223],a[76:79],v[156:159]
ds_read_b64_tr_b16 a[206:207],v9 offset:63488
v_accvgpr_write_b32 a1,v33
v_mfma_f32_16x16x32_bf16 v[212:215],a[216:219],a[80:83],v[212:215]
v_accvgpr_write_b32 a2,v34
v_accvgpr_write_b32 a3,v35
v_mfma_f32_16x16x32_bf16 v[212:215],a[220:223],a[84:87],v[212:215]
ds_write_b128 v18,v[32:35] offset:0
v_mfma_f32_16x16x32_bf16 v[220:223],a[216:219],a[88:91],v[220:223]
v_accvgpr_read_b32 v40,a164
v_accvgpr_read_b32 v41,a165
v_mfma_f32_16x16x32_bf16 v[220:223],a[220:223],a[92:95],v[220:223]
s_waitcnt lgkmcnt(5)
v_accvgpr_read_b32 v42,a166
v_accvgpr_read_b32 v43,a167
v_mfma_f32_16x16x32_bf16 v[36:39],a[192:195],a[64:67],v[36:39]
ds_read_b64_tr_b16 a[208:209],v10 offset:57344
v_mul_f32 v40,s70,v40
v_mfma_f32_16x16x32_bf16 v[36:39],a[196:199],a[68:71],v[36:39]
ds_read_b64_tr_b16 a[210:211],v10 offset:59392
v_mul_f32 v41,s70,v41
v_mfma_f32_16x16x32_bf16 v[44:47],a[192:195],a[72:75],v[44:47]
ds_read_b64_tr_b16 a[212:213],v10 offset:61440
v_mul_f32 v42,s70,v42
v_mfma_f32_16x16x32_bf16 v[44:47],a[196:199],a[76:79],v[44:47]
ds_read_b64_tr_b16 a[214:215],v10 offset:63488
v_mul_f32 v43,s70,v43
v_mfma_f32_16x16x32_bf16 v[100:103],a[192:195],a[80:83],v[100:103]
v_mul_f32 v76,s70,v76
v_mul_f32 v77,s70,v77
v_mfma_f32_16x16x32_bf16 v[100:103],a[196:199],a[84:87],v[100:103]
v_mul_f32 v78,s70,v78
v_mul_f32 v79,s70,v79
v_mfma_f32_16x16x32_bf16 v[108:111],a[192:195],a[88:91],v[108:111]
s_waitcnt lgkmcnt(5)
v_cvt_pk_bf16_f32 v40,v40,v41
v_cvt_pk_bf16_f32 v41,v42,v43
v_mfma_f32_16x16x32_bf16 v[108:111],a[196:199],a[92:95],v[108:111]
buffer_store_dwordx4 v[112:115],v1,s[16:19],s50 offen offset:3072 sc1
v_mfma_f32_16x16x32_bf16 v[164:167],a[200:203],a[64:67],v[164:167]
ds_read_b64_tr_b16 a[216:217],v11 offset:57344
v_cvt_pk_bf16_f32 v42,v76,v77
v_mfma_f32_16x16x32_bf16 v[164:167],a[204:207],a[68:71],v[164:167]
ds_read_b64_tr_b16 a[218:219],v11 offset:59392
v_cvt_pk_bf16_f32 v43,v78,v79
v_mfma_f32_16x16x32_bf16 v[172:175],a[200:203],a[72:75],v[172:175]
ds_read_b64_tr_b16 a[220:221],v11 offset:61440
v_accvgpr_write_b32 a16,v40
v_mfma_f32_16x16x32_bf16 v[172:175],a[204:207],a[76:79],v[172:175]
ds_read_b64_tr_b16 a[222:223],v11 offset:63488
v_accvgpr_write_b32 a17,v41
v_mfma_f32_16x16x32_bf16 v[228:231],a[200:203],a[80:83],v[228:231]
v_accvgpr_write_b32 a18,v42
v_accvgpr_write_b32 a19,v43
v_mfma_f32_16x16x32_bf16 v[228:231],a[204:207],a[84:87],v[228:231]
ds_write_b128 v18,v[40:43] offset:4096
v_mfma_f32_16x16x32_bf16 v[236:239],a[200:203],a[88:91],v[236:239]
v_accvgpr_read_b32 v48,a168
v_accvgpr_read_b32 v49,a169
v_accvgpr_read_b32 v50,a170
v_accvgpr_read_b32 v51,a171
v_mul_f32 v48,s70,v48
v_mul_f32 v49,s70,v49
v_mul_f32 v50,s70,v50
v_mul_f32 v51,s70,v51
v_mul_f32 v132,s70,v132
v_mul_f32 v133,s70,v133
v_mul_f32 v134,s70,v134
v_mul_f32 v135,s70,v135
v_cvt_pk_bf16_f32 v48,v48,v49
v_cvt_pk_bf16_f32 v49,v50,v51
v_cvt_pk_bf16_f32 v50,v132,v133
v_cvt_pk_bf16_f32 v51,v134,v135
v_accvgpr_write_b32 a32,v48
v_accvgpr_write_b32 a33,v49
v_accvgpr_write_b32 a34,v50
v_accvgpr_write_b32 a35,v51
v_accvgpr_read_b32 v56,a172
v_accvgpr_read_b32 v57,a173
v_accvgpr_read_b32 v58,a174
v_accvgpr_read_b32 v59,a175
v_mfma_f32_16x16x32_bf16 v[236:239],a[204:207],a[92:95],v[236:239]
s_waitcnt vmcnt(7) lgkmcnt(0)
v_mul_f32 v56,s70,v56
v_mul_f32 v57,s70,v57
v_mfma_f32_16x16x32_bf16 v[52:55],a[208:211],a[64:67],v[52:55]
s_barrier
v_mul_f32 v58,s70,v58
v_mul_f32 v59,s70,v59
v_mfma_f32_16x16x32_bf16 v[52:55],a[212:215],a[68:71],v[52:55]
ds_read_b64 a[160:161],v16 offset:3776
v_mul_f32 v140,s70,v140
v_mfma_f32_16x16x32_bf16 v[60:63],a[208:211],a[72:75],v[60:63]
ds_read_b64 a[162:163],v16 offset:3784
v_mul_f32 v141,s70,v141
v_mfma_f32_16x16x32_bf16 v[60:63],a[212:215],a[76:79],v[60:63]
ds_read_b128 a[224:227],v17 offset:192
v_mul_f32 v142,s70,v142
v_mfma_f32_16x16x32_bf16 v[116:119],a[208:211],a[80:83],v[116:119]
ds_read_b64 a[164:165],v16 offset:3264
v_mul_f32 v143,s70,v143
v_mfma_f32_16x16x32_bf16 v[116:119],a[212:215],a[84:87],v[116:119]
ds_read_b64 a[166:167],v16 offset:3272
v_cvt_pk_bf16_f32 v56,v56,v57
v_mfma_f32_16x16x32_bf16 v[124:127],a[208:211],a[88:91],v[124:127]
ds_read_b128 a[228:231],v17 offset:704
v_cvt_pk_bf16_f32 v57,v58,v59
v_mfma_f32_16x16x32_bf16 v[124:127],a[212:215],a[92:95],v[124:127]
ds_read_b64 a[168:169],v16 offset:2752
v_cvt_pk_bf16_f32 v58,v140,v141
v_mfma_f32_16x16x32_bf16 v[180:183],a[216:219],a[64:67],v[180:183]
ds_read_b64 a[170:171],v16 offset:2760
v_cvt_pk_bf16_f32 v59,v142,v143
v_mfma_f32_16x16x32_bf16 v[180:183],a[220:223],a[68:71],v[180:183]
ds_read_b128 a[232:235],v17 offset:1216
v_accvgpr_write_b32 a48,v56
v_mfma_f32_16x16x32_bf16 v[188:191],a[216:219],a[72:75],v[188:191]
ds_read_b64 a[172:173],v16 offset:2240
v_accvgpr_write_b32 a49,v57
v_mfma_f32_16x16x32_bf16 v[188:191],a[220:223],a[76:79],v[188:191]
ds_read_b64 a[174:175],v16 offset:2248
v_accvgpr_write_b32 a50,v58
v_mfma_f32_16x16x32_bf16 v[244:247],a[216:219],a[80:83],v[244:247]
ds_read_b128 a[236:239],v17 offset:1728
v_accvgpr_write_b32 a51,v59
v_mfma_f32_16x16x32_bf16 v[244:247],a[220:223],a[84:87],v[244:247]
buffer_store_dwordx4 v[120:123],v1,s[16:19],s51 offen offset:3072 sc1
v_mfma_f32_16x16x32_bf16 v[252:255],a[216:219],a[88:91],v[252:255]
ds_read_b64 a[176:177],v16 offset:1728
v_mul_f32 v196,s70,v196
v_mfma_f32_16x16x32_bf16 v[252:255],a[220:223],a[92:95],v[252:255]
ds_read_b64 a[178:179],v16 offset:1736
v_mul_f32 v197,s70,v197
s_waitcnt lgkmcnt(11)
v_mfma_f32_16x16x32_bf16 v[64:67],a[160:163],a[224:227],0
ds_read_b128 a[240:243],v17 offset:2240
v_mul_f32 v198,s70,v198
s_waitcnt lgkmcnt(9)
v_mfma_f32_16x16x32_bf16 v[72:75],a[160:163],a[228:231],0
ds_read_b64 a[180:181],v16 offset:1216
v_mul_f32 v199,s70,v199
v_mfma_f32_16x16x32_bf16 v[72:75],a[164:167],a[224:227],v[72:75]
ds_read_b64 a[182:183],v16 offset:1224
v_mul_f32 v148,s70,v148
s_waitcnt lgkmcnt(8)
v_mfma_f32_16x16x32_bf16 v[80:83],a[160:163],a[232:235],0
ds_read_b128 a[244:247],v17 offset:2752
v_mul_f32 v149,s70,v149
v_mfma_f32_16x16x32_bf16 v[80:83],a[164:167],a[228:231],v[80:83]
ds_read_b64 a[184:185],v16 offset:704
v_mul_f32 v150,s70,v150
v_mfma_f32_16x16x32_bf16 v[80:83],a[168:171],a[224:227],v[80:83]
ds_read_b64 a[186:187],v16 offset:712
v_mul_f32 v151,s70,v151
s_waitcnt lgkmcnt(8)
v_mfma_f32_16x16x32_bf16 v[88:91],a[160:163],a[236:239],0
ds_read_b128 a[248:251],v17 offset:3264
v_cvt_pk_bf16_f32 v196,v196,v197
v_mfma_f32_16x16x32_bf16 v[88:91],a[164:167],a[232:235],v[88:91]
ds_read_b64 a[188:189],v16 offset:192
v_cvt_pk_bf16_f32 v197,v198,v199
v_mfma_f32_16x16x32_bf16 v[88:91],a[168:171],a[228:231],v[88:91]
ds_read_b64 a[190:191],v16 offset:200
v_cvt_pk_bf16_f32 v198,v148,v149
v_mfma_f32_16x16x32_bf16 v[88:91],a[172:175],a[224:227],v[88:91]
ds_read_b128 a[252:255],v17 offset:3776
v_cvt_pk_bf16_f32 v199,v150,v151
s_waitcnt lgkmcnt(9)
v_mfma_f32_16x16x32_bf16 v[96:99],a[160:163],a[240:243],0
ds_read_b64 a[192:193],v16 offset:3712
buffer_store_dwordx4 v[128:131],v1,s[16:19],s4 offen offset:0 sc1
v_mfma_f32_16x16x32_bf16 v[96:99],a[164:167],a[236:239],v[96:99]
ds_read_b64 a[194:195],v16 offset:3720
v_accvgpr_write_b32 a4,v196
v_mfma_f32_16x16x32_bf16 v[96:99],a[168:171],a[232:235],v[96:99]
ds_read_b128 a[64:67],v17 offset:128
v_accvgpr_write_b32 a5,v197
v_mfma_f32_16x16x32_bf16 v[96:99],a[172:175],a[228:231],v[96:99]
ds_read_b64 a[196:197],v16 offset:3200
v_accvgpr_write_b32 a6,v198
v_mfma_f32_16x16x32_bf16 v[96:99],a[176:179],a[224:227],v[96:99]
ds_read_b64 a[198:199],v16 offset:3208
v_accvgpr_write_b32 a7,v199
s_waitcnt lgkmcnt(11)
v_mfma_f32_16x16x32_bf16 v[104:107],a[160:163],a[244:247],0
ds_write_b128 v18,v[196:199] offset:1024
v_mfma_f32_16x16x32_bf16 v[104:107],a[164:167],a[240:243],v[104:107]
ds_read_b128 a[68:71],v17 offset:640
v_mul_f32 v204,s70,v204
v_mfma_f32_16x16x32_bf16 v[104:107],a[168:171],a[236:239],v[104:107]
ds_read_b64 a[200:201],v16 offset:2688
v_mul_f32 v205,s70,v205
v_mfma_f32_16x16x32_bf16 v[104:107],a[172:175],a[232:235],v[104:107]
ds_read_b64 a[202:203],v16 offset:2696
v_mul_f32 v206,s70,v206
v_mfma_f32_16x16x32_bf16 v[104:107],a[176:179],a[228:231],v[104:107]
ds_read_b128 a[72:75],v17 offset:1152
v_mul_f32 v207,s70,v207
v_mfma_f32_16x16x32_bf16 v[104:107],a[180:183],a[224:227],v[104:107]
ds_read_b64 a[204:205],v16 offset:2176
v_mul_f32 v156,s70,v156
s_waitcnt lgkmcnt(14)
v_mfma_f32_16x16x32_bf16 v[112:115],a[160:163],a[248:251],0
ds_read_b64 a[206:207],v16 offset:2184
v_mul_f32 v157,s70,v157
v_mfma_f32_16x16x32_bf16 v[112:115],a[164:167],a[244:247],v[112:115]
ds_read_b128 a[76:79],v17 offset:1664
v_mul_f32 v158,s70,v158
v_mfma_f32_16x16x32_bf16 v[112:115],a[168:171],a[240:243],v[112:115]
ds_read_b64 a[208:209],v16 offset:1664
v_mul_f32 v159,s70,v159
v_mfma_f32_16x16x32_bf16 v[112:115],a[172:175],a[236:239],v[112:115]
ds_read_b64 a[210:211],v16 offset:1672
v_cvt_pk_bf16_f32 v204,v204,v205
v_mfma_f32_16x16x32_bf16 v[112:115],a[176:179],a[232:235],v[112:115]
ds_read_b128 a[80:83],v17 offset:2176
v_cvt_pk_bf16_f32 v205,v206,v207
v_mfma_f32_16x16x32_bf16 v[112:115],a[180:183],a[228:231],v[112:115]
ds_read_b64 a[212:213],v16 offset:1152
v_cvt_pk_bf16_f32 v206,v156,v157
v_mfma_f32_16x16x32_bf16 v[112:115],a[184:187],a[224:227],v[112:115]
ds_read_b64 a[214:215],v16 offset:1160
v_cvt_pk_bf16_f32 v207,v158,v159
s_waitcnt lgkmcnt(15)
v_mfma_f32_16x16x32_bf16 v[120:123],a[160:163],a[252:255],0
ds_read_b128 a[84:87],v17 offset:2688
v_accvgpr_write_b32 a20,v204
v_mfma_f32_16x16x32_bf16 v[120:123],a[164:167],a[248:251],v[120:123]
ds_read_b64 a[216:217],v16 offset:640
v_accvgpr_write_b32 a21,v205
v_mfma_f32_16x16x32_bf16 v[120:123],a[168:171],a[244:247],v[120:123]
ds_read_b64 a[218:219],v16 offset:648
v_accvgpr_write_b32 a22,v206
v_mfma_f32_16x16x32_bf16 v[120:123],a[172:175],a[240:243],v[120:123]
ds_read_b128 a[88:91],v17 offset:3200
ds_read_b64 a[220:221],v16 offset:128
buffer_store_dwordx4 v[160:163],v1,s[16:19],s4 offen offset:2048 sc1
v_mfma_f32_16x16x32_bf16 v[120:123],a[176:179],a[236:239],v[120:123]
ds_read_b64 a[222:223],v16 offset:136
v_accvgpr_write_b32 a23,v207
v_mfma_f32_16x16x32_bf16 v[120:123],a[180:183],a[232:235],v[120:123]
ds_write_b128 v18,v[204:207] offset:5120
v_mfma_f32_16x16x32_bf16 v[120:123],a[184:187],a[228:231],v[120:123]
ds_read_b128 a[92:95],v17 offset:3712
v_mul_f32 v84,s70,v84
v_mfma_f32_16x16x32_bf16 v[120:123],a[188:191],a[224:227],v[120:123]
s_waitcnt lgkmcnt(15)
v_mul_f32 v85,s70,v85
v_mul_f32 v86,s70,v86
v_mfma_f32_16x16x32_bf16 v[64:67],a[192:195],a[64:67],v[64:67]
s_waitcnt lgkmcnt(15)
v_mul_f32 v87,s70,v87
v_mul_f32 v212,s70,v212
v_mfma_f32_16x16x32_bf16 v[72:75],a[192:195],a[68:71],v[72:75]
s_waitcnt lgkmcnt(15)
v_mul_f32 v213,s70,v213
v_mul_f32 v214,s70,v214
v_mfma_f32_16x16x32_bf16 v[72:75],a[196:199],a[64:67],v[72:75]
ds_read_b64 a[160:161],v16 offset:3648
v_mul_f32 v215,s70,v215
v_mfma_f32_16x16x32_bf16 v[80:83],a[192:195],a[72:75],v[80:83]
ds_read_b64 a[162:163],v16 offset:3656
v_cvt_pk_bf16_f32 v84,v84,v85
v_mfma_f32_16x16x32_bf16 v[80:83],a[196:199],a[68:71],v[80:83]
ds_read_b128 a[224:227],v17 offset:64
v_cvt_pk_bf16_f32 v85,v86,v87
v_mfma_f32_16x16x32_bf16 v[80:83],a[200:203],a[64:67],v[80:83]
ds_read_b64 a[164:165],v16 offset:3136
v_cvt_pk_bf16_f32 v86,v212,v213
s_waitcnt lgkmcnt(15)
v_mfma_f32_16x16x32_bf16 v[88:91],a[192:195],a[76:79],v[88:91]
ds_read_b64 a[166:167],v16 offset:3144
v_cvt_pk_bf16_f32 v87,v214,v215
v_mfma_f32_16x16x32_bf16 v[88:91],a[196:199],a[72:75],v[88:91]
ds_read_b128 a[228:231],v17 offset:576
v_accvgpr_write_b32 a36,v84
v_mfma_f32_16x16x32_bf16 v[88:91],a[200:203],a[68:71],v[88:91]
ds_read_b64 a[168:169],v16 offset:2624
v_accvgpr_write_b32 a37,v85
v_mfma_f32_16x16x32_bf16 v[88:91],a[204:207],a[64:67],v[88:91]
ds_read_b64 a[170:171],v16 offset:2632
v_accvgpr_write_b32 a38,v86
s_waitcnt lgkmcnt(15)
v_mfma_f32_16x16x32_bf16 v[96:99],a[192:195],a[80:83],v[96:99]
ds_read_b128 a[232:235],v17 offset:1088
v_accvgpr_write_b32 a39,v87
v_mfma_f32_16x16x32_bf16 v[96:99],a[196:199],a[76:79],v[96:99]
ds_read_b64 a[172:173],v16 offset:2112
v_mul_f32 v92,s70,v92
v_mfma_f32_16x16x32_bf16 v[96:99],a[200:203],a[72:75],v[96:99]
ds_read_b64 a[174:175],v16 offset:2120
v_mul_f32 v93,s70,v93
v_mfma_f32_16x16x32_bf16 v[96:99],a[204:207],a[68:71],v[96:99]
ds_read_b128 a[236:239],v17 offset:1600
v_mul_f32 v94,s70,v94
v_mfma_f32_16x16x32_bf16 v[96:99],a[208:211],a[64:67],v[96:99]
ds_read_b64 a[176:177],v16 offset:1600
v_mul_f32 v95,s70,v95
s_waitcnt lgkmcnt(15)
v_mfma_f32_16x16x32_bf16 v[104:107],a[192:195],a[84:87],v[104:107]
buffer_store_dwordx4 v[192:195],v1,s[16:19],s6 offen offset:0 sc1
v_mfma_f32_16x16x32_bf16 v[104:107],a[196:199],a[80:83],v[104:107]
ds_read_b64 a[178:179],v16 offset:1608
v_mul_f32 v220,s70,v220
v_mfma_f32_16x16x32_bf16 v[104:107],a[200:203],a[76:79],v[104:107]
ds_read_b128 a[240:243],v17 offset:2112
v_mul_f32 v221,s70,v221
v_mfma_f32_16x16x32_bf16 v[104:107],a[204:207],a[72:75],v[104:107]
ds_read_b64 a[180:181],v16 offset:1088
v_mul_f32 v222,s70,v222
v_mfma_f32_16x16x32_bf16 v[104:107],a[208:211],a[68:71],v[104:107]
ds_read_b64 a[182:183],v16 offset:1096
v_mul_f32 v223,s70,v223
v_mfma_f32_16x16x32_bf16 v[104:107],a[212:215],a[64:67],v[104:107]
ds_read_b128 a[244:247],v17 offset:2624
v_cvt_pk_bf16_f32 v92,v92,v93
s_waitcnt lgkmcnt(15)
v_mfma_f32_16x16x32_bf16 v[112:115],a[192:195],a[88:91],v[112:115]
ds_read_b64 a[184:185],v16 offset:576
v_cvt_pk_bf16_f32 v93,v94,v95
v_mfma_f32_16x16x32_bf16 v[112:115],a[196:199],a[84:87],v[112:115]
ds_read_b64 a[186:187],v16 offset:584
v_cvt_pk_bf16_f32 v94,v220,v221
v_mfma_f32_16x16x32_bf16 v[112:115],a[200:203],a[80:83],v[112:115]
ds_read_b128 a[248:251],v17 offset:3136
v_cvt_pk_bf16_f32 v95,v222,v223
v_mfma_f32_16x16x32_bf16 v[112:115],a[204:207],a[76:79],v[112:115]
ds_read_b64 a[188:189],v16 offset:64
v_accvgpr_write_b32 a52,v92
v_mfma_f32_16x16x32_bf16 v[112:115],a[208:211],a[72:75],v[112:115]
ds_read_b64 a[190:191],v16 offset:72
v_accvgpr_write_b32 a53,v93
v_mfma_f32_16x16x32_bf16 v[112:115],a[212:215],a[68:71],v[112:115]
ds_read_b128 a[252:255],v17 offset:3648
v_accvgpr_write_b32 a54,v94
v_mfma_f32_16x16x32_bf16 v[112:115],a[216:219],a[64:67],v[112:115]
s_waitcnt lgkmcnt(15)
v_accvgpr_write_b32 a55,v95
v_mul_f32 v36,s70,v36
v_mfma_f32_16x16x32_bf16 v[120:123],a[192:195],a[92:95],v[120:123]
v_mul_f32 v37,s70,v37
v_mul_f32 v38,s70,v38
v_mfma_f32_16x16x32_bf16 v[120:123],a[196:199],a[88:91],v[120:123]
v_mul_f32 v39,s70,v39
v_mul_f32 v164,s70,v164
v_mfma_f32_16x16x32_bf16 v[120:123],a[200:203],a[84:87],v[120:123]
v_mul_f32 v165,s70,v165
v_mul_f32 v166,s70,v166
v_mfma_f32_16x16x32_bf16 v[120:123],a[204:207],a[80:83],v[120:123]
v_mul_f32 v167,s70,v167
v_cvt_pk_bf16_f32 v36,v36,v37
v_mfma_f32_16x16x32_bf16 v[120:123],a[208:211],a[76:79],v[120:123]
v_cvt_pk_bf16_f32 v37,v38,v39
v_cvt_pk_bf16_f32 v38,v164,v165
v_mfma_f32_16x16x32_bf16 v[120:123],a[212:215],a[72:75],v[120:123]
v_cvt_pk_bf16_f32 v39,v166,v167
v_accvgpr_write_b32 a8,v36
v_mfma_f32_16x16x32_bf16 v[120:123],a[216:219],a[68:71],v[120:123]
v_accvgpr_write_b32 a9,v37
v_accvgpr_write_b32 a10,v38
v_mfma_f32_16x16x32_bf16 v[120:123],a[220:223],a[64:67],v[120:123]
s_waitcnt lgkmcnt(15)
v_accvgpr_write_b32 a11,v39
v_mfma_f32_16x16x32_bf16 v[64:67],a[160:163],a[224:227],v[64:67]
ds_write_b128 v18,v[36:39] offset:2048
v_mfma_f32_16x16x32_bf16 v[72:75],a[160:163],a[228:231],v[72:75]
buffer_store_dwordx4 v[224:227],v1,s[16:19],s6 offen offset:2048 sc1
v_mfma_f32_16x16x32_bf16 v[72:75],a[164:167],a[224:227],v[72:75]
ds_read_b64 a[192:193],v16 offset:3584
v_mul_f32 v44,s70,v44
s_waitcnt lgkmcnt(15)
v_mfma_f32_16x16x32_bf16 v[80:83],a[160:163],a[232:235],v[80:83]
ds_read_b64 a[194:195],v16 offset:3592
v_mul_f32 v45,s70,v45
v_mfma_f32_16x16x32_bf16 v[80:83],a[164:167],a[228:231],v[80:83]
ds_read_b128 a[64:67],v17 offset:0
v_mul_f32 v46,s70,v46
v_mfma_f32_16x16x32_bf16 v[80:83],a[168:171],a[224:227],v[80:83]
ds_read_b64 a[196:197],v16 offset:3072
v_mul_f32 v47,s70,v47
s_waitcnt lgkmcnt(15)
v_mfma_f32_16x16x32_bf16 v[88:91],a[160:163],a[236:239],v[88:91]
ds_read_b64 a[198:199],v16 offset:3080
v_mul_f32 v172,s70,v172
v_mfma_f32_16x16x32_bf16 v[88:91],a[164:167],a[232:235],v[88:91]
ds_read_b128 a[68:71],v17 offset:512
v_mul_f32 v173,s70,v173
v_mfma_f32_16x16x32_bf16 v[88:91],a[168:171],a[228:231],v[88:91]
ds_read_b64 a[200:201],v16 offset:2560
v_mul_f32 v174,s70,v174
v_mfma_f32_16x16x32_bf16 v[88:91],a[172:175],a[224:227],v[88:91]
ds_read_b64 a[202:203],v16 offset:2568
v_mul_f32 v175,s70,v175
s_waitcnt lgkmcnt(15)
v_mfma_f32_16x16x32_bf16 v[96:99],a[160:163],a[240:243],v[96:99]
ds_read_b128 a[72:75],v17 offset:1024
v_cvt_pk_bf16_f32 v44,v44,v45
v_mfma_f32_16x16x32_bf16 v[96:99],a[164:167],a[236:239],v[96:99]
ds_read_b64 a[204:205],v16 offset:2048
v_cvt_pk_bf16_f32 v45,v46,v47
v_mfma_f32_16x16x32_bf16 v[96:99],a[168:171],a[232:235],v[96:99]
ds_read_b64 a[206:207],v16 offset:2056
v_cvt_pk_bf16_f32 v46,v172,v173
v_mfma_f32_16x16x32_bf16 v[96:99],a[172:175],a[228:231],v[96:99]
ds_read_b128 a[76:79],v17 offset:1536
v_cvt_pk_bf16_f32 v47,v174,v175
v_mfma_f32_16x16x32_bf16 v[96:99],a[176:179],a[224:227],v[96:99]
ds_read_b64 a[208:209],v16 offset:1536
v_accvgpr_write_b32 a24,v44
s_waitcnt lgkmcnt(15)
v_mfma_f32_16x16x32_bf16 v[104:107],a[160:163],a[244:247],v[104:107]
ds_read_b64 a[210:211],v16 offset:1544
v_accvgpr_write_b32 a25,v45
v_mfma_f32_16x16x32_bf16 v[104:107],a[164:167],a[240:243],v[104:107]
ds_read_b128 a[80:83],v17 offset:2048
v_accvgpr_write_b32 a26,v46
v_mfma_f32_16x16x32_bf16 v[104:107],a[168:171],a[236:239],v[104:107]
ds_read_b64 a[212:213],v16 offset:1024
v_accvgpr_write_b32 a27,v47
v_mfma_f32_16x16x32_bf16 v[104:107],a[172:175],a[232:235],v[104:107]
ds_write_b128 v18,v[44:47] offset:6144
v_mfma_f32_16x16x32_bf16 v[104:107],a[176:179],a[228:231],v[104:107]
ds_read_b64 a[214:215],v16 offset:1032
v_mul_f32 v100,s70,v100
v_mfma_f32_16x16x32_bf16 v[104:107],a[180:183],a[224:227],v[104:107]
ds_read_b128 a[84:87],v17 offset:2560
v_mul_f32 v101,s70,v101
s_waitcnt lgkmcnt(15)
v_mfma_f32_16x16x32_bf16 v[112:115],a[160:163],a[248:251],v[112:115]
ds_read_b64 a[216:217],v16 offset:512
v_mul_f32 v102,s70,v102
v_mfma_f32_16x16x32_bf16 v[112:115],a[164:167],a[244:247],v[112:115]
ds_read_b64 a[218:219],v16 offset:520
v_mul_f32 v103,s70,v103
v_mfma_f32_16x16x32_bf16 v[112:115],a[168:171],a[240:243],v[112:115]
buffer_store_dwordx4 v[136:139],v1,s[16:19],s5 offen offset:0 sc1
v_mfma_f32_16x16x32_bf16 v[112:115],a[172:175],a[236:239],v[112:115]
ds_read_b128 a[88:91],v17 offset:3072
v_mul_f32 v228,s70,v228
v_mfma_f32_16x16x32_bf16 v[112:115],a[176:179],a[232:235],v[112:115]
ds_read_b64 a[220:221],v16 offset:0
v_mul_f32 v229,s70,v229
v_mfma_f32_16x16x32_bf16 v[112:115],a[180:183],a[228:231],v[112:115]
ds_read_b64 a[222:223],v16 offset:8
v_mul_f32 v230,s70,v230
v_mfma_f32_16x16x32_bf16 v[112:115],a[184:187],a[224:227],v[112:115]
ds_read_b128 a[92:95],v17 offset:3584
v_mul_f32 v231,s70,v231
s_waitcnt lgkmcnt(15)
v_mfma_f32_16x16x32_bf16 v[120:123],a[160:163],a[252:255],v[120:123]
v_cvt_pk_bf16_f32 v100,v100,v101
v_cvt_pk_bf16_f32 v101,v102,v103
v_mfma_f32_16x16x32_bf16 v[120:123],a[164:167],a[248:251],v[120:123]
v_cvt_pk_bf16_f32 v102,v228,v229
v_cvt_pk_bf16_f32 v103,v230,v231
v_mfma_f32_16x16x32_bf16 v[120:123],a[168:171],a[244:247],v[120:123]
v_accvgpr_write_b32 a40,v100
v_accvgpr_write_b32 a41,v101
v_mfma_f32_16x16x32_bf16 v[120:123],a[172:175],a[240:243],v[120:123]
v_accvgpr_write_b32 a42,v102
v_accvgpr_write_b32 a43,v103
v_mfma_f32_16x16x32_bf16 v[120:123],a[176:179],a[236:239],v[120:123]
v_mul_f32 v108,s70,v108
v_mul_f32 v109,s70,v109
v_mfma_f32_16x16x32_bf16 v[120:123],a[180:183],a[232:235],v[120:123]
v_mul_f32 v110,s70,v110
v_mul_f32 v111,s70,v111
v_mfma_f32_16x16x32_bf16 v[120:123],a[184:187],a[228:231],v[120:123]
v_mul_f32 v236,s70,v236
v_mul_f32 v237,s70,v237
v_mfma_f32_16x16x32_bf16 v[120:123],a[188:191],a[224:227],v[120:123]
s_waitcnt lgkmcnt(15)
v_mul_f32 v238,s70,v238
v_mul_f32 v239,s70,v239
v_mfma_f32_16x16x32_bf16 v[64:67],a[192:195],a[64:67],v[64:67]
s_waitcnt lgkmcnt(15)
v_cvt_pk_bf16_f32 v108,v108,v109
v_cvt_pk_bf16_f32 v109,v110,v111
v_mfma_f32_16x16x32_bf16 v[72:75],a[192:195],a[68:71],v[72:75]
v_cvt_pk_bf16_f32 v110,v236,v237
v_cvt_pk_bf16_f32 v111,v238,v239
v_mfma_f32_16x16x32_bf16 v[72:75],a[196:199],a[64:67],v[72:75]
s_waitcnt lgkmcnt(15)
v_accvgpr_write_b32 a56,v108
v_accvgpr_write_b32 a57,v109
v_mfma_f32_16x16x32_bf16 v[80:83],a[192:195],a[72:75],v[80:83]
v_accvgpr_write_b32 a58,v110
v_accvgpr_write_b32 a59,v111
v_mfma_f32_16x16x32_bf16 v[80:83],a[196:199],a[68:71],v[80:83]
s_waitcnt lgkmcnt(13)
v_mul_f32 v52,s70,v52
v_mul_f32 v53,s70,v53
v_mfma_f32_16x16x32_bf16 v[80:83],a[200:203],a[64:67],v[80:83]
ds_write_b128 v22,v[64:67] offset:0
v_mfma_f32_16x16x32_bf16 v[88:91],a[192:195],a[76:79],v[88:91]
ds_read_b128 a[160:163],v2 offset:0
v_mul_f32 v54,s70,v54
v_mfma_f32_16x16x32_bf16 v[88:91],a[196:199],a[72:75],v[88:91]
ds_read_b128 a[164:167],v2 offset:1024
v_mul_f32 v55,s70,v55
v_mfma_f32_16x16x32_bf16 v[88:91],a[200:203],a[68:71],v[88:91]
ds_write_b128 v22,v[72:75] offset:1024
v_mfma_f32_16x16x32_bf16 v[88:91],a[204:207],a[64:67],v[88:91]
buffer_store_dwordx4 v[168:171],v1,s[16:19],s5 offen offset:2048 sc1
s_waitcnt lgkmcnt(14)
v_mfma_f32_16x16x32_bf16 v[96:99],a[192:195],a[80:83],v[96:99]
ds_read_b128 a[168:171],v2 offset:2048
v_mul_f32 v180,s70,v180
v_mfma_f32_16x16x32_bf16 v[96:99],a[196:199],a[76:79],v[96:99]
ds_read_b128 a[172:175],v2 offset:3072
v_mul_f32 v181,s70,v181
v_mfma_f32_16x16x32_bf16 v[96:99],a[200:203],a[72:75],v[96:99]
ds_write_b128 v22,v[80:83] offset:2048
v_mul_f32 v182,s70,v182
v_mul_f32 v183,s70,v183
v_cvt_pk_bf16_f32 v52,v52,v53
v_cvt_pk_bf16_f32 v53,v54,v55
v_cvt_pk_bf16_f32 v54,v180,v181
v_cvt_pk_bf16_f32 v55,v182,v183
v_accvgpr_write_b32 a12,v52
v_accvgpr_write_b32 a13,v53
v_accvgpr_write_b32 a14,v54
v_accvgpr_write_b32 a15,v55
ds_write_b128 v18,v[52:55] offset:3072
v_mul_f32 v60,s70,v60
v_mul_f32 v61,s70,v61
v_mul_f32 v62,s70,v62
v_mul_f32 v63,s70,v63
v_mul_f32 v188,s70,v188
v_mul_f32 v189,s70,v189
v_mul_f32 v190,s70,v190
v_mul_f32 v191,s70,v191
v_cvt_pk_bf16_f32 v60,v60,v61
v_cvt_pk_bf16_f32 v61,v62,v63
v_cvt_pk_bf16_f32 v62,v188,v189
v_cvt_pk_bf16_f32 v63,v190,v191
v_accvgpr_write_b32 a28,v60
v_accvgpr_write_b32 a29,v61
v_accvgpr_write_b32 a30,v62
v_accvgpr_write_b32 a31,v63
ds_write_b128 v18,v[60:63] offset:7168
v_mul_f32 v116,s70,v116
v_mul_f32 v117,s70,v117
v_mul_f32 v118,s70,v118
v_mul_f32 v119,s70,v119
v_mul_f32 v244,s70,v244
v_mul_f32 v245,s70,v245
v_mul_f32 v246,s70,v246
v_mul_f32 v247,s70,v247
v_cvt_pk_bf16_f32 v116,v116,v117
v_cvt_pk_bf16_f32 v117,v118,v119
v_cvt_pk_bf16_f32 v118,v244,v245
v_cvt_pk_bf16_f32 v119,v246,v247
v_accvgpr_write_b32 a44,v116
v_accvgpr_write_b32 a45,v117
v_accvgpr_write_b32 a46,v118
v_accvgpr_write_b32 a47,v119
v_mul_f32 v124,s70,v124
v_mul_f32 v125,s70,v125
v_mul_f32 v126,s70,v126
v_mul_f32 v127,s70,v127
v_mul_f32 v252,s70,v252
v_mul_f32 v253,s70,v253
v_mul_f32 v254,s70,v254
v_mul_f32 v255,s70,v255
v_cvt_pk_bf16_f32 v124,v124,v125
v_cvt_pk_bf16_f32 v125,v126,v127
v_cvt_pk_bf16_f32 v126,v252,v253
v_cvt_pk_bf16_f32 v127,v254,v255
v_accvgpr_write_b32 a60,v124
v_accvgpr_write_b32 a61,v125
v_accvgpr_write_b32 a62,v126
v_accvgpr_write_b32 a63,v127
v_mfma_f32_16x16x32_bf16 v[96:99],a[204:207],a[68:71],v[96:99]
s_waitcnt lgkmcnt(15)
v_and_b32 v8,15,v7
v_lshrrev_b32 v9,4,v7
v_mfma_f32_16x16x32_bf16 v[96:99],a[208:211],a[64:67],v[96:99]
ds_read_b64 v[52:53],v0 offset:512
v_lshlrev_b32 v9,2,v9
v_mfma_f32_16x16x32_bf16 v[104:107],a[192:195],a[84:87],v[104:107]
ds_write_b128 v22,v[88:91] offset:3072
v_mfma_f32_16x16x32_bf16 v[104:107],a[196:199],a[80:83],v[104:107]
ds_read_b64 v[54:55],v0 offset:17152
v_sub_u32 v8,v8,v9
v_mfma_f32_16x16x32_bf16 v[104:107],a[200:203],a[76:79],v[104:107]
ds_read_b64 v[60:61],v0 offset:0
s_lshl_b32 s28,s20,4
v_mfma_f32_16x16x32_bf16 v[104:107],a[204:207],a[72:75],v[104:107]
ds_read_b64 v[62:63],v0 offset:16640
v_add_u32 v9,s28,v8
v_mfma_f32_16x16x32_bf16 v[104:107],a[208:211],a[68:71],v[104:107]
ds_write_b128 v22,v[96:99] offset:4096
v_mfma_f32_16x16x32_bf16 v[104:107],a[212:215],a[64:67],v[104:107]
s_lshr_b32 s28,s20,1
s_lshl_b32 s28,s28,4
s_waitcnt lgkmcnt(15)
v_mfma_f32_16x16x32_bf16 v[112:115],a[192:195],a[88:91],v[112:115]
v_add_u32 v10,s28,v8
v_cmp_le_i32 s[32:33],0,v9
v_mfma_f32_16x16x32_bf16 v[112:115],a[196:199],a[84:87],v[112:115]
v_cmp_le_i32 s[34:35],1,v9
v_cmp_le_i32 s[36:37],2,v9
v_mfma_f32_16x16x32_bf16 v[112:115],a[200:203],a[80:83],v[112:115]
v_cmp_le_i32 s[38:39],3,v9
v_cmp_le_i32 s[40:41],16,v9
v_mfma_f32_16x16x32_bf16 v[112:115],a[204:207],a[76:79],v[112:115]
v_cmp_le_i32 s[42:43],17,v9
v_cmp_le_i32 s[44:45],18,v9
v_mfma_f32_16x16x32_bf16 v[112:115],a[208:211],a[72:75],v[112:115]
ds_write_b128 v22,v[104:107] offset:5120
v_mfma_f32_16x16x32_bf16 v[112:115],a[212:215],a[68:71],v[112:115]
v_cmp_le_i32 s[46:47],19,v9
v_cmp_le_i32 s[48:49],32,v9
v_mfma_f32_16x16x32_bf16 v[112:115],a[216:219],a[64:67],v[112:115]
s_waitcnt lgkmcnt(15)
v_cmp_le_i32 s[50:51],33,v9
v_cmp_le_i32 s[52:53],34,v9
v_mfma_f32_16x16x32_bf16 v[120:123],a[192:195],a[92:95],v[120:123]
buffer_store_dwordx4 v[200:203],v1,s[16:19],s7 offen offset:0 sc1
v_mfma_f32_16x16x32_bf16 v[120:123],a[196:199],a[88:91],v[120:123]
v_cmp_le_i32 s[54:55],35,v9
v_cmp_le_i32 s[56:57],48,v9
v_mfma_f32_16x16x32_bf16 v[120:123],a[200:203],a[84:87],v[120:123]
v_cmp_le_i32 s[58:59],49,v9
v_cmp_le_i32 s[60:61],50,v9
v_mfma_f32_16x16x32_bf16 v[120:123],a[204:207],a[80:83],v[120:123]
v_cmp_le_i32 s[62:63],51,v9
v_cmp_le_i32 s[64:65],0,v10
v_mfma_f32_16x16x32_bf16 v[120:123],a[208:211],a[76:79],v[120:123]
ds_write_b128 v22,v[112:115] offset:6144
v_mfma_f32_16x16x32_bf16 v[120:123],a[212:215],a[72:75],v[120:123]
v_cmp_le_i32 s[66:67],1,v10
v_cmp_le_i32 s[68:69],2,v10
v_mfma_f32_16x16x32_bf16 v[120:123],a[216:219],a[68:71],v[120:123]
v_cmp_le_i32 s[70:71],3,v10
v_cmp_le_i32 s[72:73],16,v10
v_mfma_f32_16x16x32_bf16 v[120:123],a[220:223],a[64:67],v[120:123]
s_waitcnt lgkmcnt(15)
v_cmp_le_i32 s[74:75],17,v10
v_cmp_le_i32 s[76:77],18,v10
v_mfma_f32_16x16x32_bf16 v[24:27],a[160:163],a[0:3],0
s_waitcnt lgkmcnt(11)
v_cmp_le_i32 s[78:79],19,v10
s_lshr_b32 s28,s20,1
v_mfma_f32_16x16x32_bf16 v[24:27],a[164:167],a[4:7],v[24:27]
s_mul_i32 s29,s28,98304
s_and_b32 s30,s20,1
v_mfma_f32_16x16x32_bf16 v[24:27],a[168:171],a[8:11],v[24:27]
s_lshl_b32 s30,s30,14
s_add_u32 s29,s29,s30
v_mfma_f32_16x16x32_bf16 v[24:27],a[172:175],a[12:15],v[24:27]
v_add_u32 v12,s29,v1
v_xor_b32 v13,16384,v12
v_mfma_f32_16x16x32_bf16 v[28:31],a[160:163],a[16:19],0
ds_write_b128 v22,v[120:123] offset:7168
v_mfma_f32_16x16x32_bf16 v[28:31],a[164:167],a[20:23],v[28:31]
s_lshl_b32 s28,s28,13
s_add_u32 s28,s28,s30
v_mfma_f32_16x16x32_bf16 v[28:31],a[168:171],a[24:27],v[28:31]
s_add_u32 s28,s28,39936
v_lshrrev_b32 v14,1,v1
v_mfma_f32_16x16x32_bf16 v[28:31],a[172:175],a[28:31],v[28:31]
v_add_u32 v14,s28,v14
v_mov_b32 v15,0x5d800000
v_mfma_f32_16x16x32_bf16 v[32:35],a[160:163],a[32:35],0
s_lshl_b32 s86,s80,17
s_lshl_b32 s28,s21,12
v_mfma_f32_16x16x32_bf16 v[32:35],a[164:167],a[36:39],v[32:35]
s_add_u32 s86,s86,s28
s_add_u32 s86,s86,33554432
v_mfma_f32_16x16x32_bf16 v[32:35],a[168:171],a[40:43],v[32:35]
s_lshl_b32 s87,s81,17
s_lshl_b32 s28,s21,12
v_mfma_f32_16x16x32_bf16 v[32:35],a[172:175],a[44:47],v[32:35]
s_add_u32 s87,s87,s28
s_add_u32 s87,s87,33554432
v_mfma_f32_16x16x32_bf16 v[36:39],a[160:163],a[48:51],0
s_lshl_b32 s88,s82,17
s_lshl_b32 s28,s21,12
v_mfma_f32_16x16x32_bf16 v[36:39],a[164:167],a[52:55],v[36:39]
s_add_u32 s88,s88,s28
s_add_u32 s88,s88,33554432
v_mfma_f32_16x16x32_bf16 v[36:39],a[168:171],a[56:59],v[36:39]
s_lshl_b32 s89,s83,17
s_lshl_b32 s28,s21,12
v_mfma_f32_16x16x32_bf16 v[36:39],a[172:175],a[60:63],v[36:39]
s_add_u32 s89,s89,s28
s_add_u32 s89,s89,33554432
v_lshrrev_b32 v8,3,v7
v_lshlrev_b32 v0,14,v8
v_lshlrev_b32 v8,9,v8
v_mov_b32 v9,0
v_mov_b32 v10,0
v_mov_b32 v11,2
s_mov_b32 s8,0
s_mov_b32 s101,0
s_and_b32 s3,s99,0xfffff1ff
s_and_b32 s9,s21,28
s_lshl_b32 s9,s9,17
s_and_b32 s28,s21,3
s_lshl_b32 s28,s28,8
s_add_u32 s9,s9,s28
s_lshl_b32 s28,s20,10
s_add_u32 s9,s9,s28
s_lshl_b32 s28,s22,3
s_sub_u32 s28,s28,32
s_lshr_b32 s10,0x00060b0f,s28
s_and_b32 s10,s10,0xff
s_cmp_lt_u32 s22,4
s_cselect_b32 s10,16,s10
s_waitcnt lgkmcnt(0)
s_barrier
s_add_u32 m0,s23,65536
s_add_u32 s25,s25,16384
ds_read_b128 a[64:67],v19 offset:0
ds_read_b128 a[68:71],v19 offset:1024
ds_read_b128 a[72:75],v19 offset:2048
ds_read_b128 a[76:79],v19 offset:3072
ds_read_b128 a[80:83],v19 offset:4096
ds_read_b128 a[84:87],v19 offset:5120
ds_read_b128 a[88:91],v19 offset:6144
ds_read_b128 a[92:95],v19 offset:7168
buffer_load_dwordx4 v1,s[16:19],s25 offen offset:0 sc1 lds
buffer_load_dwordx4 v1,s[16:19],s25 offen offset:1024 sc1 lds
buffer_load_dwordx4 v1,s[16:19],s25 offen offset:2048 sc1 lds
buffer_load_dwordx4 v1,s[16:19],s25 offen offset:3072 sc1 lds
ds_read_b128 v[64:67],v20 offset:0
ds_read_b128 v[68:71],v20 offset:8192
ds_read_b128 v[72:75],v21 offset:0
ds_read_b128 v[76:79],v21 offset:8192
ds_read_b128 v[80:83],v20 offset:1024
ds_read_b128 v[84:87],v20 offset:9216
ds_read_b128 v[88:91],v21 offset:1024
ds_read_b128 v[92:95],v21 offset:9216
v_lshrrev_b32 v100,3,v7
v_lshlrev_b32 v100,10,v100
v_bfe_u32 v101,v7,1,2
v_lshrrev_b32 v102,4,v7
v_xor_b32 v101,v101,v102
v_lshl_add_u32 v100,v101,5,v100
v_and_b32 v101,1,v7
v_lshl_add_u32 v100,v101,4,v100
s_and_b32 s28,s21,3
s_lshl_b32 s28,s28,8
s_and_b32 s29,s20,1
s_lshl_b32 s29,s29,7
s_add_u32 s28,s28,s29
s_lshr_b32 s29,s20,1
s_lshl_b32 s29,s29,16
s_add_u32 s28,s28,s29
v_add_u32 v100,s28,v100
v_accvgpr_write_b32 a248,v100
s_mov_b32 s12,s90
s_and_b32 s13,s91,0xffff
s_lshr_b32 s30,s2,3
s_lshl_b32 s30,s30,2
s_add_u32 s30,s30,s20
s_lshl_b32 s30,s30,10
v_and_b32 v100,7,v7
v_lshlrev_b32 v100,7,v100
v_add_u32 v100,s30,v100
v_min_u32 v100,F_END-F_PC,v100
v_accvgpr_write_b32 a251,v100
s_lshr_b32 s28,s2,3
s_lshl_b32 s28,s28,16
s_lshl_b32 s29,s20,14
s_add_u32 s28,s28,s29
s_and_b32 s29,s2,7
s_lshl_b32 s29,s29,7
s_add_u32 s28,s28,s29
v_bfe_u32 v22,v7,1,4
v_lshlrev_b32 v22,10,v22
v_add_u32 v22,s28,v22
v_cmp_gt_u32 vcc,32,v7
v_and_b32 v100,0x3ffff,v22
s_nop 0
v_cndmask_b32 v22,v100,v22,vcc
s_waitcnt lgkmcnt(15)
v_mfma_f32_16x16x32_bf16 v[40:43],a[160:163],a[64:67],0
s_waitcnt lgkmcnt(14)
v_mfma_f32_16x16x32_bf16 v[40:43],a[164:167],a[68:71],v[40:43]
s_waitcnt lgkmcnt(13)
v_mfma_f32_16x16x32_bf16 v[40:43],a[168:171],a[72:75],v[40:43]
s_waitcnt lgkmcnt(12)
v_mfma_f32_16x16x32_bf16 v[40:43],a[172:175],a[76:79],v[40:43]
s_waitcnt lgkmcnt(11)
v_mfma_f32_16x16x32_bf16 v[44:47],a[160:163],a[80:83],0
s_waitcnt lgkmcnt(10)
v_mfma_f32_16x16x32_bf16 v[44:47],a[164:167],a[84:87],v[44:47]
s_waitcnt lgkmcnt(9)
v_mfma_f32_16x16x32_bf16 v[44:47],a[168:171],a[88:91],v[44:47]
s_waitcnt lgkmcnt(8)
v_mfma_f32_16x16x32_bf16 v[44:47],a[172:175],a[92:95],v[44:47]
s_waitcnt lgkmcnt(0)
v_mov_b32 v98,s26
v_and_b32 v97,0xffff0000,v98
v_lshlrev_b32 v96,16,v98
v_add_f32 v64,v64,v68
v_and_b32 v98,0xffff0000,v53
v_fmac_f32 v64,v98,v96
v_add_f32 v72,v72,v76
v_and_b32 v98,0xffff0000,v55
v_fmac_f32 v72,v98,v97
v_cvt_pk_bf16_f32 v64,v64,v72
v_add_f32 v65,v65,v69
v_lshlrev_b32 v98,16,v53
v_fmac_f32 v65,v98,v96
v_add_f32 v73,v73,v77
v_lshlrev_b32 v98,16,v55
v_fmac_f32 v73,v98,v97
v_cvt_pk_bf16_f32 v65,v65,v73
v_add_f32 v66,v66,v70
v_and_b32 v98,0xffff0000,v52
v_fmac_f32 v66,v98,v96
v_add_f32 v74,v74,v78
v_and_b32 v98,0xffff0000,v54
v_fmac_f32 v74,v98,v97
v_cvt_pk_bf16_f32 v66,v66,v74
v_add_f32 v67,v67,v71
v_lshlrev_b32 v98,16,v52
v_fmac_f32 v67,v98,v96
v_add_f32 v75,v75,v79
v_lshlrev_b32 v98,16,v54
v_fmac_f32 v75,v98,v97
v_cvt_pk_bf16_f32 v67,v67,v75
buffer_store_dwordx4 v[64:67],v1,s[16:19],s100 offen offset:0 sc1
v_add_f32 v80,v80,v84
v_and_b32 v98,0xffff0000,v61
v_fmac_f32 v80,v98,v96
v_add_f32 v88,v88,v92
v_and_b32 v98,0xffff0000,v63
v_fmac_f32 v88,v98,v97
v_cvt_pk_bf16_f32 v80,v80,v88
v_add_f32 v81,v81,v85
v_lshlrev_b32 v98,16,v61
v_fmac_f32 v81,v98,v96
v_add_f32 v89,v89,v93
v_lshlrev_b32 v98,16,v63
v_fmac_f32 v89,v98,v97
v_cvt_pk_bf16_f32 v81,v81,v89
v_add_f32 v82,v82,v86
v_and_b32 v98,0xffff0000,v60
v_fmac_f32 v82,v98,v96
v_add_f32 v90,v90,v94
v_and_b32 v98,0xffff0000,v62
v_fmac_f32 v90,v98,v97
v_cvt_pk_bf16_f32 v82,v82,v90
v_add_f32 v83,v83,v87
v_lshlrev_b32 v98,16,v60
v_fmac_f32 v83,v98,v96
v_add_f32 v91,v91,v95
v_lshlrev_b32 v98,16,v62
v_fmac_f32 v91,v98,v97
v_cvt_pk_bf16_f32 v83,v83,v91
buffer_store_dwordx4 v[80:83],v1,s[16:19],s100 offen offset:1024 sc1
s_cmp_eq_u32 s82,0
s_cselect_b64 s[28:29],s[32:33],-1
v_cndmask_b32 v32,v6,v32,s[28:29]
s_cselect_b64 s[28:29],s[34:35],-1
v_cndmask_b32 v33,v6,v33,s[28:29]
s_cselect_b64 s[28:29],s[36:37],-1
v_cndmask_b32 v34,v6,v34,s[28:29]
s_cselect_b64 s[28:29],s[38:39],-1
v_cndmask_b32 v35,v6,v35,s[28:29]
v_max_f32 v24,v24,v25
v_max3_f32 v24,v24,v26,v27
v_max_f32 v28,v28,v29
v_max3_f32 v28,v28,v30,v31
v_max_f32 v32,v32,v33
v_max3_f32 v32,v32,v34,v35
v_max_f32 v36,v36,v37
v_max3_f32 v36,v36,v38,v39
v_max_f32 v40,v40,v41
v_max3_f32 v40,v40,v42,v43
v_max_f32 v44,v44,v45
v_max3_f32 v44,v44,v46,v47
v_mov_b32 v25,v24
v_mov_b32 v29,v28
v_mov_b32 v33,v32
v_mov_b32 v37,v36
v_mov_b32 v41,v40
v_mov_b32 v45,v44
v_permlane32_swap_b32 v25,v24
v_permlane32_swap_b32 v29,v28
v_permlane32_swap_b32 v33,v32
v_permlane32_swap_b32 v37,v36
v_permlane32_swap_b32 v41,v40
v_permlane32_swap_b32 v45,v44
v_max_f32 v24,v24,v25
v_max_f32 v28,v28,v29
v_max_f32 v32,v32,v33
v_max_f32 v36,v36,v37
v_max_f32 v40,v40,v41
v_max_f32 v44,v44,v45
v_mov_b32 v25,v24
v_mov_b32 v29,v28
v_mov_b32 v33,v32
v_mov_b32 v37,v36
v_mov_b32 v41,v40
v_mov_b32 v45,v44
v_permlane16_swap_b32 v25,v24
v_permlane16_swap_b32 v29,v28
v_permlane16_swap_b32 v33,v32
v_permlane16_swap_b32 v37,v36
v_permlane16_swap_b32 v41,v40
v_permlane16_swap_b32 v45,v44
v_max_f32 v24,v24,v25
v_max_f32 v28,v28,v29
v_max_f32 v32,v32,v33
v_max_f32 v36,v36,v37
v_max_f32 v40,v40,v41
v_max_f32 v44,v44,v45
K2_ATT:
v_sub_f32 v27,0,v24
v_sub_f32 v26,0,v24
v_sub_f32 v25,0,v24
v_sub_f32 v24,0,v24
v_sub_f32 v31,0,v28
v_sub_f32 v30,0,v28
v_sub_f32 v29,0,v28
v_sub_f32 v28,0,v28
v_sub_f32 v35,0,v32
v_sub_f32 v34,0,v32
v_sub_f32 v33,0,v32
v_sub_f32 v32,0,v32
v_sub_f32 v39,0,v36
v_sub_f32 v38,0,v36
v_sub_f32 v37,0,v36
v_sub_f32 v36,0,v36
v_sub_f32 v43,0,v40
v_sub_f32 v42,0,v40
v_sub_f32 v41,0,v40
v_sub_f32 v40,0,v40
v_sub_f32 v47,0,v44
v_sub_f32 v46,0,v44
v_sub_f32 v45,0,v44
v_sub_f32 v44,0,v44
v_mov_b32 v16,0
v_mov_b32 v17,0
v_mov_b32 v18,0
v_mov_b32 v19,0
v_mov_b32 v20,0
v_mov_b32 v21,0
s_cmp_eq_u32 s22,0
s_cbranch_scc1 K2_MID0
v_mfma_f32_16x16x32_bf16 v[48:51],a[160:163],a[0:3],v[24:27]
ds_read_b128 a[176:179],v2 offset:4096
v_mfma_f32_16x16x32_bf16 v[48:51],a[164:167],a[4:7],v[48:51]
v_mfma_f32_16x16x32_bf16 v[48:51],a[168:171],a[8:11],v[48:51]
buffer_store_dwordx4 v[232:235],v1,s[16:19],s7 offen offset:2048 sc1
v_mfma_f32_16x16x32_bf16 v[48:51],a[172:175],a[12:15],v[48:51]
ds_read_b128 a[180:183],v2 offset:5120
v_mfma_f32_16x16x32_bf16 v[52:55],a[160:163],a[16:19],v[28:31]
v_mfma_f32_16x16x32_bf16 v[52:55],a[164:167],a[20:23],v[52:55]
v_mfma_f32_16x16x32_bf16 v[52:55],a[168:171],a[24:27],v[52:55]
ds_read_b128 a[184:187],v2 offset:6144
v_mfma_f32_16x16x32_bf16 v[52:55],a[172:175],a[28:31],v[52:55]
v_mfma_f32_16x16x32_bf16 v[56:59],a[160:163],a[32:35],v[32:35]
s_nop 0
v_exp_f32 v48,v48
v_exp_f32 v49,v49
v_mfma_f32_16x16x32_bf16 v[56:59],a[164:167],a[36:39],v[56:59]
ds_read_b128 a[188:191],v2 offset:7168
v_add_f32 v16,v16,v48
v_add_f32 v16,v16,v49
v_cvt_pk_bf16_f32 v64,v48,v49
v_mfma_f32_16x16x32_bf16 v[56:59],a[168:171],a[40:43],v[56:59]
v_exp_f32 v50,v50
v_exp_f32 v51,v51
v_mfma_f32_16x16x32_bf16 v[56:59],a[172:175],a[44:47],v[56:59]
buffer_store_dwordx4 v[144:147],v1,s[16:19],s4 offen offset:1024 sc1
v_add_f32 v16,v16,v50
v_add_f32 v16,v16,v51
v_cvt_pk_bf16_f32 v65,v50,v51
v_mfma_f32_16x16x32_bf16 v[60:63],a[160:163],a[48:51],v[36:39]
v_exp_f32 v52,v52
v_exp_f32 v53,v53
v_mfma_f32_16x16x32_bf16 v[60:63],a[164:167],a[52:55],v[60:63]
v_add_f32 v17,v17,v52
v_add_f32 v17,v17,v53
v_cvt_pk_bf16_f32 v72,v52,v53
v_mfma_f32_16x16x32_bf16 v[60:63],a[168:171],a[56:59],v[60:63]
s_waitcnt lgkmcnt(3)
v_exp_f32 v54,v54
v_exp_f32 v55,v55
v_mfma_f32_16x16x32_bf16 v[60:63],a[172:175],a[60:63],v[60:63]
ds_read_b128 a[160:163],v2 offset:8192
v_add_f32 v17,v17,v54
v_add_f32 v17,v17,v55
v_cvt_pk_bf16_f32 v73,v54,v55
v_mfma_f32_16x16x32_bf16 v[48:51],a[176:179],a[0:3],v[24:27]
s_waitcnt lgkmcnt(3)
v_exp_f32 v56,v56
v_exp_f32 v57,v57
v_mfma_f32_16x16x32_bf16 v[48:51],a[180:183],a[4:7],v[48:51]
s_waitcnt lgkmcnt(2)
v_add_f32 v18,v18,v56
v_add_f32 v18,v18,v57
v_cvt_pk_bf16_f32 v80,v56,v57
v_mfma_f32_16x16x32_bf16 v[48:51],a[184:187],a[8:11],v[48:51]
s_waitcnt lgkmcnt(1)
v_exp_f32 v58,v58
v_exp_f32 v59,v59
v_mfma_f32_16x16x32_bf16 v[48:51],a[188:191],a[12:15],v[48:51]
ds_read_b128 a[164:167],v2 offset:9216
v_add_f32 v18,v18,v58
v_add_f32 v18,v18,v59
v_cvt_pk_bf16_f32 v81,v58,v59
v_mfma_f32_16x16x32_bf16 v[52:55],a[176:179],a[16:19],v[28:31]
buffer_store_dwordx4 v[176:179],v1,s[16:19],s4 offen offset:3072 sc1
v_exp_f32 v60,v60
v_exp_f32 v61,v61
v_mfma_f32_16x16x32_bf16 v[52:55],a[180:183],a[20:23],v[52:55]
v_add_f32 v19,v19,v60
v_add_f32 v19,v19,v61
v_cvt_pk_bf16_f32 v88,v60,v61
v_mfma_f32_16x16x32_bf16 v[52:55],a[184:187],a[24:27],v[52:55]
v_exp_f32 v62,v62
v_exp_f32 v63,v63
v_mfma_f32_16x16x32_bf16 v[52:55],a[188:191],a[28:31],v[52:55]
ds_read_b128 a[168:171],v2 offset:10240
v_add_f32 v19,v19,v62
v_add_f32 v19,v19,v63
v_cvt_pk_bf16_f32 v89,v62,v63
v_mfma_f32_16x16x32_bf16 v[56:59],a[176:179],a[32:35],v[32:35]
v_exp_f32 v48,v48
v_exp_f32 v49,v49
v_mfma_f32_16x16x32_bf16 v[56:59],a[180:183],a[36:39],v[56:59]
ds_read_b128 a[172:175],v2 offset:11264
v_add_f32 v16,v16,v48
v_add_f32 v16,v16,v49
v_cvt_pk_bf16_f32 v66,v48,v49
v_mfma_f32_16x16x32_bf16 v[56:59],a[184:187],a[40:43],v[56:59]
v_exp_f32 v50,v50
v_exp_f32 v51,v51
v_mfma_f32_16x16x32_bf16 v[56:59],a[188:191],a[44:47],v[56:59]
v_add_f32 v16,v16,v50
v_add_f32 v16,v16,v51
v_cvt_pk_bf16_f32 v67,v50,v51
v_mfma_f32_16x16x32_bf16 v[60:63],a[176:179],a[48:51],v[36:39]
v_exp_f32 v52,v52
v_exp_f32 v53,v53
v_mfma_f32_16x16x32_bf16 v[60:63],a[180:183],a[52:55],v[60:63]
buffer_store_dwordx4 v[208:211],v1,s[16:19],s6 offen offset:1024 sc1
v_add_f32 v17,v17,v52
v_add_f32 v17,v17,v53
v_cvt_pk_bf16_f32 v74,v52,v53
v_mfma_f32_16x16x32_bf16 v[60:63],a[184:187],a[56:59],v[60:63]
s_waitcnt lgkmcnt(3)
v_exp_f32 v54,v54
v_exp_f32 v55,v55
v_mfma_f32_16x16x32_bf16 v[60:63],a[188:191],a[60:63],v[60:63]
ds_read_b128 a[176:179],v2 offset:12288
v_add_f32 v17,v17,v54
v_add_f32 v17,v17,v55
v_cvt_pk_bf16_f32 v75,v54,v55
v_mfma_f32_16x16x32_bf16 v[48:51],a[160:163],a[0:3],v[24:27]
s_waitcnt lgkmcnt(3)
v_exp_f32 v56,v56
v_exp_f32 v57,v57
v_mfma_f32_16x16x32_bf16 v[48:51],a[164:167],a[4:7],v[48:51]
s_waitcnt lgkmcnt(2)
v_add_f32 v18,v18,v56
v_add_f32 v18,v18,v57
v_cvt_pk_bf16_f32 v82,v56,v57
v_mfma_f32_16x16x32_bf16 v[48:51],a[168:171],a[8:11],v[48:51]
s_waitcnt lgkmcnt(1)
v_exp_f32 v58,v58
v_exp_f32 v59,v59
v_mfma_f32_16x16x32_bf16 v[48:51],a[172:175],a[12:15],v[48:51]
ds_read_b128 a[180:183],v2 offset:13312
v_add_f32 v18,v18,v58
v_add_f32 v18,v18,v59
v_cvt_pk_bf16_f32 v83,v58,v59
v_mfma_f32_16x16x32_bf16 v[52:55],a[160:163],a[16:19],v[28:31]
v_exp_f32 v60,v60
v_exp_f32 v61,v61
v_mfma_f32_16x16x32_bf16 v[52:55],a[164:167],a[20:23],v[52:55]
v_add_f32 v19,v19,v60
v_add_f32 v19,v19,v61
v_cvt_pk_bf16_f32 v90,v60,v61
v_mfma_f32_16x16x32_bf16 v[52:55],a[168:171],a[24:27],v[52:55]
ds_read_b128 a[184:187],v2 offset:14336
buffer_store_dwordx4 v[240:243],v1,s[16:19],s6 offen offset:3072 sc1
v_exp_f32 v62,v62
v_exp_f32 v63,v63
v_mfma_f32_16x16x32_bf16 v[52:55],a[172:175],a[28:31],v[52:55]
v_add_f32 v19,v19,v62
v_add_f32 v19,v19,v63
v_cvt_pk_bf16_f32 v91,v62,v63
v_mfma_f32_16x16x32_bf16 v[56:59],a[160:163],a[32:35],v[32:35]
v_exp_f32 v48,v48
v_exp_f32 v49,v49
v_mfma_f32_16x16x32_bf16 v[56:59],a[164:167],a[36:39],v[56:59]
ds_read_b128 a[188:191],v2 offset:15360
v_add_f32 v16,v16,v48
v_add_f32 v16,v16,v49
v_cvt_pk_bf16_f32 v68,v48,v49
v_mfma_f32_16x16x32_bf16 v[56:59],a[168:171],a[40:43],v[56:59]
v_exp_f32 v50,v50
v_exp_f32 v51,v51
v_mfma_f32_16x16x32_bf16 v[56:59],a[172:175],a[44:47],v[56:59]
v_add_f32 v16,v16,v50
v_add_f32 v16,v16,v51
v_cvt_pk_bf16_f32 v69,v50,v51
v_mfma_f32_16x16x32_bf16 v[60:63],a[160:163],a[48:51],v[36:39]
v_exp_f32 v52,v52
v_exp_f32 v53,v53
v_mfma_f32_16x16x32_bf16 v[60:63],a[164:167],a[52:55],v[60:63]
v_add_f32 v17,v17,v52
v_add_f32 v17,v17,v53
v_cvt_pk_bf16_f32 v76,v52,v53
v_mfma_f32_16x16x32_bf16 v[60:63],a[168:171],a[56:59],v[60:63]
v_exp_f32 v54,v54
v_exp_f32 v55,v55
v_mfma_f32_16x16x32_bf16 v[60:63],a[172:175],a[60:63],v[60:63]
s_waitcnt lgkmcnt(3)
v_add_f32 v17,v17,v54
v_add_f32 v17,v17,v55
v_cvt_pk_bf16_f32 v77,v54,v55
v_mfma_f32_16x16x32_bf16 v[48:51],a[176:179],a[0:3],v[24:27]
s_waitcnt lgkmcnt(2)
v_exp_f32 v56,v56
v_exp_f32 v57,v57
v_mfma_f32_16x16x32_bf16 v[48:51],a[180:183],a[4:7],v[48:51]
s_waitcnt lgkmcnt(1)
v_add_f32 v18,v18,v56
v_add_f32 v18,v18,v57
v_cvt_pk_bf16_f32 v84,v56,v57
v_mfma_f32_16x16x32_bf16 v[48:51],a[184:187],a[8:11],v[48:51]
s_waitcnt lgkmcnt(0)
v_exp_f32 v58,v58
v_exp_f32 v59,v59
v_mfma_f32_16x16x32_bf16 v[48:51],a[188:191],a[12:15],v[48:51]
s_waitcnt vmcnt(7) lgkmcnt(0)
v_add_f32 v18,v18,v58
v_add_f32 v18,v18,v59
v_cvt_pk_bf16_f32 v85,v58,v59
v_mfma_f32_16x16x32_bf16 v[52:55],a[176:179],a[16:19],v[28:31]
s_barrier
v_exp_f32 v60,v60
v_exp_f32 v61,v61
v_mfma_f32_16x16x32_bf16 v[52:55],a[180:183],a[20:23],v[52:55]
s_add_u32 m0,s23,0
v_add_f32 v19,v19,v60
v_add_f32 v19,v19,v61
v_cvt_pk_bf16_f32 v92,v60,v61
v_mfma_f32_16x16x32_bf16 v[52:55],a[184:187],a[24:27],v[52:55]
ds_read_b128 a[160:163],v2 offset:32768
v_exp_f32 v62,v62
v_exp_f32 v63,v63
v_mfma_f32_16x16x32_bf16 v[52:55],a[188:191],a[28:31],v[52:55]
s_add_u32 s24,s24,16384
ds_read_b128 a[192:195],v4 offset:0
v_add_f32 v19,v19,v62
v_add_f32 v19,v19,v63
v_cvt_pk_bf16_f32 v93,v62,v63
v_mfma_f32_16x16x32_bf16 v[56:59],a[176:179],a[32:35],v[32:35]
ds_read_b128 a[164:167],v2 offset:33792
v_exp_f32 v48,v48
v_exp_f32 v49,v49
v_mfma_f32_16x16x32_bf16 v[56:59],a[180:183],a[36:39],v[56:59]
ds_read_b128 a[196:199],v4 offset:4096
buffer_load_dwordx4 v1,s[16:19],s24 offen offset:0 sc1 lds
v_add_f32 v16,v16,v48
v_add_f32 v16,v16,v49
v_cvt_pk_bf16_f32 v70,v48,v49
v_mfma_f32_16x16x32_bf16 v[56:59],a[184:187],a[40:43],v[56:59]
buffer_load_dwordx4 v1,s[16:19],s24 offen offset:1024 sc1 lds
v_exp_f32 v50,v50
v_exp_f32 v51,v51
v_mfma_f32_16x16x32_bf16 v[56:59],a[188:191],a[44:47],v[56:59]
ds_read_b128 a[168:171],v2 offset:34816
buffer_load_dwordx4 v1,s[16:19],s24 offen offset:2048 sc1 lds
v_add_f32 v16,v16,v50
v_add_f32 v16,v16,v51
v_cvt_pk_bf16_f32 v71,v50,v51
v_mfma_f32_16x16x32_bf16 v[60:63],a[176:179],a[48:51],v[36:39]
ds_read_b128 a[200:203],v4 offset:8192
buffer_load_dwordx4 v1,s[16:19],s24 offen offset:3072 sc1 lds
v_exp_f32 v52,v52
v_exp_f32 v53,v53
v_mfma_f32_16x16x32_bf16 v[60:63],a[180:183],a[52:55],v[60:63]
ds_read_b128 a[172:175],v2 offset:35840
s_add_u32 m0,s23,98304
s_add_u32 s25,s25,16384
buffer_load_dwordx4 v1,s[16:19],s25 offen offset:0 sc1 lds
v_add_f32 v17,v17,v52
v_add_f32 v17,v17,v53
v_cvt_pk_bf16_f32 v78,v52,v53
v_mfma_f32_16x16x32_bf16 v[60:63],a[184:187],a[56:59],v[60:63]
ds_read_b128 a[204:207],v4 offset:12288
buffer_load_dwordx4 v1,s[16:19],s25 offen offset:1024 sc1 lds
v_exp_f32 v54,v54
v_exp_f32 v55,v55
v_mfma_f32_16x16x32_bf16 v[60:63],a[188:191],a[60:63],v[60:63]
s_waitcnt lgkmcnt(7)
v_add_f32 v17,v17,v54
v_add_f32 v17,v17,v55
v_cvt_pk_bf16_f32 v79,v54,v55
v_mfma_f32_16x16x32_bf16 v[48:51],a[160:163],a[0:3],v[24:27]
s_waitcnt lgkmcnt(5)
v_exp_f32 v56,v56
v_exp_f32 v57,v57
v_mfma_f32_16x16x32_bf16 v[48:51],a[164:167],a[4:7],v[48:51]
s_waitcnt lgkmcnt(3)
v_add_f32 v18,v18,v56
v_add_f32 v18,v18,v57
v_cvt_pk_bf16_f32 v86,v56,v57
v_mfma_f32_16x16x32_bf16 v[48:51],a[168:171],a[8:11],v[48:51]
ds_read_b128 a[176:179],v2 offset:36864
v_exp_f32 v58,v58
v_exp_f32 v59,v59
s_waitcnt lgkmcnt(2)
v_mfma_f32_16x16x32_bf16 v[48:51],a[172:175],a[12:15],v[48:51]
buffer_load_dwordx4 v1,s[16:19],s25 offen offset:2048 sc1 lds
v_add_f32 v18,v18,v58
v_add_f32 v18,v18,v59
v_cvt_pk_bf16_f32 v87,v58,v59
v_mfma_f32_16x16x32_bf16 v[128:131],a[192:195],v[64:67],0
v_exp_f32 v60,v60
v_exp_f32 v61,v61
v_mfma_f32_16x16x32_bf16 v[128:131],a[196:199],v[68:71],v[128:131]
v_add_f32 v19,v19,v60
v_add_f32 v19,v19,v61
v_cvt_pk_bf16_f32 v94,v60,v61
v_mfma_f32_16x16x32_bf16 v[160:163],a[192:195],v[72:75],0
ds_read_b128 a[208:211],v4 offset:1024
v_exp_f32 v62,v62
v_exp_f32 v63,v63
v_mfma_f32_16x16x32_bf16 v[160:163],a[196:199],v[76:79],v[160:163]
buffer_load_dwordx4 v1,s[16:19],s25 offen offset:3072 sc1 lds
v_add_f32 v19,v19,v62
v_add_f32 v19,v19,v63
v_cvt_pk_bf16_f32 v95,v62,v63
v_mfma_f32_16x16x32_bf16 v[52:55],a[160:163],a[16:19],v[28:31]
v_exp_f32 v48,v48
v_mfma_f32_16x16x32_bf16 v[52:55],a[164:167],a[20:23],v[52:55]
v_exp_f32 v49,v49
v_mfma_f32_16x16x32_bf16 v[52:55],a[168:171],a[24:27],v[52:55]
ds_read_b128 a[180:183],v2 offset:37888
v_add_f32 v16,v16,v48
v_mfma_f32_16x16x32_bf16 v[52:55],a[172:175],a[28:31],v[52:55]
buffer_store_dwordx4 v[152:155],v1,s[16:19],s5 offen offset:1024 sc1
v_add_f32 v16,v16,v49
v_cvt_pk_bf16_f32 v96,v48,v49
v_mfma_f32_16x16x32_bf16 v[192:195],a[192:195],v[80:83],0
v_exp_f32 v50,v50
v_mfma_f32_16x16x32_bf16 v[192:195],a[196:199],v[84:87],v[192:195]
v_exp_f32 v51,v51
v_mfma_f32_16x16x32_bf16 v[224:227],a[192:195],v[88:91],0
ds_read_b128 a[212:215],v4 offset:5120
v_add_f32 v16,v16,v50
v_mfma_f32_16x16x32_bf16 v[224:227],a[196:199],v[92:95],v[224:227]
v_add_f32 v16,v16,v51
v_cvt_pk_bf16_f32 v97,v50,v51
v_mfma_f32_16x16x32_bf16 v[56:59],a[160:163],a[32:35],v[32:35]
v_exp_f32 v52,v52
v_mfma_f32_16x16x32_bf16 v[56:59],a[164:167],a[36:39],v[56:59]
v_exp_f32 v53,v53
v_mfma_f32_16x16x32_bf16 v[56:59],a[168:171],a[40:43],v[56:59]
ds_read_b128 a[184:187],v2 offset:38912
v_add_f32 v17,v17,v52
v_mfma_f32_16x16x32_bf16 v[56:59],a[172:175],a[44:47],v[56:59]
v_add_f32 v17,v17,v53
v_cvt_pk_bf16_f32 v104,v52,v53
v_mfma_f32_16x16x32_bf16 v[132:135],a[200:203],v[64:67],0
s_waitcnt lgkmcnt(5)
v_exp_f32 v54,v54
v_mfma_f32_16x16x32_bf16 v[132:135],a[204:207],v[68:71],v[132:135]
v_exp_f32 v55,v55
v_mfma_f32_16x16x32_bf16 v[164:167],a[200:203],v[72:75],0
ds_read_b128 a[216:219],v4 offset:9216
v_add_f32 v17,v17,v54
v_mfma_f32_16x16x32_bf16 v[164:167],a[204:207],v[76:79],v[164:167]
buffer_store_dwordx4 v[184:187],v1,s[16:19],s5 offen offset:3072 sc1
v_add_f32 v17,v17,v55
v_cvt_pk_bf16_f32 v105,v54,v55
v_mfma_f32_16x16x32_bf16 v[60:63],a[160:163],a[48:51],v[36:39]
v_exp_f32 v56,v56
v_mfma_f32_16x16x32_bf16 v[60:63],a[164:167],a[52:55],v[60:63]
v_exp_f32 v57,v57
v_mfma_f32_16x16x32_bf16 v[60:63],a[168:171],a[56:59],v[60:63]
ds_read_b128 a[188:191],v2 offset:39936
v_add_f32 v18,v18,v56
v_mfma_f32_16x16x32_bf16 v[60:63],a[172:175],a[60:63],v[60:63]
v_add_f32 v18,v18,v57
v_cvt_pk_bf16_f32 v112,v56,v57
v_mfma_f32_16x16x32_bf16 v[196:199],a[200:203],v[80:83],0
v_exp_f32 v58,v58
v_mfma_f32_16x16x32_bf16 v[196:199],a[204:207],v[84:87],v[196:199]
v_exp_f32 v59,v59
v_mfma_f32_16x16x32_bf16 v[228:231],a[200:203],v[88:91],0
ds_read_b128 a[220:223],v4 offset:13312
v_add_f32 v18,v18,v58
v_mfma_f32_16x16x32_bf16 v[228:231],a[204:207],v[92:95],v[228:231]
s_waitcnt lgkmcnt(7)
v_add_f32 v18,v18,v59
v_cvt_pk_bf16_f32 v113,v58,v59
v_mfma_f32_16x16x32_bf16 v[48:51],a[176:179],a[0:3],v[24:27]
s_waitcnt lgkmcnt(5)
v_exp_f32 v60,v60
v_mfma_f32_16x16x32_bf16 v[48:51],a[180:183],a[4:7],v[48:51]
s_waitcnt lgkmcnt(1)
v_exp_f32 v61,v61
v_mfma_f32_16x16x32_bf16 v[48:51],a[184:187],a[8:11],v[48:51]
ds_read_b128 a[160:163],v2 offset:40960
v_add_f32 v19,v19,v60
v_mfma_f32_16x16x32_bf16 v[48:51],a[188:191],a[12:15],v[48:51]
v_add_f32 v19,v19,v61
v_cvt_pk_bf16_f32 v120,v60,v61
v_mfma_f32_16x16x32_bf16 v[136:139],a[208:211],v[64:67],0
v_exp_f32 v62,v62
v_mfma_f32_16x16x32_bf16 v[136:139],a[212:215],v[68:71],v[136:139]
v_exp_f32 v63,v63
v_mfma_f32_16x16x32_bf16 v[168:171],a[208:211],v[72:75],0
ds_read_b128 a[192:195],v4 offset:2048
v_add_f32 v19,v19,v62
v_mfma_f32_16x16x32_bf16 v[168:171],a[212:215],v[76:79],v[168:171]
buffer_store_dwordx4 v[216:219],v1,s[16:19],s7 offen offset:1024 sc1
v_add_f32 v19,v19,v63
v_cvt_pk_bf16_f32 v121,v62,v63
v_mfma_f32_16x16x32_bf16 v[52:55],a[176:179],a[16:19],v[28:31]
v_exp_f32 v48,v48
v_mfma_f32_16x16x32_bf16 v[52:55],a[180:183],a[20:23],v[52:55]
v_exp_f32 v49,v49
v_mfma_f32_16x16x32_bf16 v[52:55],a[184:187],a[24:27],v[52:55]
ds_read_b128 a[164:167],v2 offset:41984
v_add_f32 v16,v16,v48
v_mfma_f32_16x16x32_bf16 v[52:55],a[188:191],a[28:31],v[52:55]
v_add_f32 v16,v16,v49
v_cvt_pk_bf16_f32 v98,v48,v49
v_mfma_f32_16x16x32_bf16 v[200:203],a[208:211],v[80:83],0
v_exp_f32 v50,v50
v_mfma_f32_16x16x32_bf16 v[200:203],a[212:215],v[84:87],v[200:203]
v_exp_f32 v51,v51
v_mfma_f32_16x16x32_bf16 v[232:235],a[208:211],v[88:91],0
ds_read_b128 a[196:199],v4 offset:6144
v_add_f32 v16,v16,v50
v_mfma_f32_16x16x32_bf16 v[232:235],a[212:215],v[92:95],v[232:235]
v_add_f32 v16,v16,v51
v_cvt_pk_bf16_f32 v99,v50,v51
v_mfma_f32_16x16x32_bf16 v[56:59],a[176:179],a[32:35],v[32:35]
v_exp_f32 v52,v52
v_mfma_f32_16x16x32_bf16 v[56:59],a[180:183],a[36:39],v[56:59]
v_exp_f32 v53,v53
v_mfma_f32_16x16x32_bf16 v[56:59],a[184:187],a[40:43],v[56:59]
ds_read_b128 a[168:171],v2 offset:43008
v_add_f32 v17,v17,v52
v_mfma_f32_16x16x32_bf16 v[56:59],a[188:191],a[44:47],v[56:59]
buffer_store_dwordx4 v[248:251],v1,s[16:19],s7 offen offset:3072 sc1
v_add_f32 v17,v17,v53
v_cvt_pk_bf16_f32 v106,v52,v53
v_mfma_f32_16x16x32_bf16 v[140:143],a[216:219],v[64:67],0
s_waitcnt lgkmcnt(5)
v_exp_f32 v54,v54
v_mfma_f32_16x16x32_bf16 v[140:143],a[220:223],v[68:71],v[140:143]
v_exp_f32 v55,v55
v_mfma_f32_16x16x32_bf16 v[172:175],a[216:219],v[72:75],0
ds_read_b128 a[200:203],v4 offset:10240
v_add_f32 v17,v17,v54
v_mfma_f32_16x16x32_bf16 v[172:175],a[220:223],v[76:79],v[172:175]
v_add_f32 v17,v17,v55
v_cvt_pk_bf16_f32 v107,v54,v55
v_mfma_f32_16x16x32_bf16 v[60:63],a[176:179],a[48:51],v[36:39]
v_exp_f32 v56,v56
v_mfma_f32_16x16x32_bf16 v[60:63],a[180:183],a[52:55],v[60:63]
v_exp_f32 v57,v57
v_mfma_f32_16x16x32_bf16 v[60:63],a[184:187],a[56:59],v[60:63]
ds_read_b128 a[172:175],v2 offset:44032
v_add_f32 v18,v18,v56
v_mfma_f32_16x16x32_bf16 v[60:63],a[188:191],a[60:63],v[60:63]
v_add_f32 v18,v18,v57
v_cvt_pk_bf16_f32 v114,v56,v57
v_mfma_f32_16x16x32_bf16 v[204:207],a[216:219],v[80:83],0
v_exp_f32 v58,v58
v_mfma_f32_16x16x32_bf16 v[204:207],a[220:223],v[84:87],v[204:207]
v_exp_f32 v59,v59
v_mfma_f32_16x16x32_bf16 v[236:239],a[216:219],v[88:91],0
ds_read_b128 a[204:207],v4 offset:14336
v_add_f32 v18,v18,v58
v_mfma_f32_16x16x32_bf16 v[236:239],a[220:223],v[92:95],v[236:239]
s_waitcnt lgkmcnt(7)
v_add_f32 v18,v18,v59
v_cvt_pk_bf16_f32 v115,v58,v59
v_mfma_f32_16x16x32_bf16 v[48:51],a[160:163],a[0:3],v[24:27]
s_waitcnt lgkmcnt(5)
v_exp_f32 v60,v60
v_mfma_f32_16x16x32_bf16 v[48:51],a[164:167],a[4:7],v[48:51]
s_waitcnt lgkmcnt(1)
v_exp_f32 v61,v61
v_mfma_f32_16x16x32_bf16 v[48:51],a[168:171],a[8:11],v[48:51]
ds_read_b128 a[176:179],v2 offset:45056
v_add_f32 v19,v19,v60
v_mfma_f32_16x16x32_bf16 v[48:51],a[172:175],a[12:15],v[48:51]
v_add_f32 v19,v19,v61
v_cvt_pk_bf16_f32 v122,v60,v61
v_mfma_f32_16x16x32_bf16 v[144:147],a[192:195],v[64:67],0
v_exp_f32 v62,v62
v_mfma_f32_16x16x32_bf16 v[144:147],a[196:199],v[68:71],v[144:147]
v_exp_f32 v63,v63
v_mfma_f32_16x16x32_bf16 v[176:179],a[192:195],v[72:75],0
ds_read_b128 a[208:211],v4 offset:3072
v_add_f32 v19,v19,v62
v_mfma_f32_16x16x32_bf16 v[176:179],a[196:199],v[76:79],v[176:179]
v_add_f32 v19,v19,v63
v_cvt_pk_bf16_f32 v123,v62,v63
v_mfma_f32_16x16x32_bf16 v[52:55],a[160:163],a[16:19],v[28:31]
v_exp_f32 v48,v48
v_mfma_f32_16x16x32_bf16 v[52:55],a[164:167],a[20:23],v[52:55]
v_exp_f32 v49,v49
v_mfma_f32_16x16x32_bf16 v[52:55],a[168:171],a[24:27],v[52:55]
ds_read_b128 a[180:183],v2 offset:46080
v_add_f32 v16,v16,v48
v_mfma_f32_16x16x32_bf16 v[52:55],a[172:175],a[28:31],v[52:55]
v_add_f32 v16,v16,v49
v_cvt_pk_bf16_f32 v100,v48,v49
v_mfma_f32_16x16x32_bf16 v[208:211],a[192:195],v[80:83],0
v_exp_f32 v50,v50
v_mfma_f32_16x16x32_bf16 v[208:211],a[196:199],v[84:87],v[208:211]
v_exp_f32 v51,v51
v_mfma_f32_16x16x32_bf16 v[240:243],a[192:195],v[88:91],0
ds_read_b128 a[212:215],v4 offset:7168
v_add_f32 v16,v16,v50
v_mfma_f32_16x16x32_bf16 v[240:243],a[196:199],v[92:95],v[240:243]
v_add_f32 v16,v16,v51
v_cvt_pk_bf16_f32 v101,v50,v51
v_mfma_f32_16x16x32_bf16 v[56:59],a[160:163],a[32:35],v[32:35]
v_exp_f32 v52,v52
v_mfma_f32_16x16x32_bf16 v[56:59],a[164:167],a[36:39],v[56:59]
v_exp_f32 v53,v53
v_mfma_f32_16x16x32_bf16 v[56:59],a[168:171],a[40:43],v[56:59]
ds_read_b128 a[184:187],v2 offset:47104
v_add_f32 v17,v17,v52
v_mfma_f32_16x16x32_bf16 v[56:59],a[172:175],a[44:47],v[56:59]
v_add_f32 v17,v17,v53
v_cvt_pk_bf16_f32 v108,v52,v53
v_mfma_f32_16x16x32_bf16 v[148:151],a[200:203],v[64:67],0
s_waitcnt lgkmcnt(5)
v_exp_f32 v54,v54
v_mfma_f32_16x16x32_bf16 v[148:151],a[204:207],v[68:71],v[148:151]
v_exp_f32 v55,v55
v_mfma_f32_16x16x32_bf16 v[180:183],a[200:203],v[72:75],0
ds_read_b128 a[216:219],v4 offset:11264
v_add_f32 v17,v17,v54
v_mfma_f32_16x16x32_bf16 v[180:183],a[204:207],v[76:79],v[180:183]
v_add_f32 v17,v17,v55
v_cvt_pk_bf16_f32 v109,v54,v55
v_mfma_f32_16x16x32_bf16 v[60:63],a[160:163],a[48:51],v[36:39]
v_exp_f32 v56,v56
v_mfma_f32_16x16x32_bf16 v[60:63],a[164:167],a[52:55],v[60:63]
v_exp_f32 v57,v57
v_mfma_f32_16x16x32_bf16 v[60:63],a[168:171],a[56:59],v[60:63]
ds_read_b128 a[188:191],v2 offset:48128
v_add_f32 v18,v18,v56
v_mfma_f32_16x16x32_bf16 v[60:63],a[172:175],a[60:63],v[60:63]
v_add_f32 v18,v18,v57
v_cvt_pk_bf16_f32 v116,v56,v57
v_mfma_f32_16x16x32_bf16 v[212:215],a[200:203],v[80:83],0
v_exp_f32 v58,v58
v_mfma_f32_16x16x32_bf16 v[212:215],a[204:207],v[84:87],v[212:215]
v_exp_f32 v59,v59
v_mfma_f32_16x16x32_bf16 v[244:247],a[200:203],v[88:91],0
ds_read_b128 a[220:223],v4 offset:15360
v_add_f32 v18,v18,v58
v_mfma_f32_16x16x32_bf16 v[244:247],a[204:207],v[92:95],v[244:247]
s_waitcnt lgkmcnt(7)
v_add_f32 v18,v18,v59
v_cvt_pk_bf16_f32 v117,v58,v59
v_mfma_f32_16x16x32_bf16 v[48:51],a[176:179],a[0:3],v[24:27]
s_waitcnt lgkmcnt(5)
v_exp_f32 v60,v60
v_mfma_f32_16x16x32_bf16 v[48:51],a[180:183],a[4:7],v[48:51]
s_waitcnt lgkmcnt(3)
v_exp_f32 v61,v61
v_mfma_f32_16x16x32_bf16 v[48:51],a[184:187],a[8:11],v[48:51]
s_waitcnt lgkmcnt(1)
v_add_f32 v19,v19,v60
v_add_f32 v19,v19,v61
v_mfma_f32_16x16x32_bf16 v[48:51],a[188:191],a[12:15],v[48:51]
v_exp_f32 v62,v62
v_mfma_f32_16x16x32_bf16 v[152:155],a[208:211],v[64:67],0
s_waitcnt vmcnt(4) lgkmcnt(0)
v_exp_f32 v63,v63
v_mfma_f32_16x16x32_bf16 v[152:155],a[212:215],v[68:71],v[152:155]
s_barrier
v_cvt_pk_bf16_f32 v124,v60,v61
v_add_f32 v19,v19,v62
v_mfma_f32_16x16x32_bf16 v[184:187],a[208:211],v[72:75],0
ds_read_b128 a[160:163],v2 offset:0
v_add_f32 v19,v19,v63
v_mfma_f32_16x16x32_bf16 v[184:187],a[212:215],v[76:79],v[184:187]
ds_read_b128 a[192:195],v4 offset:32768
v_cvt_pk_bf16_f32 v125,v62,v63
v_mfma_f32_16x16x32_bf16 v[52:55],a[176:179],a[16:19],v[28:31]
s_add_u32 m0,s23,32768
v_exp_f32 v48,v48
v_mfma_f32_16x16x32_bf16 v[52:55],a[180:183],a[20:23],v[52:55]
s_add_u32 s24,s24,16384
v_exp_f32 v49,v49
v_mfma_f32_16x16x32_bf16 v[52:55],a[184:187],a[24:27],v[52:55]
ds_read_b128 a[164:167],v2 offset:1024
v_add_f32 v16,v16,v48
v_mfma_f32_16x16x32_bf16 v[52:55],a[188:191],a[28:31],v[52:55]
buffer_load_dwordx4 v1,s[16:19],s24 offen offset:0 sc1 lds
v_add_f32 v16,v16,v49
v_cvt_pk_bf16_f32 v102,v48,v49
v_mfma_f32_16x16x32_bf16 v[216:219],a[208:211],v[80:83],0
v_exp_f32 v50,v50
v_mfma_f32_16x16x32_bf16 v[216:219],a[212:215],v[84:87],v[216:219]
v_exp_f32 v51,v51
v_mfma_f32_16x16x32_bf16 v[248:251],a[208:211],v[88:91],0
ds_read_b128 a[196:199],v4 offset:36864
v_add_f32 v16,v16,v50
v_mfma_f32_16x16x32_bf16 v[248:251],a[212:215],v[92:95],v[248:251]
buffer_load_dwordx4 v1,s[16:19],s24 offen offset:1024 sc1 lds
v_add_f32 v16,v16,v51
v_cvt_pk_bf16_f32 v103,v50,v51
v_mfma_f32_16x16x32_bf16 v[56:59],a[176:179],a[32:35],v[32:35]
v_exp_f32 v52,v52
v_mfma_f32_16x16x32_bf16 v[56:59],a[180:183],a[36:39],v[56:59]
v_exp_f32 v53,v53
v_mfma_f32_16x16x32_bf16 v[56:59],a[184:187],a[40:43],v[56:59]
ds_read_b128 a[168:171],v2 offset:2048
v_add_f32 v17,v17,v52
v_mfma_f32_16x16x32_bf16 v[56:59],a[188:191],a[44:47],v[56:59]
buffer_load_dwordx4 v1,s[16:19],s24 offen offset:2048 sc1 lds
v_add_f32 v17,v17,v53
v_cvt_pk_bf16_f32 v110,v52,v53
v_mfma_f32_16x16x32_bf16 v[156:159],a[216:219],v[64:67],0
v_exp_f32 v54,v54
v_mfma_f32_16x16x32_bf16 v[156:159],a[220:223],v[68:71],v[156:159]
v_exp_f32 v55,v55
v_mfma_f32_16x16x32_bf16 v[188:191],a[216:219],v[72:75],0
ds_read_b128 a[200:203],v4 offset:40960
v_add_f32 v17,v17,v54
v_mfma_f32_16x16x32_bf16 v[188:191],a[220:223],v[76:79],v[188:191]
buffer_load_dwordx4 v1,s[16:19],s24 offen offset:3072 sc1 lds
v_add_f32 v17,v17,v55
v_cvt_pk_bf16_f32 v111,v54,v55
v_mfma_f32_16x16x32_bf16 v[60:63],a[176:179],a[48:51],v[36:39]
s_add_u32 m0,s23,65536
v_exp_f32 v56,v56
v_mfma_f32_16x16x32_bf16 v[60:63],a[180:183],a[52:55],v[60:63]
s_add_u32 s25,s25,16384
v_exp_f32 v57,v57
v_mfma_f32_16x16x32_bf16 v[60:63],a[184:187],a[56:59],v[60:63]
ds_read_b128 a[172:175],v2 offset:3072
v_add_f32 v18,v18,v56
v_mfma_f32_16x16x32_bf16 v[60:63],a[188:191],a[60:63],v[60:63]
buffer_load_dwordx4 v1,s[16:19],s25 offen offset:0 sc1 lds
v_add_f32 v18,v18,v57
v_cvt_pk_bf16_f32 v118,v56,v57
v_mfma_f32_16x16x32_bf16 v[220:223],a[216:219],v[80:83],0
v_exp_f32 v58,v58
v_mfma_f32_16x16x32_bf16 v[220:223],a[220:223],v[84:87],v[220:223]
v_exp_f32 v59,v59
v_mfma_f32_16x16x32_bf16 v[252:255],a[216:219],v[88:91],0
ds_read_b128 a[204:207],v4 offset:45056
v_add_f32 v18,v18,v58
v_mfma_f32_16x16x32_bf16 v[252:255],a[220:223],v[92:95],v[252:255]
buffer_load_dwordx4 v1,s[16:19],s25 offen offset:1024 sc1 lds
v_add_f32 v18,v18,v59
v_cvt_pk_bf16_f32 v119,v58,v59
s_sub_u32 s26,s22,1
s_cmp_eq_u32 s26,0
s_cbranch_scc1 K2_MID
.p2align 3
K2_L1:
s_waitcnt lgkmcnt(7)
v_mfma_f32_16x16x32_bf16 v[48:51],a[160:163],a[0:3],v[24:27]
s_waitcnt lgkmcnt(5)
v_exp_f32 v60,v60
v_mfma_f32_16x16x32_bf16 v[48:51],a[164:167],a[4:7],v[48:51]
s_waitcnt lgkmcnt(1)
v_exp_f32 v61,v61
v_mfma_f32_16x16x32_bf16 v[48:51],a[168:171],a[8:11],v[48:51]
ds_read_b128 a[176:179],v2 offset:4096
v_add_f32 v19,v19,v60
v_mfma_f32_16x16x32_bf16 v[48:51],a[172:175],a[12:15],v[48:51]
buffer_load_dwordx4 v1,s[16:19],s25 offen offset:2048 sc1 lds
v_add_f32 v19,v19,v61
v_cvt_pk_bf16_f32 v126,v60,v61
v_mfma_f32_16x16x32_bf16 v[128:131],a[192:195],v[96:99],v[128:131]
v_exp_f32 v62,v62
v_mfma_f32_16x16x32_bf16 v[128:131],a[196:199],v[100:103],v[128:131]
v_exp_f32 v63,v63
v_mfma_f32_16x16x32_bf16 v[160:163],a[192:195],v[104:107],v[160:163]
ds_read_b128 a[208:211],v4 offset:33792
v_add_f32 v19,v19,v62
v_mfma_f32_16x16x32_bf16 v[160:163],a[196:199],v[108:111],v[160:163]
buffer_load_dwordx4 v1,s[16:19],s25 offen offset:3072 sc1 lds
v_add_f32 v19,v19,v63
v_cvt_pk_bf16_f32 v127,v62,v63
v_mfma_f32_16x16x32_bf16 v[52:55],a[160:163],a[16:19],v[28:31]
s_lshr_b32 s28,s10,2
v_exp_f32 v48,v48
v_mfma_f32_16x16x32_bf16 v[52:55],a[164:167],a[20:23],v[52:55]
s_lshl_b32 s28,s28,17
v_exp_f32 v49,v49
v_mfma_f32_16x16x32_bf16 v[52:55],a[168:171],a[24:27],v[52:55]
ds_read_b128 a[180:183],v2 offset:5120
v_add_f32 v16,v16,v48
v_mfma_f32_16x16x32_bf16 v[52:55],a[172:175],a[28:31],v[52:55]
v_add_f32 v16,v16,v49
v_cvt_pk_bf16_f32 v64,v48,v49
v_mfma_f32_16x16x32_bf16 v[192:195],a[192:195],v[112:115],v[192:195]
s_and_b32 s29,s10,3
v_exp_f32 v50,v50
v_mfma_f32_16x16x32_bf16 v[192:195],a[196:199],v[116:119],v[192:195]
s_lshl_b32 s29,s29,12
v_exp_f32 v51,v51
v_mfma_f32_16x16x32_bf16 v[224:227],a[192:195],v[120:123],v[224:227]
ds_read_b128 a[212:215],v4 offset:37888
v_add_f32 v16,v16,v50
v_mfma_f32_16x16x32_bf16 v[224:227],a[196:199],v[124:127],v[224:227]
s_add_u32 s28,s28,s29
v_add_f32 v16,v16,v51
v_cvt_pk_bf16_f32 v65,v50,v51
v_mfma_f32_16x16x32_bf16 v[56:59],a[160:163],a[32:35],v[32:35]
s_add_u32 s28,s28,s9
v_exp_f32 v52,v52
v_mfma_f32_16x16x32_bf16 v[56:59],a[164:167],a[36:39],v[56:59]
s_cmp_lt_u32 s10,16
v_exp_f32 v53,v53
v_mfma_f32_16x16x32_bf16 v[56:59],a[168:171],a[40:43],v[56:59]
ds_read_b128 a[184:187],v2 offset:6144
v_add_f32 v17,v17,v52
v_mfma_f32_16x16x32_bf16 v[56:59],a[172:175],a[44:47],v[56:59]
s_cselect_b32 s28,s28,0x40000000
v_add_f32 v17,v17,v53
v_cvt_pk_bf16_f32 v72,v52,v53
v_mfma_f32_16x16x32_bf16 v[132:135],a[200:203],v[96:99],v[132:135]
s_add_u32 s10,s10,1
v_exp_f32 v54,v54
s_waitcnt lgkmcnt(5)
v_mfma_f32_16x16x32_bf16 v[132:135],a[204:207],v[100:103],v[132:135]
v_exp_f32 v55,v55
v_mfma_f32_16x16x32_bf16 v[164:167],a[200:203],v[104:107],v[164:167]
ds_read_b128 a[216:219],v4 offset:41984
v_add_f32 v17,v17,v54
v_mfma_f32_16x16x32_bf16 v[164:167],a[204:207],v[108:111],v[164:167]
buffer_load_dword a250,v0,s[12:15],s28 offen
v_add_f32 v17,v17,v55
v_cvt_pk_bf16_f32 v73,v54,v55
v_mfma_f32_16x16x32_bf16 v[60:63],a[160:163],a[48:51],v[36:39]
v_exp_f32 v56,v56
v_mfma_f32_16x16x32_bf16 v[60:63],a[164:167],a[52:55],v[60:63]
v_exp_f32 v57,v57
v_mfma_f32_16x16x32_bf16 v[60:63],a[168:171],a[56:59],v[60:63]
ds_read_b128 a[188:191],v2 offset:7168
v_add_f32 v18,v18,v56
v_mfma_f32_16x16x32_bf16 v[60:63],a[172:175],a[60:63],v[60:63]
buffer_load_dword a252,v0,s[12:15],s28 offen offset:128
v_add_f32 v18,v18,v57
v_cvt_pk_bf16_f32 v80,v56,v57
v_mfma_f32_16x16x32_bf16 v[196:199],a[200:203],v[112:115],v[196:199]
v_exp_f32 v58,v58
v_mfma_f32_16x16x32_bf16 v[196:199],a[204:207],v[116:119],v[196:199]
v_exp_f32 v59,v59
v_mfma_f32_16x16x32_bf16 v[228:231],a[200:203],v[120:123],v[228:231]
ds_read_b128 a[220:223],v4 offset:46080
v_add_f32 v18,v18,v58
v_mfma_f32_16x16x32_bf16 v[228:231],a[204:207],v[124:127],v[228:231]
s_waitcnt lgkmcnt(7)
v_add_f32 v18,v18,v59
v_cvt_pk_bf16_f32 v81,v58,v59
v_mfma_f32_16x16x32_bf16 v[48:51],a[176:179],a[0:3],v[24:27]
s_waitcnt lgkmcnt(5)
v_exp_f32 v60,v60
v_mfma_f32_16x16x32_bf16 v[48:51],a[180:183],a[4:7],v[48:51]
s_waitcnt lgkmcnt(1)
v_exp_f32 v61,v61
v_mfma_f32_16x16x32_bf16 v[48:51],a[184:187],a[8:11],v[48:51]
ds_read_b128 a[160:163],v2 offset:8192
v_add_f32 v19,v19,v60
v_mfma_f32_16x16x32_bf16 v[48:51],a[188:191],a[12:15],v[48:51]
v_add_f32 v19,v19,v61
v_cvt_pk_bf16_f32 v88,v60,v61
v_mfma_f32_16x16x32_bf16 v[136:139],a[208:211],v[96:99],v[136:139]
v_exp_f32 v62,v62
v_mfma_f32_16x16x32_bf16 v[136:139],a[212:215],v[100:103],v[136:139]
v_exp_f32 v63,v63
v_mfma_f32_16x16x32_bf16 v[168:171],a[208:211],v[104:107],v[168:171]
ds_read_b128 a[192:195],v4 offset:34816
v_add_f32 v19,v19,v62
v_mfma_f32_16x16x32_bf16 v[168:171],a[212:215],v[108:111],v[168:171]
v_add_f32 v19,v19,v63
v_cvt_pk_bf16_f32 v89,v62,v63
v_mfma_f32_16x16x32_bf16 v[52:55],a[176:179],a[16:19],v[28:31]
v_exp_f32 v48,v48
v_mfma_f32_16x16x32_bf16 v[52:55],a[180:183],a[20:23],v[52:55]
v_exp_f32 v49,v49
v_mfma_f32_16x16x32_bf16 v[52:55],a[184:187],a[24:27],v[52:55]
ds_read_b128 a[164:167],v2 offset:9216
v_add_f32 v16,v16,v48
v_mfma_f32_16x16x32_bf16 v[52:55],a[188:191],a[28:31],v[52:55]
v_add_f32 v16,v16,v49
v_cvt_pk_bf16_f32 v66,v48,v49
v_mfma_f32_16x16x32_bf16 v[200:203],a[208:211],v[112:115],v[200:203]
v_exp_f32 v50,v50
v_mfma_f32_16x16x32_bf16 v[200:203],a[212:215],v[116:119],v[200:203]
v_exp_f32 v51,v51
v_mfma_f32_16x16x32_bf16 v[232:235],a[208:211],v[120:123],v[232:235]
ds_read_b128 a[196:199],v4 offset:38912
v_add_f32 v16,v16,v50
v_mfma_f32_16x16x32_bf16 v[232:235],a[212:215],v[124:127],v[232:235]
v_add_f32 v16,v16,v51
v_cvt_pk_bf16_f32 v67,v50,v51
v_mfma_f32_16x16x32_bf16 v[56:59],a[176:179],a[32:35],v[32:35]
v_exp_f32 v52,v52
v_mfma_f32_16x16x32_bf16 v[56:59],a[180:183],a[36:39],v[56:59]
v_exp_f32 v53,v53
v_mfma_f32_16x16x32_bf16 v[56:59],a[184:187],a[40:43],v[56:59]
ds_read_b128 a[168:171],v2 offset:10240
v_add_f32 v17,v17,v52
v_mfma_f32_16x16x32_bf16 v[56:59],a[188:191],a[44:47],v[56:59]
v_add_f32 v17,v17,v53
v_cvt_pk_bf16_f32 v74,v52,v53
v_mfma_f32_16x16x32_bf16 v[140:143],a[216:219],v[96:99],v[140:143]
s_waitcnt lgkmcnt(5)
v_exp_f32 v54,v54
v_mfma_f32_16x16x32_bf16 v[140:143],a[220:223],v[100:103],v[140:143]
v_exp_f32 v55,v55
v_mfma_f32_16x16x32_bf16 v[172:175],a[216:219],v[104:107],v[172:175]
ds_read_b128 a[200:203],v4 offset:43008
v_add_f32 v17,v17,v54
v_mfma_f32_16x16x32_bf16 v[172:175],a[220:223],v[108:111],v[172:175]
v_add_f32 v17,v17,v55
v_cvt_pk_bf16_f32 v75,v54,v55
v_mfma_f32_16x16x32_bf16 v[60:63],a[176:179],a[48:51],v[36:39]
v_exp_f32 v56,v56
v_mfma_f32_16x16x32_bf16 v[60:63],a[180:183],a[52:55],v[60:63]
v_exp_f32 v57,v57
v_mfma_f32_16x16x32_bf16 v[60:63],a[184:187],a[56:59],v[60:63]
ds_read_b128 a[172:175],v2 offset:11264
v_add_f32 v18,v18,v56
v_mfma_f32_16x16x32_bf16 v[60:63],a[188:191],a[60:63],v[60:63]
v_add_f32 v18,v18,v57
v_cvt_pk_bf16_f32 v82,v56,v57
v_mfma_f32_16x16x32_bf16 v[204:207],a[216:219],v[112:115],v[204:207]
v_exp_f32 v58,v58
v_mfma_f32_16x16x32_bf16 v[204:207],a[220:223],v[116:119],v[204:207]
v_exp_f32 v59,v59
v_mfma_f32_16x16x32_bf16 v[236:239],a[216:219],v[120:123],v[236:239]
ds_read_b128 a[204:207],v4 offset:47104
v_add_f32 v18,v18,v58
v_mfma_f32_16x16x32_bf16 v[236:239],a[220:223],v[124:127],v[236:239]
s_waitcnt lgkmcnt(7)
v_add_f32 v18,v18,v59
v_cvt_pk_bf16_f32 v83,v58,v59
v_mfma_f32_16x16x32_bf16 v[48:51],a[160:163],a[0:3],v[24:27]
s_waitcnt lgkmcnt(5)
v_exp_f32 v60,v60
v_mfma_f32_16x16x32_bf16 v[48:51],a[164:167],a[4:7],v[48:51]
s_waitcnt lgkmcnt(1)
v_exp_f32 v61,v61
v_mfma_f32_16x16x32_bf16 v[48:51],a[168:171],a[8:11],v[48:51]
ds_read_b128 a[176:179],v2 offset:12288
v_add_f32 v19,v19,v60
v_mfma_f32_16x16x32_bf16 v[48:51],a[172:175],a[12:15],v[48:51]
v_add_f32 v19,v19,v61
v_cvt_pk_bf16_f32 v90,v60,v61
v_mfma_f32_16x16x32_bf16 v[144:147],a[192:195],v[96:99],v[144:147]
v_exp_f32 v62,v62
v_mfma_f32_16x16x32_bf16 v[144:147],a[196:199],v[100:103],v[144:147]
v_exp_f32 v63,v63
v_mfma_f32_16x16x32_bf16 v[176:179],a[192:195],v[104:107],v[176:179]
ds_read_b128 a[208:211],v4 offset:35840
v_add_f32 v19,v19,v62
v_mfma_f32_16x16x32_bf16 v[176:179],a[196:199],v[108:111],v[176:179]
v_add_f32 v19,v19,v63
v_cvt_pk_bf16_f32 v91,v62,v63
v_mfma_f32_16x16x32_bf16 v[52:55],a[160:163],a[16:19],v[28:31]
v_exp_f32 v48,v48
v_mfma_f32_16x16x32_bf16 v[52:55],a[164:167],a[20:23],v[52:55]
v_exp_f32 v49,v49
v_mfma_f32_16x16x32_bf16 v[52:55],a[168:171],a[24:27],v[52:55]
ds_read_b128 a[180:183],v2 offset:13312
v_add_f32 v16,v16,v48
v_mfma_f32_16x16x32_bf16 v[52:55],a[172:175],a[28:31],v[52:55]
v_add_f32 v16,v16,v49
v_cvt_pk_bf16_f32 v68,v48,v49
v_mfma_f32_16x16x32_bf16 v[208:211],a[192:195],v[112:115],v[208:211]
v_exp_f32 v50,v50
v_mfma_f32_16x16x32_bf16 v[208:211],a[196:199],v[116:119],v[208:211]
v_exp_f32 v51,v51
v_mfma_f32_16x16x32_bf16 v[240:243],a[192:195],v[120:123],v[240:243]
ds_read_b128 a[212:215],v4 offset:39936
v_add_f32 v16,v16,v50
v_mfma_f32_16x16x32_bf16 v[240:243],a[196:199],v[124:127],v[240:243]
v_add_f32 v16,v16,v51
v_cvt_pk_bf16_f32 v69,v50,v51
v_mfma_f32_16x16x32_bf16 v[56:59],a[160:163],a[32:35],v[32:35]
v_exp_f32 v52,v52
v_mfma_f32_16x16x32_bf16 v[56:59],a[164:167],a[36:39],v[56:59]
v_exp_f32 v53,v53
v_mfma_f32_16x16x32_bf16 v[56:59],a[168:171],a[40:43],v[56:59]
ds_read_b128 a[184:187],v2 offset:14336
v_add_f32 v17,v17,v52
v_mfma_f32_16x16x32_bf16 v[56:59],a[172:175],a[44:47],v[56:59]
v_add_f32 v17,v17,v53
v_cvt_pk_bf16_f32 v76,v52,v53
v_mfma_f32_16x16x32_bf16 v[148:151],a[200:203],v[96:99],v[148:151]
s_waitcnt lgkmcnt(5)
v_exp_f32 v54,v54
v_mfma_f32_16x16x32_bf16 v[148:151],a[204:207],v[100:103],v[148:151]
v_exp_f32 v55,v55
v_mfma_f32_16x16x32_bf16 v[180:183],a[200:203],v[104:107],v[180:183]
ds_read_b128 a[216:219],v4 offset:44032
v_add_f32 v17,v17,v54
v_mfma_f32_16x16x32_bf16 v[180:183],a[204:207],v[108:111],v[180:183]
v_add_f32 v17,v17,v55
v_cvt_pk_bf16_f32 v77,v54,v55
v_mfma_f32_16x16x32_bf16 v[60:63],a[160:163],a[48:51],v[36:39]
v_exp_f32 v56,v56
v_mfma_f32_16x16x32_bf16 v[60:63],a[164:167],a[52:55],v[60:63]
v_exp_f32 v57,v57
v_mfma_f32_16x16x32_bf16 v[60:63],a[168:171],a[56:59],v[60:63]
ds_read_b128 a[188:191],v2 offset:15360
v_add_f32 v18,v18,v56
v_mfma_f32_16x16x32_bf16 v[60:63],a[172:175],a[60:63],v[60:63]
v_add_f32 v18,v18,v57
v_cvt_pk_bf16_f32 v84,v56,v57
v_mfma_f32_16x16x32_bf16 v[212:215],a[200:203],v[112:115],v[212:215]
v_exp_f32 v58,v58
v_mfma_f32_16x16x32_bf16 v[212:215],a[204:207],v[116:119],v[212:215]
v_exp_f32 v59,v59
v_mfma_f32_16x16x32_bf16 v[244:247],a[200:203],v[120:123],v[244:247]
ds_read_b128 a[220:223],v4 offset:48128
v_add_f32 v18,v18,v58
v_mfma_f32_16x16x32_bf16 v[244:247],a[204:207],v[124:127],v[244:247]
s_waitcnt lgkmcnt(7)
v_add_f32 v18,v18,v59
v_cvt_pk_bf16_f32 v85,v58,v59
v_mfma_f32_16x16x32_bf16 v[48:51],a[176:179],a[0:3],v[24:27]
s_waitcnt lgkmcnt(5)
v_exp_f32 v60,v60
v_mfma_f32_16x16x32_bf16 v[48:51],a[180:183],a[4:7],v[48:51]
s_waitcnt lgkmcnt(3)
v_exp_f32 v61,v61
v_mfma_f32_16x16x32_bf16 v[48:51],a[184:187],a[8:11],v[48:51]
s_waitcnt lgkmcnt(1)
v_add_f32 v19,v19,v60
v_add_f32 v19,v19,v61
v_mfma_f32_16x16x32_bf16 v[48:51],a[188:191],a[12:15],v[48:51]
s_cmp_eq_u32 s8,0
v_exp_f32 v62,v62
v_mfma_f32_16x16x32_bf16 v[152:155],a[208:211],v[96:99],v[152:155]
s_waitcnt vmcnt(2) lgkmcnt(0)
v_exp_f32 v63,v63
v_mfma_f32_16x16x32_bf16 v[152:155],a[212:215],v[100:103],v[152:155]
s_barrier
s_cbranch_scc1 F_H1_O
F_H1_B:
v_cvt_pk_bf16_f32 v92,v60,v61
v_add_f32 v19,v19,v62
v_mfma_f32_16x16x32_bf16 v[184:187],a[208:211],v[104:107],v[184:187]
ds_read_b128 a[160:163],v2 offset:32768
v_add_f32 v19,v19,v63
v_mfma_f32_16x16x32_bf16 v[184:187],a[212:215],v[108:111],v[184:187]
ds_read_b128 a[192:195],v4 offset:0
v_cvt_pk_bf16_f32 v93,v62,v63
v_mfma_f32_16x16x32_bf16 v[52:55],a[176:179],a[16:19],v[28:31]
s_add_u32 m0,s23,0
v_exp_f32 v48,v48
v_mfma_f32_16x16x32_bf16 v[52:55],a[180:183],a[20:23],v[52:55]
s_add_u32 s24,s24,16384
v_exp_f32 v49,v49
v_mfma_f32_16x16x32_bf16 v[52:55],a[184:187],a[24:27],v[52:55]
ds_read_b128 a[164:167],v2 offset:33792
v_add_f32 v16,v16,v48
v_mfma_f32_16x16x32_bf16 v[52:55],a[188:191],a[28:31],v[52:55]
buffer_load_dwordx4 v1,s[16:19],s24 offen offset:0 sc1 lds
v_add_f32 v16,v16,v49
v_cvt_pk_bf16_f32 v70,v48,v49
v_mfma_f32_16x16x32_bf16 v[216:219],a[208:211],v[112:115],v[216:219]
v_exp_f32 v50,v50
v_mfma_f32_16x16x32_bf16 v[216:219],a[212:215],v[116:119],v[216:219]
v_exp_f32 v51,v51
v_mfma_f32_16x16x32_bf16 v[248:251],a[208:211],v[120:123],v[248:251]
ds_read_b128 a[196:199],v4 offset:4096
v_add_f32 v16,v16,v50
v_mfma_f32_16x16x32_bf16 v[248:251],a[212:215],v[124:127],v[248:251]
buffer_load_dwordx4 v1,s[16:19],s24 offen offset:1024 sc1 lds
v_add_f32 v16,v16,v51
v_cvt_pk_bf16_f32 v71,v50,v51
v_mfma_f32_16x16x32_bf16 v[56:59],a[176:179],a[32:35],v[32:35]
v_exp_f32 v52,v52
v_mfma_f32_16x16x32_bf16 v[56:59],a[180:183],a[36:39],v[56:59]
v_exp_f32 v53,v53
v_mfma_f32_16x16x32_bf16 v[56:59],a[184:187],a[40:43],v[56:59]
ds_read_b128 a[168:171],v2 offset:34816
v_add_f32 v17,v17,v52
v_mfma_f32_16x16x32_bf16 v[56:59],a[188:191],a[44:47],v[56:59]
buffer_load_dwordx4 v1,s[16:19],s24 offen offset:2048 sc1 lds
v_add_f32 v17,v17,v53
v_cvt_pk_bf16_f32 v78,v52,v53
v_mfma_f32_16x16x32_bf16 v[156:159],a[216:219],v[96:99],v[156:159]
v_exp_f32 v54,v54
v_mfma_f32_16x16x32_bf16 v[156:159],a[220:223],v[100:103],v[156:159]
v_exp_f32 v55,v55
v_mfma_f32_16x16x32_bf16 v[188:191],a[216:219],v[104:107],v[188:191]
ds_read_b128 a[200:203],v4 offset:8192
v_add_f32 v17,v17,v54
v_mfma_f32_16x16x32_bf16 v[188:191],a[220:223],v[108:111],v[188:191]
buffer_load_dwordx4 v1,s[16:19],s24 offen offset:3072 sc1 lds
v_add_f32 v17,v17,v55
v_cvt_pk_bf16_f32 v79,v54,v55
v_mfma_f32_16x16x32_bf16 v[60:63],a[176:179],a[48:51],v[36:39]
s_add_u32 m0,s23,98304
v_exp_f32 v56,v56
v_mfma_f32_16x16x32_bf16 v[60:63],a[180:183],a[52:55],v[60:63]
s_add_u32 s25,s25,16384
v_exp_f32 v57,v57
v_mfma_f32_16x16x32_bf16 v[60:63],a[184:187],a[56:59],v[60:63]
ds_read_b128 a[172:175],v2 offset:35840
v_add_f32 v18,v18,v56
v_mfma_f32_16x16x32_bf16 v[60:63],a[188:191],a[60:63],v[60:63]
buffer_load_dwordx4 v1,s[16:19],s25 offen offset:0 sc1 lds
v_add_f32 v18,v18,v57
v_cvt_pk_bf16_f32 v86,v56,v57
v_mfma_f32_16x16x32_bf16 v[220:223],a[216:219],v[112:115],v[220:223]
v_exp_f32 v58,v58
v_mfma_f32_16x16x32_bf16 v[220:223],a[220:223],v[116:119],v[220:223]
s_waitcnt lgkmcnt(6)
v_exp_f32 v59,v59
v_mfma_f32_16x16x32_bf16 v[252:255],a[216:219],v[120:123],v[252:255]
ds_read_b128 a[204:207],v4 offset:12288
v_add_f32 v18,v18,v58
v_mfma_f32_16x16x32_bf16 v[252:255],a[220:223],v[124:127],v[252:255]
buffer_load_dwordx4 v1,s[16:19],s25 offen offset:1024 sc1 lds
v_add_f32 v18,v18,v59
v_cvt_pk_bf16_f32 v87,v58,v59
v_mfma_f32_16x16x32_bf16 v[48:51],a[160:163],a[0:3],v[24:27]
s_waitcnt lgkmcnt(5)
v_exp_f32 v60,v60
v_mfma_f32_16x16x32_bf16 v[48:51],a[164:167],a[4:7],v[48:51]
s_waitcnt lgkmcnt(1)
v_exp_f32 v61,v61
v_mfma_f32_16x16x32_bf16 v[48:51],a[168:171],a[8:11],v[48:51]
ds_read_b128 a[176:179],v2 offset:36864
v_add_f32 v19,v19,v60
v_mfma_f32_16x16x32_bf16 v[48:51],a[172:175],a[12:15],v[48:51]
buffer_load_dwordx4 v1,s[16:19],s25 offen offset:2048 sc1 lds
v_add_f32 v19,v19,v61
v_cvt_pk_bf16_f32 v94,v60,v61
v_mfma_f32_16x16x32_bf16 v[128:131],a[192:195],v[64:67],v[128:131]
v_exp_f32 v62,v62
v_mfma_f32_16x16x32_bf16 v[128:131],a[196:199],v[68:71],v[128:131]
v_exp_f32 v63,v63
v_mfma_f32_16x16x32_bf16 v[160:163],a[192:195],v[72:75],v[160:163]
ds_read_b128 a[208:211],v4 offset:1024
v_add_f32 v19,v19,v62
v_mfma_f32_16x16x32_bf16 v[160:163],a[196:199],v[76:79],v[160:163]
buffer_load_dwordx4 v1,s[16:19],s25 offen offset:3072 sc1 lds
v_add_f32 v19,v19,v63
v_cvt_pk_bf16_f32 v95,v62,v63
v_mfma_f32_16x16x32_bf16 v[52:55],a[160:163],a[16:19],v[28:31]
v_exp_f32 v48,v48
v_mfma_f32_16x16x32_bf16 v[52:55],a[164:167],a[20:23],v[52:55]
v_exp_f32 v49,v49
v_mfma_f32_16x16x32_bf16 v[52:55],a[168:171],a[24:27],v[52:55]
ds_read_b128 a[180:183],v2 offset:37888
v_add_f32 v16,v16,v48
v_mfma_f32_16x16x32_bf16 v[52:55],a[172:175],a[28:31],v[52:55]
v_add_f32 v16,v16,v49
v_cvt_pk_bf16_f32 v96,v48,v49
v_mfma_f32_16x16x32_bf16 v[192:195],a[192:195],v[80:83],v[192:195]
v_exp_f32 v50,v50
v_mfma_f32_16x16x32_bf16 v[192:195],a[196:199],v[84:87],v[192:195]
v_exp_f32 v51,v51
v_mfma_f32_16x16x32_bf16 v[224:227],a[192:195],v[88:91],v[224:227]
ds_read_b128 a[212:215],v4 offset:5120
v_add_f32 v16,v16,v50
v_mfma_f32_16x16x32_bf16 v[224:227],a[196:199],v[92:95],v[224:227]
v_add_f32 v16,v16,v51
v_cvt_pk_bf16_f32 v97,v50,v51
v_mfma_f32_16x16x32_bf16 v[56:59],a[160:163],a[32:35],v[32:35]
v_exp_f32 v52,v52
v_mfma_f32_16x16x32_bf16 v[56:59],a[164:167],a[36:39],v[56:59]
v_exp_f32 v53,v53
v_mfma_f32_16x16x32_bf16 v[56:59],a[168:171],a[40:43],v[56:59]
ds_read_b128 a[184:187],v2 offset:38912
v_add_f32 v17,v17,v52
v_mfma_f32_16x16x32_bf16 v[56:59],a[172:175],a[44:47],v[56:59]
v_add_f32 v17,v17,v53
v_cvt_pk_bf16_f32 v104,v52,v53
v_mfma_f32_16x16x32_bf16 v[132:135],a[200:203],v[64:67],v[132:135]
s_waitcnt lgkmcnt(5)
v_exp_f32 v54,v54
v_mfma_f32_16x16x32_bf16 v[132:135],a[204:207],v[68:71],v[132:135]
v_exp_f32 v55,v55
v_mfma_f32_16x16x32_bf16 v[164:167],a[200:203],v[72:75],v[164:167]
ds_read_b128 a[216:219],v4 offset:9216
v_add_f32 v17,v17,v54
v_mfma_f32_16x16x32_bf16 v[164:167],a[204:207],v[76:79],v[164:167]
v_add_f32 v17,v17,v55
v_cvt_pk_bf16_f32 v105,v54,v55
v_mfma_f32_16x16x32_bf16 v[60:63],a[160:163],a[48:51],v[36:39]
v_exp_f32 v56,v56
v_mfma_f32_16x16x32_bf16 v[60:63],a[164:167],a[52:55],v[60:63]
v_exp_f32 v57,v57
v_mfma_f32_16x16x32_bf16 v[60:63],a[168:171],a[56:59],v[60:63]
ds_read_b128 a[188:191],v2 offset:39936
v_add_f32 v18,v18,v56
v_mfma_f32_16x16x32_bf16 v[60:63],a[172:175],a[60:63],v[60:63]
v_add_f32 v18,v18,v57
v_cvt_pk_bf16_f32 v112,v56,v57
v_mfma_f32_16x16x32_bf16 v[196:199],a[200:203],v[80:83],v[196:199]
v_exp_f32 v58,v58
v_mfma_f32_16x16x32_bf16 v[196:199],a[204:207],v[84:87],v[196:199]
v_exp_f32 v59,v59
v_mfma_f32_16x16x32_bf16 v[228:231],a[200:203],v[88:91],v[228:231]
ds_read_b128 a[220:223],v4 offset:13312
v_add_f32 v18,v18,v58
v_mfma_f32_16x16x32_bf16 v[228:231],a[204:207],v[92:95],v[228:231]
s_waitcnt lgkmcnt(7)
v_add_f32 v18,v18,v59
v_cvt_pk_bf16_f32 v113,v58,v59
v_mfma_f32_16x16x32_bf16 v[48:51],a[176:179],a[0:3],v[24:27]
s_waitcnt lgkmcnt(5)
v_exp_f32 v60,v60
v_mfma_f32_16x16x32_bf16 v[48:51],a[180:183],a[4:7],v[48:51]
s_waitcnt lgkmcnt(1)
v_exp_f32 v61,v61
v_mfma_f32_16x16x32_bf16 v[48:51],a[184:187],a[8:11],v[48:51]
ds_read_b128 a[160:163],v2 offset:40960
v_add_f32 v19,v19,v60
v_mfma_f32_16x16x32_bf16 v[48:51],a[188:191],a[12:15],v[48:51]
v_add_f32 v19,v19,v61
v_cvt_pk_bf16_f32 v120,v60,v61
v_mfma_f32_16x16x32_bf16 v[136:139],a[208:211],v[64:67],v[136:139]
v_exp_f32 v62,v62
v_mfma_f32_16x16x32_bf16 v[136:139],a[212:215],v[68:71],v[136:139]
v_exp_f32 v63,v63
v_mfma_f32_16x16x32_bf16 v[168:171],a[208:211],v[72:75],v[168:171]
ds_read_b128 a[192:195],v4 offset:2048
v_add_f32 v19,v19,v62
v_mfma_f32_16x16x32_bf16 v[168:171],a[212:215],v[76:79],v[168:171]
v_add_f32 v19,v19,v63
v_cvt_pk_bf16_f32 v121,v62,v63
v_mfma_f32_16x16x32_bf16 v[52:55],a[176:179],a[16:19],v[28:31]
v_exp_f32 v48,v48
v_mfma_f32_16x16x32_bf16 v[52:55],a[180:183],a[20:23],v[52:55]
v_exp_f32 v49,v49
v_mfma_f32_16x16x32_bf16 v[52:55],a[184:187],a[24:27],v[52:55]
ds_read_b128 a[164:167],v2 offset:41984
v_add_f32 v16,v16,v48
v_mfma_f32_16x16x32_bf16 v[52:55],a[188:191],a[28:31],v[52:55]
v_add_f32 v16,v16,v49
v_cvt_pk_bf16_f32 v98,v48,v49
v_mfma_f32_16x16x32_bf16 v[200:203],a[208:211],v[80:83],v[200:203]
v_exp_f32 v50,v50
v_mfma_f32_16x16x32_bf16 v[200:203],a[212:215],v[84:87],v[200:203]
v_exp_f32 v51,v51
v_mfma_f32_16x16x32_bf16 v[232:235],a[208:211],v[88:91],v[232:235]
ds_read_b128 a[196:199],v4 offset:6144
v_add_f32 v16,v16,v50
v_mfma_f32_16x16x32_bf16 v[232:235],a[212:215],v[92:95],v[232:235]
v_add_f32 v16,v16,v51
v_cvt_pk_bf16_f32 v99,v50,v51
v_mfma_f32_16x16x32_bf16 v[56:59],a[176:179],a[32:35],v[32:35]
v_exp_f32 v52,v52
v_mfma_f32_16x16x32_bf16 v[56:59],a[180:183],a[36:39],v[56:59]
v_exp_f32 v53,v53
v_mfma_f32_16x16x32_bf16 v[56:59],a[184:187],a[40:43],v[56:59]
ds_read_b128 a[168:171],v2 offset:43008
v_add_f32 v17,v17,v52
v_mfma_f32_16x16x32_bf16 v[56:59],a[188:191],a[44:47],v[56:59]
v_add_f32 v17,v17,v53
v_cvt_pk_bf16_f32 v106,v52,v53
v_mfma_f32_16x16x32_bf16 v[140:143],a[216:219],v[64:67],v[140:143]
s_waitcnt lgkmcnt(5)
v_exp_f32 v54,v54
v_mfma_f32_16x16x32_bf16 v[140:143],a[220:223],v[68:71],v[140:143]
v_exp_f32 v55,v55
v_mfma_f32_16x16x32_bf16 v[172:175],a[216:219],v[72:75],v[172:175]
ds_read_b128 a[200:203],v4 offset:10240
v_add_f32 v17,v17,v54
v_mfma_f32_16x16x32_bf16 v[172:175],a[220:223],v[76:79],v[172:175]
v_add_f32 v17,v17,v55
v_cvt_pk_bf16_f32 v107,v54,v55
v_mfma_f32_16x16x32_bf16 v[60:63],a[176:179],a[48:51],v[36:39]
s_cmp_eq_u32 s8,0
v_exp_f32 v56,v56
v_mfma_f32_16x16x32_bf16 v[60:63],a[180:183],a[52:55],v[60:63]
s_cbranch_scc1 F_H2L1_O
F_H2L1_B:
v_exp_f32 v57,v57
v_mfma_f32_16x16x32_bf16 v[60:63],a[184:187],a[56:59],v[60:63]
ds_read_b128 a[172:175],v2 offset:44032
v_add_f32 v18,v18,v56
v_mfma_f32_16x16x32_bf16 v[60:63],a[188:191],a[60:63],v[60:63]
v_add_f32 v18,v18,v57
v_cvt_pk_bf16_f32 v114,v56,v57
v_mfma_f32_16x16x32_bf16 v[204:207],a[216:219],v[80:83],v[204:207]
v_exp_f32 v58,v58
v_mfma_f32_16x16x32_bf16 v[204:207],a[220:223],v[84:87],v[204:207]
v_exp_f32 v59,v59
v_mfma_f32_16x16x32_bf16 v[236:239],a[216:219],v[88:91],v[236:239]
ds_read_b128 a[204:207],v4 offset:14336
v_add_f32 v18,v18,v58
v_mfma_f32_16x16x32_bf16 v[236:239],a[220:223],v[92:95],v[236:239]
s_waitcnt lgkmcnt(7)
v_add_f32 v18,v18,v59
v_cvt_pk_bf16_f32 v115,v58,v59
v_mfma_f32_16x16x32_bf16 v[48:51],a[160:163],a[0:3],v[24:27]
s_waitcnt lgkmcnt(5)
v_exp_f32 v60,v60
v_mfma_f32_16x16x32_bf16 v[48:51],a[164:167],a[4:7],v[48:51]
s_waitcnt lgkmcnt(1)
v_exp_f32 v61,v61
v_mfma_f32_16x16x32_bf16 v[48:51],a[168:171],a[8:11],v[48:51]
ds_read_b128 a[176:179],v2 offset:45056
v_add_f32 v19,v19,v60
v_mfma_f32_16x16x32_bf16 v[48:51],a[172:175],a[12:15],v[48:51]
v_add_f32 v19,v19,v61
v_cvt_pk_bf16_f32 v122,v60,v61
v_mfma_f32_16x16x32_bf16 v[144:147],a[192:195],v[64:67],v[144:147]
v_exp_f32 v62,v62
v_mfma_f32_16x16x32_bf16 v[144:147],a[196:199],v[68:71],v[144:147]
v_exp_f32 v63,v63
v_mfma_f32_16x16x32_bf16 v[176:179],a[192:195],v[72:75],v[176:179]
ds_read_b128 a[208:211],v4 offset:3072
v_add_f32 v19,v19,v62
v_mfma_f32_16x16x32_bf16 v[176:179],a[196:199],v[76:79],v[176:179]
v_add_f32 v19,v19,v63
v_cvt_pk_bf16_f32 v123,v62,v63
v_mfma_f32_16x16x32_bf16 v[52:55],a[160:163],a[16:19],v[28:31]
v_exp_f32 v48,v48
v_mfma_f32_16x16x32_bf16 v[52:55],a[164:167],a[20:23],v[52:55]
v_exp_f32 v49,v49
v_mfma_f32_16x16x32_bf16 v[52:55],a[168:171],a[24:27],v[52:55]
ds_read_b128 a[180:183],v2 offset:46080
v_add_f32 v16,v16,v48
v_mfma_f32_16x16x32_bf16 v[52:55],a[172:175],a[28:31],v[52:55]
v_add_f32 v16,v16,v49
v_cvt_pk_bf16_f32 v100,v48,v49
v_mfma_f32_16x16x32_bf16 v[208:211],a[192:195],v[80:83],v[208:211]
v_exp_f32 v50,v50
v_mfma_f32_16x16x32_bf16 v[208:211],a[196:199],v[84:87],v[208:211]
v_exp_f32 v51,v51
v_mfma_f32_16x16x32_bf16 v[240:243],a[192:195],v[88:91],v[240:243]
ds_read_b128 a[212:215],v4 offset:7168
v_add_f32 v16,v16,v50
v_mfma_f32_16x16x32_bf16 v[240:243],a[196:199],v[92:95],v[240:243]
v_add_f32 v16,v16,v51
v_cvt_pk_bf16_f32 v101,v50,v51
v_mfma_f32_16x16x32_bf16 v[56:59],a[160:163],a[32:35],v[32:35]
v_exp_f32 v52,v52
v_mfma_f32_16x16x32_bf16 v[56:59],a[164:167],a[36:39],v[56:59]
v_exp_f32 v53,v53
v_mfma_f32_16x16x32_bf16 v[56:59],a[168:171],a[40:43],v[56:59]
ds_read_b128 a[184:187],v2 offset:47104
v_add_f32 v17,v17,v52
v_mfma_f32_16x16x32_bf16 v[56:59],a[172:175],a[44:47],v[56:59]
v_add_f32 v17,v17,v53
v_cvt_pk_bf16_f32 v108,v52,v53
v_mfma_f32_16x16x32_bf16 v[148:151],a[200:203],v[64:67],v[148:151]
s_waitcnt lgkmcnt(5)
v_exp_f32 v54,v54
v_mfma_f32_16x16x32_bf16 v[148:151],a[204:207],v[68:71],v[148:151]
v_exp_f32 v55,v55
v_mfma_f32_16x16x32_bf16 v[180:183],a[200:203],v[72:75],v[180:183]
ds_read_b128 a[216:219],v4 offset:11264
v_add_f32 v17,v17,v54
v_mfma_f32_16x16x32_bf16 v[180:183],a[204:207],v[76:79],v[180:183]
v_add_f32 v17,v17,v55
v_cvt_pk_bf16_f32 v109,v54,v55
v_mfma_f32_16x16x32_bf16 v[60:63],a[160:163],a[48:51],v[36:39]
v_exp_f32 v56,v56
v_mfma_f32_16x16x32_bf16 v[60:63],a[164:167],a[52:55],v[60:63]
v_exp_f32 v57,v57
v_mfma_f32_16x16x32_bf16 v[60:63],a[168:171],a[56:59],v[60:63]
ds_read_b128 a[188:191],v2 offset:48128
v_add_f32 v18,v18,v56
v_mfma_f32_16x16x32_bf16 v[60:63],a[172:175],a[60:63],v[60:63]
v_add_f32 v18,v18,v57
v_cvt_pk_bf16_f32 v116,v56,v57
v_mfma_f32_16x16x32_bf16 v[212:215],a[200:203],v[80:83],v[212:215]
v_exp_f32 v58,v58
v_mfma_f32_16x16x32_bf16 v[212:215],a[204:207],v[84:87],v[212:215]
v_exp_f32 v59,v59
v_mfma_f32_16x16x32_bf16 v[244:247],a[200:203],v[88:91],v[244:247]
ds_read_b128 a[220:223],v4 offset:15360
v_add_f32 v18,v18,v58
v_mfma_f32_16x16x32_bf16 v[244:247],a[204:207],v[92:95],v[244:247]
s_waitcnt lgkmcnt(7)
v_add_f32 v18,v18,v59
v_cvt_pk_bf16_f32 v117,v58,v59
v_mfma_f32_16x16x32_bf16 v[48:51],a[176:179],a[0:3],v[24:27]
s_waitcnt lgkmcnt(5)
v_exp_f32 v60,v60
v_mfma_f32_16x16x32_bf16 v[48:51],a[180:183],a[4:7],v[48:51]
s_waitcnt lgkmcnt(3)
v_exp_f32 v61,v61
v_mfma_f32_16x16x32_bf16 v[48:51],a[184:187],a[8:11],v[48:51]
s_waitcnt lgkmcnt(1)
v_add_f32 v19,v19,v60
v_add_f32 v19,v19,v61
v_mfma_f32_16x16x32_bf16 v[48:51],a[188:191],a[12:15],v[48:51]
s_cmp_eq_u32 s8,0
v_exp_f32 v62,v62
v_mfma_f32_16x16x32_bf16 v[152:155],a[208:211],v[64:67],v[152:155]
s_waitcnt vmcnt(0) lgkmcnt(0)
v_exp_f32 v63,v63
v_mfma_f32_16x16x32_bf16 v[152:155],a[212:215],v[68:71],v[152:155]
s_barrier
s_cbranch_scc1 F_H3L1_O
F_H3L1_B:
v_cvt_pk_bf16_f32 v124,v60,v61
v_add_f32 v19,v19,v62
v_mfma_f32_16x16x32_bf16 v[184:187],a[208:211],v[72:75],v[184:187]
ds_read_b128 a[160:163],v2 offset:0
v_add_f32 v19,v19,v63
v_mfma_f32_16x16x32_bf16 v[184:187],a[212:215],v[76:79],v[184:187]
ds_read_b128 a[192:195],v4 offset:32768
v_cvt_pk_bf16_f32 v125,v62,v63
v_mfma_f32_16x16x32_bf16 v[52:55],a[176:179],a[16:19],v[28:31]
s_add_u32 m0,s23,32768
v_exp_f32 v48,v48
v_mfma_f32_16x16x32_bf16 v[52:55],a[180:183],a[20:23],v[52:55]
s_add_u32 s24,s24,16384
v_exp_f32 v49,v49
v_mfma_f32_16x16x32_bf16 v[52:55],a[184:187],a[24:27],v[52:55]
ds_read_b128 a[164:167],v2 offset:1024
v_add_f32 v16,v16,v48
v_mfma_f32_16x16x32_bf16 v[52:55],a[188:191],a[28:31],v[52:55]
buffer_load_dwordx4 v1,s[16:19],s24 offen offset:0 sc1 lds
v_add_f32 v16,v16,v49
v_cvt_pk_bf16_f32 v102,v48,v49
v_mfma_f32_16x16x32_bf16 v[216:219],a[208:211],v[80:83],v[216:219]
v_exp_f32 v50,v50
v_mfma_f32_16x16x32_bf16 v[216:219],a[212:215],v[84:87],v[216:219]
v_exp_f32 v51,v51
v_mfma_f32_16x16x32_bf16 v[248:251],a[208:211],v[88:91],v[248:251]
ds_read_b128 a[196:199],v4 offset:36864
v_add_f32 v16,v16,v50
v_mfma_f32_16x16x32_bf16 v[248:251],a[212:215],v[92:95],v[248:251]
buffer_load_dwordx4 v1,s[16:19],s24 offen offset:1024 sc1 lds
v_add_f32 v16,v16,v51
v_cvt_pk_bf16_f32 v103,v50,v51
v_mfma_f32_16x16x32_bf16 v[56:59],a[176:179],a[32:35],v[32:35]
v_exp_f32 v52,v52
v_mfma_f32_16x16x32_bf16 v[56:59],a[180:183],a[36:39],v[56:59]
v_exp_f32 v53,v53
v_mfma_f32_16x16x32_bf16 v[56:59],a[184:187],a[40:43],v[56:59]
ds_read_b128 a[168:171],v2 offset:2048
v_add_f32 v17,v17,v52
v_mfma_f32_16x16x32_bf16 v[56:59],a[188:191],a[44:47],v[56:59]
buffer_load_dwordx4 v1,s[16:19],s24 offen offset:2048 sc1 lds
v_add_f32 v17,v17,v53
v_cvt_pk_bf16_f32 v110,v52,v53
v_mfma_f32_16x16x32_bf16 v[156:159],a[216:219],v[64:67],v[156:159]
v_exp_f32 v54,v54
v_mfma_f32_16x16x32_bf16 v[156:159],a[220:223],v[68:71],v[156:159]
v_exp_f32 v55,v55
v_mfma_f32_16x16x32_bf16 v[188:191],a[216:219],v[72:75],v[188:191]
ds_read_b128 a[200:203],v4 offset:40960
v_add_f32 v17,v17,v54
v_mfma_f32_16x16x32_bf16 v[188:191],a[220:223],v[76:79],v[188:191]
buffer_load_dwordx4 v1,s[16:19],s24 offen offset:3072 sc1 lds
v_add_f32 v17,v17,v55
v_cvt_pk_bf16_f32 v111,v54,v55
v_mfma_f32_16x16x32_bf16 v[60:63],a[176:179],a[48:51],v[36:39]
s_add_u32 m0,s23,65536
v_exp_f32 v56,v56
v_mfma_f32_16x16x32_bf16 v[60:63],a[180:183],a[52:55],v[60:63]
s_sub_u32 s26,s26,1
v_exp_f32 v57,v57
v_mfma_f32_16x16x32_bf16 v[60:63],a[184:187],a[56:59],v[60:63]
s_add_u32 s25,s25,16384
ds_read_b128 a[172:175],v2 offset:3072
v_add_f32 v18,v18,v56
v_mfma_f32_16x16x32_bf16 v[60:63],a[188:191],a[60:63],v[60:63]
buffer_load_dwordx4 v1,s[16:19],s25 offen offset:0 sc1 lds
v_add_f32 v18,v18,v57
v_cvt_pk_bf16_f32 v118,v56,v57
v_mfma_f32_16x16x32_bf16 v[220:223],a[216:219],v[80:83],v[220:223]
s_cmp_lg_u32 s26,0
v_exp_f32 v58,v58
v_mfma_f32_16x16x32_bf16 v[220:223],a[220:223],v[84:87],v[220:223]
v_exp_f32 v59,v59
v_mfma_f32_16x16x32_bf16 v[252:255],a[216:219],v[88:91],v[252:255]
ds_read_b128 a[204:207],v4 offset:45056
v_add_f32 v18,v18,v58
v_mfma_f32_16x16x32_bf16 v[252:255],a[220:223],v[92:95],v[252:255]
buffer_load_dwordx4 v1,s[16:19],s25 offen offset:1024 sc1 lds
v_add_f32 v18,v18,v59
v_cvt_pk_bf16_f32 v119,v58,v59
s_cbranch_scc1 K2_L1
s_cmp_eq_u32 s22,7
s_cbranch_scc1 K2_MID7
K2_MID:
s_waitcnt lgkmcnt(7)
v_mfma_f32_16x16x32_bf16 v[48:51],a[160:163],a[0:3],v[24:27]
s_waitcnt lgkmcnt(5)
v_exp_f32 v60,v60
v_mfma_f32_16x16x32_bf16 v[48:51],a[164:167],a[4:7],v[48:51]
s_waitcnt lgkmcnt(1)
v_exp_f32 v61,v61
v_mfma_f32_16x16x32_bf16 v[48:51],a[168:171],a[8:11],v[48:51]
ds_read_b128 a[176:179],v2 offset:4096
v_add_f32 v19,v19,v60
v_mfma_f32_16x16x32_bf16 v[48:51],a[172:175],a[12:15],v[48:51]
buffer_load_dwordx4 v1,s[16:19],s25 offen offset:2048 sc1 lds
v_add_f32 v19,v19,v61
v_cvt_pk_bf16_f32 v126,v60,v61
v_mfma_f32_16x16x32_bf16 v[128:131],a[192:195],v[96:99],v[128:131]
v_exp_f32 v62,v62
v_mfma_f32_16x16x32_bf16 v[128:131],a[196:199],v[100:103],v[128:131]
v_exp_f32 v63,v63
v_mfma_f32_16x16x32_bf16 v[160:163],a[192:195],v[104:107],v[160:163]
ds_read_b128 a[208:211],v4 offset:33792
v_add_f32 v19,v19,v62
v_mfma_f32_16x16x32_bf16 v[160:163],a[196:199],v[108:111],v[160:163]
buffer_load_dwordx4 v1,s[16:19],s25 offen offset:3072 sc1 lds
v_add_f32 v19,v19,v63
v_cvt_pk_bf16_f32 v127,v62,v63
v_mfma_f32_16x16x32_bf16 v[52:55],a[160:163],a[16:19],v[28:31]
v_cndmask_b32 v56,v6,v32,s[32:33]
v_cndmask_b32 v57,v6,v32,s[34:35]
v_cndmask_b32 v58,v6,v32,s[36:37]
v_cndmask_b32 v59,v6,v32,s[38:39]
v_exp_f32 v48,v48
v_mfma_f32_16x16x32_bf16 v[52:55],a[164:167],a[20:23],v[52:55]
v_exp_f32 v49,v49
v_mfma_f32_16x16x32_bf16 v[52:55],a[168:171],a[24:27],v[52:55]
ds_read_b128 a[180:183],v2 offset:5120
v_add_f32 v16,v16,v48
v_mfma_f32_16x16x32_bf16 v[52:55],a[172:175],a[28:31],v[52:55]
global_load_dword a250,v22,s[94:95]
v_add_f32 v16,v16,v49
v_cvt_pk_bf16_f32 v64,v48,v49
v_mfma_f32_16x16x32_bf16 v[192:195],a[192:195],v[112:115],v[192:195]
v_exp_f32 v50,v50
v_mfma_f32_16x16x32_bf16 v[192:195],a[196:199],v[116:119],v[192:195]
v_exp_f32 v51,v51
v_mfma_f32_16x16x32_bf16 v[224:227],a[192:195],v[120:123],v[224:227]
ds_read_b128 a[212:215],v4 offset:37888
v_add_f32 v16,v16,v50
v_mfma_f32_16x16x32_bf16 v[224:227],a[196:199],v[124:127],v[224:227]
v_add_f32 v16,v16,v51
v_cvt_pk_bf16_f32 v65,v50,v51
v_mfma_f32_16x16x32_bf16 v[56:59],a[160:163],a[32:35],v[56:59]
v_exp_f32 v52,v52
v_mfma_f32_16x16x32_bf16 v[56:59],a[164:167],a[36:39],v[56:59]
v_exp_f32 v53,v53
v_mfma_f32_16x16x32_bf16 v[56:59],a[168:171],a[40:43],v[56:59]
ds_read_b128 a[184:187],v2 offset:6144
v_add_f32 v17,v17,v52
v_mfma_f32_16x16x32_bf16 v[56:59],a[172:175],a[44:47],v[56:59]
v_add_f32 v17,v17,v53
v_cvt_pk_bf16_f32 v72,v52,v53
v_mfma_f32_16x16x32_bf16 v[132:135],a[200:203],v[96:99],v[132:135]
s_waitcnt lgkmcnt(5)
v_exp_f32 v54,v54
v_mfma_f32_16x16x32_bf16 v[132:135],a[204:207],v[100:103],v[132:135]
v_exp_f32 v55,v55
v_mfma_f32_16x16x32_bf16 v[164:167],a[200:203],v[104:107],v[164:167]
ds_read_b128 a[216:219],v4 offset:41984
v_add_f32 v17,v17,v54
v_mfma_f32_16x16x32_bf16 v[164:167],a[204:207],v[108:111],v[164:167]
v_add_f32 v17,v17,v55
v_cvt_pk_bf16_f32 v73,v54,v55
v_mfma_f32_16x16x32_bf16 v[60:63],a[160:163],a[48:51],v[36:39]
v_exp_f32 v56,v56
v_mfma_f32_16x16x32_bf16 v[60:63],a[164:167],a[52:55],v[60:63]
v_exp_f32 v57,v57
v_mfma_f32_16x16x32_bf16 v[60:63],a[168:171],a[56:59],v[60:63]
ds_read_b128 a[188:191],v2 offset:7168
v_add_f32 v18,v18,v56
v_mfma_f32_16x16x32_bf16 v[60:63],a[172:175],a[60:63],v[60:63]
v_add_f32 v18,v18,v57
v_cvt_pk_bf16_f32 v80,v56,v57
v_mfma_f32_16x16x32_bf16 v[196:199],a[200:203],v[112:115],v[196:199]
v_exp_f32 v58,v58
v_mfma_f32_16x16x32_bf16 v[196:199],a[204:207],v[116:119],v[196:199]
v_exp_f32 v59,v59
v_mfma_f32_16x16x32_bf16 v[228:231],a[200:203],v[120:123],v[228:231]
ds_read_b128 a[220:223],v4 offset:46080
v_add_f32 v18,v18,v58
v_mfma_f32_16x16x32_bf16 v[228:231],a[204:207],v[124:127],v[228:231]
s_waitcnt lgkmcnt(7)
v_add_f32 v18,v18,v59
v_cvt_pk_bf16_f32 v81,v58,v59
v_mfma_f32_16x16x32_bf16 v[48:51],a[176:179],a[0:3],v[24:27]
s_waitcnt lgkmcnt(5)
v_exp_f32 v60,v60
v_mfma_f32_16x16x32_bf16 v[48:51],a[180:183],a[4:7],v[48:51]
s_waitcnt lgkmcnt(1)
v_exp_f32 v61,v61
v_mfma_f32_16x16x32_bf16 v[48:51],a[184:187],a[8:11],v[48:51]
ds_read_b128 a[160:163],v2 offset:8192
v_add_f32 v19,v19,v60
v_mfma_f32_16x16x32_bf16 v[48:51],a[188:191],a[12:15],v[48:51]
v_add_f32 v19,v19,v61
v_cvt_pk_bf16_f32 v88,v60,v61
v_mfma_f32_16x16x32_bf16 v[136:139],a[208:211],v[96:99],v[136:139]
v_exp_f32 v62,v62
v_mfma_f32_16x16x32_bf16 v[136:139],a[212:215],v[100:103],v[136:139]
v_exp_f32 v63,v63
v_mfma_f32_16x16x32_bf16 v[168:171],a[208:211],v[104:107],v[168:171]
ds_read_b128 a[192:195],v4 offset:34816
v_add_f32 v19,v19,v62
v_mfma_f32_16x16x32_bf16 v[168:171],a[212:215],v[108:111],v[168:171]
v_add_f32 v19,v19,v63
v_cvt_pk_bf16_f32 v89,v62,v63
v_mfma_f32_16x16x32_bf16 v[52:55],a[176:179],a[16:19],v[28:31]
v_cndmask_b32 v56,v6,v32,s[40:41]
v_cndmask_b32 v57,v6,v32,s[42:43]
v_cndmask_b32 v58,v6,v32,s[44:45]
v_cndmask_b32 v59,v6,v32,s[46:47]
v_exp_f32 v48,v48
v_mfma_f32_16x16x32_bf16 v[52:55],a[180:183],a[20:23],v[52:55]
v_exp_f32 v49,v49
v_mfma_f32_16x16x32_bf16 v[52:55],a[184:187],a[24:27],v[52:55]
ds_read_b128 a[164:167],v2 offset:9216
v_add_f32 v16,v16,v48
v_mfma_f32_16x16x32_bf16 v[52:55],a[188:191],a[28:31],v[52:55]
v_add_f32 v16,v16,v49
v_cvt_pk_bf16_f32 v66,v48,v49
v_mfma_f32_16x16x32_bf16 v[200:203],a[208:211],v[112:115],v[200:203]
v_exp_f32 v50,v50
v_mfma_f32_16x16x32_bf16 v[200:203],a[212:215],v[116:119],v[200:203]
v_exp_f32 v51,v51
v_mfma_f32_16x16x32_bf16 v[232:235],a[208:211],v[120:123],v[232:235]
ds_read_b128 a[196:199],v4 offset:38912
v_add_f32 v16,v16,v50
v_mfma_f32_16x16x32_bf16 v[232:235],a[212:215],v[124:127],v[232:235]
v_add_f32 v16,v16,v51
v_cvt_pk_bf16_f32 v67,v50,v51
v_mfma_f32_16x16x32_bf16 v[56:59],a[176:179],a[32:35],v[56:59]
v_exp_f32 v52,v52
v_mfma_f32_16x16x32_bf16 v[56:59],a[180:183],a[36:39],v[56:59]
v_exp_f32 v53,v53
v_mfma_f32_16x16x32_bf16 v[56:59],a[184:187],a[40:43],v[56:59]
ds_read_b128 a[168:171],v2 offset:10240
v_add_f32 v17,v17,v52
v_mfma_f32_16x16x32_bf16 v[56:59],a[188:191],a[44:47],v[56:59]
v_add_f32 v17,v17,v53
v_cvt_pk_bf16_f32 v74,v52,v53
v_mfma_f32_16x16x32_bf16 v[140:143],a[216:219],v[96:99],v[140:143]
s_waitcnt lgkmcnt(5)
v_exp_f32 v54,v54
v_mfma_f32_16x16x32_bf16 v[140:143],a[220:223],v[100:103],v[140:143]
v_exp_f32 v55,v55
v_mfma_f32_16x16x32_bf16 v[172:175],a[216:219],v[104:107],v[172:175]
ds_read_b128 a[200:203],v4 offset:43008
v_add_f32 v17,v17,v54
v_mfma_f32_16x16x32_bf16 v[172:175],a[220:223],v[108:111],v[172:175]
v_add_f32 v17,v17,v55
v_cvt_pk_bf16_f32 v75,v54,v55
v_mfma_f32_16x16x32_bf16 v[60:63],a[176:179],a[48:51],v[36:39]
v_exp_f32 v56,v56
v_mfma_f32_16x16x32_bf16 v[60:63],a[180:183],a[52:55],v[60:63]
v_exp_f32 v57,v57
v_mfma_f32_16x16x32_bf16 v[60:63],a[184:187],a[56:59],v[60:63]
ds_read_b128 a[172:175],v2 offset:11264
v_add_f32 v18,v18,v56
v_mfma_f32_16x16x32_bf16 v[60:63],a[188:191],a[60:63],v[60:63]
v_add_f32 v18,v18,v57
v_cvt_pk_bf16_f32 v82,v56,v57
v_mfma_f32_16x16x32_bf16 v[204:207],a[216:219],v[112:115],v[204:207]
v_exp_f32 v58,v58
v_mfma_f32_16x16x32_bf16 v[204:207],a[220:223],v[116:119],v[204:207]
v_exp_f32 v59,v59
v_mfma_f32_16x16x32_bf16 v[236:239],a[216:219],v[120:123],v[236:239]
ds_read_b128 a[204:207],v4 offset:47104
v_add_f32 v18,v18,v58
v_mfma_f32_16x16x32_bf16 v[236:239],a[220:223],v[124:127],v[236:239]
s_waitcnt lgkmcnt(7)
v_add_f32 v18,v18,v59
v_cvt_pk_bf16_f32 v83,v58,v59
v_mfma_f32_16x16x32_bf16 v[48:51],a[160:163],a[0:3],v[24:27]
s_waitcnt lgkmcnt(5)
v_exp_f32 v60,v60
v_mfma_f32_16x16x32_bf16 v[48:51],a[164:167],a[4:7],v[48:51]
s_waitcnt lgkmcnt(1)
v_exp_f32 v61,v61
v_mfma_f32_16x16x32_bf16 v[48:51],a[168:171],a[8:11],v[48:51]
ds_read_b128 a[176:179],v2 offset:12288
v_add_f32 v19,v19,v60
v_mfma_f32_16x16x32_bf16 v[48:51],a[172:175],a[12:15],v[48:51]
v_add_f32 v19,v19,v61
v_cvt_pk_bf16_f32 v90,v60,v61
v_mfma_f32_16x16x32_bf16 v[144:147],a[192:195],v[96:99],v[144:147]
v_exp_f32 v62,v62
v_mfma_f32_16x16x32_bf16 v[144:147],a[196:199],v[100:103],v[144:147]
v_exp_f32 v63,v63
v_mfma_f32_16x16x32_bf16 v[176:179],a[192:195],v[104:107],v[176:179]
ds_read_b128 a[208:211],v4 offset:35840
v_add_f32 v19,v19,v62
v_mfma_f32_16x16x32_bf16 v[176:179],a[196:199],v[108:111],v[176:179]
v_add_f32 v19,v19,v63
v_cvt_pk_bf16_f32 v91,v62,v63
v_mfma_f32_16x16x32_bf16 v[52:55],a[160:163],a[16:19],v[28:31]
v_cndmask_b32 v56,v6,v32,s[48:49]
v_cndmask_b32 v57,v6,v32,s[50:51]
v_cndmask_b32 v58,v6,v32,s[52:53]
v_cndmask_b32 v59,v6,v32,s[54:55]
v_exp_f32 v48,v48
v_mfma_f32_16x16x32_bf16 v[52:55],a[164:167],a[20:23],v[52:55]
v_exp_f32 v49,v49
v_mfma_f32_16x16x32_bf16 v[52:55],a[168:171],a[24:27],v[52:55]
ds_read_b128 a[180:183],v2 offset:13312
v_add_f32 v16,v16,v48
v_mfma_f32_16x16x32_bf16 v[52:55],a[172:175],a[28:31],v[52:55]
v_add_f32 v16,v16,v49
v_cvt_pk_bf16_f32 v68,v48,v49
v_mfma_f32_16x16x32_bf16 v[208:211],a[192:195],v[112:115],v[208:211]
v_exp_f32 v50,v50
v_mfma_f32_16x16x32_bf16 v[208:211],a[196:199],v[116:119],v[208:211]
v_exp_f32 v51,v51
v_mfma_f32_16x16x32_bf16 v[240:243],a[192:195],v[120:123],v[240:243]
ds_read_b128 a[212:215],v4 offset:39936
v_add_f32 v16,v16,v50
v_mfma_f32_16x16x32_bf16 v[240:243],a[196:199],v[124:127],v[240:243]
v_add_f32 v16,v16,v51
v_cvt_pk_bf16_f32 v69,v50,v51
v_mfma_f32_16x16x32_bf16 v[56:59],a[160:163],a[32:35],v[56:59]
v_exp_f32 v52,v52
v_mfma_f32_16x16x32_bf16 v[56:59],a[164:167],a[36:39],v[56:59]
v_exp_f32 v53,v53
v_mfma_f32_16x16x32_bf16 v[56:59],a[168:171],a[40:43],v[56:59]
ds_read_b128 a[184:187],v2 offset:14336
v_add_f32 v17,v17,v52
v_mfma_f32_16x16x32_bf16 v[56:59],a[172:175],a[44:47],v[56:59]
v_add_f32 v17,v17,v53
v_cvt_pk_bf16_f32 v76,v52,v53
v_mfma_f32_16x16x32_bf16 v[148:151],a[200:203],v[96:99],v[148:151]
s_waitcnt lgkmcnt(5)
v_exp_f32 v54,v54
v_mfma_f32_16x16x32_bf16 v[148:151],a[204:207],v[100:103],v[148:151]
v_exp_f32 v55,v55
v_mfma_f32_16x16x32_bf16 v[180:183],a[200:203],v[104:107],v[180:183]
ds_read_b128 a[216:219],v4 offset:44032
v_add_f32 v17,v17,v54
v_mfma_f32_16x16x32_bf16 v[180:183],a[204:207],v[108:111],v[180:183]
v_add_f32 v17,v17,v55
v_cvt_pk_bf16_f32 v77,v54,v55
v_mfma_f32_16x16x32_bf16 v[60:63],a[160:163],a[48:51],v[36:39]
v_exp_f32 v56,v56
v_mfma_f32_16x16x32_bf16 v[60:63],a[164:167],a[52:55],v[60:63]
v_exp_f32 v57,v57
v_mfma_f32_16x16x32_bf16 v[60:63],a[168:171],a[56:59],v[60:63]
ds_read_b128 a[188:191],v2 offset:15360
v_add_f32 v18,v18,v56
v_mfma_f32_16x16x32_bf16 v[60:63],a[172:175],a[60:63],v[60:63]
v_add_f32 v18,v18,v57
v_cvt_pk_bf16_f32 v84,v56,v57
v_mfma_f32_16x16x32_bf16 v[212:215],a[200:203],v[112:115],v[212:215]
v_exp_f32 v58,v58
v_mfma_f32_16x16x32_bf16 v[212:215],a[204:207],v[116:119],v[212:215]
v_exp_f32 v59,v59
v_mfma_f32_16x16x32_bf16 v[244:247],a[200:203],v[120:123],v[244:247]
ds_read_b128 a[220:223],v4 offset:48128
v_add_f32 v18,v18,v58
v_mfma_f32_16x16x32_bf16 v[244:247],a[204:207],v[124:127],v[244:247]
s_waitcnt lgkmcnt(7)
v_add_f32 v18,v18,v59
v_cvt_pk_bf16_f32 v85,v58,v59
v_mfma_f32_16x16x32_bf16 v[48:51],a[176:179],a[0:3],v[24:27]
s_waitcnt lgkmcnt(5)
v_exp_f32 v60,v60
v_mfma_f32_16x16x32_bf16 v[48:51],a[180:183],a[4:7],v[48:51]
s_waitcnt lgkmcnt(3)
v_exp_f32 v61,v61
v_mfma_f32_16x16x32_bf16 v[48:51],a[184:187],a[8:11],v[48:51]
s_waitcnt lgkmcnt(1)
v_add_f32 v19,v19,v60
v_add_f32 v19,v19,v61
v_mfma_f32_16x16x32_bf16 v[48:51],a[188:191],a[12:15],v[48:51]
v_exp_f32 v62,v62
v_mfma_f32_16x16x32_bf16 v[152:155],a[208:211],v[96:99],v[152:155]
s_waitcnt vmcnt(1) lgkmcnt(0)
v_exp_f32 v63,v63
v_mfma_f32_16x16x32_bf16 v[152:155],a[212:215],v[100:103],v[152:155]
s_barrier
buffer_store_dword v11,v10,s[16:19],s99 offen sc1
v_cvt_pk_bf16_f32 v92,v60,v61
v_add_f32 v19,v19,v62
v_mfma_f32_16x16x32_bf16 v[184:187],a[208:211],v[104:107],v[184:187]
ds_read_b128 a[160:163],v2 offset:32768
v_add_f32 v19,v19,v63
v_mfma_f32_16x16x32_bf16 v[184:187],a[212:215],v[108:111],v[184:187]
ds_read_b128 a[192:195],v4 offset:0
v_cvt_pk_bf16_f32 v93,v62,v63
v_mfma_f32_16x16x32_bf16 v[52:55],a[176:179],a[16:19],v[28:31]
s_add_u32 m0,s23,0
v_cndmask_b32 v56,v6,v32,s[56:57]
v_cndmask_b32 v57,v6,v32,s[58:59]
v_cndmask_b32 v58,v6,v32,s[60:61]
v_cndmask_b32 v59,v6,v32,s[62:63]
v_exp_f32 v48,v48
v_mfma_f32_16x16x32_bf16 v[52:55],a[180:183],a[20:23],v[52:55]
s_add_u32 s24,s24,16384
v_exp_f32 v49,v49
v_mfma_f32_16x16x32_bf16 v[52:55],a[184:187],a[24:27],v[52:55]
ds_read_b128 a[164:167],v2 offset:33792
v_add_f32 v16,v16,v48
v_mfma_f32_16x16x32_bf16 v[52:55],a[188:191],a[28:31],v[52:55]
buffer_load_dwordx4 v1,s[16:19],s24 offen offset:0 sc1 lds
v_add_f32 v16,v16,v49
v_cvt_pk_bf16_f32 v70,v48,v49
v_mfma_f32_16x16x32_bf16 v[216:219],a[208:211],v[112:115],v[216:219]
v_exp_f32 v50,v50
v_mfma_f32_16x16x32_bf16 v[216:219],a[212:215],v[116:119],v[216:219]
v_exp_f32 v51,v51
v_mfma_f32_16x16x32_bf16 v[248:251],a[208:211],v[120:123],v[248:251]
ds_read_b128 a[196:199],v4 offset:4096
v_add_f32 v16,v16,v50
v_mfma_f32_16x16x32_bf16 v[248:251],a[212:215],v[124:127],v[248:251]
buffer_load_dwordx4 v1,s[16:19],s24 offen offset:1024 sc1 lds
v_add_f32 v16,v16,v51
v_cvt_pk_bf16_f32 v71,v50,v51
v_mfma_f32_16x16x32_bf16 v[56:59],a[176:179],a[32:35],v[56:59]
v_exp_f32 v52,v52
v_mfma_f32_16x16x32_bf16 v[56:59],a[180:183],a[36:39],v[56:59]
v_exp_f32 v53,v53
v_mfma_f32_16x16x32_bf16 v[56:59],a[184:187],a[40:43],v[56:59]
ds_read_b128 a[168:171],v2 offset:34816
v_add_f32 v17,v17,v52
v_mfma_f32_16x16x32_bf16 v[56:59],a[188:191],a[44:47],v[56:59]
buffer_load_dwordx4 v1,s[16:19],s24 offen offset:2048 sc1 lds
v_add_f32 v17,v17,v53
v_cvt_pk_bf16_f32 v78,v52,v53
v_mfma_f32_16x16x32_bf16 v[156:159],a[216:219],v[96:99],v[156:159]
v_exp_f32 v54,v54
v_mfma_f32_16x16x32_bf16 v[156:159],a[220:223],v[100:103],v[156:159]
v_exp_f32 v55,v55
v_mfma_f32_16x16x32_bf16 v[188:191],a[216:219],v[104:107],v[188:191]
ds_read_b128 a[200:203],v4 offset:8192
v_add_f32 v17,v17,v54
v_mfma_f32_16x16x32_bf16 v[188:191],a[220:223],v[108:111],v[188:191]
buffer_load_dwordx4 v1,s[16:19],s24 offen offset:3072 sc1 lds
v_add_f32 v17,v17,v55
v_cvt_pk_bf16_f32 v79,v54,v55
v_mfma_f32_16x16x32_bf16 v[60:63],a[176:179],a[48:51],v[36:39]
s_add_u32 m0,s23,16384
v_exp_f32 v56,v56
v_mfma_f32_16x16x32_bf16 v[60:63],a[180:183],a[52:55],v[60:63]
s_add_u32 s24,s24,16384
v_exp_f32 v57,v57
v_mfma_f32_16x16x32_bf16 v[60:63],a[184:187],a[56:59],v[60:63]
ds_read_b128 a[172:175],v2 offset:35840
v_add_f32 v18,v18,v56
v_mfma_f32_16x16x32_bf16 v[60:63],a[188:191],a[60:63],v[60:63]
buffer_load_dwordx4 v1,s[16:19],s24 offen offset:0 sc1 lds
v_add_f32 v18,v18,v57
v_cvt_pk_bf16_f32 v86,v56,v57
v_mfma_f32_16x16x32_bf16 v[220:223],a[216:219],v[112:115],v[220:223]
v_exp_f32 v58,v58
v_mfma_f32_16x16x32_bf16 v[220:223],a[220:223],v[116:119],v[220:223]
s_waitcnt lgkmcnt(6)
v_exp_f32 v59,v59
v_mfma_f32_16x16x32_bf16 v[252:255],a[216:219],v[120:123],v[252:255]
ds_read_b128 a[204:207],v4 offset:12288
v_add_f32 v18,v18,v58
v_mfma_f32_16x16x32_bf16 v[252:255],a[220:223],v[124:127],v[252:255]
buffer_load_dwordx4 v1,s[16:19],s24 offen offset:1024 sc1 lds
v_add_f32 v18,v18,v59
v_cvt_pk_bf16_f32 v87,v58,v59
v_mfma_f32_16x16x32_bf16 v[48:51],a[160:163],a[0:3],v[24:27]
s_waitcnt lgkmcnt(3)
v_exp_f32 v60,v60
v_mfma_f32_16x16x32_bf16 v[48:51],a[164:167],a[4:7],v[48:51]
ds_read_b128 a[176:179],v2 offset:36864
v_exp_f32 v61,v61
v_mfma_f32_16x16x32_bf16 v[48:51],a[168:171],a[8:11],v[48:51]
s_waitcnt lgkmcnt(2)
v_add_f32 v19,v19,v60
v_mfma_f32_16x16x32_bf16 v[48:51],a[172:175],a[12:15],v[48:51]
buffer_load_dwordx4 v1,s[16:19],s24 offen offset:2048 sc1 lds
v_add_f32 v19,v19,v61
v_cvt_pk_bf16_f32 v94,v60,v61
v_mfma_f32_16x16x32_bf16 v[128:131],a[192:195],v[64:67],v[128:131]
v_exp_f32 v62,v62
v_mfma_f32_16x16x32_bf16 v[128:131],a[196:199],v[68:71],v[128:131]
ds_read_b128 a[208:211],v4 offset:1024
v_exp_f32 v63,v63
v_mfma_f32_16x16x32_bf16 v[160:163],a[192:195],v[72:75],v[160:163]
ds_read_b128 a[180:183],v2 offset:37888
v_add_f32 v19,v19,v62
v_mfma_f32_16x16x32_bf16 v[160:163],a[196:199],v[76:79],v[160:163]
buffer_load_dwordx4 v1,s[16:19],s24 offen offset:3072 sc1 lds
v_add_f32 v19,v19,v63
v_cvt_pk_bf16_f32 v95,v62,v63
v_mfma_f32_16x16x32_bf16 v[192:195],a[192:195],v[80:83],v[192:195]
s_add_u32 m0,s23,98304
v_cndmask_b32 v56,v6,v36,s[32:33]
v_cndmask_b32 v57,v6,v36,s[34:35]
v_cndmask_b32 v58,v6,v36,s[36:37]
v_cndmask_b32 v59,v6,v36,s[38:39]
v_exp_f32 v48,v48
v_mfma_f32_16x16x32_bf16 v[192:195],a[196:199],v[84:87],v[192:195]
s_add_u32 s25,s25,16384
v_exp_f32 v49,v49
v_mfma_f32_16x16x32_bf16 v[52:55],a[160:163],a[16:19],v[28:31]
ds_read_b128 a[212:215],v4 offset:5120
v_add_f32 v16,v16,v48
v_mfma_f32_16x16x32_bf16 v[52:55],a[164:167],a[20:23],v[52:55]
buffer_load_dwordx4 v1,s[16:19],s25 offen offset:0 sc1 lds
v_add_f32 v16,v16,v49
v_mfma_f32_16x16x32_bf16 v[52:55],a[168:171],a[24:27],v[52:55]
ds_read_b128 a[184:187],v2 offset:38912
v_cvt_pk_bf16_f32 v96,v48,v49
v_mfma_f32_16x16x32_bf16 v[52:55],a[172:175],a[28:31],v[52:55]
v_exp_f32 v50,v50
v_mfma_f32_16x16x32_bf16 v[224:227],a[192:195],v[88:91],v[224:227]
s_waitcnt lgkmcnt(5)
v_exp_f32 v51,v51
v_mfma_f32_16x16x32_bf16 v[224:227],a[196:199],v[92:95],v[224:227]
buffer_load_dwordx4 v1,s[16:19],s25 offen offset:1024 sc1 lds
v_mfma_f32_16x16x32_bf16 v[132:135],a[200:203],v[64:67],v[132:135]
ds_read_b128 a[216:219],v4 offset:9216
v_add_f32 v16,v16,v50
v_add_f32 v16,v16,v51
v_mfma_f32_16x16x32_bf16 v[132:135],a[204:207],v[68:71],v[132:135]
v_cvt_pk_bf16_f32 v97,v50,v51
v_mfma_f32_16x16x32_bf16 v[164:167],a[200:203],v[72:75],v[164:167]
v_exp_f32 v52,v52
v_mfma_f32_16x16x32_bf16 v[164:167],a[204:207],v[76:79],v[164:167]
ds_read_b128 a[188:191],v2 offset:39936
v_exp_f32 v53,v53
v_mfma_f32_16x16x32_bf16 v[56:59],a[160:163],a[48:51],v[56:59]
buffer_load_dwordx4 v1,s[16:19],s25 offen offset:2048 sc1 lds
v_mfma_f32_16x16x32_bf16 v[56:59],a[164:167],a[52:55],v[56:59]
v_add_f32 v17,v17,v52
v_add_f32 v17,v17,v53
v_mfma_f32_16x16x32_bf16 v[56:59],a[168:171],a[56:59],v[56:59]
v_cvt_pk_bf16_f32 v104,v52,v53
v_mfma_f32_16x16x32_bf16 v[56:59],a[172:175],a[60:63],v[56:59]
v_exp_f32 v54,v54
v_mfma_f32_16x16x32_bf16 v[196:199],a[200:203],v[80:83],v[196:199]
ds_read_b128 a[160:163],v2 offset:40960
buffer_load_dwordx4 v1,s[16:19],s25 offen offset:3072 sc1 lds
v_exp_f32 v55,v55
v_mfma_f32_16x16x32_bf16 v[196:199],a[204:207],v[84:87],v[196:199]
ds_read_b128 a[220:223],v4 offset:13312
v_add_f32 v17,v17,v54
v_mfma_f32_16x16x32_bf16 v[228:231],a[200:203],v[88:91],v[228:231]
v_add_f32 v17,v17,v55
v_cvt_pk_bf16_f32 v105,v54,v55
v_mfma_f32_16x16x32_bf16 v[228:231],a[204:207],v[92:95],v[228:231]
s_waitcnt lgkmcnt(8)
v_mfma_f32_16x16x32_bf16 v[60:63],a[176:179],a[0:3],v[24:27]
s_waitcnt lgkmcnt(6)
v_exp_f32 v56,v56
v_mfma_f32_16x16x32_bf16 v[60:63],a[180:183],a[4:7],v[60:63]
s_waitcnt lgkmcnt(2)
v_exp_f32 v57,v57
v_mfma_f32_16x16x32_bf16 v[60:63],a[184:187],a[8:11],v[60:63]
ds_read_b128 a[164:167],v2 offset:41984
v_add_f32 v19,v19,v56
v_mfma_f32_16x16x32_bf16 v[60:63],a[188:191],a[12:15],v[60:63]
v_add_f32 v19,v19,v57
v_cvt_pk_bf16_f32 v120,v56,v57
v_mfma_f32_16x16x32_bf16 v[136:139],a[208:211],v[64:67],v[136:139]
v_exp_f32 v58,v58
v_mfma_f32_16x16x32_bf16 v[136:139],a[212:215],v[68:71],v[136:139]
ds_read_b128 a[192:195],v4 offset:2048
v_exp_f32 v59,v59
v_mfma_f32_16x16x32_bf16 v[168:171],a[208:211],v[72:75],v[168:171]
v_add_f32 v19,v19,v58
v_add_f32 v19,v19,v59
v_mfma_f32_16x16x32_bf16 v[168:171],a[212:215],v[76:79],v[168:171]
v_cvt_pk_bf16_f32 v121,v58,v59
v_mfma_f32_16x16x32_bf16 v[200:203],a[208:211],v[80:83],v[200:203]
v_cndmask_b32 v52,v6,v36,s[40:41]
v_cndmask_b32 v53,v6,v36,s[42:43]
v_cndmask_b32 v54,v6,v36,s[44:45]
v_cndmask_b32 v55,v6,v36,s[46:47]
v_exp_f32 v60,v60
v_mfma_f32_16x16x32_bf16 v[200:203],a[212:215],v[84:87],v[200:203]
v_exp_f32 v61,v61
v_mfma_f32_16x16x32_bf16 v[48:51],a[176:179],a[16:19],v[28:31]
ds_read_b128 a[168:171],v2 offset:43008
v_add_f32 v16,v16,v60
v_mfma_f32_16x16x32_bf16 v[48:51],a[180:183],a[20:23],v[48:51]
ds_read_b128 a[196:199],v4 offset:6144
v_add_f32 v16,v16,v61
v_mfma_f32_16x16x32_bf16 v[48:51],a[184:187],a[24:27],v[48:51]
v_cvt_pk_bf16_f32 v98,v60,v61
v_mfma_f32_16x16x32_bf16 v[48:51],a[188:191],a[28:31],v[48:51]
v_exp_f32 v62,v62
v_mfma_f32_16x16x32_bf16 v[232:235],a[208:211],v[88:91],v[232:235]
v_exp_f32 v63,v63
v_mfma_f32_16x16x32_bf16 v[232:235],a[212:215],v[92:95],v[232:235]
s_waitcnt lgkmcnt(4)
v_add_f32 v16,v16,v62
v_add_f32 v16,v16,v63
v_mfma_f32_16x16x32_bf16 v[140:143],a[216:219],v[64:67],v[140:143]
ds_read_b128 a[200:203],v4 offset:10240
v_cvt_pk_bf16_f32 v99,v62,v63
v_mfma_f32_16x16x32_bf16 v[140:143],a[220:223],v[68:71],v[140:143]
ds_read_b128 a[172:175],v2 offset:44032
v_mfma_f32_16x16x32_bf16 v[172:175],a[216:219],v[72:75],v[172:175]
v_exp_f32 v48,v48
v_mfma_f32_16x16x32_bf16 v[172:175],a[220:223],v[76:79],v[172:175]
v_exp_f32 v49,v49
v_mfma_f32_16x16x32_bf16 v[52:55],a[176:179],a[48:51],v[52:55]
v_add_f32 v17,v17,v48
v_add_f32 v17,v17,v49
v_mfma_f32_16x16x32_bf16 v[52:55],a[180:183],a[52:55],v[52:55]
v_cvt_pk_bf16_f32 v106,v48,v49
v_mfma_f32_16x16x32_bf16 v[52:55],a[184:187],a[56:59],v[52:55]
v_exp_f32 v50,v50
v_mfma_f32_16x16x32_bf16 v[52:55],a[188:191],a[60:63],v[52:55]
ds_read_b128 a[176:179],v2 offset:45056
buffer_load_dword v9,v8,s[16:19],s3 offen sc1
v_mfma_f32_16x16x32_bf16 v[204:207],a[216:219],v[80:83],v[204:207]
v_exp_f32 v51,v51
v_mfma_f32_16x16x32_bf16 v[204:207],a[220:223],v[84:87],v[204:207]
ds_read_b128 a[204:207],v4 offset:14336
v_add_f32 v17,v17,v50
v_mfma_f32_16x16x32_bf16 v[236:239],a[216:219],v[88:91],v[236:239]
v_add_f32 v17,v17,v51
v_cvt_pk_bf16_f32 v107,v50,v51
v_mfma_f32_16x16x32_bf16 v[236:239],a[220:223],v[92:95],v[236:239]
v_mfma_f32_16x16x32_bf16 v[56:59],a[160:163],a[0:3],v[24:27]
s_waitcnt lgkmcnt(7)
v_exp_f32 v52,v52
v_mfma_f32_16x16x32_bf16 v[56:59],a[164:167],a[4:7],v[56:59]
s_waitcnt lgkmcnt(2)
v_exp_f32 v53,v53
v_mfma_f32_16x16x32_bf16 v[56:59],a[168:171],a[8:11],v[56:59]
ds_read_b128 a[180:183],v2 offset:46080
v_add_f32 v19,v19,v52
v_mfma_f32_16x16x32_bf16 v[56:59],a[172:175],a[12:15],v[56:59]
v_add_f32 v19,v19,v53
v_cvt_pk_bf16_f32 v122,v52,v53
v_mfma_f32_16x16x32_bf16 v[144:147],a[192:195],v[64:67],v[144:147]
v_exp_f32 v54,v54
v_mfma_f32_16x16x32_bf16 v[144:147],a[196:199],v[68:71],v[144:147]
ds_read_b128 a[208:211],v4 offset:3072
v_exp_f32 v55,v55
v_mfma_f32_16x16x32_bf16 v[176:179],a[192:195],v[72:75],v[176:179]
v_add_f32 v19,v19,v54
v_add_f32 v19,v19,v55
v_mfma_f32_16x16x32_bf16 v[176:179],a[196:199],v[76:79],v[176:179]
v_cvt_pk_bf16_f32 v123,v54,v55
v_mfma_f32_16x16x32_bf16 v[208:211],a[192:195],v[80:83],v[208:211]
v_cndmask_b32 v48,v6,v36,s[48:49]
v_cndmask_b32 v49,v6,v36,s[50:51]
v_cndmask_b32 v50,v6,v36,s[52:53]
v_cndmask_b32 v51,v6,v36,s[54:55]
v_exp_f32 v56,v56
v_mfma_f32_16x16x32_bf16 v[208:211],a[196:199],v[84:87],v[208:211]
v_exp_f32 v57,v57
v_mfma_f32_16x16x32_bf16 v[60:63],a[160:163],a[16:19],v[28:31]
ds_read_b128 a[184:187],v2 offset:47104
v_add_f32 v16,v16,v56
v_mfma_f32_16x16x32_bf16 v[60:63],a[164:167],a[20:23],v[60:63]
ds_read_b128 a[212:215],v4 offset:7168
v_add_f32 v16,v16,v57
v_mfma_f32_16x16x32_bf16 v[60:63],a[168:171],a[24:27],v[60:63]
v_cvt_pk_bf16_f32 v100,v56,v57
v_mfma_f32_16x16x32_bf16 v[60:63],a[172:175],a[28:31],v[60:63]
v_exp_f32 v58,v58
v_mfma_f32_16x16x32_bf16 v[240:243],a[192:195],v[88:91],v[240:243]
v_exp_f32 v59,v59
v_mfma_f32_16x16x32_bf16 v[240:243],a[196:199],v[92:95],v[240:243]
s_waitcnt lgkmcnt(4)
v_add_f32 v16,v16,v58
v_add_f32 v16,v16,v59
v_mfma_f32_16x16x32_bf16 v[148:151],a[200:203],v[64:67],v[148:151]
ds_read_b128 a[216:219],v4 offset:11264
v_cvt_pk_bf16_f32 v101,v58,v59
v_mfma_f32_16x16x32_bf16 v[148:151],a[204:207],v[68:71],v[148:151]
ds_read_b128 a[188:191],v2 offset:48128
v_mfma_f32_16x16x32_bf16 v[180:183],a[200:203],v[72:75],v[180:183]
v_exp_f32 v60,v60
v_mfma_f32_16x16x32_bf16 v[180:183],a[204:207],v[76:79],v[180:183]
v_exp_f32 v61,v61
v_mfma_f32_16x16x32_bf16 v[48:51],a[160:163],a[48:51],v[48:51]
v_add_f32 v17,v17,v60
v_add_f32 v17,v17,v61
v_mfma_f32_16x16x32_bf16 v[48:51],a[164:167],a[52:55],v[48:51]
v_cvt_pk_bf16_f32 v108,v60,v61
v_mfma_f32_16x16x32_bf16 v[48:51],a[168:171],a[56:59],v[48:51]
v_exp_f32 v62,v62
v_mfma_f32_16x16x32_bf16 v[48:51],a[172:175],a[60:63],v[48:51]
v_exp_f32 v63,v63
v_mfma_f32_16x16x32_bf16 v[212:215],a[200:203],v[80:83],v[212:215]
ds_read_b128 a[220:223],v4 offset:15360
v_add_f32 v17,v17,v62
v_mfma_f32_16x16x32_bf16 v[212:215],a[204:207],v[84:87],v[212:215]
v_add_f32 v17,v17,v63
v_cvt_pk_bf16_f32 v109,v62,v63
v_mfma_f32_16x16x32_bf16 v[244:247],a[200:203],v[88:91],v[244:247]
v_mfma_f32_16x16x32_bf16 v[244:247],a[204:207],v[92:95],v[244:247]
v_mfma_f32_16x16x32_bf16 v[52:55],a[176:179],a[0:3],v[24:27]
s_waitcnt lgkmcnt(6)
v_exp_f32 v48,v48
v_mfma_f32_16x16x32_bf16 v[52:55],a[180:183],a[4:7],v[52:55]
s_waitcnt lgkmcnt(4)
v_exp_f32 v49,v49
v_mfma_f32_16x16x32_bf16 v[52:55],a[184:187],a[8:11],v[52:55]
s_waitcnt lgkmcnt(1)
v_add_f32 v19,v19,v48
v_add_f32 v19,v19,v49
v_mfma_f32_16x16x32_bf16 v[52:55],a[188:191],a[12:15],v[52:55]
v_cvt_pk_bf16_f32 v124,v48,v49
v_mfma_f32_16x16x32_bf16 v[152:155],a[208:211],v[64:67],v[152:155]
v_exp_f32 v50,v50
v_mfma_f32_16x16x32_bf16 v[152:155],a[212:215],v[68:71],v[152:155]
v_exp_f32 v51,v51
v_mfma_f32_16x16x32_bf16 v[184:187],a[208:211],v[72:75],v[184:187]
v_add_f32 v19,v19,v50
v_add_f32 v19,v19,v51
v_mfma_f32_16x16x32_bf16 v[184:187],a[212:215],v[76:79],v[184:187]
s_waitcnt vmcnt(0) lgkmcnt(0)
v_cvt_pk_bf16_f32 v125,v50,v51
v_mfma_f32_16x16x32_bf16 v[216:219],a[208:211],v[80:83],v[216:219]
s_barrier
v_cmp_gt_u32 vcc,2,v9
s_nop 0
s_cbranch_vccnz F_P2MID_S
F_P2MID_R:
s_mov_b32 s8,1
v_cndmask_b32 v60,v6,v36,s[56:57]
v_cndmask_b32 v61,v6,v36,s[58:59]
v_cndmask_b32 v62,v6,v36,s[60:61]
v_cndmask_b32 v63,v6,v36,s[62:63]
v_exp_f32 v52,v52
v_mfma_f32_16x16x32_bf16 v[216:219],a[212:215],v[84:87],v[216:219]
s_add_u32 m0,s23,32768
v_exp_f32 v53,v53
v_mfma_f32_16x16x32_bf16 v[56:59],a[176:179],a[16:19],v[28:31]
ds_read_b128 a[160:163],v3 offset:0
v_add_f32 v16,v16,v52
v_mfma_f32_16x16x32_bf16 v[56:59],a[180:183],a[20:23],v[56:59]
s_add_u32 s24,s24,16384
v_add_f32 v16,v16,v53
v_cvt_pk_bf16_f32 v102,v52,v53
v_mfma_f32_16x16x32_bf16 v[56:59],a[184:187],a[24:27],v[56:59]
ds_read_b128 a[192:195],v4 offset:32768
v_mfma_f32_16x16x32_bf16 v[56:59],a[188:191],a[28:31],v[56:59]
buffer_load_dwordx4 v1,s[16:19],s24 offen offset:0 sc1 lds
v_exp_f32 v54,v54
v_mfma_f32_16x16x32_bf16 v[248:251],a[208:211],v[88:91],v[248:251]
ds_read_b128 a[164:167],v3 offset:1024
v_exp_f32 v55,v55
v_mfma_f32_16x16x32_bf16 v[248:251],a[212:215],v[92:95],v[248:251]
buffer_load_dwordx4 v1,s[16:19],s24 offen offset:1024 sc1 lds
v_mfma_f32_16x16x32_bf16 v[156:159],a[216:219],v[64:67],v[156:159]
ds_read_b128 a[196:199],v4 offset:36864
v_add_f32 v16,v16,v54
v_add_f32 v16,v16,v55
v_mfma_f32_16x16x32_bf16 v[156:159],a[220:223],v[68:71],v[156:159]
buffer_load_dwordx4 v1,s[16:19],s24 offen offset:2048 sc1 lds
v_cvt_pk_bf16_f32 v103,v54,v55
v_mfma_f32_16x16x32_bf16 v[188:191],a[216:219],v[72:75],v[188:191]
v_exp_f32 v56,v56
v_mfma_f32_16x16x32_bf16 v[188:191],a[220:223],v[76:79],v[188:191]
ds_read_b128 a[168:171],v3 offset:2048
v_exp_f32 v57,v57
v_mfma_f32_16x16x32_bf16 v[60:63],a[176:179],a[48:51],v[60:63]
buffer_load_dwordx4 v1,s[16:19],s24 offen offset:3072 sc1 lds
v_mfma_f32_16x16x32_bf16 v[60:63],a[180:183],a[52:55],v[60:63]
ds_read_b128 a[200:203],v4 offset:40960
s_add_u32 m0,s23,49152
v_add_f32 v17,v17,v56
v_add_f32 v17,v17,v57
v_mfma_f32_16x16x32_bf16 v[60:63],a[184:187],a[56:59],v[60:63]
ds_read_b128 a[172:175],v3 offset:3072
s_add_u32 s24,s24,16384
v_cvt_pk_bf16_f32 v110,v56,v57
v_mfma_f32_16x16x32_bf16 v[60:63],a[188:191],a[60:63],v[60:63]
buffer_load_dwordx4 v1,s[16:19],s24 offen offset:0 sc1 lds
v_exp_f32 v58,v58
v_mfma_f32_16x16x32_bf16 v[220:223],a[216:219],v[80:83],v[220:223]
v_exp_f32 v59,v59
v_mfma_f32_16x16x32_bf16 v[220:223],a[220:223],v[84:87],v[220:223]
ds_read_b128 a[204:207],v4 offset:45056
buffer_load_dwordx4 v1,s[16:19],s24 offen offset:1024 sc1 lds
v_mfma_f32_16x16x32_bf16 v[252:255],a[216:219],v[88:91],v[252:255]
v_add_f32 v17,v17,v58
v_add_f32 v17,v17,v59
v_mfma_f32_16x16x32_bf16 v[252:255],a[220:223],v[92:95],v[252:255]
s_waitcnt lgkmcnt(7)
v_cvt_pk_bf16_f32 v111,v58,v59
v_mfma_f32_16x16x32_bf16 v[48:51],a[160:163],a[0:3],v[24:27]
s_waitcnt lgkmcnt(3)
v_exp_f32 v60,v60
v_mfma_f32_16x16x32_bf16 v[48:51],a[164:167],a[4:7],v[48:51]
ds_read_b128 a[176:179],v3 offset:4096
v_exp_f32 v61,v61
v_mfma_f32_16x16x32_bf16 v[48:51],a[168:171],a[8:11],v[48:51]
s_waitcnt lgkmcnt(2)
v_add_f32 v19,v19,v60
v_add_f32 v19,v19,v61
v_mfma_f32_16x16x32_bf16 v[48:51],a[172:175],a[12:15],v[48:51]
buffer_load_dwordx4 v1,s[16:19],s24 offen offset:2048 sc1 lds
v_cvt_pk_bf16_f32 v126,v60,v61
v_mfma_f32_16x16x32_bf16 v[128:131],a[192:195],v[96:99],v[128:131]
v_exp_f32 v62,v62
v_mfma_f32_16x16x32_bf16 v[128:131],a[196:199],v[100:103],v[128:131]
ds_read_b128 a[208:211],v4 offset:33792
v_exp_f32 v63,v63
v_mfma_f32_16x16x32_bf16 v[160:163],a[192:195],v[104:107],v[160:163]
ds_read_b128 a[180:183],v3 offset:5120
v_add_f32 v19,v19,v62
v_mfma_f32_16x16x32_bf16 v[160:163],a[196:199],v[108:111],v[160:163]
buffer_load_dwordx4 v1,s[16:19],s24 offen offset:3072 sc1 lds
v_add_f32 v19,v19,v63
v_cvt_pk_bf16_f32 v127,v62,v63
v_mfma_f32_16x16x32_bf16 v[52:55],a[160:163],a[16:19],v[28:31]
s_add_u32 m0,s23,65536
v_exp_f32 v48,v48
v_mfma_f32_16x16x32_bf16 v[52:55],a[164:167],a[20:23],v[52:55]
s_add_u32 s25,s25,16384
v_exp_f32 v49,v49
v_mfma_f32_16x16x32_bf16 v[52:55],a[168:171],a[24:27],v[52:55]
v_add_f32 v16,v16,v48
v_add_f32 v16,v16,v49
v_mfma_f32_16x16x32_bf16 v[52:55],a[172:175],a[28:31],v[52:55]
ds_read_b128 a[212:215],v4 offset:37888
v_cvt_pk_bf16_f32 v64,v48,v49
v_mfma_f32_16x16x32_bf16 v[224:227],a[192:195],v[120:123],v[224:227]
buffer_load_dwordx4 v1,s[16:19],s25 offen offset:0 sc1 lds
v_exp_f32 v50,v50
v_mfma_f32_16x16x32_bf16 v[224:227],a[196:199],v[124:127],v[224:227]
ds_read_b128 a[184:187],v3 offset:6144
v_exp_f32 v51,v51
v_mfma_f32_16x16x32_bf16 v[56:59],a[160:163],a[64:67],v[40:43]
v_add_f32 v16,v16,v50
v_add_f32 v16,v16,v51
v_mfma_f32_16x16x32_bf16 v[56:59],a[164:167],a[68:71],v[56:59]
buffer_load_dwordx4 v1,s[16:19],s25 offen offset:1024 sc1 lds
v_cvt_pk_bf16_f32 v65,v50,v51
v_mfma_f32_16x16x32_bf16 v[56:59],a[168:171],a[72:75],v[56:59]
v_exp_f32 v52,v52
v_exp_f32 v53,v53
v_mfma_f32_16x16x32_bf16 v[56:59],a[172:175],a[76:79],v[56:59]
s_waitcnt lgkmcnt(5)
v_add_f32 v17,v17,v52
v_add_f32 v17,v17,v53
v_mfma_f32_16x16x32_bf16 v[132:135],a[200:203],v[96:99],v[132:135]
ds_read_b128 a[188:191],v3 offset:7168
v_cvt_pk_bf16_f32 v72,v52,v53
v_mfma_f32_16x16x32_bf16 v[132:135],a[204:207],v[100:103],v[132:135]
ds_read_b128 a[216:219],v4 offset:41984
v_exp_f32 v54,v54
v_exp_f32 v55,v55
v_mfma_f32_16x16x32_bf16 v[164:167],a[200:203],v[104:107],v[164:167]
buffer_load_dwordx4 v1,s[16:19],s25 offen offset:2048 sc1 lds
v_add_f32 v17,v17,v54
v_mfma_f32_16x16x32_bf16 v[164:167],a[204:207],v[108:111],v[164:167]
v_add_f32 v17,v17,v55
v_cvt_pk_bf16_f32 v73,v54,v55
v_mfma_f32_16x16x32_bf16 v[60:63],a[160:163],a[80:83],v[44:47]
v_exp_f32 v56,v56
v_mfma_f32_16x16x32_bf16 v[60:63],a[164:167],a[84:87],v[60:63]
v_exp_f32 v57,v57
v_mfma_f32_16x16x32_bf16 v[60:63],a[168:171],a[88:91],v[60:63]
buffer_load_dwordx4 v1,s[16:19],s25 offen offset:3072 sc1 lds
v_add_f32 v20,v20,v56
v_mfma_f32_16x16x32_bf16 v[60:63],a[172:175],a[92:95],v[60:63]
ds_read_b128 a[160:163],v3 offset:8192
s_add_u32 m0,s23,81920
v_add_f32 v20,v20,v57
v_cvt_pk_bf16_f32 v80,v56,v57
v_mfma_f32_16x16x32_bf16 v[228:231],a[200:203],v[120:123],v[228:231]
ds_read_b128 a[220:223],v4 offset:46080
s_add_u32 s25,s25,16384
v_exp_f32 v58,v58
v_mfma_f32_16x16x32_bf16 v[228:231],a[204:207],v[124:127],v[228:231]
s_waitcnt lgkmcnt(6)
v_exp_f32 v59,v59
v_mfma_f32_16x16x32_bf16 v[48:51],a[176:179],a[0:3],v[24:27]
buffer_load_dwordx4 v1,s[16:19],s25 offen offset:0 sc1 lds
v_add_f32 v20,v20,v58
v_mfma_f32_16x16x32_bf16 v[48:51],a[180:183],a[4:7],v[48:51]
s_waitcnt lgkmcnt(4)
v_add_f32 v20,v20,v59
v_cvt_pk_bf16_f32 v81,v58,v59
v_mfma_f32_16x16x32_bf16 v[48:51],a[184:187],a[8:11],v[48:51]
s_waitcnt lgkmcnt(3)
v_exp_f32 v60,v60
v_exp_f32 v61,v61
v_mfma_f32_16x16x32_bf16 v[48:51],a[188:191],a[12:15],v[48:51]
buffer_load_dwordx4 v1,s[16:19],s25 offen offset:1024 sc1 lds
v_add_f32 v21,v21,v60
v_mfma_f32_16x16x32_bf16 v[136:139],a[208:211],v[96:99],v[136:139]
ds_read_b128 a[164:167],v3 offset:9216
v_add_f32 v21,v21,v61
v_cvt_pk_bf16_f32 v88,v60,v61
v_mfma_f32_16x16x32_bf16 v[136:139],a[212:215],v[100:103],v[136:139]
ds_read_b128 a[192:195],v4 offset:34816
v_exp_f32 v62,v62
v_exp_f32 v63,v63
v_mfma_f32_16x16x32_bf16 v[168:171],a[208:211],v[104:107],v[168:171]
v_add_f32 v21,v21,v62
v_add_f32 v21,v21,v63
v_mfma_f32_16x16x32_bf16 v[168:171],a[212:215],v[108:111],v[168:171]
buffer_load_dwordx4 v1,s[16:19],s25 offen offset:2048 sc1 lds
v_cvt_pk_bf16_f32 v89,v62,v63
v_mfma_f32_16x16x32_bf16 v[52:55],a[176:179],a[16:19],v[28:31]
v_exp_f32 v48,v48
v_mfma_f32_16x16x32_bf16 v[52:55],a[180:183],a[20:23],v[52:55]
v_exp_f32 v49,v49
v_mfma_f32_16x16x32_bf16 v[52:55],a[184:187],a[24:27],v[52:55]
v_add_f32 v16,v16,v48
v_add_f32 v16,v16,v49
v_mfma_f32_16x16x32_bf16 v[52:55],a[188:191],a[28:31],v[52:55]
ds_read_b128 a[168:171],v3 offset:10240
v_cvt_pk_bf16_f32 v66,v48,v49
v_mfma_f32_16x16x32_bf16 v[232:235],a[208:211],v[120:123],v[232:235]
ds_read_b128 a[196:199],v4 offset:38912
buffer_load_dwordx4 v1,s[16:19],s25 offen offset:3072 sc1 lds
v_exp_f32 v50,v50
v_mfma_f32_16x16x32_bf16 v[232:235],a[212:215],v[124:127],v[232:235]
v_exp_f32 v51,v51
v_mfma_f32_16x16x32_bf16 v[56:59],a[176:179],a[64:67],v[40:43]
v_add_f32 v16,v16,v50
v_add_f32 v16,v16,v51
v_mfma_f32_16x16x32_bf16 v[56:59],a[180:183],a[68:71],v[56:59]
v_cvt_pk_bf16_f32 v67,v50,v51
v_mfma_f32_16x16x32_bf16 v[56:59],a[184:187],a[72:75],v[56:59]
v_exp_f32 v52,v52
v_exp_f32 v53,v53
v_mfma_f32_16x16x32_bf16 v[56:59],a[188:191],a[76:79],v[56:59]
s_waitcnt lgkmcnt(4)
v_add_f32 v17,v17,v52
v_add_f32 v17,v17,v53
v_mfma_f32_16x16x32_bf16 v[140:143],a[216:219],v[96:99],v[140:143]
ds_read_b128 a[172:175],v3 offset:11264
v_cvt_pk_bf16_f32 v74,v52,v53
v_mfma_f32_16x16x32_bf16 v[140:143],a[220:223],v[100:103],v[140:143]
ds_read_b128 a[200:203],v4 offset:43008
v_exp_f32 v54,v54
v_exp_f32 v55,v55
v_mfma_f32_16x16x32_bf16 v[172:175],a[216:219],v[104:107],v[172:175]
v_add_f32 v17,v17,v54
v_add_f32 v17,v17,v55
v_mfma_f32_16x16x32_bf16 v[172:175],a[220:223],v[108:111],v[172:175]
v_cvt_pk_bf16_f32 v75,v54,v55
v_mfma_f32_16x16x32_bf16 v[60:63],a[176:179],a[80:83],v[44:47]
v_exp_f32 v56,v56
v_mfma_f32_16x16x32_bf16 v[60:63],a[180:183],a[84:87],v[60:63]
v_exp_f32 v57,v57
v_mfma_f32_16x16x32_bf16 v[60:63],a[184:187],a[88:91],v[60:63]
v_add_f32 v20,v20,v56
v_add_f32 v20,v20,v57
v_mfma_f32_16x16x32_bf16 v[60:63],a[188:191],a[92:95],v[60:63]
ds_read_b128 a[176:179],v3 offset:12288
v_cvt_pk_bf16_f32 v82,v56,v57
v_mfma_f32_16x16x32_bf16 v[236:239],a[216:219],v[120:123],v[236:239]
ds_read_b128 a[204:207],v4 offset:47104
v_exp_f32 v58,v58
v_mfma_f32_16x16x32_bf16 v[236:239],a[220:223],v[124:127],v[236:239]
v_exp_f32 v59,v59
v_mfma_f32_16x16x32_bf16 v[48:51],a[160:163],a[0:3],v[24:27]
s_waitcnt lgkmcnt(7)
v_add_f32 v20,v20,v58
v_add_f32 v20,v20,v59
v_mfma_f32_16x16x32_bf16 v[48:51],a[164:167],a[4:7],v[48:51]
s_waitcnt lgkmcnt(5)
v_cvt_pk_bf16_f32 v83,v58,v59
v_mfma_f32_16x16x32_bf16 v[48:51],a[168:171],a[8:11],v[48:51]
s_waitcnt lgkmcnt(3)
v_exp_f32 v60,v60
v_exp_f32 v61,v61
v_mfma_f32_16x16x32_bf16 v[48:51],a[172:175],a[12:15],v[48:51]
v_add_f32 v21,v21,v60
v_add_f32 v21,v21,v61
v_mfma_f32_16x16x32_bf16 v[144:147],a[192:195],v[96:99],v[144:147]
ds_read_b128 a[180:183],v3 offset:13312
v_cvt_pk_bf16_f32 v90,v60,v61
v_mfma_f32_16x16x32_bf16 v[144:147],a[196:199],v[100:103],v[144:147]
ds_read_b128 a[208:211],v4 offset:35840
v_exp_f32 v62,v62
v_exp_f32 v63,v63
v_mfma_f32_16x16x32_bf16 v[176:179],a[192:195],v[104:107],v[176:179]
v_add_f32 v21,v21,v62
v_add_f32 v21,v21,v63
v_mfma_f32_16x16x32_bf16 v[176:179],a[196:199],v[108:111],v[176:179]
v_cvt_pk_bf16_f32 v91,v62,v63
v_mfma_f32_16x16x32_bf16 v[52:55],a[160:163],a[16:19],v[28:31]
v_exp_f32 v48,v48
v_mfma_f32_16x16x32_bf16 v[52:55],a[164:167],a[20:23],v[52:55]
v_exp_f32 v49,v49
v_mfma_f32_16x16x32_bf16 v[52:55],a[168:171],a[24:27],v[52:55]
v_add_f32 v16,v16,v48
v_add_f32 v16,v16,v49
v_mfma_f32_16x16x32_bf16 v[52:55],a[172:175],a[28:31],v[52:55]
ds_read_b128 a[184:187],v3 offset:14336
v_cvt_pk_bf16_f32 v68,v48,v49
v_mfma_f32_16x16x32_bf16 v[240:243],a[192:195],v[120:123],v[240:243]
ds_read_b128 a[212:215],v4 offset:39936
v_exp_f32 v50,v50
v_mfma_f32_16x16x32_bf16 v[240:243],a[196:199],v[124:127],v[240:243]
v_exp_f32 v51,v51
v_mfma_f32_16x16x32_bf16 v[56:59],a[160:163],a[64:67],v[40:43]
v_add_f32 v16,v16,v50
v_add_f32 v16,v16,v51
v_mfma_f32_16x16x32_bf16 v[56:59],a[164:167],a[68:71],v[56:59]
v_cvt_pk_bf16_f32 v69,v50,v51
v_mfma_f32_16x16x32_bf16 v[56:59],a[168:171],a[72:75],v[56:59]
v_exp_f32 v52,v52
v_exp_f32 v53,v53
v_mfma_f32_16x16x32_bf16 v[56:59],a[172:175],a[76:79],v[56:59]
s_waitcnt lgkmcnt(4)
v_add_f32 v17,v17,v52
v_add_f32 v17,v17,v53
v_mfma_f32_16x16x32_bf16 v[148:151],a[200:203],v[96:99],v[148:151]
ds_read_b128 a[188:191],v3 offset:15360
v_cvt_pk_bf16_f32 v76,v52,v53
v_mfma_f32_16x16x32_bf16 v[148:151],a[204:207],v[100:103],v[148:151]
ds_read_b128 a[216:219],v4 offset:44032
v_exp_f32 v54,v54
v_exp_f32 v55,v55
v_mfma_f32_16x16x32_bf16 v[180:183],a[200:203],v[104:107],v[180:183]
v_add_f32 v17,v17,v54
v_add_f32 v17,v17,v55
v_mfma_f32_16x16x32_bf16 v[180:183],a[204:207],v[108:111],v[180:183]
v_cvt_pk_bf16_f32 v77,v54,v55
v_mfma_f32_16x16x32_bf16 v[60:63],a[160:163],a[80:83],v[44:47]
v_exp_f32 v56,v56
v_mfma_f32_16x16x32_bf16 v[60:63],a[164:167],a[84:87],v[60:63]
v_exp_f32 v57,v57
v_mfma_f32_16x16x32_bf16 v[60:63],a[168:171],a[88:91],v[60:63]
v_add_f32 v20,v20,v56
v_add_f32 v20,v20,v57
v_mfma_f32_16x16x32_bf16 v[60:63],a[172:175],a[92:95],v[60:63]
ds_read_b128 a[220:223],v4 offset:48128
v_cvt_pk_bf16_f32 v84,v56,v57
v_mfma_f32_16x16x32_bf16 v[244:247],a[200:203],v[120:123],v[244:247]
v_exp_f32 v58,v58
v_mfma_f32_16x16x32_bf16 v[244:247],a[204:207],v[124:127],v[244:247]
v_exp_f32 v59,v59
v_mfma_f32_16x16x32_bf16 v[48:51],a[176:179],a[0:3],v[24:27]
s_waitcnt lgkmcnt(6)
v_add_f32 v20,v20,v58
v_add_f32 v20,v20,v59
v_mfma_f32_16x16x32_bf16 v[48:51],a[180:183],a[4:7],v[48:51]
s_waitcnt lgkmcnt(4)
v_cvt_pk_bf16_f32 v85,v58,v59
v_mfma_f32_16x16x32_bf16 v[48:51],a[184:187],a[8:11],v[48:51]
s_waitcnt lgkmcnt(2)
v_exp_f32 v60,v60
v_exp_f32 v61,v61
v_mfma_f32_16x16x32_bf16 v[48:51],a[188:191],a[12:15],v[48:51]
v_add_f32 v21,v21,v60
v_add_f32 v21,v21,v61
v_mfma_f32_16x16x32_bf16 v[152:155],a[208:211],v[96:99],v[152:155]
v_cvt_pk_bf16_f32 v92,v60,v61
v_mfma_f32_16x16x32_bf16 v[152:155],a[212:215],v[100:103],v[152:155]
v_exp_f32 v62,v62
v_exp_f32 v63,v63
v_mfma_f32_16x16x32_bf16 v[184:187],a[208:211],v[104:107],v[184:187]
v_add_f32 v21,v21,v62
v_add_f32 v21,v21,v63
v_mfma_f32_16x16x32_bf16 v[184:187],a[212:215],v[108:111],v[184:187]
s_waitcnt vmcnt(0) lgkmcnt(0)
v_cvt_pk_bf16_f32 v93,v62,v63
v_mfma_f32_16x16x32_bf16 v[52:55],a[176:179],a[16:19],v[28:31]
s_barrier
v_exp_f32 v48,v48
v_mfma_f32_16x16x32_bf16 v[52:55],a[180:183],a[20:23],v[52:55]
s_add_u32 m0,s23,0
v_exp_f32 v49,v49
v_mfma_f32_16x16x32_bf16 v[52:55],a[184:187],a[24:27],v[52:55]
ds_read_b128 a[160:163],v3 offset:32768
v_add_f32 v16,v16,v48
v_mfma_f32_16x16x32_bf16 v[52:55],a[188:191],a[28:31],v[52:55]
s_add_u32 s24,s24,16384
v_add_f32 v16,v16,v49
v_cvt_pk_bf16_f32 v70,v48,v49
v_mfma_f32_16x16x32_bf16 v[248:251],a[208:211],v[120:123],v[248:251]
ds_read_b128 a[192:195],v5 offset:0
v_exp_f32 v50,v50
v_mfma_f32_16x16x32_bf16 v[248:251],a[212:215],v[124:127],v[248:251]
buffer_load_dwordx4 v1,s[16:19],s24 offen offset:0 sc1 lds
v_exp_f32 v51,v51
v_mfma_f32_16x16x32_bf16 v[56:59],a[176:179],a[64:67],v[40:43]
ds_read_b128 a[164:167],v3 offset:33792
v_add_f32 v16,v16,v50
v_mfma_f32_16x16x32_bf16 v[56:59],a[180:183],a[68:71],v[56:59]
buffer_load_dwordx4 v1,s[16:19],s24 offen offset:1024 sc1 lds
v_add_f32 v16,v16,v51
v_cvt_pk_bf16_f32 v71,v50,v51
v_mfma_f32_16x16x32_bf16 v[56:59],a[184:187],a[72:75],v[56:59]
ds_read_b128 a[196:199],v5 offset:4096
v_exp_f32 v52,v52
v_exp_f32 v53,v53
v_mfma_f32_16x16x32_bf16 v[56:59],a[188:191],a[76:79],v[56:59]
buffer_load_dwordx4 v1,s[16:19],s24 offen offset:2048 sc1 lds
v_add_f32 v17,v17,v52
v_mfma_f32_16x16x32_bf16 v[156:159],a[216:219],v[96:99],v[156:159]
ds_read_b128 a[168:171],v3 offset:34816
v_add_f32 v17,v17,v53
v_cvt_pk_bf16_f32 v78,v52,v53
v_mfma_f32_16x16x32_bf16 v[156:159],a[220:223],v[100:103],v[156:159]
v_exp_f32 v54,v54
v_exp_f32 v55,v55
v_mfma_f32_16x16x32_bf16 v[188:191],a[216:219],v[104:107],v[188:191]
buffer_load_dwordx4 v1,s[16:19],s24 offen offset:3072 sc1 lds
v_add_f32 v17,v17,v54
v_mfma_f32_16x16x32_bf16 v[188:191],a[220:223],v[108:111],v[188:191]
ds_read_b128 a[200:203],v5 offset:8192
s_add_u32 m0,s23,16384
v_add_f32 v17,v17,v55
v_cvt_pk_bf16_f32 v79,v54,v55
v_mfma_f32_16x16x32_bf16 v[60:63],a[176:179],a[80:83],v[44:47]
s_add_u32 s24,s24,16384
v_exp_f32 v56,v56
v_exp_f32 v57,v57
v_mfma_f32_16x16x32_bf16 v[60:63],a[180:183],a[84:87],v[60:63]
ds_read_b128 a[172:175],v3 offset:35840
buffer_load_dwordx4 v1,s[16:19],s24 offen offset:0 sc1 lds
v_add_f32 v20,v20,v56
v_mfma_f32_16x16x32_bf16 v[60:63],a[184:187],a[88:91],v[60:63]
ds_read_b128 a[204:207],v5 offset:12288
v_add_f32 v20,v20,v57
v_cvt_pk_bf16_f32 v86,v56,v57
v_mfma_f32_16x16x32_bf16 v[60:63],a[188:191],a[92:95],v[60:63]
buffer_load_dwordx4 v1,s[16:19],s24 offen offset:1024 sc1 lds
v_exp_f32 v58,v58
v_exp_f32 v59,v59
v_mfma_f32_16x16x32_bf16 v[252:255],a[216:219],v[120:123],v[252:255]
v_add_f32 v20,v20,v58
v_add_f32 v20,v20,v59
v_mfma_f32_16x16x32_bf16 v[252:255],a[220:223],v[124:127],v[252:255]
v_cvt_pk_bf16_f32 v87,v58,v59
s_nop 7
v_mov_b32 v48,v18
v_mov_b32 v49,v19
s_nop 1
v_permlane32_swap_b32 v48,v18
v_permlane32_swap_b32 v49,v19
v_add_f32 v18,v18,v48
v_add_f32 v19,v19,v49
v_mov_b32 v48,v18
v_mov_b32 v49,v19
s_nop 1
v_permlane16_swap_b32 v48,v18
v_permlane16_swap_b32 v49,v19
v_add_f32 v18,v18,v48
v_add_f32 v19,v19,v49
v_rcp_f32 v48,v18
v_rcp_f32 v49,v19
v_add_f32 v50,v18,v19
v_cmp_nle_f32 vcc,v50,v15
v_mul_f32 v192,v48,v192
v_mul_f32 v193,v48,v193
v_mul_f32 v194,v48,v194
v_mul_f32 v195,v48,v195
v_mul_f32 v196,v48,v196
v_mul_f32 v197,v48,v197
v_mul_f32 v198,v48,v198
v_mul_f32 v199,v48,v199
v_cvt_pk_bf16_f32 v192,v192,v193
v_cvt_pk_bf16_f32 v193,v194,v195
v_cvt_pk_bf16_f32 v194,v196,v197
v_cvt_pk_bf16_f32 v195,v198,v199
buffer_store_dwordx4 v[192:195],v1,s[16:19],s88 offen offset:0 sc1
v_mul_f32 v200,v48,v200
v_mul_f32 v201,v48,v201
v_mul_f32 v202,v48,v202
v_mul_f32 v203,v48,v203
v_mul_f32 v204,v48,v204
v_mul_f32 v205,v48,v205
v_mul_f32 v206,v48,v206
v_mul_f32 v207,v48,v207
v_cvt_pk_bf16_f32 v200,v200,v201
v_cvt_pk_bf16_f32 v201,v202,v203
v_cvt_pk_bf16_f32 v202,v204,v205
v_cvt_pk_bf16_f32 v203,v206,v207
buffer_store_dwordx4 v[200:203],v1,s[16:19],s88 offen offset:1024 sc1
v_mul_f32 v208,v48,v208
v_mul_f32 v209,v48,v209
v_mul_f32 v210,v48,v210
v_mul_f32 v211,v48,v211
v_mul_f32 v212,v48,v212
v_mul_f32 v213,v48,v213
v_mul_f32 v214,v48,v214
v_mul_f32 v215,v48,v215
v_cvt_pk_bf16_f32 v208,v208,v209
v_cvt_pk_bf16_f32 v209,v210,v211
v_cvt_pk_bf16_f32 v210,v212,v213
v_cvt_pk_bf16_f32 v211,v214,v215
buffer_store_dwordx4 v[208:211],v1,s[16:19],s88 offen offset:2048 sc1
v_mul_f32 v216,v48,v216
v_mul_f32 v217,v48,v217
v_mul_f32 v218,v48,v218
v_mul_f32 v219,v48,v219
v_mul_f32 v220,v48,v220
v_mul_f32 v221,v48,v221
v_mul_f32 v222,v48,v222
v_mul_f32 v223,v48,v223
v_cvt_pk_bf16_f32 v216,v216,v217
v_cvt_pk_bf16_f32 v217,v218,v219
v_cvt_pk_bf16_f32 v218,v220,v221
v_cvt_pk_bf16_f32 v219,v222,v223
buffer_store_dwordx4 v[216:219],v1,s[16:19],s88 offen offset:3072 sc1
s_cmp_eq_u64 vcc,0
s_cselect_b32 s100,3,2
s_or_b32 s100,s100,s27
v_mul_f32 v224,v49,v224
v_mul_f32 v225,v49,v225
v_mul_f32 v226,v49,v226
v_mul_f32 v227,v49,v227
v_mul_f32 v228,v49,v228
v_mul_f32 v229,v49,v229
v_mul_f32 v230,v49,v230
v_mul_f32 v231,v49,v231
v_cvt_pk_bf16_f32 v224,v224,v225
v_cvt_pk_bf16_f32 v225,v226,v227
v_cvt_pk_bf16_f32 v226,v228,v229
v_cvt_pk_bf16_f32 v227,v230,v231
buffer_store_dwordx4 v[224:227],v1,s[16:19],s89 offen offset:0 sc1
v_mul_f32 v232,v49,v232
v_mul_f32 v233,v49,v233
v_mul_f32 v234,v49,v234
v_mul_f32 v235,v49,v235
v_mul_f32 v236,v49,v236
v_mul_f32 v237,v49,v237
v_mul_f32 v238,v49,v238
v_mul_f32 v239,v49,v239
v_cvt_pk_bf16_f32 v232,v232,v233
v_cvt_pk_bf16_f32 v233,v234,v235
v_cvt_pk_bf16_f32 v234,v236,v237
v_cvt_pk_bf16_f32 v235,v238,v239
buffer_store_dwordx4 v[232:235],v1,s[16:19],s89 offen offset:1024 sc1
v_mul_f32 v240,v49,v240
v_mul_f32 v241,v49,v241
v_mul_f32 v242,v49,v242
v_mul_f32 v243,v49,v243
v_mul_f32 v244,v49,v244
v_mul_f32 v245,v49,v245
v_mul_f32 v246,v49,v246
v_mul_f32 v247,v49,v247
v_cvt_pk_bf16_f32 v240,v240,v241
v_cvt_pk_bf16_f32 v241,v242,v243
v_cvt_pk_bf16_f32 v242,v244,v245
v_cvt_pk_bf16_f32 v243,v246,v247
buffer_store_dwordx4 v[240:243],v1,s[16:19],s89 offen offset:2048 sc1
v_mul_f32 v248,v49,v248
v_mul_f32 v249,v49,v249
v_mul_f32 v250,v49,v250
v_mul_f32 v251,v49,v251
v_mul_f32 v252,v49,v252
v_mul_f32 v253,v49,v253
v_mul_f32 v254,v49,v254
v_mul_f32 v255,v49,v255
v_cvt_pk_bf16_f32 v248,v248,v249
v_cvt_pk_bf16_f32 v249,v250,v251
v_cvt_pk_bf16_f32 v250,v252,v253
v_cvt_pk_bf16_f32 v251,v254,v255
buffer_store_dwordx4 v[248:251],v1,s[16:19],s89 offen offset:3072 sc1
K2_P2:
s_sub_u32 s26,6,s22
s_cmp_eq_u32 s26,0
s_cbranch_scc1 K2_TAIL
.p2align 3
K2_L2:
s_waitcnt lgkmcnt(7)
v_mfma_f32_16x16x32_bf16 v[48:51],a[160:163],a[0:3],v[24:27]
s_waitcnt lgkmcnt(5)
v_exp_f32 v60,v60
v_mfma_f32_16x16x32_bf16 v[48:51],a[164:167],a[4:7],v[48:51]
s_waitcnt lgkmcnt(1)
v_exp_f32 v61,v61
v_mfma_f32_16x16x32_bf16 v[48:51],a[168:171],a[8:11],v[48:51]
ds_read_b128 a[176:179],v3 offset:36864
v_add_f32 v21,v21,v60
v_mfma_f32_16x16x32_bf16 v[48:51],a[172:175],a[12:15],v[48:51]
buffer_load_dwordx4 v1,s[16:19],s24 offen offset:2048 sc1 lds
v_add_f32 v21,v21,v61
v_cvt_pk_bf16_f32 v94,v60,v61
v_mfma_f32_16x16x32_bf16 v[128:131],a[192:195],v[64:67],v[128:131]
v_exp_f32 v62,v62
v_mfma_f32_16x16x32_bf16 v[128:131],a[196:199],v[68:71],v[128:131]
v_exp_f32 v63,v63
v_mfma_f32_16x16x32_bf16 v[160:163],a[192:195],v[72:75],v[160:163]
ds_read_b128 a[208:211],v5 offset:1024
v_add_f32 v21,v21,v62
v_mfma_f32_16x16x32_bf16 v[160:163],a[196:199],v[76:79],v[160:163]
buffer_load_dwordx4 v1,s[16:19],s24 offen offset:3072 sc1 lds
v_add_f32 v21,v21,v63
v_cvt_pk_bf16_f32 v95,v62,v63
v_mfma_f32_16x16x32_bf16 v[52:55],a[160:163],a[16:19],v[28:31]
s_add_u32 m0,s23,98304
v_exp_f32 v48,v48
v_mfma_f32_16x16x32_bf16 v[52:55],a[164:167],a[20:23],v[52:55]
s_add_u32 s25,s25,16384
v_exp_f32 v49,v49
v_mfma_f32_16x16x32_bf16 v[52:55],a[168:171],a[24:27],v[52:55]
ds_read_b128 a[180:183],v3 offset:37888
v_add_f32 v16,v16,v48
v_mfma_f32_16x16x32_bf16 v[52:55],a[172:175],a[28:31],v[52:55]
buffer_load_dwordx4 v1,s[16:19],s25 offen offset:0 sc1 lds
v_add_f32 v16,v16,v49
v_cvt_pk_bf16_f32 v96,v48,v49
v_mfma_f32_16x16x32_bf16 a[96:99],a[192:195],v[80:83],a[96:99]
v_exp_f32 v50,v50
v_mfma_f32_16x16x32_bf16 a[96:99],a[196:199],v[84:87],a[96:99]
v_exp_f32 v51,v51
v_mfma_f32_16x16x32_bf16 a[128:131],a[192:195],v[88:91],a[128:131]
ds_read_b128 a[212:215],v5 offset:5120
v_add_f32 v16,v16,v50
v_mfma_f32_16x16x32_bf16 a[128:131],a[196:199],v[92:95],a[128:131]
buffer_load_dwordx4 v1,s[16:19],s25 offen offset:1024 sc1 lds
v_add_f32 v16,v16,v51
v_cvt_pk_bf16_f32 v97,v50,v51
v_mfma_f32_16x16x32_bf16 v[56:59],a[160:163],a[64:67],v[40:43]
v_exp_f32 v52,v52
v_mfma_f32_16x16x32_bf16 v[56:59],a[164:167],a[68:71],v[56:59]
v_exp_f32 v53,v53
v_mfma_f32_16x16x32_bf16 v[56:59],a[168:171],a[72:75],v[56:59]
ds_read_b128 a[184:187],v3 offset:38912
v_add_f32 v17,v17,v52
v_mfma_f32_16x16x32_bf16 v[56:59],a[172:175],a[76:79],v[56:59]
buffer_load_dwordx4 v1,s[16:19],s25 offen offset:2048 sc1 lds
v_add_f32 v17,v17,v53
v_cvt_pk_bf16_f32 v104,v52,v53
v_mfma_f32_16x16x32_bf16 v[132:135],a[200:203],v[64:67],v[132:135]
s_waitcnt lgkmcnt(5)
v_exp_f32 v54,v54
v_mfma_f32_16x16x32_bf16 v[132:135],a[204:207],v[68:71],v[132:135]
v_exp_f32 v55,v55
v_mfma_f32_16x16x32_bf16 v[164:167],a[200:203],v[72:75],v[164:167]
ds_read_b128 a[216:219],v5 offset:9216
v_add_f32 v17,v17,v54
v_mfma_f32_16x16x32_bf16 v[164:167],a[204:207],v[76:79],v[164:167]
buffer_load_dwordx4 v1,s[16:19],s25 offen offset:3072 sc1 lds
v_add_f32 v17,v17,v55
v_cvt_pk_bf16_f32 v105,v54,v55
v_mfma_f32_16x16x32_bf16 v[60:63],a[160:163],a[80:83],v[44:47]
s_add_u32 m0,s23,114688
v_exp_f32 v56,v56
v_mfma_f32_16x16x32_bf16 v[60:63],a[164:167],a[84:87],v[60:63]
s_add_u32 s25,s25,16384
v_exp_f32 v57,v57
v_mfma_f32_16x16x32_bf16 v[60:63],a[168:171],a[88:91],v[60:63]
ds_read_b128 a[188:191],v3 offset:39936
v_add_f32 v20,v20,v56
v_mfma_f32_16x16x32_bf16 v[60:63],a[172:175],a[92:95],v[60:63]
buffer_load_dwordx4 v1,s[16:19],s25 offen offset:0 sc1 lds
v_add_f32 v20,v20,v57
v_cvt_pk_bf16_f32 v112,v56,v57
v_mfma_f32_16x16x32_bf16 a[100:103],a[200:203],v[80:83],a[100:103]
v_exp_f32 v58,v58
v_mfma_f32_16x16x32_bf16 a[100:103],a[204:207],v[84:87],a[100:103]
s_waitcnt lgkmcnt(6)
v_exp_f32 v59,v59
v_mfma_f32_16x16x32_bf16 a[132:135],a[200:203],v[88:91],a[132:135]
ds_read_b128 a[220:223],v5 offset:13312
v_add_f32 v20,v20,v58
v_mfma_f32_16x16x32_bf16 a[132:135],a[204:207],v[92:95],a[132:135]
buffer_load_dwordx4 v1,s[16:19],s25 offen offset:1024 sc1 lds
v_add_f32 v20,v20,v59
v_cvt_pk_bf16_f32 v113,v58,v59
v_mfma_f32_16x16x32_bf16 v[48:51],a[176:179],a[0:3],v[24:27]
s_waitcnt lgkmcnt(5)
v_exp_f32 v60,v60
v_mfma_f32_16x16x32_bf16 v[48:51],a[180:183],a[4:7],v[48:51]
s_waitcnt lgkmcnt(1)
v_exp_f32 v61,v61
v_mfma_f32_16x16x32_bf16 v[48:51],a[184:187],a[8:11],v[48:51]
ds_read_b128 a[160:163],v3 offset:40960
v_add_f32 v21,v21,v60
v_mfma_f32_16x16x32_bf16 v[48:51],a[188:191],a[12:15],v[48:51]
buffer_load_dwordx4 v1,s[16:19],s25 offen offset:2048 sc1 lds
v_add_f32 v21,v21,v61
v_cvt_pk_bf16_f32 v120,v60,v61
v_mfma_f32_16x16x32_bf16 v[136:139],a[208:211],v[64:67],v[136:139]
v_exp_f32 v62,v62
v_mfma_f32_16x16x32_bf16 v[136:139],a[212:215],v[68:71],v[136:139]
v_exp_f32 v63,v63
v_mfma_f32_16x16x32_bf16 v[168:171],a[208:211],v[72:75],v[168:171]
ds_read_b128 a[192:195],v5 offset:2048
v_add_f32 v21,v21,v62
v_mfma_f32_16x16x32_bf16 v[168:171],a[212:215],v[76:79],v[168:171]
buffer_load_dwordx4 v1,s[16:19],s25 offen offset:3072 sc1 lds
v_add_f32 v21,v21,v63
v_cvt_pk_bf16_f32 v121,v62,v63
v_mfma_f32_16x16x32_bf16 v[52:55],a[176:179],a[16:19],v[28:31]
v_exp_f32 v48,v48
v_mfma_f32_16x16x32_bf16 v[52:55],a[180:183],a[20:23],v[52:55]
v_exp_f32 v49,v49
v_mfma_f32_16x16x32_bf16 v[52:55],a[184:187],a[24:27],v[52:55]
ds_read_b128 a[164:167],v3 offset:41984
v_add_f32 v16,v16,v48
v_mfma_f32_16x16x32_bf16 v[52:55],a[188:191],a[28:31],v[52:55]
v_add_f32 v16,v16,v49
v_cvt_pk_bf16_f32 v98,v48,v49
v_mfma_f32_16x16x32_bf16 a[104:107],a[208:211],v[80:83],a[104:107]
v_exp_f32 v50,v50
v_mfma_f32_16x16x32_bf16 a[104:107],a[212:215],v[84:87],a[104:107]
v_exp_f32 v51,v51
v_mfma_f32_16x16x32_bf16 a[136:139],a[208:211],v[88:91],a[136:139]
ds_read_b128 a[196:199],v5 offset:6144
v_add_f32 v16,v16,v50
v_mfma_f32_16x16x32_bf16 a[136:139],a[212:215],v[92:95],a[136:139]
v_add_f32 v16,v16,v51
v_cvt_pk_bf16_f32 v99,v50,v51
v_mfma_f32_16x16x32_bf16 v[56:59],a[176:179],a[64:67],v[40:43]
v_exp_f32 v52,v52
v_mfma_f32_16x16x32_bf16 v[56:59],a[180:183],a[68:71],v[56:59]
v_exp_f32 v53,v53
v_mfma_f32_16x16x32_bf16 v[56:59],a[184:187],a[72:75],v[56:59]
ds_read_b128 a[168:171],v3 offset:43008
v_add_f32 v17,v17,v52
v_mfma_f32_16x16x32_bf16 v[56:59],a[188:191],a[76:79],v[56:59]
v_add_f32 v17,v17,v53
v_cvt_pk_bf16_f32 v106,v52,v53
v_mfma_f32_16x16x32_bf16 v[140:143],a[216:219],v[64:67],v[140:143]
s_waitcnt lgkmcnt(5)
v_exp_f32 v54,v54
v_mfma_f32_16x16x32_bf16 v[140:143],a[220:223],v[68:71],v[140:143]
v_exp_f32 v55,v55
v_mfma_f32_16x16x32_bf16 v[172:175],a[216:219],v[72:75],v[172:175]
ds_read_b128 a[200:203],v5 offset:10240
v_add_f32 v17,v17,v54
v_mfma_f32_16x16x32_bf16 v[172:175],a[220:223],v[76:79],v[172:175]
v_add_f32 v17,v17,v55
v_cvt_pk_bf16_f32 v107,v54,v55
v_mfma_f32_16x16x32_bf16 v[60:63],a[176:179],a[80:83],v[44:47]
s_cmp_eq_u32 s8,0
v_exp_f32 v56,v56
v_mfma_f32_16x16x32_bf16 v[60:63],a[180:183],a[84:87],v[60:63]
s_cbranch_scc1 F_H2L2_O
F_H2L2_B:
v_exp_f32 v57,v57
v_mfma_f32_16x16x32_bf16 v[60:63],a[184:187],a[88:91],v[60:63]
ds_read_b128 a[172:175],v3 offset:44032
v_add_f32 v20,v20,v56
v_mfma_f32_16x16x32_bf16 v[60:63],a[188:191],a[92:95],v[60:63]
v_add_f32 v20,v20,v57
v_cvt_pk_bf16_f32 v114,v56,v57
v_mfma_f32_16x16x32_bf16 a[108:111],a[216:219],v[80:83],a[108:111]
v_exp_f32 v58,v58
v_mfma_f32_16x16x32_bf16 a[108:111],a[220:223],v[84:87],a[108:111]
v_exp_f32 v59,v59
v_mfma_f32_16x16x32_bf16 a[140:143],a[216:219],v[88:91],a[140:143]
ds_read_b128 a[204:207],v5 offset:14336
v_add_f32 v20,v20,v58
v_mfma_f32_16x16x32_bf16 a[140:143],a[220:223],v[92:95],a[140:143]
s_waitcnt lgkmcnt(7)
v_add_f32 v20,v20,v59
v_cvt_pk_bf16_f32 v115,v58,v59
v_mfma_f32_16x16x32_bf16 v[48:51],a[160:163],a[0:3],v[24:27]
s_waitcnt lgkmcnt(5)
v_exp_f32 v60,v60
v_mfma_f32_16x16x32_bf16 v[48:51],a[164:167],a[4:7],v[48:51]
s_waitcnt lgkmcnt(1)
v_exp_f32 v61,v61
v_mfma_f32_16x16x32_bf16 v[48:51],a[168:171],a[8:11],v[48:51]
ds_read_b128 a[176:179],v3 offset:45056
v_add_f32 v21,v21,v60
v_mfma_f32_16x16x32_bf16 v[48:51],a[172:175],a[12:15],v[48:51]
v_add_f32 v21,v21,v61
v_cvt_pk_bf16_f32 v122,v60,v61
v_mfma_f32_16x16x32_bf16 v[144:147],a[192:195],v[64:67],v[144:147]
v_exp_f32 v62,v62
v_mfma_f32_16x16x32_bf16 v[144:147],a[196:199],v[68:71],v[144:147]
v_exp_f32 v63,v63
v_mfma_f32_16x16x32_bf16 v[176:179],a[192:195],v[72:75],v[176:179]
ds_read_b128 a[208:211],v5 offset:3072
v_add_f32 v21,v21,v62
v_mfma_f32_16x16x32_bf16 v[176:179],a[196:199],v[76:79],v[176:179]
v_add_f32 v21,v21,v63
v_cvt_pk_bf16_f32 v123,v62,v63
v_mfma_f32_16x16x32_bf16 v[52:55],a[160:163],a[16:19],v[28:31]
v_exp_f32 v48,v48
v_mfma_f32_16x16x32_bf16 v[52:55],a[164:167],a[20:23],v[52:55]
v_exp_f32 v49,v49
v_mfma_f32_16x16x32_bf16 v[52:55],a[168:171],a[24:27],v[52:55]
ds_read_b128 a[180:183],v3 offset:46080
v_add_f32 v16,v16,v48
v_mfma_f32_16x16x32_bf16 v[52:55],a[172:175],a[28:31],v[52:55]
v_add_f32 v16,v16,v49
v_cvt_pk_bf16_f32 v100,v48,v49
v_mfma_f32_16x16x32_bf16 a[112:115],a[192:195],v[80:83],a[112:115]
v_exp_f32 v50,v50
v_mfma_f32_16x16x32_bf16 a[112:115],a[196:199],v[84:87],a[112:115]
v_exp_f32 v51,v51
v_mfma_f32_16x16x32_bf16 a[144:147],a[192:195],v[88:91],a[144:147]
ds_read_b128 a[212:215],v5 offset:7168
v_add_f32 v16,v16,v50
v_mfma_f32_16x16x32_bf16 a[144:147],a[196:199],v[92:95],a[144:147]
v_add_f32 v16,v16,v51
v_cvt_pk_bf16_f32 v101,v50,v51
v_mfma_f32_16x16x32_bf16 v[56:59],a[160:163],a[64:67],v[40:43]
v_exp_f32 v52,v52
v_mfma_f32_16x16x32_bf16 v[56:59],a[164:167],a[68:71],v[56:59]
v_exp_f32 v53,v53
v_mfma_f32_16x16x32_bf16 v[56:59],a[168:171],a[72:75],v[56:59]
ds_read_b128 a[184:187],v3 offset:47104
v_add_f32 v17,v17,v52
v_mfma_f32_16x16x32_bf16 v[56:59],a[172:175],a[76:79],v[56:59]
v_add_f32 v17,v17,v53
v_cvt_pk_bf16_f32 v108,v52,v53
v_mfma_f32_16x16x32_bf16 v[148:151],a[200:203],v[64:67],v[148:151]
s_waitcnt lgkmcnt(5)
v_exp_f32 v54,v54
v_mfma_f32_16x16x32_bf16 v[148:151],a[204:207],v[68:71],v[148:151]
v_exp_f32 v55,v55
v_mfma_f32_16x16x32_bf16 v[180:183],a[200:203],v[72:75],v[180:183]
ds_read_b128 a[216:219],v5 offset:11264
v_add_f32 v17,v17,v54
v_mfma_f32_16x16x32_bf16 v[180:183],a[204:207],v[76:79],v[180:183]
v_add_f32 v17,v17,v55
v_cvt_pk_bf16_f32 v109,v54,v55
v_mfma_f32_16x16x32_bf16 v[60:63],a[160:163],a[80:83],v[44:47]
v_exp_f32 v56,v56
v_mfma_f32_16x16x32_bf16 v[60:63],a[164:167],a[84:87],v[60:63]
v_exp_f32 v57,v57
v_mfma_f32_16x16x32_bf16 v[60:63],a[168:171],a[88:91],v[60:63]
ds_read_b128 a[188:191],v3 offset:48128
v_add_f32 v20,v20,v56
v_mfma_f32_16x16x32_bf16 v[60:63],a[172:175],a[92:95],v[60:63]
v_add_f32 v20,v20,v57
v_cvt_pk_bf16_f32 v116,v56,v57
v_mfma_f32_16x16x32_bf16 a[116:119],a[200:203],v[80:83],a[116:119]
v_exp_f32 v58,v58
v_mfma_f32_16x16x32_bf16 a[116:119],a[204:207],v[84:87],a[116:119]
v_exp_f32 v59,v59
v_mfma_f32_16x16x32_bf16 a[148:151],a[200:203],v[88:91],a[148:151]
ds_read_b128 a[220:223],v5 offset:15360
v_add_f32 v20,v20,v58
v_mfma_f32_16x16x32_bf16 a[148:151],a[204:207],v[92:95],a[148:151]
s_waitcnt lgkmcnt(7)
v_add_f32 v20,v20,v59
v_cvt_pk_bf16_f32 v117,v58,v59
v_mfma_f32_16x16x32_bf16 v[48:51],a[176:179],a[0:3],v[24:27]
s_waitcnt lgkmcnt(5)
v_exp_f32 v60,v60
v_mfma_f32_16x16x32_bf16 v[48:51],a[180:183],a[4:7],v[48:51]
s_waitcnt lgkmcnt(3)
v_exp_f32 v61,v61
v_mfma_f32_16x16x32_bf16 v[48:51],a[184:187],a[8:11],v[48:51]
s_waitcnt lgkmcnt(1)
v_add_f32 v21,v21,v60
v_add_f32 v21,v21,v61
v_mfma_f32_16x16x32_bf16 v[48:51],a[188:191],a[12:15],v[48:51]
s_cmp_eq_u32 s8,0
v_exp_f32 v62,v62
v_mfma_f32_16x16x32_bf16 v[152:155],a[208:211],v[64:67],v[152:155]
s_waitcnt vmcnt(0) lgkmcnt(0)
v_exp_f32 v63,v63
v_mfma_f32_16x16x32_bf16 v[152:155],a[212:215],v[68:71],v[152:155]
s_barrier
s_cbranch_scc1 F_H3L2_O
F_H3L2_B:
v_cvt_pk_bf16_f32 v124,v60,v61
v_add_f32 v21,v21,v62
v_mfma_f32_16x16x32_bf16 v[184:187],a[208:211],v[72:75],v[184:187]
ds_read_b128 a[160:163],v3 offset:0
v_add_f32 v21,v21,v63
v_mfma_f32_16x16x32_bf16 v[184:187],a[212:215],v[76:79],v[184:187]
ds_read_b128 a[192:195],v5 offset:32768
v_cvt_pk_bf16_f32 v125,v62,v63
v_mfma_f32_16x16x32_bf16 v[52:55],a[176:179],a[16:19],v[28:31]
s_add_u32 m0,s23,32768
v_exp_f32 v48,v48
v_mfma_f32_16x16x32_bf16 v[52:55],a[180:183],a[20:23],v[52:55]
s_add_u32 s24,s24,16384
v_exp_f32 v49,v49
v_mfma_f32_16x16x32_bf16 v[52:55],a[184:187],a[24:27],v[52:55]
ds_read_b128 a[164:167],v3 offset:1024
v_add_f32 v16,v16,v48
v_mfma_f32_16x16x32_bf16 v[52:55],a[188:191],a[28:31],v[52:55]
buffer_load_dwordx4 v1,s[16:19],s24 offen offset:0 sc1 lds
v_add_f32 v16,v16,v49
v_cvt_pk_bf16_f32 v102,v48,v49
v_mfma_f32_16x16x32_bf16 a[120:123],a[208:211],v[80:83],a[120:123]
v_exp_f32 v50,v50
v_mfma_f32_16x16x32_bf16 a[120:123],a[212:215],v[84:87],a[120:123]
v_exp_f32 v51,v51
v_mfma_f32_16x16x32_bf16 a[152:155],a[208:211],v[88:91],a[152:155]
ds_read_b128 a[196:199],v5 offset:36864
v_add_f32 v16,v16,v50
v_mfma_f32_16x16x32_bf16 a[152:155],a[212:215],v[92:95],a[152:155]
buffer_load_dwordx4 v1,s[16:19],s24 offen offset:1024 sc1 lds
v_add_f32 v16,v16,v51
v_cvt_pk_bf16_f32 v103,v50,v51
v_mfma_f32_16x16x32_bf16 v[56:59],a[176:179],a[64:67],v[40:43]
v_exp_f32 v52,v52
v_mfma_f32_16x16x32_bf16 v[56:59],a[180:183],a[68:71],v[56:59]
v_exp_f32 v53,v53
v_mfma_f32_16x16x32_bf16 v[56:59],a[184:187],a[72:75],v[56:59]
ds_read_b128 a[168:171],v3 offset:2048
v_add_f32 v17,v17,v52
v_mfma_f32_16x16x32_bf16 v[56:59],a[188:191],a[76:79],v[56:59]
buffer_load_dwordx4 v1,s[16:19],s24 offen offset:2048 sc1 lds
v_add_f32 v17,v17,v53
v_cvt_pk_bf16_f32 v110,v52,v53
v_mfma_f32_16x16x32_bf16 v[156:159],a[216:219],v[64:67],v[156:159]
v_exp_f32 v54,v54
v_mfma_f32_16x16x32_bf16 v[156:159],a[220:223],v[68:71],v[156:159]
v_exp_f32 v55,v55
v_mfma_f32_16x16x32_bf16 v[188:191],a[216:219],v[72:75],v[188:191]
ds_read_b128 a[200:203],v5 offset:40960
v_add_f32 v17,v17,v54
v_mfma_f32_16x16x32_bf16 v[188:191],a[220:223],v[76:79],v[188:191]
buffer_load_dwordx4 v1,s[16:19],s24 offen offset:3072 sc1 lds
v_add_f32 v17,v17,v55
v_cvt_pk_bf16_f32 v111,v54,v55
v_mfma_f32_16x16x32_bf16 v[60:63],a[176:179],a[80:83],v[44:47]
s_add_u32 m0,s23,49152
v_exp_f32 v56,v56
v_mfma_f32_16x16x32_bf16 v[60:63],a[180:183],a[84:87],v[60:63]
s_add_u32 s24,s24,16384
v_exp_f32 v57,v57
v_mfma_f32_16x16x32_bf16 v[60:63],a[184:187],a[88:91],v[60:63]
ds_read_b128 a[172:175],v3 offset:3072
v_add_f32 v20,v20,v56
v_mfma_f32_16x16x32_bf16 v[60:63],a[188:191],a[92:95],v[60:63]
buffer_load_dwordx4 v1,s[16:19],s24 offen offset:0 sc1 lds
v_add_f32 v20,v20,v57
v_cvt_pk_bf16_f32 v118,v56,v57
v_mfma_f32_16x16x32_bf16 a[124:127],a[216:219],v[80:83],a[124:127]
v_exp_f32 v58,v58
v_mfma_f32_16x16x32_bf16 a[124:127],a[220:223],v[84:87],a[124:127]
s_waitcnt lgkmcnt(6)
v_exp_f32 v59,v59
v_mfma_f32_16x16x32_bf16 a[156:159],a[216:219],v[88:91],a[156:159]
ds_read_b128 a[204:207],v5 offset:45056
v_add_f32 v20,v20,v58
v_mfma_f32_16x16x32_bf16 a[156:159],a[220:223],v[92:95],a[156:159]
buffer_load_dwordx4 v1,s[16:19],s24 offen offset:1024 sc1 lds
v_add_f32 v20,v20,v59
v_cvt_pk_bf16_f32 v119,v58,v59
v_mfma_f32_16x16x32_bf16 v[48:51],a[160:163],a[0:3],v[24:27]
s_waitcnt lgkmcnt(5)
v_exp_f32 v60,v60
v_mfma_f32_16x16x32_bf16 v[48:51],a[164:167],a[4:7],v[48:51]
s_waitcnt lgkmcnt(1)
v_exp_f32 v61,v61
v_mfma_f32_16x16x32_bf16 v[48:51],a[168:171],a[8:11],v[48:51]
ds_read_b128 a[176:179],v3 offset:4096
v_add_f32 v21,v21,v60
v_mfma_f32_16x16x32_bf16 v[48:51],a[172:175],a[12:15],v[48:51]
buffer_load_dwordx4 v1,s[16:19],s24 offen offset:2048 sc1 lds
v_add_f32 v21,v21,v61
v_cvt_pk_bf16_f32 v126,v60,v61
v_mfma_f32_16x16x32_bf16 v[128:131],a[192:195],v[96:99],v[128:131]
v_exp_f32 v62,v62
v_mfma_f32_16x16x32_bf16 v[128:131],a[196:199],v[100:103],v[128:131]
v_exp_f32 v63,v63
v_mfma_f32_16x16x32_bf16 v[160:163],a[192:195],v[104:107],v[160:163]
ds_read_b128 a[208:211],v5 offset:33792
v_add_f32 v21,v21,v62
v_mfma_f32_16x16x32_bf16 v[160:163],a[196:199],v[108:111],v[160:163]
buffer_load_dwordx4 v1,s[16:19],s24 offen offset:3072 sc1 lds
v_add_f32 v21,v21,v63
v_cvt_pk_bf16_f32 v127,v62,v63
v_mfma_f32_16x16x32_bf16 v[52:55],a[160:163],a[16:19],v[28:31]
s_add_u32 m0,s23,65536
v_exp_f32 v48,v48
v_mfma_f32_16x16x32_bf16 v[52:55],a[164:167],a[20:23],v[52:55]
s_add_u32 s25,s25,16384
v_exp_f32 v49,v49
v_mfma_f32_16x16x32_bf16 v[52:55],a[168:171],a[24:27],v[52:55]
ds_read_b128 a[180:183],v3 offset:5120
v_add_f32 v16,v16,v48
v_mfma_f32_16x16x32_bf16 v[52:55],a[172:175],a[28:31],v[52:55]
buffer_load_dwordx4 v1,s[16:19],s25 offen offset:0 sc1 lds
v_add_f32 v16,v16,v49
v_cvt_pk_bf16_f32 v64,v48,v49
v_mfma_f32_16x16x32_bf16 a[96:99],a[192:195],v[112:115],a[96:99]
v_exp_f32 v50,v50
v_mfma_f32_16x16x32_bf16 a[96:99],a[196:199],v[116:119],a[96:99]
v_exp_f32 v51,v51
v_mfma_f32_16x16x32_bf16 a[128:131],a[192:195],v[120:123],a[128:131]
ds_read_b128 a[212:215],v5 offset:37888
v_add_f32 v16,v16,v50
v_mfma_f32_16x16x32_bf16 a[128:131],a[196:199],v[124:127],a[128:131]
buffer_load_dwordx4 v1,s[16:19],s25 offen offset:1024 sc1 lds
v_add_f32 v16,v16,v51
v_cvt_pk_bf16_f32 v65,v50,v51
v_mfma_f32_16x16x32_bf16 v[56:59],a[160:163],a[64:67],v[40:43]
v_exp_f32 v52,v52
v_mfma_f32_16x16x32_bf16 v[56:59],a[164:167],a[68:71],v[56:59]
v_exp_f32 v53,v53
v_mfma_f32_16x16x32_bf16 v[56:59],a[168:171],a[72:75],v[56:59]
ds_read_b128 a[184:187],v3 offset:6144
v_add_f32 v17,v17,v52
v_mfma_f32_16x16x32_bf16 v[56:59],a[172:175],a[76:79],v[56:59]
buffer_load_dwordx4 v1,s[16:19],s25 offen offset:2048 sc1 lds
v_add_f32 v17,v17,v53
v_cvt_pk_bf16_f32 v72,v52,v53
v_mfma_f32_16x16x32_bf16 v[132:135],a[200:203],v[96:99],v[132:135]
s_waitcnt lgkmcnt(5)
v_exp_f32 v54,v54
v_mfma_f32_16x16x32_bf16 v[132:135],a[204:207],v[100:103],v[132:135]
v_exp_f32 v55,v55
v_mfma_f32_16x16x32_bf16 v[164:167],a[200:203],v[104:107],v[164:167]
ds_read_b128 a[216:219],v5 offset:41984
v_add_f32 v17,v17,v54
v_mfma_f32_16x16x32_bf16 v[164:167],a[204:207],v[108:111],v[164:167]
buffer_load_dwordx4 v1,s[16:19],s25 offen offset:3072 sc1 lds
v_add_f32 v17,v17,v55
v_cvt_pk_bf16_f32 v73,v54,v55
v_mfma_f32_16x16x32_bf16 v[60:63],a[160:163],a[80:83],v[44:47]
s_add_u32 m0,s23,81920
v_exp_f32 v56,v56
v_mfma_f32_16x16x32_bf16 v[60:63],a[164:167],a[84:87],v[60:63]
s_add_u32 s25,s25,16384
v_exp_f32 v57,v57
v_mfma_f32_16x16x32_bf16 v[60:63],a[168:171],a[88:91],v[60:63]
ds_read_b128 a[188:191],v3 offset:7168
v_add_f32 v20,v20,v56
v_mfma_f32_16x16x32_bf16 v[60:63],a[172:175],a[92:95],v[60:63]
buffer_load_dwordx4 v1,s[16:19],s25 offen offset:0 sc1 lds
v_add_f32 v20,v20,v57
v_cvt_pk_bf16_f32 v80,v56,v57
v_mfma_f32_16x16x32_bf16 a[100:103],a[200:203],v[112:115],a[100:103]
v_exp_f32 v58,v58
v_mfma_f32_16x16x32_bf16 a[100:103],a[204:207],v[116:119],a[100:103]
s_waitcnt lgkmcnt(6)
v_exp_f32 v59,v59
v_mfma_f32_16x16x32_bf16 a[132:135],a[200:203],v[120:123],a[132:135]
ds_read_b128 a[220:223],v5 offset:46080
v_add_f32 v20,v20,v58
v_mfma_f32_16x16x32_bf16 a[132:135],a[204:207],v[124:127],a[132:135]
buffer_load_dwordx4 v1,s[16:19],s25 offen offset:1024 sc1 lds
v_add_f32 v20,v20,v59
v_cvt_pk_bf16_f32 v81,v58,v59
v_mfma_f32_16x16x32_bf16 v[48:51],a[176:179],a[0:3],v[24:27]
s_waitcnt lgkmcnt(5)
v_exp_f32 v60,v60
v_mfma_f32_16x16x32_bf16 v[48:51],a[180:183],a[4:7],v[48:51]
s_waitcnt lgkmcnt(1)
v_exp_f32 v61,v61
v_mfma_f32_16x16x32_bf16 v[48:51],a[184:187],a[8:11],v[48:51]
ds_read_b128 a[160:163],v3 offset:8192
v_add_f32 v21,v21,v60
v_mfma_f32_16x16x32_bf16 v[48:51],a[188:191],a[12:15],v[48:51]
buffer_load_dwordx4 v1,s[16:19],s25 offen offset:2048 sc1 lds
v_add_f32 v21,v21,v61
v_cvt_pk_bf16_f32 v88,v60,v61
v_mfma_f32_16x16x32_bf16 v[136:139],a[208:211],v[96:99],v[136:139]
v_exp_f32 v62,v62
v_mfma_f32_16x16x32_bf16 v[136:139],a[212:215],v[100:103],v[136:139]
v_exp_f32 v63,v63
v_mfma_f32_16x16x32_bf16 v[168:171],a[208:211],v[104:107],v[168:171]
ds_read_b128 a[192:195],v5 offset:34816
v_add_f32 v21,v21,v62
v_mfma_f32_16x16x32_bf16 v[168:171],a[212:215],v[108:111],v[168:171]
buffer_load_dwordx4 v1,s[16:19],s25 offen offset:3072 sc1 lds
v_add_f32 v21,v21,v63
v_cvt_pk_bf16_f32 v89,v62,v63
v_mfma_f32_16x16x32_bf16 v[52:55],a[176:179],a[16:19],v[28:31]
v_exp_f32 v48,v48
v_mfma_f32_16x16x32_bf16 v[52:55],a[180:183],a[20:23],v[52:55]
v_exp_f32 v49,v49
v_mfma_f32_16x16x32_bf16 v[52:55],a[184:187],a[24:27],v[52:55]
ds_read_b128 a[164:167],v3 offset:9216
v_add_f32 v16,v16,v48
v_mfma_f32_16x16x32_bf16 v[52:55],a[188:191],a[28:31],v[52:55]
v_add_f32 v16,v16,v49
v_cvt_pk_bf16_f32 v66,v48,v49
v_mfma_f32_16x16x32_bf16 a[104:107],a[208:211],v[112:115],a[104:107]
v_exp_f32 v50,v50
v_mfma_f32_16x16x32_bf16 a[104:107],a[212:215],v[116:119],a[104:107]
v_exp_f32 v51,v51
v_mfma_f32_16x16x32_bf16 a[136:139],a[208:211],v[120:123],a[136:139]
ds_read_b128 a[196:199],v5 offset:38912
v_add_f32 v16,v16,v50
v_mfma_f32_16x16x32_bf16 a[136:139],a[212:215],v[124:127],a[136:139]
v_add_f32 v16,v16,v51
v_cvt_pk_bf16_f32 v67,v50,v51
v_mfma_f32_16x16x32_bf16 v[56:59],a[176:179],a[64:67],v[40:43]
v_exp_f32 v52,v52
v_mfma_f32_16x16x32_bf16 v[56:59],a[180:183],a[68:71],v[56:59]
v_exp_f32 v53,v53
v_mfma_f32_16x16x32_bf16 v[56:59],a[184:187],a[72:75],v[56:59]
ds_read_b128 a[168:171],v3 offset:10240
v_add_f32 v17,v17,v52
v_mfma_f32_16x16x32_bf16 v[56:59],a[188:191],a[76:79],v[56:59]
v_add_f32 v17,v17,v53
v_cvt_pk_bf16_f32 v74,v52,v53
v_mfma_f32_16x16x32_bf16 v[140:143],a[216:219],v[96:99],v[140:143]
s_waitcnt lgkmcnt(5)
v_exp_f32 v54,v54
v_mfma_f32_16x16x32_bf16 v[140:143],a[220:223],v[100:103],v[140:143]
v_exp_f32 v55,v55
v_mfma_f32_16x16x32_bf16 v[172:175],a[216:219],v[104:107],v[172:175]
ds_read_b128 a[200:203],v5 offset:43008
v_add_f32 v17,v17,v54
v_mfma_f32_16x16x32_bf16 v[172:175],a[220:223],v[108:111],v[172:175]
v_add_f32 v17,v17,v55
v_cvt_pk_bf16_f32 v75,v54,v55
v_mfma_f32_16x16x32_bf16 v[60:63],a[176:179],a[80:83],v[44:47]
v_exp_f32 v56,v56
v_mfma_f32_16x16x32_bf16 v[60:63],a[180:183],a[84:87],v[60:63]
v_exp_f32 v57,v57
v_mfma_f32_16x16x32_bf16 v[60:63],a[184:187],a[88:91],v[60:63]
ds_read_b128 a[172:175],v3 offset:11264
v_add_f32 v20,v20,v56
v_mfma_f32_16x16x32_bf16 v[60:63],a[188:191],a[92:95],v[60:63]
v_add_f32 v20,v20,v57
v_cvt_pk_bf16_f32 v82,v56,v57
v_mfma_f32_16x16x32_bf16 a[108:111],a[216:219],v[112:115],a[108:111]
v_exp_f32 v58,v58
v_mfma_f32_16x16x32_bf16 a[108:111],a[220:223],v[116:119],a[108:111]
v_exp_f32 v59,v59
v_mfma_f32_16x16x32_bf16 a[140:143],a[216:219],v[120:123],a[140:143]
ds_read_b128 a[204:207],v5 offset:47104
v_add_f32 v20,v20,v58
v_mfma_f32_16x16x32_bf16 a[140:143],a[220:223],v[124:127],a[140:143]
s_waitcnt lgkmcnt(7)
v_add_f32 v20,v20,v59
v_cvt_pk_bf16_f32 v83,v58,v59
v_mfma_f32_16x16x32_bf16 v[48:51],a[160:163],a[0:3],v[24:27]
s_waitcnt lgkmcnt(5)
v_exp_f32 v60,v60
v_mfma_f32_16x16x32_bf16 v[48:51],a[164:167],a[4:7],v[48:51]
s_waitcnt lgkmcnt(1)
v_exp_f32 v61,v61
v_mfma_f32_16x16x32_bf16 v[48:51],a[168:171],a[8:11],v[48:51]
ds_read_b128 a[176:179],v3 offset:12288
v_add_f32 v21,v21,v60
v_mfma_f32_16x16x32_bf16 v[48:51],a[172:175],a[12:15],v[48:51]
v_add_f32 v21,v21,v61
v_cvt_pk_bf16_f32 v90,v60,v61
v_mfma_f32_16x16x32_bf16 v[144:147],a[192:195],v[96:99],v[144:147]
v_exp_f32 v62,v62
v_mfma_f32_16x16x32_bf16 v[144:147],a[196:199],v[100:103],v[144:147]
v_exp_f32 v63,v63
v_mfma_f32_16x16x32_bf16 v[176:179],a[192:195],v[104:107],v[176:179]
ds_read_b128 a[208:211],v5 offset:35840
v_add_f32 v21,v21,v62
v_mfma_f32_16x16x32_bf16 v[176:179],a[196:199],v[108:111],v[176:179]
v_add_f32 v21,v21,v63
v_cvt_pk_bf16_f32 v91,v62,v63
v_mfma_f32_16x16x32_bf16 v[52:55],a[160:163],a[16:19],v[28:31]
v_exp_f32 v48,v48
v_mfma_f32_16x16x32_bf16 v[52:55],a[164:167],a[20:23],v[52:55]
v_exp_f32 v49,v49
v_mfma_f32_16x16x32_bf16 v[52:55],a[168:171],a[24:27],v[52:55]
ds_read_b128 a[180:183],v3 offset:13312
v_add_f32 v16,v16,v48
v_mfma_f32_16x16x32_bf16 v[52:55],a[172:175],a[28:31],v[52:55]
v_add_f32 v16,v16,v49
v_cvt_pk_bf16_f32 v68,v48,v49
v_mfma_f32_16x16x32_bf16 a[112:115],a[192:195],v[112:115],a[112:115]
v_exp_f32 v50,v50
v_mfma_f32_16x16x32_bf16 a[112:115],a[196:199],v[116:119],a[112:115]
v_exp_f32 v51,v51
v_mfma_f32_16x16x32_bf16 a[144:147],a[192:195],v[120:123],a[144:147]
ds_read_b128 a[212:215],v5 offset:39936
v_add_f32 v16,v16,v50
v_mfma_f32_16x16x32_bf16 a[144:147],a[196:199],v[124:127],a[144:147]
v_add_f32 v16,v16,v51
v_cvt_pk_bf16_f32 v69,v50,v51
v_mfma_f32_16x16x32_bf16 v[56:59],a[160:163],a[64:67],v[40:43]
v_exp_f32 v52,v52
v_mfma_f32_16x16x32_bf16 v[56:59],a[164:167],a[68:71],v[56:59]
v_exp_f32 v53,v53
v_mfma_f32_16x16x32_bf16 v[56:59],a[168:171],a[72:75],v[56:59]
ds_read_b128 a[184:187],v3 offset:14336
v_add_f32 v17,v17,v52
v_mfma_f32_16x16x32_bf16 v[56:59],a[172:175],a[76:79],v[56:59]
v_add_f32 v17,v17,v53
v_cvt_pk_bf16_f32 v76,v52,v53
v_mfma_f32_16x16x32_bf16 v[148:151],a[200:203],v[96:99],v[148:151]
s_waitcnt lgkmcnt(5)
v_exp_f32 v54,v54
v_mfma_f32_16x16x32_bf16 v[148:151],a[204:207],v[100:103],v[148:151]
v_exp_f32 v55,v55
v_mfma_f32_16x16x32_bf16 v[180:183],a[200:203],v[104:107],v[180:183]
ds_read_b128 a[216:219],v5 offset:44032
v_add_f32 v17,v17,v54
v_mfma_f32_16x16x32_bf16 v[180:183],a[204:207],v[108:111],v[180:183]
v_add_f32 v17,v17,v55
v_cvt_pk_bf16_f32 v77,v54,v55
v_mfma_f32_16x16x32_bf16 v[60:63],a[160:163],a[80:83],v[44:47]
v_exp_f32 v56,v56
v_mfma_f32_16x16x32_bf16 v[60:63],a[164:167],a[84:87],v[60:63]
v_exp_f32 v57,v57
v_mfma_f32_16x16x32_bf16 v[60:63],a[168:171],a[88:91],v[60:63]
ds_read_b128 a[188:191],v3 offset:15360
v_add_f32 v20,v20,v56
v_mfma_f32_16x16x32_bf16 v[60:63],a[172:175],a[92:95],v[60:63]
v_add_f32 v20,v20,v57
v_cvt_pk_bf16_f32 v84,v56,v57
v_mfma_f32_16x16x32_bf16 a[116:119],a[200:203],v[112:115],a[116:119]
v_exp_f32 v58,v58
v_mfma_f32_16x16x32_bf16 a[116:119],a[204:207],v[116:119],a[116:119]
v_exp_f32 v59,v59
v_mfma_f32_16x16x32_bf16 a[148:151],a[200:203],v[120:123],a[148:151]
ds_read_b128 a[220:223],v5 offset:48128
v_add_f32 v20,v20,v58
v_mfma_f32_16x16x32_bf16 a[148:151],a[204:207],v[124:127],a[148:151]
s_waitcnt lgkmcnt(7)
v_add_f32 v20,v20,v59
v_cvt_pk_bf16_f32 v85,v58,v59
v_mfma_f32_16x16x32_bf16 v[48:51],a[176:179],a[0:3],v[24:27]
s_waitcnt lgkmcnt(5)
v_exp_f32 v60,v60
v_mfma_f32_16x16x32_bf16 v[48:51],a[180:183],a[4:7],v[48:51]
s_waitcnt lgkmcnt(3)
v_exp_f32 v61,v61
v_mfma_f32_16x16x32_bf16 v[48:51],a[184:187],a[8:11],v[48:51]
s_waitcnt lgkmcnt(1)
v_add_f32 v21,v21,v60
v_add_f32 v21,v21,v61
v_mfma_f32_16x16x32_bf16 v[48:51],a[188:191],a[12:15],v[48:51]
v_exp_f32 v62,v62
v_mfma_f32_16x16x32_bf16 v[152:155],a[208:211],v[96:99],v[152:155]
s_waitcnt vmcnt(0) lgkmcnt(0)
v_exp_f32 v63,v63
v_mfma_f32_16x16x32_bf16 v[152:155],a[212:215],v[100:103],v[152:155]
s_barrier
v_cvt_pk_bf16_f32 v92,v60,v61
v_add_f32 v21,v21,v62
v_mfma_f32_16x16x32_bf16 v[184:187],a[208:211],v[104:107],v[184:187]
ds_read_b128 a[160:163],v3 offset:32768
v_add_f32 v21,v21,v63
v_mfma_f32_16x16x32_bf16 v[184:187],a[212:215],v[108:111],v[184:187]
ds_read_b128 a[192:195],v5 offset:0
v_cvt_pk_bf16_f32 v93,v62,v63
v_mfma_f32_16x16x32_bf16 v[52:55],a[176:179],a[16:19],v[28:31]
s_add_u32 m0,s23,0
v_exp_f32 v48,v48
v_mfma_f32_16x16x32_bf16 v[52:55],a[180:183],a[20:23],v[52:55]
s_add_u32 s24,s24,16384
v_exp_f32 v49,v49
v_mfma_f32_16x16x32_bf16 v[52:55],a[184:187],a[24:27],v[52:55]
ds_read_b128 a[164:167],v3 offset:33792
v_add_f32 v16,v16,v48
v_mfma_f32_16x16x32_bf16 v[52:55],a[188:191],a[28:31],v[52:55]
buffer_load_dwordx4 v1,s[16:19],s24 offen offset:0 sc1 lds
v_add_f32 v16,v16,v49
v_cvt_pk_bf16_f32 v70,v48,v49
v_mfma_f32_16x16x32_bf16 a[120:123],a[208:211],v[112:115],a[120:123]
v_exp_f32 v50,v50
v_mfma_f32_16x16x32_bf16 a[120:123],a[212:215],v[116:119],a[120:123]
v_exp_f32 v51,v51
v_mfma_f32_16x16x32_bf16 a[152:155],a[208:211],v[120:123],a[152:155]
ds_read_b128 a[196:199],v5 offset:4096
v_add_f32 v16,v16,v50
v_mfma_f32_16x16x32_bf16 a[152:155],a[212:215],v[124:127],a[152:155]
buffer_load_dwordx4 v1,s[16:19],s24 offen offset:1024 sc1 lds
v_add_f32 v16,v16,v51
v_cvt_pk_bf16_f32 v71,v50,v51
v_mfma_f32_16x16x32_bf16 v[56:59],a[176:179],a[64:67],v[40:43]
v_exp_f32 v52,v52
v_mfma_f32_16x16x32_bf16 v[56:59],a[180:183],a[68:71],v[56:59]
v_exp_f32 v53,v53
v_mfma_f32_16x16x32_bf16 v[56:59],a[184:187],a[72:75],v[56:59]
ds_read_b128 a[168:171],v3 offset:34816
v_add_f32 v17,v17,v52
v_mfma_f32_16x16x32_bf16 v[56:59],a[188:191],a[76:79],v[56:59]
buffer_load_dwordx4 v1,s[16:19],s24 offen offset:2048 sc1 lds
v_add_f32 v17,v17,v53
v_cvt_pk_bf16_f32 v78,v52,v53
v_mfma_f32_16x16x32_bf16 v[156:159],a[216:219],v[96:99],v[156:159]
v_exp_f32 v54,v54
v_mfma_f32_16x16x32_bf16 v[156:159],a[220:223],v[100:103],v[156:159]
v_exp_f32 v55,v55
v_mfma_f32_16x16x32_bf16 v[188:191],a[216:219],v[104:107],v[188:191]
ds_read_b128 a[200:203],v5 offset:8192
v_add_f32 v17,v17,v54
v_mfma_f32_16x16x32_bf16 v[188:191],a[220:223],v[108:111],v[188:191]
buffer_load_dwordx4 v1,s[16:19],s24 offen offset:3072 sc1 lds
v_add_f32 v17,v17,v55
v_cvt_pk_bf16_f32 v79,v54,v55
v_mfma_f32_16x16x32_bf16 v[60:63],a[176:179],a[80:83],v[44:47]
s_add_u32 m0,s23,16384
v_exp_f32 v56,v56
v_mfma_f32_16x16x32_bf16 v[60:63],a[180:183],a[84:87],v[60:63]
s_sub_u32 s26,s26,1
v_exp_f32 v57,v57
v_mfma_f32_16x16x32_bf16 v[60:63],a[184:187],a[88:91],v[60:63]
s_add_u32 s24,s24,16384
ds_read_b128 a[172:175],v3 offset:35840
v_add_f32 v20,v20,v56
v_mfma_f32_16x16x32_bf16 v[60:63],a[188:191],a[92:95],v[60:63]
buffer_load_dwordx4 v1,s[16:19],s24 offen offset:0 sc1 lds
v_add_f32 v20,v20,v57
v_cvt_pk_bf16_f32 v86,v56,v57
v_mfma_f32_16x16x32_bf16 a[124:127],a[216:219],v[112:115],a[124:127]
s_cmp_lg_u32 s26,0
v_exp_f32 v58,v58
v_mfma_f32_16x16x32_bf16 a[124:127],a[220:223],v[116:119],a[124:127]
v_exp_f32 v59,v59
v_mfma_f32_16x16x32_bf16 a[156:159],a[216:219],v[120:123],a[156:159]
ds_read_b128 a[204:207],v5 offset:12288
v_add_f32 v20,v20,v58
v_mfma_f32_16x16x32_bf16 a[156:159],a[220:223],v[124:127],a[156:159]
buffer_load_dwordx4 v1,s[16:19],s24 offen offset:1024 sc1 lds
v_add_f32 v20,v20,v59
v_cvt_pk_bf16_f32 v87,v58,v59
s_cbranch_scc1 K2_L2
K2_TAIL:
s_bitcmp1_b32 s20,0
s_cbranch_scc1 K2_TAIL1
s_waitcnt lgkmcnt(7)
v_mfma_f32_16x16x32_bf16 v[48:51],a[160:163],a[0:3],v[24:27]
s_waitcnt lgkmcnt(5)
v_exp_f32 v60,v60
v_mfma_f32_16x16x32_bf16 v[48:51],a[164:167],a[4:7],v[48:51]
s_waitcnt lgkmcnt(1)
v_exp_f32 v61,v61
v_mfma_f32_16x16x32_bf16 v[48:51],a[168:171],a[8:11],v[48:51]
ds_read_b128 a[176:179],v3 offset:36864
v_add_f32 v21,v21,v60
v_mfma_f32_16x16x32_bf16 v[48:51],a[172:175],a[12:15],v[48:51]
buffer_load_dwordx4 v1,s[16:19],s24 offen offset:2048 sc1 lds
v_add_f32 v21,v21,v61
v_cvt_pk_bf16_f32 v94,v60,v61
v_mfma_f32_16x16x32_bf16 v[128:131],a[192:195],v[64:67],v[128:131]
v_exp_f32 v62,v62
v_mfma_f32_16x16x32_bf16 v[128:131],a[196:199],v[68:71],v[128:131]
v_exp_f32 v63,v63
v_mfma_f32_16x16x32_bf16 v[160:163],a[192:195],v[72:75],v[160:163]
ds_read_b128 a[208:211],v5 offset:1024
v_add_f32 v21,v21,v62
v_mfma_f32_16x16x32_bf16 v[160:163],a[196:199],v[76:79],v[160:163]
buffer_load_dwordx4 v1,s[16:19],s24 offen offset:3072 sc1 lds
v_add_f32 v21,v21,v63
v_cvt_pk_bf16_f32 v95,v62,v63
v_mfma_f32_16x16x32_bf16 v[52:55],a[160:163],a[16:19],v[28:31]
s_add_u32 m0,s23,98304
v_exp_f32 v48,v48
v_mfma_f32_16x16x32_bf16 v[52:55],a[164:167],a[20:23],v[52:55]
s_add_u32 s25,s25,16384
v_exp_f32 v49,v49
v_mfma_f32_16x16x32_bf16 v[52:55],a[168:171],a[24:27],v[52:55]
ds_read_b128 a[180:183],v3 offset:37888
v_add_f32 v16,v16,v48
v_mfma_f32_16x16x32_bf16 v[52:55],a[172:175],a[28:31],v[52:55]
buffer_load_dwordx4 v1,s[16:19],s25 offen offset:0 sc1 lds
v_add_f32 v16,v16,v49
v_cvt_pk_bf16_f32 v96,v48,v49
v_mfma_f32_16x16x32_bf16 a[96:99],a[192:195],v[80:83],a[96:99]
v_exp_f32 v50,v50
v_mfma_f32_16x16x32_bf16 a[96:99],a[196:199],v[84:87],a[96:99]
v_exp_f32 v51,v51
v_mfma_f32_16x16x32_bf16 a[128:131],a[192:195],v[88:91],a[128:131]
ds_read_b128 a[212:215],v5 offset:5120
v_add_f32 v16,v16,v50
v_mfma_f32_16x16x32_bf16 a[128:131],a[196:199],v[92:95],a[128:131]
buffer_load_dwordx4 v1,s[16:19],s25 offen offset:1024 sc1 lds
v_add_f32 v16,v16,v51
v_cvt_pk_bf16_f32 v97,v50,v51
v_mfma_f32_16x16x32_bf16 v[56:59],a[160:163],a[64:67],v[40:43]
v_exp_f32 v52,v52
v_mfma_f32_16x16x32_bf16 v[56:59],a[164:167],a[68:71],v[56:59]
v_exp_f32 v53,v53
v_mfma_f32_16x16x32_bf16 v[56:59],a[168:171],a[72:75],v[56:59]
ds_read_b128 a[184:187],v3 offset:38912
v_add_f32 v17,v17,v52
v_mfma_f32_16x16x32_bf16 v[56:59],a[172:175],a[76:79],v[56:59]
buffer_load_dwordx4 v1,s[16:19],s25 offen offset:2048 sc1 lds
v_add_f32 v17,v17,v53
v_cvt_pk_bf16_f32 v104,v52,v53
v_mfma_f32_16x16x32_bf16 v[132:135],a[200:203],v[64:67],v[132:135]
s_and_b32 s28,s20,1
v_exp_f32 v54,v54
s_waitcnt lgkmcnt(5)
v_mfma_f32_16x16x32_bf16 v[132:135],a[204:207],v[68:71],v[132:135]
s_lshl_b32 s28,s28,14
v_exp_f32 v55,v55
v_mfma_f32_16x16x32_bf16 v[164:167],a[200:203],v[72:75],v[164:167]
ds_read_b128 a[216:219],v5 offset:9216
v_add_f32 v17,v17,v54
v_mfma_f32_16x16x32_bf16 v[164:167],a[204:207],v[76:79],v[164:167]
buffer_load_dwordx4 v1,s[16:19],s25 offen offset:3072 sc1 lds
v_add_f32 v17,v17,v55
v_cvt_pk_bf16_f32 v105,v54,v55
v_mfma_f32_16x16x32_bf16 v[60:63],a[160:163],a[80:83],v[44:47]
s_lshr_b32 s4,s20,1
v_exp_f32 v56,v56
v_mfma_f32_16x16x32_bf16 v[60:63],a[164:167],a[84:87],v[60:63]
s_add_u32 m0,s23,114688
v_exp_f32 v57,v57
v_mfma_f32_16x16x32_bf16 v[60:63],a[168:171],a[88:91],v[60:63]
s_lshl_b32 s4,s4,13
s_add_u32 s25,s25,16384
ds_read_b128 a[188:191],v3 offset:39936
v_add_f32 v20,v20,v56
v_mfma_f32_16x16x32_bf16 v[60:63],a[172:175],a[92:95],v[60:63]
buffer_load_dwordx4 v1,s[16:19],s25 offen offset:0 sc1 lds
v_add_f32 v20,v20,v57
v_cvt_pk_bf16_f32 v112,v56,v57
v_mfma_f32_16x16x32_bf16 a[100:103],a[200:203],v[80:83],a[100:103]
s_add_u32 s4,s4,s28
v_exp_f32 v58,v58
v_mfma_f32_16x16x32_bf16 a[100:103],a[204:207],v[84:87],a[100:103]
s_lshl_b32 s6,s21,17
v_exp_f32 v59,v59
v_mfma_f32_16x16x32_bf16 a[132:135],a[200:203],v[88:91],a[132:135]
ds_read_b128 a[220:223],v5 offset:13312
v_add_f32 v20,v20,v58
v_mfma_f32_16x16x32_bf16 a[132:135],a[204:207],v[92:95],a[132:135]
buffer_load_dwordx4 v1,s[16:19],s25 offen offset:1024 sc1 lds
v_add_f32 v20,v20,v59
v_cvt_pk_bf16_f32 v113,v58,v59
s_waitcnt lgkmcnt(7)
v_mfma_f32_16x16x32_bf16 v[48:51],a[176:179],a[0:3],v[24:27]
s_add_u32 s28,s21,1
v_exp_f32 v60,v60
s_waitcnt lgkmcnt(5)
v_mfma_f32_16x16x32_bf16 v[48:51],a[180:183],a[4:7],v[48:51]
s_and_b32 s28,s28,3
v_exp_f32 v61,v61
s_waitcnt lgkmcnt(3)
v_mfma_f32_16x16x32_bf16 v[48:51],a[184:187],a[8:11],v[48:51]
ds_read_b128 a[160:163],v3 offset:40960
v_add_f32 v21,v21,v60
s_waitcnt lgkmcnt(2)
v_mfma_f32_16x16x32_bf16 v[48:51],a[188:191],a[12:15],v[48:51]
buffer_load_dwordx4 v1,s[16:19],s25 offen offset:2048 sc1 lds
v_add_f32 v21,v21,v61
v_cvt_pk_bf16_f32 v120,v60,v61
v_mfma_f32_16x16x32_bf16 v[136:139],a[208:211],v[64:67],v[136:139]
s_and_b32 s7,s21,28
v_exp_f32 v62,v62
v_mfma_f32_16x16x32_bf16 v[136:139],a[212:215],v[68:71],v[136:139]
s_add_u32 s7,s7,s28
v_exp_f32 v63,v63
v_mfma_f32_16x16x32_bf16 v[168:171],a[208:211],v[72:75],v[168:171]
ds_read_b128 a[192:195],v5 offset:2048
v_add_f32 v21,v21,v62
v_mfma_f32_16x16x32_bf16 v[168:171],a[212:215],v[76:79],v[168:171]
buffer_load_dwordx4 v1,s[16:19],s25 offen offset:3072 sc1 lds
v_add_f32 v21,v21,v63
v_cvt_pk_bf16_f32 v121,v62,v63
v_mfma_f32_16x16x32_bf16 v[52:55],a[176:179],a[16:19],v[28:31]
s_waitcnt vmcnt(10)
v_mov_b32 v11,s100
s_lshl_b32 s7,s7,17
v_exp_f32 v48,v48
v_mfma_f32_16x16x32_bf16 v[52:55],a[180:183],a[20:23],v[52:55]
v_exp_f32 v49,v49
v_mfma_f32_16x16x32_bf16 v[52:55],a[184:187],a[24:27],v[52:55]
s_getpc_b64 s[30:31]
F_W4:
s_sub_u32 s30,s30,F_W4-F_PC
s_subb_u32 s31,s31,0
v_accvgpr_read_b32 v9,a251
global_load_dword a249,v9,s[30:31]
ds_read_b128 a[164:167],v3 offset:41984
v_add_f32 v16,v16,v48
v_mfma_f32_16x16x32_bf16 v[52:55],a[188:191],a[28:31],v[52:55]
buffer_store_dword v11,v10,s[16:19],s99 offen sc1
v_add_f32 v16,v16,v49
v_cvt_pk_bf16_f32 v98,v48,v49
v_mfma_f32_16x16x32_bf16 a[104:107],a[208:211],v[80:83],a[104:107]
v_accvgpr_read_b32 v0,a248
v_exp_f32 v50,v50
v_mfma_f32_16x16x32_bf16 a[104:107],a[212:215],v[84:87],a[104:107]
s_add_u32 m0,s4,131072
v_exp_f32 v51,v51
v_mfma_f32_16x16x32_bf16 a[136:139],a[208:211],v[88:91],a[136:139]
s_add_u32 s5,s6,0
ds_read_b128 a[196:199],v5 offset:6144
v_add_f32 v16,v16,v50
v_mfma_f32_16x16x32_bf16 a[136:139],a[212:215],v[92:95],a[136:139]
buffer_load_dwordx4 v0,s[12:15],s5 offen lds
v_add_f32 v16,v16,v51
v_cvt_pk_bf16_f32 v99,v50,v51
v_mfma_f32_16x16x32_bf16 v[56:59],a[176:179],a[64:67],v[40:43]
s_add_u32 m0,s4,132096
v_exp_f32 v52,v52
v_mfma_f32_16x16x32_bf16 v[56:59],a[180:183],a[68:71],v[56:59]
s_add_u32 s5,s6,8192
v_exp_f32 v53,v53
v_mfma_f32_16x16x32_bf16 v[56:59],a[184:187],a[72:75],v[56:59]
ds_read_b128 a[168:171],v3 offset:43008
v_add_f32 v17,v17,v52
v_mfma_f32_16x16x32_bf16 v[56:59],a[188:191],a[76:79],v[56:59]
buffer_load_dwordx4 v0,s[12:15],s5 offen lds
v_add_f32 v17,v17,v53
v_cvt_pk_bf16_f32 v106,v52,v53
v_mfma_f32_16x16x32_bf16 v[140:143],a[216:219],v[64:67],v[140:143]
s_add_u32 m0,s4,133120
v_exp_f32 v54,v54
s_waitcnt lgkmcnt(5)
v_mfma_f32_16x16x32_bf16 v[140:143],a[220:223],v[68:71],v[140:143]
s_add_u32 s5,s6,16384
v_exp_f32 v55,v55
v_mfma_f32_16x16x32_bf16 v[172:175],a[216:219],v[72:75],v[172:175]
ds_read_b128 a[200:203],v5 offset:10240
v_add_f32 v17,v17,v54
v_mfma_f32_16x16x32_bf16 v[172:175],a[220:223],v[76:79],v[172:175]
buffer_load_dwordx4 v0,s[12:15],s5 offen lds
v_add_f32 v17,v17,v55
v_cvt_pk_bf16_f32 v107,v54,v55
v_mfma_f32_16x16x32_bf16 v[60:63],a[176:179],a[80:83],v[44:47]
s_add_u32 m0,s4,134144
v_exp_f32 v56,v56
v_mfma_f32_16x16x32_bf16 v[60:63],a[180:183],a[84:87],v[60:63]
s_add_u32 s5,s6,24576
v_exp_f32 v57,v57
v_mfma_f32_16x16x32_bf16 v[60:63],a[184:187],a[88:91],v[60:63]
ds_read_b128 a[172:175],v3 offset:44032
v_add_f32 v20,v20,v56
v_mfma_f32_16x16x32_bf16 v[60:63],a[188:191],a[92:95],v[60:63]
buffer_load_dwordx4 v0,s[12:15],s5 offen lds
v_add_f32 v20,v20,v57
v_cvt_pk_bf16_f32 v114,v56,v57
v_mfma_f32_16x16x32_bf16 a[108:111],a[216:219],v[80:83],a[108:111]
s_add_u32 m0,s4,135168
v_exp_f32 v58,v58
v_mfma_f32_16x16x32_bf16 a[108:111],a[220:223],v[84:87],a[108:111]
s_add_u32 s5,s6,32768
v_exp_f32 v59,v59
v_mfma_f32_16x16x32_bf16 a[140:143],a[216:219],v[88:91],a[140:143]
ds_read_b128 a[204:207],v5 offset:14336
v_add_f32 v20,v20,v58
v_mfma_f32_16x16x32_bf16 a[140:143],a[220:223],v[92:95],a[140:143]
buffer_load_dwordx4 v0,s[12:15],s5 offen lds
v_add_f32 v20,v20,v59
v_cvt_pk_bf16_f32 v115,v58,v59
s_waitcnt lgkmcnt(7)
v_mfma_f32_16x16x32_bf16 v[48:51],a[160:163],a[0:3],v[24:27]
s_add_u32 m0,s4,136192
v_exp_f32 v60,v60
s_waitcnt lgkmcnt(5)
v_mfma_f32_16x16x32_bf16 v[48:51],a[164:167],a[4:7],v[48:51]
s_add_u32 s5,s6,40960
v_exp_f32 v61,v61
s_waitcnt lgkmcnt(3)
v_mfma_f32_16x16x32_bf16 v[48:51],a[168:171],a[8:11],v[48:51]
ds_read_b128 a[176:179],v3 offset:45056
v_add_f32 v21,v21,v60
s_waitcnt lgkmcnt(2)
v_mfma_f32_16x16x32_bf16 v[48:51],a[172:175],a[12:15],v[48:51]
buffer_load_dwordx4 v0,s[12:15],s5 offen lds
v_add_f32 v21,v21,v61
v_cvt_pk_bf16_f32 v122,v60,v61
v_mfma_f32_16x16x32_bf16 v[144:147],a[192:195],v[64:67],v[144:147]
s_add_u32 m0,s4,137216
v_exp_f32 v62,v62
v_mfma_f32_16x16x32_bf16 v[144:147],a[196:199],v[68:71],v[144:147]
s_add_u32 s5,s6,49152
v_exp_f32 v63,v63
v_mfma_f32_16x16x32_bf16 v[176:179],a[192:195],v[72:75],v[176:179]
ds_read_b128 a[208:211],v5 offset:3072
v_add_f32 v21,v21,v62
v_mfma_f32_16x16x32_bf16 v[176:179],a[196:199],v[76:79],v[176:179]
buffer_load_dwordx4 v0,s[12:15],s5 offen lds
v_add_f32 v21,v21,v63
v_cvt_pk_bf16_f32 v123,v62,v63
v_mfma_f32_16x16x32_bf16 v[52:55],a[160:163],a[16:19],v[28:31]
s_add_u32 m0,s4,138240
v_exp_f32 v48,v48
v_mfma_f32_16x16x32_bf16 v[52:55],a[164:167],a[20:23],v[52:55]
s_add_u32 s5,s6,57344
v_exp_f32 v49,v49
v_mfma_f32_16x16x32_bf16 v[52:55],a[168:171],a[24:27],v[52:55]
ds_read_b128 a[180:183],v3 offset:46080
v_add_f32 v16,v16,v48
v_mfma_f32_16x16x32_bf16 v[52:55],a[172:175],a[28:31],v[52:55]
buffer_load_dwordx4 v0,s[12:15],s5 offen lds
v_add_f32 v16,v16,v49
v_cvt_pk_bf16_f32 v100,v48,v49
v_mfma_f32_16x16x32_bf16 a[112:115],a[192:195],v[80:83],a[112:115]
v_exp_f32 v50,v50
v_mfma_f32_16x16x32_bf16 a[112:115],a[196:199],v[84:87],a[112:115]
v_exp_f32 v51,v51
v_mfma_f32_16x16x32_bf16 a[144:147],a[192:195],v[88:91],a[144:147]
ds_read_b128 a[212:215],v5 offset:7168
v_add_f32 v16,v16,v50
v_mfma_f32_16x16x32_bf16 a[144:147],a[196:199],v[92:95],a[144:147]
v_add_f32 v16,v16,v51
v_cvt_pk_bf16_f32 v101,v50,v51
v_mfma_f32_16x16x32_bf16 v[56:59],a[160:163],a[64:67],v[40:43]
s_and_b32 s44,s99,0xfffffe7f
v_exp_f32 v52,v52
v_mfma_f32_16x16x32_bf16 v[56:59],a[164:167],a[68:71],v[56:59]
s_add_u32 s28,s21,1
v_exp_f32 v53,v53
v_mfma_f32_16x16x32_bf16 v[56:59],a[168:171],a[72:75],v[56:59]
ds_read_b128 a[184:187],v3 offset:47104
v_add_f32 v17,v17,v52
v_mfma_f32_16x16x32_bf16 v[56:59],a[172:175],a[76:79],v[56:59]
s_and_b32 s28,s28,3
v_add_f32 v17,v17,v53
v_cvt_pk_bf16_f32 v108,v52,v53
v_mfma_f32_16x16x32_bf16 v[148:151],a[200:203],v[64:67],v[148:151]
s_and_b32 s29,s21,3
v_exp_f32 v54,v54
s_waitcnt lgkmcnt(5)
v_mfma_f32_16x16x32_bf16 v[148:151],a[204:207],v[68:71],v[148:151]
s_sub_u32 s28,s28,s29
v_exp_f32 v55,v55
v_mfma_f32_16x16x32_bf16 v[180:183],a[200:203],v[72:75],v[180:183]
s_lshl_b32 s28,s28,12
ds_read_b128 a[216:219],v5 offset:11264
v_add_f32 v17,v17,v54
v_mfma_f32_16x16x32_bf16 v[180:183],a[204:207],v[76:79],v[180:183]
s_add_u32 s38,s88,s28
v_add_f32 v17,v17,v55
v_cvt_pk_bf16_f32 v109,v54,v55
v_mfma_f32_16x16x32_bf16 v[60:63],a[160:163],a[80:83],v[44:47]
s_add_u32 s41,s89,s28
v_exp_f32 v56,v56
v_mfma_f32_16x16x32_bf16 v[60:63],a[164:167],a[84:87],v[60:63]
s_add_u32 s28,s21,2
v_exp_f32 v57,v57
v_mfma_f32_16x16x32_bf16 v[60:63],a[168:171],a[88:91],v[60:63]
s_and_b32 s28,s28,3
ds_read_b128 a[188:191],v3 offset:48128
v_add_f32 v20,v20,v56
v_mfma_f32_16x16x32_bf16 v[60:63],a[172:175],a[92:95],v[60:63]
s_and_b32 s29,s21,3
v_add_f32 v20,v20,v57
v_cvt_pk_bf16_f32 v116,v56,v57
v_mfma_f32_16x16x32_bf16 a[116:119],a[200:203],v[80:83],a[116:119]
s_sub_u32 s28,s28,s29
v_exp_f32 v58,v58
v_mfma_f32_16x16x32_bf16 a[116:119],a[204:207],v[84:87],a[116:119]
s_lshl_b32 s28,s28,12
v_exp_f32 v59,v59
v_mfma_f32_16x16x32_bf16 a[148:151],a[200:203],v[88:91],a[148:151]
s_add_u32 s39,s88,s28
ds_read_b128 a[220:223],v5 offset:15360
v_add_f32 v20,v20,v58
v_mfma_f32_16x16x32_bf16 a[148:151],a[204:207],v[92:95],a[148:151]
s_add_u32 s42,s89,s28
v_add_f32 v20,v20,v59
v_cvt_pk_bf16_f32 v117,v58,v59
s_waitcnt lgkmcnt(7)
v_mfma_f32_16x16x32_bf16 v[48:51],a[176:179],a[0:3],v[24:27]
s_add_u32 s28,s21,3
v_exp_f32 v60,v60
s_waitcnt lgkmcnt(5)
v_mfma_f32_16x16x32_bf16 v[48:51],a[180:183],a[4:7],v[48:51]
s_and_b32 s28,s28,3
v_exp_f32 v61,v61
s_waitcnt lgkmcnt(3)
v_mfma_f32_16x16x32_bf16 v[48:51],a[184:187],a[8:11],v[48:51]
s_and_b32 s29,s21,3
v_add_f32 v21,v21,v60
v_add_f32 v21,v21,v61
s_waitcnt lgkmcnt(1)
v_mfma_f32_16x16x32_bf16 v[48:51],a[188:191],a[12:15],v[48:51]
s_sub_u32 s28,s28,s29
v_exp_f32 v62,v62
v_mfma_f32_16x16x32_bf16 v[152:155],a[208:211],v[64:67],v[152:155]
s_waitcnt vmcnt(10) lgkmcnt(0)
s_lshl_b32 s28,s28,12
v_exp_f32 v63,v63
v_mfma_f32_16x16x32_bf16 v[152:155],a[212:215],v[68:71],v[152:155]
s_barrier
s_add_u32 s40,s88,s28
v_cvt_pk_bf16_f32 v124,v60,v61
v_add_f32 v21,v21,v62
v_mfma_f32_16x16x32_bf16 v[184:187],a[208:211],v[72:75],v[184:187]
s_add_u32 s43,s89,s28
ds_read_b128 a[160:163],v2 offset:0
v_add_f32 v21,v21,v63
v_mfma_f32_16x16x32_bf16 v[184:187],a[212:215],v[76:79],v[184:187]
ds_read_b128 a[192:195],v5 offset:32768
v_cvt_pk_bf16_f32 v125,v62,v63
v_mfma_f32_16x16x32_bf16 v[52:55],a[176:179],a[16:19],v[28:31]
s_add_u32 m0,s23,65536
v_exp_f32 v48,v48
v_mfma_f32_16x16x32_bf16 v[52:55],a[180:183],a[20:23],v[52:55]
s_add_u32 s25,s25,16384
v_exp_f32 v49,v49
v_mfma_f32_16x16x32_bf16 v[52:55],a[184:187],a[24:27],v[52:55]
ds_read_b128 a[164:167],v2 offset:1024
v_add_f32 v16,v16,v48
v_mfma_f32_16x16x32_bf16 v[52:55],a[188:191],a[28:31],v[52:55]
buffer_load_dwordx4 v1,s[16:19],s25 offen offset:0 sc1 lds
v_add_f32 v16,v16,v49
v_cvt_pk_bf16_f32 v102,v48,v49
v_mfma_f32_16x16x32_bf16 a[120:123],a[208:211],v[80:83],a[120:123]
v_exp_f32 v50,v50
v_mfma_f32_16x16x32_bf16 a[120:123],a[212:215],v[84:87],a[120:123]
v_exp_f32 v51,v51
v_mfma_f32_16x16x32_bf16 a[152:155],a[208:211],v[88:91],a[152:155]
ds_read_b128 a[196:199],v5 offset:36864
v_add_f32 v16,v16,v50
v_mfma_f32_16x16x32_bf16 a[152:155],a[212:215],v[92:95],a[152:155]
buffer_load_dwordx4 v1,s[16:19],s25 offen offset:1024 sc1 lds
v_add_f32 v16,v16,v51
v_cvt_pk_bf16_f32 v103,v50,v51
v_mfma_f32_16x16x32_bf16 v[56:59],a[176:179],a[64:67],v[40:43]
v_exp_f32 v52,v52
v_mfma_f32_16x16x32_bf16 v[56:59],a[180:183],a[68:71],v[56:59]
v_exp_f32 v53,v53
v_mfma_f32_16x16x32_bf16 v[56:59],a[184:187],a[72:75],v[56:59]
ds_read_b128 a[168:171],v2 offset:2048
v_add_f32 v17,v17,v52
v_mfma_f32_16x16x32_bf16 v[56:59],a[188:191],a[76:79],v[56:59]
buffer_load_dwordx4 v1,s[16:19],s25 offen offset:2048 sc1 lds
v_add_f32 v17,v17,v53
v_cvt_pk_bf16_f32 v110,v52,v53
v_mfma_f32_16x16x32_bf16 v[156:159],a[216:219],v[64:67],v[156:159]
v_exp_f32 v54,v54
v_mfma_f32_16x16x32_bf16 v[156:159],a[220:223],v[68:71],v[156:159]
v_exp_f32 v55,v55
v_mfma_f32_16x16x32_bf16 v[188:191],a[216:219],v[72:75],v[188:191]
ds_read_b128 a[200:203],v5 offset:40960
v_add_f32 v17,v17,v54
v_mfma_f32_16x16x32_bf16 v[188:191],a[220:223],v[76:79],v[188:191]
buffer_load_dwordx4 v1,s[16:19],s25 offen offset:3072 sc1 lds
v_add_f32 v17,v17,v55
v_cvt_pk_bf16_f32 v111,v54,v55
v_mfma_f32_16x16x32_bf16 v[60:63],a[176:179],a[80:83],v[44:47]
s_add_u32 m0,s23,81920
v_exp_f32 v56,v56
v_mfma_f32_16x16x32_bf16 v[60:63],a[180:183],a[84:87],v[60:63]
s_add_u32 s25,s25,16384
v_exp_f32 v57,v57
v_mfma_f32_16x16x32_bf16 v[60:63],a[184:187],a[88:91],v[60:63]
ds_read_b128 a[172:175],v2 offset:3072
v_add_f32 v20,v20,v56
v_mfma_f32_16x16x32_bf16 v[60:63],a[188:191],a[92:95],v[60:63]
buffer_load_dwordx4 v1,s[16:19],s25 offen offset:0 sc1 lds
v_add_f32 v20,v20,v57
v_cvt_pk_bf16_f32 v118,v56,v57
v_mfma_f32_16x16x32_bf16 a[124:127],a[216:219],v[80:83],a[124:127]
v_exp_f32 v58,v58
v_mfma_f32_16x16x32_bf16 a[124:127],a[220:223],v[84:87],a[124:127]
s_waitcnt lgkmcnt(6)
v_exp_f32 v59,v59
v_mfma_f32_16x16x32_bf16 a[156:159],a[216:219],v[88:91],a[156:159]
ds_read_b128 a[204:207],v5 offset:45056
v_add_f32 v20,v20,v58
v_mfma_f32_16x16x32_bf16 a[156:159],a[220:223],v[92:95],a[156:159]
buffer_load_dwordx4 v1,s[16:19],s25 offen offset:1024 sc1 lds
v_add_f32 v20,v20,v59
v_cvt_pk_bf16_f32 v119,v58,v59
v_mfma_f32_16x16x32_bf16 v[56:59],a[160:163],a[80:83],v[44:47]
s_waitcnt lgkmcnt(3)
v_exp_f32 v60,v60
v_mfma_f32_16x16x32_bf16 v[56:59],a[164:167],a[84:87],v[56:59]
ds_read_b128 a[176:179],v2 offset:4096
v_exp_f32 v61,v61
v_mfma_f32_16x16x32_bf16 v[56:59],a[168:171],a[88:91],v[56:59]
s_waitcnt lgkmcnt(2)
v_add_f32 v21,v21,v60
v_mfma_f32_16x16x32_bf16 v[56:59],a[172:175],a[92:95],v[56:59]
buffer_load_dwordx4 v1,s[16:19],s25 offen offset:2048 sc1 lds
v_add_f32 v21,v21,v61
v_cvt_pk_bf16_f32 v126,v60,v61
v_mfma_f32_16x16x32_bf16 v[128:131],a[192:195],v[96:99],v[128:131]
v_exp_f32 v62,v62
v_mfma_f32_16x16x32_bf16 v[128:131],a[196:199],v[100:103],v[128:131]
ds_read_b128 a[208:211],v5 offset:33792
v_exp_f32 v63,v63
v_mfma_f32_16x16x32_bf16 v[160:163],a[192:195],v[104:107],v[160:163]
v_add_f32 v21,v21,v62
v_mfma_f32_16x16x32_bf16 v[160:163],a[196:199],v[108:111],v[160:163]
buffer_load_dwordx4 v1,s[16:19],s25 offen offset:3072 sc1 lds
v_add_f32 v21,v21,v63
v_cvt_pk_bf16_f32 v127,v62,v63
v_mfma_f32_16x16x32_bf16 a[96:99],a[192:195],v[112:115],a[96:99]
v_exp_f32 v56,v56
v_mfma_f32_16x16x32_bf16 a[96:99],a[196:199],v[116:119],a[96:99]
v_exp_f32 v57,v57
v_mfma_f32_16x16x32_bf16 v[60:63],a[160:163],a[64:67],v[40:43]
ds_read_b128 a[180:183],v2 offset:5120
v_add_f32 v21,v21,v56
v_mfma_f32_16x16x32_bf16 v[60:63],a[164:167],a[68:71],v[60:63]
ds_read_b128 a[212:215],v5 offset:37888
v_add_f32 v21,v21,v57
v_mfma_f32_16x16x32_bf16 v[60:63],a[168:171],a[72:75],v[60:63]
s_add_u32 m0,s4,32768
v_cvt_pk_bf16_f32 v88,v56,v57
v_mfma_f32_16x16x32_bf16 v[60:63],a[172:175],a[76:79],v[60:63]
s_add_u32 s5,s7,0
v_exp_f32 v58,v58
v_mfma_f32_16x16x32_bf16 a[128:131],a[192:195],v[120:123],a[128:131]
s_waitcnt lgkmcnt(4)
v_exp_f32 v59,v59
v_mfma_f32_16x16x32_bf16 a[128:131],a[196:199],v[124:127],a[128:131]
buffer_load_dwordx4 v0,s[12:15],s5 offen lds
v_mfma_f32_16x16x32_bf16 v[132:135],a[200:203],v[96:99],v[132:135]
s_add_u32 m0,s4,33792
v_add_f32 v21,v21,v58
v_add_f32 v21,v21,v59
v_mfma_f32_16x16x32_bf16 v[132:135],a[204:207],v[100:103],v[132:135]
ds_read_b128 a[216:219],v5 offset:41984
v_cvt_pk_bf16_f32 v89,v58,v59
v_mfma_f32_16x16x32_bf16 v[164:167],a[200:203],v[104:107],v[164:167]
s_add_u32 s5,s7,8192
v_cndmask_b32 v52,v6,v24,s[64:65]
v_cndmask_b32 v53,v6,v24,s[66:67]
v_cndmask_b32 v54,v6,v24,s[68:69]
v_cndmask_b32 v55,v6,v24,s[70:71]
v_exp_f32 v60,v60
v_mfma_f32_16x16x32_bf16 v[164:167],a[204:207],v[108:111],v[164:167]
ds_read_b128 a[184:187],v2 offset:6144
buffer_load_dwordx4 v0,s[12:15],s5 offen lds
v_exp_f32 v61,v61
v_mfma_f32_16x16x32_bf16 v[48:51],a[160:163],a[16:19],v[28:31]
s_add_u32 m0,s4,34816
v_add_f32 v20,v20,v60
v_add_f32 v20,v20,v61
v_mfma_f32_16x16x32_bf16 v[48:51],a[164:167],a[20:23],v[48:51]
s_add_u32 s5,s7,16384
v_cvt_pk_bf16_f32 v80,v60,v61
v_mfma_f32_16x16x32_bf16 v[48:51],a[168:171],a[24:27],v[48:51]
v_exp_f32 v62,v62
v_mfma_f32_16x16x32_bf16 v[48:51],a[172:175],a[28:31],v[48:51]
ds_read_b128 a[220:223],v5 offset:46080
buffer_load_dwordx4 v0,s[12:15],s5 offen lds
v_mfma_f32_16x16x32_bf16 a[100:103],a[200:203],v[112:115],a[100:103]
s_add_u32 m0,s4,35840
v_exp_f32 v63,v63
v_mfma_f32_16x16x32_bf16 a[100:103],a[204:207],v[116:119],a[100:103]
s_add_u32 s5,s7,24576
v_add_f32 v20,v20,v62
v_add_f32 v20,v20,v63
v_mfma_f32_16x16x32_bf16 a[132:135],a[200:203],v[120:123],a[132:135]
s_waitcnt lgkmcnt(3)
v_cvt_pk_bf16_f32 v81,v62,v63
v_mfma_f32_16x16x32_bf16 a[132:135],a[204:207],v[124:127],a[132:135]
ds_read_b128 a[188:191],v2 offset:7168
buffer_load_dwordx4 v0,s[12:15],s5 offen lds
v_mfma_f32_16x16x32_bf16 v[136:139],a[208:211],v[96:99],v[136:139]
s_add_u32 m0,s4,36864
v_exp_f32 v48,v48
v_mfma_f32_16x16x32_bf16 v[136:139],a[212:215],v[100:103],v[136:139]
ds_read_b128 a[192:195],v5 offset:34816
v_exp_f32 v49,v49
v_mfma_f32_16x16x32_bf16 v[52:55],a[160:163],a[0:3],v[52:55]
s_add_u32 s5,s7,32768
v_add_f32 v17,v17,v48
v_add_f32 v17,v17,v49
v_mfma_f32_16x16x32_bf16 v[52:55],a[164:167],a[4:7],v[52:55]
v_lshrrev_b32 v8,4,v7
buffer_load_dwordx4 v0,s[12:15],s5 offen lds
v_mfma_f32_16x16x32_bf16 v[52:55],a[168:171],a[8:11],v[52:55]
v_lshlrev_b32 v8,7,v8
v_cvt_pk_bf16_f32 v72,v48,v49
v_mfma_f32_16x16x32_bf16 v[52:55],a[172:175],a[12:15],v[52:55]
s_add_u32 m0,s4,37888
v_exp_f32 v50,v50
v_mfma_f32_16x16x32_bf16 v[168:171],a[208:211],v[104:107],v[168:171]
s_add_u32 s5,s7,40960
ds_read_b128 a[160:163],v2 offset:24576
buffer_load_dword v9,v8,s[16:19],s44 offen sc1
v_exp_f32 v51,v51
v_mfma_f32_16x16x32_bf16 v[168:171],a[212:215],v[108:111],v[168:171]
buffer_load_dwordx4 v0,s[12:15],s5 offen lds
v_mfma_f32_16x16x32_bf16 a[104:107],a[208:211],v[112:115],a[104:107]
s_add_u32 m0,s4,38912
v_add_f32 v17,v17,v50
v_add_f32 v17,v17,v51
v_mfma_f32_16x16x32_bf16 a[104:107],a[212:215],v[116:119],a[104:107]
ds_read_b128 a[196:199],v5 offset:38912
v_cvt_pk_bf16_f32 v73,v50,v51
v_mfma_f32_16x16x32_bf16 a[136:139],a[208:211],v[120:123],a[136:139]
s_add_u32 s5,s7,49152
v_exp_f32 v52,v52
v_mfma_f32_16x16x32_bf16 a[136:139],a[212:215],v[124:127],a[136:139]
buffer_load_dwordx4 v0,s[12:15],s5 offen lds
v_exp_f32 v53,v53
v_mfma_f32_16x16x32_bf16 v[56:59],a[176:179],a[80:83],v[44:47]
v_add_f32 v16,v16,v52
v_add_f32 v16,v16,v53
v_mfma_f32_16x16x32_bf16 v[56:59],a[180:183],a[84:87],v[56:59]
s_waitcnt lgkmcnt(5)
v_cvt_pk_bf16_f32 v64,v52,v53
v_mfma_f32_16x16x32_bf16 v[56:59],a[184:187],a[88:91],v[56:59]
s_waitcnt lgkmcnt(3)
v_exp_f32 v54,v54
v_mfma_f32_16x16x32_bf16 v[56:59],a[188:191],a[92:95],v[56:59]
v_exp_f32 v55,v55
v_mfma_f32_16x16x32_bf16 v[140:143],a[216:219],v[96:99],v[140:143]
ds_read_b128 a[164:167],v2 offset:25600
v_add_f32 v16,v16,v54
v_mfma_f32_16x16x32_bf16 v[140:143],a[220:223],v[100:103],v[140:143]
ds_read_b128 a[200:203],v5 offset:43008
v_add_f32 v16,v16,v55
v_mfma_f32_16x16x32_bf16 v[172:175],a[216:219],v[104:107],v[172:175]
v_cvt_pk_bf16_f32 v65,v54,v55
v_mfma_f32_16x16x32_bf16 v[172:175],a[220:223],v[108:111],v[172:175]
v_mfma_f32_16x16x32_bf16 a[108:111],a[216:219],v[112:115],a[108:111]
v_exp_f32 v56,v56
v_mfma_f32_16x16x32_bf16 a[108:111],a[220:223],v[116:119],a[108:111]
v_exp_f32 v57,v57
v_mfma_f32_16x16x32_bf16 v[60:63],a[176:179],a[64:67],v[40:43]
ds_read_b128 a[204:207],v5 offset:47104
v_add_f32 v21,v21,v56
v_mfma_f32_16x16x32_bf16 v[60:63],a[180:183],a[68:71],v[60:63]
v_add_f32 v21,v21,v57
v_cvt_pk_bf16_f32 v90,v56,v57
v_mfma_f32_16x16x32_bf16 v[60:63],a[184:187],a[72:75],v[60:63]
v_exp_f32 v58,v58
v_mfma_f32_16x16x32_bf16 v[60:63],a[188:191],a[76:79],v[60:63]
v_exp_f32 v59,v59
v_mfma_f32_16x16x32_bf16 a[140:143],a[216:219],v[120:123],a[140:143]
s_waitcnt lgkmcnt(3)
v_add_f32 v21,v21,v58
v_add_f32 v21,v21,v59
v_mfma_f32_16x16x32_bf16 a[140:143],a[220:223],v[124:127],a[140:143]
ds_read_b128 a[168:171],v2 offset:26624
v_cvt_pk_bf16_f32 v91,v58,v59
v_mfma_f32_16x16x32_bf16 v[144:147],a[192:195],v[96:99],v[144:147]
ds_read_b128 a[208:211],v5 offset:35840
v_mfma_f32_16x16x32_bf16 v[144:147],a[196:199],v[100:103],v[144:147]
v_mfma_f32_16x16x32_bf16 v[176:179],a[192:195],v[104:107],v[176:179]
v_cndmask_b32 v52,v6,v24,s[72:73]
v_cndmask_b32 v53,v6,v24,s[74:75]
v_cndmask_b32 v54,v6,v24,s[76:77]
v_cndmask_b32 v55,v6,v24,s[78:79]
v_exp_f32 v60,v60
v_mfma_f32_16x16x32_bf16 v[176:179],a[196:199],v[108:111],v[176:179]
v_exp_f32 v61,v61
v_mfma_f32_16x16x32_bf16 v[48:51],a[176:179],a[16:19],v[28:31]
v_add_f32 v20,v20,v60
v_add_f32 v20,v20,v61
v_mfma_f32_16x16x32_bf16 v[48:51],a[180:183],a[20:23],v[48:51]
v_cvt_pk_bf16_f32 v82,v60,v61
v_mfma_f32_16x16x32_bf16 v[48:51],a[184:187],a[24:27],v[48:51]
v_exp_f32 v62,v62
v_mfma_f32_16x16x32_bf16 v[48:51],a[188:191],a[28:31],v[48:51]
ds_read_b128 a[212:215],v5 offset:39936
v_mfma_f32_16x16x32_bf16 a[112:115],a[192:195],v[112:115],a[112:115]
v_exp_f32 v63,v63
v_mfma_f32_16x16x32_bf16 a[112:115],a[196:199],v[116:119],a[112:115]
s_waitcnt lgkmcnt(4)
v_add_f32 v20,v20,v62
v_add_f32 v20,v20,v63
v_mfma_f32_16x16x32_bf16 a[144:147],a[192:195],v[120:123],a[144:147]
s_waitcnt vmcnt(2)
v_cmp_gt_u32 vcc,3,v9
v_cvt_pk_bf16_f32 v83,v62,v63
v_mfma_f32_16x16x32_bf16 a[144:147],a[196:199],v[124:127],a[144:147]
s_cmp_eq_u64 vcc,0
s_cselect_b32 s101,1,0
s_cselect_b32 s30,0,0x40000000
v_add_u32 v8,s30,v1
ds_read_b128 a[172:175],v2 offset:27648
v_mfma_f32_16x16x32_bf16 v[148:151],a[200:203],v[96:99],v[148:151]
ds_read_b128 a[216:219],v5 offset:44032
v_cndmask_b32 v56,v6,v28,s[64:65]
v_cndmask_b32 v57,v6,v28,s[66:67]
v_cndmask_b32 v58,v6,v28,s[68:69]
v_cndmask_b32 v59,v6,v28,s[70:71]
v_exp_f32 v48,v48
s_waitcnt lgkmcnt(5)
v_mfma_f32_16x16x32_bf16 v[148:151],a[204:207],v[100:103],v[148:151]
buffer_load_dwordx4 a[224:227],v8,s[16:19],s39 offen offset:0 sc1
v_exp_f32 v49,v49
v_mfma_f32_16x16x32_bf16 v[52:55],a[176:179],a[0:3],v[52:55]
v_add_f32 v17,v17,v48
v_add_f32 v17,v17,v49
v_mfma_f32_16x16x32_bf16 v[52:55],a[180:183],a[4:7],v[52:55]
v_cvt_pk_bf16_f32 v74,v48,v49
v_mfma_f32_16x16x32_bf16 v[52:55],a[184:187],a[8:11],v[52:55]
buffer_load_dwordx4 a[228:231],v8,s[16:19],s39 offen offset:1024 sc1
v_mfma_f32_16x16x32_bf16 v[52:55],a[188:191],a[12:15],v[52:55]
v_exp_f32 v50,v50
v_mfma_f32_16x16x32_bf16 v[180:183],a[200:203],v[104:107],v[180:183]
ds_read_b128 a[176:179],v2 offset:28672
v_exp_f32 v51,v51
v_mfma_f32_16x16x32_bf16 v[180:183],a[204:207],v[108:111],v[180:183]
buffer_load_dwordx4 a[232:235],v8,s[16:19],s39 offen offset:2048 sc1
v_mfma_f32_16x16x32_bf16 a[116:119],a[200:203],v[112:115],a[116:119]
ds_read_b128 a[180:183],v2 offset:29696
v_add_f32 v17,v17,v50
v_add_f32 v17,v17,v51
v_mfma_f32_16x16x32_bf16 a[116:119],a[204:207],v[116:119],a[116:119]
ds_read_b128 a[220:223],v5 offset:48128
v_cvt_pk_bf16_f32 v75,v50,v51
v_mfma_f32_16x16x32_bf16 a[148:151],a[200:203],v[120:123],a[148:151]
buffer_load_dwordx4 a[236:239],v8,s[16:19],s39 offen offset:3072 sc1
v_cndmask_b32 v60,v6,v28,s[72:73]
v_cndmask_b32 v61,v6,v28,s[74:75]
v_cndmask_b32 v62,v6,v28,s[76:77]
v_cndmask_b32 v63,v6,v28,s[78:79]
v_exp_f32 v52,v52
v_mfma_f32_16x16x32_bf16 a[148:151],a[204:207],v[124:127],a[148:151]
s_waitcnt lgkmcnt(7)
v_exp_f32 v53,v53
v_mfma_f32_16x16x32_bf16 v[56:59],a[160:163],a[16:19],v[56:59]
ds_read_b128 a[184:187],v2 offset:30720
v_add_f32 v16,v16,v52
v_mfma_f32_16x16x32_bf16 v[56:59],a[164:167],a[20:23],v[56:59]
buffer_load_dwordx4 a[240:243],v8,s[16:19],s42 offen offset:0 sc1
v_add_f32 v16,v16,v53
v_mfma_f32_16x16x32_bf16 v[56:59],a[168:171],a[24:27],v[56:59]
s_waitcnt lgkmcnt(5)
v_cvt_pk_bf16_f32 v66,v52,v53
v_mfma_f32_16x16x32_bf16 v[56:59],a[172:175],a[28:31],v[56:59]
v_exp_f32 v54,v54
v_mfma_f32_16x16x32_bf16 v[152:155],a[208:211],v[96:99],v[152:155]
ds_read_b128 a[188:191],v2 offset:31744
buffer_load_dwordx4 a[244:247],v8,s[16:19],s42 offen offset:1024 sc1
v_exp_f32 v55,v55
v_mfma_f32_16x16x32_bf16 v[152:155],a[212:215],v[100:103],v[152:155]
v_add_f32 v16,v16,v54
v_add_f32 v16,v16,v55
v_mfma_f32_16x16x32_bf16 v[184:187],a[208:211],v[104:107],v[184:187]
v_cvt_pk_bf16_f32 v67,v54,v55
v_mfma_f32_16x16x32_bf16 v[184:187],a[212:215],v[108:111],v[184:187]
buffer_load_dwordx4 a[248:251],v8,s[16:19],s42 offen offset:2048 sc1
v_mfma_f32_16x16x32_bf16 a[120:123],a[208:211],v[112:115],a[120:123]
v_exp_f32 v56,v56
v_mfma_f32_16x16x32_bf16 a[120:123],a[212:215],v[116:119],a[120:123]
s_waitcnt lgkmcnt(3)
v_exp_f32 v57,v57
v_mfma_f32_16x16x32_bf16 v[60:63],a[176:179],a[16:19],v[60:63]
buffer_load_dwordx4 a[252:255],v8,s[16:19],s42 offen offset:3072 sc1
v_mfma_f32_16x16x32_bf16 v[60:63],a[180:183],a[20:23],v[60:63]
s_waitcnt lgkmcnt(1)
v_add_f32 v17,v17,v56
v_add_f32 v17,v17,v57
v_mfma_f32_16x16x32_bf16 v[60:63],a[184:187],a[24:27],v[60:63]
s_waitcnt lgkmcnt(0)
v_cvt_pk_bf16_f32 v76,v56,v57
v_mfma_f32_16x16x32_bf16 v[60:63],a[188:191],a[28:31],v[60:63]
s_waitcnt vmcnt(16) lgkmcnt(0)
buffer_load_dwordx4 v[196:199],v8,s[16:19],s38 offen offset:0 sc1
v_exp_f32 v58,v58
v_mfma_f32_16x16x32_bf16 a[152:155],a[208:211],v[120:123],a[152:155]
s_barrier
v_exp_f32 v59,v59
v_mfma_f32_16x16x32_bf16 a[152:155],a[212:215],v[124:127],a[152:155]
ds_read_b128 a[192:195],v4 offset:0
v_add_f32 v17,v17,v58
v_mfma_f32_16x16x32_bf16 v[156:159],a[216:219],v[96:99],v[156:159]
buffer_load_dwordx4 v[204:207],v8,s[16:19],s38 offen offset:1024 sc1
v_add_f32 v17,v17,v59
v_mfma_f32_16x16x32_bf16 v[156:159],a[220:223],v[100:103],v[156:159]
ds_read_b128 a[196:199],v4 offset:20480
v_cvt_pk_bf16_f32 v77,v58,v59
v_mfma_f32_16x16x32_bf16 v[188:191],a[216:219],v[104:107],v[188:191]
v_exp_f32 v60,v60
v_mfma_f32_16x16x32_bf16 v[188:191],a[220:223],v[108:111],v[188:191]
ds_read_b128 a[200:203],v4 offset:8192
buffer_load_dwordx4 v[212:215],v8,s[16:19],s38 offen offset:2048 sc1
v_exp_f32 v61,v61
v_mfma_f32_16x16x32_bf16 a[124:127],a[216:219],v[112:115],a[124:127]
v_add_f32 v17,v17,v60
v_add_f32 v17,v17,v61
v_mfma_f32_16x16x32_bf16 a[124:127],a[220:223],v[116:119],a[124:127]
ds_read_b128 a[204:207],v4 offset:28672
v_cvt_pk_bf16_f32 v78,v60,v61
v_mfma_f32_16x16x32_bf16 a[156:159],a[216:219],v[120:123],a[156:159]
buffer_load_dwordx4 v[220:223],v8,s[16:19],s38 offen offset:3072 sc1
v_exp_f32 v62,v62
v_mfma_f32_16x16x32_bf16 a[156:159],a[220:223],v[124:127],a[156:159]
s_waitcnt lgkmcnt(3)
v_exp_f32 v63,v63
v_mfma_f32_16x16x32_bf16 a[128:131],a[192:195],v[88:91],a[128:131]
ds_read_b128 a[208:211],v4 offset:1024
v_add_f32 v17,v17,v62
v_mfma_f32_16x16x32_bf16 a[96:99],a[192:195],v[80:83],a[96:99]
buffer_load_dwordx4 v[228:231],v8,s[16:19],s41 offen offset:0 sc1
v_add_f32 v17,v17,v63
v_cvt_pk_bf16_f32 v79,v62,v63
v_mfma_f32_16x16x32_bf16 v[128:131],a[192:195],v[64:67],v[128:131]
ds_read_b128 a[212:215],v4 offset:21504
v_mfma_f32_16x16x32_bf16 v[160:163],a[192:195],v[72:75],v[160:163]
s_waitcnt lgkmcnt(3)
v_mfma_f32_16x16x32_bf16 v[160:163],a[196:199],v[76:79],v[160:163]
buffer_load_dwordx4 v[236:239],v8,s[16:19],s41 offen offset:1024 sc1
v_mfma_f32_16x16x32_bf16 a[132:135],a[200:203],v[88:91],a[132:135]
ds_read_b128 a[216:219],v4 offset:9216
v_mfma_f32_16x16x32_bf16 a[100:103],a[200:203],v[80:83],a[100:103]
ds_write_b128 v12,a[128:131] offset:8192
v_mfma_f32_16x16x32_bf16 v[132:135],a[200:203],v[64:67],v[132:135]
ds_write_b128 v12,a[96:99] offset:0
ds_read_b128 a[220:223],v4 offset:29696
buffer_load_dwordx4 v[244:247],v8,s[16:19],s41 offen offset:2048 sc1
v_mfma_f32_16x16x32_bf16 v[164:167],a[200:203],v[72:75],v[164:167]
s_waitcnt lgkmcnt(6)
v_mfma_f32_16x16x32_bf16 v[164:167],a[204:207],v[76:79],v[164:167]
s_waitcnt lgkmcnt(5)
v_mfma_f32_16x16x32_bf16 a[136:139],a[208:211],v[88:91],a[136:139]
ds_read_b128 a[192:195],v4 offset:2048
buffer_load_dwordx4 v[252:255],v8,s[16:19],s41 offen offset:3072 sc1
v_mfma_f32_16x16x32_bf16 a[104:107],a[208:211],v[80:83],a[104:107]
ds_write_b128 v12,a[132:135] offset:9216
v_mfma_f32_16x16x32_bf16 v[136:139],a[208:211],v[64:67],v[136:139]
ds_write_b128 v12,a[100:103] offset:1024
v_mfma_f32_16x16x32_bf16 v[168:171],a[208:211],v[72:75],v[168:171]
ds_read_b128 a[196:199],v4 offset:22528
buffer_load_dwordx4 a[160:163],v8,s[16:19],s40 offen offset:0 sc1
s_waitcnt lgkmcnt(8)
v_mfma_f32_16x16x32_bf16 v[168:171],a[212:215],v[76:79],v[168:171]
s_waitcnt lgkmcnt(7)
v_mfma_f32_16x16x32_bf16 a[140:143],a[216:219],v[88:91],a[140:143]
ds_read_b128 a[200:203],v4 offset:10240
v_mfma_f32_16x16x32_bf16 a[108:111],a[216:219],v[80:83],a[108:111]
ds_write_b128 v12,a[136:139] offset:10240
buffer_load_dwordx4 a[164:167],v8,s[16:19],s40 offen offset:1024 sc1
v_mfma_f32_16x16x32_bf16 v[140:143],a[216:219],v[64:67],v[140:143]
ds_write_b128 v12,a[104:107] offset:2048
v_mfma_f32_16x16x32_bf16 v[172:175],a[216:219],v[72:75],v[172:175]
ds_read_b128 a[204:207],v4 offset:30720
s_waitcnt lgkmcnt(8)
v_mfma_f32_16x16x32_bf16 v[172:175],a[220:223],v[76:79],v[172:175]
buffer_load_dwordx4 a[168:171],v8,s[16:19],s40 offen offset:2048 sc1
s_waitcnt lgkmcnt(7)
v_mfma_f32_16x16x32_bf16 a[144:147],a[192:195],v[88:91],a[144:147]
ds_read_b128 a[208:211],v4 offset:3072
v_mfma_f32_16x16x32_bf16 a[112:115],a[192:195],v[80:83],a[112:115]
ds_write_b128 v12,a[140:143] offset:11264
v_mfma_f32_16x16x32_bf16 v[144:147],a[192:195],v[64:67],v[144:147]
ds_write_b128 v12,a[108:111] offset:3072
ds_read_b128 a[212:215],v4 offset:23552
buffer_load_dwordx4 a[172:175],v8,s[16:19],s40 offen offset:3072 sc1
v_mfma_f32_16x16x32_bf16 v[176:179],a[192:195],v[72:75],v[176:179]
s_waitcnt lgkmcnt(8)
v_mfma_f32_16x16x32_bf16 v[176:179],a[196:199],v[76:79],v[176:179]
s_waitcnt lgkmcnt(7)
v_mfma_f32_16x16x32_bf16 a[148:151],a[200:203],v[88:91],a[148:151]
ds_read_b128 a[216:219],v4 offset:11264
buffer_load_dwordx4 a[176:179],v8,s[16:19],s43 offen offset:0 sc1
v_mfma_f32_16x16x32_bf16 a[116:119],a[200:203],v[80:83],a[116:119]
ds_write_b128 v12,a[144:147] offset:12288
v_mfma_f32_16x16x32_bf16 v[148:151],a[200:203],v[64:67],v[148:151]
ds_write_b128 v12,a[112:115] offset:4096
v_mfma_f32_16x16x32_bf16 v[180:183],a[200:203],v[72:75],v[180:183]
ds_read_b128 a[220:223],v4 offset:31744
buffer_load_dwordx4 a[180:183],v8,s[16:19],s43 offen offset:1024 sc1
s_waitcnt lgkmcnt(8)
v_mfma_f32_16x16x32_bf16 v[180:183],a[204:207],v[76:79],v[180:183]
s_waitcnt lgkmcnt(7)
v_mfma_f32_16x16x32_bf16 a[152:155],a[208:211],v[88:91],a[152:155]
ds_write_b128 v12,a[148:151] offset:13312
v_mfma_f32_16x16x32_bf16 a[120:123],a[208:211],v[80:83],a[120:123]
buffer_load_dwordx4 a[184:187],v8,s[16:19],s43 offen offset:2048 sc1
v_mfma_f32_16x16x32_bf16 v[152:155],a[208:211],v[64:67],v[152:155]
ds_write_b128 v12,a[116:119] offset:5120
v_mfma_f32_16x16x32_bf16 v[184:187],a[208:211],v[72:75],v[184:187]
s_waitcnt lgkmcnt(5)
v_mfma_f32_16x16x32_bf16 v[184:187],a[212:215],v[76:79],v[184:187]
buffer_load_dwordx4 a[188:191],v8,s[16:19],s43 offen offset:3072 sc1
v_mfma_f32_16x16x32_bf16 a[156:159],a[216:219],v[88:91],a[156:159]
ds_write_b128 v12,a[152:155] offset:14336
v_mfma_f32_16x16x32_bf16 a[124:127],a[216:219],v[80:83],a[124:127]
ds_write_b128 v12,a[120:123] offset:6144
v_mfma_f32_16x16x32_bf16 v[156:159],a[216:219],v[64:67],v[156:159]
v_mfma_f32_16x16x32_bf16 v[188:191],a[216:219],v[72:75],v[188:191]
s_waitcnt lgkmcnt(4)
v_mfma_f32_16x16x32_bf16 v[188:191],a[220:223],v[76:79],v[188:191]
s_nop 3
ds_write_b128 v12,a[156:159] offset:15360
ds_write_b128 v12,a[124:127] offset:7168
s_branch K2_FIN
K2_MID0:
v_mfma_f32_16x16x32_bf16 v[48:51],a[160:163],a[0:3],v[24:27]
ds_read_b128 a[176:179],v2 offset:4096
v_cndmask_b32 v56,v6,v32,s[32:33]
v_mfma_f32_16x16x32_bf16 v[48:51],a[164:167],a[4:7],v[48:51]
v_cndmask_b32 v57,v6,v32,s[34:35]
v_cndmask_b32 v58,v6,v32,s[36:37]
v_mfma_f32_16x16x32_bf16 v[48:51],a[168:171],a[8:11],v[48:51]
buffer_store_dwordx4 v[232:235],v1,s[16:19],s7 offen offset:2048 sc1
v_mfma_f32_16x16x32_bf16 v[48:51],a[172:175],a[12:15],v[48:51]
ds_read_b128 a[180:183],v2 offset:5120
v_cndmask_b32 v59,v6,v32,s[38:39]
v_mfma_f32_16x16x32_bf16 v[52:55],a[160:163],a[16:19],v[28:31]
v_mfma_f32_16x16x32_bf16 v[52:55],a[164:167],a[20:23],v[52:55]
v_mfma_f32_16x16x32_bf16 v[52:55],a[168:171],a[24:27],v[52:55]
ds_read_b128 a[184:187],v2 offset:6144
v_mfma_f32_16x16x32_bf16 v[52:55],a[172:175],a[28:31],v[52:55]
v_mfma_f32_16x16x32_bf16 v[56:59],a[160:163],a[32:35],v[56:59]
v_exp_f32 v48,v48
v_exp_f32 v49,v49
v_mfma_f32_16x16x32_bf16 v[56:59],a[164:167],a[36:39],v[56:59]
ds_read_b128 a[188:191],v2 offset:7168
v_add_f32 v16,v16,v48
v_add_f32 v16,v16,v49
v_cvt_pk_bf16_f32 v64,v48,v49
v_mfma_f32_16x16x32_bf16 v[56:59],a[168:171],a[40:43],v[56:59]
v_exp_f32 v50,v50
v_exp_f32 v51,v51
v_mfma_f32_16x16x32_bf16 v[56:59],a[172:175],a[44:47],v[56:59]
buffer_store_dwordx4 v[144:147],v1,s[16:19],s4 offen offset:1024 sc1
v_add_f32 v16,v16,v50
v_add_f32 v16,v16,v51
v_cvt_pk_bf16_f32 v65,v50,v51
v_mfma_f32_16x16x32_bf16 v[60:63],a[160:163],a[48:51],v[36:39]
v_exp_f32 v52,v52
v_exp_f32 v53,v53
v_mfma_f32_16x16x32_bf16 v[60:63],a[164:167],a[52:55],v[60:63]
v_add_f32 v17,v17,v52
v_add_f32 v17,v17,v53
v_cvt_pk_bf16_f32 v72,v52,v53
v_mfma_f32_16x16x32_bf16 v[60:63],a[168:171],a[56:59],v[60:63]
s_waitcnt lgkmcnt(3)
v_exp_f32 v54,v54
v_exp_f32 v55,v55
v_mfma_f32_16x16x32_bf16 v[60:63],a[172:175],a[60:63],v[60:63]
ds_read_b128 a[160:163],v2 offset:8192
v_add_f32 v17,v17,v54
v_add_f32 v17,v17,v55
v_cvt_pk_bf16_f32 v73,v54,v55
v_mfma_f32_16x16x32_bf16 v[48:51],a[176:179],a[0:3],v[24:27]
s_waitcnt lgkmcnt(3)
v_exp_f32 v56,v56
v_exp_f32 v57,v57
v_mfma_f32_16x16x32_bf16 v[48:51],a[180:183],a[4:7],v[48:51]
s_waitcnt lgkmcnt(2)
v_add_f32 v18,v18,v56
v_add_f32 v18,v18,v57
v_cvt_pk_bf16_f32 v80,v56,v57
v_mfma_f32_16x16x32_bf16 v[48:51],a[184:187],a[8:11],v[48:51]
s_waitcnt lgkmcnt(1)
v_exp_f32 v58,v58
v_exp_f32 v59,v59
v_mfma_f32_16x16x32_bf16 v[48:51],a[188:191],a[12:15],v[48:51]
ds_read_b128 a[164:167],v2 offset:9216
v_add_f32 v18,v18,v58
v_add_f32 v18,v18,v59
v_cvt_pk_bf16_f32 v81,v58,v59
v_mfma_f32_16x16x32_bf16 v[52:55],a[176:179],a[16:19],v[28:31]
buffer_store_dwordx4 v[176:179],v1,s[16:19],s4 offen offset:3072 sc1
v_exp_f32 v60,v60
v_exp_f32 v61,v61
v_mfma_f32_16x16x32_bf16 v[52:55],a[180:183],a[20:23],v[52:55]
v_add_f32 v19,v19,v60
v_add_f32 v19,v19,v61
v_cvt_pk_bf16_f32 v88,v60,v61
v_exp_f32 v62,v62
v_exp_f32 v63,v63
v_add_f32 v19,v19,v62
v_add_f32 v19,v19,v63
v_cvt_pk_bf16_f32 v89,v62,v63
v_cndmask_b32 v56,v6,v32,s[40:41]
v_cndmask_b32 v57,v6,v32,s[42:43]
v_cndmask_b32 v58,v6,v32,s[44:45]
v_cndmask_b32 v59,v6,v32,s[46:47]
v_mfma_f32_16x16x32_bf16 v[52:55],a[184:187],a[24:27],v[52:55]
ds_read_b128 a[168:171],v2 offset:10240
v_mfma_f32_16x16x32_bf16 v[52:55],a[188:191],a[28:31],v[52:55]
v_mfma_f32_16x16x32_bf16 v[56:59],a[176:179],a[32:35],v[56:59]
v_exp_f32 v48,v48
v_exp_f32 v49,v49
v_mfma_f32_16x16x32_bf16 v[56:59],a[180:183],a[36:39],v[56:59]
ds_read_b128 a[172:175],v2 offset:11264
v_add_f32 v16,v16,v48
v_add_f32 v16,v16,v49
v_cvt_pk_bf16_f32 v66,v48,v49
v_mfma_f32_16x16x32_bf16 v[56:59],a[184:187],a[40:43],v[56:59]
v_exp_f32 v50,v50
v_exp_f32 v51,v51
v_mfma_f32_16x16x32_bf16 v[56:59],a[188:191],a[44:47],v[56:59]
v_add_f32 v16,v16,v50
v_add_f32 v16,v16,v51
v_cvt_pk_bf16_f32 v67,v50,v51
v_mfma_f32_16x16x32_bf16 v[60:63],a[176:179],a[48:51],v[36:39]
v_exp_f32 v52,v52
v_exp_f32 v53,v53
v_mfma_f32_16x16x32_bf16 v[60:63],a[180:183],a[52:55],v[60:63]
buffer_store_dwordx4 v[208:211],v1,s[16:19],s6 offen offset:1024 sc1
v_add_f32 v17,v17,v52
v_add_f32 v17,v17,v53
v_cvt_pk_bf16_f32 v74,v52,v53
v_mfma_f32_16x16x32_bf16 v[60:63],a[184:187],a[56:59],v[60:63]
s_waitcnt lgkmcnt(3)
v_exp_f32 v54,v54
v_exp_f32 v55,v55
v_mfma_f32_16x16x32_bf16 v[60:63],a[188:191],a[60:63],v[60:63]
ds_read_b128 a[176:179],v2 offset:12288
v_add_f32 v17,v17,v54
v_add_f32 v17,v17,v55
v_cvt_pk_bf16_f32 v75,v54,v55
v_mfma_f32_16x16x32_bf16 v[48:51],a[160:163],a[0:3],v[24:27]
s_waitcnt lgkmcnt(3)
v_exp_f32 v56,v56
v_exp_f32 v57,v57
v_mfma_f32_16x16x32_bf16 v[48:51],a[164:167],a[4:7],v[48:51]
s_waitcnt lgkmcnt(2)
v_add_f32 v18,v18,v56
v_add_f32 v18,v18,v57
v_cvt_pk_bf16_f32 v82,v56,v57
v_mfma_f32_16x16x32_bf16 v[48:51],a[168:171],a[8:11],v[48:51]
s_waitcnt lgkmcnt(1)
v_exp_f32 v58,v58
v_exp_f32 v59,v59
v_mfma_f32_16x16x32_bf16 v[48:51],a[172:175],a[12:15],v[48:51]
ds_read_b128 a[180:183],v2 offset:13312
v_add_f32 v18,v18,v58
v_add_f32 v18,v18,v59
v_cvt_pk_bf16_f32 v83,v58,v59
v_mfma_f32_16x16x32_bf16 v[52:55],a[160:163],a[16:19],v[28:31]
v_exp_f32 v60,v60
v_exp_f32 v61,v61
v_mfma_f32_16x16x32_bf16 v[52:55],a[164:167],a[20:23],v[52:55]
v_add_f32 v19,v19,v60
v_add_f32 v19,v19,v61
v_cvt_pk_bf16_f32 v90,v60,v61
v_exp_f32 v62,v62
v_exp_f32 v63,v63
v_add_f32 v19,v19,v62
v_add_f32 v19,v19,v63
v_cvt_pk_bf16_f32 v91,v62,v63
v_cndmask_b32 v56,v6,v32,s[48:49]
v_cndmask_b32 v57,v6,v32,s[50:51]
v_cndmask_b32 v58,v6,v32,s[52:53]
v_cndmask_b32 v59,v6,v32,s[54:55]
v_mfma_f32_16x16x32_bf16 v[52:55],a[168:171],a[24:27],v[52:55]
ds_read_b128 a[184:187],v2 offset:14336
buffer_store_dwordx4 v[240:243],v1,s[16:19],s6 offen offset:3072 sc1
v_mfma_f32_16x16x32_bf16 v[52:55],a[172:175],a[28:31],v[52:55]
v_mfma_f32_16x16x32_bf16 v[56:59],a[160:163],a[32:35],v[56:59]
v_exp_f32 v48,v48
v_exp_f32 v49,v49
v_mfma_f32_16x16x32_bf16 v[56:59],a[164:167],a[36:39],v[56:59]
ds_read_b128 a[188:191],v2 offset:15360
v_add_f32 v16,v16,v48
v_add_f32 v16,v16,v49
v_cvt_pk_bf16_f32 v68,v48,v49
v_mfma_f32_16x16x32_bf16 v[56:59],a[168:171],a[40:43],v[56:59]
v_exp_f32 v50,v50
v_exp_f32 v51,v51
v_mfma_f32_16x16x32_bf16 v[56:59],a[172:175],a[44:47],v[56:59]
v_add_f32 v16,v16,v50
v_add_f32 v16,v16,v51
v_cvt_pk_bf16_f32 v69,v50,v51
v_mfma_f32_16x16x32_bf16 v[60:63],a[160:163],a[48:51],v[36:39]
v_exp_f32 v52,v52
v_exp_f32 v53,v53
v_mfma_f32_16x16x32_bf16 v[60:63],a[164:167],a[52:55],v[60:63]
v_add_f32 v17,v17,v52
v_add_f32 v17,v17,v53
v_cvt_pk_bf16_f32 v76,v52,v53
v_mfma_f32_16x16x32_bf16 v[60:63],a[168:171],a[56:59],v[60:63]
v_exp_f32 v54,v54
v_exp_f32 v55,v55
v_mfma_f32_16x16x32_bf16 v[60:63],a[172:175],a[60:63],v[60:63]
s_waitcnt lgkmcnt(3)
v_add_f32 v17,v17,v54
v_add_f32 v17,v17,v55
v_cvt_pk_bf16_f32 v77,v54,v55
v_mfma_f32_16x16x32_bf16 v[48:51],a[176:179],a[0:3],v[24:27]
s_waitcnt lgkmcnt(2)
v_exp_f32 v56,v56
v_exp_f32 v57,v57
v_mfma_f32_16x16x32_bf16 v[48:51],a[180:183],a[4:7],v[48:51]
s_waitcnt lgkmcnt(1)
v_add_f32 v18,v18,v56
v_add_f32 v18,v18,v57
v_cvt_pk_bf16_f32 v84,v56,v57
v_mfma_f32_16x16x32_bf16 v[48:51],a[184:187],a[8:11],v[48:51]
s_waitcnt lgkmcnt(0)
v_exp_f32 v58,v58
v_exp_f32 v59,v59
v_mfma_f32_16x16x32_bf16 v[48:51],a[188:191],a[12:15],v[48:51]
s_waitcnt vmcnt(7) lgkmcnt(0)
v_add_f32 v18,v18,v58
v_add_f32 v18,v18,v59
v_cvt_pk_bf16_f32 v85,v58,v59
v_mfma_f32_16x16x32_bf16 v[52:55],a[176:179],a[16:19],v[28:31]
s_barrier
v_exp_f32 v60,v60
v_exp_f32 v61,v61
v_mfma_f32_16x16x32_bf16 v[52:55],a[180:183],a[20:23],v[52:55]
s_add_u32 m0,s23,0
v_add_f32 v19,v19,v60
v_add_f32 v19,v19,v61
v_cvt_pk_bf16_f32 v92,v60,v61
v_exp_f32 v62,v62
v_exp_f32 v63,v63
v_add_f32 v19,v19,v62
v_add_f32 v19,v19,v63
v_cvt_pk_bf16_f32 v93,v62,v63
v_cndmask_b32 v56,v6,v32,s[56:57]
v_cndmask_b32 v57,v6,v32,s[58:59]
v_cndmask_b32 v58,v6,v32,s[60:61]
v_cndmask_b32 v59,v6,v32,s[62:63]
v_mfma_f32_16x16x32_bf16 v[52:55],a[184:187],a[24:27],v[52:55]
ds_read_b128 a[160:163],v2 offset:32768
s_add_u32 s24,s24,16384
v_mfma_f32_16x16x32_bf16 v[52:55],a[188:191],a[28:31],v[52:55]
ds_read_b128 a[192:195],v4 offset:0
v_mfma_f32_16x16x32_bf16 v[56:59],a[176:179],a[32:35],v[56:59]
ds_read_b128 a[164:167],v2 offset:33792
v_exp_f32 v48,v48
v_exp_f32 v49,v49
v_mfma_f32_16x16x32_bf16 v[56:59],a[180:183],a[36:39],v[56:59]
ds_read_b128 a[196:199],v4 offset:4096
buffer_load_dwordx4 v1,s[16:19],s24 offen offset:0 sc1 lds
v_add_f32 v16,v16,v48
v_add_f32 v16,v16,v49
v_cvt_pk_bf16_f32 v70,v48,v49
v_mfma_f32_16x16x32_bf16 v[56:59],a[184:187],a[40:43],v[56:59]
buffer_load_dwordx4 v1,s[16:19],s24 offen offset:1024 sc1 lds
v_exp_f32 v50,v50
v_exp_f32 v51,v51
v_mfma_f32_16x16x32_bf16 v[56:59],a[188:191],a[44:47],v[56:59]
ds_read_b128 a[168:171],v2 offset:34816
buffer_load_dwordx4 v1,s[16:19],s24 offen offset:2048 sc1 lds
v_add_f32 v16,v16,v50
v_add_f32 v16,v16,v51
v_cvt_pk_bf16_f32 v71,v50,v51
v_mfma_f32_16x16x32_bf16 v[60:63],a[176:179],a[48:51],v[36:39]
ds_read_b128 a[200:203],v4 offset:8192
buffer_load_dwordx4 v1,s[16:19],s24 offen offset:3072 sc1 lds
v_exp_f32 v52,v52
v_exp_f32 v53,v53
v_mfma_f32_16x16x32_bf16 v[60:63],a[180:183],a[52:55],v[60:63]
ds_read_b128 a[172:175],v2 offset:35840
s_add_u32 m0,s23,16384
s_add_u32 s24,s24,16384
buffer_load_dwordx4 v1,s[16:19],s24 offen offset:0 sc1 lds
v_add_f32 v17,v17,v52
v_add_f32 v17,v17,v53
v_cvt_pk_bf16_f32 v78,v52,v53
v_mfma_f32_16x16x32_bf16 v[60:63],a[184:187],a[56:59],v[60:63]
ds_read_b128 a[204:207],v4 offset:12288
buffer_load_dwordx4 v1,s[16:19],s24 offen offset:1024 sc1 lds
v_exp_f32 v54,v54
v_exp_f32 v55,v55
v_mfma_f32_16x16x32_bf16 v[60:63],a[188:191],a[60:63],v[60:63]
s_waitcnt lgkmcnt(7)
v_add_f32 v17,v17,v54
v_add_f32 v17,v17,v55
v_cvt_pk_bf16_f32 v79,v54,v55
v_mfma_f32_16x16x32_bf16 v[48:51],a[160:163],a[0:3],v[24:27]
s_waitcnt lgkmcnt(3)
v_exp_f32 v56,v56
v_exp_f32 v57,v57
v_mfma_f32_16x16x32_bf16 v[48:51],a[164:167],a[4:7],v[48:51]
ds_read_b128 a[176:179],v2 offset:36864
v_add_f32 v18,v18,v56
v_add_f32 v18,v18,v57
v_cvt_pk_bf16_f32 v86,v56,v57
v_mfma_f32_16x16x32_bf16 v[48:51],a[168:171],a[8:11],v[48:51]
s_waitcnt lgkmcnt(2)
v_exp_f32 v58,v58
v_exp_f32 v59,v59
v_mfma_f32_16x16x32_bf16 v[48:51],a[172:175],a[12:15],v[48:51]
buffer_load_dwordx4 v1,s[16:19],s24 offen offset:2048 sc1 lds
v_add_f32 v18,v18,v58
v_add_f32 v18,v18,v59
v_cvt_pk_bf16_f32 v87,v58,v59
v_mfma_f32_16x16x32_bf16 v[128:131],a[192:195],v[64:67],0
v_exp_f32 v60,v60
v_exp_f32 v61,v61
v_mfma_f32_16x16x32_bf16 v[128:131],a[196:199],v[68:71],v[128:131]
ds_read_b128 a[208:211],v4 offset:1024
v_add_f32 v19,v19,v60
v_add_f32 v19,v19,v61
v_cvt_pk_bf16_f32 v94,v60,v61
v_mfma_f32_16x16x32_bf16 v[160:163],a[192:195],v[72:75],0
v_exp_f32 v62,v62
v_exp_f32 v63,v63
v_mfma_f32_16x16x32_bf16 v[160:163],a[196:199],v[76:79],v[160:163]
ds_read_b128 a[180:183],v2 offset:37888
v_add_f32 v19,v19,v62
v_add_f32 v19,v19,v63
v_cvt_pk_bf16_f32 v95,v62,v63
v_mfma_f32_16x16x32_bf16 v[192:195],a[192:195],v[80:83],0
buffer_load_dwordx4 v1,s[16:19],s24 offen offset:3072 sc1 lds
v_cndmask_b32 v56,v6,v36,s[32:33]
v_cndmask_b32 v57,v6,v36,s[34:35]
v_cndmask_b32 v58,v6,v36,s[36:37]
v_cndmask_b32 v59,v6,v36,s[38:39]
v_exp_f32 v48,v48
v_mfma_f32_16x16x32_bf16 v[192:195],a[196:199],v[84:87],v[192:195]
s_add_u32 m0,s23,98304
v_exp_f32 v49,v49
v_mfma_f32_16x16x32_bf16 v[52:55],a[160:163],a[16:19],v[28:31]
ds_read_b128 a[212:215],v4 offset:5120
s_add_u32 s25,s25,16384
v_mfma_f32_16x16x32_bf16 v[52:55],a[164:167],a[20:23],v[52:55]
buffer_load_dwordx4 v1,s[16:19],s25 offen offset:0 sc1 lds
v_add_f32 v16,v16,v48
v_add_f32 v16,v16,v49
v_mfma_f32_16x16x32_bf16 v[52:55],a[168:171],a[24:27],v[52:55]
ds_read_b128 a[184:187],v2 offset:38912
v_cvt_pk_bf16_f32 v96,v48,v49
v_mfma_f32_16x16x32_bf16 v[52:55],a[172:175],a[28:31],v[52:55]
v_exp_f32 v50,v50
v_mfma_f32_16x16x32_bf16 v[224:227],a[192:195],v[88:91],0
s_waitcnt lgkmcnt(5)
v_exp_f32 v51,v51
v_mfma_f32_16x16x32_bf16 v[224:227],a[196:199],v[92:95],v[224:227]
buffer_load_dwordx4 v1,s[16:19],s25 offen offset:1024 sc1 lds
v_mfma_f32_16x16x32_bf16 v[132:135],a[200:203],v[64:67],0
ds_read_b128 a[216:219],v4 offset:9216
v_add_f32 v16,v16,v50
v_add_f32 v16,v16,v51
v_mfma_f32_16x16x32_bf16 v[132:135],a[204:207],v[68:71],v[132:135]
v_cvt_pk_bf16_f32 v97,v50,v51
v_mfma_f32_16x16x32_bf16 v[164:167],a[200:203],v[72:75],0
v_exp_f32 v52,v52
v_mfma_f32_16x16x32_bf16 v[164:167],a[204:207],v[76:79],v[164:167]
ds_read_b128 a[188:191],v2 offset:39936
v_exp_f32 v53,v53
v_mfma_f32_16x16x32_bf16 v[56:59],a[160:163],a[48:51],v[56:59]
buffer_load_dwordx4 v1,s[16:19],s25 offen offset:2048 sc1 lds
v_mfma_f32_16x16x32_bf16 v[56:59],a[164:167],a[52:55],v[56:59]
v_add_f32 v17,v17,v52
v_add_f32 v17,v17,v53
v_mfma_f32_16x16x32_bf16 v[56:59],a[168:171],a[56:59],v[56:59]
v_cvt_pk_bf16_f32 v104,v52,v53
v_mfma_f32_16x16x32_bf16 v[56:59],a[172:175],a[60:63],v[56:59]
v_exp_f32 v54,v54
v_mfma_f32_16x16x32_bf16 v[196:199],a[200:203],v[80:83],0
ds_read_b128 a[160:163],v2 offset:40960
buffer_load_dwordx4 v1,s[16:19],s25 offen offset:3072 sc1 lds
v_exp_f32 v55,v55
v_mfma_f32_16x16x32_bf16 v[196:199],a[204:207],v[84:87],v[196:199]
ds_read_b128 a[220:223],v4 offset:13312
v_add_f32 v17,v17,v54
v_mfma_f32_16x16x32_bf16 v[228:231],a[200:203],v[88:91],0
s_waitcnt lgkmcnt(8)
v_add_f32 v17,v17,v55
v_cvt_pk_bf16_f32 v105,v54,v55
v_mfma_f32_16x16x32_bf16 v[228:231],a[204:207],v[92:95],v[228:231]
buffer_store_dwordx4 v[152:155],v1,s[16:19],s5 offen offset:1024 sc1
v_mfma_f32_16x16x32_bf16 v[60:63],a[176:179],a[0:3],v[24:27]
s_waitcnt lgkmcnt(6)
v_exp_f32 v56,v56
v_mfma_f32_16x16x32_bf16 v[60:63],a[180:183],a[4:7],v[60:63]
s_waitcnt lgkmcnt(2)
v_exp_f32 v57,v57
v_mfma_f32_16x16x32_bf16 v[60:63],a[184:187],a[8:11],v[60:63]
ds_read_b128 a[164:167],v2 offset:41984
v_add_f32 v19,v19,v56
v_mfma_f32_16x16x32_bf16 v[60:63],a[188:191],a[12:15],v[60:63]
v_add_f32 v19,v19,v57
v_cvt_pk_bf16_f32 v120,v56,v57
v_mfma_f32_16x16x32_bf16 v[136:139],a[208:211],v[64:67],0
v_exp_f32 v58,v58
v_mfma_f32_16x16x32_bf16 v[136:139],a[212:215],v[68:71],v[136:139]
ds_read_b128 a[192:195],v4 offset:2048
v_exp_f32 v59,v59
v_mfma_f32_16x16x32_bf16 v[168:171],a[208:211],v[72:75],0
v_add_f32 v19,v19,v58
v_add_f32 v19,v19,v59
v_mfma_f32_16x16x32_bf16 v[168:171],a[212:215],v[76:79],v[168:171]
v_cvt_pk_bf16_f32 v121,v58,v59
v_mfma_f32_16x16x32_bf16 v[200:203],a[208:211],v[80:83],0
v_cndmask_b32 v52,v6,v36,s[40:41]
v_cndmask_b32 v53,v6,v36,s[42:43]
v_cndmask_b32 v54,v6,v36,s[44:45]
v_cndmask_b32 v55,v6,v36,s[46:47]
v_exp_f32 v60,v60
v_mfma_f32_16x16x32_bf16 v[200:203],a[212:215],v[84:87],v[200:203]
v_exp_f32 v61,v61
v_mfma_f32_16x16x32_bf16 v[48:51],a[176:179],a[16:19],v[28:31]
ds_read_b128 a[168:171],v2 offset:43008
v_add_f32 v16,v16,v60
v_mfma_f32_16x16x32_bf16 v[48:51],a[180:183],a[20:23],v[48:51]
ds_read_b128 a[196:199],v4 offset:6144
buffer_store_dwordx4 v[184:187],v1,s[16:19],s5 offen offset:3072 sc1
v_add_f32 v16,v16,v61
v_mfma_f32_16x16x32_bf16 v[48:51],a[184:187],a[24:27],v[48:51]
v_cvt_pk_bf16_f32 v98,v60,v61
v_mfma_f32_16x16x32_bf16 v[48:51],a[188:191],a[28:31],v[48:51]
v_exp_f32 v62,v62
v_mfma_f32_16x16x32_bf16 v[232:235],a[208:211],v[88:91],0
v_exp_f32 v63,v63
v_mfma_f32_16x16x32_bf16 v[232:235],a[212:215],v[92:95],v[232:235]
s_waitcnt lgkmcnt(4)
v_add_f32 v16,v16,v62
v_add_f32 v16,v16,v63
v_mfma_f32_16x16x32_bf16 v[140:143],a[216:219],v[64:67],0
ds_read_b128 a[200:203],v4 offset:10240
v_cvt_pk_bf16_f32 v99,v62,v63
v_mfma_f32_16x16x32_bf16 v[140:143],a[220:223],v[68:71],v[140:143]
ds_read_b128 a[172:175],v2 offset:44032
v_mfma_f32_16x16x32_bf16 v[172:175],a[216:219],v[72:75],0
v_exp_f32 v48,v48
v_mfma_f32_16x16x32_bf16 v[172:175],a[220:223],v[76:79],v[172:175]
v_exp_f32 v49,v49
v_mfma_f32_16x16x32_bf16 v[52:55],a[176:179],a[48:51],v[52:55]
v_add_f32 v17,v17,v48
v_add_f32 v17,v17,v49
v_mfma_f32_16x16x32_bf16 v[52:55],a[180:183],a[52:55],v[52:55]
v_cvt_pk_bf16_f32 v106,v48,v49
v_mfma_f32_16x16x32_bf16 v[52:55],a[184:187],a[56:59],v[52:55]
v_exp_f32 v50,v50
v_mfma_f32_16x16x32_bf16 v[52:55],a[188:191],a[60:63],v[52:55]
v_exp_f32 v51,v51
v_mfma_f32_16x16x32_bf16 v[204:207],a[216:219],v[80:83],0
ds_read_b128 a[176:179],v2 offset:45056
v_add_f32 v17,v17,v50
v_mfma_f32_16x16x32_bf16 v[204:207],a[220:223],v[84:87],v[204:207]
ds_read_b128 a[204:207],v4 offset:14336
v_add_f32 v17,v17,v51
v_mfma_f32_16x16x32_bf16 v[236:239],a[216:219],v[88:91],0
v_cvt_pk_bf16_f32 v107,v50,v51
v_mfma_f32_16x16x32_bf16 v[236:239],a[220:223],v[92:95],v[236:239]
buffer_store_dwordx4 v[216:219],v1,s[16:19],s7 offen offset:1024 sc1
v_mfma_f32_16x16x32_bf16 v[56:59],a[160:163],a[0:3],v[24:27]
s_waitcnt lgkmcnt(7)
v_exp_f32 v52,v52
v_mfma_f32_16x16x32_bf16 v[56:59],a[164:167],a[4:7],v[56:59]
s_waitcnt lgkmcnt(2)
v_exp_f32 v53,v53
v_mfma_f32_16x16x32_bf16 v[56:59],a[168:171],a[8:11],v[56:59]
ds_read_b128 a[180:183],v2 offset:46080
v_add_f32 v19,v19,v52
v_mfma_f32_16x16x32_bf16 v[56:59],a[172:175],a[12:15],v[56:59]
v_add_f32 v19,v19,v53
v_cvt_pk_bf16_f32 v122,v52,v53
v_mfma_f32_16x16x32_bf16 v[144:147],a[192:195],v[64:67],0
v_exp_f32 v54,v54
v_mfma_f32_16x16x32_bf16 v[144:147],a[196:199],v[68:71],v[144:147]
ds_read_b128 a[208:211],v4 offset:3072
v_exp_f32 v55,v55
v_mfma_f32_16x16x32_bf16 v[176:179],a[192:195],v[72:75],0
v_add_f32 v19,v19,v54
v_add_f32 v19,v19,v55
v_mfma_f32_16x16x32_bf16 v[176:179],a[196:199],v[76:79],v[176:179]
v_cvt_pk_bf16_f32 v123,v54,v55
v_mfma_f32_16x16x32_bf16 v[208:211],a[192:195],v[80:83],0
v_cndmask_b32 v48,v6,v36,s[48:49]
v_cndmask_b32 v49,v6,v36,s[50:51]
v_cndmask_b32 v50,v6,v36,s[52:53]
v_cndmask_b32 v51,v6,v36,s[54:55]
v_exp_f32 v56,v56
v_mfma_f32_16x16x32_bf16 v[208:211],a[196:199],v[84:87],v[208:211]
v_exp_f32 v57,v57
v_mfma_f32_16x16x32_bf16 v[60:63],a[160:163],a[16:19],v[28:31]
ds_read_b128 a[184:187],v2 offset:47104
v_add_f32 v16,v16,v56
v_mfma_f32_16x16x32_bf16 v[60:63],a[164:167],a[20:23],v[60:63]
ds_read_b128 a[212:215],v4 offset:7168
buffer_store_dwordx4 v[248:251],v1,s[16:19],s7 offen offset:3072 sc1
v_add_f32 v16,v16,v57
v_mfma_f32_16x16x32_bf16 v[60:63],a[168:171],a[24:27],v[60:63]
v_cvt_pk_bf16_f32 v100,v56,v57
v_mfma_f32_16x16x32_bf16 v[60:63],a[172:175],a[28:31],v[60:63]
v_exp_f32 v58,v58
v_mfma_f32_16x16x32_bf16 v[240:243],a[192:195],v[88:91],0
v_exp_f32 v59,v59
v_mfma_f32_16x16x32_bf16 v[240:243],a[196:199],v[92:95],v[240:243]
s_waitcnt lgkmcnt(4)
v_add_f32 v16,v16,v58
v_add_f32 v16,v16,v59
v_mfma_f32_16x16x32_bf16 v[148:151],a[200:203],v[64:67],0
ds_read_b128 a[216:219],v4 offset:11264
v_cvt_pk_bf16_f32 v101,v58,v59
v_mfma_f32_16x16x32_bf16 v[148:151],a[204:207],v[68:71],v[148:151]
ds_read_b128 a[188:191],v2 offset:48128
v_mfma_f32_16x16x32_bf16 v[180:183],a[200:203],v[72:75],0
v_exp_f32 v60,v60
v_mfma_f32_16x16x32_bf16 v[180:183],a[204:207],v[76:79],v[180:183]
v_exp_f32 v61,v61
v_mfma_f32_16x16x32_bf16 v[48:51],a[160:163],a[48:51],v[48:51]
v_add_f32 v17,v17,v60
v_add_f32 v17,v17,v61
v_mfma_f32_16x16x32_bf16 v[48:51],a[164:167],a[52:55],v[48:51]
v_cvt_pk_bf16_f32 v108,v60,v61
v_mfma_f32_16x16x32_bf16 v[48:51],a[168:171],a[56:59],v[48:51]
v_exp_f32 v62,v62
v_mfma_f32_16x16x32_bf16 v[48:51],a[172:175],a[60:63],v[48:51]
v_exp_f32 v63,v63
v_mfma_f32_16x16x32_bf16 v[212:215],a[200:203],v[80:83],0
ds_read_b128 a[220:223],v4 offset:15360
v_add_f32 v17,v17,v62
v_mfma_f32_16x16x32_bf16 v[212:215],a[204:207],v[84:87],v[212:215]
v_add_f32 v17,v17,v63
v_cvt_pk_bf16_f32 v109,v62,v63
v_mfma_f32_16x16x32_bf16 v[244:247],a[200:203],v[88:91],0
v_mfma_f32_16x16x32_bf16 v[244:247],a[204:207],v[92:95],v[244:247]
v_mfma_f32_16x16x32_bf16 v[52:55],a[176:179],a[0:3],v[24:27]
s_waitcnt lgkmcnt(6)
v_exp_f32 v48,v48
v_mfma_f32_16x16x32_bf16 v[52:55],a[180:183],a[4:7],v[52:55]
s_waitcnt lgkmcnt(4)
v_exp_f32 v49,v49
v_mfma_f32_16x16x32_bf16 v[52:55],a[184:187],a[8:11],v[52:55]
s_waitcnt lgkmcnt(1)
v_add_f32 v19,v19,v48
v_add_f32 v19,v19,v49
v_mfma_f32_16x16x32_bf16 v[52:55],a[188:191],a[12:15],v[52:55]
v_cvt_pk_bf16_f32 v124,v48,v49
v_mfma_f32_16x16x32_bf16 v[152:155],a[208:211],v[64:67],0
v_exp_f32 v50,v50
v_mfma_f32_16x16x32_bf16 v[152:155],a[212:215],v[68:71],v[152:155]
v_exp_f32 v51,v51
v_mfma_f32_16x16x32_bf16 v[184:187],a[208:211],v[72:75],0
v_add_f32 v19,v19,v50
v_add_f32 v19,v19,v51
v_mfma_f32_16x16x32_bf16 v[184:187],a[212:215],v[76:79],v[184:187]
s_waitcnt vmcnt(4) lgkmcnt(0)
v_cvt_pk_bf16_f32 v125,v50,v51
v_mfma_f32_16x16x32_bf16 v[216:219],a[208:211],v[80:83],0
s_barrier
v_cndmask_b32 v60,v6,v36,s[56:57]
v_cndmask_b32 v61,v6,v36,s[58:59]
v_cndmask_b32 v62,v6,v36,s[60:61]
v_cndmask_b32 v63,v6,v36,s[62:63]
v_exp_f32 v52,v52
v_mfma_f32_16x16x32_bf16 v[216:219],a[212:215],v[84:87],v[216:219]
s_add_u32 m0,s23,32768
v_exp_f32 v53,v53
v_mfma_f32_16x16x32_bf16 v[56:59],a[176:179],a[16:19],v[28:31]
ds_read_b128 a[160:163],v3 offset:0
v_add_f32 v16,v16,v52
v_mfma_f32_16x16x32_bf16 v[56:59],a[180:183],a[20:23],v[56:59]
s_add_u32 s24,s24,16384
v_add_f32 v16,v16,v53
v_cvt_pk_bf16_f32 v102,v52,v53
v_mfma_f32_16x16x32_bf16 v[56:59],a[184:187],a[24:27],v[56:59]
ds_read_b128 a[192:195],v4 offset:32768
v_mfma_f32_16x16x32_bf16 v[56:59],a[188:191],a[28:31],v[56:59]
buffer_load_dwordx4 v1,s[16:19],s24 offen offset:0 sc1 lds
v_exp_f32 v54,v54
v_mfma_f32_16x16x32_bf16 v[248:251],a[208:211],v[88:91],0
ds_read_b128 a[164:167],v3 offset:1024
v_exp_f32 v55,v55
v_mfma_f32_16x16x32_bf16 v[248:251],a[212:215],v[92:95],v[248:251]
buffer_load_dwordx4 v1,s[16:19],s24 offen offset:1024 sc1 lds
v_mfma_f32_16x16x32_bf16 v[156:159],a[216:219],v[64:67],0
ds_read_b128 a[196:199],v4 offset:36864
v_add_f32 v16,v16,v54
v_add_f32 v16,v16,v55
v_mfma_f32_16x16x32_bf16 v[156:159],a[220:223],v[68:71],v[156:159]
buffer_load_dwordx4 v1,s[16:19],s24 offen offset:2048 sc1 lds
v_cvt_pk_bf16_f32 v103,v54,v55
v_mfma_f32_16x16x32_bf16 v[188:191],a[216:219],v[72:75],0
v_exp_f32 v56,v56
v_mfma_f32_16x16x32_bf16 v[188:191],a[220:223],v[76:79],v[188:191]
ds_read_b128 a[168:171],v3 offset:2048
v_exp_f32 v57,v57
v_mfma_f32_16x16x32_bf16 v[60:63],a[176:179],a[48:51],v[60:63]
buffer_load_dwordx4 v1,s[16:19],s24 offen offset:3072 sc1 lds
v_mfma_f32_16x16x32_bf16 v[60:63],a[180:183],a[52:55],v[60:63]
ds_read_b128 a[200:203],v4 offset:40960
s_add_u32 m0,s23,49152
v_add_f32 v17,v17,v56
v_add_f32 v17,v17,v57
v_mfma_f32_16x16x32_bf16 v[60:63],a[184:187],a[56:59],v[60:63]
ds_read_b128 a[172:175],v3 offset:3072
s_add_u32 s24,s24,16384
v_cvt_pk_bf16_f32 v110,v56,v57
v_mfma_f32_16x16x32_bf16 v[60:63],a[188:191],a[60:63],v[60:63]
buffer_load_dwordx4 v1,s[16:19],s24 offen offset:0 sc1 lds
v_exp_f32 v58,v58
v_mfma_f32_16x16x32_bf16 v[220:223],a[216:219],v[80:83],0
v_exp_f32 v59,v59
v_mfma_f32_16x16x32_bf16 v[220:223],a[220:223],v[84:87],v[220:223]
ds_read_b128 a[204:207],v4 offset:45056
buffer_load_dwordx4 v1,s[16:19],s24 offen offset:1024 sc1 lds
v_mfma_f32_16x16x32_bf16 v[252:255],a[216:219],v[88:91],0
v_add_f32 v17,v17,v58
v_add_f32 v17,v17,v59
v_mfma_f32_16x16x32_bf16 v[252:255],a[220:223],v[92:95],v[252:255]
s_waitcnt lgkmcnt(7)
v_cvt_pk_bf16_f32 v111,v58,v59
v_mfma_f32_16x16x32_bf16 v[48:51],a[160:163],a[0:3],v[24:27]
s_waitcnt lgkmcnt(3)
v_exp_f32 v60,v60
v_mfma_f32_16x16x32_bf16 v[48:51],a[164:167],a[4:7],v[48:51]
ds_read_b128 a[176:179],v3 offset:4096
v_exp_f32 v61,v61
v_mfma_f32_16x16x32_bf16 v[48:51],a[168:171],a[8:11],v[48:51]
s_waitcnt lgkmcnt(2)
v_add_f32 v19,v19,v60
v_add_f32 v19,v19,v61
v_mfma_f32_16x16x32_bf16 v[48:51],a[172:175],a[12:15],v[48:51]
buffer_load_dwordx4 v1,s[16:19],s24 offen offset:2048 sc1 lds
v_cvt_pk_bf16_f32 v126,v60,v61
v_mfma_f32_16x16x32_bf16 v[128:131],a[192:195],v[96:99],v[128:131]
v_exp_f32 v62,v62
v_mfma_f32_16x16x32_bf16 v[128:131],a[196:199],v[100:103],v[128:131]
ds_read_b128 a[208:211],v4 offset:33792
v_exp_f32 v63,v63
v_mfma_f32_16x16x32_bf16 v[160:163],a[192:195],v[104:107],v[160:163]
ds_read_b128 a[180:183],v3 offset:5120
v_add_f32 v19,v19,v62
v_mfma_f32_16x16x32_bf16 v[160:163],a[196:199],v[108:111],v[160:163]
buffer_load_dwordx4 v1,s[16:19],s24 offen offset:3072 sc1 lds
v_add_f32 v19,v19,v63
v_cvt_pk_bf16_f32 v127,v62,v63
v_mfma_f32_16x16x32_bf16 v[52:55],a[160:163],a[16:19],v[28:31]
s_add_u32 m0,s23,65536
v_exp_f32 v48,v48
v_mfma_f32_16x16x32_bf16 v[52:55],a[164:167],a[20:23],v[52:55]
s_add_u32 s25,s25,16384
v_exp_f32 v49,v49
v_mfma_f32_16x16x32_bf16 v[52:55],a[168:171],a[24:27],v[52:55]
v_add_f32 v16,v16,v48
v_add_f32 v16,v16,v49
v_mfma_f32_16x16x32_bf16 v[52:55],a[172:175],a[28:31],v[52:55]
ds_read_b128 a[212:215],v4 offset:37888
v_cvt_pk_bf16_f32 v64,v48,v49
v_mfma_f32_16x16x32_bf16 v[224:227],a[192:195],v[120:123],v[224:227]
buffer_load_dwordx4 v1,s[16:19],s25 offen offset:0 sc1 lds
v_exp_f32 v50,v50
v_mfma_f32_16x16x32_bf16 v[224:227],a[196:199],v[124:127],v[224:227]
ds_read_b128 a[184:187],v3 offset:6144
v_exp_f32 v51,v51
v_mfma_f32_16x16x32_bf16 v[56:59],a[160:163],a[64:67],v[40:43]
v_add_f32 v16,v16,v50
v_add_f32 v16,v16,v51
v_mfma_f32_16x16x32_bf16 v[56:59],a[164:167],a[68:71],v[56:59]
buffer_load_dwordx4 v1,s[16:19],s25 offen offset:1024 sc1 lds
v_cvt_pk_bf16_f32 v65,v50,v51
v_mfma_f32_16x16x32_bf16 v[56:59],a[168:171],a[72:75],v[56:59]
v_exp_f32 v52,v52
v_exp_f32 v53,v53
v_mfma_f32_16x16x32_bf16 v[56:59],a[172:175],a[76:79],v[56:59]
s_waitcnt lgkmcnt(5)
v_add_f32 v17,v17,v52
v_add_f32 v17,v17,v53
v_mfma_f32_16x16x32_bf16 v[132:135],a[200:203],v[96:99],v[132:135]
ds_read_b128 a[188:191],v3 offset:7168
v_cvt_pk_bf16_f32 v72,v52,v53
v_mfma_f32_16x16x32_bf16 v[132:135],a[204:207],v[100:103],v[132:135]
ds_read_b128 a[216:219],v4 offset:41984
v_exp_f32 v54,v54
v_exp_f32 v55,v55
v_mfma_f32_16x16x32_bf16 v[164:167],a[200:203],v[104:107],v[164:167]
buffer_load_dwordx4 v1,s[16:19],s25 offen offset:2048 sc1 lds
v_add_f32 v17,v17,v54
v_mfma_f32_16x16x32_bf16 v[164:167],a[204:207],v[108:111],v[164:167]
v_add_f32 v17,v17,v55
v_cvt_pk_bf16_f32 v73,v54,v55
v_mfma_f32_16x16x32_bf16 v[60:63],a[160:163],a[80:83],v[44:47]
v_exp_f32 v56,v56
v_mfma_f32_16x16x32_bf16 v[60:63],a[164:167],a[84:87],v[60:63]
v_exp_f32 v57,v57
v_mfma_f32_16x16x32_bf16 v[60:63],a[168:171],a[88:91],v[60:63]
buffer_load_dwordx4 v1,s[16:19],s25 offen offset:3072 sc1 lds
v_add_f32 v20,v20,v56
v_mfma_f32_16x16x32_bf16 v[60:63],a[172:175],a[92:95],v[60:63]
ds_read_b128 a[160:163],v3 offset:8192
s_add_u32 m0,s23,81920
v_add_f32 v20,v20,v57
v_cvt_pk_bf16_f32 v80,v56,v57
v_mfma_f32_16x16x32_bf16 v[228:231],a[200:203],v[120:123],v[228:231]
ds_read_b128 a[220:223],v4 offset:46080
s_add_u32 s25,s25,16384
v_exp_f32 v58,v58
v_mfma_f32_16x16x32_bf16 v[228:231],a[204:207],v[124:127],v[228:231]
s_waitcnt lgkmcnt(6)
v_exp_f32 v59,v59
v_mfma_f32_16x16x32_bf16 v[48:51],a[176:179],a[0:3],v[24:27]
buffer_load_dwordx4 v1,s[16:19],s25 offen offset:0 sc1 lds
v_add_f32 v20,v20,v58
v_mfma_f32_16x16x32_bf16 v[48:51],a[180:183],a[4:7],v[48:51]
s_waitcnt lgkmcnt(4)
v_add_f32 v20,v20,v59
v_cvt_pk_bf16_f32 v81,v58,v59
v_mfma_f32_16x16x32_bf16 v[48:51],a[184:187],a[8:11],v[48:51]
s_waitcnt lgkmcnt(3)
v_exp_f32 v60,v60
v_exp_f32 v61,v61
v_mfma_f32_16x16x32_bf16 v[48:51],a[188:191],a[12:15],v[48:51]
buffer_load_dwordx4 v1,s[16:19],s25 offen offset:1024 sc1 lds
v_add_f32 v21,v21,v60
v_mfma_f32_16x16x32_bf16 v[136:139],a[208:211],v[96:99],v[136:139]
ds_read_b128 a[164:167],v3 offset:9216
v_add_f32 v21,v21,v61
v_cvt_pk_bf16_f32 v88,v60,v61
v_mfma_f32_16x16x32_bf16 v[136:139],a[212:215],v[100:103],v[136:139]
ds_read_b128 a[192:195],v4 offset:34816
v_exp_f32 v62,v62
v_exp_f32 v63,v63
v_mfma_f32_16x16x32_bf16 v[168:171],a[208:211],v[104:107],v[168:171]
v_add_f32 v21,v21,v62
v_add_f32 v21,v21,v63
v_mfma_f32_16x16x32_bf16 v[168:171],a[212:215],v[108:111],v[168:171]
buffer_load_dwordx4 v1,s[16:19],s25 offen offset:2048 sc1 lds
v_cvt_pk_bf16_f32 v89,v62,v63
v_mfma_f32_16x16x32_bf16 v[52:55],a[176:179],a[16:19],v[28:31]
v_exp_f32 v48,v48
v_mfma_f32_16x16x32_bf16 v[52:55],a[180:183],a[20:23],v[52:55]
v_exp_f32 v49,v49
v_mfma_f32_16x16x32_bf16 v[52:55],a[184:187],a[24:27],v[52:55]
v_add_f32 v16,v16,v48
v_add_f32 v16,v16,v49
v_mfma_f32_16x16x32_bf16 v[52:55],a[188:191],a[28:31],v[52:55]
ds_read_b128 a[168:171],v3 offset:10240
v_cvt_pk_bf16_f32 v66,v48,v49
v_mfma_f32_16x16x32_bf16 v[232:235],a[208:211],v[120:123],v[232:235]
ds_read_b128 a[196:199],v4 offset:38912
buffer_load_dwordx4 v1,s[16:19],s25 offen offset:3072 sc1 lds
v_exp_f32 v50,v50
v_mfma_f32_16x16x32_bf16 v[232:235],a[212:215],v[124:127],v[232:235]
v_exp_f32 v51,v51
v_mfma_f32_16x16x32_bf16 v[56:59],a[176:179],a[64:67],v[40:43]
v_add_f32 v16,v16,v50
v_add_f32 v16,v16,v51
v_mfma_f32_16x16x32_bf16 v[56:59],a[180:183],a[68:71],v[56:59]
v_cvt_pk_bf16_f32 v67,v50,v51
v_mfma_f32_16x16x32_bf16 v[56:59],a[184:187],a[72:75],v[56:59]
v_exp_f32 v52,v52
v_exp_f32 v53,v53
v_mfma_f32_16x16x32_bf16 v[56:59],a[188:191],a[76:79],v[56:59]
s_waitcnt lgkmcnt(4)
v_add_f32 v17,v17,v52
v_add_f32 v17,v17,v53
v_mfma_f32_16x16x32_bf16 v[140:143],a[216:219],v[96:99],v[140:143]
ds_read_b128 a[172:175],v3 offset:11264
v_cvt_pk_bf16_f32 v74,v52,v53
v_mfma_f32_16x16x32_bf16 v[140:143],a[220:223],v[100:103],v[140:143]
ds_read_b128 a[200:203],v4 offset:43008
v_exp_f32 v54,v54
v_exp_f32 v55,v55
v_mfma_f32_16x16x32_bf16 v[172:175],a[216:219],v[104:107],v[172:175]
v_add_f32 v17,v17,v54
v_add_f32 v17,v17,v55
v_mfma_f32_16x16x32_bf16 v[172:175],a[220:223],v[108:111],v[172:175]
v_cvt_pk_bf16_f32 v75,v54,v55
v_mfma_f32_16x16x32_bf16 v[60:63],a[176:179],a[80:83],v[44:47]
v_exp_f32 v56,v56
v_mfma_f32_16x16x32_bf16 v[60:63],a[180:183],a[84:87],v[60:63]
v_exp_f32 v57,v57
v_mfma_f32_16x16x32_bf16 v[60:63],a[184:187],a[88:91],v[60:63]
v_add_f32 v20,v20,v56
v_add_f32 v20,v20,v57
v_mfma_f32_16x16x32_bf16 v[60:63],a[188:191],a[92:95],v[60:63]
ds_read_b128 a[176:179],v3 offset:12288
v_cvt_pk_bf16_f32 v82,v56,v57
v_mfma_f32_16x16x32_bf16 v[236:239],a[216:219],v[120:123],v[236:239]
ds_read_b128 a[204:207],v4 offset:47104
v_exp_f32 v58,v58
v_mfma_f32_16x16x32_bf16 v[236:239],a[220:223],v[124:127],v[236:239]
v_exp_f32 v59,v59
v_mfma_f32_16x16x32_bf16 v[48:51],a[160:163],a[0:3],v[24:27]
s_waitcnt lgkmcnt(7)
v_add_f32 v20,v20,v58
v_add_f32 v20,v20,v59
v_mfma_f32_16x16x32_bf16 v[48:51],a[164:167],a[4:7],v[48:51]
s_waitcnt lgkmcnt(5)
v_cvt_pk_bf16_f32 v83,v58,v59
v_mfma_f32_16x16x32_bf16 v[48:51],a[168:171],a[8:11],v[48:51]
s_waitcnt lgkmcnt(3)
v_exp_f32 v60,v60
v_exp_f32 v61,v61
v_mfma_f32_16x16x32_bf16 v[48:51],a[172:175],a[12:15],v[48:51]
v_add_f32 v21,v21,v60
v_add_f32 v21,v21,v61
v_mfma_f32_16x16x32_bf16 v[144:147],a[192:195],v[96:99],v[144:147]
ds_read_b128 a[180:183],v3 offset:13312
v_cvt_pk_bf16_f32 v90,v60,v61
v_mfma_f32_16x16x32_bf16 v[144:147],a[196:199],v[100:103],v[144:147]
ds_read_b128 a[208:211],v4 offset:35840
v_exp_f32 v62,v62
v_exp_f32 v63,v63
v_mfma_f32_16x16x32_bf16 v[176:179],a[192:195],v[104:107],v[176:179]
v_add_f32 v21,v21,v62
v_add_f32 v21,v21,v63
v_mfma_f32_16x16x32_bf16 v[176:179],a[196:199],v[108:111],v[176:179]
v_cvt_pk_bf16_f32 v91,v62,v63
v_mfma_f32_16x16x32_bf16 v[52:55],a[160:163],a[16:19],v[28:31]
v_exp_f32 v48,v48
v_mfma_f32_16x16x32_bf16 v[52:55],a[164:167],a[20:23],v[52:55]
v_exp_f32 v49,v49
v_mfma_f32_16x16x32_bf16 v[52:55],a[168:171],a[24:27],v[52:55]
v_add_f32 v16,v16,v48
v_add_f32 v16,v16,v49
v_mfma_f32_16x16x32_bf16 v[52:55],a[172:175],a[28:31],v[52:55]
ds_read_b128 a[184:187],v3 offset:14336
v_cvt_pk_bf16_f32 v68,v48,v49
v_mfma_f32_16x16x32_bf16 v[240:243],a[192:195],v[120:123],v[240:243]
ds_read_b128 a[212:215],v4 offset:39936
v_exp_f32 v50,v50
v_mfma_f32_16x16x32_bf16 v[240:243],a[196:199],v[124:127],v[240:243]
v_exp_f32 v51,v51
v_mfma_f32_16x16x32_bf16 v[56:59],a[160:163],a[64:67],v[40:43]
v_add_f32 v16,v16,v50
v_add_f32 v16,v16,v51
v_mfma_f32_16x16x32_bf16 v[56:59],a[164:167],a[68:71],v[56:59]
v_cvt_pk_bf16_f32 v69,v50,v51
v_mfma_f32_16x16x32_bf16 v[56:59],a[168:171],a[72:75],v[56:59]
v_exp_f32 v52,v52
v_exp_f32 v53,v53
v_mfma_f32_16x16x32_bf16 v[56:59],a[172:175],a[76:79],v[56:59]
s_waitcnt lgkmcnt(4)
v_add_f32 v17,v17,v52
v_add_f32 v17,v17,v53
v_mfma_f32_16x16x32_bf16 v[148:151],a[200:203],v[96:99],v[148:151]
ds_read_b128 a[188:191],v3 offset:15360
v_cvt_pk_bf16_f32 v76,v52,v53
v_mfma_f32_16x16x32_bf16 v[148:151],a[204:207],v[100:103],v[148:151]
ds_read_b128 a[216:219],v4 offset:44032
v_exp_f32 v54,v54
v_exp_f32 v55,v55
v_mfma_f32_16x16x32_bf16 v[180:183],a[200:203],v[104:107],v[180:183]
v_add_f32 v17,v17,v54
v_add_f32 v17,v17,v55
v_mfma_f32_16x16x32_bf16 v[180:183],a[204:207],v[108:111],v[180:183]
v_cvt_pk_bf16_f32 v77,v54,v55
v_mfma_f32_16x16x32_bf16 v[60:63],a[160:163],a[80:83],v[44:47]
v_exp_f32 v56,v56
v_mfma_f32_16x16x32_bf16 v[60:63],a[164:167],a[84:87],v[60:63]
v_exp_f32 v57,v57
v_mfma_f32_16x16x32_bf16 v[60:63],a[168:171],a[88:91],v[60:63]
v_add_f32 v20,v20,v56
v_add_f32 v20,v20,v57
v_mfma_f32_16x16x32_bf16 v[60:63],a[172:175],a[92:95],v[60:63]
ds_read_b128 a[220:223],v4 offset:48128
v_cvt_pk_bf16_f32 v84,v56,v57
v_mfma_f32_16x16x32_bf16 v[244:247],a[200:203],v[120:123],v[244:247]
v_exp_f32 v58,v58
v_mfma_f32_16x16x32_bf16 v[244:247],a[204:207],v[124:127],v[244:247]
v_exp_f32 v59,v59
v_mfma_f32_16x16x32_bf16 v[48:51],a[176:179],a[0:3],v[24:27]
s_waitcnt lgkmcnt(6)
v_add_f32 v20,v20,v58
v_add_f32 v20,v20,v59
v_mfma_f32_16x16x32_bf16 v[48:51],a[180:183],a[4:7],v[48:51]
s_waitcnt lgkmcnt(4)
v_cvt_pk_bf16_f32 v85,v58,v59
v_mfma_f32_16x16x32_bf16 v[48:51],a[184:187],a[8:11],v[48:51]
s_waitcnt lgkmcnt(2)
v_exp_f32 v60,v60
v_exp_f32 v61,v61
v_mfma_f32_16x16x32_bf16 v[48:51],a[188:191],a[12:15],v[48:51]
v_add_f32 v21,v21,v60
v_add_f32 v21,v21,v61
v_mfma_f32_16x16x32_bf16 v[152:155],a[208:211],v[96:99],v[152:155]
v_cvt_pk_bf16_f32 v92,v60,v61
v_mfma_f32_16x16x32_bf16 v[152:155],a[212:215],v[100:103],v[152:155]
v_exp_f32 v62,v62
v_exp_f32 v63,v63
v_mfma_f32_16x16x32_bf16 v[184:187],a[208:211],v[104:107],v[184:187]
v_add_f32 v21,v21,v62
v_add_f32 v21,v21,v63
v_mfma_f32_16x16x32_bf16 v[184:187],a[212:215],v[108:111],v[184:187]
s_waitcnt vmcnt(0) lgkmcnt(0)
v_cvt_pk_bf16_f32 v93,v62,v63
v_mfma_f32_16x16x32_bf16 v[52:55],a[176:179],a[16:19],v[28:31]
s_barrier
buffer_store_dword v11,v10,s[16:19],s99 offen sc1
v_exp_f32 v48,v48
v_mfma_f32_16x16x32_bf16 v[52:55],a[180:183],a[20:23],v[52:55]
s_add_u32 m0,s23,0
v_exp_f32 v49,v49
v_mfma_f32_16x16x32_bf16 v[52:55],a[184:187],a[24:27],v[52:55]
ds_read_b128 a[160:163],v3 offset:32768
v_add_f32 v16,v16,v48
v_mfma_f32_16x16x32_bf16 v[52:55],a[188:191],a[28:31],v[52:55]
s_add_u32 s24,s24,16384
v_add_f32 v16,v16,v49
v_cvt_pk_bf16_f32 v70,v48,v49
v_mfma_f32_16x16x32_bf16 v[248:251],a[208:211],v[120:123],v[248:251]
ds_read_b128 a[192:195],v5 offset:0
v_exp_f32 v50,v50
v_mfma_f32_16x16x32_bf16 v[248:251],a[212:215],v[124:127],v[248:251]
buffer_load_dwordx4 v1,s[16:19],s24 offen offset:0 sc1 lds
v_exp_f32 v51,v51
v_mfma_f32_16x16x32_bf16 v[56:59],a[176:179],a[64:67],v[40:43]
ds_read_b128 a[164:167],v3 offset:33792
v_add_f32 v16,v16,v50
v_mfma_f32_16x16x32_bf16 v[56:59],a[180:183],a[68:71],v[56:59]
buffer_load_dwordx4 v1,s[16:19],s24 offen offset:1024 sc1 lds
v_add_f32 v16,v16,v51
v_cvt_pk_bf16_f32 v71,v50,v51
v_mfma_f32_16x16x32_bf16 v[56:59],a[184:187],a[72:75],v[56:59]
ds_read_b128 a[196:199],v5 offset:4096
v_exp_f32 v52,v52
v_exp_f32 v53,v53
v_mfma_f32_16x16x32_bf16 v[56:59],a[188:191],a[76:79],v[56:59]
buffer_load_dwordx4 v1,s[16:19],s24 offen offset:2048 sc1 lds
v_add_f32 v17,v17,v52
v_mfma_f32_16x16x32_bf16 v[156:159],a[216:219],v[96:99],v[156:159]
ds_read_b128 a[168:171],v3 offset:34816
v_add_f32 v17,v17,v53
v_cvt_pk_bf16_f32 v78,v52,v53
v_mfma_f32_16x16x32_bf16 v[156:159],a[220:223],v[100:103],v[156:159]
v_exp_f32 v54,v54
v_exp_f32 v55,v55
v_mfma_f32_16x16x32_bf16 v[188:191],a[216:219],v[104:107],v[188:191]
buffer_load_dwordx4 v1,s[16:19],s24 offen offset:3072 sc1 lds
v_add_f32 v17,v17,v54
v_mfma_f32_16x16x32_bf16 v[188:191],a[220:223],v[108:111],v[188:191]
ds_read_b128 a[200:203],v5 offset:8192
s_add_u32 m0,s23,16384
v_add_f32 v17,v17,v55
v_cvt_pk_bf16_f32 v79,v54,v55
v_mfma_f32_16x16x32_bf16 v[60:63],a[176:179],a[80:83],v[44:47]
s_add_u32 s24,s24,16384
v_exp_f32 v56,v56
v_exp_f32 v57,v57
v_mfma_f32_16x16x32_bf16 v[60:63],a[180:183],a[84:87],v[60:63]
ds_read_b128 a[172:175],v3 offset:35840
buffer_load_dwordx4 v1,s[16:19],s24 offen offset:0 sc1 lds
v_add_f32 v20,v20,v56
v_mfma_f32_16x16x32_bf16 v[60:63],a[184:187],a[88:91],v[60:63]
ds_read_b128 a[204:207],v5 offset:12288
v_add_f32 v20,v20,v57
v_cvt_pk_bf16_f32 v86,v56,v57
v_mfma_f32_16x16x32_bf16 v[60:63],a[188:191],a[92:95],v[60:63]
buffer_load_dwordx4 v1,s[16:19],s24 offen offset:1024 sc1 lds
v_exp_f32 v58,v58
v_exp_f32 v59,v59
v_mfma_f32_16x16x32_bf16 v[252:255],a[216:219],v[120:123],v[252:255]
v_add_f32 v20,v20,v58
v_add_f32 v20,v20,v59
v_mfma_f32_16x16x32_bf16 v[252:255],a[220:223],v[124:127],v[252:255]
v_cvt_pk_bf16_f32 v87,v58,v59
s_nop 7
v_mov_b32 v48,v18
v_mov_b32 v49,v19
s_nop 1
v_permlane32_swap_b32 v48,v18
v_permlane32_swap_b32 v49,v19
v_add_f32 v18,v18,v48
v_add_f32 v19,v19,v49
v_mov_b32 v48,v18
v_mov_b32 v49,v19
s_nop 1
v_permlane16_swap_b32 v48,v18
v_permlane16_swap_b32 v49,v19
v_add_f32 v18,v18,v48
v_add_f32 v19,v19,v49
v_rcp_f32 v48,v18
v_rcp_f32 v49,v19
v_add_f32 v50,v18,v19
v_cmp_nle_f32 vcc,v50,v15
v_mul_f32 v192,v48,v192
v_mul_f32 v193,v48,v193
v_mul_f32 v194,v48,v194
v_mul_f32 v195,v48,v195
v_mul_f32 v196,v48,v196
v_mul_f32 v197,v48,v197
v_mul_f32 v198,v48,v198
v_mul_f32 v199,v48,v199
v_cvt_pk_bf16_f32 v192,v192,v193
v_cvt_pk_bf16_f32 v193,v194,v195
v_cvt_pk_bf16_f32 v194,v196,v197
v_cvt_pk_bf16_f32 v195,v198,v199
buffer_store_dwordx4 v[192:195],v1,s[16:19],s88 offen offset:0 sc1
v_mul_f32 v200,v48,v200
v_mul_f32 v201,v48,v201
v_mul_f32 v202,v48,v202
v_mul_f32 v203,v48,v203
v_mul_f32 v204,v48,v204
v_mul_f32 v205,v48,v205
v_mul_f32 v206,v48,v206
v_mul_f32 v207,v48,v207
v_cvt_pk_bf16_f32 v200,v200,v201
v_cvt_pk_bf16_f32 v201,v202,v203
v_cvt_pk_bf16_f32 v202,v204,v205
v_cvt_pk_bf16_f32 v203,v206,v207
buffer_store_dwordx4 v[200:203],v1,s[16:19],s88 offen offset:1024 sc1
v_mul_f32 v208,v48,v208
v_mul_f32 v209,v48,v209
v_mul_f32 v210,v48,v210
v_mul_f32 v211,v48,v211
v_mul_f32 v212,v48,v212
v_mul_f32 v213,v48,v213
v_mul_f32 v214,v48,v214
v_mul_f32 v215,v48,v215
v_cvt_pk_bf16_f32 v208,v208,v209
v_cvt_pk_bf16_f32 v209,v210,v211
v_cvt_pk_bf16_f32 v210,v212,v213
v_cvt_pk_bf16_f32 v211,v214,v215
buffer_store_dwordx4 v[208:211],v1,s[16:19],s88 offen offset:2048 sc1
v_mul_f32 v216,v48,v216
v_mul_f32 v217,v48,v217
v_mul_f32 v218,v48,v218
v_mul_f32 v219,v48,v219
v_mul_f32 v220,v48,v220
v_mul_f32 v221,v48,v221
v_mul_f32 v222,v48,v222
v_mul_f32 v223,v48,v223
v_cvt_pk_bf16_f32 v216,v216,v217
v_cvt_pk_bf16_f32 v217,v218,v219
v_cvt_pk_bf16_f32 v218,v220,v221
v_cvt_pk_bf16_f32 v219,v222,v223
buffer_store_dwordx4 v[216:219],v1,s[16:19],s88 offen offset:3072 sc1
s_cmp_eq_u64 vcc,0
s_cselect_b32 s100,3,2
s_or_b32 s100,s100,s27
v_mul_f32 v224,v49,v224
v_mul_f32 v225,v49,v225
v_mul_f32 v226,v49,v226
v_mul_f32 v227,v49,v227
v_mul_f32 v228,v49,v228
v_mul_f32 v229,v49,v229
v_mul_f32 v230,v49,v230
v_mul_f32 v231,v49,v231
v_cvt_pk_bf16_f32 v224,v224,v225
v_cvt_pk_bf16_f32 v225,v226,v227
v_cvt_pk_bf16_f32 v226,v228,v229
v_cvt_pk_bf16_f32 v227,v230,v231
buffer_store_dwordx4 v[224:227],v1,s[16:19],s89 offen offset:0 sc1
v_mul_f32 v232,v49,v232
v_mul_f32 v233,v49,v233
v_mul_f32 v234,v49,v234
v_mul_f32 v235,v49,v235
v_mul_f32 v236,v49,v236
v_mul_f32 v237,v49,v237
v_mul_f32 v238,v49,v238
v_mul_f32 v239,v49,v239
v_cvt_pk_bf16_f32 v232,v232,v233
v_cvt_pk_bf16_f32 v233,v234,v235
v_cvt_pk_bf16_f32 v234,v236,v237
v_cvt_pk_bf16_f32 v235,v238,v239
buffer_store_dwordx4 v[232:235],v1,s[16:19],s89 offen offset:1024 sc1
v_mul_f32 v240,v49,v240
v_mul_f32 v241,v49,v241
v_mul_f32 v242,v49,v242
v_mul_f32 v243,v49,v243
v_mul_f32 v244,v49,v244
v_mul_f32 v245,v49,v245
v_mul_f32 v246,v49,v246
v_mul_f32 v247,v49,v247
v_cvt_pk_bf16_f32 v240,v240,v241
v_cvt_pk_bf16_f32 v241,v242,v243
v_cvt_pk_bf16_f32 v242,v244,v245
v_cvt_pk_bf16_f32 v243,v246,v247
buffer_store_dwordx4 v[240:243],v1,s[16:19],s89 offen offset:2048 sc1
v_mul_f32 v248,v49,v248
v_mul_f32 v249,v49,v249
v_mul_f32 v250,v49,v250
v_mul_f32 v251,v49,v251
v_mul_f32 v252,v49,v252
v_mul_f32 v253,v49,v253
v_mul_f32 v254,v49,v254
v_mul_f32 v255,v49,v255
v_cvt_pk_bf16_f32 v248,v248,v249
v_cvt_pk_bf16_f32 v249,v250,v251
v_cvt_pk_bf16_f32 v250,v252,v253
v_cvt_pk_bf16_f32 v251,v254,v255
buffer_store_dwordx4 v[248:251],v1,s[16:19],s89 offen offset:3072 sc1
s_branch K2_P2
K2_MID7:
s_bitcmp1_b32 s20,0
s_cbranch_scc1 K2_MID71
s_waitcnt lgkmcnt(7)
v_mfma_f32_16x16x32_bf16 v[48:51],a[160:163],a[0:3],v[24:27]
s_waitcnt lgkmcnt(5)
v_exp_f32 v60,v60
v_mfma_f32_16x16x32_bf16 v[48:51],a[164:167],a[4:7],v[48:51]
s_waitcnt lgkmcnt(1)
v_exp_f32 v61,v61
v_mfma_f32_16x16x32_bf16 v[48:51],a[168:171],a[8:11],v[48:51]
ds_read_b128 a[176:179],v2 offset:4096
v_add_f32 v19,v19,v60
v_mfma_f32_16x16x32_bf16 v[48:51],a[172:175],a[12:15],v[48:51]
buffer_load_dwordx4 v1,s[16:19],s25 offen offset:2048 sc1 lds
v_add_f32 v19,v19,v61
v_cvt_pk_bf16_f32 v126,v60,v61
v_mfma_f32_16x16x32_bf16 v[128:131],a[192:195],v[96:99],v[128:131]
v_exp_f32 v62,v62
v_mfma_f32_16x16x32_bf16 v[128:131],a[196:199],v[100:103],v[128:131]
v_exp_f32 v63,v63
v_mfma_f32_16x16x32_bf16 v[160:163],a[192:195],v[104:107],v[160:163]
ds_read_b128 a[208:211],v4 offset:33792
v_add_f32 v19,v19,v62
v_mfma_f32_16x16x32_bf16 v[160:163],a[196:199],v[108:111],v[160:163]
buffer_load_dwordx4 v1,s[16:19],s25 offen offset:3072 sc1 lds
v_add_f32 v19,v19,v63
v_cvt_pk_bf16_f32 v127,v62,v63
v_mfma_f32_16x16x32_bf16 v[52:55],a[160:163],a[16:19],v[28:31]
v_cndmask_b32 v56,v6,v32,s[32:33]
v_cndmask_b32 v57,v6,v32,s[34:35]
v_cndmask_b32 v58,v6,v32,s[36:37]
v_cndmask_b32 v59,v6,v32,s[38:39]
v_exp_f32 v48,v48
v_mfma_f32_16x16x32_bf16 v[52:55],a[164:167],a[20:23],v[52:55]
v_exp_f32 v49,v49
v_mfma_f32_16x16x32_bf16 v[52:55],a[168:171],a[24:27],v[52:55]
ds_read_b128 a[180:183],v2 offset:5120
v_add_f32 v16,v16,v48
v_mfma_f32_16x16x32_bf16 v[52:55],a[172:175],a[28:31],v[52:55]
global_load_dword a250,v22,s[94:95]
v_add_f32 v16,v16,v49
v_cvt_pk_bf16_f32 v64,v48,v49
v_mfma_f32_16x16x32_bf16 v[192:195],a[192:195],v[112:115],v[192:195]
v_exp_f32 v50,v50
v_mfma_f32_16x16x32_bf16 v[192:195],a[196:199],v[116:119],v[192:195]
v_exp_f32 v51,v51
v_mfma_f32_16x16x32_bf16 v[224:227],a[192:195],v[120:123],v[224:227]
ds_read_b128 a[212:215],v4 offset:37888
v_add_f32 v16,v16,v50
v_mfma_f32_16x16x32_bf16 v[224:227],a[196:199],v[124:127],v[224:227]
v_add_f32 v16,v16,v51
v_cvt_pk_bf16_f32 v65,v50,v51
v_mfma_f32_16x16x32_bf16 v[56:59],a[160:163],a[32:35],v[56:59]
v_exp_f32 v52,v52
v_mfma_f32_16x16x32_bf16 v[56:59],a[164:167],a[36:39],v[56:59]
v_exp_f32 v53,v53
v_mfma_f32_16x16x32_bf16 v[56:59],a[168:171],a[40:43],v[56:59]
ds_read_b128 a[184:187],v2 offset:6144
v_add_f32 v17,v17,v52
v_mfma_f32_16x16x32_bf16 v[56:59],a[172:175],a[44:47],v[56:59]
v_add_f32 v17,v17,v53
v_cvt_pk_bf16_f32 v72,v52,v53
v_mfma_f32_16x16x32_bf16 v[132:135],a[200:203],v[96:99],v[132:135]
s_waitcnt lgkmcnt(5)
v_exp_f32 v54,v54
v_mfma_f32_16x16x32_bf16 v[132:135],a[204:207],v[100:103],v[132:135]
v_exp_f32 v55,v55
v_mfma_f32_16x16x32_bf16 v[164:167],a[200:203],v[104:107],v[164:167]
ds_read_b128 a[216:219],v4 offset:41984
v_add_f32 v17,v17,v54
v_mfma_f32_16x16x32_bf16 v[164:167],a[204:207],v[108:111],v[164:167]
v_add_f32 v17,v17,v55
v_cvt_pk_bf16_f32 v73,v54,v55
v_mfma_f32_16x16x32_bf16 v[60:63],a[160:163],a[48:51],v[36:39]
v_exp_f32 v56,v56
v_mfma_f32_16x16x32_bf16 v[60:63],a[164:167],a[52:55],v[60:63]
v_exp_f32 v57,v57
v_mfma_f32_16x16x32_bf16 v[60:63],a[168:171],a[56:59],v[60:63]
ds_read_b128 a[188:191],v2 offset:7168
v_add_f32 v18,v18,v56
v_mfma_f32_16x16x32_bf16 v[60:63],a[172:175],a[60:63],v[60:63]
v_add_f32 v18,v18,v57
v_cvt_pk_bf16_f32 v80,v56,v57
v_mfma_f32_16x16x32_bf16 v[196:199],a[200:203],v[112:115],v[196:199]
v_exp_f32 v58,v58
v_mfma_f32_16x16x32_bf16 v[196:199],a[204:207],v[116:119],v[196:199]
v_exp_f32 v59,v59
v_mfma_f32_16x16x32_bf16 v[228:231],a[200:203],v[120:123],v[228:231]
ds_read_b128 a[220:223],v4 offset:46080
v_add_f32 v18,v18,v58
v_mfma_f32_16x16x32_bf16 v[228:231],a[204:207],v[124:127],v[228:231]
s_waitcnt lgkmcnt(7)
v_add_f32 v18,v18,v59
v_cvt_pk_bf16_f32 v81,v58,v59
v_mfma_f32_16x16x32_bf16 v[48:51],a[176:179],a[0:3],v[24:27]
s_waitcnt lgkmcnt(5)
v_exp_f32 v60,v60
v_mfma_f32_16x16x32_bf16 v[48:51],a[180:183],a[4:7],v[48:51]
s_waitcnt lgkmcnt(1)
v_exp_f32 v61,v61
v_mfma_f32_16x16x32_bf16 v[48:51],a[184:187],a[8:11],v[48:51]
ds_read_b128 a[160:163],v2 offset:8192
v_add_f32 v19,v19,v60
v_mfma_f32_16x16x32_bf16 v[48:51],a[188:191],a[12:15],v[48:51]
v_add_f32 v19,v19,v61
v_cvt_pk_bf16_f32 v88,v60,v61
v_mfma_f32_16x16x32_bf16 v[136:139],a[208:211],v[96:99],v[136:139]
v_exp_f32 v62,v62
v_mfma_f32_16x16x32_bf16 v[136:139],a[212:215],v[100:103],v[136:139]
v_exp_f32 v63,v63
v_mfma_f32_16x16x32_bf16 v[168:171],a[208:211],v[104:107],v[168:171]
ds_read_b128 a[192:195],v4 offset:34816
v_add_f32 v19,v19,v62
v_mfma_f32_16x16x32_bf16 v[168:171],a[212:215],v[108:111],v[168:171]
v_add_f32 v19,v19,v63
v_cvt_pk_bf16_f32 v89,v62,v63
v_mfma_f32_16x16x32_bf16 v[52:55],a[176:179],a[16:19],v[28:31]
v_cndmask_b32 v56,v6,v32,s[40:41]
v_cndmask_b32 v57,v6,v32,s[42:43]
v_cndmask_b32 v58,v6,v32,s[44:45]
v_cndmask_b32 v59,v6,v32,s[46:47]
v_exp_f32 v48,v48
v_mfma_f32_16x16x32_bf16 v[52:55],a[180:183],a[20:23],v[52:55]
v_exp_f32 v49,v49
v_mfma_f32_16x16x32_bf16 v[52:55],a[184:187],a[24:27],v[52:55]
ds_read_b128 a[164:167],v2 offset:9216
v_add_f32 v16,v16,v48
v_mfma_f32_16x16x32_bf16 v[52:55],a[188:191],a[28:31],v[52:55]
v_add_f32 v16,v16,v49
v_cvt_pk_bf16_f32 v66,v48,v49
v_mfma_f32_16x16x32_bf16 v[200:203],a[208:211],v[112:115],v[200:203]
v_exp_f32 v50,v50
v_mfma_f32_16x16x32_bf16 v[200:203],a[212:215],v[116:119],v[200:203]
v_exp_f32 v51,v51
v_mfma_f32_16x16x32_bf16 v[232:235],a[208:211],v[120:123],v[232:235]
ds_read_b128 a[196:199],v4 offset:38912
v_add_f32 v16,v16,v50
v_mfma_f32_16x16x32_bf16 v[232:235],a[212:215],v[124:127],v[232:235]
v_add_f32 v16,v16,v51
v_cvt_pk_bf16_f32 v67,v50,v51
v_mfma_f32_16x16x32_bf16 v[56:59],a[176:179],a[32:35],v[56:59]
v_exp_f32 v52,v52
v_mfma_f32_16x16x32_bf16 v[56:59],a[180:183],a[36:39],v[56:59]
v_exp_f32 v53,v53
v_mfma_f32_16x16x32_bf16 v[56:59],a[184:187],a[40:43],v[56:59]
ds_read_b128 a[168:171],v2 offset:10240
v_add_f32 v17,v17,v52
v_mfma_f32_16x16x32_bf16 v[56:59],a[188:191],a[44:47],v[56:59]
v_add_f32 v17,v17,v53
v_cvt_pk_bf16_f32 v74,v52,v53
v_mfma_f32_16x16x32_bf16 v[140:143],a[216:219],v[96:99],v[140:143]
s_waitcnt lgkmcnt(5)
v_exp_f32 v54,v54
v_mfma_f32_16x16x32_bf16 v[140:143],a[220:223],v[100:103],v[140:143]
v_exp_f32 v55,v55
v_mfma_f32_16x16x32_bf16 v[172:175],a[216:219],v[104:107],v[172:175]
ds_read_b128 a[200:203],v4 offset:43008
v_add_f32 v17,v17,v54
v_mfma_f32_16x16x32_bf16 v[172:175],a[220:223],v[108:111],v[172:175]
v_add_f32 v17,v17,v55
v_cvt_pk_bf16_f32 v75,v54,v55
v_mfma_f32_16x16x32_bf16 v[60:63],a[176:179],a[48:51],v[36:39]
v_exp_f32 v56,v56
v_mfma_f32_16x16x32_bf16 v[60:63],a[180:183],a[52:55],v[60:63]
v_exp_f32 v57,v57
v_mfma_f32_16x16x32_bf16 v[60:63],a[184:187],a[56:59],v[60:63]
ds_read_b128 a[172:175],v2 offset:11264
v_add_f32 v18,v18,v56
v_mfma_f32_16x16x32_bf16 v[60:63],a[188:191],a[60:63],v[60:63]
v_add_f32 v18,v18,v57
v_cvt_pk_bf16_f32 v82,v56,v57
v_mfma_f32_16x16x32_bf16 v[204:207],a[216:219],v[112:115],v[204:207]
v_exp_f32 v58,v58
v_mfma_f32_16x16x32_bf16 v[204:207],a[220:223],v[116:119],v[204:207]
v_exp_f32 v59,v59
v_mfma_f32_16x16x32_bf16 v[236:239],a[216:219],v[120:123],v[236:239]
ds_read_b128 a[204:207],v4 offset:47104
v_add_f32 v18,v18,v58
v_mfma_f32_16x16x32_bf16 v[236:239],a[220:223],v[124:127],v[236:239]
s_waitcnt lgkmcnt(7)
v_add_f32 v18,v18,v59
v_cvt_pk_bf16_f32 v83,v58,v59
v_mfma_f32_16x16x32_bf16 v[48:51],a[160:163],a[0:3],v[24:27]
s_waitcnt lgkmcnt(5)
v_exp_f32 v60,v60
v_mfma_f32_16x16x32_bf16 v[48:51],a[164:167],a[4:7],v[48:51]
s_waitcnt lgkmcnt(1)
v_exp_f32 v61,v61
v_mfma_f32_16x16x32_bf16 v[48:51],a[168:171],a[8:11],v[48:51]
ds_read_b128 a[176:179],v2 offset:12288
v_add_f32 v19,v19,v60
v_mfma_f32_16x16x32_bf16 v[48:51],a[172:175],a[12:15],v[48:51]
v_add_f32 v19,v19,v61
v_cvt_pk_bf16_f32 v90,v60,v61
v_mfma_f32_16x16x32_bf16 v[144:147],a[192:195],v[96:99],v[144:147]
v_exp_f32 v62,v62
v_mfma_f32_16x16x32_bf16 v[144:147],a[196:199],v[100:103],v[144:147]
v_exp_f32 v63,v63
v_mfma_f32_16x16x32_bf16 v[176:179],a[192:195],v[104:107],v[176:179]
ds_read_b128 a[208:211],v4 offset:35840
v_add_f32 v19,v19,v62
v_mfma_f32_16x16x32_bf16 v[176:179],a[196:199],v[108:111],v[176:179]
v_add_f32 v19,v19,v63
v_cvt_pk_bf16_f32 v91,v62,v63
v_mfma_f32_16x16x32_bf16 v[52:55],a[160:163],a[16:19],v[28:31]
v_cndmask_b32 v56,v6,v32,s[48:49]
v_cndmask_b32 v57,v6,v32,s[50:51]
v_cndmask_b32 v58,v6,v32,s[52:53]
v_cndmask_b32 v59,v6,v32,s[54:55]
v_exp_f32 v48,v48
v_mfma_f32_16x16x32_bf16 v[52:55],a[164:167],a[20:23],v[52:55]
v_exp_f32 v49,v49
v_mfma_f32_16x16x32_bf16 v[52:55],a[168:171],a[24:27],v[52:55]
ds_read_b128 a[180:183],v2 offset:13312
v_add_f32 v16,v16,v48
v_mfma_f32_16x16x32_bf16 v[52:55],a[172:175],a[28:31],v[52:55]
v_add_f32 v16,v16,v49
v_cvt_pk_bf16_f32 v68,v48,v49
v_mfma_f32_16x16x32_bf16 v[208:211],a[192:195],v[112:115],v[208:211]
v_exp_f32 v50,v50
v_mfma_f32_16x16x32_bf16 v[208:211],a[196:199],v[116:119],v[208:211]
v_exp_f32 v51,v51
v_mfma_f32_16x16x32_bf16 v[240:243],a[192:195],v[120:123],v[240:243]
ds_read_b128 a[212:215],v4 offset:39936
v_add_f32 v16,v16,v50
v_mfma_f32_16x16x32_bf16 v[240:243],a[196:199],v[124:127],v[240:243]
v_add_f32 v16,v16,v51
v_cvt_pk_bf16_f32 v69,v50,v51
v_mfma_f32_16x16x32_bf16 v[56:59],a[160:163],a[32:35],v[56:59]
v_exp_f32 v52,v52
v_mfma_f32_16x16x32_bf16 v[56:59],a[164:167],a[36:39],v[56:59]
v_exp_f32 v53,v53
v_mfma_f32_16x16x32_bf16 v[56:59],a[168:171],a[40:43],v[56:59]
ds_read_b128 a[184:187],v2 offset:14336
v_add_f32 v17,v17,v52
v_mfma_f32_16x16x32_bf16 v[56:59],a[172:175],a[44:47],v[56:59]
v_add_f32 v17,v17,v53
v_cvt_pk_bf16_f32 v76,v52,v53
v_mfma_f32_16x16x32_bf16 v[148:151],a[200:203],v[96:99],v[148:151]
s_waitcnt lgkmcnt(5)
v_exp_f32 v54,v54
v_mfma_f32_16x16x32_bf16 v[148:151],a[204:207],v[100:103],v[148:151]
v_exp_f32 v55,v55
v_mfma_f32_16x16x32_bf16 v[180:183],a[200:203],v[104:107],v[180:183]
ds_read_b128 a[216:219],v4 offset:44032
v_add_f32 v17,v17,v54
v_mfma_f32_16x16x32_bf16 v[180:183],a[204:207],v[108:111],v[180:183]
v_add_f32 v17,v17,v55
v_cvt_pk_bf16_f32 v77,v54,v55
v_mfma_f32_16x16x32_bf16 v[60:63],a[160:163],a[48:51],v[36:39]
v_exp_f32 v56,v56
v_mfma_f32_16x16x32_bf16 v[60:63],a[164:167],a[52:55],v[60:63]
v_exp_f32 v57,v57
v_mfma_f32_16x16x32_bf16 v[60:63],a[168:171],a[56:59],v[60:63]
ds_read_b128 a[188:191],v2 offset:15360
v_add_f32 v18,v18,v56
v_mfma_f32_16x16x32_bf16 v[60:63],a[172:175],a[60:63],v[60:63]
v_add_f32 v18,v18,v57
v_cvt_pk_bf16_f32 v84,v56,v57
v_mfma_f32_16x16x32_bf16 v[212:215],a[200:203],v[112:115],v[212:215]
v_exp_f32 v58,v58
v_mfma_f32_16x16x32_bf16 v[212:215],a[204:207],v[116:119],v[212:215]
v_exp_f32 v59,v59
v_mfma_f32_16x16x32_bf16 v[244:247],a[200:203],v[120:123],v[244:247]
ds_read_b128 a[220:223],v4 offset:48128
v_add_f32 v18,v18,v58
v_mfma_f32_16x16x32_bf16 v[244:247],a[204:207],v[124:127],v[244:247]
s_waitcnt lgkmcnt(7)
v_add_f32 v18,v18,v59
v_cvt_pk_bf16_f32 v85,v58,v59
v_mfma_f32_16x16x32_bf16 v[48:51],a[176:179],a[0:3],v[24:27]
s_waitcnt lgkmcnt(5)
v_exp_f32 v60,v60
v_mfma_f32_16x16x32_bf16 v[48:51],a[180:183],a[4:7],v[48:51]
s_waitcnt lgkmcnt(3)
v_exp_f32 v61,v61
v_mfma_f32_16x16x32_bf16 v[48:51],a[184:187],a[8:11],v[48:51]
s_waitcnt lgkmcnt(1)
v_add_f32 v19,v19,v60
v_add_f32 v19,v19,v61
v_mfma_f32_16x16x32_bf16 v[48:51],a[188:191],a[12:15],v[48:51]
v_exp_f32 v62,v62
v_mfma_f32_16x16x32_bf16 v[152:155],a[208:211],v[96:99],v[152:155]
s_waitcnt vmcnt(1) lgkmcnt(0)
v_exp_f32 v63,v63
v_mfma_f32_16x16x32_bf16 v[152:155],a[212:215],v[100:103],v[152:155]
s_barrier
v_cvt_pk_bf16_f32 v92,v60,v61
v_add_f32 v19,v19,v62
v_mfma_f32_16x16x32_bf16 v[184:187],a[208:211],v[104:107],v[184:187]
ds_read_b128 a[160:163],v2 offset:32768
v_add_f32 v19,v19,v63
v_mfma_f32_16x16x32_bf16 v[184:187],a[212:215],v[108:111],v[184:187]
ds_read_b128 a[192:195],v4 offset:0
v_cvt_pk_bf16_f32 v93,v62,v63
v_mfma_f32_16x16x32_bf16 v[52:55],a[176:179],a[16:19],v[28:31]
s_add_u32 m0,s23,0
v_cndmask_b32 v56,v6,v32,s[56:57]
v_cndmask_b32 v57,v6,v32,s[58:59]
v_cndmask_b32 v58,v6,v32,s[60:61]
v_cndmask_b32 v59,v6,v32,s[62:63]
v_exp_f32 v48,v48
v_mfma_f32_16x16x32_bf16 v[52:55],a[180:183],a[20:23],v[52:55]
s_add_u32 s24,s24,16384
v_exp_f32 v49,v49
v_mfma_f32_16x16x32_bf16 v[52:55],a[184:187],a[24:27],v[52:55]
ds_read_b128 a[164:167],v2 offset:33792
v_add_f32 v16,v16,v48
v_mfma_f32_16x16x32_bf16 v[52:55],a[188:191],a[28:31],v[52:55]
buffer_load_dwordx4 v1,s[16:19],s24 offen offset:0 sc1 lds
v_add_f32 v16,v16,v49
v_cvt_pk_bf16_f32 v70,v48,v49
v_mfma_f32_16x16x32_bf16 v[216:219],a[208:211],v[112:115],v[216:219]
v_exp_f32 v50,v50
v_mfma_f32_16x16x32_bf16 v[216:219],a[212:215],v[116:119],v[216:219]
v_exp_f32 v51,v51
v_mfma_f32_16x16x32_bf16 v[248:251],a[208:211],v[120:123],v[248:251]
ds_read_b128 a[196:199],v4 offset:4096
v_add_f32 v16,v16,v50
v_mfma_f32_16x16x32_bf16 v[248:251],a[212:215],v[124:127],v[248:251]
buffer_load_dwordx4 v1,s[16:19],s24 offen offset:1024 sc1 lds
v_add_f32 v16,v16,v51
v_cvt_pk_bf16_f32 v71,v50,v51
v_mfma_f32_16x16x32_bf16 v[56:59],a[176:179],a[32:35],v[56:59]
v_exp_f32 v52,v52
v_mfma_f32_16x16x32_bf16 v[56:59],a[180:183],a[36:39],v[56:59]
v_exp_f32 v53,v53
v_mfma_f32_16x16x32_bf16 v[56:59],a[184:187],a[40:43],v[56:59]
ds_read_b128 a[168:171],v2 offset:34816
v_add_f32 v17,v17,v52
v_mfma_f32_16x16x32_bf16 v[56:59],a[188:191],a[44:47],v[56:59]
buffer_load_dwordx4 v1,s[16:19],s24 offen offset:2048 sc1 lds
v_add_f32 v17,v17,v53
v_cvt_pk_bf16_f32 v78,v52,v53
v_mfma_f32_16x16x32_bf16 v[156:159],a[216:219],v[96:99],v[156:159]
v_exp_f32 v54,v54
v_mfma_f32_16x16x32_bf16 v[156:159],a[220:223],v[100:103],v[156:159]
v_exp_f32 v55,v55
v_mfma_f32_16x16x32_bf16 v[188:191],a[216:219],v[104:107],v[188:191]
ds_read_b128 a[200:203],v4 offset:8192
v_add_f32 v17,v17,v54
v_mfma_f32_16x16x32_bf16 v[188:191],a[220:223],v[108:111],v[188:191]
buffer_load_dwordx4 v1,s[16:19],s24 offen offset:3072 sc1 lds
v_add_f32 v17,v17,v55
v_cvt_pk_bf16_f32 v79,v54,v55
v_mfma_f32_16x16x32_bf16 v[60:63],a[176:179],a[48:51],v[36:39]
s_add_u32 m0,s23,16384
v_exp_f32 v56,v56
v_mfma_f32_16x16x32_bf16 v[60:63],a[180:183],a[52:55],v[60:63]
s_add_u32 s24,s24,16384
v_exp_f32 v57,v57
v_mfma_f32_16x16x32_bf16 v[60:63],a[184:187],a[56:59],v[60:63]
ds_read_b128 a[172:175],v2 offset:35840
v_add_f32 v18,v18,v56
v_mfma_f32_16x16x32_bf16 v[60:63],a[188:191],a[60:63],v[60:63]
buffer_load_dwordx4 v1,s[16:19],s24 offen offset:0 sc1 lds
v_add_f32 v18,v18,v57
v_cvt_pk_bf16_f32 v86,v56,v57
v_mfma_f32_16x16x32_bf16 v[220:223],a[216:219],v[112:115],v[220:223]
v_exp_f32 v58,v58
v_mfma_f32_16x16x32_bf16 v[220:223],a[220:223],v[116:119],v[220:223]
s_waitcnt lgkmcnt(6)
v_exp_f32 v59,v59
v_mfma_f32_16x16x32_bf16 v[252:255],a[216:219],v[120:123],v[252:255]
ds_read_b128 a[204:207],v4 offset:12288
v_add_f32 v18,v18,v58
v_mfma_f32_16x16x32_bf16 v[252:255],a[220:223],v[124:127],v[252:255]
buffer_load_dwordx4 v1,s[16:19],s24 offen offset:1024 sc1 lds
v_add_f32 v18,v18,v59
v_cvt_pk_bf16_f32 v87,v58,v59
v_mfma_f32_16x16x32_bf16 v[48:51],a[160:163],a[0:3],v[24:27]
s_waitcnt lgkmcnt(3)
v_exp_f32 v60,v60
v_mfma_f32_16x16x32_bf16 v[48:51],a[164:167],a[4:7],v[48:51]
ds_read_b128 a[176:179],v2 offset:36864
v_exp_f32 v61,v61
v_mfma_f32_16x16x32_bf16 v[48:51],a[168:171],a[8:11],v[48:51]
s_waitcnt lgkmcnt(2)
v_add_f32 v19,v19,v60
v_mfma_f32_16x16x32_bf16 v[48:51],a[172:175],a[12:15],v[48:51]
buffer_load_dwordx4 v1,s[16:19],s24 offen offset:2048 sc1 lds
v_add_f32 v19,v19,v61
v_cvt_pk_bf16_f32 v94,v60,v61
v_mfma_f32_16x16x32_bf16 v[128:131],a[192:195],v[64:67],v[128:131]
s_and_b32 s28,s20,1
v_exp_f32 v62,v62
v_mfma_f32_16x16x32_bf16 v[128:131],a[196:199],v[68:71],v[128:131]
ds_read_b128 a[208:211],v4 offset:1024
v_exp_f32 v63,v63
v_mfma_f32_16x16x32_bf16 v[160:163],a[192:195],v[72:75],v[160:163]
s_lshl_b32 s28,s28,14
v_add_f32 v19,v19,v62
v_mfma_f32_16x16x32_bf16 v[160:163],a[196:199],v[76:79],v[160:163]
ds_read_b128 a[180:183],v2 offset:37888
v_add_f32 v19,v19,v63
v_cvt_pk_bf16_f32 v95,v62,v63
v_mfma_f32_16x16x32_bf16 v[192:195],a[192:195],v[80:83],v[192:195]
s_lshr_b32 s4,s20,1
buffer_load_dwordx4 v1,s[16:19],s24 offen offset:3072 sc1 lds
v_cndmask_b32 v56,v6,v36,s[32:33]
v_cndmask_b32 v57,v6,v36,s[34:35]
v_cndmask_b32 v58,v6,v36,s[36:37]
v_cndmask_b32 v59,v6,v36,s[38:39]
v_exp_f32 v48,v48
v_mfma_f32_16x16x32_bf16 v[192:195],a[196:199],v[84:87],v[192:195]
s_lshl_b32 s4,s4,13
s_add_u32 m0,s23,98304
v_exp_f32 v49,v49
v_mfma_f32_16x16x32_bf16 v[52:55],a[160:163],a[16:19],v[28:31]
ds_read_b128 a[212:215],v4 offset:5120
s_add_u32 s25,s25,16384
v_mfma_f32_16x16x32_bf16 v[52:55],a[164:167],a[20:23],v[52:55]
buffer_load_dwordx4 v1,s[16:19],s25 offen offset:0 sc1 lds
v_add_f32 v16,v16,v48
v_add_f32 v16,v16,v49
v_mfma_f32_16x16x32_bf16 v[52:55],a[168:171],a[24:27],v[52:55]
s_add_u32 s4,s4,s28
v_cvt_pk_bf16_f32 v96,v48,v49
v_mfma_f32_16x16x32_bf16 v[52:55],a[172:175],a[28:31],v[52:55]
ds_read_b128 a[184:187],v2 offset:38912
v_exp_f32 v50,v50
v_mfma_f32_16x16x32_bf16 v[224:227],a[192:195],v[88:91],v[224:227]
s_lshl_b32 s6,s21,17
v_exp_f32 v51,v51
v_mfma_f32_16x16x32_bf16 v[224:227],a[196:199],v[92:95],v[224:227]
buffer_load_dwordx4 v1,s[16:19],s25 offen offset:1024 sc1 lds
v_mfma_f32_16x16x32_bf16 v[132:135],a[200:203],v[64:67],v[132:135]
s_add_u32 s28,s21,1
v_add_f32 v16,v16,v50
v_add_f32 v16,v16,v51
s_waitcnt lgkmcnt(5)
v_mfma_f32_16x16x32_bf16 v[132:135],a[204:207],v[68:71],v[132:135]
ds_read_b128 a[216:219],v4 offset:9216
v_cvt_pk_bf16_f32 v97,v50,v51
v_mfma_f32_16x16x32_bf16 v[164:167],a[200:203],v[72:75],v[164:167]
s_and_b32 s28,s28,3
v_exp_f32 v52,v52
v_mfma_f32_16x16x32_bf16 v[164:167],a[204:207],v[76:79],v[164:167]
ds_read_b128 a[188:191],v2 offset:39936
v_exp_f32 v53,v53
v_mfma_f32_16x16x32_bf16 v[56:59],a[160:163],a[48:51],v[56:59]
s_and_b32 s7,s21,28
buffer_load_dwordx4 v1,s[16:19],s25 offen offset:2048 sc1 lds
v_mfma_f32_16x16x32_bf16 v[56:59],a[164:167],a[52:55],v[56:59]
s_add_u32 s7,s7,s28
v_add_f32 v17,v17,v52
v_add_f32 v17,v17,v53
v_mfma_f32_16x16x32_bf16 v[56:59],a[168:171],a[56:59],v[56:59]
v_cvt_pk_bf16_f32 v104,v52,v53
v_mfma_f32_16x16x32_bf16 v[56:59],a[172:175],a[60:63],v[56:59]
s_lshl_b32 s7,s7,17
v_exp_f32 v54,v54
v_mfma_f32_16x16x32_bf16 v[196:199],a[200:203],v[80:83],v[196:199]
ds_read_b128 a[160:163],v2 offset:40960
buffer_load_dwordx4 v1,s[16:19],s25 offen offset:3072 sc1 lds
v_exp_f32 v55,v55
v_mfma_f32_16x16x32_bf16 v[196:199],a[204:207],v[84:87],v[196:199]
ds_read_b128 a[220:223],v4 offset:13312
v_add_f32 v17,v17,v54
v_mfma_f32_16x16x32_bf16 v[228:231],a[200:203],v[88:91],v[228:231]
s_getpc_b64 s[30:31]
F_W5:
s_sub_u32 s30,s30,F_W5-F_PC
s_subb_u32 s31,s31,0
v_accvgpr_read_b32 v9,a251
global_load_dword a249,v9,s[30:31]
v_add_f32 v17,v17,v55
v_mfma_f32_16x16x32_bf16 v[228:231],a[204:207],v[92:95],v[228:231]
s_waitcnt lgkmcnt(8)
v_cvt_pk_bf16_f32 v105,v54,v55
v_mfma_f32_16x16x32_bf16 v[60:63],a[176:179],a[0:3],v[24:27]
s_waitcnt lgkmcnt(2)
v_accvgpr_read_b32 v0,a248
v_exp_f32 v56,v56
v_mfma_f32_16x16x32_bf16 v[60:63],a[180:183],a[4:7],v[60:63]
s_add_u32 m0,s4,131072
v_exp_f32 v57,v57
v_mfma_f32_16x16x32_bf16 v[60:63],a[184:187],a[8:11],v[60:63]
s_add_u32 s5,s6,0
v_add_f32 v19,v19,v56
v_add_f32 v19,v19,v57
v_mfma_f32_16x16x32_bf16 v[60:63],a[188:191],a[12:15],v[60:63]
ds_read_b128 a[164:167],v2 offset:41984
buffer_load_dwordx4 v0,s[12:15],s5 offen lds
v_cvt_pk_bf16_f32 v120,v56,v57
v_mfma_f32_16x16x32_bf16 v[136:139],a[208:211],v[64:67],v[136:139]
s_add_u32 m0,s4,132096
v_exp_f32 v58,v58
v_mfma_f32_16x16x32_bf16 v[136:139],a[212:215],v[68:71],v[136:139]
ds_read_b128 a[192:195],v4 offset:2048
v_exp_f32 v59,v59
v_mfma_f32_16x16x32_bf16 v[168:171],a[208:211],v[72:75],v[168:171]
s_add_u32 s5,s6,8192
v_add_f32 v19,v19,v58
v_add_f32 v19,v19,v59
v_mfma_f32_16x16x32_bf16 v[168:171],a[212:215],v[76:79],v[168:171]
buffer_load_dwordx4 v0,s[12:15],s5 offen lds
v_cvt_pk_bf16_f32 v121,v58,v59
v_mfma_f32_16x16x32_bf16 v[200:203],a[208:211],v[80:83],v[200:203]
s_add_u32 m0,s4,133120
v_cndmask_b32 v52,v6,v36,s[40:41]
v_cndmask_b32 v53,v6,v36,s[42:43]
v_cndmask_b32 v54,v6,v36,s[44:45]
v_cndmask_b32 v55,v6,v36,s[46:47]
v_exp_f32 v60,v60
v_mfma_f32_16x16x32_bf16 v[200:203],a[212:215],v[84:87],v[200:203]
s_add_u32 s5,s6,16384
v_exp_f32 v61,v61
v_mfma_f32_16x16x32_bf16 v[48:51],a[176:179],a[16:19],v[28:31]
ds_read_b128 a[168:171],v2 offset:43008
v_add_f32 v16,v16,v60
v_mfma_f32_16x16x32_bf16 v[48:51],a[180:183],a[20:23],v[48:51]
ds_read_b128 a[196:199],v4 offset:6144
buffer_load_dwordx4 v0,s[12:15],s5 offen lds
v_add_f32 v16,v16,v61
v_mfma_f32_16x16x32_bf16 v[48:51],a[184:187],a[24:27],v[48:51]
s_add_u32 m0,s4,134144
v_cvt_pk_bf16_f32 v98,v60,v61
v_mfma_f32_16x16x32_bf16 v[48:51],a[188:191],a[28:31],v[48:51]
s_add_u32 s5,s6,24576
v_exp_f32 v62,v62
v_mfma_f32_16x16x32_bf16 v[232:235],a[208:211],v[88:91],v[232:235]
s_waitcnt lgkmcnt(4)
v_exp_f32 v63,v63
v_mfma_f32_16x16x32_bf16 v[232:235],a[212:215],v[92:95],v[232:235]
buffer_load_dwordx4 v0,s[12:15],s5 offen lds
v_mfma_f32_16x16x32_bf16 v[140:143],a[216:219],v[64:67],v[140:143]
s_add_u32 m0,s4,135168
v_add_f32 v16,v16,v62
v_add_f32 v16,v16,v63
v_mfma_f32_16x16x32_bf16 v[140:143],a[220:223],v[68:71],v[140:143]
ds_read_b128 a[200:203],v4 offset:10240
v_cvt_pk_bf16_f32 v99,v62,v63
v_mfma_f32_16x16x32_bf16 v[172:175],a[216:219],v[72:75],v[172:175]
s_add_u32 s5,s6,32768
ds_read_b128 a[172:175],v2 offset:44032
v_exp_f32 v48,v48
v_mfma_f32_16x16x32_bf16 v[172:175],a[220:223],v[76:79],v[172:175]
buffer_load_dwordx4 v0,s[12:15],s5 offen lds
v_exp_f32 v49,v49
v_mfma_f32_16x16x32_bf16 v[52:55],a[176:179],a[48:51],v[52:55]
s_add_u32 m0,s4,136192
v_add_f32 v17,v17,v48
v_add_f32 v17,v17,v49
v_mfma_f32_16x16x32_bf16 v[52:55],a[180:183],a[52:55],v[52:55]
s_add_u32 s5,s6,40960
v_cvt_pk_bf16_f32 v106,v48,v49
v_mfma_f32_16x16x32_bf16 v[52:55],a[184:187],a[56:59],v[52:55]
v_exp_f32 v50,v50
v_mfma_f32_16x16x32_bf16 v[52:55],a[188:191],a[60:63],v[52:55]
ds_read_b128 a[176:179],v2 offset:45056
buffer_load_dwordx4 v0,s[12:15],s5 offen lds
v_mfma_f32_16x16x32_bf16 v[204:207],a[216:219],v[80:83],v[204:207]
s_add_u32 m0,s4,137216
v_exp_f32 v51,v51
v_mfma_f32_16x16x32_bf16 v[204:207],a[220:223],v[84:87],v[204:207]
ds_read_b128 a[204:207],v4 offset:14336
v_add_f32 v17,v17,v50
v_mfma_f32_16x16x32_bf16 v[236:239],a[216:219],v[88:91],v[236:239]
s_add_u32 s5,s6,49152
v_add_f32 v17,v17,v51
v_cvt_pk_bf16_f32 v107,v50,v51
v_mfma_f32_16x16x32_bf16 v[236:239],a[220:223],v[92:95],v[236:239]
buffer_load_dwordx4 v0,s[12:15],s5 offen lds
v_mfma_f32_16x16x32_bf16 v[56:59],a[160:163],a[0:3],v[24:27]
s_add_u32 m0,s4,138240
v_exp_f32 v52,v52
s_waitcnt lgkmcnt(7)
v_mfma_f32_16x16x32_bf16 v[56:59],a[164:167],a[4:7],v[56:59]
s_add_u32 s5,s6,57344
v_exp_f32 v53,v53
s_waitcnt lgkmcnt(5)
v_mfma_f32_16x16x32_bf16 v[56:59],a[168:171],a[8:11],v[56:59]
ds_read_b128 a[180:183],v2 offset:46080
v_add_f32 v19,v19,v52
s_waitcnt lgkmcnt(3)
v_mfma_f32_16x16x32_bf16 v[56:59],a[172:175],a[12:15],v[56:59]
buffer_load_dwordx4 v0,s[12:15],s5 offen lds
v_add_f32 v19,v19,v53
v_cvt_pk_bf16_f32 v122,v52,v53
v_mfma_f32_16x16x32_bf16 v[144:147],a[192:195],v[64:67],v[144:147]
v_exp_f32 v54,v54
v_mfma_f32_16x16x32_bf16 v[144:147],a[196:199],v[68:71],v[144:147]
ds_read_b128 a[208:211],v4 offset:3072
v_exp_f32 v55,v55
v_mfma_f32_16x16x32_bf16 v[176:179],a[192:195],v[72:75],v[176:179]
v_add_f32 v19,v19,v54
v_add_f32 v19,v19,v55
v_mfma_f32_16x16x32_bf16 v[176:179],a[196:199],v[76:79],v[176:179]
v_cvt_pk_bf16_f32 v123,v54,v55
v_mfma_f32_16x16x32_bf16 v[208:211],a[192:195],v[80:83],v[208:211]
v_cndmask_b32 v48,v6,v36,s[48:49]
v_cndmask_b32 v49,v6,v36,s[50:51]
v_cndmask_b32 v50,v6,v36,s[52:53]
v_cndmask_b32 v51,v6,v36,s[54:55]
v_exp_f32 v56,v56
v_mfma_f32_16x16x32_bf16 v[208:211],a[196:199],v[84:87],v[208:211]
v_exp_f32 v57,v57
v_mfma_f32_16x16x32_bf16 v[60:63],a[160:163],a[16:19],v[28:31]
ds_read_b128 a[184:187],v2 offset:47104
v_add_f32 v16,v16,v56
v_mfma_f32_16x16x32_bf16 v[60:63],a[164:167],a[20:23],v[60:63]
ds_read_b128 a[212:215],v4 offset:7168
v_add_f32 v16,v16,v57
v_mfma_f32_16x16x32_bf16 v[60:63],a[168:171],a[24:27],v[60:63]
v_cvt_pk_bf16_f32 v100,v56,v57
v_mfma_f32_16x16x32_bf16 v[60:63],a[172:175],a[28:31],v[60:63]
v_exp_f32 v58,v58
v_mfma_f32_16x16x32_bf16 v[240:243],a[192:195],v[88:91],v[240:243]
v_exp_f32 v59,v59
v_mfma_f32_16x16x32_bf16 v[240:243],a[196:199],v[92:95],v[240:243]
s_waitcnt lgkmcnt(4)
v_add_f32 v16,v16,v58
v_add_f32 v16,v16,v59
v_mfma_f32_16x16x32_bf16 v[148:151],a[200:203],v[64:67],v[148:151]
ds_read_b128 a[216:219],v4 offset:11264
v_cvt_pk_bf16_f32 v101,v58,v59
v_mfma_f32_16x16x32_bf16 v[148:151],a[204:207],v[68:71],v[148:151]
ds_read_b128 a[188:191],v2 offset:48128
v_mfma_f32_16x16x32_bf16 v[180:183],a[200:203],v[72:75],v[180:183]
v_exp_f32 v60,v60
v_mfma_f32_16x16x32_bf16 v[180:183],a[204:207],v[76:79],v[180:183]
v_exp_f32 v61,v61
v_mfma_f32_16x16x32_bf16 v[48:51],a[160:163],a[48:51],v[48:51]
v_add_f32 v17,v17,v60
v_add_f32 v17,v17,v61
v_mfma_f32_16x16x32_bf16 v[48:51],a[164:167],a[52:55],v[48:51]
v_cvt_pk_bf16_f32 v108,v60,v61
v_mfma_f32_16x16x32_bf16 v[48:51],a[168:171],a[56:59],v[48:51]
v_exp_f32 v62,v62
v_mfma_f32_16x16x32_bf16 v[48:51],a[172:175],a[60:63],v[48:51]
v_exp_f32 v63,v63
v_mfma_f32_16x16x32_bf16 v[212:215],a[200:203],v[80:83],v[212:215]
ds_read_b128 a[220:223],v4 offset:15360
v_add_f32 v17,v17,v62
v_mfma_f32_16x16x32_bf16 v[212:215],a[204:207],v[84:87],v[212:215]
v_add_f32 v17,v17,v63
v_cvt_pk_bf16_f32 v109,v62,v63
v_mfma_f32_16x16x32_bf16 v[244:247],a[200:203],v[88:91],v[244:247]
v_mfma_f32_16x16x32_bf16 v[244:247],a[204:207],v[92:95],v[244:247]
v_mfma_f32_16x16x32_bf16 v[52:55],a[176:179],a[0:3],v[24:27]
s_waitcnt lgkmcnt(6)
v_exp_f32 v48,v48
v_mfma_f32_16x16x32_bf16 v[52:55],a[180:183],a[4:7],v[52:55]
s_waitcnt lgkmcnt(4)
v_exp_f32 v49,v49
v_mfma_f32_16x16x32_bf16 v[52:55],a[184:187],a[8:11],v[52:55]
s_waitcnt lgkmcnt(1)
v_add_f32 v19,v19,v48
v_add_f32 v19,v19,v49
v_mfma_f32_16x16x32_bf16 v[52:55],a[188:191],a[12:15],v[52:55]
v_cvt_pk_bf16_f32 v124,v48,v49
v_mfma_f32_16x16x32_bf16 v[152:155],a[208:211],v[64:67],v[152:155]
v_exp_f32 v50,v50
v_mfma_f32_16x16x32_bf16 v[152:155],a[212:215],v[68:71],v[152:155]
v_exp_f32 v51,v51
v_mfma_f32_16x16x32_bf16 v[184:187],a[208:211],v[72:75],v[184:187]
v_add_f32 v19,v19,v50
v_add_f32 v19,v19,v51
v_mfma_f32_16x16x32_bf16 v[184:187],a[212:215],v[76:79],v[184:187]
s_waitcnt vmcnt(9) lgkmcnt(0)
v_cvt_pk_bf16_f32 v125,v50,v51
v_mfma_f32_16x16x32_bf16 v[216:219],a[208:211],v[80:83],v[216:219]
s_barrier
v_cndmask_b32 v60,v6,v36,s[56:57]
v_cndmask_b32 v61,v6,v36,s[58:59]
v_cndmask_b32 v62,v6,v36,s[60:61]
v_cndmask_b32 v63,v6,v36,s[62:63]
v_exp_f32 v52,v52
v_mfma_f32_16x16x32_bf16 v[216:219],a[212:215],v[84:87],v[216:219]
s_add_u32 m0,s23,65536
v_exp_f32 v53,v53
v_mfma_f32_16x16x32_bf16 v[56:59],a[176:179],a[16:19],v[28:31]
ds_read_b128 a[160:163],v2 offset:0
v_add_f32 v16,v16,v52
v_mfma_f32_16x16x32_bf16 v[56:59],a[180:183],a[20:23],v[56:59]
s_add_u32 s25,s25,16384
v_add_f32 v16,v16,v53
v_cvt_pk_bf16_f32 v102,v52,v53
v_mfma_f32_16x16x32_bf16 v[56:59],a[184:187],a[24:27],v[56:59]
ds_read_b128 a[192:195],v4 offset:32768
v_mfma_f32_16x16x32_bf16 v[56:59],a[188:191],a[28:31],v[56:59]
buffer_load_dwordx4 v1,s[16:19],s25 offen offset:0 sc1 lds
v_exp_f32 v54,v54
v_mfma_f32_16x16x32_bf16 v[248:251],a[208:211],v[88:91],v[248:251]
ds_read_b128 a[164:167],v2 offset:1024
v_exp_f32 v55,v55
v_mfma_f32_16x16x32_bf16 v[248:251],a[212:215],v[92:95],v[248:251]
buffer_load_dwordx4 v1,s[16:19],s25 offen offset:1024 sc1 lds
v_mfma_f32_16x16x32_bf16 v[156:159],a[216:219],v[64:67],v[156:159]
ds_read_b128 a[196:199],v4 offset:36864
v_add_f32 v16,v16,v54
v_add_f32 v16,v16,v55
v_mfma_f32_16x16x32_bf16 v[156:159],a[220:223],v[68:71],v[156:159]
buffer_load_dwordx4 v1,s[16:19],s25 offen offset:2048 sc1 lds
v_cvt_pk_bf16_f32 v103,v54,v55
v_mfma_f32_16x16x32_bf16 v[188:191],a[216:219],v[72:75],v[188:191]
v_exp_f32 v56,v56
v_mfma_f32_16x16x32_bf16 v[188:191],a[220:223],v[76:79],v[188:191]
ds_read_b128 a[168:171],v2 offset:2048
v_exp_f32 v57,v57
v_mfma_f32_16x16x32_bf16 v[60:63],a[176:179],a[48:51],v[60:63]
buffer_load_dwordx4 v1,s[16:19],s25 offen offset:3072 sc1 lds
v_mfma_f32_16x16x32_bf16 v[60:63],a[180:183],a[52:55],v[60:63]
ds_read_b128 a[200:203],v4 offset:40960
s_add_u32 m0,s23,81920
v_add_f32 v17,v17,v56
v_add_f32 v17,v17,v57
v_mfma_f32_16x16x32_bf16 v[60:63],a[184:187],a[56:59],v[60:63]
ds_read_b128 a[172:175],v2 offset:3072
s_add_u32 s25,s25,16384
v_cvt_pk_bf16_f32 v110,v56,v57
v_mfma_f32_16x16x32_bf16 v[60:63],a[188:191],a[60:63],v[60:63]
buffer_load_dwordx4 v1,s[16:19],s25 offen offset:0 sc1 lds
v_exp_f32 v58,v58
v_mfma_f32_16x16x32_bf16 v[220:223],a[216:219],v[80:83],v[220:223]
v_exp_f32 v59,v59
v_mfma_f32_16x16x32_bf16 v[220:223],a[220:223],v[84:87],v[220:223]
ds_read_b128 a[204:207],v4 offset:45056
buffer_load_dwordx4 v1,s[16:19],s25 offen offset:1024 sc1 lds
v_mfma_f32_16x16x32_bf16 v[252:255],a[216:219],v[88:91],v[252:255]
v_add_f32 v17,v17,v58
v_add_f32 v17,v17,v59
v_mfma_f32_16x16x32_bf16 v[252:255],a[220:223],v[92:95],v[252:255]
s_waitcnt lgkmcnt(7)
v_cvt_pk_bf16_f32 v111,v58,v59
v_mfma_f32_16x16x32_bf16 v[56:59],a[160:163],a[80:83],v[44:47]
s_waitcnt lgkmcnt(3)
v_exp_f32 v60,v60
v_mfma_f32_16x16x32_bf16 v[56:59],a[164:167],a[84:87],v[56:59]
ds_read_b128 a[176:179],v2 offset:4096
v_exp_f32 v61,v61
v_mfma_f32_16x16x32_bf16 v[56:59],a[168:171],a[88:91],v[56:59]
s_waitcnt lgkmcnt(2)
v_add_f32 v19,v19,v60
v_add_f32 v19,v19,v61
v_mfma_f32_16x16x32_bf16 v[56:59],a[172:175],a[92:95],v[56:59]
buffer_load_dwordx4 v1,s[16:19],s25 offen offset:2048 sc1 lds
v_cvt_pk_bf16_f32 v126,v60,v61
v_mfma_f32_16x16x32_bf16 v[128:131],a[192:195],v[96:99],v[128:131]
v_exp_f32 v62,v62
v_mfma_f32_16x16x32_bf16 v[128:131],a[196:199],v[100:103],v[128:131]
ds_read_b128 a[208:211],v4 offset:33792
v_exp_f32 v63,v63
v_mfma_f32_16x16x32_bf16 v[160:163],a[192:195],v[104:107],v[160:163]
v_add_f32 v19,v19,v62
v_add_f32 v19,v19,v63
v_cvt_pk_bf16_f32 v127,v62,v63
v_mfma_f32_16x16x32_bf16 v[160:163],a[196:199],v[108:111],v[160:163]
ds_read_b128 a[180:183],v2 offset:5120
v_mfma_f32_16x16x32_bf16 v[224:227],a[192:195],v[120:123],v[224:227]
buffer_load_dwordx4 v1,s[16:19],s25 offen offset:3072 sc1 lds
v_exp_f32 v56,v56
v_mfma_f32_16x16x32_bf16 v[224:227],a[196:199],v[124:127],v[224:227]
v_exp_f32 v57,v57
v_mfma_f32_16x16x32_bf16 v[60:63],a[160:163],a[64:67],v[40:43]
ds_read_b128 a[212:215],v4 offset:37888
v_add_f32 v21,v21,v56
v_mfma_f32_16x16x32_bf16 v[60:63],a[164:167],a[68:71],v[60:63]
v_add_f32 v21,v21,v57
v_cvt_pk_bf16_f32 v88,v56,v57
v_mfma_f32_16x16x32_bf16 v[60:63],a[168:171],a[72:75],v[60:63]
s_add_u32 m0,s4,32768
v_exp_f32 v58,v58
v_mfma_f32_16x16x32_bf16 v[60:63],a[172:175],a[76:79],v[60:63]
s_add_u32 s5,s7,0
v_exp_f32 v59,v59
v_mfma_f32_16x16x32_bf16 v[132:135],a[200:203],v[96:99],v[132:135]
ds_read_b128 a[216:219],v4 offset:41984
v_add_f32 v21,v21,v58
s_waitcnt lgkmcnt(5)
v_mfma_f32_16x16x32_bf16 v[132:135],a[204:207],v[100:103],v[132:135]
ds_read_b128 a[184:187],v2 offset:6144
buffer_load_dwordx4 v0,s[12:15],s5 offen lds
v_mfma_f32_16x16x32_bf16 v[164:167],a[200:203],v[104:107],v[164:167]
s_add_u32 m0,s4,33792
v_add_f32 v21,v21,v59
v_cvt_pk_bf16_f32 v89,v58,v59
v_mfma_f32_16x16x32_bf16 v[164:167],a[204:207],v[108:111],v[164:167]
s_add_u32 s5,s7,8192
v_cndmask_b32 v52,v6,v24,s[64:65]
v_cndmask_b32 v53,v6,v24,s[66:67]
v_mfma_f32_16x16x32_bf16 v[48:51],a[160:163],a[16:19],v[28:31]
v_cndmask_b32 v54,v6,v24,s[68:69]
v_cndmask_b32 v55,v6,v24,s[70:71]
v_exp_f32 v60,v60
v_mfma_f32_16x16x32_bf16 v[48:51],a[164:167],a[20:23],v[48:51]
ds_read_b128 a[220:223],v4 offset:46080
buffer_load_dwordx4 v0,s[12:15],s5 offen lds
v_exp_f32 v61,v61
v_mfma_f32_16x16x32_bf16 v[48:51],a[168:171],a[24:27],v[48:51]
s_add_u32 m0,s4,34816
v_add_f32 v20,v20,v60
v_add_f32 v20,v20,v61
v_mfma_f32_16x16x32_bf16 v[48:51],a[172:175],a[28:31],v[48:51]
s_add_u32 s5,s7,16384
v_cvt_pk_bf16_f32 v80,v60,v61
v_mfma_f32_16x16x32_bf16 v[228:231],a[200:203],v[120:123],v[228:231]
s_waitcnt lgkmcnt(3)
v_exp_f32 v62,v62
v_mfma_f32_16x16x32_bf16 v[228:231],a[204:207],v[124:127],v[228:231]
ds_read_b128 a[188:191],v2 offset:7168
buffer_load_dwordx4 v0,s[12:15],s5 offen lds
v_exp_f32 v63,v63
v_mfma_f32_16x16x32_bf16 v[136:139],a[208:211],v[96:99],v[136:139]
s_add_u32 m0,s4,35840
v_add_f32 v20,v20,v62
v_add_f32 v20,v20,v63
v_mfma_f32_16x16x32_bf16 v[136:139],a[212:215],v[100:103],v[136:139]
ds_read_b128 a[192:195],v4 offset:34816
v_cvt_pk_bf16_f32 v81,v62,v63
v_mfma_f32_16x16x32_bf16 v[52:55],a[160:163],a[0:3],v[52:55]
s_add_u32 s5,s7,24576
v_exp_f32 v48,v48
v_mfma_f32_16x16x32_bf16 v[52:55],a[164:167],a[4:7],v[52:55]
buffer_load_dwordx4 v0,s[12:15],s5 offen lds
v_exp_f32 v49,v49
v_mfma_f32_16x16x32_bf16 v[52:55],a[168:171],a[8:11],v[52:55]
s_add_u32 m0,s4,36864
v_add_f32 v17,v17,v48
v_add_f32 v17,v17,v49
v_mfma_f32_16x16x32_bf16 v[52:55],a[172:175],a[12:15],v[52:55]
s_add_u32 s5,s7,32768
v_cvt_pk_bf16_f32 v72,v48,v49
v_mfma_f32_16x16x32_bf16 v[168:171],a[208:211],v[104:107],v[168:171]
ds_read_b128 a[160:163],v2 offset:24576
v_exp_f32 v50,v50
v_mfma_f32_16x16x32_bf16 v[168:171],a[212:215],v[108:111],v[168:171]
ds_read_b128 a[196:199],v4 offset:38912
buffer_load_dwordx4 v0,s[12:15],s5 offen lds
v_exp_f32 v51,v51
v_mfma_f32_16x16x32_bf16 v[232:235],a[208:211],v[120:123],v[232:235]
s_add_u32 m0,s4,37888
v_add_f32 v17,v17,v50
v_add_f32 v17,v17,v51
v_mfma_f32_16x16x32_bf16 v[232:235],a[212:215],v[124:127],v[232:235]
s_add_u32 s5,s7,40960
v_cvt_pk_bf16_f32 v73,v50,v51
v_mfma_f32_16x16x32_bf16 v[56:59],a[176:179],a[80:83],v[44:47]
s_waitcnt lgkmcnt(3)
v_exp_f32 v52,v52
v_mfma_f32_16x16x32_bf16 v[56:59],a[180:183],a[84:87],v[56:59]
buffer_load_dwordx4 v0,s[12:15],s5 offen lds
v_exp_f32 v53,v53
v_mfma_f32_16x16x32_bf16 v[56:59],a[184:187],a[88:91],v[56:59]
s_add_u32 m0,s4,38912
v_add_f32 v16,v16,v52
v_add_f32 v16,v16,v53
v_mfma_f32_16x16x32_bf16 v[56:59],a[188:191],a[92:95],v[56:59]
s_add_u32 s5,s7,49152
v_cvt_pk_bf16_f32 v64,v52,v53
v_mfma_f32_16x16x32_bf16 v[140:143],a[216:219],v[96:99],v[140:143]
v_exp_f32 v54,v54
v_mfma_f32_16x16x32_bf16 v[140:143],a[220:223],v[100:103],v[140:143]
ds_read_b128 a[164:167],v2 offset:25600
ds_read_b128 a[200:203],v4 offset:43008
buffer_load_dwordx4 v0,s[12:15],s5 offen lds
v_exp_f32 v55,v55
v_mfma_f32_16x16x32_bf16 v[172:175],a[216:219],v[104:107],v[172:175]
v_add_f32 v16,v16,v54
v_add_f32 v16,v16,v55
v_mfma_f32_16x16x32_bf16 v[172:175],a[220:223],v[108:111],v[172:175]
v_cvt_pk_bf16_f32 v65,v54,v55
v_mfma_f32_16x16x32_bf16 v[60:63],a[176:179],a[64:67],v[40:43]
v_exp_f32 v56,v56
v_mfma_f32_16x16x32_bf16 v[60:63],a[180:183],a[68:71],v[60:63]
v_exp_f32 v57,v57
v_mfma_f32_16x16x32_bf16 v[60:63],a[184:187],a[72:75],v[60:63]
ds_read_b128 a[204:207],v4 offset:47104
v_add_f32 v21,v21,v56
v_mfma_f32_16x16x32_bf16 v[60:63],a[188:191],a[76:79],v[60:63]
v_add_f32 v21,v21,v57
v_cvt_pk_bf16_f32 v90,v56,v57
v_mfma_f32_16x16x32_bf16 v[236:239],a[216:219],v[120:123],v[236:239]
v_exp_f32 v58,v58
v_mfma_f32_16x16x32_bf16 v[236:239],a[220:223],v[124:127],v[236:239]
s_waitcnt lgkmcnt(3)
v_exp_f32 v59,v59
v_mfma_f32_16x16x32_bf16 v[144:147],a[192:195],v[96:99],v[144:147]
ds_read_b128 a[168:171],v2 offset:26624
v_add_f32 v21,v21,v58
v_mfma_f32_16x16x32_bf16 v[144:147],a[196:199],v[100:103],v[144:147]
ds_read_b128 a[208:211],v4 offset:35840
v_add_f32 v21,v21,v59
v_cvt_pk_bf16_f32 v91,v58,v59
v_mfma_f32_16x16x32_bf16 v[176:179],a[192:195],v[104:107],v[176:179]
v_cndmask_b32 v52,v6,v24,s[72:73]
v_cndmask_b32 v53,v6,v24,s[74:75]
v_cndmask_b32 v54,v6,v24,s[76:77]
v_cndmask_b32 v55,v6,v24,s[78:79]
v_exp_f32 v60,v60
v_mfma_f32_16x16x32_bf16 v[176:179],a[196:199],v[108:111],v[176:179]
v_exp_f32 v61,v61
v_mfma_f32_16x16x32_bf16 v[48:51],a[176:179],a[16:19],v[28:31]
v_add_f32 v20,v20,v60
v_add_f32 v20,v20,v61
v_mfma_f32_16x16x32_bf16 v[48:51],a[180:183],a[20:23],v[48:51]
ds_read_b128 a[212:215],v4 offset:39936
v_cvt_pk_bf16_f32 v82,v60,v61
v_mfma_f32_16x16x32_bf16 v[48:51],a[184:187],a[24:27],v[48:51]
v_exp_f32 v62,v62
v_mfma_f32_16x16x32_bf16 v[48:51],a[188:191],a[28:31],v[48:51]
v_exp_f32 v63,v63
v_mfma_f32_16x16x32_bf16 v[240:243],a[192:195],v[120:123],v[240:243]
ds_read_b128 a[172:175],v2 offset:27648
v_add_f32 v20,v20,v62
v_mfma_f32_16x16x32_bf16 v[240:243],a[196:199],v[124:127],v[240:243]
s_waitcnt lgkmcnt(4)
v_add_f32 v20,v20,v63
v_cvt_pk_bf16_f32 v83,v62,v63
v_mfma_f32_16x16x32_bf16 v[148:151],a[200:203],v[96:99],v[148:151]
ds_read_b128 a[216:219],v4 offset:44032
v_mfma_f32_16x16x32_bf16 v[148:151],a[204:207],v[100:103],v[148:151]
v_cndmask_b32 v56,v6,v28,s[64:65]
v_cndmask_b32 v57,v6,v28,s[66:67]
v_mfma_f32_16x16x32_bf16 v[52:55],a[176:179],a[0:3],v[52:55]
v_cndmask_b32 v58,v6,v28,s[68:69]
v_cndmask_b32 v59,v6,v28,s[70:71]
v_exp_f32 v48,v48
v_mfma_f32_16x16x32_bf16 v[52:55],a[180:183],a[4:7],v[52:55]
v_exp_f32 v49,v49
v_mfma_f32_16x16x32_bf16 v[52:55],a[184:187],a[8:11],v[52:55]
v_add_f32 v17,v17,v48
v_add_f32 v17,v17,v49
v_mfma_f32_16x16x32_bf16 v[52:55],a[188:191],a[12:15],v[52:55]
ds_read_b128 a[176:179],v2 offset:28672
v_cvt_pk_bf16_f32 v74,v48,v49
v_mfma_f32_16x16x32_bf16 v[180:183],a[200:203],v[104:107],v[180:183]
v_exp_f32 v50,v50
v_mfma_f32_16x16x32_bf16 v[180:183],a[204:207],v[108:111],v[180:183]
v_exp_f32 v51,v51
v_mfma_f32_16x16x32_bf16 v[244:247],a[200:203],v[120:123],v[244:247]
ds_read_b128 a[180:183],v2 offset:29696
ds_read_b128 a[220:223],v4 offset:48128
v_add_f32 v17,v17,v50
v_mfma_f32_16x16x32_bf16 v[244:247],a[204:207],v[124:127],v[244:247]
v_add_f32 v17,v17,v51
v_cvt_pk_bf16_f32 v75,v50,v51
v_mfma_f32_16x16x32_bf16 v[56:59],a[160:163],a[16:19],v[56:59]
ds_read_b128 a[184:187],v2 offset:30720
v_cndmask_b32 v60,v6,v28,s[72:73]
v_cndmask_b32 v61,v6,v28,s[74:75]
v_cndmask_b32 v62,v6,v28,s[76:77]
v_cndmask_b32 v63,v6,v28,s[78:79]
v_exp_f32 v52,v52
v_mfma_f32_16x16x32_bf16 v[56:59],a[164:167],a[20:23],v[56:59]
s_waitcnt lgkmcnt(5)
v_exp_f32 v53,v53
v_mfma_f32_16x16x32_bf16 v[56:59],a[168:171],a[24:27],v[56:59]
ds_read_b128 a[188:191],v2 offset:31744
v_add_f32 v16,v16,v52
v_mfma_f32_16x16x32_bf16 v[56:59],a[172:175],a[28:31],v[56:59]
v_add_f32 v16,v16,v53
v_cvt_pk_bf16_f32 v66,v52,v53
v_mfma_f32_16x16x32_bf16 v[152:155],a[208:211],v[96:99],v[152:155]
v_exp_f32 v54,v54
v_mfma_f32_16x16x32_bf16 v[152:155],a[212:215],v[100:103],v[152:155]
v_exp_f32 v55,v55
v_mfma_f32_16x16x32_bf16 v[184:187],a[208:211],v[104:107],v[184:187]
v_add_f32 v16,v16,v54
v_add_f32 v16,v16,v55
v_mfma_f32_16x16x32_bf16 v[184:187],a[212:215],v[108:111],v[184:187]
s_waitcnt lgkmcnt(4)
v_cvt_pk_bf16_f32 v67,v54,v55
v_mfma_f32_16x16x32_bf16 v[60:63],a[176:179],a[16:19],v[60:63]
s_waitcnt lgkmcnt(3)
v_exp_f32 v56,v56
v_mfma_f32_16x16x32_bf16 v[60:63],a[180:183],a[20:23],v[60:63]
s_waitcnt lgkmcnt(1)
v_exp_f32 v57,v57
v_mfma_f32_16x16x32_bf16 v[60:63],a[184:187],a[24:27],v[60:63]
s_waitcnt lgkmcnt(0)
v_add_f32 v17,v17,v56
v_add_f32 v17,v17,v57
v_mfma_f32_16x16x32_bf16 v[60:63],a[188:191],a[28:31],v[60:63]
s_waitcnt vmcnt(7) lgkmcnt(0)
v_cvt_pk_bf16_f32 v76,v56,v57
v_mfma_f32_16x16x32_bf16 v[248:251],a[208:211],v[120:123],v[248:251]
s_barrier
v_exp_f32 v58,v58
v_mfma_f32_16x16x32_bf16 v[248:251],a[212:215],v[124:127],v[248:251]
v_exp_f32 v59,v59
v_mfma_f32_16x16x32_bf16 v[156:159],a[216:219],v[96:99],v[156:159]
ds_read_b128 a[192:195],v4 offset:0
v_add_f32 v17,v17,v58
v_mfma_f32_16x16x32_bf16 v[156:159],a[220:223],v[100:103],v[156:159]
ds_read_b128 a[196:199],v4 offset:20480
v_add_f32 v17,v17,v59
v_cvt_pk_bf16_f32 v77,v58,v59
v_mfma_f32_16x16x32_bf16 v[188:191],a[216:219],v[104:107],v[188:191]
v_exp_f32 v60,v60
v_mfma_f32_16x16x32_bf16 v[188:191],a[220:223],v[108:111],v[188:191]
ds_read_b128 a[200:203],v4 offset:8192
v_exp_f32 v61,v61
v_mfma_f32_16x16x32_bf16 v[252:255],a[216:219],v[120:123],v[252:255]
ds_read_b128 a[204:207],v4 offset:28672
v_add_f32 v17,v17,v60
v_mfma_f32_16x16x32_bf16 v[252:255],a[220:223],v[124:127],v[252:255]
s_waitcnt lgkmcnt(3)
v_add_f32 v17,v17,v61
v_cvt_pk_bf16_f32 v78,v60,v61
v_mfma_f32_16x16x32_bf16 a[128:131],a[192:195],v[88:91],a[128:131]
v_exp_f32 v62,v62
v_mfma_f32_16x16x32_bf16 a[96:99],a[192:195],v[80:83],a[96:99]
ds_read_b128 a[208:211],v4 offset:1024
v_exp_f32 v63,v63
v_add_f32 v17,v17,v62
v_add_f32 v17,v17,v63
v_cvt_pk_bf16_f32 v79,v62,v63
v_mfma_f32_16x16x32_bf16 v[128:131],a[192:195],v[64:67],v[128:131]
ds_read_b128 a[212:215],v4 offset:21504
v_mfma_f32_16x16x32_bf16 v[160:163],a[192:195],v[72:75],v[160:163]
s_waitcnt lgkmcnt(4)
v_mfma_f32_16x16x32_bf16 v[160:163],a[196:199],v[76:79],v[160:163]
s_waitcnt lgkmcnt(3)
v_mov_b32 v8,v18
v_mov_b32 v9,v19
v_mfma_f32_16x16x32_bf16 a[132:135],a[200:203],v[88:91],a[132:135]
ds_read_b128 a[216:219],v4 offset:9216
v_permlane32_swap_b32 v8,v18
v_mfma_f32_16x16x32_bf16 a[100:103],a[200:203],v[80:83],a[100:103]
ds_write_b128 v12,a[128:131] offset:8192
v_mfma_f32_16x16x32_bf16 v[132:135],a[200:203],v[64:67],v[132:135]
ds_write_b128 v12,a[96:99] offset:0
v_mfma_f32_16x16x32_bf16 v[164:167],a[200:203],v[72:75],v[164:167]
ds_read_b128 a[220:223],v4 offset:29696
v_permlane32_swap_b32 v9,v19
s_waitcnt lgkmcnt(6)
v_mfma_f32_16x16x32_bf16 v[164:167],a[204:207],v[76:79],v[164:167]
s_waitcnt lgkmcnt(5)
v_add_f32 v18,v18,v8
v_add_f32 v19,v19,v9
v_mfma_f32_16x16x32_bf16 a[136:139],a[208:211],v[88:91],a[136:139]
ds_read_b128 a[192:195],v4 offset:2048
v_mov_b32 v8,v18
v_mfma_f32_16x16x32_bf16 a[104:107],a[208:211],v[80:83],a[104:107]
ds_write_b128 v12,a[132:135] offset:9216
v_mfma_f32_16x16x32_bf16 v[136:139],a[208:211],v[64:67],v[136:139]
ds_write_b128 v12,a[100:103] offset:1024
v_mfma_f32_16x16x32_bf16 v[168:171],a[208:211],v[72:75],v[168:171]
ds_read_b128 a[196:199],v4 offset:22528
v_mov_b32 v9,v19
s_waitcnt lgkmcnt(8)
v_mfma_f32_16x16x32_bf16 v[168:171],a[212:215],v[76:79],v[168:171]
s_waitcnt lgkmcnt(7)
v_permlane16_swap_b32 v8,v18
v_permlane16_swap_b32 v9,v19
v_mfma_f32_16x16x32_bf16 a[140:143],a[216:219],v[88:91],a[140:143]
ds_read_b128 a[200:203],v4 offset:10240
v_add_f32 v18,v18,v8
v_mfma_f32_16x16x32_bf16 a[108:111],a[216:219],v[80:83],a[108:111]
ds_write_b128 v12,a[136:139] offset:10240
v_mfma_f32_16x16x32_bf16 v[140:143],a[216:219],v[64:67],v[140:143]
ds_write_b128 v12,a[104:107] offset:2048
v_mfma_f32_16x16x32_bf16 v[172:175],a[216:219],v[72:75],v[172:175]
ds_read_b128 a[204:207],v4 offset:30720
v_add_f32 v19,v19,v9
s_waitcnt lgkmcnt(8)
v_mfma_f32_16x16x32_bf16 v[172:175],a[220:223],v[76:79],v[172:175]
s_waitcnt lgkmcnt(7)
v_rcp_f32 v8,v18
v_mfma_f32_16x16x32_bf16 a[144:147],a[192:195],v[88:91],a[144:147]
v_rcp_f32 v9,v19
v_mfma_f32_16x16x32_bf16 a[112:115],a[192:195],v[80:83],a[112:115]
ds_read_b128 a[208:211],v4 offset:3072
v_mul_f32 v192,v8,v192
v_mfma_f32_16x16x32_bf16 v[144:147],a[192:195],v[64:67],v[144:147]
ds_write_b128 v12,a[140:143] offset:11264
v_mfma_f32_16x16x32_bf16 v[176:179],a[192:195],v[72:75],v[176:179]
ds_write_b128 v12,a[108:111] offset:3072
ds_read_b128 a[212:215],v4 offset:23552
s_waitcnt lgkmcnt(8)
v_mfma_f32_16x16x32_bf16 v[176:179],a[196:199],v[76:79],v[176:179]
s_waitcnt lgkmcnt(7)
v_mul_f32 v193,v8,v193
v_mul_f32 v194,v8,v194
v_mfma_f32_16x16x32_bf16 a[148:151],a[200:203],v[88:91],a[148:151]
ds_read_b128 a[216:219],v4 offset:11264
v_mul_f32 v195,v8,v195
v_mfma_f32_16x16x32_bf16 a[116:119],a[200:203],v[80:83],a[116:119]
ds_write_b128 v12,a[144:147] offset:12288
v_mfma_f32_16x16x32_bf16 v[148:151],a[200:203],v[64:67],v[148:151]
ds_write_b128 v12,a[112:115] offset:4096
v_mfma_f32_16x16x32_bf16 v[180:183],a[200:203],v[72:75],v[180:183]
ds_read_b128 a[220:223],v4 offset:31744
v_mul_f32 v196,v8,v196
s_waitcnt lgkmcnt(8)
v_mfma_f32_16x16x32_bf16 v[180:183],a[204:207],v[76:79],v[180:183]
s_waitcnt lgkmcnt(7)
v_mul_f32 v197,v8,v197
v_mul_f32 v198,v8,v198
v_mfma_f32_16x16x32_bf16 a[152:155],a[208:211],v[88:91],a[152:155]
ds_write_b128 v12,a[148:151] offset:13312
v_mfma_f32_16x16x32_bf16 a[120:123],a[208:211],v[80:83],a[120:123]
ds_write_b128 v12,a[116:119] offset:5120
v_mfma_f32_16x16x32_bf16 v[152:155],a[208:211],v[64:67],v[152:155]
v_mul_f32 v199,v8,v199
v_cvt_pk_bf16_f32 v192,v192,v193
v_mfma_f32_16x16x32_bf16 v[184:187],a[208:211],v[72:75],v[184:187]
s_waitcnt lgkmcnt(6)
v_cvt_pk_bf16_f32 v193,v194,v195
v_cvt_pk_bf16_f32 v194,v196,v197
v_mfma_f32_16x16x32_bf16 v[184:187],a[212:215],v[76:79],v[184:187]
s_waitcnt lgkmcnt(5)
v_cvt_pk_bf16_f32 v195,v198,v199
v_mfma_f32_16x16x32_bf16 a[156:159],a[216:219],v[88:91],a[156:159]
buffer_store_dwordx4 v[192:195],v1,s[16:19],s88 offen offset:0 sc1
v_mfma_f32_16x16x32_bf16 a[124:127],a[216:219],v[80:83],a[124:127]
ds_write_b128 v12,a[152:155] offset:14336
v_mfma_f32_16x16x32_bf16 v[156:159],a[216:219],v[64:67],v[156:159]
ds_write_b128 v12,a[120:123] offset:6144
v_mfma_f32_16x16x32_bf16 v[188:191],a[216:219],v[72:75],v[188:191]
s_waitcnt lgkmcnt(4)
v_mul_f32 v200,v8,v200
v_mul_f32 v201,v8,v201
v_mfma_f32_16x16x32_bf16 v[188:191],a[220:223],v[76:79],v[188:191]
v_mul_f32 v202,v8,v202
v_mul_f32 v203,v8,v203
v_mul_f32 v204,v8,v204
v_mul_f32 v205,v8,v205
v_mul_f32 v206,v8,v206
v_mul_f32 v207,v8,v207
v_cvt_pk_bf16_f32 v200,v200,v201
v_cvt_pk_bf16_f32 v201,v202,v203
v_cvt_pk_bf16_f32 v202,v204,v205
v_cvt_pk_bf16_f32 v203,v206,v207
buffer_store_dwordx4 v[200:203],v1,s[16:19],s88 offen offset:1024 sc1
v_mul_f32 v208,v8,v208
v_mul_f32 v209,v8,v209
v_mul_f32 v210,v8,v210
v_mul_f32 v211,v8,v211
v_mul_f32 v212,v8,v212
v_mul_f32 v213,v8,v213
v_mul_f32 v214,v8,v214
v_mul_f32 v215,v8,v215
v_cvt_pk_bf16_f32 v208,v208,v209
v_cvt_pk_bf16_f32 v209,v210,v211
v_cvt_pk_bf16_f32 v210,v212,v213
v_cvt_pk_bf16_f32 v211,v214,v215
buffer_store_dwordx4 v[208:211],v1,s[16:19],s88 offen offset:2048 sc1
v_mul_f32 v216,v8,v216
v_mul_f32 v217,v8,v217
v_mul_f32 v218,v8,v218
v_mul_f32 v219,v8,v219
v_mul_f32 v220,v8,v220
v_mul_f32 v221,v8,v221
v_mul_f32 v222,v8,v222
v_mul_f32 v223,v8,v223
v_cvt_pk_bf16_f32 v216,v216,v217
v_cvt_pk_bf16_f32 v217,v218,v219
v_cvt_pk_bf16_f32 v218,v220,v221
v_cvt_pk_bf16_f32 v219,v222,v223
buffer_store_dwordx4 v[216:219],v1,s[16:19],s88 offen offset:3072 sc1
v_mul_f32 v224,v9,v224
v_mul_f32 v225,v9,v225
v_mul_f32 v226,v9,v226
v_mul_f32 v227,v9,v227
v_mul_f32 v228,v9,v228
v_mul_f32 v229,v9,v229
v_mul_f32 v230,v9,v230
v_mul_f32 v231,v9,v231
v_cvt_pk_bf16_f32 v224,v224,v225
v_cvt_pk_bf16_f32 v225,v226,v227
v_cvt_pk_bf16_f32 v226,v228,v229
v_cvt_pk_bf16_f32 v227,v230,v231
buffer_store_dwordx4 v[224:227],v1,s[16:19],s89 offen offset:0 sc1
v_mul_f32 v232,v9,v232
v_mul_f32 v233,v9,v233
v_mul_f32 v234,v9,v234
v_mul_f32 v235,v9,v235
v_mul_f32 v236,v9,v236
v_mul_f32 v237,v9,v237
v_mul_f32 v238,v9,v238
v_mul_f32 v239,v9,v239
v_cvt_pk_bf16_f32 v232,v232,v233
v_cvt_pk_bf16_f32 v233,v234,v235
v_cvt_pk_bf16_f32 v234,v236,v237
v_cvt_pk_bf16_f32 v235,v238,v239
buffer_store_dwordx4 v[232:235],v1,s[16:19],s89 offen offset:1024 sc1
v_mul_f32 v240,v9,v240
v_mul_f32 v241,v9,v241
v_mul_f32 v242,v9,v242
v_mul_f32 v243,v9,v243
v_mul_f32 v244,v9,v244
v_mul_f32 v245,v9,v245
v_mul_f32 v246,v9,v246
v_mul_f32 v247,v9,v247
v_cvt_pk_bf16_f32 v240,v240,v241
v_cvt_pk_bf16_f32 v241,v242,v243
v_cvt_pk_bf16_f32 v242,v244,v245
v_cvt_pk_bf16_f32 v243,v246,v247
buffer_store_dwordx4 v[240:243],v1,s[16:19],s89 offen offset:2048 sc1
v_mul_f32 v248,v9,v248
v_mul_f32 v249,v9,v249
v_mul_f32 v250,v9,v250
v_mul_f32 v251,v9,v251
v_mul_f32 v252,v9,v252
v_mul_f32 v253,v9,v253
v_mul_f32 v254,v9,v254
v_mul_f32 v255,v9,v255
v_cvt_pk_bf16_f32 v248,v248,v249
v_cvt_pk_bf16_f32 v249,v250,v251
v_cvt_pk_bf16_f32 v250,v252,v253
v_cvt_pk_bf16_f32 v251,v254,v255
buffer_store_dwordx4 v[248:251],v1,s[16:19],s89 offen offset:3072 sc1
s_nop 3
ds_write_b128 v12,a[156:159] offset:15360
ds_write_b128 v12,a[124:127] offset:7168
s_branch K2_FIN
K2_MID71:
s_waitcnt lgkmcnt(7)
v_mfma_f32_16x16x32_bf16 v[48:51],a[160:163],a[0:3],v[24:27]
s_waitcnt lgkmcnt(5)
v_exp_f32 v60,v60
v_mfma_f32_16x16x32_bf16 v[48:51],a[164:167],a[4:7],v[48:51]
s_waitcnt lgkmcnt(1)
v_exp_f32 v61,v61
v_mfma_f32_16x16x32_bf16 v[48:51],a[168:171],a[8:11],v[48:51]
ds_read_b128 a[176:179],v2 offset:4096
v_add_f32 v19,v19,v60
v_mfma_f32_16x16x32_bf16 v[48:51],a[172:175],a[12:15],v[48:51]
buffer_load_dwordx4 v1,s[16:19],s25 offen offset:2048 sc1 lds
v_add_f32 v19,v19,v61
v_cvt_pk_bf16_f32 v126,v60,v61
v_mfma_f32_16x16x32_bf16 v[128:131],a[192:195],v[96:99],v[128:131]
v_exp_f32 v62,v62
v_mfma_f32_16x16x32_bf16 v[128:131],a[196:199],v[100:103],v[128:131]
v_exp_f32 v63,v63
v_mfma_f32_16x16x32_bf16 v[160:163],a[192:195],v[104:107],v[160:163]
ds_read_b128 a[208:211],v4 offset:33792
v_add_f32 v19,v19,v62
v_mfma_f32_16x16x32_bf16 v[160:163],a[196:199],v[108:111],v[160:163]
buffer_load_dwordx4 v1,s[16:19],s25 offen offset:3072 sc1 lds
v_add_f32 v19,v19,v63
v_cvt_pk_bf16_f32 v127,v62,v63
v_mfma_f32_16x16x32_bf16 v[52:55],a[160:163],a[16:19],v[28:31]
v_cndmask_b32 v56,v6,v32,s[32:33]
v_cndmask_b32 v57,v6,v32,s[34:35]
v_cndmask_b32 v58,v6,v32,s[36:37]
v_cndmask_b32 v59,v6,v32,s[38:39]
v_exp_f32 v48,v48
v_mfma_f32_16x16x32_bf16 v[52:55],a[164:167],a[20:23],v[52:55]
v_exp_f32 v49,v49
v_mfma_f32_16x16x32_bf16 v[52:55],a[168:171],a[24:27],v[52:55]
ds_read_b128 a[180:183],v2 offset:5120
v_add_f32 v16,v16,v48
v_mfma_f32_16x16x32_bf16 v[52:55],a[172:175],a[28:31],v[52:55]
global_load_dword a250,v22,s[94:95]
v_add_f32 v16,v16,v49
v_cvt_pk_bf16_f32 v64,v48,v49
v_mfma_f32_16x16x32_bf16 v[192:195],a[192:195],v[112:115],v[192:195]
v_exp_f32 v50,v50
v_mfma_f32_16x16x32_bf16 v[192:195],a[196:199],v[116:119],v[192:195]
v_exp_f32 v51,v51
v_mfma_f32_16x16x32_bf16 v[224:227],a[192:195],v[120:123],v[224:227]
ds_read_b128 a[212:215],v4 offset:37888
v_add_f32 v16,v16,v50
v_mfma_f32_16x16x32_bf16 v[224:227],a[196:199],v[124:127],v[224:227]
v_add_f32 v16,v16,v51
v_cvt_pk_bf16_f32 v65,v50,v51
v_mfma_f32_16x16x32_bf16 v[56:59],a[160:163],a[32:35],v[56:59]
v_exp_f32 v52,v52
v_mfma_f32_16x16x32_bf16 v[56:59],a[164:167],a[36:39],v[56:59]
v_exp_f32 v53,v53
v_mfma_f32_16x16x32_bf16 v[56:59],a[168:171],a[40:43],v[56:59]
ds_read_b128 a[184:187],v2 offset:6144
v_add_f32 v17,v17,v52
v_mfma_f32_16x16x32_bf16 v[56:59],a[172:175],a[44:47],v[56:59]
v_add_f32 v17,v17,v53
v_cvt_pk_bf16_f32 v72,v52,v53
v_mfma_f32_16x16x32_bf16 v[132:135],a[200:203],v[96:99],v[132:135]
s_waitcnt lgkmcnt(5)
v_exp_f32 v54,v54
v_mfma_f32_16x16x32_bf16 v[132:135],a[204:207],v[100:103],v[132:135]
v_exp_f32 v55,v55
v_mfma_f32_16x16x32_bf16 v[164:167],a[200:203],v[104:107],v[164:167]
ds_read_b128 a[216:219],v4 offset:41984
v_add_f32 v17,v17,v54
v_mfma_f32_16x16x32_bf16 v[164:167],a[204:207],v[108:111],v[164:167]
v_add_f32 v17,v17,v55
v_cvt_pk_bf16_f32 v73,v54,v55
v_mfma_f32_16x16x32_bf16 v[60:63],a[160:163],a[48:51],v[36:39]
v_exp_f32 v56,v56
v_mfma_f32_16x16x32_bf16 v[60:63],a[164:167],a[52:55],v[60:63]
v_exp_f32 v57,v57
v_mfma_f32_16x16x32_bf16 v[60:63],a[168:171],a[56:59],v[60:63]
ds_read_b128 a[188:191],v2 offset:7168
v_add_f32 v18,v18,v56
v_mfma_f32_16x16x32_bf16 v[60:63],a[172:175],a[60:63],v[60:63]
v_add_f32 v18,v18,v57
v_cvt_pk_bf16_f32 v80,v56,v57
v_mfma_f32_16x16x32_bf16 v[196:199],a[200:203],v[112:115],v[196:199]
v_exp_f32 v58,v58
v_mfma_f32_16x16x32_bf16 v[196:199],a[204:207],v[116:119],v[196:199]
v_exp_f32 v59,v59
v_mfma_f32_16x16x32_bf16 v[228:231],a[200:203],v[120:123],v[228:231]
ds_read_b128 a[220:223],v4 offset:46080
v_add_f32 v18,v18,v58
v_mfma_f32_16x16x32_bf16 v[228:231],a[204:207],v[124:127],v[228:231]
s_waitcnt lgkmcnt(7)
v_add_f32 v18,v18,v59
v_cvt_pk_bf16_f32 v81,v58,v59
v_mfma_f32_16x16x32_bf16 v[48:51],a[176:179],a[0:3],v[24:27]
s_waitcnt lgkmcnt(5)
v_exp_f32 v60,v60
v_mfma_f32_16x16x32_bf16 v[48:51],a[180:183],a[4:7],v[48:51]
s_waitcnt lgkmcnt(1)
v_exp_f32 v61,v61
v_mfma_f32_16x16x32_bf16 v[48:51],a[184:187],a[8:11],v[48:51]
ds_read_b128 a[160:163],v2 offset:8192
v_add_f32 v19,v19,v60
v_mfma_f32_16x16x32_bf16 v[48:51],a[188:191],a[12:15],v[48:51]
v_add_f32 v19,v19,v61
v_cvt_pk_bf16_f32 v88,v60,v61
v_mfma_f32_16x16x32_bf16 v[136:139],a[208:211],v[96:99],v[136:139]
v_exp_f32 v62,v62
v_mfma_f32_16x16x32_bf16 v[136:139],a[212:215],v[100:103],v[136:139]
v_exp_f32 v63,v63
v_mfma_f32_16x16x32_bf16 v[168:171],a[208:211],v[104:107],v[168:171]
ds_read_b128 a[192:195],v4 offset:34816
v_add_f32 v19,v19,v62
v_mfma_f32_16x16x32_bf16 v[168:171],a[212:215],v[108:111],v[168:171]
v_add_f32 v19,v19,v63
v_cvt_pk_bf16_f32 v89,v62,v63
v_mfma_f32_16x16x32_bf16 v[52:55],a[176:179],a[16:19],v[28:31]
v_cndmask_b32 v56,v6,v32,s[40:41]
v_cndmask_b32 v57,v6,v32,s[42:43]
v_cndmask_b32 v58,v6,v32,s[44:45]
v_cndmask_b32 v59,v6,v32,s[46:47]
v_exp_f32 v48,v48
v_mfma_f32_16x16x32_bf16 v[52:55],a[180:183],a[20:23],v[52:55]
v_exp_f32 v49,v49
v_mfma_f32_16x16x32_bf16 v[52:55],a[184:187],a[24:27],v[52:55]
ds_read_b128 a[164:167],v2 offset:9216
v_add_f32 v16,v16,v48
v_mfma_f32_16x16x32_bf16 v[52:55],a[188:191],a[28:31],v[52:55]
v_add_f32 v16,v16,v49
v_cvt_pk_bf16_f32 v66,v48,v49
v_mfma_f32_16x16x32_bf16 v[200:203],a[208:211],v[112:115],v[200:203]
v_exp_f32 v50,v50
v_mfma_f32_16x16x32_bf16 v[200:203],a[212:215],v[116:119],v[200:203]
v_exp_f32 v51,v51
v_mfma_f32_16x16x32_bf16 v[232:235],a[208:211],v[120:123],v[232:235]
ds_read_b128 a[196:199],v4 offset:38912
v_add_f32 v16,v16,v50
v_mfma_f32_16x16x32_bf16 v[232:235],a[212:215],v[124:127],v[232:235]
v_add_f32 v16,v16,v51
v_cvt_pk_bf16_f32 v67,v50,v51
v_mfma_f32_16x16x32_bf16 v[56:59],a[176:179],a[32:35],v[56:59]
v_exp_f32 v52,v52
v_mfma_f32_16x16x32_bf16 v[56:59],a[180:183],a[36:39],v[56:59]
v_exp_f32 v53,v53
v_mfma_f32_16x16x32_bf16 v[56:59],a[184:187],a[40:43],v[56:59]
ds_read_b128 a[168:171],v2 offset:10240
v_add_f32 v17,v17,v52
v_mfma_f32_16x16x32_bf16 v[56:59],a[188:191],a[44:47],v[56:59]
v_add_f32 v17,v17,v53
v_cvt_pk_bf16_f32 v74,v52,v53
v_mfma_f32_16x16x32_bf16 v[140:143],a[216:219],v[96:99],v[140:143]
s_waitcnt lgkmcnt(5)
v_exp_f32 v54,v54
v_mfma_f32_16x16x32_bf16 v[140:143],a[220:223],v[100:103],v[140:143]
v_exp_f32 v55,v55
v_mfma_f32_16x16x32_bf16 v[172:175],a[216:219],v[104:107],v[172:175]
ds_read_b128 a[200:203],v4 offset:43008
v_add_f32 v17,v17,v54
v_mfma_f32_16x16x32_bf16 v[172:175],a[220:223],v[108:111],v[172:175]
v_add_f32 v17,v17,v55
v_cvt_pk_bf16_f32 v75,v54,v55
v_mfma_f32_16x16x32_bf16 v[60:63],a[176:179],a[48:51],v[36:39]
v_exp_f32 v56,v56
v_mfma_f32_16x16x32_bf16 v[60:63],a[180:183],a[52:55],v[60:63]
v_exp_f32 v57,v57
v_mfma_f32_16x16x32_bf16 v[60:63],a[184:187],a[56:59],v[60:63]
ds_read_b128 a[172:175],v2 offset:11264
v_add_f32 v18,v18,v56
v_mfma_f32_16x16x32_bf16 v[60:63],a[188:191],a[60:63],v[60:63]
v_add_f32 v18,v18,v57
v_cvt_pk_bf16_f32 v82,v56,v57
v_mfma_f32_16x16x32_bf16 v[204:207],a[216:219],v[112:115],v[204:207]
v_exp_f32 v58,v58
v_mfma_f32_16x16x32_bf16 v[204:207],a[220:223],v[116:119],v[204:207]
v_exp_f32 v59,v59
v_mfma_f32_16x16x32_bf16 v[236:239],a[216:219],v[120:123],v[236:239]
ds_read_b128 a[204:207],v4 offset:47104
v_add_f32 v18,v18,v58
v_mfma_f32_16x16x32_bf16 v[236:239],a[220:223],v[124:127],v[236:239]
s_waitcnt lgkmcnt(7)
v_add_f32 v18,v18,v59
v_cvt_pk_bf16_f32 v83,v58,v59
v_mfma_f32_16x16x32_bf16 v[48:51],a[160:163],a[0:3],v[24:27]
s_waitcnt lgkmcnt(5)
v_exp_f32 v60,v60
v_mfma_f32_16x16x32_bf16 v[48:51],a[164:167],a[4:7],v[48:51]
s_waitcnt lgkmcnt(1)
v_exp_f32 v61,v61
v_mfma_f32_16x16x32_bf16 v[48:51],a[168:171],a[8:11],v[48:51]
ds_read_b128 a[176:179],v2 offset:12288
v_add_f32 v19,v19,v60
v_mfma_f32_16x16x32_bf16 v[48:51],a[172:175],a[12:15],v[48:51]
v_add_f32 v19,v19,v61
v_cvt_pk_bf16_f32 v90,v60,v61
v_mfma_f32_16x16x32_bf16 v[144:147],a[192:195],v[96:99],v[144:147]
v_exp_f32 v62,v62
v_mfma_f32_16x16x32_bf16 v[144:147],a[196:199],v[100:103],v[144:147]
v_exp_f32 v63,v63
v_mfma_f32_16x16x32_bf16 v[176:179],a[192:195],v[104:107],v[176:179]
ds_read_b128 a[208:211],v4 offset:35840
v_add_f32 v19,v19,v62
v_mfma_f32_16x16x32_bf16 v[176:179],a[196:199],v[108:111],v[176:179]
v_add_f32 v19,v19,v63
v_cvt_pk_bf16_f32 v91,v62,v63
v_mfma_f32_16x16x32_bf16 v[52:55],a[160:163],a[16:19],v[28:31]
v_cndmask_b32 v56,v6,v32,s[48:49]
v_cndmask_b32 v57,v6,v32,s[50:51]
v_cndmask_b32 v58,v6,v32,s[52:53]
v_cndmask_b32 v59,v6,v32,s[54:55]
v_exp_f32 v48,v48
v_mfma_f32_16x16x32_bf16 v[52:55],a[164:167],a[20:23],v[52:55]
v_exp_f32 v49,v49
v_mfma_f32_16x16x32_bf16 v[52:55],a[168:171],a[24:27],v[52:55]
ds_read_b128 a[180:183],v2 offset:13312
v_add_f32 v16,v16,v48
v_mfma_f32_16x16x32_bf16 v[52:55],a[172:175],a[28:31],v[52:55]
v_add_f32 v16,v16,v49
v_cvt_pk_bf16_f32 v68,v48,v49
v_mfma_f32_16x16x32_bf16 v[208:211],a[192:195],v[112:115],v[208:211]
v_exp_f32 v50,v50
v_mfma_f32_16x16x32_bf16 v[208:211],a[196:199],v[116:119],v[208:211]
v_exp_f32 v51,v51
v_mfma_f32_16x16x32_bf16 v[240:243],a[192:195],v[120:123],v[240:243]
ds_read_b128 a[212:215],v4 offset:39936
v_add_f32 v16,v16,v50
v_mfma_f32_16x16x32_bf16 v[240:243],a[196:199],v[124:127],v[240:243]
v_add_f32 v16,v16,v51
v_cvt_pk_bf16_f32 v69,v50,v51
v_mfma_f32_16x16x32_bf16 v[56:59],a[160:163],a[32:35],v[56:59]
v_exp_f32 v52,v52
v_mfma_f32_16x16x32_bf16 v[56:59],a[164:167],a[36:39],v[56:59]
v_exp_f32 v53,v53
v_mfma_f32_16x16x32_bf16 v[56:59],a[168:171],a[40:43],v[56:59]
ds_read_b128 a[184:187],v2 offset:14336
v_add_f32 v17,v17,v52
v_mfma_f32_16x16x32_bf16 v[56:59],a[172:175],a[44:47],v[56:59]
v_add_f32 v17,v17,v53
v_cvt_pk_bf16_f32 v76,v52,v53
v_mfma_f32_16x16x32_bf16 v[148:151],a[200:203],v[96:99],v[148:151]
s_waitcnt lgkmcnt(5)
v_exp_f32 v54,v54
v_mfma_f32_16x16x32_bf16 v[148:151],a[204:207],v[100:103],v[148:151]
v_exp_f32 v55,v55
v_mfma_f32_16x16x32_bf16 v[180:183],a[200:203],v[104:107],v[180:183]
ds_read_b128 a[216:219],v4 offset:44032
v_add_f32 v17,v17,v54
v_mfma_f32_16x16x32_bf16 v[180:183],a[204:207],v[108:111],v[180:183]
v_add_f32 v17,v17,v55
v_cvt_pk_bf16_f32 v77,v54,v55
v_mfma_f32_16x16x32_bf16 v[60:63],a[160:163],a[48:51],v[36:39]
v_exp_f32 v56,v56
v_mfma_f32_16x16x32_bf16 v[60:63],a[164:167],a[52:55],v[60:63]
v_exp_f32 v57,v57
v_mfma_f32_16x16x32_bf16 v[60:63],a[168:171],a[56:59],v[60:63]
ds_read_b128 a[188:191],v2 offset:15360
v_add_f32 v18,v18,v56
v_mfma_f32_16x16x32_bf16 v[60:63],a[172:175],a[60:63],v[60:63]
v_add_f32 v18,v18,v57
v_cvt_pk_bf16_f32 v84,v56,v57
v_mfma_f32_16x16x32_bf16 v[212:215],a[200:203],v[112:115],v[212:215]
v_exp_f32 v58,v58
v_mfma_f32_16x16x32_bf16 v[212:215],a[204:207],v[116:119],v[212:215]
v_exp_f32 v59,v59
v_mfma_f32_16x16x32_bf16 v[244:247],a[200:203],v[120:123],v[244:247]
ds_read_b128 a[220:223],v4 offset:48128
v_add_f32 v18,v18,v58
v_mfma_f32_16x16x32_bf16 v[244:247],a[204:207],v[124:127],v[244:247]
s_waitcnt lgkmcnt(7)
v_add_f32 v18,v18,v59
v_cvt_pk_bf16_f32 v85,v58,v59
v_mfma_f32_16x16x32_bf16 v[48:51],a[176:179],a[0:3],v[24:27]
s_waitcnt lgkmcnt(5)
v_exp_f32 v60,v60
v_mfma_f32_16x16x32_bf16 v[48:51],a[180:183],a[4:7],v[48:51]
s_waitcnt lgkmcnt(3)
v_exp_f32 v61,v61
v_mfma_f32_16x16x32_bf16 v[48:51],a[184:187],a[8:11],v[48:51]
s_waitcnt lgkmcnt(1)
v_add_f32 v19,v19,v60
v_add_f32 v19,v19,v61
v_mfma_f32_16x16x32_bf16 v[48:51],a[188:191],a[12:15],v[48:51]
v_exp_f32 v62,v62
v_mfma_f32_16x16x32_bf16 v[152:155],a[208:211],v[96:99],v[152:155]
s_waitcnt vmcnt(1) lgkmcnt(0)
v_exp_f32 v63,v63
v_mfma_f32_16x16x32_bf16 v[152:155],a[212:215],v[100:103],v[152:155]
s_barrier
v_cvt_pk_bf16_f32 v92,v60,v61
v_add_f32 v19,v19,v62
v_mfma_f32_16x16x32_bf16 v[184:187],a[208:211],v[104:107],v[184:187]
ds_read_b128 a[160:163],v2 offset:32768
v_add_f32 v19,v19,v63
v_mfma_f32_16x16x32_bf16 v[184:187],a[212:215],v[108:111],v[184:187]
ds_read_b128 a[192:195],v4 offset:0
v_cvt_pk_bf16_f32 v93,v62,v63
v_mfma_f32_16x16x32_bf16 v[52:55],a[176:179],a[16:19],v[28:31]
s_add_u32 m0,s23,0
v_cndmask_b32 v56,v6,v32,s[56:57]
v_cndmask_b32 v57,v6,v32,s[58:59]
v_cndmask_b32 v58,v6,v32,s[60:61]
v_cndmask_b32 v59,v6,v32,s[62:63]
v_exp_f32 v48,v48
v_mfma_f32_16x16x32_bf16 v[52:55],a[180:183],a[20:23],v[52:55]
s_add_u32 s24,s24,16384
v_exp_f32 v49,v49
v_mfma_f32_16x16x32_bf16 v[52:55],a[184:187],a[24:27],v[52:55]
ds_read_b128 a[164:167],v2 offset:33792
v_add_f32 v16,v16,v48
v_mfma_f32_16x16x32_bf16 v[52:55],a[188:191],a[28:31],v[52:55]
buffer_load_dwordx4 v1,s[16:19],s24 offen offset:0 sc1 lds
v_add_f32 v16,v16,v49
v_cvt_pk_bf16_f32 v70,v48,v49
v_mfma_f32_16x16x32_bf16 v[216:219],a[208:211],v[112:115],v[216:219]
v_exp_f32 v50,v50
v_mfma_f32_16x16x32_bf16 v[216:219],a[212:215],v[116:119],v[216:219]
v_exp_f32 v51,v51
v_mfma_f32_16x16x32_bf16 v[248:251],a[208:211],v[120:123],v[248:251]
ds_read_b128 a[196:199],v4 offset:4096
v_add_f32 v16,v16,v50
v_mfma_f32_16x16x32_bf16 v[248:251],a[212:215],v[124:127],v[248:251]
buffer_load_dwordx4 v1,s[16:19],s24 offen offset:1024 sc1 lds
v_add_f32 v16,v16,v51
v_cvt_pk_bf16_f32 v71,v50,v51
v_mfma_f32_16x16x32_bf16 v[56:59],a[176:179],a[32:35],v[56:59]
v_exp_f32 v52,v52
v_mfma_f32_16x16x32_bf16 v[56:59],a[180:183],a[36:39],v[56:59]
v_exp_f32 v53,v53
v_mfma_f32_16x16x32_bf16 v[56:59],a[184:187],a[40:43],v[56:59]
ds_read_b128 a[168:171],v2 offset:34816
v_add_f32 v17,v17,v52
v_mfma_f32_16x16x32_bf16 v[56:59],a[188:191],a[44:47],v[56:59]
buffer_load_dwordx4 v1,s[16:19],s24 offen offset:2048 sc1 lds
v_add_f32 v17,v17,v53
v_cvt_pk_bf16_f32 v78,v52,v53
v_mfma_f32_16x16x32_bf16 v[156:159],a[216:219],v[96:99],v[156:159]
v_exp_f32 v54,v54
v_mfma_f32_16x16x32_bf16 v[156:159],a[220:223],v[100:103],v[156:159]
v_exp_f32 v55,v55
v_mfma_f32_16x16x32_bf16 v[188:191],a[216:219],v[104:107],v[188:191]
ds_read_b128 a[200:203],v4 offset:8192
v_add_f32 v17,v17,v54
v_mfma_f32_16x16x32_bf16 v[188:191],a[220:223],v[108:111],v[188:191]
buffer_load_dwordx4 v1,s[16:19],s24 offen offset:3072 sc1 lds
v_add_f32 v17,v17,v55
v_cvt_pk_bf16_f32 v79,v54,v55
v_mfma_f32_16x16x32_bf16 v[60:63],a[176:179],a[48:51],v[36:39]
s_add_u32 m0,s23,16384
v_exp_f32 v56,v56
v_mfma_f32_16x16x32_bf16 v[60:63],a[180:183],a[52:55],v[60:63]
s_add_u32 s24,s24,16384
v_exp_f32 v57,v57
v_mfma_f32_16x16x32_bf16 v[60:63],a[184:187],a[56:59],v[60:63]
ds_read_b128 a[172:175],v2 offset:35840
v_add_f32 v18,v18,v56
v_mfma_f32_16x16x32_bf16 v[60:63],a[188:191],a[60:63],v[60:63]
buffer_load_dwordx4 v1,s[16:19],s24 offen offset:0 sc1 lds
v_add_f32 v18,v18,v57
v_cvt_pk_bf16_f32 v86,v56,v57
v_mfma_f32_16x16x32_bf16 v[220:223],a[216:219],v[112:115],v[220:223]
v_exp_f32 v58,v58
v_mfma_f32_16x16x32_bf16 v[220:223],a[220:223],v[116:119],v[220:223]
s_waitcnt lgkmcnt(6)
v_exp_f32 v59,v59
v_mfma_f32_16x16x32_bf16 v[252:255],a[216:219],v[120:123],v[252:255]
ds_read_b128 a[204:207],v4 offset:12288
v_add_f32 v18,v18,v58
v_mfma_f32_16x16x32_bf16 v[252:255],a[220:223],v[124:127],v[252:255]
buffer_load_dwordx4 v1,s[16:19],s24 offen offset:1024 sc1 lds
v_add_f32 v18,v18,v59
v_cvt_pk_bf16_f32 v87,v58,v59
v_mfma_f32_16x16x32_bf16 v[48:51],a[160:163],a[0:3],v[24:27]
s_waitcnt lgkmcnt(3)
v_exp_f32 v60,v60
v_mfma_f32_16x16x32_bf16 v[48:51],a[164:167],a[4:7],v[48:51]
ds_read_b128 a[176:179],v2 offset:36864
v_exp_f32 v61,v61
v_mfma_f32_16x16x32_bf16 v[48:51],a[168:171],a[8:11],v[48:51]
s_waitcnt lgkmcnt(2)
v_add_f32 v19,v19,v60
v_mfma_f32_16x16x32_bf16 v[48:51],a[172:175],a[12:15],v[48:51]
buffer_load_dwordx4 v1,s[16:19],s24 offen offset:2048 sc1 lds
v_add_f32 v19,v19,v61
v_cvt_pk_bf16_f32 v94,v60,v61
v_mfma_f32_16x16x32_bf16 v[128:131],a[192:195],v[64:67],v[128:131]
s_and_b32 s28,s20,1
v_exp_f32 v62,v62
v_mfma_f32_16x16x32_bf16 v[128:131],a[196:199],v[68:71],v[128:131]
ds_read_b128 a[208:211],v4 offset:1024
v_exp_f32 v63,v63
v_mfma_f32_16x16x32_bf16 v[160:163],a[192:195],v[72:75],v[160:163]
s_lshl_b32 s28,s28,14
v_add_f32 v19,v19,v62
v_mfma_f32_16x16x32_bf16 v[160:163],a[196:199],v[76:79],v[160:163]
ds_read_b128 a[180:183],v2 offset:37888
v_add_f32 v19,v19,v63
v_cvt_pk_bf16_f32 v95,v62,v63
v_mfma_f32_16x16x32_bf16 v[192:195],a[192:195],v[80:83],v[192:195]
s_lshr_b32 s4,s20,1
buffer_load_dwordx4 v1,s[16:19],s24 offen offset:3072 sc1 lds
v_cndmask_b32 v56,v6,v36,s[32:33]
v_cndmask_b32 v57,v6,v36,s[34:35]
v_cndmask_b32 v58,v6,v36,s[36:37]
v_cndmask_b32 v59,v6,v36,s[38:39]
v_exp_f32 v48,v48
v_mfma_f32_16x16x32_bf16 v[192:195],a[196:199],v[84:87],v[192:195]
s_lshl_b32 s4,s4,13
s_add_u32 m0,s23,98304
v_exp_f32 v49,v49
v_mfma_f32_16x16x32_bf16 v[52:55],a[160:163],a[16:19],v[28:31]
ds_read_b128 a[212:215],v4 offset:5120
s_add_u32 s25,s25,16384
v_mfma_f32_16x16x32_bf16 v[52:55],a[164:167],a[20:23],v[52:55]
buffer_load_dwordx4 v1,s[16:19],s25 offen offset:0 sc1 lds
v_add_f32 v16,v16,v48
v_add_f32 v16,v16,v49
v_mfma_f32_16x16x32_bf16 v[52:55],a[168:171],a[24:27],v[52:55]
s_add_u32 s4,s4,s28
v_cvt_pk_bf16_f32 v96,v48,v49
v_mfma_f32_16x16x32_bf16 v[52:55],a[172:175],a[28:31],v[52:55]
ds_read_b128 a[184:187],v2 offset:38912
v_exp_f32 v50,v50
v_mfma_f32_16x16x32_bf16 v[224:227],a[192:195],v[88:91],v[224:227]
s_lshl_b32 s6,s21,17
v_exp_f32 v51,v51
v_mfma_f32_16x16x32_bf16 v[224:227],a[196:199],v[92:95],v[224:227]
buffer_load_dwordx4 v1,s[16:19],s25 offen offset:1024 sc1 lds
v_mfma_f32_16x16x32_bf16 v[132:135],a[200:203],v[64:67],v[132:135]
s_add_u32 s28,s21,1
v_add_f32 v16,v16,v50
v_add_f32 v16,v16,v51
s_waitcnt lgkmcnt(5)
v_mfma_f32_16x16x32_bf16 v[132:135],a[204:207],v[68:71],v[132:135]
ds_read_b128 a[216:219],v4 offset:9216
v_cvt_pk_bf16_f32 v97,v50,v51
v_mfma_f32_16x16x32_bf16 v[164:167],a[200:203],v[72:75],v[164:167]
s_and_b32 s28,s28,3
v_exp_f32 v52,v52
v_mfma_f32_16x16x32_bf16 v[164:167],a[204:207],v[76:79],v[164:167]
ds_read_b128 a[188:191],v2 offset:39936
v_exp_f32 v53,v53
v_mfma_f32_16x16x32_bf16 v[56:59],a[160:163],a[48:51],v[56:59]
s_and_b32 s7,s21,28
buffer_load_dwordx4 v1,s[16:19],s25 offen offset:2048 sc1 lds
v_mfma_f32_16x16x32_bf16 v[56:59],a[164:167],a[52:55],v[56:59]
s_add_u32 s7,s7,s28
v_add_f32 v17,v17,v52
v_add_f32 v17,v17,v53
v_mfma_f32_16x16x32_bf16 v[56:59],a[168:171],a[56:59],v[56:59]
v_cvt_pk_bf16_f32 v104,v52,v53
v_mfma_f32_16x16x32_bf16 v[56:59],a[172:175],a[60:63],v[56:59]
s_lshl_b32 s7,s7,17
v_exp_f32 v54,v54
v_mfma_f32_16x16x32_bf16 v[196:199],a[200:203],v[80:83],v[196:199]
ds_read_b128 a[160:163],v2 offset:40960
buffer_load_dwordx4 v1,s[16:19],s25 offen offset:3072 sc1 lds
v_exp_f32 v55,v55
v_mfma_f32_16x16x32_bf16 v[196:199],a[204:207],v[84:87],v[196:199]
ds_read_b128 a[220:223],v4 offset:13312
v_add_f32 v17,v17,v54
v_mfma_f32_16x16x32_bf16 v[228:231],a[200:203],v[88:91],v[228:231]
s_getpc_b64 s[30:31]
F_W7:
s_sub_u32 s30,s30,F_W7-F_PC
s_subb_u32 s31,s31,0
v_accvgpr_read_b32 v9,a251
global_load_dword a249,v9,s[30:31]
v_add_f32 v17,v17,v55
v_mfma_f32_16x16x32_bf16 v[228:231],a[204:207],v[92:95],v[228:231]
s_waitcnt lgkmcnt(8)
v_cvt_pk_bf16_f32 v105,v54,v55
v_mfma_f32_16x16x32_bf16 v[60:63],a[176:179],a[0:3],v[24:27]
s_waitcnt lgkmcnt(2)
v_accvgpr_read_b32 v0,a248
v_exp_f32 v56,v56
v_mfma_f32_16x16x32_bf16 v[60:63],a[180:183],a[4:7],v[60:63]
s_add_u32 m0,s4,131072
v_exp_f32 v57,v57
v_mfma_f32_16x16x32_bf16 v[60:63],a[184:187],a[8:11],v[60:63]
s_add_u32 s5,s6,0
v_add_f32 v19,v19,v56
v_add_f32 v19,v19,v57
v_mfma_f32_16x16x32_bf16 v[60:63],a[188:191],a[12:15],v[60:63]
ds_read_b128 a[164:167],v2 offset:41984
buffer_load_dwordx4 v0,s[12:15],s5 offen lds
v_cvt_pk_bf16_f32 v120,v56,v57
v_mfma_f32_16x16x32_bf16 v[136:139],a[208:211],v[64:67],v[136:139]
s_add_u32 m0,s4,132096
v_exp_f32 v58,v58
v_mfma_f32_16x16x32_bf16 v[136:139],a[212:215],v[68:71],v[136:139]
ds_read_b128 a[192:195],v4 offset:2048
v_exp_f32 v59,v59
v_mfma_f32_16x16x32_bf16 v[168:171],a[208:211],v[72:75],v[168:171]
s_add_u32 s5,s6,8192
v_add_f32 v19,v19,v58
v_add_f32 v19,v19,v59
v_mfma_f32_16x16x32_bf16 v[168:171],a[212:215],v[76:79],v[168:171]
buffer_load_dwordx4 v0,s[12:15],s5 offen lds
v_cvt_pk_bf16_f32 v121,v58,v59
v_mfma_f32_16x16x32_bf16 v[200:203],a[208:211],v[80:83],v[200:203]
s_add_u32 m0,s4,133120
v_cndmask_b32 v52,v6,v36,s[40:41]
v_cndmask_b32 v53,v6,v36,s[42:43]
v_cndmask_b32 v54,v6,v36,s[44:45]
v_cndmask_b32 v55,v6,v36,s[46:47]
v_exp_f32 v60,v60
v_mfma_f32_16x16x32_bf16 v[200:203],a[212:215],v[84:87],v[200:203]
s_add_u32 s5,s6,16384
v_exp_f32 v61,v61
v_mfma_f32_16x16x32_bf16 v[48:51],a[176:179],a[16:19],v[28:31]
ds_read_b128 a[168:171],v2 offset:43008
v_add_f32 v16,v16,v60
v_mfma_f32_16x16x32_bf16 v[48:51],a[180:183],a[20:23],v[48:51]
ds_read_b128 a[196:199],v4 offset:6144
buffer_load_dwordx4 v0,s[12:15],s5 offen lds
v_add_f32 v16,v16,v61
v_mfma_f32_16x16x32_bf16 v[48:51],a[184:187],a[24:27],v[48:51]
s_add_u32 m0,s4,134144
v_cvt_pk_bf16_f32 v98,v60,v61
v_mfma_f32_16x16x32_bf16 v[48:51],a[188:191],a[28:31],v[48:51]
s_add_u32 s5,s6,24576
v_exp_f32 v62,v62
v_mfma_f32_16x16x32_bf16 v[232:235],a[208:211],v[88:91],v[232:235]
s_waitcnt lgkmcnt(4)
v_exp_f32 v63,v63
v_mfma_f32_16x16x32_bf16 v[232:235],a[212:215],v[92:95],v[232:235]
buffer_load_dwordx4 v0,s[12:15],s5 offen lds
v_mfma_f32_16x16x32_bf16 v[140:143],a[216:219],v[64:67],v[140:143]
s_add_u32 m0,s4,135168
v_add_f32 v16,v16,v62
v_add_f32 v16,v16,v63
v_mfma_f32_16x16x32_bf16 v[140:143],a[220:223],v[68:71],v[140:143]
ds_read_b128 a[200:203],v4 offset:10240
v_cvt_pk_bf16_f32 v99,v62,v63
v_mfma_f32_16x16x32_bf16 v[172:175],a[216:219],v[72:75],v[172:175]
s_add_u32 s5,s6,32768
ds_read_b128 a[172:175],v2 offset:44032
v_exp_f32 v48,v48
v_mfma_f32_16x16x32_bf16 v[172:175],a[220:223],v[76:79],v[172:175]
buffer_load_dwordx4 v0,s[12:15],s5 offen lds
v_exp_f32 v49,v49
v_mfma_f32_16x16x32_bf16 v[52:55],a[176:179],a[48:51],v[52:55]
s_add_u32 m0,s4,136192
v_add_f32 v17,v17,v48
v_add_f32 v17,v17,v49
v_mfma_f32_16x16x32_bf16 v[52:55],a[180:183],a[52:55],v[52:55]
s_add_u32 s5,s6,40960
v_cvt_pk_bf16_f32 v106,v48,v49
v_mfma_f32_16x16x32_bf16 v[52:55],a[184:187],a[56:59],v[52:55]
v_exp_f32 v50,v50
v_mfma_f32_16x16x32_bf16 v[52:55],a[188:191],a[60:63],v[52:55]
ds_read_b128 a[176:179],v2 offset:45056
buffer_load_dwordx4 v0,s[12:15],s5 offen lds
v_mfma_f32_16x16x32_bf16 v[204:207],a[216:219],v[80:83],v[204:207]
s_add_u32 m0,s4,137216
v_exp_f32 v51,v51
v_mfma_f32_16x16x32_bf16 v[204:207],a[220:223],v[84:87],v[204:207]
ds_read_b128 a[204:207],v4 offset:14336
v_add_f32 v17,v17,v50
v_mfma_f32_16x16x32_bf16 v[236:239],a[216:219],v[88:91],v[236:239]
s_add_u32 s5,s6,49152
v_add_f32 v17,v17,v51
v_cvt_pk_bf16_f32 v107,v50,v51
v_mfma_f32_16x16x32_bf16 v[236:239],a[220:223],v[92:95],v[236:239]
buffer_load_dwordx4 v0,s[12:15],s5 offen lds
v_mfma_f32_16x16x32_bf16 v[56:59],a[160:163],a[0:3],v[24:27]
s_add_u32 m0,s4,138240
v_exp_f32 v52,v52
s_waitcnt lgkmcnt(7)
v_mfma_f32_16x16x32_bf16 v[56:59],a[164:167],a[4:7],v[56:59]
s_add_u32 s5,s6,57344
v_exp_f32 v53,v53
s_waitcnt lgkmcnt(5)
v_mfma_f32_16x16x32_bf16 v[56:59],a[168:171],a[8:11],v[56:59]
ds_read_b128 a[180:183],v2 offset:46080
v_add_f32 v19,v19,v52
s_waitcnt lgkmcnt(3)
v_mfma_f32_16x16x32_bf16 v[56:59],a[172:175],a[12:15],v[56:59]
buffer_load_dwordx4 v0,s[12:15],s5 offen lds
v_add_f32 v19,v19,v53
v_cvt_pk_bf16_f32 v122,v52,v53
v_mfma_f32_16x16x32_bf16 v[144:147],a[192:195],v[64:67],v[144:147]
v_exp_f32 v54,v54
v_mfma_f32_16x16x32_bf16 v[144:147],a[196:199],v[68:71],v[144:147]
ds_read_b128 a[208:211],v4 offset:3072
v_exp_f32 v55,v55
v_mfma_f32_16x16x32_bf16 v[176:179],a[192:195],v[72:75],v[176:179]
v_add_f32 v19,v19,v54
v_add_f32 v19,v19,v55
v_mfma_f32_16x16x32_bf16 v[176:179],a[196:199],v[76:79],v[176:179]
v_cvt_pk_bf16_f32 v123,v54,v55
v_mfma_f32_16x16x32_bf16 v[208:211],a[192:195],v[80:83],v[208:211]
v_cndmask_b32 v48,v6,v36,s[48:49]
v_cndmask_b32 v49,v6,v36,s[50:51]
v_cndmask_b32 v50,v6,v36,s[52:53]
v_cndmask_b32 v51,v6,v36,s[54:55]
v_exp_f32 v56,v56
v_mfma_f32_16x16x32_bf16 v[208:211],a[196:199],v[84:87],v[208:211]
v_exp_f32 v57,v57
v_mfma_f32_16x16x32_bf16 v[60:63],a[160:163],a[16:19],v[28:31]
ds_read_b128 a[184:187],v2 offset:47104
v_add_f32 v16,v16,v56
v_mfma_f32_16x16x32_bf16 v[60:63],a[164:167],a[20:23],v[60:63]
ds_read_b128 a[212:215],v4 offset:7168
v_add_f32 v16,v16,v57
v_mfma_f32_16x16x32_bf16 v[60:63],a[168:171],a[24:27],v[60:63]
v_cvt_pk_bf16_f32 v100,v56,v57
v_mfma_f32_16x16x32_bf16 v[60:63],a[172:175],a[28:31],v[60:63]
v_exp_f32 v58,v58
v_mfma_f32_16x16x32_bf16 v[240:243],a[192:195],v[88:91],v[240:243]
v_exp_f32 v59,v59
v_mfma_f32_16x16x32_bf16 v[240:243],a[196:199],v[92:95],v[240:243]
s_waitcnt lgkmcnt(4)
v_add_f32 v16,v16,v58
v_add_f32 v16,v16,v59
v_mfma_f32_16x16x32_bf16 v[148:151],a[200:203],v[64:67],v[148:151]
ds_read_b128 a[216:219],v4 offset:11264
v_cvt_pk_bf16_f32 v101,v58,v59
v_mfma_f32_16x16x32_bf16 v[148:151],a[204:207],v[68:71],v[148:151]
ds_read_b128 a[188:191],v2 offset:48128
v_mfma_f32_16x16x32_bf16 v[180:183],a[200:203],v[72:75],v[180:183]
v_exp_f32 v60,v60
v_mfma_f32_16x16x32_bf16 v[180:183],a[204:207],v[76:79],v[180:183]
v_exp_f32 v61,v61
v_mfma_f32_16x16x32_bf16 v[48:51],a[160:163],a[48:51],v[48:51]
v_add_f32 v17,v17,v60
v_add_f32 v17,v17,v61
v_mfma_f32_16x16x32_bf16 v[48:51],a[164:167],a[52:55],v[48:51]
v_cvt_pk_bf16_f32 v108,v60,v61
v_mfma_f32_16x16x32_bf16 v[48:51],a[168:171],a[56:59],v[48:51]
v_exp_f32 v62,v62
v_mfma_f32_16x16x32_bf16 v[48:51],a[172:175],a[60:63],v[48:51]
v_exp_f32 v63,v63
v_mfma_f32_16x16x32_bf16 v[212:215],a[200:203],v[80:83],v[212:215]
ds_read_b128 a[220:223],v4 offset:15360
v_add_f32 v17,v17,v62
v_mfma_f32_16x16x32_bf16 v[212:215],a[204:207],v[84:87],v[212:215]
v_add_f32 v17,v17,v63
v_cvt_pk_bf16_f32 v109,v62,v63
v_mfma_f32_16x16x32_bf16 v[244:247],a[200:203],v[88:91],v[244:247]
v_mfma_f32_16x16x32_bf16 v[244:247],a[204:207],v[92:95],v[244:247]
v_mfma_f32_16x16x32_bf16 v[52:55],a[176:179],a[0:3],v[24:27]
s_waitcnt lgkmcnt(6)
v_exp_f32 v48,v48
v_mfma_f32_16x16x32_bf16 v[52:55],a[180:183],a[4:7],v[52:55]
s_waitcnt lgkmcnt(4)
v_exp_f32 v49,v49
v_mfma_f32_16x16x32_bf16 v[52:55],a[184:187],a[8:11],v[52:55]
s_waitcnt lgkmcnt(1)
v_add_f32 v19,v19,v48
v_add_f32 v19,v19,v49
v_mfma_f32_16x16x32_bf16 v[52:55],a[188:191],a[12:15],v[52:55]
v_cvt_pk_bf16_f32 v124,v48,v49
v_mfma_f32_16x16x32_bf16 v[152:155],a[208:211],v[64:67],v[152:155]
v_exp_f32 v50,v50
v_mfma_f32_16x16x32_bf16 v[152:155],a[212:215],v[68:71],v[152:155]
v_exp_f32 v51,v51
v_mfma_f32_16x16x32_bf16 v[184:187],a[208:211],v[72:75],v[184:187]
v_add_f32 v19,v19,v50
v_add_f32 v19,v19,v51
v_mfma_f32_16x16x32_bf16 v[184:187],a[212:215],v[76:79],v[184:187]
s_waitcnt vmcnt(9) lgkmcnt(0)
v_cvt_pk_bf16_f32 v125,v50,v51
v_mfma_f32_16x16x32_bf16 v[216:219],a[208:211],v[80:83],v[216:219]
s_barrier
v_cndmask_b32 v60,v6,v36,s[56:57]
v_cndmask_b32 v61,v6,v36,s[58:59]
v_cndmask_b32 v62,v6,v36,s[60:61]
v_cndmask_b32 v63,v6,v36,s[62:63]
v_exp_f32 v52,v52
v_mfma_f32_16x16x32_bf16 v[216:219],a[212:215],v[84:87],v[216:219]
s_add_u32 m0,s23,65536
v_exp_f32 v53,v53
v_mfma_f32_16x16x32_bf16 v[56:59],a[176:179],a[16:19],v[28:31]
ds_read_b128 a[160:163],v2 offset:8192
v_add_f32 v16,v16,v52
v_mfma_f32_16x16x32_bf16 v[56:59],a[180:183],a[20:23],v[56:59]
s_add_u32 s25,s25,16384
v_add_f32 v16,v16,v53
v_cvt_pk_bf16_f32 v102,v52,v53
v_mfma_f32_16x16x32_bf16 v[56:59],a[184:187],a[24:27],v[56:59]
ds_read_b128 a[192:195],v4 offset:32768
v_mfma_f32_16x16x32_bf16 v[56:59],a[188:191],a[28:31],v[56:59]
buffer_load_dwordx4 v1,s[16:19],s25 offen offset:0 sc1 lds
v_exp_f32 v54,v54
v_mfma_f32_16x16x32_bf16 v[248:251],a[208:211],v[88:91],v[248:251]
ds_read_b128 a[164:167],v2 offset:9216
v_exp_f32 v55,v55
v_mfma_f32_16x16x32_bf16 v[248:251],a[212:215],v[92:95],v[248:251]
buffer_load_dwordx4 v1,s[16:19],s25 offen offset:1024 sc1 lds
v_mfma_f32_16x16x32_bf16 v[156:159],a[216:219],v[64:67],v[156:159]
ds_read_b128 a[196:199],v4 offset:36864
v_add_f32 v16,v16,v54
v_add_f32 v16,v16,v55
v_mfma_f32_16x16x32_bf16 v[156:159],a[220:223],v[68:71],v[156:159]
buffer_load_dwordx4 v1,s[16:19],s25 offen offset:2048 sc1 lds
v_cvt_pk_bf16_f32 v103,v54,v55
v_mfma_f32_16x16x32_bf16 v[188:191],a[216:219],v[72:75],v[188:191]
v_exp_f32 v56,v56
v_mfma_f32_16x16x32_bf16 v[188:191],a[220:223],v[76:79],v[188:191]
ds_read_b128 a[168:171],v2 offset:10240
v_exp_f32 v57,v57
v_mfma_f32_16x16x32_bf16 v[60:63],a[176:179],a[48:51],v[60:63]
buffer_load_dwordx4 v1,s[16:19],s25 offen offset:3072 sc1 lds
v_mfma_f32_16x16x32_bf16 v[60:63],a[180:183],a[52:55],v[60:63]
ds_read_b128 a[200:203],v4 offset:40960
s_add_u32 m0,s23,81920
v_add_f32 v17,v17,v56
v_add_f32 v17,v17,v57
v_mfma_f32_16x16x32_bf16 v[60:63],a[184:187],a[56:59],v[60:63]
ds_read_b128 a[172:175],v2 offset:11264
s_add_u32 s25,s25,16384
v_cvt_pk_bf16_f32 v110,v56,v57
v_mfma_f32_16x16x32_bf16 v[60:63],a[188:191],a[60:63],v[60:63]
buffer_load_dwordx4 v1,s[16:19],s25 offen offset:0 sc1 lds
v_exp_f32 v58,v58
v_mfma_f32_16x16x32_bf16 v[220:223],a[216:219],v[80:83],v[220:223]
v_exp_f32 v59,v59
v_mfma_f32_16x16x32_bf16 v[220:223],a[220:223],v[84:87],v[220:223]
ds_read_b128 a[204:207],v4 offset:45056
buffer_load_dwordx4 v1,s[16:19],s25 offen offset:1024 sc1 lds
v_mfma_f32_16x16x32_bf16 v[252:255],a[216:219],v[88:91],v[252:255]
v_add_f32 v17,v17,v58
v_add_f32 v17,v17,v59
v_mfma_f32_16x16x32_bf16 v[252:255],a[220:223],v[92:95],v[252:255]
s_waitcnt lgkmcnt(7)
v_cvt_pk_bf16_f32 v111,v58,v59
v_mfma_f32_16x16x32_bf16 v[56:59],a[160:163],a[80:83],v[44:47]
s_waitcnt lgkmcnt(3)
v_exp_f32 v60,v60
v_mfma_f32_16x16x32_bf16 v[56:59],a[164:167],a[84:87],v[56:59]
ds_read_b128 a[176:179],v2 offset:12288
v_exp_f32 v61,v61
v_mfma_f32_16x16x32_bf16 v[56:59],a[168:171],a[88:91],v[56:59]
s_waitcnt lgkmcnt(2)
v_add_f32 v19,v19,v60
v_add_f32 v19,v19,v61
v_mfma_f32_16x16x32_bf16 v[56:59],a[172:175],a[92:95],v[56:59]
buffer_load_dwordx4 v1,s[16:19],s25 offen offset:2048 sc1 lds
v_cvt_pk_bf16_f32 v126,v60,v61
v_mfma_f32_16x16x32_bf16 v[128:131],a[192:195],v[96:99],v[128:131]
v_exp_f32 v62,v62
v_mfma_f32_16x16x32_bf16 v[128:131],a[196:199],v[100:103],v[128:131]
ds_read_b128 a[208:211],v4 offset:33792
v_exp_f32 v63,v63
v_mfma_f32_16x16x32_bf16 v[160:163],a[192:195],v[104:107],v[160:163]
ds_read_b128 a[180:183],v2 offset:13312
v_add_f32 v19,v19,v62
v_add_f32 v19,v19,v63
v_cvt_pk_bf16_f32 v127,v62,v63
v_mfma_f32_16x16x32_bf16 v[160:163],a[196:199],v[108:111],v[160:163]
buffer_load_dwordx4 v1,s[16:19],s25 offen offset:3072 sc1 lds
v_mfma_f32_16x16x32_bf16 v[224:227],a[192:195],v[120:123],v[224:227]
v_cndmask_b32 v48,v6,v24,s[64:65]
v_cndmask_b32 v49,v6,v24,s[66:67]
v_cndmask_b32 v50,v6,v24,s[68:69]
v_cndmask_b32 v51,v6,v24,s[70:71]
v_exp_f32 v56,v56
v_mfma_f32_16x16x32_bf16 v[224:227],a[196:199],v[124:127],v[224:227]
v_exp_f32 v57,v57
v_mfma_f32_16x16x32_bf16 v[60:63],a[160:163],a[16:19],v[28:31]
ds_read_b128 a[212:215],v4 offset:37888
v_add_f32 v21,v21,v56
v_mfma_f32_16x16x32_bf16 v[60:63],a[164:167],a[20:23],v[60:63]
ds_read_b128 a[184:187],v2 offset:14336
v_add_f32 v21,v21,v57
v_mfma_f32_16x16x32_bf16 v[60:63],a[168:171],a[24:27],v[60:63]
s_add_u32 m0,s4,32768
v_cvt_pk_bf16_f32 v88,v56,v57
v_mfma_f32_16x16x32_bf16 v[60:63],a[172:175],a[28:31],v[60:63]
s_add_u32 s5,s7,0
v_exp_f32 v58,v58
v_mfma_f32_16x16x32_bf16 v[132:135],a[200:203],v[96:99],v[132:135]
s_waitcnt lgkmcnt(5)
v_exp_f32 v59,v59
v_mfma_f32_16x16x32_bf16 v[132:135],a[204:207],v[100:103],v[132:135]
ds_read_b128 a[216:219],v4 offset:41984
buffer_load_dwordx4 v0,s[12:15],s5 offen lds
v_mfma_f32_16x16x32_bf16 v[164:167],a[200:203],v[104:107],v[164:167]
s_add_u32 m0,s4,33792
v_add_f32 v21,v21,v58
v_add_f32 v21,v21,v59
v_mfma_f32_16x16x32_bf16 v[164:167],a[204:207],v[108:111],v[164:167]
s_add_u32 s5,s7,8192
v_cvt_pk_bf16_f32 v89,v58,v59
v_mfma_f32_16x16x32_bf16 v[48:51],a[160:163],a[0:3],v[48:51]
ds_read_b128 a[188:191],v2 offset:15360
v_exp_f32 v60,v60
v_mfma_f32_16x16x32_bf16 v[48:51],a[164:167],a[4:7],v[48:51]
ds_read_b128 a[220:223],v4 offset:46080
buffer_load_dwordx4 v0,s[12:15],s5 offen lds
v_exp_f32 v61,v61
v_mfma_f32_16x16x32_bf16 v[48:51],a[168:171],a[8:11],v[48:51]
s_add_u32 m0,s4,34816
v_add_f32 v17,v17,v60
v_add_f32 v17,v17,v61
v_mfma_f32_16x16x32_bf16 v[48:51],a[172:175],a[12:15],v[48:51]
s_add_u32 s5,s7,16384
v_cvt_pk_bf16_f32 v72,v60,v61
v_mfma_f32_16x16x32_bf16 v[228:231],a[200:203],v[120:123],v[228:231]
ds_read_b128 a[160:163],v2 offset:16384
v_exp_f32 v62,v62
v_mfma_f32_16x16x32_bf16 v[228:231],a[204:207],v[124:127],v[228:231]
buffer_load_dwordx4 v0,s[12:15],s5 offen lds
v_exp_f32 v63,v63
s_waitcnt lgkmcnt(7)
v_mfma_f32_16x16x32_bf16 v[136:139],a[208:211],v[96:99],v[136:139]
s_add_u32 m0,s4,35840
v_add_f32 v17,v17,v62
v_add_f32 v17,v17,v63
s_waitcnt lgkmcnt(5)
v_mfma_f32_16x16x32_bf16 v[136:139],a[212:215],v[100:103],v[136:139]
ds_read_b128 a[192:195],v4 offset:34816
v_cvt_pk_bf16_f32 v73,v62,v63
v_mfma_f32_16x16x32_bf16 v[52:55],a[176:179],a[80:83],v[44:47]
s_add_u32 s5,s7,24576
v_exp_f32 v48,v48
v_mfma_f32_16x16x32_bf16 v[52:55],a[180:183],a[84:87],v[52:55]
buffer_load_dwordx4 v0,s[12:15],s5 offen lds
v_exp_f32 v49,v49
s_waitcnt lgkmcnt(5)
v_mfma_f32_16x16x32_bf16 v[52:55],a[184:187],a[88:91],v[52:55]
s_add_u32 m0,s4,36864
v_add_f32 v16,v16,v48
v_add_f32 v16,v16,v49
s_waitcnt lgkmcnt(3)
v_mfma_f32_16x16x32_bf16 v[52:55],a[188:191],a[92:95],v[52:55]
ds_read_b128 a[164:167],v2 offset:17408
v_cvt_pk_bf16_f32 v64,v48,v49
v_mfma_f32_16x16x32_bf16 v[168:171],a[208:211],v[104:107],v[168:171]
s_add_u32 s5,s7,32768
v_exp_f32 v50,v50
v_mfma_f32_16x16x32_bf16 v[168:171],a[212:215],v[108:111],v[168:171]
ds_read_b128 a[196:199],v4 offset:38912
buffer_load_dwordx4 v0,s[12:15],s5 offen lds
v_exp_f32 v51,v51
v_mfma_f32_16x16x32_bf16 v[232:235],a[208:211],v[120:123],v[232:235]
s_add_u32 m0,s4,37888
v_add_f32 v16,v16,v50
v_add_f32 v16,v16,v51
v_mfma_f32_16x16x32_bf16 v[232:235],a[212:215],v[124:127],v[232:235]
s_add_u32 s5,s7,40960
v_cvt_pk_bf16_f32 v65,v50,v51
v_cndmask_b32 v60,v6,v24,s[72:73]
v_mfma_f32_16x16x32_bf16 v[56:59],a[176:179],a[16:19],v[28:31]
v_cndmask_b32 v61,v6,v24,s[74:75]
v_cndmask_b32 v62,v6,v24,s[76:77]
v_cndmask_b32 v63,v6,v24,s[78:79]
v_exp_f32 v52,v52
v_mfma_f32_16x16x32_bf16 v[56:59],a[180:183],a[20:23],v[56:59]
ds_read_b128 a[168:171],v2 offset:18432
buffer_load_dwordx4 v0,s[12:15],s5 offen lds
v_exp_f32 v53,v53
v_mfma_f32_16x16x32_bf16 v[56:59],a[184:187],a[24:27],v[56:59]
s_add_u32 m0,s4,38912
v_add_f32 v21,v21,v52
v_add_f32 v21,v21,v53
v_mfma_f32_16x16x32_bf16 v[56:59],a[188:191],a[28:31],v[56:59]
s_add_u32 s5,s7,49152
v_cvt_pk_bf16_f32 v90,v52,v53
v_mfma_f32_16x16x32_bf16 v[140:143],a[216:219],v[96:99],v[140:143]
s_waitcnt lgkmcnt(5)
v_exp_f32 v54,v54
v_mfma_f32_16x16x32_bf16 v[140:143],a[220:223],v[100:103],v[140:143]
ds_read_b128 a[200:203],v4 offset:43008
buffer_load_dwordx4 v0,s[12:15],s5 offen lds
v_exp_f32 v55,v55
v_mfma_f32_16x16x32_bf16 v[172:175],a[216:219],v[104:107],v[172:175]
v_add_f32 v21,v21,v54
v_add_f32 v21,v21,v55
v_mfma_f32_16x16x32_bf16 v[172:175],a[220:223],v[108:111],v[172:175]
v_cvt_pk_bf16_f32 v91,v54,v55
v_mfma_f32_16x16x32_bf16 v[60:63],a[176:179],a[0:3],v[60:63]
v_exp_f32 v56,v56
v_mfma_f32_16x16x32_bf16 v[60:63],a[180:183],a[4:7],v[60:63]
ds_read_b128 a[172:175],v2 offset:19456
v_exp_f32 v57,v57
v_mfma_f32_16x16x32_bf16 v[60:63],a[184:187],a[8:11],v[60:63]
ds_read_b128 a[204:207],v4 offset:47104
v_add_f32 v17,v17,v56
v_mfma_f32_16x16x32_bf16 v[60:63],a[188:191],a[12:15],v[60:63]
ds_read_b128 a[176:179],v2 offset:20480
v_add_f32 v17,v17,v57
v_cvt_pk_bf16_f32 v74,v56,v57
v_mfma_f32_16x16x32_bf16 v[236:239],a[216:219],v[120:123],v[236:239]
v_exp_f32 v58,v58
v_mfma_f32_16x16x32_bf16 v[236:239],a[220:223],v[124:127],v[236:239]
s_waitcnt lgkmcnt(5)
v_exp_f32 v59,v59
v_mfma_f32_16x16x32_bf16 v[144:147],a[192:195],v[96:99],v[144:147]
ds_read_b128 a[208:211],v4 offset:35840
v_add_f32 v17,v17,v58
v_mfma_f32_16x16x32_bf16 v[144:147],a[196:199],v[100:103],v[144:147]
v_add_f32 v17,v17,v59
v_cvt_pk_bf16_f32 v75,v58,v59
v_mfma_f32_16x16x32_bf16 v[176:179],a[192:195],v[104:107],v[176:179]
ds_read_b128 a[180:183],v2 offset:21504
v_cndmask_b32 v52,v6,v28,s[64:65]
v_cndmask_b32 v53,v6,v28,s[66:67]
v_cndmask_b32 v54,v6,v28,s[68:69]
v_cndmask_b32 v55,v6,v28,s[70:71]
v_exp_f32 v60,v60
v_mfma_f32_16x16x32_bf16 v[176:179],a[196:199],v[108:111],v[176:179]
v_exp_f32 v61,v61
v_mfma_f32_16x16x32_bf16 v[48:51],a[160:163],a[80:83],v[44:47]
s_waitcnt lgkmcnt(6)
v_add_f32 v16,v16,v60
v_add_f32 v16,v16,v61
v_mfma_f32_16x16x32_bf16 v[48:51],a[164:167],a[84:87],v[48:51]
ds_read_b128 a[212:215],v4 offset:39936
v_cvt_pk_bf16_f32 v66,v60,v61
v_mfma_f32_16x16x32_bf16 v[48:51],a[168:171],a[88:91],v[48:51]
s_waitcnt lgkmcnt(5)
v_exp_f32 v62,v62
v_mfma_f32_16x16x32_bf16 v[48:51],a[172:175],a[92:95],v[48:51]
v_exp_f32 v63,v63
v_mfma_f32_16x16x32_bf16 v[240:243],a[192:195],v[120:123],v[240:243]
ds_read_b128 a[184:187],v2 offset:22528
v_add_f32 v16,v16,v62
v_mfma_f32_16x16x32_bf16 v[240:243],a[196:199],v[124:127],v[240:243]
s_waitcnt lgkmcnt(5)
v_add_f32 v16,v16,v63
v_cvt_pk_bf16_f32 v67,v62,v63
v_mfma_f32_16x16x32_bf16 v[148:151],a[200:203],v[96:99],v[148:151]
ds_read_b128 a[216:219],v4 offset:44032
v_mfma_f32_16x16x32_bf16 v[148:151],a[204:207],v[100:103],v[148:151]
v_mfma_f32_16x16x32_bf16 v[52:55],a[160:163],a[16:19],v[52:55]
v_exp_f32 v48,v48
v_mfma_f32_16x16x32_bf16 v[52:55],a[164:167],a[20:23],v[52:55]
ds_read_b128 a[188:191],v2 offset:23552
v_exp_f32 v49,v49
v_mfma_f32_16x16x32_bf16 v[52:55],a[168:171],a[24:27],v[52:55]
v_add_f32 v21,v21,v48
v_add_f32 v21,v21,v49
v_mfma_f32_16x16x32_bf16 v[52:55],a[172:175],a[28:31],v[52:55]
v_cvt_pk_bf16_f32 v92,v48,v49
v_mfma_f32_16x16x32_bf16 v[180:183],a[200:203],v[104:107],v[180:183]
v_exp_f32 v50,v50
v_mfma_f32_16x16x32_bf16 v[180:183],a[204:207],v[108:111],v[180:183]
v_exp_f32 v51,v51
v_mfma_f32_16x16x32_bf16 v[244:247],a[200:203],v[120:123],v[244:247]
ds_read_b128 a[220:223],v4 offset:48128
v_add_f32 v21,v21,v50
v_mfma_f32_16x16x32_bf16 v[244:247],a[204:207],v[124:127],v[244:247]
s_waitcnt lgkmcnt(7)
v_add_f32 v21,v21,v51
v_cvt_pk_bf16_f32 v93,v50,v51
v_mfma_f32_16x16x32_bf16 v[56:59],a[176:179],a[80:83],v[44:47]
s_waitcnt lgkmcnt(5)
v_cndmask_b32 v60,v6,v28,s[72:73]
v_cndmask_b32 v61,v6,v28,s[74:75]
v_cndmask_b32 v62,v6,v28,s[76:77]
v_cndmask_b32 v63,v6,v28,s[78:79]
v_exp_f32 v52,v52
v_mfma_f32_16x16x32_bf16 v[56:59],a[180:183],a[84:87],v[56:59]
s_waitcnt lgkmcnt(3)
v_exp_f32 v53,v53
v_mfma_f32_16x16x32_bf16 v[56:59],a[184:187],a[88:91],v[56:59]
s_waitcnt lgkmcnt(1)
v_add_f32 v17,v17,v52
v_add_f32 v17,v17,v53
v_mfma_f32_16x16x32_bf16 v[56:59],a[188:191],a[92:95],v[56:59]
v_cvt_pk_bf16_f32 v76,v52,v53
v_mfma_f32_16x16x32_bf16 v[152:155],a[208:211],v[96:99],v[152:155]
v_exp_f32 v54,v54
v_mfma_f32_16x16x32_bf16 v[152:155],a[212:215],v[100:103],v[152:155]
v_exp_f32 v55,v55
v_mfma_f32_16x16x32_bf16 v[184:187],a[208:211],v[104:107],v[184:187]
v_add_f32 v17,v17,v54
v_add_f32 v17,v17,v55
v_mfma_f32_16x16x32_bf16 v[184:187],a[212:215],v[108:111],v[184:187]
s_waitcnt vmcnt(7) lgkmcnt(0)
v_cvt_pk_bf16_f32 v77,v54,v55
v_mfma_f32_16x16x32_bf16 v[60:63],a[176:179],a[16:19],v[60:63]
s_barrier
v_exp_f32 v56,v56
v_mfma_f32_16x16x32_bf16 v[60:63],a[180:183],a[20:23],v[60:63]
v_exp_f32 v57,v57
v_mfma_f32_16x16x32_bf16 v[60:63],a[184:187],a[24:27],v[60:63]
ds_read_b128 a[192:195],v4 offset:4096
v_add_f32 v21,v21,v56
v_mfma_f32_16x16x32_bf16 v[60:63],a[188:191],a[28:31],v[60:63]
ds_read_b128 a[196:199],v4 offset:16384
v_add_f32 v21,v21,v57
v_cvt_pk_bf16_f32 v94,v56,v57
v_mfma_f32_16x16x32_bf16 v[248:251],a[208:211],v[120:123],v[248:251]
v_exp_f32 v58,v58
v_mfma_f32_16x16x32_bf16 v[248:251],a[212:215],v[124:127],v[248:251]
v_exp_f32 v59,v59
v_mfma_f32_16x16x32_bf16 v[156:159],a[216:219],v[96:99],v[156:159]
ds_read_b128 a[200:203],v4 offset:12288
v_add_f32 v21,v21,v58
v_mfma_f32_16x16x32_bf16 v[156:159],a[220:223],v[100:103],v[156:159]
v_add_f32 v21,v21,v59
v_cvt_pk_bf16_f32 v95,v58,v59
v_mfma_f32_16x16x32_bf16 v[188:191],a[216:219],v[104:107],v[188:191]
v_exp_f32 v60,v60
v_mfma_f32_16x16x32_bf16 v[188:191],a[220:223],v[108:111],v[188:191]
ds_read_b128 a[204:207],v4 offset:24576
v_exp_f32 v61,v61
v_mfma_f32_16x16x32_bf16 v[252:255],a[216:219],v[120:123],v[252:255]
v_add_f32 v17,v17,v60
v_add_f32 v17,v17,v61
v_mfma_f32_16x16x32_bf16 v[252:255],a[220:223],v[124:127],v[252:255]
s_waitcnt lgkmcnt(3)
v_cvt_pk_bf16_f32 v78,v60,v61
v_mfma_f32_16x16x32_bf16 a[128:131],a[192:195],v[88:91],a[128:131]
s_waitcnt lgkmcnt(2)
v_exp_f32 v62,v62
v_mfma_f32_16x16x32_bf16 a[128:131],a[196:199],v[92:95],a[128:131]
ds_read_b128 a[208:211],v4 offset:5120
v_exp_f32 v63,v63
v_add_f32 v17,v17,v62
v_add_f32 v17,v17,v63
v_cvt_pk_bf16_f32 v79,v62,v63
v_mfma_f32_16x16x32_bf16 v[128:131],a[192:195],v[64:67],v[128:131]
ds_write_b128 v12,a[96:99] offset:0
v_mfma_f32_16x16x32_bf16 v[160:163],a[192:195],v[72:75],v[160:163]
ds_write_b128 v12,a[100:103] offset:1024
ds_write_b128 v12,a[104:107] offset:2048
ds_write_b128 v12,a[108:111] offset:3072
ds_write_b128 v12,a[112:115] offset:4096
ds_write_b128 v12,a[116:119] offset:5120
ds_write_b128 v12,a[120:123] offset:6144
ds_write_b128 v12,a[124:127] offset:7168
ds_read_b128 a[212:215],v4 offset:17408
v_mfma_f32_16x16x32_bf16 v[160:163],a[196:199],v[76:79],v[160:163]
s_waitcnt lgkmcnt(10)
v_mov_b32 v8,v18
v_mov_b32 v9,v19
v_mfma_f32_16x16x32_bf16 a[132:135],a[200:203],v[88:91],a[132:135]
ds_read_b128 a[216:219],v4 offset:13312
v_permlane32_swap_b32 v8,v18
v_mfma_f32_16x16x32_bf16 a[132:135],a[204:207],v[92:95],a[132:135]
ds_write_b128 v12,a[128:131] offset:8192
v_mfma_f32_16x16x32_bf16 v[132:135],a[200:203],v[64:67],v[132:135]
ds_read_b128 a[220:223],v4 offset:25600
v_permlane32_swap_b32 v9,v19
v_mfma_f32_16x16x32_bf16 v[164:167],a[200:203],v[72:75],v[164:167]
v_add_f32 v18,v18,v8
v_add_f32 v19,v19,v9
v_mfma_f32_16x16x32_bf16 v[164:167],a[204:207],v[76:79],v[164:167]
s_waitcnt lgkmcnt(3)
v_mov_b32 v8,v18
v_mov_b32 v9,v19
v_mfma_f32_16x16x32_bf16 a[136:139],a[208:211],v[88:91],a[136:139]
ds_read_b128 a[192:195],v4 offset:6144
v_permlane16_swap_b32 v8,v18
v_mfma_f32_16x16x32_bf16 a[136:139],a[212:215],v[92:95],a[136:139]
ds_write_b128 v12,a[132:135] offset:9216
v_mfma_f32_16x16x32_bf16 v[136:139],a[208:211],v[64:67],v[136:139]
ds_read_b128 a[196:199],v4 offset:18432
v_permlane16_swap_b32 v9,v19
v_mfma_f32_16x16x32_bf16 v[168:171],a[208:211],v[72:75],v[168:171]
v_add_f32 v18,v18,v8
v_add_f32 v19,v19,v9
v_mfma_f32_16x16x32_bf16 v[168:171],a[212:215],v[76:79],v[168:171]
s_waitcnt lgkmcnt(5)
v_rcp_f32 v8,v18
v_mfma_f32_16x16x32_bf16 a[140:143],a[216:219],v[88:91],a[140:143]
s_waitcnt lgkmcnt(3)
v_rcp_f32 v9,v19
v_mfma_f32_16x16x32_bf16 a[140:143],a[220:223],v[92:95],a[140:143]
ds_read_b128 a[200:203],v4 offset:14336
v_mul_f32 v192,v8,v192
v_mfma_f32_16x16x32_bf16 v[140:143],a[216:219],v[64:67],v[140:143]
ds_write_b128 v12,a[136:139] offset:10240
v_mfma_f32_16x16x32_bf16 v[172:175],a[216:219],v[72:75],v[172:175]
ds_read_b128 a[204:207],v4 offset:26624
v_mul_f32 v193,v8,v193
v_mfma_f32_16x16x32_bf16 v[172:175],a[220:223],v[76:79],v[172:175]
s_waitcnt lgkmcnt(3)
v_mul_f32 v194,v8,v194
v_mul_f32 v195,v8,v195
v_mfma_f32_16x16x32_bf16 a[144:147],a[192:195],v[88:91],a[144:147]
ds_read_b128 a[208:211],v4 offset:7168
v_mul_f32 v196,v8,v196
v_mfma_f32_16x16x32_bf16 a[144:147],a[196:199],v[92:95],a[144:147]
ds_write_b128 v12,a[140:143] offset:11264
v_mfma_f32_16x16x32_bf16 v[144:147],a[192:195],v[64:67],v[144:147]
ds_read_b128 a[212:215],v4 offset:19456
v_mul_f32 v197,v8,v197
v_mfma_f32_16x16x32_bf16 v[176:179],a[192:195],v[72:75],v[176:179]
v_mul_f32 v198,v8,v198
v_mul_f32 v199,v8,v199
v_mfma_f32_16x16x32_bf16 v[176:179],a[196:199],v[76:79],v[176:179]
s_waitcnt lgkmcnt(3)
v_cvt_pk_bf16_f32 v192,v192,v193
v_cvt_pk_bf16_f32 v193,v194,v195
v_mfma_f32_16x16x32_bf16 a[148:151],a[200:203],v[88:91],a[148:151]
ds_read_b128 a[216:219],v4 offset:15360
v_cvt_pk_bf16_f32 v194,v196,v197
v_mfma_f32_16x16x32_bf16 a[148:151],a[204:207],v[92:95],a[148:151]
ds_write_b128 v12,a[144:147] offset:12288
v_mfma_f32_16x16x32_bf16 v[148:151],a[200:203],v[64:67],v[148:151]
ds_read_b128 a[220:223],v4 offset:27648
v_cvt_pk_bf16_f32 v195,v198,v199
v_mfma_f32_16x16x32_bf16 v[180:183],a[200:203],v[72:75],v[180:183]
buffer_store_dwordx4 v[192:195],v1,s[16:19],s88 offen offset:0 sc1
v_mfma_f32_16x16x32_bf16 v[180:183],a[204:207],v[76:79],v[180:183]
s_waitcnt lgkmcnt(5)
v_mul_f32 v200,v8,v200
v_mul_f32 v201,v8,v201
v_mfma_f32_16x16x32_bf16 a[152:155],a[208:211],v[88:91],a[152:155]
s_waitcnt lgkmcnt(3)
v_mul_f32 v202,v8,v202
v_mul_f32 v203,v8,v203
v_mfma_f32_16x16x32_bf16 a[152:155],a[212:215],v[92:95],a[152:155]
ds_write_b128 v12,a[148:151] offset:13312
v_mfma_f32_16x16x32_bf16 v[152:155],a[208:211],v[64:67],v[152:155]
v_mul_f32 v204,v8,v204
v_mul_f32 v205,v8,v205
v_mfma_f32_16x16x32_bf16 v[184:187],a[208:211],v[72:75],v[184:187]
v_mul_f32 v206,v8,v206
v_mul_f32 v207,v8,v207
v_mfma_f32_16x16x32_bf16 v[184:187],a[212:215],v[76:79],v[184:187]
s_waitcnt lgkmcnt(3)
v_cvt_pk_bf16_f32 v200,v200,v201
v_cvt_pk_bf16_f32 v201,v202,v203
v_mfma_f32_16x16x32_bf16 a[156:159],a[216:219],v[88:91],a[156:159]
s_waitcnt lgkmcnt(1)
v_cvt_pk_bf16_f32 v202,v204,v205
v_cvt_pk_bf16_f32 v203,v206,v207
v_mfma_f32_16x16x32_bf16 a[156:159],a[220:223],v[92:95],a[156:159]
buffer_store_dwordx4 v[200:203],v1,s[16:19],s88 offen offset:1024 sc1
v_mfma_f32_16x16x32_bf16 v[156:159],a[216:219],v[64:67],v[156:159]
ds_write_b128 v12,a[152:155] offset:14336
v_mfma_f32_16x16x32_bf16 v[188:191],a[216:219],v[72:75],v[188:191]
v_mul_f32 v208,v8,v208
v_mul_f32 v209,v8,v209
v_mfma_f32_16x16x32_bf16 v[188:191],a[220:223],v[76:79],v[188:191]
v_mul_f32 v210,v8,v210
v_mul_f32 v211,v8,v211
v_mul_f32 v212,v8,v212
v_mul_f32 v213,v8,v213
v_mul_f32 v214,v8,v214
v_mul_f32 v215,v8,v215
v_cvt_pk_bf16_f32 v208,v208,v209
v_cvt_pk_bf16_f32 v209,v210,v211
v_cvt_pk_bf16_f32 v210,v212,v213
v_cvt_pk_bf16_f32 v211,v214,v215
buffer_store_dwordx4 v[208:211],v1,s[16:19],s88 offen offset:2048 sc1
v_mul_f32 v216,v8,v216
v_mul_f32 v217,v8,v217
v_mul_f32 v218,v8,v218
v_mul_f32 v219,v8,v219
v_mul_f32 v220,v8,v220
v_mul_f32 v221,v8,v221
v_mul_f32 v222,v8,v222
v_mul_f32 v223,v8,v223
v_cvt_pk_bf16_f32 v216,v216,v217
v_cvt_pk_bf16_f32 v217,v218,v219
v_cvt_pk_bf16_f32 v218,v220,v221
v_cvt_pk_bf16_f32 v219,v222,v223
buffer_store_dwordx4 v[216:219],v1,s[16:19],s88 offen offset:3072 sc1
v_mul_f32 v224,v9,v224
v_mul_f32 v225,v9,v225
v_mul_f32 v226,v9,v226
v_mul_f32 v227,v9,v227
v_mul_f32 v228,v9,v228
v_mul_f32 v229,v9,v229
v_mul_f32 v230,v9,v230
v_mul_f32 v231,v9,v231
v_cvt_pk_bf16_f32 v224,v224,v225
v_cvt_pk_bf16_f32 v225,v226,v227
v_cvt_pk_bf16_f32 v226,v228,v229
v_cvt_pk_bf16_f32 v227,v230,v231
buffer_store_dwordx4 v[224:227],v1,s[16:19],s89 offen offset:0 sc1
v_mul_f32 v232,v9,v232
v_mul_f32 v233,v9,v233
v_mul_f32 v234,v9,v234
v_mul_f32 v235,v9,v235
v_mul_f32 v236,v9,v236
v_mul_f32 v237,v9,v237
v_mul_f32 v238,v9,v238
v_mul_f32 v239,v9,v239
v_cvt_pk_bf16_f32 v232,v232,v233
v_cvt_pk_bf16_f32 v233,v234,v235
v_cvt_pk_bf16_f32 v234,v236,v237
v_cvt_pk_bf16_f32 v235,v238,v239
buffer_store_dwordx4 v[232:235],v1,s[16:19],s89 offen offset:1024 sc1
v_mul_f32 v240,v9,v240
v_mul_f32 v241,v9,v241
v_mul_f32 v242,v9,v242
v_mul_f32 v243,v9,v243
v_mul_f32 v244,v9,v244
v_mul_f32 v245,v9,v245
v_mul_f32 v246,v9,v246
v_mul_f32 v247,v9,v247
v_cvt_pk_bf16_f32 v240,v240,v241
v_cvt_pk_bf16_f32 v241,v242,v243
v_cvt_pk_bf16_f32 v242,v244,v245
v_cvt_pk_bf16_f32 v243,v246,v247
buffer_store_dwordx4 v[240:243],v1,s[16:19],s89 offen offset:2048 sc1
v_mul_f32 v248,v9,v248
v_mul_f32 v249,v9,v249
v_mul_f32 v250,v9,v250
v_mul_f32 v251,v9,v251
v_mul_f32 v252,v9,v252
v_mul_f32 v253,v9,v253
v_mul_f32 v254,v9,v254
v_mul_f32 v255,v9,v255
v_cvt_pk_bf16_f32 v248,v248,v249
v_cvt_pk_bf16_f32 v249,v250,v251
v_cvt_pk_bf16_f32 v250,v252,v253
v_cvt_pk_bf16_f32 v251,v254,v255
buffer_store_dwordx4 v[248:251],v1,s[16:19],s89 offen offset:3072 sc1
s_nop 3
ds_write_b128 v12,a[156:159] offset:15360
s_branch K2_FIN
K2_SLOW:
s_waitcnt vmcnt(0) lgkmcnt(0)
s_barrier
s_mov_b32 s27,1
s_mov_b32 s4,0x40000000
s_mov_b32 s5,0x40000000
s_mov_b32 s6,0x40000000
s_mov_b32 s7,0x40000000
v_and_b32 v8,15,v7
v_lshrrev_b32 v9,4,v7
v_lshlrev_b32 v9,2,v9
v_sub_u32 v8,v8,v9
s_lshl_b32 s28,s20,4
v_add_u32 v9,s28,v8
s_lshr_b32 s28,s20,1
s_lshl_b32 s28,s28,4
v_add_u32 v10,s28,v8
v_cmp_le_i32 s[32:33],0,v9
v_cmp_le_i32 s[34:35],1,v9
v_cmp_le_i32 s[36:37],2,v9
v_cmp_le_i32 s[38:39],3,v9
v_cmp_le_i32 s[40:41],16,v9
v_cmp_le_i32 s[42:43],17,v9
v_cmp_le_i32 s[44:45],18,v9
v_cmp_le_i32 s[46:47],19,v9
v_cmp_le_i32 s[48:49],32,v9
v_cmp_le_i32 s[50:51],33,v9
v_cmp_le_i32 s[52:53],34,v9
v_cmp_le_i32 s[54:55],35,v9
v_cmp_le_i32 s[56:57],48,v9
v_cmp_le_i32 s[58:59],49,v9
v_cmp_le_i32 s[60:61],50,v9
v_cmp_le_i32 s[62:63],51,v9
v_cmp_le_i32 s[64:65],0,v10
v_cmp_le_i32 s[66:67],1,v10
v_cmp_le_i32 s[68:69],2,v10
v_cmp_le_i32 s[70:71],3,v10
v_cmp_le_i32 s[72:73],16,v10
v_cmp_le_i32 s[74:75],17,v10
v_cmp_le_i32 s[76:77],18,v10
v_cmp_le_i32 s[78:79],19,v10
v_lshrrev_b32 v48,3,v7
v_lshlrev_b32 v48,10,v48
v_bfe_u32 v49,v7,1,2
v_lshrrev_b32 v50,4,v7
v_xor_b32 v49,v49,v50
v_lshl_add_u32 v48,v49,5,v48
v_and_b32 v49,1,v7
v_lshl_add_u32 v48,v49,4,v48
s_and_b32 s28,s21,3
s_lshl_b32 s28,s28,8
s_and_b32 s29,s20,1
s_lshl_b32 s29,s29,7
s_add_u32 s28,s28,s29
s_lshr_b32 s29,s20,1
s_lshl_b32 s29,s29,16
s_add_u32 s28,s28,s29
v_add_u32 v48,s28,v48
v_accvgpr_write_b32 a248,v48
s_mov_b32 s12,s90
s_and_b32 s13,s91,0xffff
s_lshr_b32 s30,s2,3
s_lshl_b32 s30,s30,2
s_add_u32 s30,s30,s20
s_lshl_b32 s30,s30,10
v_and_b32 v48,7,v7
v_lshlrev_b32 v48,7,v48
v_add_u32 v48,s30,v48
v_min_u32 v48,F_END-F_PC,v48
v_accvgpr_write_b32 a251,v48
s_lshr_b32 s28,s20,1
s_mul_i32 s29,s28,98304
s_and_b32 s30,s20,1
s_lshl_b32 s30,s30,14
s_add_u32 s29,s29,s30
v_add_u32 v12,s29,v1
v_xor_b32 v13,16384,v12
s_lshl_b32 s28,s28,13
s_add_u32 s28,s28,s30
s_add_u32 s28,s28,39936
v_lshrrev_b32 v14,1,v1
v_add_u32 v14,s28,v14
v_mov_b32 v15,0x5d800000
s_lshl_b32 s86,s80,17
s_lshl_b32 s28,s21,12
s_add_u32 s86,s86,s28
s_add_u32 s86,s86,33554432
s_lshl_b32 s87,s81,17
s_lshl_b32 s28,s21,12
s_add_u32 s87,s87,s28
s_add_u32 s87,s87,33554432
s_lshl_b32 s88,s82,17
s_lshl_b32 s28,s21,12
s_add_u32 s88,s88,s28
s_add_u32 s88,s88,33554432
s_lshl_b32 s89,s83,17
s_lshl_b32 s28,s21,12
s_add_u32 s89,s89,s28
s_add_u32 s89,s89,33554432
v_lshrrev_b32 v8,3,v7
v_lshlrev_b32 v0,14,v8
v_lshlrev_b32 v8,9,v8
v_mov_b32 v9,0
v_mov_b32 v10,0
v_mov_b32 v11,2
s_mov_b32 s8,0
s_mov_b32 s101,0
s_and_b32 s3,s99,0xfffff1ff
s_and_b32 s9,s21,28
s_lshl_b32 s9,s9,17
s_and_b32 s28,s21,3
s_lshl_b32 s28,s28,8
s_add_u32 s9,s9,s28
s_lshl_b32 s28,s20,10
s_add_u32 s9,s9,s28
s_lshl_b32 s28,s22,3
s_sub_u32 s28,s28,32
s_lshr_b32 s10,0x00060b0f,s28
s_and_b32 s10,s10,0xff
s_cmp_lt_u32 s22,4
s_cselect_b32 s10,16,s10
v_mov_b32 v24,v6
v_mov_b32 v28,v6
v_mov_b32 v32,v6
v_mov_b32 v36,v6
v_mov_b32 v40,v6
v_mov_b32 v44,v6
v_and_b32 v64,15,v7
v_lshrrev_b32 v65,4,v7
v_lshlrev_b32 v65,2,v65
v_sub_u32 v64,v64,v65
s_lshl_b32 s28,s80,4
v_add_u32 v66,s28,v64
s_lshl_b32 s28,s81,4
v_add_u32 v67,s28,v64
s_lshl_b32 s28,s82,4
v_add_u32 v68,s28,v64
s_lshl_b32 s28,s83,4
v_add_u32 v69,s28,v64
s_lshl_b32 s28,s84,4
v_add_u32 v70,s28,v64
s_lshl_b32 s28,s85,4
v_add_u32 v71,s28,v64
s_lshl_b32 s24,s21,19
s_sub_u32 s26,16,s22
s_lshl_b32 s26,s26,3
K2_SLOWL:
buffer_load_dwordx4 a[160:163],v1,s[16:19],s24 offen offset:0 sc1
buffer_load_dwordx4 a[164:167],v1,s[16:19],s24 offen offset:1024 sc1
buffer_load_dwordx4 a[168:171],v1,s[16:19],s24 offen offset:2048 sc1
buffer_load_dwordx4 a[172:175],v1,s[16:19],s24 offen offset:3072 sc1
s_waitcnt vmcnt(0)
v_mfma_f32_16x16x32_bf16 v[80:83],a[160:163],a[0:3],0
v_mfma_f32_16x16x32_bf16 v[80:83],a[164:167],a[4:7],v[80:83]
v_mfma_f32_16x16x32_bf16 v[80:83],a[168:171],a[8:11],v[80:83]
v_mfma_f32_16x16x32_bf16 v[80:83],a[172:175],a[12:15],v[80:83]
v_mfma_f32_16x16x32_bf16 v[84:87],a[160:163],a[16:19],0
v_mfma_f32_16x16x32_bf16 v[84:87],a[164:167],a[20:23],v[84:87]
v_mfma_f32_16x16x32_bf16 v[84:87],a[168:171],a[24:27],v[84:87]
v_mfma_f32_16x16x32_bf16 v[84:87],a[172:175],a[28:31],v[84:87]
v_mfma_f32_16x16x32_bf16 v[88:91],a[160:163],a[32:35],0
v_mfma_f32_16x16x32_bf16 v[88:91],a[164:167],a[36:39],v[88:91]
v_mfma_f32_16x16x32_bf16 v[88:91],a[168:171],a[40:43],v[88:91]
v_mfma_f32_16x16x32_bf16 v[88:91],a[172:175],a[44:47],v[88:91]
v_mfma_f32_16x16x32_bf16 v[92:95],a[160:163],a[48:51],0
v_mfma_f32_16x16x32_bf16 v[92:95],a[164:167],a[52:55],v[92:95]
v_mfma_f32_16x16x32_bf16 v[92:95],a[168:171],a[56:59],v[92:95]
v_mfma_f32_16x16x32_bf16 v[92:95],a[172:175],a[60:63],v[92:95]
v_mfma_f32_16x16x32_bf16 v[96:99],a[160:163],a[64:67],0
v_mfma_f32_16x16x32_bf16 v[96:99],a[164:167],a[68:71],v[96:99]
v_mfma_f32_16x16x32_bf16 v[96:99],a[168:171],a[72:75],v[96:99]
v_mfma_f32_16x16x32_bf16 v[96:99],a[172:175],a[76:79],v[96:99]
v_mfma_f32_16x16x32_bf16 v[100:103],a[160:163],a[80:83],0
v_mfma_f32_16x16x32_bf16 v[100:103],a[164:167],a[84:87],v[100:103]
v_mfma_f32_16x16x32_bf16 v[100:103],a[168:171],a[88:91],v[100:103]
v_mfma_f32_16x16x32_bf16 v[100:103],a[172:175],a[92:95],v[100:103]
s_nop 7
v_cmp_le_i32 vcc,0,v66
s_nop 1
v_cndmask_b32 v80,v6,v80,vcc
v_max_f32 v24,v24,v80
v_cmp_le_i32 vcc,1,v66
s_nop 1
v_cndmask_b32 v81,v6,v81,vcc
v_max_f32 v24,v24,v81
v_cmp_le_i32 vcc,2,v66
s_nop 1
v_cndmask_b32 v82,v6,v82,vcc
v_max_f32 v24,v24,v82
v_cmp_le_i32 vcc,3,v66
s_nop 1
v_cndmask_b32 v83,v6,v83,vcc
v_max_f32 v24,v24,v83
v_subrev_u32 v66,16,v66
v_cmp_le_i32 vcc,0,v67
s_nop 1
v_cndmask_b32 v84,v6,v84,vcc
v_max_f32 v28,v28,v84
v_cmp_le_i32 vcc,1,v67
s_nop 1
v_cndmask_b32 v85,v6,v85,vcc
v_max_f32 v28,v28,v85
v_cmp_le_i32 vcc,2,v67
s_nop 1
v_cndmask_b32 v86,v6,v86,vcc
v_max_f32 v28,v28,v86
v_cmp_le_i32 vcc,3,v67
s_nop 1
v_cndmask_b32 v87,v6,v87,vcc
v_max_f32 v28,v28,v87
v_subrev_u32 v67,16,v67
v_cmp_le_i32 vcc,0,v68
s_nop 1
v_cndmask_b32 v88,v6,v88,vcc
v_max_f32 v32,v32,v88
v_cmp_le_i32 vcc,1,v68
s_nop 1
v_cndmask_b32 v89,v6,v89,vcc
v_max_f32 v32,v32,v89
v_cmp_le_i32 vcc,2,v68
s_nop 1
v_cndmask_b32 v90,v6,v90,vcc
v_max_f32 v32,v32,v90
v_cmp_le_i32 vcc,3,v68
s_nop 1
v_cndmask_b32 v91,v6,v91,vcc
v_max_f32 v32,v32,v91
v_subrev_u32 v68,16,v68
v_cmp_le_i32 vcc,0,v69
s_nop 1
v_cndmask_b32 v92,v6,v92,vcc
v_max_f32 v36,v36,v92
v_cmp_le_i32 vcc,1,v69
s_nop 1
v_cndmask_b32 v93,v6,v93,vcc
v_max_f32 v36,v36,v93
v_cmp_le_i32 vcc,2,v69
s_nop 1
v_cndmask_b32 v94,v6,v94,vcc
v_max_f32 v36,v36,v94
v_cmp_le_i32 vcc,3,v69
s_nop 1
v_cndmask_b32 v95,v6,v95,vcc
v_max_f32 v36,v36,v95
v_subrev_u32 v69,16,v69
v_cmp_le_i32 vcc,0,v70
s_nop 1
v_cndmask_b32 v96,v6,v96,vcc
v_max_f32 v40,v40,v96
v_cmp_le_i32 vcc,1,v70
s_nop 1
v_cndmask_b32 v97,v6,v97,vcc
v_max_f32 v40,v40,v97
v_cmp_le_i32 vcc,2,v70
s_nop 1
v_cndmask_b32 v98,v6,v98,vcc
v_max_f32 v40,v40,v98
v_cmp_le_i32 vcc,3,v70
s_nop 1
v_cndmask_b32 v99,v6,v99,vcc
v_max_f32 v40,v40,v99
v_subrev_u32 v70,16,v70
v_cmp_le_i32 vcc,0,v71
s_nop 1
v_cndmask_b32 v100,v6,v100,vcc
v_max_f32 v44,v44,v100
v_cmp_le_i32 vcc,1,v71
s_nop 1
v_cndmask_b32 v101,v6,v101,vcc
v_max_f32 v44,v44,v101
v_cmp_le_i32 vcc,2,v71
s_nop 1
v_cndmask_b32 v102,v6,v102,vcc
v_max_f32 v44,v44,v102
v_cmp_le_i32 vcc,3,v71
s_nop 1
v_cndmask_b32 v103,v6,v103,vcc
v_max_f32 v44,v44,v103
v_subrev_u32 v71,16,v71
s_add_u32 s24,s24,4096
s_sub_u32 s26,s26,1
s_cmp_lg_u32 s26,0
s_cbranch_scc1 K2_SLOWL
v_mov_b32 v25,v24
v_mov_b32 v29,v28
v_mov_b32 v33,v32
v_mov_b32 v37,v36
v_mov_b32 v41,v40
v_mov_b32 v45,v44
v_permlane32_swap_b32 v25,v24
v_permlane32_swap_b32 v29,v28
v_permlane32_swap_b32 v33,v32
v_permlane32_swap_b32 v37,v36
v_permlane32_swap_b32 v41,v40
v_permlane32_swap_b32 v45,v44
v_max_f32 v24,v24,v25
v_max_f32 v28,v28,v29
v_max_f32 v32,v32,v33
v_max_f32 v36,v36,v37
v_max_f32 v40,v40,v41
v_max_f32 v44,v44,v45
v_mov_b32 v25,v24
v_mov_b32 v29,v28
v_mov_b32 v33,v32
v_mov_b32 v37,v36
v_mov_b32 v41,v40
v_mov_b32 v45,v44
v_permlane16_swap_b32 v25,v24
v_permlane16_swap_b32 v29,v28
v_permlane16_swap_b32 v33,v32
v_permlane16_swap_b32 v37,v36
v_permlane16_swap_b32 v41,v40
v_permlane16_swap_b32 v45,v44
v_max_f32 v24,v24,v25
v_max_f32 v28,v28,v29
v_max_f32 v32,v32,v33
v_max_f32 v36,v36,v37
v_max_f32 v40,v40,v41
v_max_f32 v44,v44,v45
v_accvgpr_write_b32 a96,0
v_accvgpr_write_b32 a97,0
v_accvgpr_write_b32 a98,0
v_accvgpr_write_b32 a99,0
v_accvgpr_write_b32 a100,0
v_accvgpr_write_b32 a101,0
v_accvgpr_write_b32 a102,0
v_accvgpr_write_b32 a103,0
v_accvgpr_write_b32 a104,0
v_accvgpr_write_b32 a105,0
v_accvgpr_write_b32 a106,0
v_accvgpr_write_b32 a107,0
v_accvgpr_write_b32 a108,0
v_accvgpr_write_b32 a109,0
v_accvgpr_write_b32 a110,0
v_accvgpr_write_b32 a111,0
v_accvgpr_write_b32 a112,0
v_accvgpr_write_b32 a113,0
v_accvgpr_write_b32 a114,0
v_accvgpr_write_b32 a115,0
v_accvgpr_write_b32 a116,0
v_accvgpr_write_b32 a117,0
v_accvgpr_write_b32 a118,0
v_accvgpr_write_b32 a119,0
v_accvgpr_write_b32 a120,0
v_accvgpr_write_b32 a121,0
v_accvgpr_write_b32 a122,0
v_accvgpr_write_b32 a123,0
v_accvgpr_write_b32 a124,0
v_accvgpr_write_b32 a125,0
v_accvgpr_write_b32 a126,0
v_accvgpr_write_b32 a127,0
v_accvgpr_write_b32 a128,0
v_accvgpr_write_b32 a129,0
v_accvgpr_write_b32 a130,0
v_accvgpr_write_b32 a131,0
v_accvgpr_write_b32 a132,0
v_accvgpr_write_b32 a133,0
v_accvgpr_write_b32 a134,0
v_accvgpr_write_b32 a135,0
v_accvgpr_write_b32 a136,0
v_accvgpr_write_b32 a137,0
v_accvgpr_write_b32 a138,0
v_accvgpr_write_b32 a139,0
v_accvgpr_write_b32 a140,0
v_accvgpr_write_b32 a141,0
v_accvgpr_write_b32 a142,0
v_accvgpr_write_b32 a143,0
v_accvgpr_write_b32 a144,0
v_accvgpr_write_b32 a145,0
v_accvgpr_write_b32 a146,0
v_accvgpr_write_b32 a147,0
v_accvgpr_write_b32 a148,0
v_accvgpr_write_b32 a149,0
v_accvgpr_write_b32 a150,0
v_accvgpr_write_b32 a151,0
v_accvgpr_write_b32 a152,0
v_accvgpr_write_b32 a153,0
v_accvgpr_write_b32 a154,0
v_accvgpr_write_b32 a155,0
v_accvgpr_write_b32 a156,0
v_accvgpr_write_b32 a157,0
v_accvgpr_write_b32 a158,0
v_accvgpr_write_b32 a159,0
s_lshl_b32 s28,s21,19
s_add_u32 s28,s28,s23
s_sub_u32 s24,s28,16384
s_add_u32 s25,s24,16777216
s_add_u32 m0,s23,0
s_add_u32 s24,s24,16384
buffer_load_dwordx4 v1,s[16:19],s24 offen offset:0 sc1 lds
buffer_load_dwordx4 v1,s[16:19],s24 offen offset:1024 sc1 lds
buffer_load_dwordx4 v1,s[16:19],s24 offen offset:2048 sc1 lds
buffer_load_dwordx4 v1,s[16:19],s24 offen offset:3072 sc1 lds
s_add_u32 m0,s23,65536
s_add_u32 s25,s25,16384
buffer_load_dwordx4 v1,s[16:19],s25 offen offset:0 sc1 lds
buffer_load_dwordx4 v1,s[16:19],s25 offen offset:1024 sc1 lds
buffer_load_dwordx4 v1,s[16:19],s25 offen offset:2048 sc1 lds
buffer_load_dwordx4 v1,s[16:19],s25 offen offset:3072 sc1 lds
s_add_u32 m0,s23,32768
s_add_u32 s24,s24,16384
buffer_load_dwordx4 v1,s[16:19],s24 offen offset:0 sc1 lds
buffer_load_dwordx4 v1,s[16:19],s24 offen offset:1024 sc1 lds
buffer_load_dwordx4 v1,s[16:19],s24 offen offset:2048 sc1 lds
buffer_load_dwordx4 v1,s[16:19],s24 offen offset:3072 sc1 lds
s_waitcnt vmcnt(8)
s_barrier
ds_read_b128 a[160:163],v2 offset:0
ds_read_b128 a[164:167],v2 offset:1024
ds_read_b128 a[168:171],v2 offset:2048
ds_read_b128 a[172:175],v2 offset:3072
s_waitcnt lgkmcnt(0)
s_branch K2_ATT
K2_TAIL1:
s_waitcnt lgkmcnt(7)
v_mfma_f32_16x16x32_bf16 v[48:51],a[160:163],a[0:3],v[24:27]
s_waitcnt lgkmcnt(5)
v_exp_f32 v60,v60
v_mfma_f32_16x16x32_bf16 v[48:51],a[164:167],a[4:7],v[48:51]
s_waitcnt lgkmcnt(1)
v_exp_f32 v61,v61
v_mfma_f32_16x16x32_bf16 v[48:51],a[168:171],a[8:11],v[48:51]
ds_read_b128 a[176:179],v3 offset:36864
v_add_f32 v21,v21,v60
v_mfma_f32_16x16x32_bf16 v[48:51],a[172:175],a[12:15],v[48:51]
buffer_load_dwordx4 v1,s[16:19],s24 offen offset:2048 sc1 lds
v_add_f32 v21,v21,v61
v_cvt_pk_bf16_f32 v94,v60,v61
v_mfma_f32_16x16x32_bf16 v[128:131],a[192:195],v[64:67],v[128:131]
v_exp_f32 v62,v62
v_mfma_f32_16x16x32_bf16 v[128:131],a[196:199],v[68:71],v[128:131]
v_exp_f32 v63,v63
v_mfma_f32_16x16x32_bf16 v[160:163],a[192:195],v[72:75],v[160:163]
ds_read_b128 a[208:211],v5 offset:1024
v_add_f32 v21,v21,v62
v_mfma_f32_16x16x32_bf16 v[160:163],a[196:199],v[76:79],v[160:163]
buffer_load_dwordx4 v1,s[16:19],s24 offen offset:3072 sc1 lds
v_add_f32 v21,v21,v63
v_cvt_pk_bf16_f32 v95,v62,v63
v_mfma_f32_16x16x32_bf16 v[52:55],a[160:163],a[16:19],v[28:31]
s_add_u32 m0,s23,98304
v_exp_f32 v48,v48
v_mfma_f32_16x16x32_bf16 v[52:55],a[164:167],a[20:23],v[52:55]
s_add_u32 s25,s25,16384
v_exp_f32 v49,v49
v_mfma_f32_16x16x32_bf16 v[52:55],a[168:171],a[24:27],v[52:55]
ds_read_b128 a[180:183],v3 offset:37888
v_add_f32 v16,v16,v48
v_mfma_f32_16x16x32_bf16 v[52:55],a[172:175],a[28:31],v[52:55]
buffer_load_dwordx4 v1,s[16:19],s25 offen offset:0 sc1 lds
v_add_f32 v16,v16,v49
v_cvt_pk_bf16_f32 v96,v48,v49
v_mfma_f32_16x16x32_bf16 a[96:99],a[192:195],v[80:83],a[96:99]
v_exp_f32 v50,v50
v_mfma_f32_16x16x32_bf16 a[96:99],a[196:199],v[84:87],a[96:99]
v_exp_f32 v51,v51
v_mfma_f32_16x16x32_bf16 a[128:131],a[192:195],v[88:91],a[128:131]
ds_read_b128 a[212:215],v5 offset:5120
v_add_f32 v16,v16,v50
v_mfma_f32_16x16x32_bf16 a[128:131],a[196:199],v[92:95],a[128:131]
buffer_load_dwordx4 v1,s[16:19],s25 offen offset:1024 sc1 lds
v_add_f32 v16,v16,v51
v_cvt_pk_bf16_f32 v97,v50,v51
v_mfma_f32_16x16x32_bf16 v[56:59],a[160:163],a[64:67],v[40:43]
v_exp_f32 v52,v52
v_mfma_f32_16x16x32_bf16 v[56:59],a[164:167],a[68:71],v[56:59]
v_exp_f32 v53,v53
v_mfma_f32_16x16x32_bf16 v[56:59],a[168:171],a[72:75],v[56:59]
ds_read_b128 a[184:187],v3 offset:38912
v_add_f32 v17,v17,v52
v_mfma_f32_16x16x32_bf16 v[56:59],a[172:175],a[76:79],v[56:59]
buffer_load_dwordx4 v1,s[16:19],s25 offen offset:2048 sc1 lds
v_add_f32 v17,v17,v53
v_cvt_pk_bf16_f32 v104,v52,v53
v_mfma_f32_16x16x32_bf16 v[132:135],a[200:203],v[64:67],v[132:135]
s_and_b32 s28,s20,1
v_exp_f32 v54,v54
s_waitcnt lgkmcnt(5)
v_mfma_f32_16x16x32_bf16 v[132:135],a[204:207],v[68:71],v[132:135]
s_lshl_b32 s28,s28,14
v_exp_f32 v55,v55
v_mfma_f32_16x16x32_bf16 v[164:167],a[200:203],v[72:75],v[164:167]
ds_read_b128 a[216:219],v5 offset:9216
v_add_f32 v17,v17,v54
v_mfma_f32_16x16x32_bf16 v[164:167],a[204:207],v[76:79],v[164:167]
buffer_load_dwordx4 v1,s[16:19],s25 offen offset:3072 sc1 lds
v_add_f32 v17,v17,v55
v_cvt_pk_bf16_f32 v105,v54,v55
v_mfma_f32_16x16x32_bf16 v[60:63],a[160:163],a[80:83],v[44:47]
s_lshr_b32 s4,s20,1
v_exp_f32 v56,v56
v_mfma_f32_16x16x32_bf16 v[60:63],a[164:167],a[84:87],v[60:63]
s_add_u32 m0,s23,114688
v_exp_f32 v57,v57
v_mfma_f32_16x16x32_bf16 v[60:63],a[168:171],a[88:91],v[60:63]
s_lshl_b32 s4,s4,13
s_add_u32 s25,s25,16384
ds_read_b128 a[188:191],v3 offset:39936
v_add_f32 v20,v20,v56
v_mfma_f32_16x16x32_bf16 v[60:63],a[172:175],a[92:95],v[60:63]
buffer_load_dwordx4 v1,s[16:19],s25 offen offset:0 sc1 lds
v_add_f32 v20,v20,v57
v_cvt_pk_bf16_f32 v112,v56,v57
v_mfma_f32_16x16x32_bf16 a[100:103],a[200:203],v[80:83],a[100:103]
s_add_u32 s4,s4,s28
v_exp_f32 v58,v58
v_mfma_f32_16x16x32_bf16 a[100:103],a[204:207],v[84:87],a[100:103]
s_lshl_b32 s6,s21,17
v_exp_f32 v59,v59
v_mfma_f32_16x16x32_bf16 a[132:135],a[200:203],v[88:91],a[132:135]
ds_read_b128 a[220:223],v5 offset:13312
v_add_f32 v20,v20,v58
v_mfma_f32_16x16x32_bf16 a[132:135],a[204:207],v[92:95],a[132:135]
buffer_load_dwordx4 v1,s[16:19],s25 offen offset:1024 sc1 lds
v_add_f32 v20,v20,v59
v_cvt_pk_bf16_f32 v113,v58,v59
s_waitcnt lgkmcnt(7)
v_mfma_f32_16x16x32_bf16 v[48:51],a[176:179],a[0:3],v[24:27]
s_add_u32 s28,s21,1
v_exp_f32 v60,v60
s_waitcnt lgkmcnt(5)
v_mfma_f32_16x16x32_bf16 v[48:51],a[180:183],a[4:7],v[48:51]
s_and_b32 s28,s28,3
v_exp_f32 v61,v61
s_waitcnt lgkmcnt(3)
v_mfma_f32_16x16x32_bf16 v[48:51],a[184:187],a[8:11],v[48:51]
ds_read_b128 a[160:163],v3 offset:40960
v_add_f32 v21,v21,v60
s_waitcnt lgkmcnt(2)
v_mfma_f32_16x16x32_bf16 v[48:51],a[188:191],a[12:15],v[48:51]
buffer_load_dwordx4 v1,s[16:19],s25 offen offset:2048 sc1 lds
v_add_f32 v21,v21,v61
v_cvt_pk_bf16_f32 v120,v60,v61
v_mfma_f32_16x16x32_bf16 v[136:139],a[208:211],v[64:67],v[136:139]
s_and_b32 s7,s21,28
v_exp_f32 v62,v62
v_mfma_f32_16x16x32_bf16 v[136:139],a[212:215],v[68:71],v[136:139]
s_add_u32 s7,s7,s28
v_exp_f32 v63,v63
v_mfma_f32_16x16x32_bf16 v[168:171],a[208:211],v[72:75],v[168:171]
ds_read_b128 a[192:195],v5 offset:2048
v_add_f32 v21,v21,v62
v_mfma_f32_16x16x32_bf16 v[168:171],a[212:215],v[76:79],v[168:171]
buffer_load_dwordx4 v1,s[16:19],s25 offen offset:3072 sc1 lds
v_add_f32 v21,v21,v63
v_cvt_pk_bf16_f32 v121,v62,v63
v_mfma_f32_16x16x32_bf16 v[52:55],a[176:179],a[16:19],v[28:31]
s_waitcnt vmcnt(10)
v_mov_b32 v11,s100
s_lshl_b32 s7,s7,17
v_exp_f32 v48,v48
v_mfma_f32_16x16x32_bf16 v[52:55],a[180:183],a[20:23],v[52:55]
v_exp_f32 v49,v49
v_mfma_f32_16x16x32_bf16 v[52:55],a[184:187],a[24:27],v[52:55]
s_getpc_b64 s[30:31]
F_W6:
s_sub_u32 s30,s30,F_W6-F_PC
s_subb_u32 s31,s31,0
v_accvgpr_read_b32 v9,a251
global_load_dword a249,v9,s[30:31]
ds_read_b128 a[164:167],v3 offset:41984
v_add_f32 v16,v16,v48
v_mfma_f32_16x16x32_bf16 v[52:55],a[188:191],a[28:31],v[52:55]
buffer_store_dword v11,v10,s[16:19],s99 offen sc1
v_add_f32 v16,v16,v49
v_cvt_pk_bf16_f32 v98,v48,v49
v_mfma_f32_16x16x32_bf16 a[104:107],a[208:211],v[80:83],a[104:107]
v_accvgpr_read_b32 v0,a248
v_exp_f32 v50,v50
v_mfma_f32_16x16x32_bf16 a[104:107],a[212:215],v[84:87],a[104:107]
s_add_u32 m0,s4,131072
v_exp_f32 v51,v51
v_mfma_f32_16x16x32_bf16 a[136:139],a[208:211],v[88:91],a[136:139]
s_add_u32 s5,s6,0
ds_read_b128 a[196:199],v5 offset:6144
v_add_f32 v16,v16,v50
v_mfma_f32_16x16x32_bf16 a[136:139],a[212:215],v[92:95],a[136:139]
buffer_load_dwordx4 v0,s[12:15],s5 offen lds
v_add_f32 v16,v16,v51
v_cvt_pk_bf16_f32 v99,v50,v51
v_mfma_f32_16x16x32_bf16 v[56:59],a[176:179],a[64:67],v[40:43]
s_add_u32 m0,s4,132096
v_exp_f32 v52,v52
v_mfma_f32_16x16x32_bf16 v[56:59],a[180:183],a[68:71],v[56:59]
s_add_u32 s5,s6,8192
v_exp_f32 v53,v53
v_mfma_f32_16x16x32_bf16 v[56:59],a[184:187],a[72:75],v[56:59]
ds_read_b128 a[168:171],v3 offset:43008
v_add_f32 v17,v17,v52
v_mfma_f32_16x16x32_bf16 v[56:59],a[188:191],a[76:79],v[56:59]
buffer_load_dwordx4 v0,s[12:15],s5 offen lds
v_add_f32 v17,v17,v53
v_cvt_pk_bf16_f32 v106,v52,v53
v_mfma_f32_16x16x32_bf16 v[140:143],a[216:219],v[64:67],v[140:143]
s_add_u32 m0,s4,133120
v_exp_f32 v54,v54
s_waitcnt lgkmcnt(5)
v_mfma_f32_16x16x32_bf16 v[140:143],a[220:223],v[68:71],v[140:143]
s_add_u32 s5,s6,16384
v_exp_f32 v55,v55
v_mfma_f32_16x16x32_bf16 v[172:175],a[216:219],v[72:75],v[172:175]
ds_read_b128 a[200:203],v5 offset:10240
v_add_f32 v17,v17,v54
v_mfma_f32_16x16x32_bf16 v[172:175],a[220:223],v[76:79],v[172:175]
buffer_load_dwordx4 v0,s[12:15],s5 offen lds
v_add_f32 v17,v17,v55
v_cvt_pk_bf16_f32 v107,v54,v55
v_mfma_f32_16x16x32_bf16 v[60:63],a[176:179],a[80:83],v[44:47]
s_add_u32 m0,s4,134144
v_exp_f32 v56,v56
v_mfma_f32_16x16x32_bf16 v[60:63],a[180:183],a[84:87],v[60:63]
s_add_u32 s5,s6,24576
v_exp_f32 v57,v57
v_mfma_f32_16x16x32_bf16 v[60:63],a[184:187],a[88:91],v[60:63]
ds_read_b128 a[172:175],v3 offset:44032
v_add_f32 v20,v20,v56
v_mfma_f32_16x16x32_bf16 v[60:63],a[188:191],a[92:95],v[60:63]
buffer_load_dwordx4 v0,s[12:15],s5 offen lds
v_add_f32 v20,v20,v57
v_cvt_pk_bf16_f32 v114,v56,v57
v_mfma_f32_16x16x32_bf16 a[108:111],a[216:219],v[80:83],a[108:111]
s_add_u32 m0,s4,135168
v_exp_f32 v58,v58
v_mfma_f32_16x16x32_bf16 a[108:111],a[220:223],v[84:87],a[108:111]
s_add_u32 s5,s6,32768
v_exp_f32 v59,v59
v_mfma_f32_16x16x32_bf16 a[140:143],a[216:219],v[88:91],a[140:143]
ds_read_b128 a[204:207],v5 offset:14336
v_add_f32 v20,v20,v58
v_mfma_f32_16x16x32_bf16 a[140:143],a[220:223],v[92:95],a[140:143]
buffer_load_dwordx4 v0,s[12:15],s5 offen lds
v_add_f32 v20,v20,v59
v_cvt_pk_bf16_f32 v115,v58,v59
s_waitcnt lgkmcnt(7)
v_mfma_f32_16x16x32_bf16 v[48:51],a[160:163],a[0:3],v[24:27]
s_add_u32 m0,s4,136192
v_exp_f32 v60,v60
s_waitcnt lgkmcnt(5)
v_mfma_f32_16x16x32_bf16 v[48:51],a[164:167],a[4:7],v[48:51]
s_add_u32 s5,s6,40960
v_exp_f32 v61,v61
s_waitcnt lgkmcnt(3)
v_mfma_f32_16x16x32_bf16 v[48:51],a[168:171],a[8:11],v[48:51]
ds_read_b128 a[176:179],v3 offset:45056
v_add_f32 v21,v21,v60
s_waitcnt lgkmcnt(2)
v_mfma_f32_16x16x32_bf16 v[48:51],a[172:175],a[12:15],v[48:51]
buffer_load_dwordx4 v0,s[12:15],s5 offen lds
v_add_f32 v21,v21,v61
v_cvt_pk_bf16_f32 v122,v60,v61
v_mfma_f32_16x16x32_bf16 v[144:147],a[192:195],v[64:67],v[144:147]
s_add_u32 m0,s4,137216
v_exp_f32 v62,v62
v_mfma_f32_16x16x32_bf16 v[144:147],a[196:199],v[68:71],v[144:147]
s_add_u32 s5,s6,49152
v_exp_f32 v63,v63
v_mfma_f32_16x16x32_bf16 v[176:179],a[192:195],v[72:75],v[176:179]
ds_read_b128 a[208:211],v5 offset:3072
v_add_f32 v21,v21,v62
v_mfma_f32_16x16x32_bf16 v[176:179],a[196:199],v[76:79],v[176:179]
buffer_load_dwordx4 v0,s[12:15],s5 offen lds
v_add_f32 v21,v21,v63
v_cvt_pk_bf16_f32 v123,v62,v63
v_mfma_f32_16x16x32_bf16 v[52:55],a[160:163],a[16:19],v[28:31]
s_add_u32 m0,s4,138240
v_exp_f32 v48,v48
v_mfma_f32_16x16x32_bf16 v[52:55],a[164:167],a[20:23],v[52:55]
s_add_u32 s5,s6,57344
v_exp_f32 v49,v49
v_mfma_f32_16x16x32_bf16 v[52:55],a[168:171],a[24:27],v[52:55]
ds_read_b128 a[180:183],v3 offset:46080
v_add_f32 v16,v16,v48
v_mfma_f32_16x16x32_bf16 v[52:55],a[172:175],a[28:31],v[52:55]
buffer_load_dwordx4 v0,s[12:15],s5 offen lds
v_add_f32 v16,v16,v49
v_cvt_pk_bf16_f32 v100,v48,v49
v_mfma_f32_16x16x32_bf16 a[112:115],a[192:195],v[80:83],a[112:115]
v_exp_f32 v50,v50
v_mfma_f32_16x16x32_bf16 a[112:115],a[196:199],v[84:87],a[112:115]
v_exp_f32 v51,v51
v_mfma_f32_16x16x32_bf16 a[144:147],a[192:195],v[88:91],a[144:147]
ds_read_b128 a[212:215],v5 offset:7168
v_add_f32 v16,v16,v50
v_mfma_f32_16x16x32_bf16 a[144:147],a[196:199],v[92:95],a[144:147]
v_add_f32 v16,v16,v51
v_cvt_pk_bf16_f32 v101,v50,v51
v_mfma_f32_16x16x32_bf16 v[56:59],a[160:163],a[64:67],v[40:43]
s_and_b32 s44,s99,0xfffffe7f
v_exp_f32 v52,v52
v_mfma_f32_16x16x32_bf16 v[56:59],a[164:167],a[68:71],v[56:59]
s_add_u32 s28,s21,1
v_exp_f32 v53,v53
v_mfma_f32_16x16x32_bf16 v[56:59],a[168:171],a[72:75],v[56:59]
ds_read_b128 a[184:187],v3 offset:47104
v_add_f32 v17,v17,v52
v_mfma_f32_16x16x32_bf16 v[56:59],a[172:175],a[76:79],v[56:59]
s_and_b32 s28,s28,3
v_add_f32 v17,v17,v53
v_cvt_pk_bf16_f32 v108,v52,v53
v_mfma_f32_16x16x32_bf16 v[148:151],a[200:203],v[64:67],v[148:151]
s_and_b32 s29,s21,3
v_exp_f32 v54,v54
s_waitcnt lgkmcnt(5)
v_mfma_f32_16x16x32_bf16 v[148:151],a[204:207],v[68:71],v[148:151]
s_sub_u32 s28,s28,s29
v_exp_f32 v55,v55
v_mfma_f32_16x16x32_bf16 v[180:183],a[200:203],v[72:75],v[180:183]
s_lshl_b32 s28,s28,12
ds_read_b128 a[216:219],v5 offset:11264
v_add_f32 v17,v17,v54
v_mfma_f32_16x16x32_bf16 v[180:183],a[204:207],v[76:79],v[180:183]
s_add_u32 s38,s88,s28
v_add_f32 v17,v17,v55
v_cvt_pk_bf16_f32 v109,v54,v55
v_mfma_f32_16x16x32_bf16 v[60:63],a[160:163],a[80:83],v[44:47]
s_add_u32 s41,s89,s28
v_exp_f32 v56,v56
v_mfma_f32_16x16x32_bf16 v[60:63],a[164:167],a[84:87],v[60:63]
s_add_u32 s28,s21,2
v_exp_f32 v57,v57
v_mfma_f32_16x16x32_bf16 v[60:63],a[168:171],a[88:91],v[60:63]
s_and_b32 s28,s28,3
ds_read_b128 a[188:191],v3 offset:48128
v_add_f32 v20,v20,v56
v_mfma_f32_16x16x32_bf16 v[60:63],a[172:175],a[92:95],v[60:63]
s_and_b32 s29,s21,3
v_add_f32 v20,v20,v57
v_cvt_pk_bf16_f32 v116,v56,v57
v_mfma_f32_16x16x32_bf16 a[116:119],a[200:203],v[80:83],a[116:119]
s_sub_u32 s28,s28,s29
v_exp_f32 v58,v58
v_mfma_f32_16x16x32_bf16 a[116:119],a[204:207],v[84:87],a[116:119]
s_lshl_b32 s28,s28,12
v_exp_f32 v59,v59
v_mfma_f32_16x16x32_bf16 a[148:151],a[200:203],v[88:91],a[148:151]
s_add_u32 s39,s88,s28
ds_read_b128 a[220:223],v5 offset:15360
v_add_f32 v20,v20,v58
v_mfma_f32_16x16x32_bf16 a[148:151],a[204:207],v[92:95],a[148:151]
s_add_u32 s42,s89,s28
v_add_f32 v20,v20,v59
v_cvt_pk_bf16_f32 v117,v58,v59
s_waitcnt lgkmcnt(7)
v_mfma_f32_16x16x32_bf16 v[48:51],a[176:179],a[0:3],v[24:27]
s_add_u32 s28,s21,3
v_exp_f32 v60,v60
s_waitcnt lgkmcnt(5)
v_mfma_f32_16x16x32_bf16 v[48:51],a[180:183],a[4:7],v[48:51]
s_and_b32 s28,s28,3
v_exp_f32 v61,v61
s_waitcnt lgkmcnt(3)
v_mfma_f32_16x16x32_bf16 v[48:51],a[184:187],a[8:11],v[48:51]
s_and_b32 s29,s21,3
v_add_f32 v21,v21,v60
v_add_f32 v21,v21,v61
s_waitcnt lgkmcnt(1)
v_mfma_f32_16x16x32_bf16 v[48:51],a[188:191],a[12:15],v[48:51]
s_sub_u32 s28,s28,s29
v_exp_f32 v62,v62
v_mfma_f32_16x16x32_bf16 v[152:155],a[208:211],v[64:67],v[152:155]
s_waitcnt vmcnt(10) lgkmcnt(0)
s_lshl_b32 s28,s28,12
v_exp_f32 v63,v63
v_mfma_f32_16x16x32_bf16 v[152:155],a[212:215],v[68:71],v[152:155]
s_barrier
s_add_u32 s40,s88,s28
v_cvt_pk_bf16_f32 v124,v60,v61
v_add_f32 v21,v21,v62
v_mfma_f32_16x16x32_bf16 v[184:187],a[208:211],v[72:75],v[184:187]
s_add_u32 s43,s89,s28
ds_read_b128 a[160:163],v2 offset:8192
v_add_f32 v21,v21,v63
v_mfma_f32_16x16x32_bf16 v[184:187],a[212:215],v[76:79],v[184:187]
ds_read_b128 a[192:195],v5 offset:32768
v_cvt_pk_bf16_f32 v125,v62,v63
v_mfma_f32_16x16x32_bf16 v[52:55],a[176:179],a[16:19],v[28:31]
s_add_u32 m0,s23,65536
v_exp_f32 v48,v48
v_mfma_f32_16x16x32_bf16 v[52:55],a[180:183],a[20:23],v[52:55]
s_add_u32 s25,s25,16384
v_exp_f32 v49,v49
v_mfma_f32_16x16x32_bf16 v[52:55],a[184:187],a[24:27],v[52:55]
ds_read_b128 a[164:167],v2 offset:9216
v_add_f32 v16,v16,v48
v_mfma_f32_16x16x32_bf16 v[52:55],a[188:191],a[28:31],v[52:55]
buffer_load_dwordx4 v1,s[16:19],s25 offen offset:0 sc1 lds
v_add_f32 v16,v16,v49
v_cvt_pk_bf16_f32 v102,v48,v49
v_mfma_f32_16x16x32_bf16 a[120:123],a[208:211],v[80:83],a[120:123]
v_exp_f32 v50,v50
v_mfma_f32_16x16x32_bf16 a[120:123],a[212:215],v[84:87],a[120:123]
v_exp_f32 v51,v51
v_mfma_f32_16x16x32_bf16 a[152:155],a[208:211],v[88:91],a[152:155]
ds_read_b128 a[196:199],v5 offset:36864
v_add_f32 v16,v16,v50
v_mfma_f32_16x16x32_bf16 a[152:155],a[212:215],v[92:95],a[152:155]
buffer_load_dwordx4 v1,s[16:19],s25 offen offset:1024 sc1 lds
v_add_f32 v16,v16,v51
v_cvt_pk_bf16_f32 v103,v50,v51
v_mfma_f32_16x16x32_bf16 v[56:59],a[176:179],a[64:67],v[40:43]
v_exp_f32 v52,v52
v_mfma_f32_16x16x32_bf16 v[56:59],a[180:183],a[68:71],v[56:59]
v_exp_f32 v53,v53
v_mfma_f32_16x16x32_bf16 v[56:59],a[184:187],a[72:75],v[56:59]
ds_read_b128 a[168:171],v2 offset:10240
v_add_f32 v17,v17,v52
v_mfma_f32_16x16x32_bf16 v[56:59],a[188:191],a[76:79],v[56:59]
buffer_load_dwordx4 v1,s[16:19],s25 offen offset:2048 sc1 lds
v_add_f32 v17,v17,v53
v_cvt_pk_bf16_f32 v110,v52,v53
v_mfma_f32_16x16x32_bf16 v[156:159],a[216:219],v[64:67],v[156:159]
v_exp_f32 v54,v54
v_mfma_f32_16x16x32_bf16 v[156:159],a[220:223],v[68:71],v[156:159]
v_exp_f32 v55,v55
v_mfma_f32_16x16x32_bf16 v[188:191],a[216:219],v[72:75],v[188:191]
ds_read_b128 a[200:203],v5 offset:40960
v_add_f32 v17,v17,v54
v_mfma_f32_16x16x32_bf16 v[188:191],a[220:223],v[76:79],v[188:191]
buffer_load_dwordx4 v1,s[16:19],s25 offen offset:3072 sc1 lds
v_add_f32 v17,v17,v55
v_cvt_pk_bf16_f32 v111,v54,v55
v_mfma_f32_16x16x32_bf16 v[60:63],a[176:179],a[80:83],v[44:47]
s_add_u32 m0,s23,81920
v_exp_f32 v56,v56
v_mfma_f32_16x16x32_bf16 v[60:63],a[180:183],a[84:87],v[60:63]
s_add_u32 s25,s25,16384
v_exp_f32 v57,v57
v_mfma_f32_16x16x32_bf16 v[60:63],a[184:187],a[88:91],v[60:63]
ds_read_b128 a[172:175],v2 offset:11264
v_add_f32 v20,v20,v56
v_mfma_f32_16x16x32_bf16 v[60:63],a[188:191],a[92:95],v[60:63]
buffer_load_dwordx4 v1,s[16:19],s25 offen offset:0 sc1 lds
v_add_f32 v20,v20,v57
v_cvt_pk_bf16_f32 v118,v56,v57
v_mfma_f32_16x16x32_bf16 a[124:127],a[216:219],v[80:83],a[124:127]
v_exp_f32 v58,v58
v_mfma_f32_16x16x32_bf16 a[124:127],a[220:223],v[84:87],a[124:127]
s_waitcnt lgkmcnt(6)
v_exp_f32 v59,v59
v_mfma_f32_16x16x32_bf16 a[156:159],a[216:219],v[88:91],a[156:159]
ds_read_b128 a[204:207],v5 offset:45056
v_add_f32 v20,v20,v58
v_mfma_f32_16x16x32_bf16 a[156:159],a[220:223],v[92:95],a[156:159]
buffer_load_dwordx4 v1,s[16:19],s25 offen offset:1024 sc1 lds
v_add_f32 v20,v20,v59
v_cvt_pk_bf16_f32 v119,v58,v59
v_mfma_f32_16x16x32_bf16 v[56:59],a[160:163],a[80:83],v[44:47]
s_waitcnt lgkmcnt(3)
v_exp_f32 v60,v60
v_mfma_f32_16x16x32_bf16 v[56:59],a[164:167],a[84:87],v[56:59]
ds_read_b128 a[176:179],v2 offset:12288
v_exp_f32 v61,v61
v_mfma_f32_16x16x32_bf16 v[56:59],a[168:171],a[88:91],v[56:59]
s_waitcnt lgkmcnt(2)
v_add_f32 v21,v21,v60
v_mfma_f32_16x16x32_bf16 v[56:59],a[172:175],a[92:95],v[56:59]
buffer_load_dwordx4 v1,s[16:19],s25 offen offset:2048 sc1 lds
v_add_f32 v21,v21,v61
v_cvt_pk_bf16_f32 v126,v60,v61
v_mfma_f32_16x16x32_bf16 v[128:131],a[192:195],v[96:99],v[128:131]
v_exp_f32 v62,v62
v_mfma_f32_16x16x32_bf16 v[128:131],a[196:199],v[100:103],v[128:131]
ds_read_b128 a[208:211],v5 offset:33792
v_exp_f32 v63,v63
v_mfma_f32_16x16x32_bf16 v[160:163],a[192:195],v[104:107],v[160:163]
ds_read_b128 a[180:183],v2 offset:13312
v_add_f32 v21,v21,v62
v_mfma_f32_16x16x32_bf16 v[160:163],a[196:199],v[108:111],v[160:163]
buffer_load_dwordx4 v1,s[16:19],s25 offen offset:3072 sc1 lds
v_add_f32 v21,v21,v63
v_cvt_pk_bf16_f32 v127,v62,v63
v_mfma_f32_16x16x32_bf16 a[96:99],a[192:195],v[112:115],a[96:99]
v_cndmask_b32 v48,v6,v24,s[64:65]
v_cndmask_b32 v49,v6,v24,s[66:67]
v_cndmask_b32 v50,v6,v24,s[68:69]
v_cndmask_b32 v51,v6,v24,s[70:71]
v_exp_f32 v56,v56
v_mfma_f32_16x16x32_bf16 a[96:99],a[196:199],v[116:119],a[96:99]
v_exp_f32 v57,v57
v_mfma_f32_16x16x32_bf16 v[60:63],a[160:163],a[16:19],v[28:31]
ds_read_b128 a[212:215],v5 offset:37888
v_add_f32 v21,v21,v56
v_mfma_f32_16x16x32_bf16 v[60:63],a[164:167],a[20:23],v[60:63]
v_add_f32 v21,v21,v57
v_cvt_pk_bf16_f32 v88,v56,v57
v_mfma_f32_16x16x32_bf16 v[60:63],a[168:171],a[24:27],v[60:63]
s_add_u32 m0,s4,32768
v_exp_f32 v58,v58
v_mfma_f32_16x16x32_bf16 v[60:63],a[172:175],a[28:31],v[60:63]
s_add_u32 s5,s7,0
v_exp_f32 v59,v59
v_mfma_f32_16x16x32_bf16 a[128:131],a[192:195],v[120:123],a[128:131]
ds_read_b128 a[184:187],v2 offset:14336
v_add_f32 v21,v21,v58
v_mfma_f32_16x16x32_bf16 a[128:131],a[196:199],v[124:127],a[128:131]
buffer_load_dwordx4 v0,s[12:15],s5 offen lds
v_mfma_f32_16x16x32_bf16 v[132:135],a[200:203],v[96:99],v[132:135]
s_add_u32 m0,s4,33792
v_add_f32 v21,v21,v59
v_cvt_pk_bf16_f32 v89,v58,v59
s_waitcnt lgkmcnt(5)
v_mfma_f32_16x16x32_bf16 v[132:135],a[204:207],v[100:103],v[132:135]
ds_read_b128 a[216:219],v5 offset:41984
s_add_u32 s5,s7,8192
v_mfma_f32_16x16x32_bf16 v[164:167],a[200:203],v[104:107],v[164:167]
v_exp_f32 v60,v60
v_mfma_f32_16x16x32_bf16 v[164:167],a[204:207],v[108:111],v[164:167]
buffer_load_dwordx4 v0,s[12:15],s5 offen lds
v_exp_f32 v61,v61
v_mfma_f32_16x16x32_bf16 v[48:51],a[160:163],a[0:3],v[48:51]
s_add_u32 m0,s4,34816
v_add_f32 v17,v17,v60
v_add_f32 v17,v17,v61
v_mfma_f32_16x16x32_bf16 v[48:51],a[164:167],a[4:7],v[48:51]
ds_read_b128 a[188:191],v2 offset:15360
v_cvt_pk_bf16_f32 v72,v60,v61
v_mfma_f32_16x16x32_bf16 v[48:51],a[168:171],a[8:11],v[48:51]
s_add_u32 s5,s7,16384
v_exp_f32 v62,v62
v_mfma_f32_16x16x32_bf16 v[48:51],a[172:175],a[12:15],v[48:51]
ds_read_b128 a[220:223],v5 offset:46080
ds_read_b128 a[160:163],v2 offset:16384
buffer_load_dwordx4 v0,s[12:15],s5 offen lds
v_mfma_f32_16x16x32_bf16 a[100:103],a[200:203],v[112:115],a[100:103]
s_add_u32 m0,s4,35840
v_exp_f32 v63,v63
v_mfma_f32_16x16x32_bf16 a[100:103],a[204:207],v[116:119],a[100:103]
s_add_u32 s5,s7,24576
v_add_f32 v17,v17,v62
v_add_f32 v17,v17,v63
v_mfma_f32_16x16x32_bf16 a[132:135],a[200:203],v[120:123],a[132:135]
s_waitcnt lgkmcnt(5)
v_cvt_pk_bf16_f32 v73,v62,v63
v_mfma_f32_16x16x32_bf16 a[132:135],a[204:207],v[124:127],a[132:135]
buffer_load_dwordx4 v0,s[12:15],s5 offen lds
v_mfma_f32_16x16x32_bf16 v[136:139],a[208:211],v[96:99],v[136:139]
s_add_u32 m0,s4,36864
v_exp_f32 v48,v48
v_mfma_f32_16x16x32_bf16 v[136:139],a[212:215],v[100:103],v[136:139]
ds_read_b128 a[192:195],v5 offset:34816
v_exp_f32 v49,v49
v_mfma_f32_16x16x32_bf16 v[52:55],a[176:179],a[80:83],v[44:47]
s_add_u32 s5,s7,32768
v_add_f32 v16,v16,v48
v_add_f32 v16,v16,v49
v_mfma_f32_16x16x32_bf16 v[52:55],a[180:183],a[84:87],v[52:55]
s_waitcnt lgkmcnt(5)
v_lshrrev_b32 v8,4,v7
ds_read_b128 a[164:167],v2 offset:17408
buffer_load_dwordx4 v0,s[12:15],s5 offen lds
v_mfma_f32_16x16x32_bf16 v[52:55],a[184:187],a[88:91],v[52:55]
s_waitcnt lgkmcnt(4)
v_lshlrev_b32 v8,7,v8
v_cvt_pk_bf16_f32 v64,v48,v49
v_mfma_f32_16x16x32_bf16 v[52:55],a[188:191],a[92:95],v[52:55]
s_add_u32 m0,s4,37888
v_exp_f32 v50,v50
v_mfma_f32_16x16x32_bf16 v[168:171],a[208:211],v[104:107],v[168:171]
s_add_u32 s5,s7,40960
buffer_load_dword v9,v8,s[16:19],s44 offen sc1
v_exp_f32 v51,v51
v_mfma_f32_16x16x32_bf16 v[168:171],a[212:215],v[108:111],v[168:171]
buffer_load_dwordx4 v0,s[12:15],s5 offen lds
v_mfma_f32_16x16x32_bf16 a[104:107],a[208:211],v[112:115],a[104:107]
s_add_u32 m0,s4,38912
v_add_f32 v16,v16,v50
v_add_f32 v16,v16,v51
v_mfma_f32_16x16x32_bf16 a[104:107],a[212:215],v[116:119],a[104:107]
ds_read_b128 a[196:199],v5 offset:38912
v_cvt_pk_bf16_f32 v65,v50,v51
v_mfma_f32_16x16x32_bf16 a[136:139],a[208:211],v[120:123],a[136:139]
s_add_u32 s5,s7,49152
v_cndmask_b32 v60,v6,v24,s[72:73]
v_cndmask_b32 v61,v6,v24,s[74:75]
v_cndmask_b32 v62,v6,v24,s[76:77]
v_cndmask_b32 v63,v6,v24,s[78:79]
v_exp_f32 v52,v52
v_mfma_f32_16x16x32_bf16 a[136:139],a[212:215],v[124:127],a[136:139]
buffer_load_dwordx4 v0,s[12:15],s5 offen lds
v_exp_f32 v53,v53
v_mfma_f32_16x16x32_bf16 v[56:59],a[176:179],a[16:19],v[28:31]
ds_read_b128 a[168:171],v2 offset:18432
v_add_f32 v21,v21,v52
v_mfma_f32_16x16x32_bf16 v[56:59],a[180:183],a[20:23],v[56:59]
v_add_f32 v21,v21,v53
v_cvt_pk_bf16_f32 v90,v52,v53
v_mfma_f32_16x16x32_bf16 v[56:59],a[184:187],a[24:27],v[56:59]
v_exp_f32 v54,v54
v_mfma_f32_16x16x32_bf16 v[56:59],a[188:191],a[28:31],v[56:59]
s_waitcnt lgkmcnt(5)
v_exp_f32 v55,v55
v_mfma_f32_16x16x32_bf16 v[140:143],a[216:219],v[96:99],v[140:143]
ds_read_b128 a[200:203],v5 offset:43008
v_add_f32 v21,v21,v54
v_mfma_f32_16x16x32_bf16 v[140:143],a[220:223],v[100:103],v[140:143]
v_add_f32 v21,v21,v55
v_cvt_pk_bf16_f32 v91,v54,v55
v_mfma_f32_16x16x32_bf16 v[172:175],a[216:219],v[104:107],v[172:175]
v_mfma_f32_16x16x32_bf16 v[172:175],a[220:223],v[108:111],v[172:175]
v_mfma_f32_16x16x32_bf16 a[108:111],a[216:219],v[112:115],a[108:111]
v_exp_f32 v56,v56
v_mfma_f32_16x16x32_bf16 a[108:111],a[220:223],v[116:119],a[108:111]
ds_read_b128 a[172:175],v2 offset:19456
v_exp_f32 v57,v57
v_mfma_f32_16x16x32_bf16 v[60:63],a[176:179],a[0:3],v[60:63]
ds_read_b128 a[204:207],v5 offset:47104
v_add_f32 v17,v17,v56
v_mfma_f32_16x16x32_bf16 v[60:63],a[180:183],a[4:7],v[60:63]
v_add_f32 v17,v17,v57
v_cvt_pk_bf16_f32 v74,v56,v57
v_mfma_f32_16x16x32_bf16 v[60:63],a[184:187],a[8:11],v[60:63]
v_exp_f32 v58,v58
v_mfma_f32_16x16x32_bf16 v[60:63],a[188:191],a[12:15],v[60:63]
v_exp_f32 v59,v59
v_mfma_f32_16x16x32_bf16 a[140:143],a[216:219],v[120:123],a[140:143]
ds_read_b128 a[176:179],v2 offset:20480
v_add_f32 v17,v17,v58
v_mfma_f32_16x16x32_bf16 a[140:143],a[220:223],v[124:127],a[140:143]
s_waitcnt lgkmcnt(5)
v_add_f32 v17,v17,v59
v_cvt_pk_bf16_f32 v75,v58,v59
v_mfma_f32_16x16x32_bf16 v[144:147],a[192:195],v[96:99],v[144:147]
ds_read_b128 a[208:211],v5 offset:35840
v_mfma_f32_16x16x32_bf16 v[144:147],a[196:199],v[100:103],v[144:147]
v_mfma_f32_16x16x32_bf16 v[176:179],a[192:195],v[104:107],v[176:179]
v_cndmask_b32 v52,v6,v28,s[64:65]
v_cndmask_b32 v53,v6,v28,s[66:67]
v_cndmask_b32 v54,v6,v28,s[68:69]
v_cndmask_b32 v55,v6,v28,s[70:71]
v_exp_f32 v60,v60
v_mfma_f32_16x16x32_bf16 v[176:179],a[196:199],v[108:111],v[176:179]
v_exp_f32 v61,v61
v_mfma_f32_16x16x32_bf16 v[48:51],a[160:163],a[80:83],v[44:47]
ds_read_b128 a[180:183],v2 offset:21504
v_add_f32 v16,v16,v60
v_mfma_f32_16x16x32_bf16 v[48:51],a[164:167],a[84:87],v[48:51]
s_waitcnt lgkmcnt(6)
v_add_f32 v16,v16,v61
v_cvt_pk_bf16_f32 v66,v60,v61
v_mfma_f32_16x16x32_bf16 v[48:51],a[168:171],a[88:91],v[48:51]
s_waitcnt lgkmcnt(4)
v_exp_f32 v62,v62
v_mfma_f32_16x16x32_bf16 v[48:51],a[172:175],a[92:95],v[48:51]
ds_read_b128 a[212:215],v5 offset:39936
v_mfma_f32_16x16x32_bf16 a[112:115],a[192:195],v[112:115],a[112:115]
v_exp_f32 v63,v63
v_mfma_f32_16x16x32_bf16 a[112:115],a[196:199],v[116:119],a[112:115]
ds_read_b128 a[184:187],v2 offset:22528
v_add_f32 v16,v16,v62
v_mfma_f32_16x16x32_bf16 a[144:147],a[192:195],v[120:123],a[144:147]
s_waitcnt vmcnt(2)
v_cmp_gt_u32 vcc,3,v9
v_add_f32 v16,v16,v63
v_mfma_f32_16x16x32_bf16 a[144:147],a[196:199],v[124:127],a[144:147]
s_cmp_eq_u64 vcc,0
s_cselect_b32 s101,1,0
s_cselect_b32 s30,0,0x40000000
v_add_u32 v8,s30,v1
v_cvt_pk_bf16_f32 v67,v62,v63
v_mfma_f32_16x16x32_bf16 v[148:151],a[200:203],v[96:99],v[148:151]
s_waitcnt lgkmcnt(5)
v_exp_f32 v48,v48
v_mfma_f32_16x16x32_bf16 v[148:151],a[204:207],v[100:103],v[148:151]
ds_read_b128 a[216:219],v5 offset:44032
buffer_load_dwordx4 a[224:227],v8,s[16:19],s39 offen offset:0 sc1
v_exp_f32 v49,v49
v_mfma_f32_16x16x32_bf16 v[52:55],a[160:163],a[16:19],v[52:55]
v_add_f32 v21,v21,v48
v_add_f32 v21,v21,v49
v_mfma_f32_16x16x32_bf16 v[52:55],a[164:167],a[20:23],v[52:55]
ds_read_b128 a[188:191],v2 offset:23552
v_cvt_pk_bf16_f32 v92,v48,v49
v_mfma_f32_16x16x32_bf16 v[52:55],a[168:171],a[24:27],v[52:55]
buffer_load_dwordx4 a[228:231],v8,s[16:19],s39 offen offset:1024 sc1
v_mfma_f32_16x16x32_bf16 v[52:55],a[172:175],a[28:31],v[52:55]
v_exp_f32 v50,v50
v_mfma_f32_16x16x32_bf16 v[180:183],a[200:203],v[104:107],v[180:183]
v_exp_f32 v51,v51
v_mfma_f32_16x16x32_bf16 v[180:183],a[204:207],v[108:111],v[180:183]
buffer_load_dwordx4 a[232:235],v8,s[16:19],s39 offen offset:2048 sc1
v_mfma_f32_16x16x32_bf16 a[116:119],a[200:203],v[112:115],a[116:119]
ds_read_b128 a[220:223],v5 offset:48128
v_add_f32 v21,v21,v50
v_add_f32 v21,v21,v51
v_mfma_f32_16x16x32_bf16 a[116:119],a[204:207],v[116:119],a[116:119]
v_cvt_pk_bf16_f32 v93,v50,v51
v_mfma_f32_16x16x32_bf16 a[148:151],a[200:203],v[120:123],a[148:151]
buffer_load_dwordx4 a[236:239],v8,s[16:19],s39 offen offset:3072 sc1
v_cndmask_b32 v60,v6,v28,s[72:73]
v_cndmask_b32 v61,v6,v28,s[74:75]
v_cndmask_b32 v62,v6,v28,s[76:77]
v_cndmask_b32 v63,v6,v28,s[78:79]
v_exp_f32 v52,v52
v_mfma_f32_16x16x32_bf16 a[148:151],a[204:207],v[124:127],a[148:151]
s_waitcnt lgkmcnt(7)
v_exp_f32 v53,v53
v_mfma_f32_16x16x32_bf16 v[56:59],a[176:179],a[80:83],v[44:47]
s_waitcnt lgkmcnt(3)
v_add_f32 v17,v17,v52
v_add_f32 v17,v17,v53
v_mfma_f32_16x16x32_bf16 v[56:59],a[180:183],a[84:87],v[56:59]
buffer_load_dwordx4 a[240:243],v8,s[16:19],s42 offen offset:0 sc1
v_mfma_f32_16x16x32_bf16 v[56:59],a[184:187],a[88:91],v[56:59]
s_waitcnt lgkmcnt(1)
v_cvt_pk_bf16_f32 v76,v52,v53
v_mfma_f32_16x16x32_bf16 v[56:59],a[188:191],a[92:95],v[56:59]
v_exp_f32 v54,v54
v_mfma_f32_16x16x32_bf16 v[152:155],a[208:211],v[96:99],v[152:155]
buffer_load_dwordx4 a[244:247],v8,s[16:19],s42 offen offset:1024 sc1
v_exp_f32 v55,v55
v_mfma_f32_16x16x32_bf16 v[152:155],a[212:215],v[100:103],v[152:155]
v_add_f32 v17,v17,v54
v_add_f32 v17,v17,v55
v_mfma_f32_16x16x32_bf16 v[184:187],a[208:211],v[104:107],v[184:187]
v_cvt_pk_bf16_f32 v77,v54,v55
v_mfma_f32_16x16x32_bf16 v[184:187],a[212:215],v[108:111],v[184:187]
s_waitcnt vmcnt(14) lgkmcnt(0)
buffer_load_dwordx4 a[248:251],v8,s[16:19],s42 offen offset:2048 sc1
v_mfma_f32_16x16x32_bf16 a[120:123],a[208:211],v[112:115],a[120:123]
s_barrier
v_exp_f32 v56,v56
v_mfma_f32_16x16x32_bf16 a[120:123],a[212:215],v[116:119],a[120:123]
v_exp_f32 v57,v57
v_mfma_f32_16x16x32_bf16 v[60:63],a[176:179],a[16:19],v[60:63]
ds_read_b128 a[192:195],v4 offset:4096
buffer_load_dwordx4 a[252:255],v8,s[16:19],s42 offen offset:3072 sc1
v_mfma_f32_16x16x32_bf16 v[60:63],a[180:183],a[20:23],v[60:63]
v_add_f32 v21,v21,v56
v_add_f32 v21,v21,v57
v_mfma_f32_16x16x32_bf16 v[60:63],a[184:187],a[24:27],v[60:63]
ds_read_b128 a[196:199],v4 offset:16384
v_cvt_pk_bf16_f32 v94,v56,v57
v_mfma_f32_16x16x32_bf16 v[60:63],a[188:191],a[28:31],v[60:63]
buffer_load_dwordx4 v[196:199],v8,s[16:19],s38 offen offset:0 sc1
v_exp_f32 v58,v58
v_mfma_f32_16x16x32_bf16 a[152:155],a[208:211],v[120:123],a[152:155]
v_exp_f32 v59,v59
v_mfma_f32_16x16x32_bf16 a[152:155],a[212:215],v[124:127],a[152:155]
v_add_f32 v21,v21,v58
v_add_f32 v21,v21,v59
v_mfma_f32_16x16x32_bf16 v[156:159],a[216:219],v[96:99],v[156:159]
ds_read_b128 a[200:203],v4 offset:12288
buffer_load_dwordx4 v[204:207],v8,s[16:19],s38 offen offset:1024 sc1
v_mfma_f32_16x16x32_bf16 v[156:159],a[220:223],v[100:103],v[156:159]
v_cvt_pk_bf16_f32 v95,v58,v59
v_mfma_f32_16x16x32_bf16 v[188:191],a[216:219],v[104:107],v[188:191]
v_exp_f32 v60,v60
v_mfma_f32_16x16x32_bf16 v[188:191],a[220:223],v[108:111],v[188:191]
ds_read_b128 a[204:207],v4 offset:24576
buffer_load_dwordx4 v[212:215],v8,s[16:19],s38 offen offset:2048 sc1
v_exp_f32 v61,v61
v_mfma_f32_16x16x32_bf16 a[124:127],a[216:219],v[112:115],a[124:127]
v_add_f32 v17,v17,v60
v_add_f32 v17,v17,v61
v_mfma_f32_16x16x32_bf16 a[124:127],a[220:223],v[116:119],a[124:127]
v_cvt_pk_bf16_f32 v78,v60,v61
v_mfma_f32_16x16x32_bf16 a[156:159],a[216:219],v[120:123],a[156:159]
buffer_load_dwordx4 v[220:223],v8,s[16:19],s38 offen offset:3072 sc1
v_exp_f32 v62,v62
v_mfma_f32_16x16x32_bf16 a[156:159],a[220:223],v[124:127],a[156:159]
s_waitcnt lgkmcnt(2)
v_exp_f32 v63,v63
v_mfma_f32_16x16x32_bf16 a[128:131],a[192:195],v[88:91],a[128:131]
ds_read_b128 a[208:211],v4 offset:5120
v_add_f32 v17,v17,v62
v_mfma_f32_16x16x32_bf16 a[128:131],a[196:199],v[92:95],a[128:131]
buffer_load_dwordx4 v[228:231],v8,s[16:19],s41 offen offset:0 sc1
v_add_f32 v17,v17,v63
v_cvt_pk_bf16_f32 v79,v62,v63
v_mfma_f32_16x16x32_bf16 v[128:131],a[192:195],v[64:67],v[128:131]
ds_write_b128 v12,a[96:99] offset:0
v_mfma_f32_16x16x32_bf16 v[160:163],a[192:195],v[72:75],v[160:163]
ds_write_b128 v12,a[100:103] offset:1024
ds_write_b128 v12,a[104:107] offset:2048
ds_write_b128 v12,a[108:111] offset:3072
ds_write_b128 v12,a[112:115] offset:4096
ds_write_b128 v12,a[116:119] offset:5120
ds_write_b128 v12,a[120:123] offset:6144
ds_write_b128 v12,a[124:127] offset:7168
ds_read_b128 a[212:215],v4 offset:17408
v_mfma_f32_16x16x32_bf16 v[160:163],a[196:199],v[76:79],v[160:163]
buffer_load_dwordx4 v[236:239],v8,s[16:19],s41 offen offset:1024 sc1
s_waitcnt lgkmcnt(11)
v_mfma_f32_16x16x32_bf16 a[132:135],a[200:203],v[88:91],a[132:135]
ds_read_b128 a[216:219],v4 offset:13312
s_waitcnt lgkmcnt(11)
v_mfma_f32_16x16x32_bf16 a[132:135],a[204:207],v[92:95],a[132:135]
ds_write_b128 v12,a[128:131] offset:8192
v_mfma_f32_16x16x32_bf16 v[132:135],a[200:203],v[64:67],v[132:135]
ds_read_b128 a[220:223],v4 offset:25600
buffer_load_dwordx4 v[244:247],v8,s[16:19],s41 offen offset:2048 sc1
v_mfma_f32_16x16x32_bf16 v[164:167],a[200:203],v[72:75],v[164:167]
v_mfma_f32_16x16x32_bf16 v[164:167],a[204:207],v[76:79],v[164:167]
s_waitcnt lgkmcnt(3)
v_mfma_f32_16x16x32_bf16 a[136:139],a[208:211],v[88:91],a[136:139]
ds_read_b128 a[192:195],v4 offset:6144
buffer_load_dwordx4 v[252:255],v8,s[16:19],s41 offen offset:3072 sc1
v_mfma_f32_16x16x32_bf16 a[136:139],a[212:215],v[92:95],a[136:139]
ds_write_b128 v12,a[132:135] offset:9216
v_mfma_f32_16x16x32_bf16 v[136:139],a[208:211],v[64:67],v[136:139]
ds_read_b128 a[196:199],v4 offset:18432
v_mfma_f32_16x16x32_bf16 v[168:171],a[208:211],v[72:75],v[168:171]
buffer_load_dwordx4 a[160:163],v8,s[16:19],s40 offen offset:0 sc1
v_mfma_f32_16x16x32_bf16 v[168:171],a[212:215],v[76:79],v[168:171]
s_waitcnt lgkmcnt(3)
v_mfma_f32_16x16x32_bf16 a[140:143],a[216:219],v[88:91],a[140:143]
ds_read_b128 a[200:203],v4 offset:14336
v_mfma_f32_16x16x32_bf16 a[140:143],a[220:223],v[92:95],a[140:143]
buffer_load_dwordx4 a[164:167],v8,s[16:19],s40 offen offset:1024 sc1
v_mfma_f32_16x16x32_bf16 v[140:143],a[216:219],v[64:67],v[140:143]
ds_write_b128 v12,a[136:139] offset:10240
v_mfma_f32_16x16x32_bf16 v[172:175],a[216:219],v[72:75],v[172:175]
ds_read_b128 a[204:207],v4 offset:26624
v_mfma_f32_16x16x32_bf16 v[172:175],a[220:223],v[76:79],v[172:175]
buffer_load_dwordx4 a[168:171],v8,s[16:19],s40 offen offset:2048 sc1
s_waitcnt lgkmcnt(5)
v_mfma_f32_16x16x32_bf16 a[144:147],a[192:195],v[88:91],a[144:147]
ds_read_b128 a[208:211],v4 offset:7168
s_waitcnt lgkmcnt(4)
v_mfma_f32_16x16x32_bf16 a[144:147],a[196:199],v[92:95],a[144:147]
ds_write_b128 v12,a[140:143] offset:11264
v_mfma_f32_16x16x32_bf16 v[144:147],a[192:195],v[64:67],v[144:147]
ds_read_b128 a[212:215],v4 offset:19456
buffer_load_dwordx4 a[172:175],v8,s[16:19],s40 offen offset:3072 sc1
v_mfma_f32_16x16x32_bf16 v[176:179],a[192:195],v[72:75],v[176:179]
v_mfma_f32_16x16x32_bf16 v[176:179],a[196:199],v[76:79],v[176:179]
s_waitcnt lgkmcnt(3)
v_mfma_f32_16x16x32_bf16 a[148:151],a[200:203],v[88:91],a[148:151]
ds_read_b128 a[216:219],v4 offset:15360
buffer_load_dwordx4 a[176:179],v8,s[16:19],s43 offen offset:0 sc1
v_mfma_f32_16x16x32_bf16 a[148:151],a[204:207],v[92:95],a[148:151]
ds_write_b128 v12,a[144:147] offset:12288
v_mfma_f32_16x16x32_bf16 v[148:151],a[200:203],v[64:67],v[148:151]
ds_read_b128 a[220:223],v4 offset:27648
v_mfma_f32_16x16x32_bf16 v[180:183],a[200:203],v[72:75],v[180:183]
buffer_load_dwordx4 a[180:183],v8,s[16:19],s43 offen offset:1024 sc1
v_mfma_f32_16x16x32_bf16 v[180:183],a[204:207],v[76:79],v[180:183]
s_waitcnt lgkmcnt(5)
v_mfma_f32_16x16x32_bf16 a[152:155],a[208:211],v[88:91],a[152:155]
s_waitcnt lgkmcnt(3)
v_mfma_f32_16x16x32_bf16 a[152:155],a[212:215],v[92:95],a[152:155]
buffer_load_dwordx4 a[184:187],v8,s[16:19],s43 offen offset:2048 sc1
v_mfma_f32_16x16x32_bf16 v[152:155],a[208:211],v[64:67],v[152:155]
ds_write_b128 v12,a[148:151] offset:13312
v_mfma_f32_16x16x32_bf16 v[184:187],a[208:211],v[72:75],v[184:187]
s_waitcnt lgkmcnt(3)
v_mfma_f32_16x16x32_bf16 v[184:187],a[212:215],v[76:79],v[184:187]
buffer_load_dwordx4 a[188:191],v8,s[16:19],s43 offen offset:3072 sc1
v_mfma_f32_16x16x32_bf16 a[156:159],a[216:219],v[88:91],a[156:159]
s_waitcnt lgkmcnt(1)
v_mfma_f32_16x16x32_bf16 a[156:159],a[220:223],v[92:95],a[156:159]
ds_write_b128 v12,a[152:155] offset:14336
v_mfma_f32_16x16x32_bf16 v[156:159],a[216:219],v[64:67],v[156:159]
v_mfma_f32_16x16x32_bf16 v[188:191],a[216:219],v[72:75],v[188:191]
v_mfma_f32_16x16x32_bf16 v[188:191],a[220:223],v[76:79],v[188:191]
s_nop 3
ds_write_b128 v12,a[156:159] offset:15360
K2_FIN:
v_max3_f32 v10,v16,v17,v18
v_max3_f32 v11,v19,v20,v21
v_add_f32 v10,v10,v11
ds_write_b64 v14,v[20:21]
v_cmp_nle_f32 vcc,v10,v15
v_and_b32 v11,0xfffffe00,v14
v_and_b32 v8,1,v7
v_lshlrev_b32 v8,14,v8
s_cmp_lg_u64 vcc,0
s_cselect_b32 s28,1,0
v_mov_b32 v10,s28
ds_write_b32 v11,v10 offset:512
v_bfe_u32 v9,v7,1,1
v_lshl_add_u32 v8,v9,13,v8
v_xor_b32 v14,16384,v14
v_mov_b32 v11,0
s_mov_b32 s52,s4
s_mov_b32 s54,s6
s_mov_b32 s55,s7
s_add_u32 s28,s21,2
s_and_b32 s28,s28,3
s_and_b32 s29,s21,28
s_add_u32 s28,s28,s29
s_lshl_b32 s56,s28,17
s_add_u32 s28,s21,3
s_and_b32 s28,s28,3
s_and_b32 s29,s21,28
s_add_u32 s28,s28,s29
s_lshl_b32 s57,s28,17
s_waitcnt lgkmcnt(0)
s_barrier
ds_read_b32 v48,v8 offset:40448
ds_read_b64 v[20:21],v14
s_add_u32 m0,s52,65536
s_add_u32 s53,s56,0
ds_read_b128 v[64:67],v13 offset:0
buffer_load_dwordx4 v0,s[12:15],s53 offen lds
s_add_u32 m0,s52,66560
s_add_u32 s53,s56,8192
ds_read_b128 v[68:71],v13 offset:1024
buffer_load_dwordx4 v0,s[12:15],s53 offen lds
s_add_u32 m0,s52,67584
s_add_u32 s53,s56,16384
ds_read_b128 v[72:75],v13 offset:2048
buffer_load_dwordx4 v0,s[12:15],s53 offen lds
s_add_u32 m0,s52,68608
s_add_u32 s53,s56,24576
ds_read_b128 v[76:79],v13 offset:3072
buffer_load_dwordx4 v0,s[12:15],s53 offen lds
s_add_u32 m0,s52,69632
s_add_u32 s53,s56,32768
ds_read_b128 v[80:83],v13 offset:4096
buffer_load_dwordx4 v0,s[12:15],s53 offen lds
s_add_u32 m0,s52,70656
s_add_u32 s53,s56,40960
ds_read_b128 v[84:87],v13 offset:5120
buffer_load_dwordx4 v0,s[12:15],s53 offen lds
s_add_u32 m0,s52,71680
s_add_u32 s53,s56,49152
ds_read_b128 v[88:91],v13 offset:6144
buffer_load_dwordx4 v0,s[12:15],s53 offen lds
s_add_u32 m0,s52,72704
s_add_u32 s53,s56,57344
ds_read_b128 v[92:95],v13 offset:7168
buffer_load_dwordx4 v0,s[12:15],s53 offen lds
ds_read_b128 v[96:99],v13 offset:8192
ds_read_b128 v[100:103],v13 offset:9216
ds_read_b128 v[104:107],v13 offset:10240
ds_read_b128 v[108:111],v13 offset:11264
s_waitcnt lgkmcnt(12)
v_cmp_ne_u32 vcc,0,v48
v_add_f32 v16,v16,v20
v_add_f32 v17,v17,v21
ds_read_b128 v[112:115],v13 offset:12288
ds_read_b128 v[116:119],v13 offset:13312
ds_read_b128 v[120:123],v13 offset:14336
ds_read_b128 v[124:127],v13 offset:15360
s_cmp_lg_u64 vcc,0
s_cselect_b32 s28,1,0
s_andn2_b32 s28,s28,s27
s_cbranch_scc1 K2_SLOW
v_mov_b32 v8,v16
v_mov_b32 v9,v17
s_nop 1
v_permlane32_swap_b32 v8,v16
v_permlane32_swap_b32 v9,v17
v_add_f32 v16,v16,v8
v_add_f32 v17,v17,v9
v_mov_b32 v8,v16
v_mov_b32 v9,v17
s_nop 1
v_permlane16_swap_b32 v8,v16
v_permlane16_swap_b32 v9,v17
v_add_f32 v16,v16,v8
v_add_f32 v17,v17,v9
v_rcp_f32 v8,v16
v_rcp_f32 v9,v17
s_cmp_eq_u32 s22,7
s_cbranch_scc0 F_ARRX
s_waitcnt vmcnt(8)
v_mov_b32 v10,3
buffer_store_dword v10,v11,s[16:19],s99 offen sc1
F_ARRX:
s_waitcnt lgkmcnt(15)
v_pk_add_f32 v[128:129],v[128:129],v[64:65]
v_pk_add_f32 v[130:131],v[130:131],v[66:67]
s_waitcnt lgkmcnt(14)
v_pk_add_f32 v[132:133],v[132:133],v[68:69]
v_pk_add_f32 v[134:135],v[134:135],v[70:71]
v_pk_mul_f32 v[128:129],v[128:129],v[8:9] op_sel:[0,0] op_sel_hi:[1,0]
v_pk_mul_f32 v[130:131],v[130:131],v[8:9] op_sel:[0,0] op_sel_hi:[1,0]
v_pk_mul_f32 v[132:133],v[132:133],v[8:9] op_sel:[0,0] op_sel_hi:[1,0]
v_pk_mul_f32 v[134:135],v[134:135],v[8:9] op_sel:[0,0] op_sel_hi:[1,0]
v_cvt_pk_bf16_f32 v128,v128,v129
v_cvt_pk_bf16_f32 v129,v130,v131
v_cvt_pk_bf16_f32 v130,v132,v133
v_cvt_pk_bf16_f32 v131,v134,v135
buffer_store_dwordx4 v[128:131],v1,s[16:19],s86 offen offset:0 sc1
v_lshrrev_b32 v48,2,v7
v_lshlrev_b32 v48,7,v48
v_and_b32 v49,3,v7
v_lshl_add_u32 v48,v49,3,v48
v_bfe_u32 v49,v7,3,2
v_lshl_add_u32 v48,v49,5,v48
v_add_u32 v48,131072,v48
v_xor_b32 v24,0,v48
v_xor_b32 v25,32,v48
v_xor_b32 v26,64,v48
v_xor_b32 v27,96,v48
s_waitcnt lgkmcnt(13)
v_pk_add_f32 v[136:137],v[136:137],v[72:73]
v_pk_add_f32 v[138:139],v[138:139],v[74:75]
s_waitcnt lgkmcnt(12)
v_pk_add_f32 v[140:141],v[140:141],v[76:77]
v_pk_add_f32 v[142:143],v[142:143],v[78:79]
v_pk_mul_f32 v[136:137],v[136:137],v[8:9] op_sel:[0,0] op_sel_hi:[1,0]
v_pk_mul_f32 v[138:139],v[138:139],v[8:9] op_sel:[0,0] op_sel_hi:[1,0]
v_pk_mul_f32 v[140:141],v[140:141],v[8:9] op_sel:[0,0] op_sel_hi:[1,0]
v_pk_mul_f32 v[142:143],v[142:143],v[8:9] op_sel:[0,0] op_sel_hi:[1,0]
v_cvt_pk_bf16_f32 v136,v136,v137
v_cvt_pk_bf16_f32 v137,v138,v139
v_cvt_pk_bf16_f32 v138,v140,v141
v_cvt_pk_bf16_f32 v139,v142,v143
buffer_store_dwordx4 v[136:139],v1,s[16:19],s86 offen offset:1024 sc1
s_waitcnt lgkmcnt(11)
v_pk_add_f32 v[144:145],v[144:145],v[80:81]
v_pk_add_f32 v[146:147],v[146:147],v[82:83]
s_waitcnt lgkmcnt(10)
v_pk_add_f32 v[148:149],v[148:149],v[84:85]
v_pk_add_f32 v[150:151],v[150:151],v[86:87]
v_pk_mul_f32 v[144:145],v[144:145],v[8:9] op_sel:[0,0] op_sel_hi:[1,0]
v_pk_mul_f32 v[146:147],v[146:147],v[8:9] op_sel:[0,0] op_sel_hi:[1,0]
v_pk_mul_f32 v[148:149],v[148:149],v[8:9] op_sel:[0,0] op_sel_hi:[1,0]
v_pk_mul_f32 v[150:151],v[150:151],v[8:9] op_sel:[0,0] op_sel_hi:[1,0]
v_cvt_pk_bf16_f32 v144,v144,v145
v_cvt_pk_bf16_f32 v145,v146,v147
v_cvt_pk_bf16_f32 v146,v148,v149
v_cvt_pk_bf16_f32 v147,v150,v151
buffer_store_dwordx4 v[144:147],v1,s[16:19],s86 offen offset:2048 sc1
s_waitcnt lgkmcnt(9)
v_pk_add_f32 v[152:153],v[152:153],v[88:89]
v_pk_add_f32 v[154:155],v[154:155],v[90:91]
s_waitcnt lgkmcnt(8)
v_pk_add_f32 v[156:157],v[156:157],v[92:93]
v_pk_add_f32 v[158:159],v[158:159],v[94:95]
v_pk_mul_f32 v[152:153],v[152:153],v[8:9] op_sel:[0,0] op_sel_hi:[1,0]
v_pk_mul_f32 v[154:155],v[154:155],v[8:9] op_sel:[0,0] op_sel_hi:[1,0]
v_pk_mul_f32 v[156:157],v[156:157],v[8:9] op_sel:[0,0] op_sel_hi:[1,0]
v_pk_mul_f32 v[158:159],v[158:159],v[8:9] op_sel:[0,0] op_sel_hi:[1,0]
v_cvt_pk_bf16_f32 v152,v152,v153
v_cvt_pk_bf16_f32 v153,v154,v155
v_cvt_pk_bf16_f32 v154,v156,v157
v_cvt_pk_bf16_f32 v155,v158,v159
buffer_store_dwordx4 v[152:155],v1,s[16:19],s86 offen offset:3072 sc1
s_waitcnt lgkmcnt(7)
v_pk_add_f32 v[160:161],v[160:161],v[96:97]
v_pk_add_f32 v[162:163],v[162:163],v[98:99]
s_waitcnt lgkmcnt(6)
v_pk_add_f32 v[164:165],v[164:165],v[100:101]
v_pk_add_f32 v[166:167],v[166:167],v[102:103]
v_pk_mul_f32 v[160:161],v[160:161],v[8:9] op_sel:[0,1] op_sel_hi:[1,1]
v_pk_mul_f32 v[162:163],v[162:163],v[8:9] op_sel:[0,1] op_sel_hi:[1,1]
v_pk_mul_f32 v[164:165],v[164:165],v[8:9] op_sel:[0,1] op_sel_hi:[1,1]
v_pk_mul_f32 v[166:167],v[166:167],v[8:9] op_sel:[0,1] op_sel_hi:[1,1]
v_cvt_pk_bf16_f32 v160,v160,v161
v_cvt_pk_bf16_f32 v161,v162,v163
v_cvt_pk_bf16_f32 v162,v164,v165
v_cvt_pk_bf16_f32 v163,v166,v167
buffer_store_dwordx4 v[160:163],v1,s[16:19],s87 offen offset:0 sc1
s_waitcnt lgkmcnt(5)
v_pk_add_f32 v[168:169],v[168:169],v[104:105]
v_pk_add_f32 v[170:171],v[170:171],v[106:107]
s_waitcnt lgkmcnt(4)
v_pk_add_f32 v[172:173],v[172:173],v[108:109]
v_pk_add_f32 v[174:175],v[174:175],v[110:111]
v_pk_mul_f32 v[168:169],v[168:169],v[8:9] op_sel:[0,1] op_sel_hi:[1,1]
v_pk_mul_f32 v[170:171],v[170:171],v[8:9] op_sel:[0,1] op_sel_hi:[1,1]
v_pk_mul_f32 v[172:173],v[172:173],v[8:9] op_sel:[0,1] op_sel_hi:[1,1]
v_pk_mul_f32 v[174:175],v[174:175],v[8:9] op_sel:[0,1] op_sel_hi:[1,1]
v_cvt_pk_bf16_f32 v168,v168,v169
v_cvt_pk_bf16_f32 v169,v170,v171
v_cvt_pk_bf16_f32 v170,v172,v173
v_cvt_pk_bf16_f32 v171,v174,v175
buffer_store_dwordx4 v[168:171],v1,s[16:19],s87 offen offset:1024 sc1
s_waitcnt lgkmcnt(3)
v_pk_add_f32 v[176:177],v[176:177],v[112:113]
v_pk_add_f32 v[178:179],v[178:179],v[114:115]
s_waitcnt lgkmcnt(2)
v_pk_add_f32 v[180:181],v[180:181],v[116:117]
v_pk_add_f32 v[182:183],v[182:183],v[118:119]
v_pk_mul_f32 v[176:177],v[176:177],v[8:9] op_sel:[0,1] op_sel_hi:[1,1]
v_pk_mul_f32 v[178:179],v[178:179],v[8:9] op_sel:[0,1] op_sel_hi:[1,1]
v_pk_mul_f32 v[180:181],v[180:181],v[8:9] op_sel:[0,1] op_sel_hi:[1,1]
v_pk_mul_f32 v[182:183],v[182:183],v[8:9] op_sel:[0,1] op_sel_hi:[1,1]
v_cvt_pk_bf16_f32 v176,v176,v177
v_cvt_pk_bf16_f32 v177,v178,v179
v_cvt_pk_bf16_f32 v178,v180,v181
v_cvt_pk_bf16_f32 v179,v182,v183
buffer_store_dwordx4 v[176:179],v1,s[16:19],s87 offen offset:2048 sc1
ds_read_b64_tr_b16 a[0:1],v24 offset:0
ds_read_b64_tr_b16 a[2:3],v24 offset:2048
ds_read_b64_tr_b16 a[4:5],v24 offset:4096
ds_read_b64_tr_b16 a[6:7],v24 offset:6144
s_waitcnt lgkmcnt(5)
v_pk_add_f32 v[184:185],v[184:185],v[120:121]
v_pk_add_f32 v[186:187],v[186:187],v[122:123]
s_waitcnt lgkmcnt(4)
v_pk_add_f32 v[188:189],v[188:189],v[124:125]
v_pk_add_f32 v[190:191],v[190:191],v[126:127]
v_pk_mul_f32 v[184:185],v[184:185],v[8:9] op_sel:[0,1] op_sel_hi:[1,1]
v_pk_mul_f32 v[186:187],v[186:187],v[8:9] op_sel:[0,1] op_sel_hi:[1,1]
v_pk_mul_f32 v[188:189],v[188:189],v[8:9] op_sel:[0,1] op_sel_hi:[1,1]
v_pk_mul_f32 v[190:191],v[190:191],v[8:9] op_sel:[0,1] op_sel_hi:[1,1]
v_cvt_pk_bf16_f32 v184,v184,v185
v_cvt_pk_bf16_f32 v185,v186,v187
v_cvt_pk_bf16_f32 v186,v188,v189
v_cvt_pk_bf16_f32 v187,v190,v191
buffer_store_dwordx4 v[184:187],v1,s[16:19],s87 offen offset:3072 sc1
ds_read_b64_tr_b16 a[8:9],v24 offset:8192
ds_read_b64_tr_b16 a[10:11],v24 offset:10240
ds_read_b64_tr_b16 a[12:13],v24 offset:12288
ds_read_b64_tr_b16 a[14:15],v24 offset:14336
K2_POST:
s_cmp_eq_u32 s101,0
s_cbranch_scc1 F_YL
s_waitcnt lgkmcnt(6)
v_mfma_f32_16x16x32_bf16 v[132:135],a[0:3],v[192:195],0
ds_read_b64_tr_b16 a[16:17],v25 offset:0
s_and_b32 s44,s99,0xfffffe7f
s_waitcnt lgkmcnt(5)
v_mfma_f32_16x16x32_bf16 v[132:135],a[4:7],v[200:203],v[132:135]
s_barrier
ds_read_b64_tr_b16 a[18:19],v25 offset:2048
s_waitcnt lgkmcnt(4)
v_mfma_f32_16x16x32_bf16 v[132:135],a[8:11],v[208:211],v[132:135]
ds_read_b64_tr_b16 a[20:21],v25 offset:4096
v_subrev_u32 v28,65536,v24
s_waitcnt lgkmcnt(3)
v_mfma_f32_16x16x32_bf16 v[132:135],a[12:15],v[216:219],v[132:135]
ds_read_b64_tr_b16 a[22:23],v25 offset:6144
v_subrev_u32 v29,65536,v25
v_mfma_f32_16x16x32_bf16 a[192:195],a[0:3],v[224:227],0
ds_read_b64_tr_b16 a[24:25],v25 offset:8192
v_subrev_u32 v30,65536,v26
v_mfma_f32_16x16x32_bf16 a[192:195],a[4:7],v[232:235],a[192:195]
ds_read_b64_tr_b16 a[26:27],v25 offset:10240
v_subrev_u32 v31,65536,v27
v_mfma_f32_16x16x32_bf16 a[192:195],a[8:11],v[240:243],a[192:195]
s_add_u32 m0,s52,39936
ds_read_b64_tr_b16 a[28:29],v25 offset:12288
v_mfma_f32_16x16x32_bf16 a[192:195],a[12:15],v[248:251],a[192:195]
s_add_u32 s53,s55,57344
ds_read_b64_tr_b16 a[30:31],v25 offset:14336
v_mfma_f32_16x16x32_bf16 v[64:67],a[0:3],v[128:131],0
v_lshrrev_b32 v32,4,v7
v_lshlrev_b32 v32,7,v32
v_mfma_f32_16x16x32_bf16 v[64:67],a[4:7],v[136:139],v[64:67]
buffer_load_dwordx4 v0,s[12:15],s53 offen lds
v_mfma_f32_16x16x32_bf16 v[64:67],a[8:11],v[144:147],v[64:67]
s_add_u32 m0,s52,0
s_add_u32 s53,s57,0
v_mov_b32 v34,0
v_mfma_f32_16x16x32_bf16 v[64:67],a[12:15],v[152:155],v[64:67]
buffer_load_dwordx4 v0,s[12:15],s53 offen lds
v_mfma_f32_16x16x32_bf16 v[96:99],a[0:3],v[160:163],0
s_add_u32 m0,s52,1024
s_add_u32 s53,s57,8192
s_add_u32 s29,s21,1
v_mfma_f32_16x16x32_bf16 v[96:99],a[4:7],v[168:171],v[96:99]
buffer_load_dwordx4 v0,s[12:15],s53 offen lds
v_mfma_f32_16x16x32_bf16 v[96:99],a[8:11],v[176:179],v[96:99]
s_add_u32 m0,s52,2048
s_add_u32 s53,s57,16384
s_and_b32 s29,s29,3
v_mfma_f32_16x16x32_bf16 v[96:99],a[12:15],v[184:187],v[96:99]
buffer_load_dwordx4 v0,s[12:15],s53 offen lds
s_waitcnt lgkmcnt(6)
v_mfma_f32_16x16x32_bf16 v[140:143],a[16:19],v[192:195],0
ds_read_b64_tr_b16 a[32:33],v26 offset:0
s_add_u32 m0,s52,3072
s_waitcnt lgkmcnt(5)
v_mfma_f32_16x16x32_bf16 v[140:143],a[20:23],v[200:203],v[140:143]
ds_read_b64_tr_b16 a[34:35],v26 offset:2048
s_add_u32 s53,s57,24576
s_waitcnt lgkmcnt(4)
v_mfma_f32_16x16x32_bf16 v[140:143],a[24:27],v[208:211],v[140:143]
ds_read_b64_tr_b16 a[36:37],v26 offset:4096
s_and_b32 s30,s21,3
s_waitcnt lgkmcnt(3)
v_mfma_f32_16x16x32_bf16 v[140:143],a[28:31],v[216:219],v[140:143]
ds_read_b64_tr_b16 a[38:39],v26 offset:6144
s_sub_u32 s29,s29,s30
v_mfma_f32_16x16x32_bf16 a[196:199],a[16:19],v[224:227],0
ds_read_b64_tr_b16 a[40:41],v26 offset:8192
s_lshl_b32 s29,s29,12
v_mfma_f32_16x16x32_bf16 a[196:199],a[20:23],v[232:235],a[196:199]
ds_read_b64_tr_b16 a[42:43],v26 offset:10240
s_add_u32 s38,s88,s29
v_mfma_f32_16x16x32_bf16 a[196:199],a[24:27],v[240:243],a[196:199]
ds_read_b64_tr_b16 a[44:45],v26 offset:12288
s_add_u32 s41,s89,s29
v_mfma_f32_16x16x32_bf16 a[196:199],a[28:31],v[248:251],a[196:199]
ds_read_b64_tr_b16 a[46:47],v26 offset:14336
s_add_u32 s32,s86,s29
v_mfma_f32_16x16x32_bf16 v[68:71],a[16:19],v[128:131],0
s_add_u32 s35,s87,s29
s_add_u32 s29,s21,2
s_and_b32 s29,s29,3
v_mfma_f32_16x16x32_bf16 v[68:71],a[20:23],v[136:139],v[68:71]
buffer_load_dwordx4 v0,s[12:15],s53 offen lds
v_mfma_f32_16x16x32_bf16 v[68:71],a[24:27],v[144:147],v[68:71]
s_add_u32 m0,s52,4096
s_add_u32 s53,s57,32768
s_and_b32 s30,s21,3
v_mfma_f32_16x16x32_bf16 v[68:71],a[28:31],v[152:155],v[68:71]
buffer_load_dwordx4 v0,s[12:15],s53 offen lds
v_mfma_f32_16x16x32_bf16 v[100:103],a[16:19],v[160:163],0
s_add_u32 m0,s52,5120
s_add_u32 s53,s57,40960
s_sub_u32 s29,s29,s30
v_mfma_f32_16x16x32_bf16 v[100:103],a[20:23],v[168:171],v[100:103]
buffer_load_dwordx4 v0,s[12:15],s53 offen lds
v_mfma_f32_16x16x32_bf16 v[100:103],a[24:27],v[176:179],v[100:103]
s_add_u32 m0,s52,6144
s_add_u32 s53,s57,49152
s_lshl_b32 s29,s29,12
v_mfma_f32_16x16x32_bf16 v[100:103],a[28:31],v[184:187],v[100:103]
buffer_load_dwordx4 v0,s[12:15],s53 offen lds
s_waitcnt lgkmcnt(6)
v_mfma_f32_16x16x32_bf16 v[148:151],a[32:35],v[192:195],0
ds_read_b64_tr_b16 a[48:49],v27 offset:0
s_add_u32 m0,s52,7168
s_waitcnt lgkmcnt(5)
v_mfma_f32_16x16x32_bf16 v[148:151],a[36:39],v[200:203],v[148:151]
ds_read_b64_tr_b16 a[50:51],v27 offset:2048
s_add_u32 s53,s57,57344
s_waitcnt lgkmcnt(4)
v_mfma_f32_16x16x32_bf16 v[148:151],a[40:43],v[208:211],v[148:151]
ds_read_b64_tr_b16 a[52:53],v27 offset:4096
s_add_u32 s39,s88,s29
s_waitcnt lgkmcnt(3)
v_mfma_f32_16x16x32_bf16 v[148:151],a[44:47],v[216:219],v[148:151]
ds_read_b64_tr_b16 a[54:55],v27 offset:6144
s_add_u32 s42,s89,s29
v_mfma_f32_16x16x32_bf16 a[200:203],a[32:35],v[224:227],0
ds_read_b64_tr_b16 a[56:57],v27 offset:8192
s_add_u32 s33,s86,s29
v_mfma_f32_16x16x32_bf16 a[200:203],a[36:39],v[232:235],a[200:203]
ds_read_b64_tr_b16 a[58:59],v27 offset:10240
s_add_u32 s36,s87,s29
v_mfma_f32_16x16x32_bf16 a[200:203],a[40:43],v[240:243],a[200:203]
ds_read_b64_tr_b16 a[60:61],v27 offset:12288
s_add_u32 s29,s21,3
v_mfma_f32_16x16x32_bf16 a[200:203],a[44:47],v[248:251],a[200:203]
ds_read_b64_tr_b16 a[62:63],v27 offset:14336
s_and_b32 s29,s29,3
v_mfma_f32_16x16x32_bf16 v[72:75],a[32:35],v[128:131],0
s_and_b32 s30,s21,3
s_sub_u32 s29,s29,s30
s_lshl_b32 s29,s29,12
v_mfma_f32_16x16x32_bf16 v[72:75],a[36:39],v[136:139],v[72:75]
buffer_load_dwordx4 v0,s[12:15],s53 offen lds
v_mfma_f32_16x16x32_bf16 v[72:75],a[40:43],v[144:147],v[72:75]
s_add_u32 s40,s88,s29
s_add_u32 s43,s89,s29
s_add_u32 s34,s86,s29
v_mfma_f32_16x16x32_bf16 v[72:75],a[44:47],v[152:155],v[72:75]
s_add_u32 s37,s87,s29
s_mov_b32 s68,s94
s_and_b32 s69,s95,0xffff
v_mfma_f32_16x16x32_bf16 v[104:107],a[32:35],v[160:163],0
s_mov_b32 s70,2097152
s_mov_b32 s71,0x20000
s_and_b32 s50,s99,0xfffff07f
v_mfma_f32_16x16x32_bf16 v[104:107],a[36:39],v[168:171],v[104:107]
v_lshrrev_b32 v36,1,v7
v_lshlrev_b32 v36,7,v36
v_mfma_f32_16x16x32_bf16 v[104:107],a[40:43],v[176:179],v[104:107]
s_waitcnt lgkmcnt(4)
v_lshrrev_b32 v51,5,v7
v_bfe_u32 v48,v7,4,1
v_mfma_f32_16x16x32_bf16 v[104:107],a[44:47],v[184:187],v[104:107]
s_and_b32 s29,s2,7
s_lshl_b32 s29,s29,5
v_and_b32 v9,31,v7
v_mfma_f32_16x16x32_bf16 v[156:159],a[48:51],v[192:195],0
ds_read_b64_tr_b16 a[0:1],v24 offset:16384
v_add_u32 v9,s29,v9
v_mfma_f32_16x16x32_bf16 v[156:159],a[52:55],v[200:203],v[156:159]
ds_read_b64_tr_b16 a[2:3],v24 offset:18432
s_lshr_b32 s29,s2,3
s_waitcnt lgkmcnt(4)
v_mfma_f32_16x16x32_bf16 v[156:159],a[56:59],v[208:211],v[156:159]
ds_read_b64_tr_b16 a[4:5],v24 offset:20480
s_lshl_b32 s29,s29,6
s_waitcnt lgkmcnt(3)
v_mfma_f32_16x16x32_bf16 v[156:159],a[60:63],v[216:219],v[156:159]
ds_read_b64_tr_b16 a[6:7],v24 offset:22528
s_lshl_b32 s30,s20,4
v_mfma_f32_16x16x32_bf16 a[204:207],a[48:51],v[224:227],0
ds_read_b64_tr_b16 a[8:9],v24 offset:24576
s_add_u32 s29,s29,s30
v_mfma_f32_16x16x32_bf16 a[204:207],a[52:55],v[232:235],a[204:207]
ds_read_b64_tr_b16 a[10:11],v24 offset:26624
v_lshlrev_b32 v10,3,v51
v_mfma_f32_16x16x32_bf16 a[204:207],a[56:59],v[240:243],a[204:207]
ds_read_b64_tr_b16 a[12:13],v24 offset:28672
v_add_u32 v10,s29,v10
v_mfma_f32_16x16x32_bf16 a[204:207],a[60:63],v[248:251],a[204:207]
ds_read_b64_tr_b16 a[14:15],v24 offset:30720
v_lshlrev_b32 v8,10,v10
v_mfma_f32_16x16x32_bf16 v[76:79],a[48:51],v[128:131],0
s_waitcnt vmcnt(9)
v_mov_b32 v35,4
buffer_store_dword v35,v34,s[16:19],s99 offen sc1
v_mfma_f32_16x16x32_bf16 v[76:79],a[52:55],v[136:139],v[76:79]
v_lshl_add_u32 v8,v9,2,v8
s_movk_i32 s77,4096
v_mfma_f32_16x16x32_bf16 v[76:79],a[56:59],v[144:147],v[76:79]
v_lshlrev_b32 v15,11,v10
v_lshl_add_u32 v15,v9,2,v15
v_mfma_f32_16x16x32_bf16 v[76:79],a[60:63],v[152:155],v[76:79]
v_lshrrev_b32 v13,4,v7
v_lshl_add_u32 v12,v13,2,s20
v_mfma_f32_16x16x32_bf16 v[108:111],a[48:51],v[160:163],0
v_xor_b32 v12,v12,v7
v_and_b32 v12,15,v12
v_mfma_f32_16x16x32_bf16 v[108:111],a[52:55],v[168:171],v[108:111]
s_waitcnt lgkmcnt(6)
v_lshlrev_b32 v12,4,v12
v_lshl_add_u32 v14,v13,13,v12
v_mfma_f32_16x16x32_bf16 v[108:111],a[56:59],v[176:179],v[108:111]
s_and_b32 s72,s2,7
s_lshl_b32 s72,s72,2
s_add_u32 s72,s72,s20
v_mfma_f32_16x16x32_bf16 v[108:111],a[60:63],v[184:187],v[108:111]
s_lshl_b32 s72,s72,16
s_lshr_b32 s73,s2,3
s_lshl_b32 s73,s73,8
v_mfma_f32_16x16x32_bf16 v[164:167],a[0:3],v[192:195],0
ds_read_b64_tr_b16 a[16:17],v25 offset:16384
s_add_u32 s72,s72,s73
s_waitcnt lgkmcnt(5)
v_mfma_f32_16x16x32_bf16 v[164:167],a[4:7],v[200:203],v[164:167]
ds_read_b64_tr_b16 a[18:19],v25 offset:18432
s_add_u32 s72,s72,58720256
s_waitcnt lgkmcnt(4)
v_mfma_f32_16x16x32_bf16 v[164:167],a[8:11],v[208:211],v[164:167]
ds_read_b64_tr_b16 a[20:21],v25 offset:20480
s_add_u32 s73,s72,31744
s_waitcnt lgkmcnt(3)
v_mfma_f32_16x16x32_bf16 v[164:167],a[12:15],v[216:219],v[164:167]
ds_read_b64_tr_b16 a[22:23],v25 offset:22528
s_lshl_b32 s74,s20,11
v_mfma_f32_16x16x32_bf16 a[208:211],a[0:3],v[224:227],0
ds_read_b64_tr_b16 a[24:25],v25 offset:24576
s_add_u32 s74,s74,98304
v_mfma_f32_16x16x32_bf16 a[208:211],a[4:7],v[232:235],a[208:211]
ds_read_b64_tr_b16 a[26:27],v25 offset:26624
v_and_b32 v12,3,v7
v_mfma_f32_16x16x32_bf16 a[208:211],a[8:11],v[240:243],a[208:211]
ds_read_b64_tr_b16 a[28:29],v25 offset:28672
v_lshlrev_b32 v12,2,v12
v_mfma_f32_16x16x32_bf16 a[208:211],a[12:15],v[248:251],a[208:211]
ds_read_b64_tr_b16 a[30:31],v25 offset:30720
v_bfe_u32 v13,v7,3,2
v_mfma_f32_16x16x32_bf16 v[80:83],a[0:3],v[128:131],0
v_add_u32 v12,v12,v13
s_lshl_b32 s29,s20,2
v_mfma_f32_16x16x32_bf16 v[80:83],a[4:7],v[136:139],v[80:83]
v_lshl_add_u32 v13,v51,1,s29
v_xor_b32 v12,v12,v13
v_mfma_f32_16x16x32_bf16 v[80:83],a[8:11],v[144:147],v[80:83]
v_lshlrev_b32 v12,4,v12
v_and_b32 v13,31,v7
v_mfma_f32_16x16x32_bf16 v[80:83],a[12:15],v[152:155],v[80:83]
v_lshl_add_u32 v12,v13,8,v12
v_add_u32 v12,98304,v12
v_mfma_f32_16x16x32_bf16 v[112:115],a[0:3],v[160:163],0
v_xor_b32 v13,16,v12
v_mfma_f32_16x16x32_bf16 v[112:115],a[4:7],v[168:171],v[112:115]
v_mfma_f32_16x16x32_bf16 v[112:115],a[8:11],v[176:179],v[112:115]
v_mfma_f32_16x16x32_bf16 v[112:115],a[12:15],v[184:187],v[112:115]
s_waitcnt lgkmcnt(2)
v_mfma_f32_16x16x32_bf16 v[172:175],a[16:19],v[192:195],0
ds_read_b64_tr_b16 a[32:33],v26 offset:16384
v_mfma_f32_16x16x32_bf16 v[172:175],a[20:23],v[200:203],v[172:175]
ds_read_b64_tr_b16 a[34:35],v26 offset:18432
v_mfma_f32_16x16x32_bf16 v[172:175],a[24:27],v[208:211],v[172:175]
ds_read_b64_tr_b16 a[36:37],v26 offset:20480
s_waitcnt lgkmcnt(3)
v_mfma_f32_16x16x32_bf16 v[172:175],a[28:31],v[216:219],v[172:175]
ds_read_b64_tr_b16 a[38:39],v26 offset:22528
v_mfma_f32_16x16x32_bf16 a[212:215],a[16:19],v[224:227],0
ds_read_b64_tr_b16 a[40:41],v26 offset:24576
v_mfma_f32_16x16x32_bf16 a[212:215],a[20:23],v[232:235],a[212:215]
ds_read_b64_tr_b16 a[42:43],v26 offset:26624
v_mfma_f32_16x16x32_bf16 a[212:215],a[24:27],v[240:243],a[212:215]
ds_read_b64_tr_b16 a[44:45],v26 offset:28672
v_mfma_f32_16x16x32_bf16 a[212:215],a[28:31],v[248:251],a[212:215]
ds_read_b64_tr_b16 a[46:47],v26 offset:30720
v_mfma_f32_16x16x32_bf16 v[84:87],a[16:19],v[128:131],0
v_mfma_f32_16x16x32_bf16 v[84:87],a[20:23],v[136:139],v[84:87]
v_mfma_f32_16x16x32_bf16 v[84:87],a[24:27],v[144:147],v[84:87]
v_mfma_f32_16x16x32_bf16 v[84:87],a[28:31],v[152:155],v[84:87]
v_mfma_f32_16x16x32_bf16 v[116:119],a[16:19],v[160:163],0
v_mfma_f32_16x16x32_bf16 v[116:119],a[20:23],v[168:171],v[116:119]
v_mfma_f32_16x16x32_bf16 v[116:119],a[24:27],v[176:179],v[116:119]
v_mfma_f32_16x16x32_bf16 v[116:119],a[28:31],v[184:187],v[116:119]
s_waitcnt lgkmcnt(2)
v_mfma_f32_16x16x32_bf16 v[180:183],a[32:35],v[192:195],0
ds_read_b64_tr_b16 a[48:49],v27 offset:16384
v_mfma_f32_16x16x32_bf16 v[180:183],a[36:39],v[200:203],v[180:183]
ds_read_b64_tr_b16 a[50:51],v27 offset:18432
v_mfma_f32_16x16x32_bf16 v[180:183],a[40:43],v[208:211],v[180:183]
ds_read_b64_tr_b16 a[52:53],v27 offset:20480
s_waitcnt lgkmcnt(3)
v_mfma_f32_16x16x32_bf16 v[180:183],a[44:47],v[216:219],v[180:183]
ds_read_b64_tr_b16 a[54:55],v27 offset:22528
v_mfma_f32_16x16x32_bf16 a[216:219],a[32:35],v[224:227],0
ds_read_b64_tr_b16 a[56:57],v27 offset:24576
s_and_b32 s29,s21,3
v_mfma_f32_16x16x32_bf16 a[216:219],a[36:39],v[232:235],a[216:219]
ds_read_b64_tr_b16 a[58:59],v27 offset:26624
s_lshl_b32 s29,s29,15
v_mfma_f32_16x16x32_bf16 a[216:219],a[40:43],v[240:243],a[216:219]
ds_read_b64_tr_b16 a[60:61],v27 offset:28672
s_and_b32 s30,s2,7
v_mfma_f32_16x16x32_bf16 a[216:219],a[44:47],v[248:251],a[216:219]
ds_read_b64_tr_b16 a[62:63],v27 offset:30720
s_lshl_b32 s30,s30,10
v_mfma_f32_16x16x32_bf16 v[88:91],a[32:35],v[128:131],0
s_add_u32 s29,s29,s30
s_add_u32 s29,s29,67108864
s_lshl_b32 s46,s80,17
v_mfma_f32_16x16x32_bf16 v[88:91],a[36:39],v[136:139],v[88:91]
s_waitcnt vmcnt(18) lgkmcnt(0)
s_add_u32 s46,s46,s29
s_lshl_b32 s47,s81,17
v_mfma_f32_16x16x32_bf16 v[88:91],a[40:43],v[144:147],v[88:91]
s_barrier
s_add_u32 s47,s47,s29
s_lshl_b32 s48,s82,17
v_mfma_f32_16x16x32_bf16 v[88:91],a[44:47],v[152:155],v[88:91]
s_add_u32 s48,s48,s29
s_lshl_b32 s49,s83,17
s_add_u32 s49,s49,s29
v_mfma_f32_16x16x32_bf16 v[120:123],a[32:35],v[160:163],0
ds_read_b64_tr_b16 a[0:1],v28 offset:0
s_mov_b32 s12,s92
v_mfma_f32_16x16x32_bf16 v[120:123],a[36:39],v[168:171],v[120:123]
ds_read_b64_tr_b16 a[2:3],v28 offset:2048
s_and_b32 s13,s93,0xffff
v_mfma_f32_16x16x32_bf16 v[120:123],a[40:43],v[176:179],v[120:123]
ds_read_b64_tr_b16 a[4:5],v28 offset:4096
v_subrev_u32 v24,131072,v24
v_mfma_f32_16x16x32_bf16 v[120:123],a[44:47],v[184:187],v[120:123]
ds_read_b64_tr_b16 a[6:7],v28 offset:6144
v_subrev_u32 v25,131072,v25
v_mfma_f32_16x16x32_bf16 v[188:191],a[48:51],v[192:195],0
ds_read_b64_tr_b16 a[8:9],v28 offset:8192
v_subrev_u32 v26,131072,v26
v_mfma_f32_16x16x32_bf16 v[188:191],a[52:55],v[200:203],v[188:191]
ds_read_b64_tr_b16 a[10:11],v28 offset:10240
v_subrev_u32 v27,131072,v27
v_mfma_f32_16x16x32_bf16 v[188:191],a[56:59],v[208:211],v[188:191]
ds_read_b64_tr_b16 a[12:13],v28 offset:12288
v_mfma_f32_16x16x32_bf16 v[188:191],a[60:63],v[216:219],v[188:191]
ds_read_b64_tr_b16 a[14:15],v28 offset:14336
v_mfma_f32_16x16x32_bf16 a[220:223],a[48:51],v[224:227],0
v_mfma_f32_16x16x32_bf16 a[220:223],a[52:55],v[232:235],a[220:223]
ds_read_b64_tr_b16 a[16:17],v29 offset:0
v_mfma_f32_16x16x32_bf16 a[220:223],a[56:59],v[240:243],a[220:223]
ds_read_b64_tr_b16 a[18:19],v29 offset:2048
v_mfma_f32_16x16x32_bf16 a[220:223],a[60:63],v[248:251],a[220:223]
ds_read_b64_tr_b16 a[20:21],v29 offset:4096
v_mfma_f32_16x16x32_bf16 v[92:95],a[48:51],v[128:131],0
ds_read_b64_tr_b16 a[22:23],v29 offset:6144
v_mfma_f32_16x16x32_bf16 v[92:95],a[52:55],v[136:139],v[92:95]
ds_read_b64_tr_b16 a[24:25],v29 offset:8192
v_mfma_f32_16x16x32_bf16 v[92:95],a[56:59],v[144:147],v[92:95]
ds_read_b64_tr_b16 a[26:27],v29 offset:10240
v_mfma_f32_16x16x32_bf16 v[92:95],a[60:63],v[152:155],v[92:95]
ds_read_b64_tr_b16 a[28:29],v29 offset:12288
v_mfma_f32_16x16x32_bf16 v[124:127],a[48:51],v[160:163],0
ds_read_b64_tr_b16 a[30:31],v29 offset:14336
v_mfma_f32_16x16x32_bf16 v[124:127],a[52:55],v[168:171],v[124:127]
v_mfma_f32_16x16x32_bf16 v[124:127],a[56:59],v[176:179],v[124:127]
v_mfma_f32_16x16x32_bf16 v[124:127],a[60:63],v[184:187],v[124:127]
F_YB:
s_waitcnt lgkmcnt(14)
v_mfma_f32_16x16x32_bf16 v[132:135],a[0:3],a[224:227],v[132:135]
ds_read_b64_tr_b16 a[32:33],v30 offset:0
s_waitcnt lgkmcnt(13)
v_mfma_f32_16x16x32_bf16 v[132:135],a[4:7],a[228:231],v[132:135]
ds_read_b64_tr_b16 a[34:35],v30 offset:2048
s_waitcnt lgkmcnt(12)
v_mfma_f32_16x16x32_bf16 v[132:135],a[8:11],a[232:235],v[132:135]
ds_read_b64_tr_b16 a[36:37],v30 offset:4096
s_waitcnt lgkmcnt(11)
v_mfma_f32_16x16x32_bf16 v[132:135],a[12:15],a[236:239],v[132:135]
ds_read_b64_tr_b16 a[38:39],v30 offset:6144
v_mfma_f32_16x16x32_bf16 a[192:195],a[0:3],a[240:243],a[192:195]
ds_read_b64_tr_b16 a[40:41],v30 offset:8192
buffer_load_dword v37,v36,s[16:19],s50 offen sc1
v_mfma_f32_16x16x32_bf16 a[192:195],a[4:7],a[244:247],a[192:195]
ds_read_b64_tr_b16 a[42:43],v30 offset:10240
v_mfma_f32_16x16x32_bf16 a[192:195],a[8:11],a[248:251],a[192:195]
ds_read_b64_tr_b16 a[44:45],v30 offset:12288
v_mfma_f32_16x16x32_bf16 a[192:195],a[12:15],a[252:255],a[192:195]
buffer_load_dword v52,v8,s[68:71],0 offen offset:0
s_waitcnt lgkmcnt(13)
v_mfma_f32_16x16x32_bf16 v[140:143],a[16:19],a[224:227],v[140:143]
ds_read_b64_tr_b16 a[46:47],v30 offset:14336
s_waitcnt lgkmcnt(12)
v_mfma_f32_16x16x32_bf16 v[140:143],a[20:23],a[228:231],v[140:143]
ds_read_b64_tr_b16 a[48:49],v31 offset:0
buffer_load_dword v53,v8,s[68:71],0 offen offset:1024
s_waitcnt lgkmcnt(11)
v_mfma_f32_16x16x32_bf16 v[140:143],a[24:27],a[232:235],v[140:143]
ds_read_b64_tr_b16 a[50:51],v31 offset:2048
s_waitcnt lgkmcnt(10)
v_mfma_f32_16x16x32_bf16 v[140:143],a[28:31],a[236:239],v[140:143]
ds_read_b64_tr_b16 a[52:53],v31 offset:4096
buffer_load_dword v54,v8,s[68:71],0 offen offset:2048
v_mfma_f32_16x16x32_bf16 a[196:199],a[16:19],a[240:243],a[196:199]
ds_read_b64_tr_b16 a[54:55],v31 offset:6144
v_mfma_f32_16x16x32_bf16 a[196:199],a[20:23],a[244:247],a[196:199]
ds_read_b64_tr_b16 a[56:57],v31 offset:8192
buffer_load_dword v55,v8,s[68:71],0 offen offset:3072
v_mfma_f32_16x16x32_bf16 a[196:199],a[24:27],a[248:251],a[196:199]
ds_read_b64_tr_b16 a[58:59],v31 offset:10240
v_mfma_f32_16x16x32_bf16 a[196:199],a[28:31],a[252:255],a[196:199]
ds_read_b64_tr_b16 a[60:61],v31 offset:12288
buffer_load_dword v56,v8,s[68:71],s77 offen offset:0
s_waitcnt lgkmcnt(13)
v_mfma_f32_16x16x32_bf16 v[148:151],a[32:35],a[224:227],v[148:151]
ds_read_b64_tr_b16 a[62:63],v31 offset:14336
s_waitcnt lgkmcnt(12)
v_mfma_f32_16x16x32_bf16 v[148:151],a[36:39],a[228:231],v[148:151]
ds_read_b64_tr_b16 a[0:1],v28 offset:16384
buffer_load_dword v57,v8,s[68:71],s77 offen offset:1024
s_waitcnt lgkmcnt(11)
v_mfma_f32_16x16x32_bf16 v[148:151],a[40:43],a[232:235],v[148:151]
ds_read_b64_tr_b16 a[2:3],v28 offset:18432
s_waitcnt lgkmcnt(10)
v_mfma_f32_16x16x32_bf16 v[148:151],a[44:47],a[236:239],v[148:151]
ds_read_b64_tr_b16 a[4:5],v28 offset:20480
buffer_load_dword v58,v8,s[68:71],s77 offen offset:2048
v_mfma_f32_16x16x32_bf16 a[200:203],a[32:35],a[240:243],a[200:203]
ds_read_b64_tr_b16 a[6:7],v28 offset:22528
v_mfma_f32_16x16x32_bf16 a[200:203],a[36:39],a[244:247],a[200:203]
ds_read_b64_tr_b16 a[8:9],v28 offset:24576
buffer_load_dword v59,v8,s[68:71],s77 offen offset:3072
v_mfma_f32_16x16x32_bf16 a[200:203],a[40:43],a[248:251],a[200:203]
ds_read_b64_tr_b16 a[10:11],v28 offset:26624
v_mfma_f32_16x16x32_bf16 a[200:203],a[44:47],a[252:255],a[200:203]
ds_read_b64_tr_b16 a[12:13],v28 offset:28672
s_waitcnt lgkmcnt(13)
v_mfma_f32_16x16x32_bf16 v[156:159],a[48:51],a[224:227],v[156:159]
ds_read_b64_tr_b16 a[14:15],v28 offset:30720
s_waitcnt lgkmcnt(12)
v_mfma_f32_16x16x32_bf16 v[156:159],a[52:55],a[228:231],v[156:159]
ds_read_b64_tr_b16 a[16:17],v29 offset:16384
s_waitcnt lgkmcnt(11)
v_mfma_f32_16x16x32_bf16 v[156:159],a[56:59],a[232:235],v[156:159]
ds_read_b64_tr_b16 a[18:19],v29 offset:18432
s_waitcnt lgkmcnt(10)
v_mfma_f32_16x16x32_bf16 v[156:159],a[60:63],a[236:239],v[156:159]
ds_read_b64_tr_b16 a[20:21],v29 offset:20480
v_mfma_f32_16x16x32_bf16 a[204:207],a[48:51],a[240:243],a[204:207]
ds_read_b64_tr_b16 a[22:23],v29 offset:22528
v_mfma_f32_16x16x32_bf16 a[204:207],a[52:55],a[244:247],a[204:207]
ds_read_b64_tr_b16 a[24:25],v29 offset:24576
v_mfma_f32_16x16x32_bf16 a[204:207],a[56:59],a[248:251],a[204:207]
ds_read_b64_tr_b16 a[26:27],v29 offset:26624
v_mfma_f32_16x16x32_bf16 a[204:207],a[60:63],a[252:255],a[204:207]
ds_read_b64_tr_b16 a[28:29],v29 offset:28672
s_waitcnt lgkmcnt(13)
v_mfma_f32_16x16x32_bf16 v[164:167],a[0:3],a[224:227],v[164:167]
ds_read_b64_tr_b16 a[30:31],v29 offset:30720
s_waitcnt lgkmcnt(12)
v_mfma_f32_16x16x32_bf16 v[164:167],a[4:7],a[228:231],v[164:167]
ds_read_b64_tr_b16 a[32:33],v30 offset:16384
s_waitcnt lgkmcnt(11)
v_mfma_f32_16x16x32_bf16 v[164:167],a[8:11],a[232:235],v[164:167]
ds_read_b64_tr_b16 a[34:35],v30 offset:18432
s_waitcnt lgkmcnt(10)
v_mfma_f32_16x16x32_bf16 v[164:167],a[12:15],a[236:239],v[164:167]
ds_read_b64_tr_b16 a[36:37],v30 offset:20480
v_mfma_f32_16x16x32_bf16 a[208:211],a[0:3],a[240:243],a[208:211]
ds_read_b64_tr_b16 a[38:39],v30 offset:22528
v_mfma_f32_16x16x32_bf16 a[208:211],a[4:7],a[244:247],a[208:211]
ds_read_b64_tr_b16 a[40:41],v30 offset:24576
v_mfma_f32_16x16x32_bf16 a[208:211],a[8:11],a[248:251],a[208:211]
ds_read_b64_tr_b16 a[42:43],v30 offset:26624
v_mfma_f32_16x16x32_bf16 a[208:211],a[12:15],a[252:255],a[208:211]
ds_read_b64_tr_b16 a[44:45],v30 offset:28672
s_waitcnt lgkmcnt(13)
v_mfma_f32_16x16x32_bf16 v[172:175],a[16:19],a[224:227],v[172:175]
ds_read_b64_tr_b16 a[46:47],v30 offset:30720
s_waitcnt lgkmcnt(12)
v_mfma_f32_16x16x32_bf16 v[172:175],a[20:23],a[228:231],v[172:175]
ds_read_b64_tr_b16 a[48:49],v31 offset:16384
s_waitcnt lgkmcnt(11)
v_mfma_f32_16x16x32_bf16 v[172:175],a[24:27],a[232:235],v[172:175]
ds_read_b64_tr_b16 a[50:51],v31 offset:18432
s_waitcnt lgkmcnt(10)
v_mfma_f32_16x16x32_bf16 v[172:175],a[28:31],a[236:239],v[172:175]
s_waitcnt vmcnt(10)
ds_read_b64_tr_b16 a[52:53],v31 offset:20480
v_mfma_f32_16x16x32_bf16 a[212:215],a[16:19],a[240:243],a[212:215]
s_barrier
ds_read_b64_tr_b16 a[54:55],v31 offset:22528
v_mfma_f32_16x16x32_bf16 a[212:215],a[20:23],a[244:247],a[212:215]
ds_read_b64_tr_b16 a[56:57],v31 offset:24576
v_mfma_f32_16x16x32_bf16 a[212:215],a[24:27],a[248:251],a[212:215]
ds_read_b64_tr_b16 a[58:59],v31 offset:26624
v_mfma_f32_16x16x32_bf16 a[212:215],a[28:31],a[252:255],a[212:215]
ds_read_b64_tr_b16 a[60:61],v31 offset:28672
s_waitcnt lgkmcnt(13)
v_mfma_f32_16x16x32_bf16 v[180:183],a[32:35],a[224:227],v[180:183]
ds_read_b64_tr_b16 a[62:63],v31 offset:30720
s_waitcnt lgkmcnt(12)
v_mfma_f32_16x16x32_bf16 v[180:183],a[36:39],a[228:231],v[180:183]
ds_read_b64_tr_b16 a[0:1],v24 offset:32768
s_waitcnt lgkmcnt(11)
v_mfma_f32_16x16x32_bf16 v[180:183],a[40:43],a[232:235],v[180:183]
ds_read_b64_tr_b16 a[2:3],v24 offset:34816
s_waitcnt lgkmcnt(10)
v_mfma_f32_16x16x32_bf16 v[180:183],a[44:47],a[236:239],v[180:183]
ds_read_b64_tr_b16 a[4:5],v24 offset:36864
v_mfma_f32_16x16x32_bf16 a[216:219],a[32:35],a[240:243],a[216:219]
ds_read_b64_tr_b16 a[6:7],v24 offset:38912
v_mfma_f32_16x16x32_bf16 a[216:219],a[36:39],a[244:247],a[216:219]
ds_read_b64_tr_b16 a[8:9],v24 offset:40960
v_mfma_f32_16x16x32_bf16 a[216:219],a[40:43],a[248:251],a[216:219]
ds_read_b64_tr_b16 a[10:11],v24 offset:43008
v_mfma_f32_16x16x32_bf16 a[216:219],a[44:47],a[252:255],a[216:219]
ds_read_b64_tr_b16 a[12:13],v24 offset:45056
s_waitcnt lgkmcnt(13)
v_mfma_f32_16x16x32_bf16 v[188:191],a[48:51],a[224:227],v[188:191]
ds_read_b64_tr_b16 a[14:15],v24 offset:47104
s_waitcnt lgkmcnt(12)
v_mfma_f32_16x16x32_bf16 v[188:191],a[52:55],a[228:231],v[188:191]
ds_read_b64_tr_b16 a[16:17],v25 offset:32768
s_waitcnt lgkmcnt(11)
v_mfma_f32_16x16x32_bf16 v[188:191],a[56:59],a[232:235],v[188:191]
ds_read_b64_tr_b16 a[18:19],v25 offset:34816
s_waitcnt lgkmcnt(10)
v_mfma_f32_16x16x32_bf16 v[188:191],a[60:63],a[236:239],v[188:191]
ds_read_b64_tr_b16 a[20:21],v25 offset:36864
v_mfma_f32_16x16x32_bf16 a[220:223],a[48:51],a[240:243],a[220:223]
ds_read_b64_tr_b16 a[22:23],v25 offset:38912
v_mfma_f32_16x16x32_bf16 a[220:223],a[52:55],a[244:247],a[220:223]
ds_read_b64_tr_b16 a[24:25],v25 offset:40960
v_mfma_f32_16x16x32_bf16 a[220:223],a[56:59],a[248:251],a[220:223]
ds_read_b64_tr_b16 a[26:27],v25 offset:43008
v_mfma_f32_16x16x32_bf16 a[220:223],a[60:63],a[252:255],a[220:223]
ds_read_b64_tr_b16 a[28:29],v25 offset:45056
s_waitcnt lgkmcnt(13)
v_mfma_f32_16x16x32_bf16 v[132:135],a[0:3],v[196:199],v[132:135]
ds_read_b64_tr_b16 a[30:31],v25 offset:47104
s_waitcnt lgkmcnt(12)
v_mfma_f32_16x16x32_bf16 v[132:135],a[4:7],v[204:207],v[132:135]
ds_read_b64_tr_b16 a[32:33],v26 offset:32768
s_waitcnt lgkmcnt(11)
v_mfma_f32_16x16x32_bf16 v[132:135],a[8:11],v[212:215],v[132:135]
ds_read_b64_tr_b16 a[34:35],v26 offset:34816
s_waitcnt lgkmcnt(10)
v_mfma_f32_16x16x32_bf16 v[132:135],a[12:15],v[220:223],v[132:135]
ds_read_b64_tr_b16 a[36:37],v26 offset:36864
v_mfma_f32_16x16x32_bf16 a[192:195],a[0:3],v[228:231],a[192:195]
ds_read_b64_tr_b16 a[38:39],v26 offset:38912
v_mfma_f32_16x16x32_bf16 a[192:195],a[4:7],v[236:239],a[192:195]
ds_read_b64_tr_b16 a[40:41],v26 offset:40960
v_mfma_f32_16x16x32_bf16 a[192:195],a[8:11],v[244:247],a[192:195]
ds_read_b64_tr_b16 a[42:43],v26 offset:43008
v_mfma_f32_16x16x32_bf16 a[192:195],a[12:15],v[252:255],a[192:195]
ds_read_b64_tr_b16 a[44:45],v26 offset:45056
s_waitcnt lgkmcnt(13)
v_mfma_f32_16x16x32_bf16 v[140:143],a[16:19],v[196:199],v[140:143]
ds_read_b64_tr_b16 a[46:47],v26 offset:47104
ds_read_b64_tr_b16 a[48:49],v27 offset:32768
buffer_load_dword v33,v32,s[16:19],s44 offen sc1
s_waitcnt lgkmcnt(13)
v_mfma_f32_16x16x32_bf16 v[140:143],a[20:23],v[204:207],v[140:143]
ds_read_b64_tr_b16 a[50:51],v27 offset:34816
s_waitcnt lgkmcnt(12)
v_mfma_f32_16x16x32_bf16 v[140:143],a[24:27],v[212:215],v[140:143]
ds_read_b64_tr_b16 a[52:53],v27 offset:36864
s_waitcnt lgkmcnt(11)
v_mfma_f32_16x16x32_bf16 v[140:143],a[28:31],v[220:223],v[140:143]
ds_read_b64_tr_b16 a[54:55],v27 offset:38912
v_mfma_f32_16x16x32_bf16 a[196:199],a[16:19],v[228:231],a[196:199]
ds_read_b64_tr_b16 a[56:57],v27 offset:40960
v_mfma_f32_16x16x32_bf16 a[196:199],a[20:23],v[236:239],a[196:199]
ds_read_b64_tr_b16 a[58:59],v27 offset:43008
v_mfma_f32_16x16x32_bf16 a[196:199],a[24:27],v[244:247],a[196:199]
ds_read_b64_tr_b16 a[60:61],v27 offset:45056
v_mfma_f32_16x16x32_bf16 a[196:199],a[28:31],v[252:255],a[196:199]
ds_read_b64_tr_b16 a[62:63],v27 offset:47104
s_waitcnt lgkmcnt(14)
v_mfma_f32_16x16x32_bf16 v[148:151],a[32:35],v[196:199],v[148:151]
ds_read_b64_tr_b16 a[0:1],v24 offset:49152
s_waitcnt lgkmcnt(13)
v_mfma_f32_16x16x32_bf16 v[148:151],a[36:39],v[204:207],v[148:151]
ds_read_b64_tr_b16 a[2:3],v24 offset:51200
s_waitcnt lgkmcnt(12)
v_mfma_f32_16x16x32_bf16 v[148:151],a[40:43],v[212:215],v[148:151]
ds_read_b64_tr_b16 a[4:5],v24 offset:53248
s_waitcnt lgkmcnt(11)
v_mfma_f32_16x16x32_bf16 v[148:151],a[44:47],v[220:223],v[148:151]
ds_read_b64_tr_b16 a[6:7],v24 offset:55296
v_mfma_f32_16x16x32_bf16 a[200:203],a[32:35],v[228:231],a[200:203]
ds_read_b64_tr_b16 a[8:9],v24 offset:57344
v_mfma_f32_16x16x32_bf16 a[200:203],a[36:39],v[236:239],a[200:203]
ds_read_b64_tr_b16 a[10:11],v24 offset:59392
v_mfma_f32_16x16x32_bf16 a[200:203],a[40:43],v[244:247],a[200:203]
ds_read_b64_tr_b16 a[12:13],v24 offset:61440
v_mfma_f32_16x16x32_bf16 a[200:203],a[44:47],v[252:255],a[200:203]
ds_read_b64_tr_b16 a[14:15],v24 offset:63488
s_waitcnt lgkmcnt(14)
v_mfma_f32_16x16x32_bf16 v[156:159],a[48:51],v[196:199],v[156:159]
ds_read_b64_tr_b16 a[16:17],v25 offset:49152
s_waitcnt lgkmcnt(13)
v_mfma_f32_16x16x32_bf16 v[156:159],a[52:55],v[204:207],v[156:159]
ds_read_b64_tr_b16 a[18:19],v25 offset:51200
s_waitcnt lgkmcnt(12)
v_mfma_f32_16x16x32_bf16 v[156:159],a[56:59],v[212:215],v[156:159]
ds_read_b64_tr_b16 a[20:21],v25 offset:53248
s_waitcnt lgkmcnt(11)
v_mfma_f32_16x16x32_bf16 v[156:159],a[60:63],v[220:223],v[156:159]
ds_read_b64_tr_b16 a[22:23],v25 offset:55296
v_mfma_f32_16x16x32_bf16 a[204:207],a[48:51],v[228:231],a[204:207]
ds_read_b64_tr_b16 a[24:25],v25 offset:57344
v_mfma_f32_16x16x32_bf16 a[204:207],a[52:55],v[236:239],a[204:207]
ds_read_b64_tr_b16 a[26:27],v25 offset:59392
v_mfma_f32_16x16x32_bf16 a[204:207],a[56:59],v[244:247],a[204:207]
ds_read_b64_tr_b16 a[28:29],v25 offset:61440
v_mfma_f32_16x16x32_bf16 a[204:207],a[60:63],v[252:255],a[204:207]
ds_read_b64_tr_b16 a[30:31],v25 offset:63488
s_waitcnt lgkmcnt(14)
v_mfma_f32_16x16x32_bf16 v[164:167],a[0:3],v[196:199],v[164:167]
ds_read_b64_tr_b16 a[32:33],v26 offset:49152
s_waitcnt lgkmcnt(13)
v_mfma_f32_16x16x32_bf16 v[164:167],a[4:7],v[204:207],v[164:167]
ds_read_b64_tr_b16 a[34:35],v26 offset:51200
s_waitcnt lgkmcnt(12)
v_mfma_f32_16x16x32_bf16 v[164:167],a[8:11],v[212:215],v[164:167]
ds_read_b64_tr_b16 a[36:37],v26 offset:53248
s_waitcnt lgkmcnt(11)
v_mfma_f32_16x16x32_bf16 v[164:167],a[12:15],v[220:223],v[164:167]
ds_read_b64_tr_b16 a[38:39],v26 offset:55296
v_mfma_f32_16x16x32_bf16 a[208:211],a[0:3],v[228:231],a[208:211]
ds_read_b64_tr_b16 a[40:41],v26 offset:57344
v_mfma_f32_16x16x32_bf16 a[208:211],a[4:7],v[236:239],a[208:211]
ds_read_b64_tr_b16 a[42:43],v26 offset:59392
v_mfma_f32_16x16x32_bf16 a[208:211],a[8:11],v[244:247],a[208:211]
ds_read_b64_tr_b16 a[44:45],v26 offset:61440
v_mfma_f32_16x16x32_bf16 a[208:211],a[12:15],v[252:255],a[208:211]
ds_read_b64_tr_b16 a[46:47],v26 offset:63488
s_waitcnt lgkmcnt(14)
v_mfma_f32_16x16x32_bf16 v[172:175],a[16:19],v[196:199],v[172:175]
ds_read_b64_tr_b16 a[48:49],v27 offset:49152
s_waitcnt lgkmcnt(13)
v_mfma_f32_16x16x32_bf16 v[172:175],a[20:23],v[204:207],v[172:175]
ds_read_b64_tr_b16 a[50:51],v27 offset:51200
s_waitcnt lgkmcnt(12)
v_mfma_f32_16x16x32_bf16 v[172:175],a[24:27],v[212:215],v[172:175]
ds_read_b64_tr_b16 a[52:53],v27 offset:53248
s_waitcnt lgkmcnt(11)
v_mfma_f32_16x16x32_bf16 v[172:175],a[28:31],v[220:223],v[172:175]
ds_read_b64_tr_b16 a[54:55],v27 offset:55296
v_mfma_f32_16x16x32_bf16 a[212:215],a[16:19],v[228:231],a[212:215]
ds_read_b64_tr_b16 a[56:57],v27 offset:57344
v_mfma_f32_16x16x32_bf16 a[212:215],a[20:23],v[236:239],a[212:215]
ds_read_b64_tr_b16 a[58:59],v27 offset:59392
v_mfma_f32_16x16x32_bf16 a[212:215],a[24:27],v[244:247],a[212:215]
ds_read_b64_tr_b16 a[60:61],v27 offset:61440
v_mfma_f32_16x16x32_bf16 a[212:215],a[28:31],v[252:255],a[212:215]
ds_read_b64_tr_b16 a[62:63],v27 offset:63488
s_waitcnt lgkmcnt(14)
v_mfma_f32_16x16x32_bf16 v[180:183],a[32:35],v[196:199],v[180:183]
s_waitcnt vmcnt(0)
v_cmp_gt_u32 vcc,4,v33
s_nop 0
s_cbranch_vccnz F_Y4_S
F_Y4_R:
v_cmp_gt_u32 vcc,2,v37
s_nop 0
s_cbranch_vccnz F_YV_S
F_YV_R:
s_mov_b32 m0,s74
s_waitcnt lgkmcnt(12)
v_mfma_f32_16x16x32_bf16 v[180:183],a[36:39],v[204:207],v[180:183]
ds_read_b64_tr_b16 a[0:1],v24 offset:0
s_waitcnt lgkmcnt(11)
v_mfma_f32_16x16x32_bf16 v[180:183],a[40:43],v[212:215],v[180:183]
ds_read_b64_tr_b16 a[2:3],v24 offset:2048
buffer_load_dwordx4 a[64:67],v1,s[16:19],s32 offen offset:0 sc1
s_waitcnt lgkmcnt(10)
v_mfma_f32_16x16x32_bf16 v[180:183],a[44:47],v[220:223],v[180:183]
ds_read_b64_tr_b16 a[4:5],v24 offset:4096
v_mfma_f32_16x16x32_bf16 a[216:219],a[32:35],v[228:231],a[216:219]
ds_read_b64_tr_b16 a[6:7],v24 offset:6144
v_mfma_f32_16x16x32_bf16 a[216:219],a[36:39],v[236:239],a[216:219]
ds_read_b64_tr_b16 a[8:9],v24 offset:8192
buffer_load_dwordx4 a[68:71],v1,s[16:19],s32 offen offset:1024 sc1
v_mfma_f32_16x16x32_bf16 a[216:219],a[40:43],v[244:247],a[216:219]
ds_read_b64_tr_b16 a[10:11],v24 offset:10240
v_mfma_f32_16x16x32_bf16 a[216:219],a[44:47],v[252:255],a[216:219]
ds_read_b64_tr_b16 a[12:13],v24 offset:12288
s_waitcnt lgkmcnt(13)
v_mfma_f32_16x16x32_bf16 v[188:191],a[48:51],v[196:199],v[188:191]
ds_read_b64_tr_b16 a[14:15],v24 offset:14336
buffer_load_dwordx4 a[72:75],v1,s[16:19],s32 offen offset:2048 sc1
s_waitcnt lgkmcnt(12)
v_mfma_f32_16x16x32_bf16 v[188:191],a[52:55],v[204:207],v[188:191]
ds_read_b64_tr_b16 a[16:17],v25 offset:0
s_waitcnt lgkmcnt(11)
v_mfma_f32_16x16x32_bf16 v[188:191],a[56:59],v[212:215],v[188:191]
ds_read_b64_tr_b16 a[18:19],v25 offset:2048
s_waitcnt lgkmcnt(10)
v_mfma_f32_16x16x32_bf16 v[188:191],a[60:63],v[220:223],v[188:191]
ds_read_b64_tr_b16 a[20:21],v25 offset:4096
buffer_load_dwordx4 a[76:79],v1,s[16:19],s32 offen offset:3072 sc1
v_mfma_f32_16x16x32_bf16 a[220:223],a[48:51],v[228:231],a[220:223]
ds_read_b64_tr_b16 a[22:23],v25 offset:6144
v_mfma_f32_16x16x32_bf16 a[220:223],a[52:55],v[236:239],a[220:223]
ds_read_b64_tr_b16 a[24:25],v25 offset:8192
v_mfma_f32_16x16x32_bf16 a[220:223],a[56:59],v[244:247],a[220:223]
ds_read_b64_tr_b16 a[26:27],v25 offset:10240
buffer_load_dwordx4 a[80:83],v1,s[16:19],s35 offen offset:0 sc1
v_mfma_f32_16x16x32_bf16 a[220:223],a[60:63],v[252:255],a[220:223]
ds_read_b64_tr_b16 a[28:29],v25 offset:12288
s_waitcnt lgkmcnt(13)
v_mfma_f32_16x16x32_bf16 v[132:135],a[0:3],a[160:163],v[132:135]
ds_read_b64_tr_b16 a[30:31],v25 offset:14336
s_waitcnt lgkmcnt(12)
v_mfma_f32_16x16x32_bf16 v[132:135],a[4:7],a[164:167],v[132:135]
ds_read_b64_tr_b16 a[32:33],v26 offset:0
buffer_load_dwordx4 a[84:87],v1,s[16:19],s35 offen offset:1024 sc1
s_waitcnt lgkmcnt(11)
v_mfma_f32_16x16x32_bf16 v[132:135],a[8:11],a[168:171],v[132:135]
ds_read_b64_tr_b16 a[34:35],v26 offset:2048
s_waitcnt lgkmcnt(10)
v_mfma_f32_16x16x32_bf16 v[132:135],a[12:15],a[172:175],v[132:135]
ds_read_b64_tr_b16 a[36:37],v26 offset:4096
v_mfma_f32_16x16x32_bf16 a[192:195],a[0:3],a[176:179],a[192:195]
ds_read_b64_tr_b16 a[38:39],v26 offset:6144
buffer_load_dwordx4 a[88:91],v1,s[16:19],s35 offen offset:2048 sc1
v_mfma_f32_16x16x32_bf16 a[192:195],a[4:7],a[180:183],a[192:195]
ds_read_b64_tr_b16 a[40:41],v26 offset:8192
v_mfma_f32_16x16x32_bf16 a[192:195],a[8:11],a[184:187],a[192:195]
ds_read_b64_tr_b16 a[42:43],v26 offset:10240
v_mfma_f32_16x16x32_bf16 a[192:195],a[12:15],a[188:191],a[192:195]
ds_read_b64_tr_b16 a[44:45],v26 offset:12288
buffer_load_dwordx4 a[92:95],v1,s[16:19],s35 offen offset:3072 sc1
s_waitcnt lgkmcnt(13)
v_mfma_f32_16x16x32_bf16 v[140:143],a[16:19],a[160:163],v[140:143]
ds_read_b64_tr_b16 a[46:47],v26 offset:14336
s_waitcnt lgkmcnt(12)
v_mfma_f32_16x16x32_bf16 v[140:143],a[20:23],a[164:167],v[140:143]
ds_read_b64_tr_b16 a[48:49],v27 offset:0
s_waitcnt lgkmcnt(11)
v_mfma_f32_16x16x32_bf16 v[140:143],a[24:27],a[168:171],v[140:143]
ds_read_b64_tr_b16 a[50:51],v27 offset:2048
buffer_load_dwordx4 a[96:99],v1,s[16:19],s33 offen offset:0 sc1
s_waitcnt lgkmcnt(10)
v_mfma_f32_16x16x32_bf16 v[140:143],a[28:31],a[172:175],v[140:143]
ds_read_b64_tr_b16 a[52:53],v27 offset:4096
v_mfma_f32_16x16x32_bf16 a[196:199],a[16:19],a[176:179],a[196:199]
ds_read_b64_tr_b16 a[54:55],v27 offset:6144
v_mfma_f32_16x16x32_bf16 a[196:199],a[20:23],a[180:183],a[196:199]
ds_read_b64_tr_b16 a[56:57],v27 offset:8192
buffer_load_dwordx4 a[100:103],v1,s[16:19],s33 offen offset:1024 sc1
v_mfma_f32_16x16x32_bf16 a[196:199],a[24:27],a[184:187],a[196:199]
ds_read_b64_tr_b16 a[58:59],v27 offset:10240
v_mfma_f32_16x16x32_bf16 a[196:199],a[28:31],a[188:191],a[196:199]
ds_read_b64_tr_b16 a[60:61],v27 offset:12288
s_waitcnt lgkmcnt(13)
v_mfma_f32_16x16x32_bf16 v[148:151],a[32:35],a[160:163],v[148:151]
ds_read_b64_tr_b16 a[62:63],v27 offset:14336
buffer_load_dwordx4 a[104:107],v1,s[16:19],s33 offen offset:2048 sc1
s_waitcnt lgkmcnt(12)
v_mfma_f32_16x16x32_bf16 v[148:151],a[36:39],a[164:167],v[148:151]
ds_read_b64_tr_b16 a[0:1],v24 offset:16384
s_waitcnt lgkmcnt(11)
v_mfma_f32_16x16x32_bf16 v[148:151],a[40:43],a[168:171],v[148:151]
ds_read_b64_tr_b16 a[2:3],v24 offset:18432
s_waitcnt lgkmcnt(10)
v_mfma_f32_16x16x32_bf16 v[148:151],a[44:47],a[172:175],v[148:151]
ds_read_b64_tr_b16 a[4:5],v24 offset:20480
buffer_load_dwordx4 a[108:111],v1,s[16:19],s33 offen offset:3072 sc1
v_mfma_f32_16x16x32_bf16 a[200:203],a[32:35],a[176:179],a[200:203]
ds_read_b64_tr_b16 a[6:7],v24 offset:22528
v_mfma_f32_16x16x32_bf16 a[200:203],a[36:39],a[180:183],a[200:203]
ds_read_b64_tr_b16 a[8:9],v24 offset:24576
v_mfma_f32_16x16x32_bf16 a[200:203],a[40:43],a[184:187],a[200:203]
ds_read_b64_tr_b16 a[10:11],v24 offset:26624
buffer_load_dwordx4 a[112:115],v1,s[16:19],s36 offen offset:0 sc1
v_mfma_f32_16x16x32_bf16 a[200:203],a[44:47],a[188:191],a[200:203]
ds_read_b64_tr_b16 a[12:13],v24 offset:28672
s_waitcnt lgkmcnt(13)
v_mfma_f32_16x16x32_bf16 v[156:159],a[48:51],a[160:163],v[156:159]
ds_read_b64_tr_b16 a[14:15],v24 offset:30720
s_waitcnt lgkmcnt(12)
v_mfma_f32_16x16x32_bf16 v[156:159],a[52:55],a[164:167],v[156:159]
ds_read_b64_tr_b16 a[16:17],v25 offset:16384
buffer_load_dwordx4 a[116:119],v1,s[16:19],s36 offen offset:1024 sc1
s_waitcnt lgkmcnt(11)
v_mfma_f32_16x16x32_bf16 v[156:159],a[56:59],a[168:171],v[156:159]
ds_read_b64_tr_b16 a[18:19],v25 offset:18432
s_waitcnt lgkmcnt(10)
v_mfma_f32_16x16x32_bf16 v[156:159],a[60:63],a[172:175],v[156:159]
ds_read_b64_tr_b16 a[20:21],v25 offset:20480
v_mfma_f32_16x16x32_bf16 a[204:207],a[48:51],a[176:179],a[204:207]
ds_read_b64_tr_b16 a[22:23],v25 offset:22528
buffer_load_dwordx4 a[120:123],v1,s[16:19],s36 offen offset:2048 sc1
v_mfma_f32_16x16x32_bf16 a[204:207],a[52:55],a[180:183],a[204:207]
ds_read_b64_tr_b16 a[24:25],v25 offset:24576
v_mfma_f32_16x16x32_bf16 a[204:207],a[56:59],a[184:187],a[204:207]
ds_read_b64_tr_b16 a[26:27],v25 offset:26624
v_mfma_f32_16x16x32_bf16 a[204:207],a[60:63],a[188:191],a[204:207]
ds_read_b64_tr_b16 a[28:29],v25 offset:28672
buffer_load_dwordx4 a[124:127],v1,s[16:19],s36 offen offset:3072 sc1
s_waitcnt lgkmcnt(13)
v_mfma_f32_16x16x32_bf16 v[164:167],a[0:3],a[160:163],v[164:167]
ds_read_b64_tr_b16 a[30:31],v25 offset:30720
s_waitcnt lgkmcnt(12)
v_mfma_f32_16x16x32_bf16 v[164:167],a[4:7],a[164:167],v[164:167]
ds_read_b64_tr_b16 a[32:33],v26 offset:16384
s_waitcnt lgkmcnt(11)
v_mfma_f32_16x16x32_bf16 v[164:167],a[8:11],a[168:171],v[164:167]
ds_read_b64_tr_b16 a[34:35],v26 offset:18432
buffer_load_dwordx4 a[128:131],v1,s[16:19],s34 offen offset:0 sc1
s_waitcnt lgkmcnt(10)
v_mfma_f32_16x16x32_bf16 v[164:167],a[12:15],a[172:175],v[164:167]
ds_read_b64_tr_b16 a[36:37],v26 offset:20480
v_mfma_f32_16x16x32_bf16 a[208:211],a[0:3],a[176:179],a[208:211]
ds_read_b64_tr_b16 a[38:39],v26 offset:22528
v_mfma_f32_16x16x32_bf16 a[208:211],a[4:7],a[180:183],a[208:211]
ds_read_b64_tr_b16 a[40:41],v26 offset:24576
buffer_load_dwordx4 a[132:135],v1,s[16:19],s34 offen offset:1024 sc1
v_mfma_f32_16x16x32_bf16 a[208:211],a[8:11],a[184:187],a[208:211]
ds_read_b64_tr_b16 a[42:43],v26 offset:26624
v_mfma_f32_16x16x32_bf16 a[208:211],a[12:15],a[188:191],a[208:211]
ds_read_b64_tr_b16 a[44:45],v26 offset:28672
s_waitcnt lgkmcnt(13)
v_mfma_f32_16x16x32_bf16 v[172:175],a[16:19],a[160:163],v[172:175]
ds_read_b64_tr_b16 a[46:47],v26 offset:30720
buffer_load_dwordx4 a[136:139],v1,s[16:19],s34 offen offset:2048 sc1
s_waitcnt lgkmcnt(12)
v_mfma_f32_16x16x32_bf16 v[172:175],a[20:23],a[164:167],v[172:175]
ds_read_b64_tr_b16 a[48:49],v27 offset:16384
s_waitcnt lgkmcnt(11)
v_mfma_f32_16x16x32_bf16 v[172:175],a[24:27],a[168:171],v[172:175]
ds_read_b64_tr_b16 a[50:51],v27 offset:18432
s_waitcnt lgkmcnt(10)
v_mfma_f32_16x16x32_bf16 v[172:175],a[28:31],a[172:175],v[172:175]
ds_read_b64_tr_b16 a[52:53],v27 offset:20480
buffer_load_dwordx4 a[140:143],v1,s[16:19],s34 offen offset:3072 sc1
v_mfma_f32_16x16x32_bf16 a[212:215],a[16:19],a[176:179],a[212:215]
ds_read_b64_tr_b16 a[54:55],v27 offset:22528
v_mfma_f32_16x16x32_bf16 a[212:215],a[20:23],a[180:183],a[212:215]
ds_read_b64_tr_b16 a[56:57],v27 offset:24576
v_mfma_f32_16x16x32_bf16 a[212:215],a[24:27],a[184:187],a[212:215]
ds_read_b64_tr_b16 a[58:59],v27 offset:26624
buffer_load_dwordx4 a[144:147],v1,s[16:19],s37 offen offset:0 sc1
v_mfma_f32_16x16x32_bf16 a[212:215],a[28:31],a[188:191],a[212:215]
ds_read_b64_tr_b16 a[60:61],v27 offset:28672
s_waitcnt lgkmcnt(13)
v_mfma_f32_16x16x32_bf16 v[180:183],a[32:35],a[160:163],v[180:183]
ds_read_b64_tr_b16 a[62:63],v27 offset:30720
s_waitcnt lgkmcnt(12)
v_mfma_f32_16x16x32_bf16 v[180:183],a[36:39],a[164:167],v[180:183]
ds_read_b64_tr_b16 a[0:1],v24 offset:32768
buffer_load_dwordx4 a[148:151],v1,s[16:19],s37 offen offset:1024 sc1
s_waitcnt lgkmcnt(11)
v_mfma_f32_16x16x32_bf16 v[180:183],a[40:43],a[168:171],v[180:183]
ds_read_b64_tr_b16 a[2:3],v24 offset:34816
s_waitcnt lgkmcnt(10)
v_mfma_f32_16x16x32_bf16 v[180:183],a[44:47],a[172:175],v[180:183]
ds_read_b64_tr_b16 a[4:5],v24 offset:36864
v_mfma_f32_16x16x32_bf16 a[216:219],a[32:35],a[176:179],a[216:219]
ds_read_b64_tr_b16 a[6:7],v24 offset:38912
buffer_load_dwordx4 a[152:155],v1,s[16:19],s37 offen offset:2048 sc1
v_mfma_f32_16x16x32_bf16 a[216:219],a[36:39],a[180:183],a[216:219]
ds_read_b64_tr_b16 a[8:9],v24 offset:40960
v_mfma_f32_16x16x32_bf16 a[216:219],a[40:43],a[184:187],a[216:219]
ds_read_b64_tr_b16 a[10:11],v24 offset:43008
v_mfma_f32_16x16x32_bf16 a[216:219],a[44:47],a[188:191],a[216:219]
ds_read_b64_tr_b16 a[12:13],v24 offset:45056
buffer_load_dwordx4 a[156:159],v1,s[16:19],s37 offen offset:3072 sc1
s_waitcnt lgkmcnt(13)
v_mfma_f32_16x16x32_bf16 v[188:191],a[48:51],a[160:163],v[188:191]
ds_read_b64_tr_b16 a[14:15],v24 offset:47104
s_waitcnt lgkmcnt(12)
v_mfma_f32_16x16x32_bf16 v[188:191],a[52:55],a[164:167],v[188:191]
ds_read_b64_tr_b16 a[16:17],v25 offset:32768
v_cvt_pk_bf16_f32 v132,v132,v133
s_waitcnt lgkmcnt(11)
v_mfma_f32_16x16x32_bf16 v[188:191],a[56:59],a[168:171],v[188:191]
ds_read_b64_tr_b16 a[18:19],v25 offset:34816
v_cvt_pk_bf16_f32 v133,v134,v135
s_waitcnt lgkmcnt(10)
v_mfma_f32_16x16x32_bf16 v[188:191],a[60:63],a[172:175],v[188:191]
ds_read_b64_tr_b16 a[20:21],v25 offset:36864
buffer_load_dwordx4 v14,s[16:19],s72 offen offset:0 sc1 lds
v_mfma_f32_16x16x32_bf16 a[220:223],a[48:51],a[176:179],a[220:223]
ds_read_b64_tr_b16 a[22:23],v25 offset:38912
buffer_load_dwordx4 v14,s[16:19],s73 offen offset:1024 sc1 lds
v_mfma_f32_16x16x32_bf16 a[220:223],a[52:55],a[180:183],a[220:223]
ds_read_b64_tr_b16 a[24:25],v25 offset:40960
v_cvt_pk_bf16_f32 v134,v140,v141
v_mfma_f32_16x16x32_bf16 a[220:223],a[56:59],a[184:187],a[220:223]
ds_read_b64_tr_b16 a[26:27],v25 offset:43008
v_cvt_pk_bf16_f32 v135,v142,v143
v_mfma_f32_16x16x32_bf16 a[220:223],a[60:63],a[188:191],a[220:223]
ds_read_b64_tr_b16 a[28:29],v25 offset:45056
s_add_u32 s28,s48,0
s_waitcnt vmcnt(25)
s_waitcnt lgkmcnt(13)
v_mfma_f32_16x16x32_bf16 v[64:67],a[0:3],a[64:67],v[64:67]
buffer_store_dwordx4 v[132:135],v1,s[16:19],s28 offen sc1
s_waitcnt vmcnt(25)
s_waitcnt lgkmcnt(11)
v_mfma_f32_16x16x32_bf16 v[64:67],a[4:7],a[68:71],v[64:67]
ds_read_b64_tr_b16 a[30:31],v25 offset:47104
v_accvgpr_read_b32 v192,a192
s_waitcnt vmcnt(24)
s_waitcnt lgkmcnt(10)
v_mfma_f32_16x16x32_bf16 v[64:67],a[8:11],a[72:75],v[64:67]
ds_read_b64_tr_b16 a[32:33],v26 offset:32768
v_accvgpr_read_b32 v193,a193
s_waitcnt vmcnt(23)
s_waitcnt lgkmcnt(9)
v_mfma_f32_16x16x32_bf16 v[64:67],a[12:15],a[76:79],v[64:67]
ds_read_b64_tr_b16 a[34:35],v26 offset:34816
v_accvgpr_read_b32 v194,a194
s_waitcnt vmcnt(22)
v_mfma_f32_16x16x32_bf16 v[96:99],a[0:3],a[80:83],v[96:99]
ds_read_b64_tr_b16 a[36:37],v26 offset:36864
v_accvgpr_read_b32 v195,a195
s_waitcnt vmcnt(21)
v_mfma_f32_16x16x32_bf16 v[96:99],a[4:7],a[84:87],v[96:99]
ds_read_b64_tr_b16 a[38:39],v26 offset:38912
v_accvgpr_read_b32 v196,a196
s_waitcnt vmcnt(20)
v_mfma_f32_16x16x32_bf16 v[96:99],a[8:11],a[88:91],v[96:99]
ds_read_b64_tr_b16 a[40:41],v26 offset:40960
v_accvgpr_read_b32 v197,a197
s_waitcnt vmcnt(19)
v_mfma_f32_16x16x32_bf16 v[96:99],a[12:15],a[92:95],v[96:99]
ds_read_b64_tr_b16 a[42:43],v26 offset:43008
v_accvgpr_read_b32 v198,a198
s_waitcnt lgkmcnt(12)
v_mfma_f32_16x16x32_bf16 v[68:71],a[16:19],a[64:67],v[68:71]
ds_read_b64_tr_b16 a[44:45],v26 offset:45056
v_accvgpr_read_b32 v199,a199
s_waitcnt lgkmcnt(11)
v_mfma_f32_16x16x32_bf16 v[68:71],a[20:23],a[68:71],v[68:71]
ds_read_b64_tr_b16 a[46:47],v26 offset:47104
v_cvt_pk_bf16_f32 v192,v192,v193
s_waitcnt lgkmcnt(10)
v_mfma_f32_16x16x32_bf16 v[68:71],a[24:27],a[72:75],v[68:71]
ds_read_b64_tr_b16 a[48:49],v27 offset:32768
v_cvt_pk_bf16_f32 v193,v194,v195
s_waitcnt lgkmcnt(9)
v_mfma_f32_16x16x32_bf16 v[68:71],a[28:31],a[76:79],v[68:71]
ds_read_b64_tr_b16 a[50:51],v27 offset:34816
v_cvt_pk_bf16_f32 v194,v196,v197
v_cvt_pk_bf16_f32 v195,v198,v199
s_add_u32 s28,s49,0
buffer_store_dwordx4 v[192:195],v1,s[16:19],s28 offen sc1
v_mfma_f32_16x16x32_bf16 v[100:103],a[16:19],a[80:83],v[100:103]
ds_read_b64_tr_b16 a[52:53],v27 offset:36864
v_cvt_pk_bf16_f32 v148,v148,v149
v_mfma_f32_16x16x32_bf16 v[100:103],a[20:23],a[84:87],v[100:103]
ds_read_b64_tr_b16 a[54:55],v27 offset:38912
v_cvt_pk_bf16_f32 v149,v150,v151
v_mfma_f32_16x16x32_bf16 v[100:103],a[24:27],a[88:91],v[100:103]
ds_read_b64_tr_b16 a[56:57],v27 offset:40960
v_cvt_pk_bf16_f32 v150,v156,v157
v_mfma_f32_16x16x32_bf16 v[100:103],a[28:31],a[92:95],v[100:103]
ds_read_b64_tr_b16 a[58:59],v27 offset:43008
v_cvt_pk_bf16_f32 v151,v158,v159
s_add_u32 s28,s48,8192
buffer_store_dwordx4 v[148:151],v1,s[16:19],s28 offen sc1
s_waitcnt lgkmcnt(12)
v_mfma_f32_16x16x32_bf16 v[72:75],a[32:35],a[64:67],v[72:75]
ds_read_b64_tr_b16 a[60:61],v27 offset:45056
v_accvgpr_read_b32 v200,a200
s_waitcnt lgkmcnt(11)
v_mfma_f32_16x16x32_bf16 v[72:75],a[36:39],a[68:71],v[72:75]
ds_read_b64_tr_b16 a[62:63],v27 offset:47104
v_accvgpr_read_b32 v201,a201
s_waitcnt lgkmcnt(10)
v_mfma_f32_16x16x32_bf16 v[72:75],a[40:43],a[72:75],v[72:75]
ds_read_b64_tr_b16 a[0:1],v24 offset:49152
v_accvgpr_read_b32 v202,a202
s_waitcnt lgkmcnt(9)
v_mfma_f32_16x16x32_bf16 v[72:75],a[44:47],a[76:79],v[72:75]
ds_read_b64_tr_b16 a[2:3],v24 offset:51200
v_accvgpr_read_b32 v203,a203
v_accvgpr_read_b32 v204,a204
v_accvgpr_read_b32 v205,a205
v_accvgpr_read_b32 v206,a206
v_accvgpr_read_b32 v207,a207
v_cvt_pk_bf16_f32 v200,v200,v201
v_cvt_pk_bf16_f32 v201,v202,v203
v_cvt_pk_bf16_f32 v202,v204,v205
v_cvt_pk_bf16_f32 v203,v206,v207
s_add_u32 s28,s49,8192
buffer_store_dwordx4 v[200:203],v1,s[16:19],s28 offen sc1
v_mfma_f32_16x16x32_bf16 v[104:107],a[32:35],a[80:83],v[104:107]
ds_read_b64_tr_b16 a[4:5],v24 offset:53248
v_cvt_pk_bf16_f32 v164,v164,v165
v_mfma_f32_16x16x32_bf16 v[104:107],a[36:39],a[84:87],v[104:107]
ds_read_b64_tr_b16 a[6:7],v24 offset:55296
v_cvt_pk_bf16_f32 v165,v166,v167
v_mfma_f32_16x16x32_bf16 v[104:107],a[40:43],a[88:91],v[104:107]
ds_read_b64_tr_b16 a[8:9],v24 offset:57344
v_cvt_pk_bf16_f32 v166,v172,v173
v_mfma_f32_16x16x32_bf16 v[104:107],a[44:47],a[92:95],v[104:107]
ds_read_b64_tr_b16 a[10:11],v24 offset:59392
v_cvt_pk_bf16_f32 v167,v174,v175
s_add_u32 s28,s48,16384
buffer_store_dwordx4 v[164:167],v1,s[16:19],s28 offen sc1
s_waitcnt lgkmcnt(12)
v_mfma_f32_16x16x32_bf16 v[76:79],a[48:51],a[64:67],v[76:79]
ds_read_b64_tr_b16 a[12:13],v24 offset:61440
v_accvgpr_read_b32 v208,a208
s_waitcnt lgkmcnt(11)
v_mfma_f32_16x16x32_bf16 v[76:79],a[52:55],a[68:71],v[76:79]
ds_read_b64_tr_b16 a[14:15],v24 offset:63488
v_accvgpr_read_b32 v209,a209
s_waitcnt lgkmcnt(10)
v_mfma_f32_16x16x32_bf16 v[76:79],a[56:59],a[72:75],v[76:79]
ds_read_b64_tr_b16 a[16:17],v25 offset:49152
v_accvgpr_read_b32 v210,a210
s_waitcnt lgkmcnt(9)
v_mfma_f32_16x16x32_bf16 v[76:79],a[60:63],a[76:79],v[76:79]
ds_read_b64_tr_b16 a[18:19],v25 offset:51200
v_accvgpr_read_b32 v211,a211
v_accvgpr_read_b32 v212,a212
v_accvgpr_read_b32 v213,a213
v_accvgpr_read_b32 v214,a214
v_accvgpr_read_b32 v215,a215
v_cvt_pk_bf16_f32 v208,v208,v209
v_cvt_pk_bf16_f32 v209,v210,v211
v_cvt_pk_bf16_f32 v210,v212,v213
v_cvt_pk_bf16_f32 v211,v214,v215
s_add_u32 s28,s49,16384
buffer_store_dwordx4 v[208:211],v1,s[16:19],s28 offen sc1
v_mfma_f32_16x16x32_bf16 v[108:111],a[48:51],a[80:83],v[108:111]
ds_read_b64_tr_b16 a[20:21],v25 offset:53248
v_cvt_pk_bf16_f32 v180,v180,v181
v_mfma_f32_16x16x32_bf16 v[108:111],a[52:55],a[84:87],v[108:111]
ds_read_b64_tr_b16 a[22:23],v25 offset:55296
v_cvt_pk_bf16_f32 v181,v182,v183
v_mfma_f32_16x16x32_bf16 v[108:111],a[56:59],a[88:91],v[108:111]
ds_read_b64_tr_b16 a[24:25],v25 offset:57344
v_cvt_pk_bf16_f32 v182,v188,v189
v_mfma_f32_16x16x32_bf16 v[108:111],a[60:63],a[92:95],v[108:111]
ds_read_b64_tr_b16 a[26:27],v25 offset:59392
v_cvt_pk_bf16_f32 v183,v190,v191
s_add_u32 s28,s48,24576
buffer_store_dwordx4 v[180:183],v1,s[16:19],s28 offen sc1
s_waitcnt lgkmcnt(12)
v_mfma_f32_16x16x32_bf16 v[80:83],a[0:3],a[64:67],v[80:83]
ds_read_b64_tr_b16 a[28:29],v25 offset:61440
v_accvgpr_read_b32 v216,a216
s_waitcnt lgkmcnt(11)
v_mfma_f32_16x16x32_bf16 v[80:83],a[4:7],a[68:71],v[80:83]
ds_read_b64_tr_b16 a[30:31],v25 offset:63488
v_accvgpr_read_b32 v217,a217
s_waitcnt lgkmcnt(10)
v_mfma_f32_16x16x32_bf16 v[80:83],a[8:11],a[72:75],v[80:83]
ds_read_b64_tr_b16 a[32:33],v26 offset:49152
v_accvgpr_read_b32 v218,a218
s_waitcnt lgkmcnt(9)
v_mfma_f32_16x16x32_bf16 v[80:83],a[12:15],a[76:79],v[80:83]
ds_read_b64_tr_b16 a[34:35],v26 offset:51200
v_accvgpr_read_b32 v219,a219
v_accvgpr_read_b32 v220,a220
v_accvgpr_read_b32 v221,a221
v_accvgpr_read_b32 v222,a222
v_accvgpr_read_b32 v223,a223
v_cvt_pk_bf16_f32 v216,v216,v217
v_cvt_pk_bf16_f32 v217,v218,v219
v_cvt_pk_bf16_f32 v218,v220,v221
v_cvt_pk_bf16_f32 v219,v222,v223
s_add_u32 s28,s49,24576
buffer_store_dwordx4 v[216:219],v1,s[16:19],s28 offen sc1
v_mfma_f32_16x16x32_bf16 v[112:115],a[0:3],a[80:83],v[112:115]
ds_read_b64_tr_b16 a[36:37],v26 offset:53248
v_lshrrev_b32 v38,3,v7
v_mfma_f32_16x16x32_bf16 v[112:115],a[4:7],a[84:87],v[112:115]
ds_read_b64_tr_b16 a[38:39],v26 offset:55296
v_lshlrev_b32 v38,12,v38
v_mfma_f32_16x16x32_bf16 v[112:115],a[8:11],a[88:91],v[112:115]
ds_read_b64_tr_b16 a[40:41],v26 offset:57344
s_and_b32 s29,s2,7
v_mfma_f32_16x16x32_bf16 v[112:115],a[12:15],a[92:95],v[112:115]
ds_read_b64_tr_b16 a[42:43],v26 offset:59392
s_lshl_b32 s30,s22,3
s_waitcnt lgkmcnt(12)
v_mfma_f32_16x16x32_bf16 v[84:87],a[16:19],a[64:67],v[84:87]
ds_read_b64_tr_b16 a[44:45],v26 offset:61440
s_add_u32 s41,s30,s29
s_waitcnt lgkmcnt(11)
v_mfma_f32_16x16x32_bf16 v[84:87],a[20:23],a[68:71],v[84:87]
ds_read_b64_tr_b16 a[46:47],v26 offset:63488
s_sub_u32 s42,120,s30
s_waitcnt lgkmcnt(10)
v_mfma_f32_16x16x32_bf16 v[84:87],a[24:27],a[72:75],v[84:87]
ds_read_b64_tr_b16 a[48:49],v27 offset:49152
s_add_u32 s42,s42,s29
s_waitcnt lgkmcnt(9)
v_mfma_f32_16x16x32_bf16 v[84:87],a[28:31],a[76:79],v[84:87]
ds_read_b64_tr_b16 a[50:51],v27 offset:51200
s_and_b32 s30,s99,0xfffe0fff
v_mfma_f32_16x16x32_bf16 v[116:119],a[16:19],a[80:83],v[116:119]
ds_read_b64_tr_b16 a[52:53],v27 offset:53248
s_and_b32 s31,s29,3
v_mfma_f32_16x16x32_bf16 v[116:119],a[20:23],a[84:87],v[116:119]
ds_read_b64_tr_b16 a[54:55],v27 offset:55296
s_lshl_b32 s31,s31,15
v_mfma_f32_16x16x32_bf16 v[116:119],a[24:27],a[88:91],v[116:119]
ds_read_b64_tr_b16 a[56:57],v27 offset:57344
s_add_u32 s38,s30,s31
v_mfma_f32_16x16x32_bf16 v[116:119],a[28:31],a[92:95],v[116:119]
ds_read_b64_tr_b16 a[58:59],v27 offset:59392
s_lshl_b32 s29,s29,2
s_waitcnt lgkmcnt(12)
v_mfma_f32_16x16x32_bf16 v[88:91],a[32:35],a[64:67],v[88:91]
ds_read_b64_tr_b16 a[60:61],v27 offset:61440
s_lshr_b32 s31,0x20313120,s29
s_waitcnt lgkmcnt(11)
v_mfma_f32_16x16x32_bf16 v[88:91],a[36:39],a[68:71],v[88:91]
ds_read_b64_tr_b16 a[62:63],v27 offset:63488
s_and_b32 s31,s31,3
s_waitcnt lgkmcnt(10)
v_mfma_f32_16x16x32_bf16 v[88:91],a[40:43],a[72:75],v[88:91]
ds_read_b64_tr_b16 a[0:1],v28 offset:0
s_lshl_b32 s31,s31,15
s_waitcnt lgkmcnt(9)
v_mfma_f32_16x16x32_bf16 v[88:91],a[44:47],a[76:79],v[88:91]
ds_read_b64_tr_b16 a[2:3],v28 offset:2048
s_add_u32 s39,s30,s31
v_mfma_f32_16x16x32_bf16 v[120:123],a[32:35],a[80:83],v[120:123]
ds_read_b64_tr_b16 a[4:5],v28 offset:4096
s_and_b32 s29,s21,3
v_mfma_f32_16x16x32_bf16 v[120:123],a[36:39],a[84:87],v[120:123]
ds_read_b64_tr_b16 a[6:7],v28 offset:6144
s_lshl_b32 s30,s29,15
v_mfma_f32_16x16x32_bf16 v[120:123],a[40:43],a[88:91],v[120:123]
ds_read_b64_tr_b16 a[8:9],v28 offset:8192
s_lshl_b32 s31,s20,13
v_mfma_f32_16x16x32_bf16 v[120:123],a[44:47],a[92:95],v[120:123]
ds_read_b64_tr_b16 a[10:11],v28 offset:10240
s_add_u32 s30,s30,s31
s_waitcnt lgkmcnt(12)
v_mfma_f32_16x16x32_bf16 v[92:95],a[48:51],a[64:67],v[92:95]
ds_read_b64_tr_b16 a[12:13],v28 offset:12288
s_add_u32 s30,s30,67108864
s_waitcnt lgkmcnt(11)
v_mfma_f32_16x16x32_bf16 v[92:95],a[52:55],a[68:71],v[92:95]
ds_read_b64_tr_b16 a[14:15],v28 offset:14336
s_lshl_b32 s32,s41,17
s_waitcnt lgkmcnt(10)
v_mfma_f32_16x16x32_bf16 v[92:95],a[56:59],a[72:75],v[92:95]
ds_read_b64_tr_b16 a[16:17],v24 offset:0
s_add_u32 s32,s32,s30
s_waitcnt lgkmcnt(9)
v_mfma_f32_16x16x32_bf16 v[92:95],a[60:63],a[76:79],v[92:95]
ds_read_b64_tr_b16 a[18:19],v24 offset:2048
s_add_u32 s34,s32,4096
v_mfma_f32_16x16x32_bf16 v[124:127],a[48:51],a[80:83],v[124:127]
ds_read_b64_tr_b16 a[20:21],v24 offset:4096
s_lshl_b32 s33,s42,17
v_mfma_f32_16x16x32_bf16 v[124:127],a[52:55],a[84:87],v[124:127]
ds_read_b64_tr_b16 a[22:23],v24 offset:6144
s_add_u32 s33,s33,s30
v_mfma_f32_16x16x32_bf16 v[124:127],a[56:59],a[88:91],v[124:127]
ds_read_b64_tr_b16 a[24:25],v24 offset:8192
s_add_u32 s35,s33,4096
v_mfma_f32_16x16x32_bf16 v[124:127],a[60:63],a[92:95],v[124:127]
ds_read_b64_tr_b16 a[26:27],v24 offset:10240
s_lshl_b32 s29,s29,8
s_waitcnt vmcnt(25)
s_waitcnt lgkmcnt(12)
v_mfma_f32_16x16x32_bf16 v[64:67],a[0:3],a[96:99],v[64:67]
ds_read_b64_tr_b16 a[28:29],v24 offset:12288
s_lshl_b32 s31,s20,6
s_waitcnt vmcnt(24)
s_waitcnt lgkmcnt(11)
v_mfma_f32_16x16x32_bf16 v[64:67],a[4:7],a[100:103],v[64:67]
ds_read_b64_tr_b16 a[30:31],v24 offset:14336
s_add_u32 s29,s29,s31
s_waitcnt vmcnt(23)
s_waitcnt lgkmcnt(10)
v_mfma_f32_16x16x32_bf16 v[64:67],a[8:11],a[104:107],v[64:67]
ds_read_b64_tr_b16 a[32:33],v29 offset:0
s_add_u32 s29,s29,1024
s_waitcnt vmcnt(22)
s_waitcnt lgkmcnt(9)
v_mfma_f32_16x16x32_bf16 v[64:67],a[12:15],a[108:111],v[64:67]
ds_read_b64_tr_b16 a[34:35],v29 offset:2048
s_lshl_b32 s36,s41,15
s_waitcnt vmcnt(21)
v_mfma_f32_16x16x32_bf16 v[96:99],a[0:3],a[112:115],v[96:99]
ds_read_b64_tr_b16 a[36:37],v29 offset:4096
s_add_u32 s36,s36,s29
s_waitcnt vmcnt(20)
v_mfma_f32_16x16x32_bf16 v[96:99],a[4:7],a[116:119],v[96:99]
ds_read_b64_tr_b16 a[38:39],v29 offset:6144
s_lshl_b32 s37,s42,15
s_waitcnt vmcnt(19)
v_mfma_f32_16x16x32_bf16 v[96:99],a[8:11],a[120:123],v[96:99]
ds_read_b64_tr_b16 a[40:41],v29 offset:8192
s_add_u32 s37,s37,s29
s_waitcnt vmcnt(18)
v_mfma_f32_16x16x32_bf16 v[96:99],a[12:15],a[124:127],v[96:99]
ds_read_b64_tr_b16 a[42:43],v29 offset:10240
v_and_b32 v39,15,v7
s_waitcnt vmcnt(17)
s_waitcnt lgkmcnt(12)
v_mfma_f32_16x16x32_bf16 v[64:67],a[16:19],a[128:131],v[64:67]
ds_read_b64_tr_b16 a[44:45],v29 offset:12288
v_lshlrev_b32 v39,11,v39
s_waitcnt vmcnt(16)
s_waitcnt lgkmcnt(11)
v_mfma_f32_16x16x32_bf16 v[64:67],a[20:23],a[132:135],v[64:67]
ds_read_b64_tr_b16 a[46:47],v29 offset:14336
v_lshl_add_u32 v39,v48,5,v39
s_waitcnt vmcnt(15)
s_waitcnt lgkmcnt(10)
v_mfma_f32_16x16x32_bf16 v[64:67],a[24:27],a[136:139],v[64:67]
ds_read_b64_tr_b16 a[48:49],v25 offset:0
v_lshl_add_u32 v39,v51,4,v39
s_waitcnt vmcnt(14)
s_waitcnt lgkmcnt(9)
v_mfma_f32_16x16x32_bf16 v[64:67],a[28:31],a[140:143],v[64:67]
ds_read_b64_tr_b16 a[50:51],v25 offset:2048
s_waitcnt vmcnt(13)
v_mfma_f32_16x16x32_bf16 v[96:99],a[16:19],a[144:147],v[96:99]
ds_read_b64_tr_b16 a[52:53],v25 offset:4096
s_waitcnt vmcnt(12)
v_mfma_f32_16x16x32_bf16 v[96:99],a[20:23],a[148:151],v[96:99]
ds_read_b64_tr_b16 a[54:55],v25 offset:6144
s_waitcnt vmcnt(11)
v_mfma_f32_16x16x32_bf16 v[96:99],a[24:27],a[152:155],v[96:99]
ds_read_b64_tr_b16 a[56:57],v25 offset:8192
s_waitcnt vmcnt(10)
v_mfma_f32_16x16x32_bf16 v[96:99],a[28:31],a[156:159],v[96:99]
ds_read_b64_tr_b16 a[58:59],v25 offset:10240
s_waitcnt lgkmcnt(12)
v_mfma_f32_16x16x32_bf16 v[68:71],a[32:35],a[96:99],v[68:71]
ds_read_b64_tr_b16 a[60:61],v25 offset:12288
s_waitcnt lgkmcnt(11)
v_mfma_f32_16x16x32_bf16 v[68:71],a[36:39],a[100:103],v[68:71]
s_waitcnt vmcnt(0)
v_mov_b32 v35,5
buffer_store_dword v35,v34,s[16:19],s99 offen sc1
s_barrier
s_waitcnt lgkmcnt(9)
v_mfma_f32_16x16x32_bf16 v[68:71],a[40:43],a[104:107],v[68:71]
ds_read_b64_tr_b16 a[62:63],v25 offset:14336
s_waitcnt lgkmcnt(8)
v_mfma_f32_16x16x32_bf16 v[68:71],a[44:47],a[108:111],v[68:71]
ds_read_b64_tr_b16 a[0:1],v30 offset:0
v_mfma_f32_16x16x32_bf16 v[100:103],a[32:35],a[112:115],v[100:103]
ds_read_b64_tr_b16 a[2:3],v30 offset:2048
v_mfma_f32_16x16x32_bf16 v[100:103],a[36:39],a[116:119],v[100:103]
ds_read_b64_tr_b16 a[4:5],v30 offset:4096
ds_read_b64_tr_b16 a[6:7],v30 offset:6144
ds_read_b128 v[40:43],v12
v_mfma_f32_16x16x32_bf16 v[100:103],a[40:43],a[120:123],v[100:103]
ds_read_b64_tr_b16 a[8:9],v30 offset:8192
ds_read_b128 v[44:47],v13
v_mfma_f32_16x16x32_bf16 v[100:103],a[44:47],a[124:127],v[100:103]
ds_read_b64_tr_b16 a[10:11],v30 offset:10240
s_waitcnt lgkmcnt(14)
v_mfma_f32_16x16x32_bf16 v[68:71],a[48:51],a[128:131],v[68:71]
ds_read_b64_tr_b16 a[12:13],v30 offset:12288
s_waitcnt lgkmcnt(13)
v_mfma_f32_16x16x32_bf16 v[68:71],a[52:55],a[132:135],v[68:71]
ds_read_b64_tr_b16 a[14:15],v30 offset:14336
s_waitcnt lgkmcnt(12)
v_mfma_f32_16x16x32_bf16 v[68:71],a[56:59],a[136:139],v[68:71]
ds_read_b64_tr_b16 a[16:17],v26 offset:0
s_waitcnt lgkmcnt(11)
v_mfma_f32_16x16x32_bf16 v[68:71],a[60:63],a[140:143],v[68:71]
ds_read_b64_tr_b16 a[18:19],v26 offset:2048
v_lshlrev_b32 v224,16,v52
v_mfma_f32_16x16x32_bf16 v[100:103],a[48:51],a[144:147],v[100:103]
ds_read_b64_tr_b16 a[20:21],v26 offset:4096
s_waitcnt lgkmcnt(8)
v_lshlrev_b32 v225,16,v40
v_mfma_f32_16x16x32_bf16 v[100:103],a[52:55],a[148:151],v[100:103]
ds_read_b64_tr_b16 a[22:23],v26 offset:6144
v_mul_f32 v224,v224,v225
v_mfma_f32_16x16x32_bf16 v[100:103],a[56:59],a[152:155],v[100:103]
ds_read_b64_tr_b16 a[24:25],v26 offset:8192
v_and_b32 v52,0xffff0000,v52
v_mfma_f32_16x16x32_bf16 v[100:103],a[60:63],a[156:159],v[100:103]
ds_read_b64_tr_b16 a[26:27],v26 offset:10240
v_and_b32 v40,0xffff0000,v40
v_mfma_f32_16x16x32_bf16 v[72:75],a[0:3],a[96:99],v[72:75]
ds_read_b64_tr_b16 a[28:29],v26 offset:12288
v_cvt_pk_bf16_f32 v64,v64,v65
v_mfma_f32_16x16x32_bf16 v[72:75],a[4:7],a[100:103],v[72:75]
ds_read_b64_tr_b16 a[30:31],v26 offset:14336
v_cvt_pk_bf16_f32 v65,v66,v67
s_waitcnt lgkmcnt(10)
v_mfma_f32_16x16x32_bf16 v[72:75],a[8:11],a[104:107],v[72:75]
ds_read_b64_tr_b16 a[32:33],v31 offset:0
v_cvt_pk_bf16_f32 v66,v68,v69
s_waitcnt lgkmcnt(9)
v_mfma_f32_16x16x32_bf16 v[72:75],a[12:15],a[108:111],v[72:75]
ds_read_b64_tr_b16 a[34:35],v31 offset:2048
v_cvt_pk_bf16_f32 v67,v70,v71
v_mfma_f32_16x16x32_bf16 v[104:107],a[0:3],a[112:115],v[104:107]
ds_read_b64_tr_b16 a[36:37],v31 offset:4096
s_add_u32 s28,s46,0
buffer_store_dwordx4 v[64:67],v1,s[16:19],s28 offen sc1
v_mul_f32 v40,v40,v52
v_mfma_f32_16x16x32_bf16 v[104:107],a[4:7],a[116:119],v[104:107]
ds_read_b64_tr_b16 a[38:39],v31 offset:6144
v_cvt_pk_bf16_f32 v40,v224,v40
v_mfma_f32_16x16x32_bf16 v[104:107],a[8:11],a[120:123],v[104:107]
ds_read_b64_tr_b16 a[40:41],v31 offset:8192
s_movk_i32 s77,0
v_mfma_f32_16x16x32_bf16 v[104:107],a[12:15],a[124:127],v[104:107]
buffer_store_dword v40,v15,s[12:15],s77 offen offset:0
s_waitcnt lgkmcnt(11)
v_mfma_f32_16x16x32_bf16 v[72:75],a[16:19],a[128:131],v[72:75]
ds_read_b64_tr_b16 a[42:43],v31 offset:10240
v_cvt_pk_bf16_f32 v96,v96,v97
v_cvt_pk_bf16_f32 v97,v98,v99
v_cvt_pk_bf16_f32 v98,v100,v101
v_cvt_pk_bf16_f32 v99,v102,v103
s_add_u32 s28,s47,0
buffer_store_dwordx4 v[96:99],v1,s[16:19],s28 offen sc1
v_lshlrev_b32 v224,16,v53
s_waitcnt lgkmcnt(10)
v_mfma_f32_16x16x32_bf16 v[72:75],a[20:23],a[132:135],v[72:75]
ds_read_b64_tr_b16 a[44:45],v31 offset:12288
v_lshlrev_b32 v225,16,v41
s_waitcnt lgkmcnt(9)
v_mfma_f32_16x16x32_bf16 v[72:75],a[24:27],a[136:139],v[72:75]
ds_read_b64_tr_b16 a[46:47],v31 offset:14336
v_mul_f32 v224,v224,v225
s_waitcnt lgkmcnt(8)
v_mfma_f32_16x16x32_bf16 v[72:75],a[28:31],a[140:143],v[72:75]
ds_read_b64_tr_b16 a[48:49],v27 offset:0
v_and_b32 v53,0xffff0000,v53
v_mfma_f32_16x16x32_bf16 v[104:107],a[16:19],a[144:147],v[104:107]
ds_read_b64_tr_b16 a[50:51],v27 offset:2048
v_and_b32 v41,0xffff0000,v41
v_mfma_f32_16x16x32_bf16 v[104:107],a[20:23],a[148:151],v[104:107]
ds_read_b64_tr_b16 a[52:53],v27 offset:4096
v_mul_f32 v41,v41,v53
v_mfma_f32_16x16x32_bf16 v[104:107],a[24:27],a[152:155],v[104:107]
ds_read_b64_tr_b16 a[54:55],v27 offset:6144
v_cvt_pk_bf16_f32 v41,v224,v41
v_mfma_f32_16x16x32_bf16 v[104:107],a[28:31],a[156:159],v[104:107]
ds_read_b64_tr_b16 a[56:57],v27 offset:8192
s_movk_i32 s77,0
s_waitcnt lgkmcnt(11)
v_mfma_f32_16x16x32_bf16 v[76:79],a[32:35],a[96:99],v[76:79]
buffer_store_dword v41,v15,s[12:15],s77 offen offset:2048
ds_read_b64_tr_b16 a[58:59],v27 offset:10240
s_waitcnt lgkmcnt(10)
v_mfma_f32_16x16x32_bf16 v[76:79],a[36:39],a[100:103],v[76:79]
ds_read_b64_tr_b16 a[60:61],v27 offset:12288
v_lshlrev_b32 v224,16,v54
s_waitcnt lgkmcnt(9)
v_mfma_f32_16x16x32_bf16 v[76:79],a[40:43],a[104:107],v[76:79]
ds_read_b64_tr_b16 a[62:63],v27 offset:14336
v_lshlrev_b32 v225,16,v42
s_waitcnt lgkmcnt(8)
v_mfma_f32_16x16x32_bf16 v[76:79],a[44:47],a[108:111],v[76:79]
ds_read_b64_tr_b16 a[0:1],v28 offset:16384
v_mul_f32 v224,v224,v225
v_mfma_f32_16x16x32_bf16 v[108:111],a[32:35],a[112:115],v[108:111]
ds_read_b64_tr_b16 a[2:3],v28 offset:18432
v_and_b32 v54,0xffff0000,v54
v_mfma_f32_16x16x32_bf16 v[108:111],a[36:39],a[116:119],v[108:111]
ds_read_b64_tr_b16 a[4:5],v28 offset:20480
v_and_b32 v42,0xffff0000,v42
v_mfma_f32_16x16x32_bf16 v[108:111],a[40:43],a[120:123],v[108:111]
ds_read_b64_tr_b16 a[6:7],v28 offset:22528
v_mul_f32 v42,v42,v54
v_mfma_f32_16x16x32_bf16 v[108:111],a[44:47],a[124:127],v[108:111]
ds_read_b64_tr_b16 a[8:9],v28 offset:24576
v_cvt_pk_bf16_f32 v42,v224,v42
s_waitcnt lgkmcnt(11)
v_mfma_f32_16x16x32_bf16 v[76:79],a[48:51],a[128:131],v[76:79]
ds_read_b64_tr_b16 a[10:11],v28 offset:26624
s_movk_i32 s77,4096
s_waitcnt lgkmcnt(10)
v_mfma_f32_16x16x32_bf16 v[76:79],a[52:55],a[132:135],v[76:79]
buffer_store_dword v42,v15,s[12:15],s77 offen offset:0
ds_read_b64_tr_b16 a[12:13],v28 offset:28672
s_waitcnt lgkmcnt(9)
v_mfma_f32_16x16x32_bf16 v[76:79],a[56:59],a[136:139],v[76:79]
ds_read_b64_tr_b16 a[14:15],v28 offset:30720
v_lshlrev_b32 v224,16,v55
s_waitcnt lgkmcnt(8)
v_mfma_f32_16x16x32_bf16 v[76:79],a[60:63],a[140:143],v[76:79]
ds_read_b64_tr_b16 a[16:17],v24 offset:16384
v_lshlrev_b32 v225,16,v43
v_mfma_f32_16x16x32_bf16 v[108:111],a[48:51],a[144:147],v[108:111]
ds_read_b64_tr_b16 a[18:19],v24 offset:18432
v_mul_f32 v224,v224,v225
v_mfma_f32_16x16x32_bf16 v[108:111],a[52:55],a[148:151],v[108:111]
ds_read_b64_tr_b16 a[20:21],v24 offset:20480
v_and_b32 v55,0xffff0000,v55
v_mfma_f32_16x16x32_bf16 v[108:111],a[56:59],a[152:155],v[108:111]
ds_read_b64_tr_b16 a[22:23],v24 offset:22528
v_and_b32 v43,0xffff0000,v43
v_mfma_f32_16x16x32_bf16 v[108:111],a[60:63],a[156:159],v[108:111]
ds_read_b64_tr_b16 a[24:25],v24 offset:24576
v_mul_f32 v43,v43,v55
s_waitcnt lgkmcnt(11)
v_mfma_f32_16x16x32_bf16 v[80:83],a[0:3],a[96:99],v[80:83]
ds_read_b64_tr_b16 a[26:27],v24 offset:26624
v_cvt_pk_bf16_f32 v43,v224,v43
s_waitcnt lgkmcnt(10)
v_mfma_f32_16x16x32_bf16 v[80:83],a[4:7],a[100:103],v[80:83]
ds_read_b64_tr_b16 a[28:29],v24 offset:28672
s_movk_i32 s77,4096
s_waitcnt lgkmcnt(9)
v_mfma_f32_16x16x32_bf16 v[80:83],a[8:11],a[104:107],v[80:83]
buffer_store_dword v43,v15,s[12:15],s77 offen offset:2048
ds_read_b64_tr_b16 a[30:31],v24 offset:30720
s_waitcnt lgkmcnt(8)
v_mfma_f32_16x16x32_bf16 v[80:83],a[12:15],a[108:111],v[80:83]
ds_read_b64_tr_b16 a[32:33],v29 offset:16384
v_lshlrev_b32 v224,16,v56
v_mfma_f32_16x16x32_bf16 v[112:115],a[0:3],a[112:115],v[112:115]
ds_read_b64_tr_b16 a[34:35],v29 offset:18432
v_cvt_pk_bf16_f32 v72,v72,v73
v_cvt_pk_bf16_f32 v73,v74,v75
v_cvt_pk_bf16_f32 v74,v76,v77
v_cvt_pk_bf16_f32 v75,v78,v79
s_add_u32 s28,s46,8192
buffer_store_dwordx4 v[72:75],v1,s[16:19],s28 offen sc1
v_lshlrev_b32 v225,16,v44
v_mfma_f32_16x16x32_bf16 v[112:115],a[4:7],a[116:119],v[112:115]
ds_read_b64_tr_b16 a[36:37],v29 offset:20480
v_mul_f32 v224,v224,v225
v_mfma_f32_16x16x32_bf16 v[112:115],a[8:11],a[120:123],v[112:115]
ds_read_b64_tr_b16 a[38:39],v29 offset:22528
v_and_b32 v56,0xffff0000,v56
v_mfma_f32_16x16x32_bf16 v[112:115],a[12:15],a[124:127],v[112:115]
ds_read_b64_tr_b16 a[40:41],v29 offset:24576
v_and_b32 v44,0xffff0000,v44
s_waitcnt lgkmcnt(11)
v_mfma_f32_16x16x32_bf16 v[80:83],a[16:19],a[128:131],v[80:83]
ds_read_b64_tr_b16 a[42:43],v29 offset:26624
v_cvt_pk_bf16_f32 v104,v104,v105
v_cvt_pk_bf16_f32 v105,v106,v107
v_cvt_pk_bf16_f32 v106,v108,v109
v_cvt_pk_bf16_f32 v107,v110,v111
s_add_u32 s28,s47,8192
buffer_store_dwordx4 v[104:107],v1,s[16:19],s28 offen sc1
v_mul_f32 v44,v44,v56
s_waitcnt lgkmcnt(10)
v_mfma_f32_16x16x32_bf16 v[80:83],a[20:23],a[132:135],v[80:83]
ds_read_b64_tr_b16 a[44:45],v29 offset:28672
v_cvt_pk_bf16_f32 v44,v224,v44
s_waitcnt lgkmcnt(9)
v_mfma_f32_16x16x32_bf16 v[80:83],a[24:27],a[136:139],v[80:83]
ds_read_b64_tr_b16 a[46:47],v29 offset:30720
s_movk_i32 s77,8192
s_waitcnt lgkmcnt(8)
v_mfma_f32_16x16x32_bf16 v[80:83],a[28:31],a[140:143],v[80:83]
buffer_store_dword v44,v15,s[12:15],s77 offen offset:0
ds_read_b64_tr_b16 a[48:49],v25 offset:16384
v_mfma_f32_16x16x32_bf16 v[112:115],a[16:19],a[144:147],v[112:115]
ds_read_b64_tr_b16 a[50:51],v25 offset:18432
v_lshlrev_b32 v224,16,v57
v_mfma_f32_16x16x32_bf16 v[112:115],a[20:23],a[148:151],v[112:115]
ds_read_b64_tr_b16 a[52:53],v25 offset:20480
v_lshlrev_b32 v225,16,v45
v_mfma_f32_16x16x32_bf16 v[112:115],a[24:27],a[152:155],v[112:115]
ds_read_b64_tr_b16 a[54:55],v25 offset:22528
v_mul_f32 v224,v224,v225
v_mfma_f32_16x16x32_bf16 v[112:115],a[28:31],a[156:159],v[112:115]
ds_read_b64_tr_b16 a[56:57],v25 offset:24576
v_and_b32 v57,0xffff0000,v57
s_waitcnt lgkmcnt(11)
v_mfma_f32_16x16x32_bf16 v[84:87],a[32:35],a[96:99],v[84:87]
ds_read_b64_tr_b16 a[58:59],v25 offset:26624
v_and_b32 v45,0xffff0000,v45
s_waitcnt lgkmcnt(10)
v_mfma_f32_16x16x32_bf16 v[84:87],a[36:39],a[100:103],v[84:87]
ds_read_b64_tr_b16 a[60:61],v25 offset:28672
v_mul_f32 v45,v45,v57
s_waitcnt lgkmcnt(9)
v_mfma_f32_16x16x32_bf16 v[84:87],a[40:43],a[104:107],v[84:87]
ds_read_b64_tr_b16 a[62:63],v25 offset:30720
v_cvt_pk_bf16_f32 v45,v224,v45
s_waitcnt lgkmcnt(8)
v_mfma_f32_16x16x32_bf16 v[84:87],a[44:47],a[108:111],v[84:87]
ds_read_b64_tr_b16 a[0:1],v30 offset:16384
s_movk_i32 s77,8192
v_mfma_f32_16x16x32_bf16 v[116:119],a[32:35],a[112:115],v[116:119]
buffer_store_dword v45,v15,s[12:15],s77 offen offset:2048
ds_read_b64_tr_b16 a[2:3],v30 offset:18432
ds_read_b64_tr_b16 a[4:5],v30 offset:20480
ds_read_b64_tr_b16 a[6:7],v30 offset:22528
ds_read_b64_tr_b16 a[8:9],v30 offset:24576
buffer_load_dword v33,v38,s[16:19],s38 offen sc1
v_mfma_f32_16x16x32_bf16 v[116:119],a[36:39],a[116:119],v[116:119]
ds_read_b64_tr_b16 a[10:11],v30 offset:26624
v_lshlrev_b32 v224,16,v58
v_mfma_f32_16x16x32_bf16 v[116:119],a[40:43],a[120:123],v[116:119]
ds_read_b64_tr_b16 a[12:13],v30 offset:28672
v_lshlrev_b32 v225,16,v46
v_mfma_f32_16x16x32_bf16 v[116:119],a[44:47],a[124:127],v[116:119]
ds_read_b64_tr_b16 a[14:15],v30 offset:30720
v_mul_f32 v224,v224,v225
s_waitcnt lgkmcnt(14)
v_mfma_f32_16x16x32_bf16 v[84:87],a[48:51],a[128:131],v[84:87]
ds_read_b64_tr_b16 a[16:17],v26 offset:16384
v_and_b32 v58,0xffff0000,v58
s_waitcnt lgkmcnt(13)
v_mfma_f32_16x16x32_bf16 v[84:87],a[52:55],a[132:135],v[84:87]
ds_read_b64_tr_b16 a[18:19],v26 offset:18432
v_and_b32 v46,0xffff0000,v46
s_waitcnt lgkmcnt(12)
v_mfma_f32_16x16x32_bf16 v[84:87],a[56:59],a[136:139],v[84:87]
ds_read_b64_tr_b16 a[20:21],v26 offset:20480
v_mul_f32 v46,v46,v58
s_waitcnt lgkmcnt(11)
v_mfma_f32_16x16x32_bf16 v[84:87],a[60:63],a[140:143],v[84:87]
ds_read_b64_tr_b16 a[22:23],v26 offset:22528
v_cvt_pk_bf16_f32 v46,v224,v46
v_mfma_f32_16x16x32_bf16 v[116:119],a[48:51],a[144:147],v[116:119]
ds_read_b64_tr_b16 a[24:25],v26 offset:24576
s_movk_i32 s77,12288
v_mfma_f32_16x16x32_bf16 v[116:119],a[52:55],a[148:151],v[116:119]
buffer_store_dword v46,v15,s[12:15],s77 offen offset:0
v_mfma_f32_16x16x32_bf16 v[116:119],a[56:59],a[152:155],v[116:119]
ds_read_b64_tr_b16 a[26:27],v26 offset:26624
v_lshlrev_b32 v224,16,v59
v_mfma_f32_16x16x32_bf16 v[116:119],a[60:63],a[156:159],v[116:119]
ds_read_b64_tr_b16 a[28:29],v26 offset:28672
v_lshlrev_b32 v225,16,v47
s_waitcnt lgkmcnt(13)
v_mfma_f32_16x16x32_bf16 v[88:91],a[0:3],a[96:99],v[88:91]
ds_read_b64_tr_b16 a[30:31],v26 offset:30720
v_mul_f32 v224,v224,v225
s_waitcnt lgkmcnt(12)
v_mfma_f32_16x16x32_bf16 v[88:91],a[4:7],a[100:103],v[88:91]
ds_read_b64_tr_b16 a[32:33],v31 offset:16384
v_and_b32 v59,0xffff0000,v59
s_waitcnt lgkmcnt(11)
v_mfma_f32_16x16x32_bf16 v[88:91],a[8:11],a[104:107],v[88:91]
ds_read_b64_tr_b16 a[34:35],v31 offset:18432
v_and_b32 v47,0xffff0000,v47
s_waitcnt lgkmcnt(10)
v_mfma_f32_16x16x32_bf16 v[88:91],a[12:15],a[108:111],v[88:91]
ds_read_b64_tr_b16 a[36:37],v31 offset:20480
v_mul_f32 v47,v47,v59
v_mfma_f32_16x16x32_bf16 v[120:123],a[0:3],a[112:115],v[120:123]
ds_read_b64_tr_b16 a[38:39],v31 offset:22528
v_cvt_pk_bf16_f32 v80,v80,v81
v_cvt_pk_bf16_f32 v81,v82,v83
v_cvt_pk_bf16_f32 v82,v84,v85
v_cvt_pk_bf16_f32 v83,v86,v87
s_add_u32 s28,s46,16384
buffer_store_dwordx4 v[80:83],v1,s[16:19],s28 offen sc1
v_cvt_pk_bf16_f32 v47,v224,v47
v_mfma_f32_16x16x32_bf16 v[120:123],a[4:7],a[116:119],v[120:123]
ds_read_b64_tr_b16 a[40:41],v31 offset:24576
s_movk_i32 s77,12288
v_mfma_f32_16x16x32_bf16 v[120:123],a[8:11],a[120:123],v[120:123]
buffer_store_dword v47,v15,s[12:15],s77 offen offset:2048
v_mfma_f32_16x16x32_bf16 v[120:123],a[12:15],a[124:127],v[120:123]
ds_read_b64_tr_b16 a[42:43],v31 offset:26624
v_cvt_pk_bf16_f32 v112,v112,v113
s_waitcnt lgkmcnt(12)
v_mfma_f32_16x16x32_bf16 v[88:91],a[16:19],a[128:131],v[88:91]
ds_read_b64_tr_b16 a[44:45],v31 offset:28672
v_cvt_pk_bf16_f32 v113,v114,v115
s_waitcnt lgkmcnt(11)
v_mfma_f32_16x16x32_bf16 v[88:91],a[20:23],a[132:135],v[88:91]
ds_read_b64_tr_b16 a[46:47],v31 offset:30720
v_cvt_pk_bf16_f32 v114,v116,v117
s_waitcnt lgkmcnt(10)
v_mfma_f32_16x16x32_bf16 v[88:91],a[24:27],a[136:139],v[88:91]
ds_read_b64_tr_b16 a[48:49],v27 offset:16384
v_cvt_pk_bf16_f32 v115,v118,v119
s_add_u32 s28,s47,16384
buffer_store_dwordx4 v[112:115],v1,s[16:19],s28 offen sc1
s_waitcnt lgkmcnt(9)
v_mfma_f32_16x16x32_bf16 v[88:91],a[28:31],a[140:143],v[88:91]
ds_read_b64_tr_b16 a[50:51],v27 offset:18432
v_mfma_f32_16x16x32_bf16 v[120:123],a[16:19],a[144:147],v[120:123]
ds_read_b64_tr_b16 a[52:53],v27 offset:20480
v_mfma_f32_16x16x32_bf16 v[120:123],a[20:23],a[148:151],v[120:123]
ds_read_b64_tr_b16 a[54:55],v27 offset:22528
v_mfma_f32_16x16x32_bf16 v[120:123],a[24:27],a[152:155],v[120:123]
ds_read_b64_tr_b16 a[56:57],v27 offset:24576
v_mfma_f32_16x16x32_bf16 v[120:123],a[28:31],a[156:159],v[120:123]
ds_read_b64_tr_b16 a[58:59],v27 offset:26624
s_waitcnt lgkmcnt(12)
v_mfma_f32_16x16x32_bf16 v[92:95],a[32:35],a[96:99],v[92:95]
ds_read_b64_tr_b16 a[60:61],v27 offset:28672
s_waitcnt lgkmcnt(11)
v_mfma_f32_16x16x32_bf16 v[92:95],a[36:39],a[100:103],v[92:95]
ds_read_b64_tr_b16 a[62:63],v27 offset:30720
s_waitcnt lgkmcnt(10)
v_mfma_f32_16x16x32_bf16 v[92:95],a[40:43],a[104:107],v[92:95]
s_waitcnt lgkmcnt(8)
v_mfma_f32_16x16x32_bf16 v[92:95],a[44:47],a[108:111],v[92:95]
v_mfma_f32_16x16x32_bf16 v[124:127],a[32:35],a[112:115],v[124:127]
v_mfma_f32_16x16x32_bf16 v[124:127],a[36:39],a[116:119],v[124:127]
v_mfma_f32_16x16x32_bf16 v[124:127],a[40:43],a[120:123],v[124:127]
v_mfma_f32_16x16x32_bf16 v[124:127],a[44:47],a[124:127],v[124:127]
s_waitcnt lgkmcnt(6)
v_mfma_f32_16x16x32_bf16 v[92:95],a[48:51],a[128:131],v[92:95]
s_waitcnt lgkmcnt(4)
v_mfma_f32_16x16x32_bf16 v[92:95],a[52:55],a[132:135],v[92:95]
s_waitcnt lgkmcnt(2)
v_mfma_f32_16x16x32_bf16 v[92:95],a[56:59],a[136:139],v[92:95]
s_waitcnt lgkmcnt(0)
v_mfma_f32_16x16x32_bf16 v[92:95],a[60:63],a[140:143],v[92:95]
v_mfma_f32_16x16x32_bf16 v[124:127],a[48:51],a[144:147],v[124:127]
v_mfma_f32_16x16x32_bf16 v[124:127],a[52:55],a[148:151],v[124:127]
v_mfma_f32_16x16x32_bf16 v[124:127],a[56:59],a[152:155],v[124:127]
v_mfma_f32_16x16x32_bf16 v[124:127],a[60:63],a[156:159],v[124:127]
v_cvt_pk_bf16_f32 v88,v88,v89
v_cvt_pk_bf16_f32 v89,v90,v91
s_nop 1
v_cvt_pk_bf16_f32 v90,v92,v93
v_cvt_pk_bf16_f32 v91,v94,v95
s_add_u32 s28,s46,24576
buffer_store_dwordx4 v[88:91],v1,s[16:19],s28 offen sc1
v_cvt_pk_bf16_f32 v120,v120,v121
v_cvt_pk_bf16_f32 v121,v122,v123
v_cvt_pk_bf16_f32 v122,v124,v125
v_cvt_pk_bf16_f32 v123,v126,v127
s_add_u32 s28,s47,24576
buffer_store_dwordx4 v[120:123],v1,s[16:19],s28 offen sc1
s_waitcnt vmcnt(6)
v_cmp_gt_u32 vcc,5,v33
s_nop 0
s_cbranch_vccnz F_T2
buffer_load_dwordx4 v[128:131],v1,s[16:19],s32 offen offset:0 sc1
buffer_load_dwordx4 v[132:135],v1,s[16:19],s32 offen offset:1024 sc1
buffer_load_dwordx4 v[136:139],v1,s[16:19],s32 offen offset:2048 sc1
buffer_load_dwordx4 v[140:143],v1,s[16:19],s32 offen offset:3072 sc1
buffer_load_dwordx4 v[144:147],v1,s[16:19],s34 offen offset:0 sc1
buffer_load_dwordx4 v[148:151],v1,s[16:19],s34 offen offset:1024 sc1
buffer_load_dwordx4 v[152:155],v1,s[16:19],s34 offen offset:2048 sc1
buffer_load_dwordx4 v[156:159],v1,s[16:19],s34 offen offset:3072 sc1
s_waitcnt vmcnt(8)
v_mov_b32 v35,6
buffer_store_dword v35,v34,s[16:19],s99 offen sc1
F_T3:
s_waitcnt vmcnt(8)
v_lshlrev_b32 v192,16,v128
v_and_b32 v193,0xffff0000,v128
v_lshlrev_b32 v194,16,v129
v_and_b32 v195,0xffff0000,v129
v_lshlrev_b32 v196,16,v130
v_and_b32 v197,0xffff0000,v130
v_lshlrev_b32 v198,16,v131
v_and_b32 v199,0xffff0000,v131
s_waitcnt vmcnt(7)
v_lshlrev_b32 v200,16,v132
v_and_b32 v201,0xffff0000,v132
v_pk_add_f32 v[192:193],v[192:193],v[200:201]
v_lshlrev_b32 v202,16,v133
v_and_b32 v203,0xffff0000,v133
v_pk_add_f32 v[194:195],v[194:195],v[202:203]
v_lshlrev_b32 v200,16,v134
v_and_b32 v201,0xffff0000,v134
v_pk_add_f32 v[196:197],v[196:197],v[200:201]
v_lshlrev_b32 v202,16,v135
v_and_b32 v203,0xffff0000,v135
v_pk_add_f32 v[198:199],v[198:199],v[202:203]
s_waitcnt vmcnt(6)
v_lshlrev_b32 v200,16,v136
v_and_b32 v201,0xffff0000,v136
v_pk_add_f32 v[192:193],v[192:193],v[200:201]
v_lshlrev_b32 v202,16,v137
v_and_b32 v203,0xffff0000,v137
v_pk_add_f32 v[194:195],v[194:195],v[202:203]
v_lshlrev_b32 v200,16,v138
v_and_b32 v201,0xffff0000,v138
v_pk_add_f32 v[196:197],v[196:197],v[200:201]
v_lshlrev_b32 v202,16,v139
v_and_b32 v203,0xffff0000,v139
v_pk_add_f32 v[198:199],v[198:199],v[202:203]
s_waitcnt vmcnt(5)
v_lshlrev_b32 v200,16,v140
v_and_b32 v201,0xffff0000,v140
v_pk_add_f32 v[192:193],v[192:193],v[200:201]
v_lshlrev_b32 v202,16,v141
v_and_b32 v203,0xffff0000,v141
v_pk_add_f32 v[194:195],v[194:195],v[202:203]
v_lshlrev_b32 v200,16,v142
v_and_b32 v201,0xffff0000,v142
buffer_load_dword v33,v38,s[16:19],s39 offen sc1
v_pk_add_f32 v[196:197],v[196:197],v[200:201]
v_lshlrev_b32 v202,16,v143
v_and_b32 v203,0xffff0000,v143
v_pk_add_f32 v[198:199],v[198:199],v[202:203]
s_waitcnt vmcnt(5)
v_lshlrev_b32 v200,16,v144
v_and_b32 v201,0xffff0000,v144
v_pk_add_f32 v[192:193],v[192:193],v[200:201]
v_lshlrev_b32 v202,16,v145
v_and_b32 v203,0xffff0000,v145
v_pk_add_f32 v[194:195],v[194:195],v[202:203]
v_lshlrev_b32 v200,16,v146
v_and_b32 v201,0xffff0000,v146
v_pk_add_f32 v[196:197],v[196:197],v[200:201]
v_lshlrev_b32 v202,16,v147
v_and_b32 v203,0xffff0000,v147
v_pk_add_f32 v[198:199],v[198:199],v[202:203]
s_waitcnt vmcnt(4)
v_lshlrev_b32 v200,16,v148
v_and_b32 v201,0xffff0000,v148
v_pk_add_f32 v[192:193],v[192:193],v[200:201]
v_lshlrev_b32 v202,16,v149
v_and_b32 v203,0xffff0000,v149
v_pk_add_f32 v[194:195],v[194:195],v[202:203]
v_lshlrev_b32 v200,16,v150
v_and_b32 v201,0xffff0000,v150
v_pk_add_f32 v[196:197],v[196:197],v[200:201]
v_lshlrev_b32 v202,16,v151
v_and_b32 v203,0xffff0000,v151
v_pk_add_f32 v[198:199],v[198:199],v[202:203]
s_waitcnt vmcnt(3)
v_lshlrev_b32 v200,16,v152
v_and_b32 v201,0xffff0000,v152
v_pk_add_f32 v[192:193],v[192:193],v[200:201]
v_lshlrev_b32 v202,16,v153
v_and_b32 v203,0xffff0000,v153
v_pk_add_f32 v[194:195],v[194:195],v[202:203]
v_lshlrev_b32 v200,16,v154
v_and_b32 v201,0xffff0000,v154
v_pk_add_f32 v[196:197],v[196:197],v[200:201]
v_lshlrev_b32 v202,16,v155
v_and_b32 v203,0xffff0000,v155
v_pk_add_f32 v[198:199],v[198:199],v[202:203]
s_waitcnt vmcnt(2)
v_lshlrev_b32 v200,16,v156
v_and_b32 v201,0xffff0000,v156
v_pk_add_f32 v[192:193],v[192:193],v[200:201]
v_lshlrev_b32 v202,16,v157
v_and_b32 v203,0xffff0000,v157
v_pk_add_f32 v[194:195],v[194:195],v[202:203]
v_lshlrev_b32 v200,16,v158
v_and_b32 v201,0xffff0000,v158
v_pk_add_f32 v[196:197],v[196:197],v[200:201]
v_lshlrev_b32 v202,16,v159
v_and_b32 v203,0xffff0000,v159
v_pk_add_f32 v[198:199],v[198:199],v[202:203]
v_cvt_pk_bf16_f32 v192,v192,v193
v_cvt_pk_bf16_f32 v193,v194,v195
v_cvt_pk_bf16_f32 v194,v196,v197
v_cvt_pk_bf16_f32 v195,v198,v199
s_nop 1
v_permlane16_swap_b32 v192,v194
v_permlane16_swap_b32 v193,v195
buffer_store_dwordx4 v[192:195],v39,s[12:15],s36 offen
s_waitcnt vmcnt(1)
v_cmp_gt_u32 vcc,6,v33
s_nop 0
s_cbranch_vccnz F_Y6_S
F_Y6_R:
buffer_load_dwordx4 v[160:163],v1,s[16:19],s33 offen offset:0 sc1
buffer_load_dwordx4 v[164:167],v1,s[16:19],s33 offen offset:1024 sc1
buffer_load_dwordx4 v[168:171],v1,s[16:19],s33 offen offset:2048 sc1
buffer_load_dwordx4 v[172:175],v1,s[16:19],s33 offen offset:3072 sc1
buffer_load_dwordx4 v[176:179],v1,s[16:19],s35 offen offset:0 sc1
buffer_load_dwordx4 v[180:183],v1,s[16:19],s35 offen offset:1024 sc1
buffer_load_dwordx4 v[184:187],v1,s[16:19],s35 offen offset:2048 sc1
buffer_load_dwordx4 v[188:191],v1,s[16:19],s35 offen offset:3072 sc1
s_waitcnt vmcnt(7)
v_lshlrev_b32 v208,16,v160
v_and_b32 v209,0xffff0000,v160
v_lshlrev_b32 v210,16,v161
v_and_b32 v211,0xffff0000,v161
v_lshlrev_b32 v212,16,v162
v_and_b32 v213,0xffff0000,v162
v_lshlrev_b32 v214,16,v163
v_and_b32 v215,0xffff0000,v163
s_waitcnt vmcnt(6)
v_lshlrev_b32 v216,16,v164
v_and_b32 v217,0xffff0000,v164
v_pk_add_f32 v[208:209],v[208:209],v[216:217]
v_lshlrev_b32 v218,16,v165
v_and_b32 v219,0xffff0000,v165
v_pk_add_f32 v[210:211],v[210:211],v[218:219]
v_lshlrev_b32 v216,16,v166
v_and_b32 v217,0xffff0000,v166
v_pk_add_f32 v[212:213],v[212:213],v[216:217]
v_lshlrev_b32 v218,16,v167
v_and_b32 v219,0xffff0000,v167
v_pk_add_f32 v[214:215],v[214:215],v[218:219]
s_waitcnt vmcnt(5)
v_lshlrev_b32 v216,16,v168
v_and_b32 v217,0xffff0000,v168
v_pk_add_f32 v[208:209],v[208:209],v[216:217]
v_lshlrev_b32 v218,16,v169
v_and_b32 v219,0xffff0000,v169
v_pk_add_f32 v[210:211],v[210:211],v[218:219]
v_lshlrev_b32 v216,16,v170
v_and_b32 v217,0xffff0000,v170
v_pk_add_f32 v[212:213],v[212:213],v[216:217]
v_lshlrev_b32 v218,16,v171
v_and_b32 v219,0xffff0000,v171
v_pk_add_f32 v[214:215],v[214:215],v[218:219]
s_waitcnt vmcnt(4)
v_lshlrev_b32 v216,16,v172
v_and_b32 v217,0xffff0000,v172
v_pk_add_f32 v[208:209],v[208:209],v[216:217]
v_lshlrev_b32 v218,16,v173
v_and_b32 v219,0xffff0000,v173
v_pk_add_f32 v[210:211],v[210:211],v[218:219]
v_lshlrev_b32 v216,16,v174
v_and_b32 v217,0xffff0000,v174
v_pk_add_f32 v[212:213],v[212:213],v[216:217]
v_lshlrev_b32 v218,16,v175
v_and_b32 v219,0xffff0000,v175
v_pk_add_f32 v[214:215],v[214:215],v[218:219]
s_waitcnt vmcnt(3)
v_lshlrev_b32 v216,16,v176
v_and_b32 v217,0xffff0000,v176
v_pk_add_f32 v[208:209],v[208:209],v[216:217]
v_lshlrev_b32 v218,16,v177
v_and_b32 v219,0xffff0000,v177
v_pk_add_f32 v[210:211],v[210:211],v[218:219]
v_lshlrev_b32 v216,16,v178
v_and_b32 v217,0xffff0000,v178
v_pk_add_f32 v[212:213],v[212:213],v[216:217]
v_lshlrev_b32 v218,16,v179
v_and_b32 v219,0xffff0000,v179
v_pk_add_f32 v[214:215],v[214:215],v[218:219]
s_waitcnt vmcnt(2)
v_lshlrev_b32 v216,16,v180
v_and_b32 v217,0xffff0000,v180
v_pk_add_f32 v[208:209],v[208:209],v[216:217]
v_lshlrev_b32 v218,16,v181
v_and_b32 v219,0xffff0000,v181
v_pk_add_f32 v[210:211],v[210:211],v[218:219]
v_lshlrev_b32 v216,16,v182
v_and_b32 v217,0xffff0000,v182
v_pk_add_f32 v[212:213],v[212:213],v[216:217]
v_lshlrev_b32 v218,16,v183
v_and_b32 v219,0xffff0000,v183
v_pk_add_f32 v[214:215],v[214:215],v[218:219]
s_waitcnt vmcnt(1)
v_lshlrev_b32 v216,16,v184
v_and_b32 v217,0xffff0000,v184
v_pk_add_f32 v[208:209],v[208:209],v[216:217]
v_lshlrev_b32 v218,16,v185
v_and_b32 v219,0xffff0000,v185
v_pk_add_f32 v[210:211],v[210:211],v[218:219]
v_lshlrev_b32 v216,16,v186
v_and_b32 v217,0xffff0000,v186
v_pk_add_f32 v[212:213],v[212:213],v[216:217]
v_lshlrev_b32 v218,16,v187
v_and_b32 v219,0xffff0000,v187
v_pk_add_f32 v[214:215],v[214:215],v[218:219]
s_waitcnt vmcnt(0)
v_lshlrev_b32 v216,16,v188
v_and_b32 v217,0xffff0000,v188
v_pk_add_f32 v[208:209],v[208:209],v[216:217]
v_lshlrev_b32 v218,16,v189
v_and_b32 v219,0xffff0000,v189
v_pk_add_f32 v[210:211],v[210:211],v[218:219]
v_lshlrev_b32 v216,16,v190
v_and_b32 v217,0xffff0000,v190
v_pk_add_f32 v[212:213],v[212:213],v[216:217]
v_lshlrev_b32 v218,16,v191
v_and_b32 v219,0xffff0000,v191
v_pk_add_f32 v[214:215],v[214:215],v[218:219]
v_cvt_pk_bf16_f32 v208,v208,v209
v_cvt_pk_bf16_f32 v209,v210,v211
v_cvt_pk_bf16_f32 v210,v212,v213
v_cvt_pk_bf16_f32 v211,v214,v215
s_nop 1
v_permlane16_swap_b32 v208,v210
v_permlane16_swap_b32 v209,v211
buffer_store_dwordx4 v[208:211],v39,s[12:15],s37 offen
s_endpgm
F_AW_S:
s_mov_b32 s31,0
F_AW_L:
s_mov_b64 exec,vcc
s_sleep 2
global_load_dword v29,v28,s[94:95] sc1
s_add_u32 s31,s31,1
s_waitcnt vmcnt(0)
v_cmp_gt_u32 vcc,32,v29
s_cmp_gt_u32 s31,1000000
s_cbranch_scc1 F_AW_X
s_cbranch_vccnz F_AW_L
F_AW_X:
s_mov_b64 exec,-1
s_branch F_AW_R
F_P1_S:
s_mov_b32 s31,0
F_P1_L:
s_mov_b64 exec,vcc
s_sleep 2
buffer_load_dword v27,v26,s[16:19],s3 offen sc1
s_add_u32 s31,s31,1
s_waitcnt vmcnt(0)
v_cmp_gt_u32 vcc,1,v27
s_cmp_gt_u32 s31,1000000
s_cbranch_scc1 F_P1_X
s_cbranch_vccnz F_P1_L
F_P1_X:
s_mov_b64 exec,-1
s_branch F_P1_R
F_H1_O:
buffer_store_dword v11,v10,s[16:19],s99 offen sc1
s_branch F_H1_B
F_H2L1_O:
buffer_load_dword v9,v8,s[16:19],s3 offen sc1
s_branch F_H2L1_B
F_P2L1_S:
s_mov_b32 s31,0
F_P2L1_L:
s_mov_b64 exec,vcc
s_sleep 2
buffer_load_dword v9,v8,s[16:19],s3 offen sc1
s_add_u32 s31,s31,1
s_waitcnt vmcnt(0)
v_cmp_gt_u32 vcc,2,v9
s_cmp_gt_u32 s31,1000000
s_cbranch_scc1 F_P2L1_X
s_cbranch_vccnz F_P2L1_L
F_P2L1_X:
s_mov_b64 exec,-1
s_branch F_P2L1_R
F_H3L1_O:
s_waitcnt vmcnt(0)
v_cmp_gt_u32 vcc,2,v9
s_nop 0
s_cbranch_vccnz F_P2L1_S
F_P2L1_R:
s_mov_b32 s8,1
s_branch F_H3L1_B
F_P2MID_S:
s_mov_b32 s31,0
F_P2MID_L:
s_mov_b64 exec,vcc
s_sleep 2
buffer_load_dword v9,v8,s[16:19],s3 offen sc1
s_add_u32 s31,s31,1
s_waitcnt vmcnt(0)
v_cmp_gt_u32 vcc,2,v9
s_cmp_gt_u32 s31,1000000
s_cbranch_scc1 F_P2MID_X
s_cbranch_vccnz F_P2MID_L
F_P2MID_X:
s_mov_b64 exec,-1
s_branch F_P2MID_R
F_H2L2_O:
buffer_load_dword v9,v8,s[16:19],s3 offen sc1
s_branch F_H2L2_B
F_P2L2_S:
s_mov_b32 s31,0
F_P2L2_L:
s_mov_b64 exec,vcc
s_sleep 2
buffer_load_dword v9,v8,s[16:19],s3 offen sc1
s_add_u32 s31,s31,1
s_waitcnt vmcnt(0)
v_cmp_gt_u32 vcc,2,v9
s_cmp_gt_u32 s31,1000000
s_cbranch_scc1 F_P2L2_X
s_cbranch_vccnz F_P2L2_L
F_P2L2_X:
s_mov_b64 exec,-1
s_branch F_P2L2_R
F_H3L2_O:
s_waitcnt vmcnt(0)
v_cmp_gt_u32 vcc,2,v9
s_nop 0
s_cbranch_vccnz F_P2L2_S
F_P2L2_R:
s_mov_b32 s8,1
s_branch F_H3L2_B
F_Y3_S:
s_mov_b32 s45,0
F_Y3_L:
s_mov_b64 exec,vcc
s_sleep 2
buffer_load_dword v33,v32,s[16:19],s44 offen sc1
s_add_u32 s45,s45,1
s_waitcnt vmcnt(0)
v_cmp_gt_u32 vcc,3,v33
s_cmp_gt_u32 s45,1000000
s_cbranch_scc1 F_Y3_X
s_cbranch_vccnz F_Y3_L
F_Y3_X:
s_mov_b64 exec,-1
s_branch F_Y3_R
F_Y4_S:
s_mov_b32 s45,0
F_Y4_L:
s_mov_b64 exec,vcc
s_sleep 2
buffer_load_dword v33,v32,s[16:19],s44 offen sc1
s_add_u32 s45,s45,1
s_waitcnt vmcnt(0)
v_cmp_gt_u32 vcc,4,v33
s_cmp_gt_u32 s45,1000000
s_cbranch_scc1 F_Y4_X
s_cbranch_vccnz F_Y4_L
F_Y4_X:
s_mov_b64 exec,-1
s_branch F_Y4_R
F_YV_S:
s_mov_b32 s45,0
F_YV_L:
s_mov_b64 exec,vcc
s_sleep 2
buffer_load_dword v37,v36,s[16:19],s50 offen sc1
s_add_u32 s45,s45,1
s_waitcnt vmcnt(0)
v_cmp_gt_u32 vcc,2,v37
s_cmp_gt_u32 s45,1000000
s_cbranch_scc1 F_YV_X
s_cbranch_vccnz F_YV_L
F_YV_X:
s_mov_b64 exec,-1
s_branch F_YV_R
F_Y5_S:
s_mov_b32 s45,0
F_Y5_L:
s_mov_b64 exec,vcc
s_sleep 2
buffer_load_dword v33,v38,s[16:19],s38 offen sc1
s_add_u32 s45,s45,1
s_waitcnt vmcnt(0)
v_cmp_gt_u32 vcc,5,v33
s_cmp_gt_u32 s45,1000000
s_cbranch_scc1 F_Y5_X
s_cbranch_vccnz F_Y5_L
F_Y5_X:
s_mov_b64 exec,-1
s_branch F_Y5_R
F_T2:
buffer_load_dword v33,v38,s[16:19],s38 offen sc1
s_waitcnt vmcnt(1)
v_mov_b32 v35,6
buffer_store_dword v35,v34,s[16:19],s99 offen sc1
s_waitcnt vmcnt(1)
v_cmp_gt_u32 vcc,5,v33
s_nop 0
s_cbranch_vccnz F_Y5_S
F_Y5_R:
buffer_load_dwordx4 v[128:131],v1,s[16:19],s32 offen offset:0 sc1
buffer_load_dwordx4 v[132:135],v1,s[16:19],s32 offen offset:1024 sc1
buffer_load_dwordx4 v[136:139],v1,s[16:19],s32 offen offset:2048 sc1
buffer_load_dwordx4 v[140:143],v1,s[16:19],s32 offen offset:3072 sc1
buffer_load_dwordx4 v[144:147],v1,s[16:19],s34 offen offset:0 sc1
buffer_load_dwordx4 v[148:151],v1,s[16:19],s34 offen offset:1024 sc1
buffer_load_dwordx4 v[152:155],v1,s[16:19],s34 offen offset:2048 sc1
buffer_load_dwordx4 v[156:159],v1,s[16:19],s34 offen offset:3072 sc1
buffer_load_dword v35,v34,s[16:19],s99 offen sc1
s_branch F_T3
F_Y6_S:
s_mov_b32 s45,0
F_Y6_L:
s_mov_b64 exec,vcc
s_sleep 2
buffer_load_dword v33,v38,s[16:19],s39 offen sc1
s_add_u32 s45,s45,1
s_waitcnt vmcnt(0)
v_cmp_gt_u32 vcc,6,v33
s_cmp_gt_u32 s45,1000000
s_cbranch_scc1 F_Y6_X
s_cbranch_vccnz F_Y6_L
F_Y6_X:
s_mov_b64 exec,-1
s_branch F_Y6_R
F_YL:
s_waitcnt lgkmcnt(6)
v_mfma_f32_16x16x32_bf16 v[132:135],a[0:3],v[192:195],0
ds_read_b64_tr_b16 a[16:17],v25 offset:0
s_and_b32 s44,s99,0xfffffe7f
s_waitcnt lgkmcnt(5)
v_mfma_f32_16x16x32_bf16 v[132:135],a[4:7],v[200:203],v[132:135]
s_barrier
ds_read_b64_tr_b16 a[18:19],v25 offset:2048
s_waitcnt lgkmcnt(4)
v_mfma_f32_16x16x32_bf16 v[132:135],a[8:11],v[208:211],v[132:135]
ds_read_b64_tr_b16 a[20:21],v25 offset:4096
v_subrev_u32 v28,65536,v24
s_waitcnt lgkmcnt(3)
v_mfma_f32_16x16x32_bf16 v[132:135],a[12:15],v[216:219],v[132:135]
ds_read_b64_tr_b16 a[22:23],v25 offset:6144
v_subrev_u32 v29,65536,v25
v_mfma_f32_16x16x32_bf16 a[192:195],a[0:3],v[224:227],0
ds_read_b64_tr_b16 a[24:25],v25 offset:8192
v_subrev_u32 v30,65536,v26
v_mfma_f32_16x16x32_bf16 a[192:195],a[4:7],v[232:235],a[192:195]
ds_read_b64_tr_b16 a[26:27],v25 offset:10240
v_subrev_u32 v31,65536,v27
v_mfma_f32_16x16x32_bf16 a[192:195],a[8:11],v[240:243],a[192:195]
s_add_u32 m0,s52,39936
ds_read_b64_tr_b16 a[28:29],v25 offset:12288
v_mfma_f32_16x16x32_bf16 a[192:195],a[12:15],v[248:251],a[192:195]
s_add_u32 s53,s55,57344
ds_read_b64_tr_b16 a[30:31],v25 offset:14336
v_mfma_f32_16x16x32_bf16 v[64:67],a[0:3],v[128:131],0
v_lshrrev_b32 v32,4,v7
v_lshlrev_b32 v32,7,v32
v_mfma_f32_16x16x32_bf16 v[64:67],a[4:7],v[136:139],v[64:67]
buffer_load_dwordx4 v0,s[12:15],s53 offen lds
v_mfma_f32_16x16x32_bf16 v[64:67],a[8:11],v[144:147],v[64:67]
s_add_u32 m0,s52,0
s_add_u32 s53,s57,0
v_mov_b32 v34,0
v_mfma_f32_16x16x32_bf16 v[64:67],a[12:15],v[152:155],v[64:67]
buffer_load_dwordx4 v0,s[12:15],s53 offen lds
v_mfma_f32_16x16x32_bf16 v[96:99],a[0:3],v[160:163],0
s_add_u32 m0,s52,1024
s_add_u32 s53,s57,8192
s_add_u32 s29,s21,1
v_mfma_f32_16x16x32_bf16 v[96:99],a[4:7],v[168:171],v[96:99]
buffer_load_dwordx4 v0,s[12:15],s53 offen lds
v_mfma_f32_16x16x32_bf16 v[96:99],a[8:11],v[176:179],v[96:99]
s_add_u32 m0,s52,2048
s_add_u32 s53,s57,16384
s_and_b32 s29,s29,3
v_mfma_f32_16x16x32_bf16 v[96:99],a[12:15],v[184:187],v[96:99]
buffer_load_dwordx4 v0,s[12:15],s53 offen lds
s_waitcnt lgkmcnt(6)
v_mfma_f32_16x16x32_bf16 v[140:143],a[16:19],v[192:195],0
ds_read_b64_tr_b16 a[32:33],v26 offset:0
s_add_u32 m0,s52,3072
s_waitcnt lgkmcnt(5)
v_mfma_f32_16x16x32_bf16 v[140:143],a[20:23],v[200:203],v[140:143]
ds_read_b64_tr_b16 a[34:35],v26 offset:2048
s_add_u32 s53,s57,24576
s_waitcnt lgkmcnt(4)
v_mfma_f32_16x16x32_bf16 v[140:143],a[24:27],v[208:211],v[140:143]
ds_read_b64_tr_b16 a[36:37],v26 offset:4096
s_and_b32 s30,s21,3
s_waitcnt lgkmcnt(3)
v_mfma_f32_16x16x32_bf16 v[140:143],a[28:31],v[216:219],v[140:143]
ds_read_b64_tr_b16 a[38:39],v26 offset:6144
s_sub_u32 s29,s29,s30
v_mfma_f32_16x16x32_bf16 a[196:199],a[16:19],v[224:227],0
ds_read_b64_tr_b16 a[40:41],v26 offset:8192
s_lshl_b32 s29,s29,12
v_mfma_f32_16x16x32_bf16 a[196:199],a[20:23],v[232:235],a[196:199]
ds_read_b64_tr_b16 a[42:43],v26 offset:10240
s_add_u32 s38,s88,s29
v_mfma_f32_16x16x32_bf16 a[196:199],a[24:27],v[240:243],a[196:199]
ds_read_b64_tr_b16 a[44:45],v26 offset:12288
s_add_u32 s41,s89,s29
v_mfma_f32_16x16x32_bf16 a[196:199],a[28:31],v[248:251],a[196:199]
ds_read_b64_tr_b16 a[46:47],v26 offset:14336
s_add_u32 s32,s86,s29
v_mfma_f32_16x16x32_bf16 v[68:71],a[16:19],v[128:131],0
buffer_load_dword v33,v32,s[16:19],s44 offen sc1
s_add_u32 s35,s87,s29
s_add_u32 s29,s21,2
s_and_b32 s29,s29,3
v_mfma_f32_16x16x32_bf16 v[68:71],a[20:23],v[136:139],v[68:71]
buffer_load_dwordx4 v0,s[12:15],s53 offen lds
v_mfma_f32_16x16x32_bf16 v[68:71],a[24:27],v[144:147],v[68:71]
s_add_u32 m0,s52,4096
s_add_u32 s53,s57,32768
s_and_b32 s30,s21,3
v_mfma_f32_16x16x32_bf16 v[68:71],a[28:31],v[152:155],v[68:71]
buffer_load_dwordx4 v0,s[12:15],s53 offen lds
v_mfma_f32_16x16x32_bf16 v[100:103],a[16:19],v[160:163],0
s_add_u32 m0,s52,5120
s_add_u32 s53,s57,40960
s_sub_u32 s29,s29,s30
v_mfma_f32_16x16x32_bf16 v[100:103],a[20:23],v[168:171],v[100:103]
buffer_load_dwordx4 v0,s[12:15],s53 offen lds
v_mfma_f32_16x16x32_bf16 v[100:103],a[24:27],v[176:179],v[100:103]
s_add_u32 m0,s52,6144
s_add_u32 s53,s57,49152
s_lshl_b32 s29,s29,12
v_mfma_f32_16x16x32_bf16 v[100:103],a[28:31],v[184:187],v[100:103]
buffer_load_dwordx4 v0,s[12:15],s53 offen lds
s_waitcnt lgkmcnt(6)
v_mfma_f32_16x16x32_bf16 v[148:151],a[32:35],v[192:195],0
ds_read_b64_tr_b16 a[48:49],v27 offset:0
s_add_u32 m0,s52,7168
s_waitcnt lgkmcnt(5)
v_mfma_f32_16x16x32_bf16 v[148:151],a[36:39],v[200:203],v[148:151]
ds_read_b64_tr_b16 a[50:51],v27 offset:2048
s_add_u32 s53,s57,57344
s_waitcnt lgkmcnt(4)
v_mfma_f32_16x16x32_bf16 v[148:151],a[40:43],v[208:211],v[148:151]
ds_read_b64_tr_b16 a[52:53],v27 offset:4096
s_add_u32 s39,s88,s29
s_waitcnt lgkmcnt(3)
v_mfma_f32_16x16x32_bf16 v[148:151],a[44:47],v[216:219],v[148:151]
ds_read_b64_tr_b16 a[54:55],v27 offset:6144
s_add_u32 s42,s89,s29
v_mfma_f32_16x16x32_bf16 a[200:203],a[32:35],v[224:227],0
ds_read_b64_tr_b16 a[56:57],v27 offset:8192
s_add_u32 s33,s86,s29
v_mfma_f32_16x16x32_bf16 a[200:203],a[36:39],v[232:235],a[200:203]
ds_read_b64_tr_b16 a[58:59],v27 offset:10240
s_add_u32 s36,s87,s29
v_mfma_f32_16x16x32_bf16 a[200:203],a[40:43],v[240:243],a[200:203]
ds_read_b64_tr_b16 a[60:61],v27 offset:12288
s_add_u32 s29,s21,3
v_mfma_f32_16x16x32_bf16 a[200:203],a[44:47],v[248:251],a[200:203]
ds_read_b64_tr_b16 a[62:63],v27 offset:14336
s_and_b32 s29,s29,3
v_mfma_f32_16x16x32_bf16 v[72:75],a[32:35],v[128:131],0
s_and_b32 s30,s21,3
s_sub_u32 s29,s29,s30
s_lshl_b32 s29,s29,12
v_mfma_f32_16x16x32_bf16 v[72:75],a[36:39],v[136:139],v[72:75]
buffer_load_dwordx4 v0,s[12:15],s53 offen lds
v_mfma_f32_16x16x32_bf16 v[72:75],a[40:43],v[144:147],v[72:75]
s_add_u32 s40,s88,s29
s_add_u32 s43,s89,s29
s_add_u32 s34,s86,s29
v_mfma_f32_16x16x32_bf16 v[72:75],a[44:47],v[152:155],v[72:75]
s_add_u32 s37,s87,s29
s_mov_b32 s68,s94
s_and_b32 s69,s95,0xffff
v_mfma_f32_16x16x32_bf16 v[104:107],a[32:35],v[160:163],0
s_mov_b32 s70,2097152
s_mov_b32 s71,0x20000
s_and_b32 s50,s99,0xfffff07f
v_mfma_f32_16x16x32_bf16 v[104:107],a[36:39],v[168:171],v[104:107]
v_lshrrev_b32 v36,1,v7
v_lshlrev_b32 v36,7,v36
v_mfma_f32_16x16x32_bf16 v[104:107],a[40:43],v[176:179],v[104:107]
s_waitcnt lgkmcnt(4)
v_lshrrev_b32 v51,5,v7
v_bfe_u32 v48,v7,4,1
v_mfma_f32_16x16x32_bf16 v[104:107],a[44:47],v[184:187],v[104:107]
s_and_b32 s29,s2,7
s_lshl_b32 s29,s29,5
v_and_b32 v9,31,v7
v_mfma_f32_16x16x32_bf16 v[156:159],a[48:51],v[192:195],0
ds_read_b64_tr_b16 a[0:1],v24 offset:16384
v_add_u32 v9,s29,v9
v_mfma_f32_16x16x32_bf16 v[156:159],a[52:55],v[200:203],v[156:159]
ds_read_b64_tr_b16 a[2:3],v24 offset:18432
s_lshr_b32 s29,s2,3
s_waitcnt lgkmcnt(4)
v_mfma_f32_16x16x32_bf16 v[156:159],a[56:59],v[208:211],v[156:159]
ds_read_b64_tr_b16 a[4:5],v24 offset:20480
s_lshl_b32 s29,s29,6
s_waitcnt lgkmcnt(3)
v_mfma_f32_16x16x32_bf16 v[156:159],a[60:63],v[216:219],v[156:159]
ds_read_b64_tr_b16 a[6:7],v24 offset:22528
s_lshl_b32 s30,s20,4
v_mfma_f32_16x16x32_bf16 a[204:207],a[48:51],v[224:227],0
ds_read_b64_tr_b16 a[8:9],v24 offset:24576
s_add_u32 s29,s29,s30
v_mfma_f32_16x16x32_bf16 a[204:207],a[52:55],v[232:235],a[204:207]
ds_read_b64_tr_b16 a[10:11],v24 offset:26624
v_lshlrev_b32 v10,3,v51
v_mfma_f32_16x16x32_bf16 a[204:207],a[56:59],v[240:243],a[204:207]
ds_read_b64_tr_b16 a[12:13],v24 offset:28672
v_add_u32 v10,s29,v10
v_mfma_f32_16x16x32_bf16 a[204:207],a[60:63],v[248:251],a[204:207]
ds_read_b64_tr_b16 a[14:15],v24 offset:30720
v_lshlrev_b32 v8,10,v10
v_mfma_f32_16x16x32_bf16 v[76:79],a[48:51],v[128:131],0
s_waitcnt vmcnt(10)
v_mov_b32 v35,4
buffer_store_dword v35,v34,s[16:19],s99 offen sc1
v_mfma_f32_16x16x32_bf16 v[76:79],a[52:55],v[136:139],v[76:79]
v_lshl_add_u32 v8,v9,2,v8
s_movk_i32 s77,4096
v_mfma_f32_16x16x32_bf16 v[76:79],a[56:59],v[144:147],v[76:79]
v_lshlrev_b32 v15,11,v10
v_lshl_add_u32 v15,v9,2,v15
v_mfma_f32_16x16x32_bf16 v[76:79],a[60:63],v[152:155],v[76:79]
v_lshrrev_b32 v13,4,v7
v_lshl_add_u32 v12,v13,2,s20
v_mfma_f32_16x16x32_bf16 v[108:111],a[48:51],v[160:163],0
s_waitcnt vmcnt(6)
v_cmp_gt_u32 vcc,3,v33
s_nop 0
s_cbranch_vccnz F_Y3_S
F_Y3_R:
v_xor_b32 v12,v12,v7
v_and_b32 v12,15,v12
v_mfma_f32_16x16x32_bf16 v[108:111],a[52:55],v[168:171],v[108:111]
buffer_load_dwordx4 a[224:227],v1,s[16:19],s39 offen offset:0 sc1
v_lshlrev_b32 v12,4,v12
v_lshl_add_u32 v14,v13,13,v12
v_mfma_f32_16x16x32_bf16 v[108:111],a[56:59],v[176:179],v[108:111]
buffer_load_dwordx4 a[228:231],v1,s[16:19],s39 offen offset:1024 sc1
s_and_b32 s72,s2,7
s_lshl_b32 s72,s72,2
s_add_u32 s72,s72,s20
v_mfma_f32_16x16x32_bf16 v[108:111],a[60:63],v[184:187],v[108:111]
s_lshl_b32 s72,s72,16
s_lshr_b32 s73,s2,3
s_lshl_b32 s73,s73,8
s_waitcnt lgkmcnt(6)
v_mfma_f32_16x16x32_bf16 v[164:167],a[0:3],v[192:195],0
ds_read_b64_tr_b16 a[16:17],v25 offset:16384
s_add_u32 s72,s72,s73
s_waitcnt lgkmcnt(5)
v_mfma_f32_16x16x32_bf16 v[164:167],a[4:7],v[200:203],v[164:167]
ds_read_b64_tr_b16 a[18:19],v25 offset:18432
s_add_u32 s72,s72,58720256
s_waitcnt lgkmcnt(4)
v_mfma_f32_16x16x32_bf16 v[164:167],a[8:11],v[208:211],v[164:167]
ds_read_b64_tr_b16 a[20:21],v25 offset:20480
s_add_u32 s73,s72,31744
s_waitcnt lgkmcnt(3)
v_mfma_f32_16x16x32_bf16 v[164:167],a[12:15],v[216:219],v[164:167]
ds_read_b64_tr_b16 a[22:23],v25 offset:22528
s_lshl_b32 s74,s20,11
v_mfma_f32_16x16x32_bf16 a[208:211],a[0:3],v[224:227],0
ds_read_b64_tr_b16 a[24:25],v25 offset:24576
s_add_u32 s74,s74,98304
v_mfma_f32_16x16x32_bf16 a[208:211],a[4:7],v[232:235],a[208:211]
ds_read_b64_tr_b16 a[26:27],v25 offset:26624
v_and_b32 v12,3,v7
v_mfma_f32_16x16x32_bf16 a[208:211],a[8:11],v[240:243],a[208:211]
ds_read_b64_tr_b16 a[28:29],v25 offset:28672
v_lshlrev_b32 v12,2,v12
v_mfma_f32_16x16x32_bf16 a[208:211],a[12:15],v[248:251],a[208:211]
ds_read_b64_tr_b16 a[30:31],v25 offset:30720
v_bfe_u32 v13,v7,3,2
v_mfma_f32_16x16x32_bf16 v[80:83],a[0:3],v[128:131],0
buffer_load_dwordx4 a[232:235],v1,s[16:19],s39 offen offset:2048 sc1
v_add_u32 v12,v12,v13
s_lshl_b32 s29,s20,2
v_mfma_f32_16x16x32_bf16 v[80:83],a[4:7],v[136:139],v[80:83]
v_lshl_add_u32 v13,v51,1,s29
v_xor_b32 v12,v12,v13
v_mfma_f32_16x16x32_bf16 v[80:83],a[8:11],v[144:147],v[80:83]
buffer_load_dwordx4 a[236:239],v1,s[16:19],s39 offen offset:3072 sc1
v_lshlrev_b32 v12,4,v12
v_and_b32 v13,31,v7
v_mfma_f32_16x16x32_bf16 v[80:83],a[12:15],v[152:155],v[80:83]
buffer_load_dwordx4 a[240:243],v1,s[16:19],s42 offen offset:0 sc1
v_lshl_add_u32 v12,v13,8,v12
v_add_u32 v12,98304,v12
v_mfma_f32_16x16x32_bf16 v[112:115],a[0:3],v[160:163],0
v_xor_b32 v13,16,v12
v_mfma_f32_16x16x32_bf16 v[112:115],a[4:7],v[168:171],v[112:115]
buffer_load_dwordx4 a[244:247],v1,s[16:19],s42 offen offset:1024 sc1
v_mfma_f32_16x16x32_bf16 v[112:115],a[8:11],v[176:179],v[112:115]
s_waitcnt lgkmcnt(4)
v_mfma_f32_16x16x32_bf16 v[112:115],a[12:15],v[184:187],v[112:115]
buffer_load_dwordx4 a[248:251],v1,s[16:19],s42 offen offset:2048 sc1
v_mfma_f32_16x16x32_bf16 v[172:175],a[16:19],v[192:195],0
ds_read_b64_tr_b16 a[32:33],v26 offset:16384
v_mfma_f32_16x16x32_bf16 v[172:175],a[20:23],v[200:203],v[172:175]
ds_read_b64_tr_b16 a[34:35],v26 offset:18432
s_waitcnt lgkmcnt(4)
v_mfma_f32_16x16x32_bf16 v[172:175],a[24:27],v[208:211],v[172:175]
ds_read_b64_tr_b16 a[36:37],v26 offset:20480
s_waitcnt lgkmcnt(3)
v_mfma_f32_16x16x32_bf16 v[172:175],a[28:31],v[216:219],v[172:175]
ds_read_b64_tr_b16 a[38:39],v26 offset:22528
v_mfma_f32_16x16x32_bf16 a[212:215],a[16:19],v[224:227],0
ds_read_b64_tr_b16 a[40:41],v26 offset:24576
v_mfma_f32_16x16x32_bf16 a[212:215],a[20:23],v[232:235],a[212:215]
ds_read_b64_tr_b16 a[42:43],v26 offset:26624
v_mfma_f32_16x16x32_bf16 a[212:215],a[24:27],v[240:243],a[212:215]
ds_read_b64_tr_b16 a[44:45],v26 offset:28672
v_mfma_f32_16x16x32_bf16 a[212:215],a[28:31],v[248:251],a[212:215]
ds_read_b64_tr_b16 a[46:47],v26 offset:30720
v_mfma_f32_16x16x32_bf16 v[84:87],a[16:19],v[128:131],0
buffer_load_dwordx4 a[252:255],v1,s[16:19],s42 offen offset:3072 sc1
v_mfma_f32_16x16x32_bf16 v[84:87],a[20:23],v[136:139],v[84:87]
v_mfma_f32_16x16x32_bf16 v[84:87],a[24:27],v[144:147],v[84:87]
buffer_load_dwordx4 v[196:199],v1,s[16:19],s38 offen offset:0 sc1
v_mfma_f32_16x16x32_bf16 v[84:87],a[28:31],v[152:155],v[84:87]
v_mfma_f32_16x16x32_bf16 v[116:119],a[16:19],v[160:163],0
buffer_load_dwordx4 v[204:207],v1,s[16:19],s38 offen offset:1024 sc1
v_mfma_f32_16x16x32_bf16 v[116:119],a[20:23],v[168:171],v[116:119]
buffer_load_dwordx4 v[212:215],v1,s[16:19],s38 offen offset:2048 sc1
v_mfma_f32_16x16x32_bf16 v[116:119],a[24:27],v[176:179],v[116:119]
s_waitcnt lgkmcnt(4)
v_mfma_f32_16x16x32_bf16 v[116:119],a[28:31],v[184:187],v[116:119]
buffer_load_dwordx4 v[220:223],v1,s[16:19],s38 offen offset:3072 sc1
v_mfma_f32_16x16x32_bf16 v[180:183],a[32:35],v[192:195],0
ds_read_b64_tr_b16 a[48:49],v27 offset:16384
v_mfma_f32_16x16x32_bf16 v[180:183],a[36:39],v[200:203],v[180:183]
ds_read_b64_tr_b16 a[50:51],v27 offset:18432
s_waitcnt lgkmcnt(4)
v_mfma_f32_16x16x32_bf16 v[180:183],a[40:43],v[208:211],v[180:183]
ds_read_b64_tr_b16 a[52:53],v27 offset:20480
s_waitcnt lgkmcnt(3)
v_mfma_f32_16x16x32_bf16 v[180:183],a[44:47],v[216:219],v[180:183]
ds_read_b64_tr_b16 a[54:55],v27 offset:22528
v_mfma_f32_16x16x32_bf16 a[216:219],a[32:35],v[224:227],0
ds_read_b64_tr_b16 a[56:57],v27 offset:24576
s_and_b32 s29,s21,3
v_mfma_f32_16x16x32_bf16 a[216:219],a[36:39],v[232:235],a[216:219]
ds_read_b64_tr_b16 a[58:59],v27 offset:26624
s_lshl_b32 s29,s29,15
v_mfma_f32_16x16x32_bf16 a[216:219],a[40:43],v[240:243],a[216:219]
ds_read_b64_tr_b16 a[60:61],v27 offset:28672
s_and_b32 s30,s2,7
v_mfma_f32_16x16x32_bf16 a[216:219],a[44:47],v[248:251],a[216:219]
ds_read_b64_tr_b16 a[62:63],v27 offset:30720
s_lshl_b32 s30,s30,10
v_mfma_f32_16x16x32_bf16 v[88:91],a[32:35],v[128:131],0
s_add_u32 s29,s29,s30
s_add_u32 s29,s29,67108864
s_lshl_b32 s46,s80,17
v_mfma_f32_16x16x32_bf16 v[88:91],a[36:39],v[136:139],v[88:91]
s_waitcnt vmcnt(31) lgkmcnt(0)
s_add_u32 s46,s46,s29
s_lshl_b32 s47,s81,17
v_mfma_f32_16x16x32_bf16 v[88:91],a[40:43],v[144:147],v[88:91]
s_barrier
s_add_u32 s47,s47,s29
s_lshl_b32 s48,s82,17
v_mfma_f32_16x16x32_bf16 v[88:91],a[44:47],v[152:155],v[88:91]
buffer_load_dwordx4 v[228:231],v1,s[16:19],s41 offen offset:0 sc1
s_add_u32 s48,s48,s29
s_lshl_b32 s49,s83,17
s_add_u32 s49,s49,s29
v_mfma_f32_16x16x32_bf16 v[120:123],a[32:35],v[160:163],0
buffer_load_dwordx4 v[236:239],v1,s[16:19],s41 offen offset:1024 sc1
ds_read_b64_tr_b16 a[0:1],v28 offset:0
s_mov_b32 s12,s92
v_mfma_f32_16x16x32_bf16 v[120:123],a[36:39],v[168:171],v[120:123]
ds_read_b64_tr_b16 a[2:3],v28 offset:2048
s_and_b32 s13,s93,0xffff
v_mfma_f32_16x16x32_bf16 v[120:123],a[40:43],v[176:179],v[120:123]
buffer_load_dwordx4 v[244:247],v1,s[16:19],s41 offen offset:2048 sc1
ds_read_b64_tr_b16 a[4:5],v28 offset:4096
v_subrev_u32 v24,131072,v24
v_mfma_f32_16x16x32_bf16 v[120:123],a[44:47],v[184:187],v[120:123]
ds_read_b64_tr_b16 a[6:7],v28 offset:6144
v_subrev_u32 v25,131072,v25
v_mfma_f32_16x16x32_bf16 v[188:191],a[48:51],v[192:195],0
buffer_load_dwordx4 v[252:255],v1,s[16:19],s41 offen offset:3072 sc1
ds_read_b64_tr_b16 a[8:9],v28 offset:8192
v_subrev_u32 v26,131072,v26
v_mfma_f32_16x16x32_bf16 v[188:191],a[52:55],v[200:203],v[188:191]
buffer_load_dwordx4 a[160:163],v1,s[16:19],s40 offen offset:0 sc1
ds_read_b64_tr_b16 a[10:11],v28 offset:10240
v_subrev_u32 v27,131072,v27
v_mfma_f32_16x16x32_bf16 v[188:191],a[56:59],v[208:211],v[188:191]
ds_read_b64_tr_b16 a[12:13],v28 offset:12288
v_mfma_f32_16x16x32_bf16 v[188:191],a[60:63],v[216:219],v[188:191]
buffer_load_dwordx4 a[164:167],v1,s[16:19],s40 offen offset:1024 sc1
ds_read_b64_tr_b16 a[14:15],v28 offset:14336
v_mfma_f32_16x16x32_bf16 a[220:223],a[48:51],v[224:227],0
v_mfma_f32_16x16x32_bf16 a[220:223],a[52:55],v[232:235],a[220:223]
buffer_load_dwordx4 a[168:171],v1,s[16:19],s40 offen offset:2048 sc1
ds_read_b64_tr_b16 a[16:17],v29 offset:0
v_mfma_f32_16x16x32_bf16 a[220:223],a[56:59],v[240:243],a[220:223]
buffer_load_dwordx4 a[172:175],v1,s[16:19],s40 offen offset:3072 sc1
ds_read_b64_tr_b16 a[18:19],v29 offset:2048
v_mfma_f32_16x16x32_bf16 a[220:223],a[60:63],v[248:251],a[220:223]
ds_read_b64_tr_b16 a[20:21],v29 offset:4096
v_mfma_f32_16x16x32_bf16 v[92:95],a[48:51],v[128:131],0
buffer_load_dwordx4 a[176:179],v1,s[16:19],s43 offen offset:0 sc1
ds_read_b64_tr_b16 a[22:23],v29 offset:6144
v_mfma_f32_16x16x32_bf16 v[92:95],a[52:55],v[136:139],v[92:95]
ds_read_b64_tr_b16 a[24:25],v29 offset:8192
v_mfma_f32_16x16x32_bf16 v[92:95],a[56:59],v[144:147],v[92:95]
buffer_load_dwordx4 a[180:183],v1,s[16:19],s43 offen offset:1024 sc1
ds_read_b64_tr_b16 a[26:27],v29 offset:10240
v_mfma_f32_16x16x32_bf16 v[92:95],a[60:63],v[152:155],v[92:95]
buffer_load_dwordx4 a[184:187],v1,s[16:19],s43 offen offset:2048 sc1
ds_read_b64_tr_b16 a[28:29],v29 offset:12288
v_mfma_f32_16x16x32_bf16 v[124:127],a[48:51],v[160:163],0
ds_read_b64_tr_b16 a[30:31],v29 offset:14336
v_mfma_f32_16x16x32_bf16 v[124:127],a[52:55],v[168:171],v[124:127]
buffer_load_dwordx4 a[188:191],v1,s[16:19],s43 offen offset:3072 sc1
v_mfma_f32_16x16x32_bf16 v[124:127],a[56:59],v[176:179],v[124:127]
v_mfma_f32_16x16x32_bf16 v[124:127],a[60:63],v[184:187],v[124:127]
s_waitcnt vmcnt(16)
s_branch F_YB
F_END:
  s_endpgm
.p2align 8
  s_endpgm
  s_endpgm
  s_endpgm
  s_endpgm
.section .rodata,"a"
.p2align 6
.amdhsa_kernel concat_heads__ssm_conv_h3__compressed_kv_cla__prompt_kernel
  .amdhsa_next_free_vgpr 512
  .amdhsa_next_free_sgpr 102
  .amdhsa_accum_offset 256
  .amdhsa_group_segment_fixed_size 0
  .amdhsa_kernarg_size 120
  .amdhsa_user_sgpr_count 2
  .amdhsa_user_sgpr_kernarg_segment_ptr 1
  .amdhsa_system_sgpr_workgroup_id_x 1
  .amdhsa_float_denorm_mode_32 3
.end_amdhsa_kernel
```
